```python
import torch

def _softmax(x, axis=-1):
    return torch.softmax(x, dim=axis)
def _gelu(x):
    return torch.nn.functional.gelu(x, approximate="tanh")
def _silu(x):
    return torch.nn.functional.silu(x)
def _sigmoid(x):
    return torch.sigmoid(x)
def _layernorm(x, axis=-1, eps=1e-5):
    m = x.mean(dim=axis, keepdim=True)
    v = x.var(dim=axis, keepdim=True, unbiased=False)
    return (x - m) / torch.sqrt(v + eps)
def _scatter_add(tgt, idx, src, axis=0):
    return tgt.clone().index_add_(axis, idx, src)
def _segment_sum(src, seg, n):
    out = torch.zeros((n,) + src.shape[1:], dtype=src.dtype)
    return out.index_add_(0, seg, src)
def _pad(x, pw):
    flat = tuple(v for pair in reversed(pw) for v in pair)
    return torch.nn.functional.pad(x, flat)

kernel_name = 'gated_mix__linear_attn_block__moe_arch_mod__prompt'

def setup_inputs():

    _w = (lambda a: (lambda t: t.to(torch.bfloat16) if t.is_floating_point() else t)(torch.as_tensor(a)))
    def _A_setup():
        B, S, D = 1, 2048, 1024
        return {
            "x": _w((lambda *s: torch.randn(*s, dtype=torch.bfloat16) * 0.05)(B, S, D)),
            "wqkv": _w((lambda *s: torch.randn(*s, dtype=torch.bfloat16) * 0.8)(D, 3 * D)),
            "wo": _w((lambda *s: torch.randn(*s, dtype=torch.bfloat16) * 0.1)(D, D)),
        }
    _A_in = _A_setup()

    def _B_setup():
        B, S, D, F, C = 1, 2048, 1024, 3584, 1
        return {
            "x": _w((lambda *s: torch.randn(*s, dtype=torch.bfloat16) * 0.05)(B, S, D)),
            "w_r": _w((lambda *s: torch.randn(*s, dtype=torch.bfloat16) * 1.6)(D)),
            "w_gate": _w((lambda *s: torch.randn(*s, dtype=torch.bfloat16) * 0.1)(D, F)),
            "w_up": _w((lambda *s: torch.randn(*s, dtype=torch.bfloat16) * 0.1)(D, F)),
            "w_down": _w((lambda *s: torch.randn(*s, dtype=torch.bfloat16) * 0.1)(F, D)),
        }
    _B_in = _B_setup()

    return {
        "A_x": _A_in["x"],
        "A_wqkv": _A_in["wqkv"],
        "A_wo": _A_in["wo"],
        "B_x": _B_in["x"],
        "B_w_r": _B_in["w_r"],
        "B_w_gate": _B_in["w_gate"],
        "B_w_up": _B_in["w_up"],
        "B_w_down": _B_in["w_down"],
        "gate_w": _w((lambda *s: torch.randn(*s, dtype=torch.bfloat16) * 0.05)(1024) * 16.0),
    }

def reference(A_x, A_wqkv, A_wo, B_x, B_w_r, B_w_gate, B_w_up, B_w_down, gate_w):
    def _A_ref(x, wqkv, wo):
        B, S, D = x.shape
        H = 32; Dh = D // H
        qkv = (lambda x, *d: x.permute(*d))((x @ wqkv).reshape(B, S, 3, H, Dh), 2, 0, 3, 1, 4)
        q, k, v = qkv[0], qkv[1], qkv[2]
        phi = lambda t: torch.where(t > 0, t + 1, torch.exp(t)) + 1e-6
        pq, pk = phi(q), phi(k)
        kv = torch.einsum("bhsd,bhse->bhde", pk, v)
        z = torch.einsum("bhsd->bhd", pk)
        num = torch.einsum("bhqd,bhde->bhqe", pq, kv)
        den = torch.einsum("bhqd,bhd->bhq", pq, z)[..., None] + 1e-6
        o = num / den
        return (lambda x, *d: x.permute(*d))(o, 0, 2, 1, 3).reshape(B, S, D) @ wo

    def _B_ref(x, w_r, w_gate, w_up, w_down):
        B, S, D = x.shape
        C = 1
        r = x @ w_r
        idx = torch.argsort(-r, axis=-1)[:, :C]
        idx_e = (lambda x, n, axis: torch.repeat_interleave(x, n, dim=axis))(idx.reshape(B, C, 1), D, axis=2)
        x_sel = (lambda x, i, axis: torch.take_along_dim(x, i, dim=axis))(x, idx_e, axis=1)
        g = _silu(x_sel @ w_gate)
        u = x_sel @ w_up
        y = (g * u) @ w_down
        r_sel = _sigmoid((lambda x, i, axis: torch.take_along_dim(x, i, dim=axis))(r, idx, axis=1))
        y = y * r_sel.reshape(B, C, 1)
        b_off = (torch.arange(B) * S).reshape(B, 1)
        flat_idx = (idx + b_off).reshape(B * C)
        zero = (x * 0.0).reshape(B * S, D)
        upd = _scatter_add(zero, flat_idx, y.reshape(B * C, D), axis=0)
        return x + upd.reshape(B, S, D)

    x = A_x
    g = _sigmoid((x * gate_w).sum(-1, keepdims=True))
    a = _A_ref(x, A_wqkv, A_wo)
    b = _B_ref(x, B_w_r, B_w_gate, B_w_up, B_w_down)
    return g * a + (1 - g) * b
```

```asm
; @launch grid=(256,1,1) block=(512,1,1) lds=163840
.amdgcn_target "amdgcn-amd-amdhsa--gfx950"
.text
.globl gated_mix__linear_attn_block__moe_arch_mod__prompt_kernel
.p2align 8
.type gated_mix__linear_attn_block__moe_arch_mod__prompt_kernel,@function
gated_mix__linear_attn_block__moe_arch_mod__prompt_kernel:
    s_cmp_ge_u32 s2, 256
    s_cbranch_scc1 END
    s_load_dwordx2 s[8:9], s[0:1], 0
    s_load_dwordx2 s[12:13], s[0:1], 8
    s_load_dwordx8 s[48:55], s[0:1], 32
    s_load_dwordx8 s[56:63], s[0:1], 64
    s_load_dwordx2 s[20:21], s[0:1], 16
    s_getpc_b64 s[64:65]
PC0:
    s_and_b32 s66, s2, 0xf8
    v_and_b32 v1, 31, v0
    v_lshl_add_u32 v1, s66, 2, v1
    v_lshlrev_b32 v1, 6, v1
    v_min_u32 v1, CODE_END-PC0-4, v1
    global_load_dword v255, v1, s[64:65]
    v_lshrrev_b32 v1, 6, v0
    v_and_b32 v2, 63, v0
    s_and_b32 s64, s2, 7
    v_readfirstlane_b32 s3, v1
    s_lshr_b32 s65, s2, 3
    s_and_b32 s4, s64, 1
    s_lshl_b32 s4, s4, 3
    s_and_b32 s66, s65, 7
    s_add_u32 s4, s4, s66
    s_lshr_b32 s5, s64, 1
    s_lshl_b32 s5, s5, 2
    s_lshr_b32 s66, s65, 3
    s_add_u32 s5, s5, s66
    s_and_b32 s44, s3, 3
    s_lshr_b32 s45, s3, 2
    v_lshrrev_b32 v6, 3, v2
    s_lshl_b32 s66, s44, 3
    v_add_u32 v6, s66, v6
    s_lshl_b32 s66, s4, 7
    v_add_u32 v7, s66, v6
    v_lshlrev_b32 v7, 11, v7
    v_lshrrev_b32 v8, 4, v2
    s_and_b32 s67, s44, 1
    s_lshl_b32 s66, s67, 2
    v_add_u32 v9, s66, v8
    v_and_b32 v10, 7, v2
    v_xor_b32 v9, v9, v10
    v_lshl_add_u32 v4, v9, 4, v7
    v_mul_u32_u24 v6, 6144, v6
    v_and_b32 v9, 1, v8
    v_lshlrev_b32 v9, 2, v9
    v_xor_b32 v9, v9, v10
    s_lshl_b32 s66, s67, 1
    v_xor_b32 v9, s66, v9
    v_lshl_add_u32 v6, v9, 4, v6
    s_lshl_b32 s66, s5, 7
    v_add_u32 v5, s66, v6
    s_mov_b32 s10, 0x400000
    s_mov_b32 s11, 0x00020000
    s_mov_b32 s14, 0x600000
    s_mov_b32 s15, 0x00020000
    s_lshl_b32 s72, s44, 10
    s_lshl_b32 s66, s45, 13
    s_add_u32 s68, s72, s66
    s_lshl_b32 s66, s45, 12
    s_add_u32 s69, s72, s66
    s_and_b32 s66, s65, 7
    s_mul_i32 s76, s66, 2
    s_lshr_b32 s66, s64, 1
    s_mul_i32 s66, s66, 4
    s_add_u32 s76, s76, s66
    s_add_u32 s71, s76, 0
    s_and_b32 s71, s71, 15
    s_lshl_b32 s70, s71, 7
    s_mul_i32 s71, s71, 393216
    s_lshl_b32 s66, s45, 17
    s_add_u32 s70, s70, s66
    s_mul_i32 s66, s45, 196608
    s_add_u32 s71, s71, s66
    s_waitcnt lgkmcnt(0)
    s_add_u32 m0, s69, 24576
    s_add_u32 s66, s71, 2048
    buffer_load_dwordx4 v5, s[12:15], s66 offen lds
    s_add_u32 m0, s69, 32768
    s_add_u32 s66, s71, 4096
    buffer_load_dwordx4 v5, s[12:15], s66 offen lds
    s_add_u32 m0, s69, 16384
    s_add_u32 s66, s71, 0
    buffer_load_dwordx4 v5, s[12:15], s66 offen lds
    s_add_u32 m0, s68, 0
    s_add_u32 s66, s70, 0
    buffer_load_dwordx4 v4, s[8:11], s66 offen lds
    s_add_u32 m0, s68, 4096
    s_add_u32 s66, s70, 65536
    buffer_load_dwordx4 v4, s[8:11], s66 offen lds
    s_barrier
    s_add_u32 s71, s76, 1
    s_and_b32 s71, s71, 15
    s_lshl_b32 s70, s71, 7
    s_mul_i32 s71, s71, 393216
    s_lshl_b32 s66, s45, 17
    s_add_u32 s70, s70, s66
    s_mul_i32 s66, s45, 196608
    s_add_u32 s71, s71, s66
    s_add_u32 m0, s69, 65536
    s_add_u32 s66, s71, 2048
    buffer_load_dwordx4 v5, s[12:15], s66 offen lds
    s_add_u32 m0, s69, 73728
    s_add_u32 s66, s71, 4096
    buffer_load_dwordx4 v5, s[12:15], s66 offen lds
    s_add_u32 m0, s69, 57344
    s_add_u32 s66, s71, 0
    buffer_load_dwordx4 v5, s[12:15], s66 offen lds
    s_add_u32 m0, s68, 40960
    s_add_u32 s66, s70, 0
    buffer_load_dwordx4 v4, s[8:11], s66 offen lds
    s_add_u32 m0, s68, 45056
    s_add_u32 s66, s70, 65536
    buffer_load_dwordx4 v4, s[8:11], s66 offen lds
    s_mov_b32 s16, s62
    s_mov_b32 s17, s63
    s_mov_b32 s32, s54
    s_mov_b32 s33, s55
    s_mov_b32 s36, s58
    s_mov_b32 s37, s59
    s_mov_b32 s40, s60
    s_mov_b32 s41, s61
    s_mov_b32 s18, 0x10000000
    s_mov_b32 s19, 0x00020000
    s_mov_b32 s34, 0x700000
    s_mov_b32 s35, 0x00020000
    s_mov_b32 s38, 0x400000
    s_mov_b32 s39, 0x00020000
    s_mov_b32 s42, 0x100
    s_mov_b32 s43, 0x00020000
    s_mov_b32 s22, 0x200000
    s_mov_b32 s23, 0x00020000
    s_bitcmp0_b32 s44, 0
    s_cselect_b32 s24, s48, s56
    s_cselect_b32 s25, s49, s57
    s_mov_b32 s26, 0x800
    s_mov_b32 s27, 0x00020000
    s_bitcmp0_b32 s44, 0
    s_cselect_b32 s28, s50, s52
    s_cselect_b32 s29, s51, s53
    s_mov_b32 s30, 0x700000
    s_mov_b32 s31, 0x00020000
    s_lshr_b32 s66, s64, 2
    s_lshl_b32 s66, s66, 1
    s_and_b32 s67, s64, 1
    s_add_u32 s66, s66, s67
    s_lshl_b32 s67, s65, 2
    s_add_u32 s66, s66, s67
    s_add_u32 s66, s66, 96
    s_bitcmp0_b32 s64, 1
    s_cselect_b32 s67, 32, 0
    s_add_u32 s66, s66, s67
    s_cmp_lt_u32 s65, 24
    s_cselect_b32 s67, s2, s66
    s_cmp_ge_u32 s67, 224
    s_cselect_b32 s30, 0, s30
    s_cselect_b32 s34, 0, s34
    s_lshr_b32 s79, s67, 2
    s_and_b32 s73, s67, 3
    s_and_b32 s6, s64, 3
    s_lshl_b32 s6, s6, 2
    s_and_b32 s66, s65, 3
    s_add_u32 s6, s6, s66
    s_lshr_b32 s7, s64, 2
    s_lshl_b32 s7, s7, 3
    s_lshr_b32 s66, s65, 2
    s_add_u32 s7, s7, s66
    s_mov_b32 s46, 0x3fb8aa3b
    s_mov_b32 s47, 0x358637bd
    s_cmp_ge_u32 s3, 4
    s_cbranch_scc1 HELP
    s_and_b32 s48, s3, 1
    s_lshr_b32 s49, s3, 1
    v_and_b32 v3, 15, v2
    s_lshl_b32 s66, s48, 6
    v_add_u32 v3, s66, v3
    v_lshlrev_b32 v3, 7, v3
    v_bfe_u32 v9, v2, 1, 3
    v_lshrrev_b32 v15, 4, v2
    v_xor_b32 v9, v9, v15
    v_xor_b32 v12, 0, v9
    v_lshl_add_u32 v4, v12, 4, v3
    v_xor_b32 v12, 4, v9
    v_lshl_add_u32 v5, v12, 4, v3
    v_bfe_u32 v12, v2, 2, 2
    v_lshl_add_u32 v13, v15, 3, v12
    v_lshlrev_b32 v13, 7, v13
    v_lshrrev_b32 v12, 1, v12
    v_xor_b32 v12, s49, v12
    v_lshl_add_u32 v13, v12, 6, v13
    v_and_b32 v12, 3, v2
    v_lshl_add_u32 v13, v12, 3, v13
    v_add_u32 v13, 16384, v13
    v_and_b32 v12, 1, v15
    v_xor_b32 v14, 0, v12
    v_lshl_add_u32 v6, v14, 5, v13
    v_xor_b32 v14, 1, v12
    v_lshl_add_u32 v7, v14, 5, v13
    v_mov_b32 v8, v4
    v_mov_b32 v9, v5
    v_mov_b32 v10, v6
    v_mov_b32 v11, v7
    v_mov_b32 v96, 0
    v_mov_b32 v97, 0
    v_mov_b32 v98, 0
    v_mov_b32 v99, 0
    v_mov_b32 v100, 0
    v_mov_b32 v101, 0
    v_mov_b32 v102, 0
    v_mov_b32 v103, 0
    v_mov_b32 v104, 0
    v_mov_b32 v105, 0
    v_mov_b32 v106, 0
    v_mov_b32 v107, 0
    v_mov_b32 v108, 0
    v_mov_b32 v109, 0
    v_mov_b32 v110, 0
    v_mov_b32 v111, 0
    v_mov_b32 v112, 0
    v_mov_b32 v113, 0
    v_mov_b32 v114, 0
    v_mov_b32 v115, 0
    v_mov_b32 v116, 0
    v_mov_b32 v117, 0
    v_mov_b32 v118, 0
    v_mov_b32 v119, 0
    v_mov_b32 v120, 0
    v_mov_b32 v121, 0
    v_mov_b32 v122, 0
    v_mov_b32 v123, 0
    v_mov_b32 v124, 0
    v_mov_b32 v125, 0
    v_mov_b32 v126, 0
    v_mov_b32 v127, 0
    v_mov_b32 v128, 0
    v_mov_b32 v129, 0
    v_mov_b32 v130, 0
    v_mov_b32 v131, 0
    v_mov_b32 v132, 0
    v_mov_b32 v133, 0
    v_mov_b32 v134, 0
    v_mov_b32 v135, 0
    v_mov_b32 v136, 0
    v_mov_b32 v137, 0
    v_mov_b32 v138, 0
    v_mov_b32 v139, 0
    v_mov_b32 v140, 0
    v_mov_b32 v141, 0
    v_mov_b32 v142, 0
    v_mov_b32 v143, 0
    v_mov_b32 v144, 0
    v_mov_b32 v145, 0
    v_mov_b32 v146, 0
    v_mov_b32 v147, 0
    v_mov_b32 v148, 0
    v_mov_b32 v149, 0
    v_mov_b32 v150, 0
    v_mov_b32 v151, 0
    v_mov_b32 v152, 0
    v_mov_b32 v153, 0
    v_mov_b32 v154, 0
    v_mov_b32 v155, 0
    v_mov_b32 v156, 0
    v_mov_b32 v157, 0
    v_mov_b32 v158, 0
    v_mov_b32 v159, 0
    v_mov_b32 v160, 0
    v_mov_b32 v161, 0
    v_mov_b32 v162, 0
    v_mov_b32 v163, 0
    v_mov_b32 v164, 0
    v_mov_b32 v165, 0
    v_mov_b32 v166, 0
    v_mov_b32 v167, 0
    v_mov_b32 v168, 0
    v_mov_b32 v169, 0
    v_mov_b32 v170, 0
    v_mov_b32 v171, 0
    v_mov_b32 v172, 0
    v_mov_b32 v173, 0
    v_mov_b32 v174, 0
    v_mov_b32 v175, 0
    v_mov_b32 v176, 0
    v_mov_b32 v177, 0
    v_mov_b32 v178, 0
    v_mov_b32 v179, 0
    v_mov_b32 v180, 0
    v_mov_b32 v181, 0
    v_mov_b32 v182, 0
    v_mov_b32 v183, 0
    v_mov_b32 v184, 0
    v_mov_b32 v185, 0
    v_mov_b32 v186, 0
    v_mov_b32 v187, 0
    v_mov_b32 v188, 0
    v_mov_b32 v189, 0
    v_mov_b32 v190, 0
    v_mov_b32 v191, 0
    v_lshlrev_b32 v12, 2, v2
    v_and_b32 v12, 63, v12
    v_add_u32 v12, 155648, v12
    ds_write_b32 v12, v96
    s_mov_b32 s50, 0
    s_mov_b32 s51, 0
    s_waitcnt vmcnt(5) lgkmcnt(0)
    s_barrier
    ds_read_b64_tr_b16 v[32:33], v10 offset:0
    ds_read_b64_tr_b16 v[34:35], v10 offset:512
    ds_read_b128 v[16:19], v8 offset:0
    ds_read_b128 v[20:23], v8 offset:2048
    ds_read_b128 v[24:27], v8 offset:4096
    ds_read_b128 v[28:31], v8 offset:6144
    ds_read_b64_tr_b16 v[36:37], v11 offset:0
    ds_read_b64_tr_b16 v[38:39], v11 offset:512
    ds_read_b64_tr_b16 v[40:41], v10 offset:8192
    ds_read_b64_tr_b16 v[42:43], v10 offset:8704
    ds_read_b64_tr_b16 v[44:45], v11 offset:8192
    ds_read_b64_tr_b16 v[46:47], v11 offset:8704
    ds_read_b64_tr_b16 v[48:49], v10 offset:16384
    ds_read_b64_tr_b16 v[50:51], v10 offset:16896
    ds_read_b64_tr_b16 v[52:53], v11 offset:16384
    ds_read_b64_tr_b16 v[54:55], v11 offset:16896
.p2align 6
LOOP:
    s_waitcnt lgkmcnt(13)
    v_mfma_f32_16x16x32_bf16 v[96:99], v[32:35], v[16:19], v[96:99]
    ds_read_b64_tr_b16 v[72:73], v10 offset:4096
    s_waitcnt lgkmcnt(13)
    v_mfma_f32_16x16x32_bf16 v[104:107], v[32:35], v[20:23], v[104:107]
    ds_read_b64_tr_b16 v[74:75], v10 offset:4608
    s_waitcnt lgkmcnt(13)
    v_mfma_f32_16x16x32_bf16 v[112:115], v[32:35], v[24:27], v[112:115]
    ds_read_b128 v[56:59], v9 offset:0
    s_waitcnt lgkmcnt(13)
    v_mfma_f32_16x16x32_bf16 v[120:123], v[32:35], v[28:31], v[120:123]
    ds_read_b128 v[60:63], v9 offset:2048
    s_waitcnt lgkmcnt(12)
    v_mfma_f32_16x16x32_bf16 v[124:127], v[36:39], v[28:31], v[124:127]
    ds_read_b128 v[64:67], v9 offset:4096
    v_mfma_f32_16x16x32_bf16 v[116:119], v[36:39], v[24:27], v[116:119]
    ds_read_b128 v[68:71], v9 offset:6144
    v_mfma_f32_16x16x32_bf16 v[108:111], v[36:39], v[20:23], v[108:111]
    ds_read_b64_tr_b16 v[76:77], v11 offset:4096
    v_mfma_f32_16x16x32_bf16 v[100:103], v[36:39], v[16:19], v[100:103]
    ds_read_b64_tr_b16 v[78:79], v11 offset:4608
    s_waitcnt lgkmcnt(14)
    v_mfma_f32_16x16x32_bf16 v[128:131], v[16:19], v[40:43], v[128:131]
    ds_read_b64_tr_b16 v[80:81], v10 offset:12288
    v_mfma_f32_16x16x32_bf16 v[136:139], v[20:23], v[40:43], v[136:139]
    ds_read_b64_tr_b16 v[82:83], v10 offset:12800
    v_mfma_f32_16x16x32_bf16 v[144:147], v[24:27], v[40:43], v[144:147]
    ds_read_b64_tr_b16 v[84:85], v11 offset:12288
    v_mfma_f32_16x16x32_bf16 v[152:155], v[28:31], v[40:43], v[152:155]
    ds_read_b64_tr_b16 v[86:87], v11 offset:12800
    s_waitcnt lgkmcnt(15)
    v_mfma_f32_16x16x32_bf16 v[156:159], v[28:31], v[44:47], v[156:159]
    ds_read_b64_tr_b16 v[88:89], v10 offset:20480
    v_mfma_f32_16x16x32_bf16 v[148:151], v[24:27], v[44:47], v[148:151]
    ds_read_b64_tr_b16 v[90:91], v10 offset:20992
    v_mfma_f32_16x16x32_bf16 v[140:143], v[20:23], v[44:47], v[140:143]
    ds_read_b64_tr_b16 v[92:93], v11 offset:20480
    v_mfma_f32_16x16x32_bf16 v[132:135], v[16:19], v[44:47], v[132:135]
    ds_read_b64_tr_b16 v[94:95], v11 offset:20992
    s_waitcnt lgkmcnt(15)
    v_mfma_f32_16x16x32_bf16 v[160:163], v[16:19], v[48:51], v[160:163]
    v_mfma_f32_16x16x32_bf16 v[168:171], v[20:23], v[48:51], v[168:171]
    v_mfma_f32_16x16x32_bf16 v[176:179], v[24:27], v[48:51], v[176:179]
    v_mfma_f32_16x16x32_bf16 v[184:187], v[28:31], v[48:51], v[184:187]
    s_waitcnt lgkmcnt(15)
    v_mfma_f32_16x16x32_bf16 v[188:191], v[28:31], v[52:55], v[188:191]
    v_mfma_f32_16x16x32_bf16 v[180:183], v[24:27], v[52:55], v[180:183]
    v_mfma_f32_16x16x32_bf16 v[172:175], v[20:23], v[52:55], v[172:175]
    v_mfma_f32_16x16x32_bf16 v[164:167], v[16:19], v[52:55], v[164:167]
    s_waitcnt lgkmcnt(13)
    v_mfma_f32_16x16x32_bf16 v[96:99], v[72:75], v[56:59], v[96:99]
    s_add_u32 s50, s50, 40960
    s_cmp_eq_u32 s50, 122880
    s_cselect_b32 s50, 0, s50
    s_waitcnt lgkmcnt(12)
    v_mfma_f32_16x16x32_bf16 v[104:107], v[72:75], v[60:63], v[104:107]
    v_add_u32 v8, s50, v4
    s_waitcnt lgkmcnt(11)
    v_mfma_f32_16x16x32_bf16 v[112:115], v[72:75], v[64:67], v[112:115]
    v_add_u32 v9, s50, v5
    s_waitcnt lgkmcnt(10)
    v_mfma_f32_16x16x32_bf16 v[120:123], v[72:75], v[68:71], v[120:123]
    v_add_u32 v10, s50, v6
    s_waitcnt lgkmcnt(8)
    v_mfma_f32_16x16x32_bf16 v[124:127], v[76:79], v[68:71], v[124:127]
    v_add_u32 v11, s50, v7
    v_mfma_f32_16x16x32_bf16 v[116:119], v[76:79], v[64:67], v[116:119]
    s_waitcnt vmcnt(0) lgkmcnt(0)
    s_barrier
    v_mfma_f32_16x16x32_bf16 v[108:111], v[76:79], v[60:63], v[108:111]
    ds_read_b64_tr_b16 v[32:33], v10 offset:0
    v_mfma_f32_16x16x32_bf16 v[100:103], v[76:79], v[56:59], v[100:103]
    ds_read_b64_tr_b16 v[34:35], v10 offset:512
    v_mfma_f32_16x16x32_bf16 v[128:131], v[56:59], v[80:83], v[128:131]
    ds_read_b128 v[16:19], v8 offset:0
    v_mfma_f32_16x16x32_bf16 v[136:139], v[60:63], v[80:83], v[136:139]
    ds_read_b128 v[20:23], v8 offset:2048
    v_mfma_f32_16x16x32_bf16 v[144:147], v[64:67], v[80:83], v[144:147]
    ds_read_b128 v[24:27], v8 offset:4096
    v_mfma_f32_16x16x32_bf16 v[152:155], v[68:71], v[80:83], v[152:155]
    ds_read_b128 v[28:31], v8 offset:6144
    v_mfma_f32_16x16x32_bf16 v[156:159], v[68:71], v[84:87], v[156:159]
    ds_read_b64_tr_b16 v[36:37], v11 offset:0
    v_mfma_f32_16x16x32_bf16 v[148:151], v[64:67], v[84:87], v[148:151]
    ds_read_b64_tr_b16 v[38:39], v11 offset:512
    v_mfma_f32_16x16x32_bf16 v[140:143], v[60:63], v[84:87], v[140:143]
    ds_read_b64_tr_b16 v[40:41], v10 offset:8192
    v_mfma_f32_16x16x32_bf16 v[132:135], v[56:59], v[84:87], v[132:135]
    ds_read_b64_tr_b16 v[42:43], v10 offset:8704
    v_mfma_f32_16x16x32_bf16 v[160:163], v[56:59], v[88:91], v[160:163]
    ds_read_b64_tr_b16 v[44:45], v11 offset:8192
    v_mfma_f32_16x16x32_bf16 v[168:171], v[60:63], v[88:91], v[168:171]
    ds_read_b64_tr_b16 v[46:47], v11 offset:8704
    v_mfma_f32_16x16x32_bf16 v[176:179], v[64:67], v[88:91], v[176:179]
    ds_read_b64_tr_b16 v[48:49], v10 offset:16384
    v_mfma_f32_16x16x32_bf16 v[184:187], v[68:71], v[88:91], v[184:187]
    ds_read_b64_tr_b16 v[50:51], v10 offset:16896
    v_mfma_f32_16x16x32_bf16 v[188:191], v[68:71], v[92:95], v[188:191]
    ds_read_b64_tr_b16 v[52:53], v11 offset:16384
    v_mfma_f32_16x16x32_bf16 v[180:183], v[64:67], v[92:95], v[180:183]
    ds_read_b64_tr_b16 v[54:55], v11 offset:16896
    v_mfma_f32_16x16x32_bf16 v[172:175], v[60:63], v[92:95], v[172:175]
    v_mfma_f32_16x16x32_bf16 v[164:167], v[56:59], v[92:95], v[164:167]
    s_add_u32 s51, s51, 1
    s_cmp_lt_u32 s51, 13
    s_cbranch_scc1 LOOP
    s_waitcnt lgkmcnt(13)
    v_mfma_f32_16x16x32_bf16 v[96:99], v[32:35], v[16:19], v[96:99]
    ds_read_b64_tr_b16 v[72:73], v10 offset:12288
    v_add_u32 v12, 122880, v4
    s_waitcnt lgkmcnt(13)
    v_mfma_f32_16x16x32_bf16 v[104:107], v[32:35], v[20:23], v[104:107]
    ds_read_b64_tr_b16 v[74:75], v10 offset:12800
    v_add_u32 v13, 122880, v5
    s_waitcnt lgkmcnt(13)
    v_mfma_f32_16x16x32_bf16 v[112:115], v[32:35], v[24:27], v[112:115]
    ds_read_b128 v[56:59], v9 offset:0
    v_add_u32 v14, 114688, v6
    s_waitcnt lgkmcnt(13)
    v_mfma_f32_16x16x32_bf16 v[120:123], v[32:35], v[28:31], v[120:123]
    ds_read_b128 v[60:63], v9 offset:2048
    v_add_u32 v15, 114688, v7
    s_waitcnt lgkmcnt(12)
    v_mfma_f32_16x16x32_bf16 v[124:127], v[36:39], v[28:31], v[124:127]
    ds_read_b128 v[64:67], v9 offset:4096
    s_lshl_b32 s66, s3, 12
    v_mfma_f32_16x16x32_bf16 v[116:119], v[36:39], v[24:27], v[116:119]
    ds_read_b128 v[68:71], v9 offset:6144
    v_lshlrev_b32 v3, 4, v2
    v_mfma_f32_16x16x32_bf16 v[108:111], v[36:39], v[20:23], v[108:111]
    ds_read_b64_tr_b16 v[76:77], v11 offset:12288
    v_add_u32 v3, s66, v3
    v_mfma_f32_16x16x32_bf16 v[100:103], v[36:39], v[16:19], v[100:103]
    ds_read_b64_tr_b16 v[78:79], v11 offset:12800
    s_lshl_b32 s66, s3, 2
    s_waitcnt lgkmcnt(14)
    v_mfma_f32_16x16x32_bf16 v[128:131], v[16:19], v[40:43], v[128:131]
    ds_read_b64_tr_b16 v[80:81], v10 offset:20480
    s_add_u32 s66, s66, 155648
    v_mfma_f32_16x16x32_bf16 v[136:139], v[20:23], v[40:43], v[136:139]
    ds_read_b64_tr_b16 v[82:83], v10 offset:20992
    v_mov_b32 v1, s66
    v_mfma_f32_16x16x32_bf16 v[144:147], v[24:27], v[40:43], v[144:147]
    ds_read_b64_tr_b16 v[84:85], v11 offset:20480
    v_mov_b32 v0, 1
    v_mfma_f32_16x16x32_bf16 v[152:155], v[28:31], v[40:43], v[152:155]
    ds_read_b64_tr_b16 v[86:87], v11 offset:20992
    s_waitcnt lgkmcnt(15)
    v_mfma_f32_16x16x32_bf16 v[156:159], v[28:31], v[44:47], v[156:159]
    v_mfma_f32_16x16x32_bf16 v[148:151], v[24:27], v[44:47], v[148:151]
    v_mfma_f32_16x16x32_bf16 v[140:143], v[20:23], v[44:47], v[140:143]
    v_mfma_f32_16x16x32_bf16 v[132:135], v[16:19], v[44:47], v[132:135]
    s_waitcnt lgkmcnt(14)
    v_mfma_f32_16x16x32_bf16 v[160:163], v[16:19], v[48:51], v[160:163]
    v_mfma_f32_16x16x32_bf16 v[168:171], v[20:23], v[48:51], v[168:171]
    v_mfma_f32_16x16x32_bf16 v[176:179], v[24:27], v[48:51], v[176:179]
    v_mfma_f32_16x16x32_bf16 v[184:187], v[28:31], v[48:51], v[184:187]
    s_waitcnt lgkmcnt(12)
    v_mfma_f32_16x16x32_bf16 v[188:191], v[28:31], v[52:55], v[188:191]
    v_mfma_f32_16x16x32_bf16 v[180:183], v[24:27], v[52:55], v[180:183]
    v_mfma_f32_16x16x32_bf16 v[172:175], v[20:23], v[52:55], v[172:175]
    v_mfma_f32_16x16x32_bf16 v[164:167], v[16:19], v[52:55], v[164:167]
    s_waitcnt lgkmcnt(9)
    v_mfma_f32_16x16x32_bf16 v[128:131], v[56:59], v[72:75], v[128:131]
    s_waitcnt lgkmcnt(8)
    v_mfma_f32_16x16x32_bf16 v[136:139], v[60:63], v[72:75], v[136:139]
    s_waitcnt lgkmcnt(7)
    v_mfma_f32_16x16x32_bf16 v[144:147], v[64:67], v[72:75], v[144:147]
    s_waitcnt lgkmcnt(6)
    v_mfma_f32_16x16x32_bf16 v[152:155], v[68:71], v[72:75], v[152:155]
    s_waitcnt lgkmcnt(4)
    v_mfma_f32_16x16x32_bf16 v[156:159], v[68:71], v[76:79], v[156:159]
    v_mfma_f32_16x16x32_bf16 v[148:151], v[64:67], v[76:79], v[148:151]
    s_barrier
    v_mfma_f32_16x16x32_bf16 v[140:143], v[60:63], v[76:79], v[140:143]
    ds_read_b64_tr_b16 v[16:17], v10 offset:49152
    v_mfma_f32_16x16x32_bf16 v[132:135], v[56:59], v[76:79], v[132:135]
    ds_read_b64_tr_b16 v[18:19], v10 offset:49664
    s_waitcnt lgkmcnt(4)
    v_mfma_f32_16x16x32_bf16 v[160:163], v[56:59], v[80:83], v[160:163]
    ds_read_b128 v[192:195], v8 offset:40960
    v_mfma_f32_16x16x32_bf16 v[168:171], v[60:63], v[80:83], v[168:171]
    ds_read_b128 v[196:199], v8 offset:43008
    v_mfma_f32_16x16x32_bf16 v[176:179], v[64:67], v[80:83], v[176:179]
    ds_read_b128 v[200:203], v8 offset:45056
    v_mfma_f32_16x16x32_bf16 v[184:187], v[68:71], v[80:83], v[184:187]
    ds_read_b128 v[204:207], v8 offset:47104
    s_waitcnt lgkmcnt(6)
    v_mfma_f32_16x16x32_bf16 v[188:191], v[68:71], v[84:87], v[188:191]
    ds_read_b64_tr_b16 v[20:21], v11 offset:49152
    v_mfma_f32_16x16x32_bf16 v[180:183], v[64:67], v[84:87], v[180:183]
    ds_read_b64_tr_b16 v[22:23], v11 offset:49664
    v_mfma_f32_16x16x32_bf16 v[172:175], v[60:63], v[84:87], v[172:175]
    v_mfma_f32_16x16x32_bf16 v[164:167], v[56:59], v[84:87], v[164:167]
    s_waitcnt lgkmcnt(5)
    v_mfma_f32_16x16x32_bf16 v[128:131], v[192:195], v[16:19], v[128:131]
    ds_read_b64_tr_b16 v[24:25], v10 offset:53248
    ds_read_b64_tr_b16 v[26:27], v10 offset:53760
    s_waitcnt lgkmcnt(6)
    v_mfma_f32_16x16x32_bf16 v[136:139], v[196:199], v[16:19], v[136:139]
    ds_read_b128 v[208:211], v9 offset:40960
    ds_read_b128 v[212:215], v9 offset:43008
    s_waitcnt lgkmcnt(7)
    v_mfma_f32_16x16x32_bf16 v[144:147], v[200:203], v[16:19], v[144:147]
    ds_read_b128 v[216:219], v9 offset:45056
    s_waitcnt lgkmcnt(7)
    v_mfma_f32_16x16x32_bf16 v[152:155], v[204:207], v[16:19], v[152:155]
    ds_read_b128 v[220:223], v9 offset:47104
    s_waitcnt lgkmcnt(6)
    v_mfma_f32_16x16x32_bf16 v[156:159], v[204:207], v[20:23], v[156:159]
    ds_read_b64_tr_b16 v[28:29], v11 offset:53248
    v_mfma_f32_16x16x32_bf16 v[148:151], v[200:203], v[20:23], v[148:151]
    ds_read_b64_tr_b16 v[30:31], v11 offset:53760
    v_mfma_f32_16x16x32_bf16 v[140:143], v[196:199], v[20:23], v[140:143]
    v_mfma_f32_16x16x32_bf16 v[132:135], v[192:195], v[20:23], v[132:135]
    s_waitcnt lgkmcnt(5)
    v_mfma_f32_16x16x32_bf16 v[128:131], v[208:211], v[24:27], v[128:131]
    s_waitcnt lgkmcnt(4)
    v_mfma_f32_16x16x32_bf16 v[136:139], v[212:215], v[24:27], v[136:139]
    s_barrier
    s_waitcnt lgkmcnt(3)
    v_mfma_f32_16x16x32_bf16 v[144:147], v[216:219], v[24:27], v[144:147]
    ds_read_b64_tr_b16 v[32:33], v14 offset:8192
    ds_read_b64_tr_b16 v[34:35], v14 offset:8704
    s_waitcnt lgkmcnt(4)
    v_mfma_f32_16x16x32_bf16 v[152:155], v[220:223], v[24:27], v[152:155]
    ds_read_b128 v[224:227], v12 offset:0
    ds_read_b128 v[228:231], v12 offset:2048
    s_waitcnt lgkmcnt(4)
    v_mfma_f32_16x16x32_bf16 v[156:159], v[220:223], v[28:31], v[156:159]
    ds_read_b128 v[232:235], v12 offset:4096
    ds_read_b128 v[236:239], v12 offset:6144
    v_mfma_f32_16x16x32_bf16 v[148:151], v[216:219], v[28:31], v[148:151]
    ds_read_b64_tr_b16 v[36:37], v15 offset:8192
    ds_read_b64_tr_b16 v[38:39], v15 offset:8704
    v_mfma_f32_16x16x32_bf16 v[140:143], v[212:215], v[28:31], v[140:143]
    v_mfma_f32_16x16x32_bf16 v[132:135], v[208:211], v[28:31], v[132:135]
    s_waitcnt lgkmcnt(5)
    v_mfma_f32_16x16x32_bf16 v[128:131], v[224:227], v[32:35], v[128:131]
    ds_read_b64_tr_b16 v[16:17], v14 offset:12288
    ds_read_b64_tr_b16 v[18:19], v14 offset:12800
    s_waitcnt lgkmcnt(6)
    v_mfma_f32_16x16x32_bf16 v[136:139], v[228:231], v[32:35], v[136:139]
    ds_read_b128 v[240:243], v13 offset:0
    ds_read_b128 v[244:247], v13 offset:2048
    s_waitcnt lgkmcnt(7)
    v_mfma_f32_16x16x32_bf16 v[144:147], v[232:235], v[32:35], v[144:147]
    ds_read_b128 v[248:251], v13 offset:4096
    s_waitcnt lgkmcnt(7)
    v_mfma_f32_16x16x32_bf16 v[152:155], v[236:239], v[32:35], v[152:155]
    ds_read_b128 v[252:255], v13 offset:6144
    s_waitcnt lgkmcnt(6)
    v_mfma_f32_16x16x32_bf16 v[156:159], v[236:239], v[36:39], v[156:159]
    ds_read_b64_tr_b16 v[20:21], v15 offset:12288
    v_mfma_f32_16x16x32_bf16 v[148:151], v[232:235], v[36:39], v[148:151]
    ds_read_b64_tr_b16 v[22:23], v15 offset:12800
    v_mfma_f32_16x16x32_bf16 v[140:143], v[228:231], v[36:39], v[140:143]
    v_mfma_f32_16x16x32_bf16 v[132:135], v[224:227], v[36:39], v[132:135]
    s_waitcnt lgkmcnt(5)
    v_mfma_f32_16x16x32_bf16 v[128:131], v[240:243], v[16:19], v[128:131]
    ds_read_b64_tr_b16 v[24:25], v10 offset:57344
    s_waitcnt lgkmcnt(5)
    v_mfma_f32_16x16x32_bf16 v[136:139], v[244:247], v[16:19], v[136:139]
    ds_read_b64_tr_b16 v[26:27], v10 offset:57856
    s_waitcnt lgkmcnt(5)
    v_mfma_f32_16x16x32_bf16 v[144:147], v[248:251], v[16:19], v[144:147]
    ds_read_b64_tr_b16 v[28:29], v11 offset:57344
    s_waitcnt lgkmcnt(5)
    v_mfma_f32_16x16x32_bf16 v[152:155], v[252:255], v[16:19], v[152:155]
    ds_read_b64_tr_b16 v[30:31], v11 offset:57856
    s_waitcnt lgkmcnt(4)
    v_mfma_f32_16x16x32_bf16 v[156:159], v[252:255], v[20:23], v[156:159]
    v_mfma_f32_16x16x32_bf16 v[148:151], v[248:251], v[20:23], v[148:151]
    v_mfma_f32_16x16x32_bf16 v[140:143], v[244:247], v[20:23], v[140:143]
    v_mfma_f32_16x16x32_bf16 v[132:135], v[240:243], v[20:23], v[132:135]
    s_waitcnt lgkmcnt(2)
    v_mfma_f32_16x16x32_bf16 v[160:163], v[192:195], v[24:27], v[160:163]
    ds_read_b64_tr_b16 v[32:33], v10 offset:61440
    s_nop 5
    v_cvt_pk_bf16_f32 v40, v128, v129
    v_mfma_f32_16x16x32_bf16 v[168:171], v[196:199], v[24:27], v[168:171]
    ds_read_b64_tr_b16 v[34:35], v10 offset:61952
    v_cvt_pk_bf16_f32 v41, v130, v131
    v_cvt_pk_bf16_f32 v42, v136, v137
    v_mfma_f32_16x16x32_bf16 v[176:179], v[200:203], v[24:27], v[176:179]
    ds_read_b64_tr_b16 v[36:37], v11 offset:61440
    v_cvt_pk_bf16_f32 v43, v138, v139
    ds_write_b128 v3, v[40:43] offset:0
    v_mfma_f32_16x16x32_bf16 v[184:187], v[204:207], v[24:27], v[184:187]
    ds_read_b64_tr_b16 v[38:39], v11 offset:61952
    v_cvt_pk_bf16_f32 v44, v132, v133
    v_cvt_pk_bf16_f32 v45, v134, v135
    s_waitcnt lgkmcnt(5)
    v_mfma_f32_16x16x32_bf16 v[188:191], v[204:207], v[28:31], v[188:191]
    v_cvt_pk_bf16_f32 v46, v140, v141
    v_cvt_pk_bf16_f32 v47, v142, v143
    v_mfma_f32_16x16x32_bf16 v[180:183], v[200:203], v[28:31], v[180:183]
    ds_write_b128 v3, v[44:47] offset:1024
    v_cvt_pk_bf16_f32 v48, v144, v145
    v_mfma_f32_16x16x32_bf16 v[172:175], v[196:199], v[28:31], v[172:175]
    v_cvt_pk_bf16_f32 v49, v146, v147
    v_cvt_pk_bf16_f32 v50, v152, v153
    v_mfma_f32_16x16x32_bf16 v[164:167], v[192:195], v[28:31], v[164:167]
    v_cvt_pk_bf16_f32 v51, v154, v155
    ds_write_b128 v3, v[48:51] offset:2048
    s_waitcnt lgkmcnt(5)
    v_mfma_f32_16x16x32_bf16 v[160:163], v[208:211], v[32:35], v[160:163]
    ds_read_b64_tr_b16 v[16:17], v14 offset:16384
    v_cvt_pk_bf16_f32 v52, v148, v149
    v_cvt_pk_bf16_f32 v53, v150, v151
    v_mfma_f32_16x16x32_bf16 v[168:171], v[212:215], v[32:35], v[168:171]
    ds_read_b64_tr_b16 v[18:19], v14 offset:16896
    v_cvt_pk_bf16_f32 v54, v156, v157
    v_cvt_pk_bf16_f32 v55, v158, v159
    v_mfma_f32_16x16x32_bf16 v[176:179], v[216:219], v[32:35], v[176:179]
    ds_read_b64_tr_b16 v[20:21], v15 offset:16384
    ds_write_b128 v3, v[52:55] offset:3072
    ds_write_b32 v1, v0
    v_mfma_f32_16x16x32_bf16 v[184:187], v[220:223], v[32:35], v[184:187]
    ds_read_b64_tr_b16 v[22:23], v15 offset:16896
    v_pk_max_u16 v72, v40, v41
    v_pk_max_u16 v72, v72, v42
    s_waitcnt lgkmcnt(8)
    v_mfma_f32_16x16x32_bf16 v[188:191], v[220:223], v[36:39], v[188:191]
    v_pk_max_u16 v72, v72, v43
    v_pk_max_u16 v72, v72, v44
    v_mfma_f32_16x16x32_bf16 v[180:183], v[216:219], v[36:39], v[180:183]
    v_pk_max_u16 v72, v72, v45
    v_mfma_f32_16x16x32_bf16 v[172:175], v[212:215], v[36:39], v[172:175]
    v_pk_max_u16 v72, v72, v46
    v_mfma_f32_16x16x32_bf16 v[164:167], v[208:211], v[36:39], v[164:167]
    v_pk_max_u16 v72, v72, v47
    s_waitcnt lgkmcnt(4)
    v_mfma_f32_16x16x32_bf16 v[160:163], v[224:227], v[16:19], v[160:163]
    ds_read_b64_tr_b16 v[24:25], v14 offset:20480
    v_pk_max_u16 v72, v72, v48
    v_pk_max_u16 v72, v72, v49
    v_pk_max_u16 v72, v72, v50
    v_mfma_f32_16x16x32_bf16 v[168:171], v[228:231], v[16:19], v[168:171]
    ds_read_b64_tr_b16 v[26:27], v14 offset:20992
    v_pk_max_u16 v72, v72, v51
    v_pk_max_u16 v72, v72, v52
    v_pk_max_u16 v72, v72, v53
    v_mfma_f32_16x16x32_bf16 v[176:179], v[232:235], v[16:19], v[176:179]
    ds_read_b64_tr_b16 v[28:29], v15 offset:20480
    v_pk_max_u16 v72, v72, v54
    v_pk_max_u16 v72, v72, v55
    v_add_u32 v3, 65536, v3
    v_mfma_f32_16x16x32_bf16 v[184:187], v[236:239], v[16:19], v[184:187]
    ds_read_b64_tr_b16 v[30:31], v15 offset:20992
    v_mov_b32 v130, 0x3f80
    v_lshlrev_b32 v9, 4, v2
    v_lshrrev_b32 v159, 3, v2
    s_waitcnt lgkmcnt(4)
    v_mfma_f32_16x16x32_bf16 v[188:191], v[236:239], v[20:23], v[188:191]
    s_lshl_b32 s67, s44, 3
    v_add_u32 v159, s67, v159
    v_lshlrev_b32 v159, 11, v159
    v_mfma_f32_16x16x32_bf16 v[180:183], v[232:235], v[20:23], v[180:183]
    v_lshrrev_b32 v131, 4, v2
    v_lshlrev_b32 v131, 1, v131
    v_and_b32 v135, 7, v2
    v_mfma_f32_16x16x32_bf16 v[172:175], v[228:231], v[20:23], v[172:175]
    v_xor_b32 v131, v131, v135
    v_lshl_add_u32 v159, v131, 4, v159
    v_mfma_f32_16x16x32_bf16 v[164:167], v[224:227], v[20:23], v[164:167]
    s_lshl_b32 s66, s7, 7
    v_add_u32 v135, s66, v159
    s_waitcnt lgkmcnt(2)
    v_mfma_f32_16x16x32_bf16 v[160:163], v[240:243], v[24:27], v[160:163]
    ds_read_b64_tr_b16 v[32:33], v10 offset:4096
    v_lshrrev_b32 v73, 16, v72
    v_and_b32 v72, 0xffff, v72
    v_mfma_f32_16x16x32_bf16 v[168:171], v[244:247], v[24:27], v[168:171]
    ds_read_b64_tr_b16 v[34:35], v10 offset:4608
    v_max_u32 v72, v72, v73
    v_cmp_lt_u32 vcc, 0xc0db, v72
    v_mfma_f32_16x16x32_bf16 v[176:179], v[248:251], v[24:27], v[176:179]
    ds_read_b64_tr_b16 v[36:37], v11 offset:4096
    s_cmp_lg_u64 vcc, 0
    s_cselect_b32 s66, 2, 1
    v_mfma_f32_16x16x32_bf16 v[184:187], v[252:255], v[24:27], v[184:187]
    ds_read_b64_tr_b16 v[38:39], v11 offset:4608
    v_mov_b32 v0, s66
    s_lshl_b32 s66, s6, 7
    s_waitcnt lgkmcnt(4)
    v_mfma_f32_16x16x32_bf16 v[188:191], v[252:255], v[28:31], v[188:191]
    s_lshl_b32 s67, s44, 5
    s_add_u32 s66, s66, s67
    v_mfma_f32_16x16x32_bf16 v[180:183], v[248:251], v[28:31], v[180:183]
    s_lshl_b32 s67, s45, 4
    s_add_u32 s66, s66, s67
    v_mfma_f32_16x16x32_bf16 v[172:175], v[244:247], v[28:31], v[172:175]
    v_and_b32 v157, 15, v2
    v_mfma_f32_16x16x32_bf16 v[164:167], v[240:243], v[28:31], v[164:167]
    v_add_u32 v157, s66, v157
    s_waitcnt lgkmcnt(2)
    v_mfma_f32_16x16x32_bf16 v[96:99], v[32:35], v[56:59], v[96:99]
    ds_read_b64_tr_b16 v[16:17], v10 offset:40960
    s_nop 5
    v_cvt_pk_bf16_f32 v40, v160, v161
    v_mfma_f32_16x16x32_bf16 v[104:107], v[32:35], v[60:63], v[104:107]
    ds_read_b64_tr_b16 v[18:19], v10 offset:41472
    v_cvt_pk_bf16_f32 v41, v162, v163
    v_cvt_pk_bf16_f32 v42, v168, v169
    v_mfma_f32_16x16x32_bf16 v[112:115], v[32:35], v[64:67], v[112:115]
    ds_read_b64_tr_b16 v[20:21], v11 offset:40960
    v_cvt_pk_bf16_f32 v43, v170, v171
    ds_write_b128 v3, v[40:43] offset:0
    v_mfma_f32_16x16x32_bf16 v[120:123], v[32:35], v[68:71], v[120:123]
    ds_read_b64_tr_b16 v[22:23], v11 offset:41472
    v_cvt_pk_bf16_f32 v44, v164, v165
    v_cvt_pk_bf16_f32 v45, v166, v167
    s_waitcnt lgkmcnt(5)
    v_mfma_f32_16x16x32_bf16 v[124:127], v[36:39], v[68:71], v[124:127]
    v_cvt_pk_bf16_f32 v46, v172, v173
    v_cvt_pk_bf16_f32 v47, v174, v175
    v_mfma_f32_16x16x32_bf16 v[116:119], v[36:39], v[64:67], v[116:119]
    ds_write_b128 v3, v[44:47] offset:1024
    v_cvt_pk_bf16_f32 v48, v176, v177
    v_mfma_f32_16x16x32_bf16 v[108:111], v[36:39], v[60:63], v[108:111]
    v_cvt_pk_bf16_f32 v49, v178, v179
    v_cvt_pk_bf16_f32 v50, v184, v185
    v_mfma_f32_16x16x32_bf16 v[100:103], v[36:39], v[56:59], v[100:103]
    v_cvt_pk_bf16_f32 v51, v186, v187
    ds_write_b128 v3, v[48:51] offset:2048
    s_waitcnt lgkmcnt(5)
    v_mfma_f32_16x16x32_bf16 v[96:99], v[16:19], v[192:195], v[96:99]
    ds_read_b64_tr_b16 v[24:25], v10 offset:45056
    v_cvt_pk_bf16_f32 v52, v180, v181
    v_mfma_f32_16x16x32_bf16 v[104:107], v[16:19], v[196:199], v[104:107]
    ds_read_b64_tr_b16 v[26:27], v10 offset:45568
    v_cvt_pk_bf16_f32 v53, v182, v183
    v_mfma_f32_16x16x32_bf16 v[112:115], v[16:19], v[200:203], v[112:115]
    ds_read_b64_tr_b16 v[28:29], v11 offset:45056
    v_cvt_pk_bf16_f32 v54, v188, v189
    v_mfma_f32_16x16x32_bf16 v[120:123], v[16:19], v[204:207], v[120:123]
    ds_read_b64_tr_b16 v[30:31], v11 offset:45568
    v_cvt_pk_bf16_f32 v55, v190, v191
    s_waitcnt lgkmcnt(6)
    v_mfma_f32_16x16x32_bf16 v[124:127], v[20:23], v[204:207], v[124:127]
    ds_write_b128 v3, v[52:55] offset:3072
    v_mfma_f32_16x16x32_bf16 v[116:119], v[20:23], v[200:203], v[116:119]
    ds_write_b32 v1, v0 offset:16
    v_mfma_f32_16x16x32_bf16 v[108:111], v[20:23], v[196:199], v[108:111]
    v_mfma_f32_16x16x32_bf16 v[100:103], v[20:23], v[192:195], v[100:103]
    s_waitcnt lgkmcnt(4)
    v_mfma_f32_16x16x32_bf16 v[96:99], v[24:27], v[208:211], v[96:99]
    ds_read_b64_tr_b16 v[32:33], v6 offset:0
    v_lshlrev_b32 v156, 11, v157
    v_bfe_u32 v159, v2, 4, 1
    v_mfma_f32_16x16x32_bf16 v[104:107], v[24:27], v[212:215], v[104:107]
    ds_read_b64_tr_b16 v[34:35], v6 offset:512
    v_lshl_add_u32 v156, v159, 5, v156
    v_lshrrev_b32 v159, 5, v2
    v_mfma_f32_16x16x32_bf16 v[112:115], v[24:27], v[216:219], v[112:115]
    ds_read_b64_tr_b16 v[36:37], v7 offset:0
    v_lshl_add_u32 v156, v159, 4, v156
    s_lshl_b32 s66, s7, 7
    v_mfma_f32_16x16x32_bf16 v[120:123], v[24:27], v[220:223], v[120:123]
    ds_read_b64_tr_b16 v[38:39], v7 offset:512
    v_add_u32 v156, s66, v156
    v_lshrrev_b32 v158, 2, v157
    s_waitcnt lgkmcnt(6)
    v_mfma_f32_16x16x32_bf16 v[124:127], v[28:31], v[220:223], v[124:127]
    v_lshlrev_b32 v158, 6, v158
    v_and_b32 v159, 3, v2
    v_mfma_f32_16x16x32_bf16 v[116:119], v[28:31], v[216:219], v[116:119]
    v_lshl_add_u32 v158, v159, 2, v158
    s_lshl_b32 s50, s6, 1
    v_mfma_f32_16x16x32_bf16 v[108:111], v[28:31], v[212:215], v[108:111]
    s_and_b32 s50, s50, 6
    s_add_u32 s50, s50, s7
    v_mfma_f32_16x16x32_bf16 v[100:103], v[28:31], v[208:211], v[100:103]
    s_and_b32 s50, s50, 7
    s_lshl_b32 s50, s50, 18
    s_waitcnt lgkmcnt(2)
    v_mfma_f32_16x16x32_bf16 v[96:99], v[32:35], v[224:227], v[96:99]
    ds_read_b64_tr_b16 v[16:17], v6 offset:4096
    s_mov_b32 s70, 0x3fb8aa3b
    s_mov_b32 s71, 0x3fb8aa3b
    s_lshl_b32 s58, s5, 2
    v_mfma_f32_16x16x32_bf16 v[104:107], v[32:35], v[228:231], v[104:107]
    ds_read_b64_tr_b16 v[18:19], v6 offset:4608
    s_add_u32 s58, s58, s44
    s_lshl_b32 s66, s58, 14
    v_mfma_f32_16x16x32_bf16 v[112:115], v[32:35], v[232:235], v[112:115]
    ds_read_b64_tr_b16 v[20:21], v7 offset:4096
    s_add_u32 s66, s66, 4194304
    v_add_u32 v132, s66, v9
    v_mfma_f32_16x16x32_bf16 v[120:123], v[32:35], v[236:239], v[120:123]
    ds_read_b64_tr_b16 v[22:23], v7 offset:4608
    s_lshl_b32 s66, s58, 10
    s_add_u32 s66, s66, 5242880
    s_waitcnt lgkmcnt(4)
    v_mfma_f32_16x16x32_bf16 v[124:127], v[36:39], v[236:239], v[124:127]
    v_and_b32 v159, 15, v2
    v_lshlrev_b32 v159, 6, v159
    v_mfma_f32_16x16x32_bf16 v[116:119], v[36:39], v[232:235], v[116:119]
    v_lshrrev_b32 v131, 4, v2
    v_lshl_add_u32 v159, v131, 4, v159
    v_mfma_f32_16x16x32_bf16 v[108:111], v[36:39], v[228:231], v[108:111]
    v_add_u32 v133, s66, v159
    s_lshl_b32 s66, s6, 6
    v_mfma_f32_16x16x32_bf16 v[100:103], v[36:39], v[224:227], v[100:103]
    s_add_u32 s66, s66, 5242880
    v_mov_b32 v76, 155664
    s_waitcnt lgkmcnt(2)
    v_mfma_f32_16x16x32_bf16 v[96:99], v[16:19], v[240:243], v[96:99]
    v_lshlrev_b32 v159, 10, v2
    v_add_u32 v134, s66, v159
    v_bfe_u32 v159, v2, 2, 2
    v_mfma_f32_16x16x32_bf16 v[104:107], v[16:19], v[244:247], v[104:107]
    v_lshrrev_b32 v131, 4, v2
    v_cmp_eq_u32 vcc, v159, v131
    v_and_b32 v159, 1, v2
    v_mfma_f32_16x16x32_bf16 v[112:115], v[16:19], v[248:251], v[112:115]
    v_lshlrev_b32 v159, 4, v159
    v_lshlrev_b32 v159, v159, v130
    v_cndmask_b32 v159, 0, v159, vcc
    v_mfma_f32_16x16x32_bf16 v[120:123], v[16:19], v[252:255], v[120:123]
    v_and_b32 v131, 2, v2
    v_cmp_eq_u32 vcc, 0, v131
    v_mov_b32 v138, 0
    s_waitcnt lgkmcnt(0)
    v_mfma_f32_16x16x32_bf16 v[124:127], v[20:23], v[252:255], v[124:127]
    v_mov_b32 v139, 0
    v_cndmask_b32 v136, 0, v159, vcc
    v_mfma_f32_16x16x32_bf16 v[116:119], v[20:23], v[248:251], v[116:119]
    v_cndmask_b32 v137, v159, 0, vcc
    v_mov_b32 v140, 0
    v_mfma_f32_16x16x32_bf16 v[108:111], v[20:23], v[244:247], v[108:111]
    v_mov_b32 v141, 0
    v_mov_b32 v142, v136
    v_mfma_f32_16x16x32_bf16 v[100:103], v[20:23], v[240:243], v[100:103]
    v_mov_b32 v143, v137
    ds_read_b128 v[72:75], v76
    s_nop 7
    v_cvt_pk_bf16_f32 v16, v96, v97
    v_cvt_pk_bf16_f32 v17, v98, v99
    v_cvt_pk_bf16_f32 v18, v100, v101
    v_cvt_pk_bf16_f32 v19, v102, v103
    v_cvt_pk_bf16_f32 v20, v104, v105
    v_cvt_pk_bf16_f32 v21, v106, v107
    v_cvt_pk_bf16_f32 v22, v108, v109
    v_cvt_pk_bf16_f32 v23, v110, v111
    v_cvt_pk_bf16_f32 v40, v112, v113
    v_cvt_pk_bf16_f32 v41, v114, v115
    v_cvt_pk_bf16_f32 v42, v116, v117
    v_cvt_pk_bf16_f32 v43, v118, v119
    v_cvt_pk_bf16_f32 v44, v120, v121
    v_cvt_pk_bf16_f32 v45, v122, v123
    v_cvt_pk_bf16_f32 v46, v124, v125
    v_cvt_pk_bf16_f32 v47, v126, v127
    s_lshl_b32 s66, s3, 11
    s_add_u32 s66, s66, 139264
    v_lshlrev_b32 v3, 4, v2
    v_add_u32 v3, s66, v3
C_qw:
    s_waitcnt lgkmcnt(0)
    v_min_u32 v72, v72, v73
    v_min3_u32 v72, v72, v74, v75
    v_cmp_eq_u32 vcc, 0, v72
    s_cbranch_vccz C_qg
    ds_read_b128 v[72:75], v76
    s_branch C_qw
C_qg:
    ds_write_b128 v3, v[40:43]
    ds_write_b128 v3, v[44:47] offset:1024
    s_waitcnt lgkmcnt(0)
    s_barrier
    v_lshlrev_b32 v32, 16, v16
    v_and_b32 v33, 0xffff0000, v16
    v_pk_mul_f32 v[34:35], v[32:33], s[70:71]
    v_pk_add_f32 v[32:33], v[32:33], 1.0 op_sel_hi:[1,0]
    v_exp_f32 v34, v34 clamp
    v_exp_f32 v35, v35 clamp
    v_lshlrev_b32 v36, 16, v17
    v_and_b32 v37, 0xffff0000, v17
    v_pk_mul_f32 v[38:39], v[36:37], s[70:71]
    v_pk_add_f32 v[36:37], v[36:37], 1.0 op_sel_hi:[1,0]
    v_exp_f32 v38, v38 clamp
    v_exp_f32 v39, v39 clamp
    v_max_f32 v32, v32, v34
    v_max_f32 v33, v33, v35
    v_min_f32 v40, v32, v33
    v_cvt_pk_bf16_f32 v24, v32, v33
    v_max_f32 v36, v36, v38
    v_max_f32 v37, v37, v39
    v_min3_f32 v40, v36, v37, v40
    v_cvt_pk_bf16_f32 v25, v36, v37
    v_lshlrev_b32 v32, 16, v18
    v_and_b32 v33, 0xffff0000, v18
    v_pk_mul_f32 v[34:35], v[32:33], s[70:71]
    v_pk_add_f32 v[32:33], v[32:33], 1.0 op_sel_hi:[1,0]
    v_exp_f32 v34, v34 clamp
    v_exp_f32 v35, v35 clamp
    v_lshlrev_b32 v36, 16, v19
    v_and_b32 v37, 0xffff0000, v19
    v_pk_mul_f32 v[38:39], v[36:37], s[70:71]
    v_pk_add_f32 v[36:37], v[36:37], 1.0 op_sel_hi:[1,0]
    v_exp_f32 v38, v38 clamp
    v_exp_f32 v39, v39 clamp
    v_max_f32 v32, v32, v34
    v_max_f32 v33, v33, v35
    v_min3_f32 v40, v32, v33, v40
    v_cvt_pk_bf16_f32 v26, v32, v33
    v_max_f32 v36, v36, v38
    v_max_f32 v37, v37, v39
    v_min3_f32 v40, v36, v37, v40
    v_cvt_pk_bf16_f32 v27, v36, v37
    v_lshlrev_b32 v32, 16, v20
    v_and_b32 v33, 0xffff0000, v20
    v_pk_mul_f32 v[34:35], v[32:33], s[70:71]
    v_pk_add_f32 v[32:33], v[32:33], 1.0 op_sel_hi:[1,0]
    v_exp_f32 v34, v34 clamp
    v_exp_f32 v35, v35 clamp
    v_lshlrev_b32 v36, 16, v21
    v_and_b32 v37, 0xffff0000, v21
    v_pk_mul_f32 v[38:39], v[36:37], s[70:71]
    v_pk_add_f32 v[36:37], v[36:37], 1.0 op_sel_hi:[1,0]
    v_exp_f32 v38, v38 clamp
    v_exp_f32 v39, v39 clamp
    v_max_f32 v32, v32, v34
    v_max_f32 v33, v33, v35
    v_min3_f32 v40, v32, v33, v40
    v_cvt_pk_bf16_f32 v28, v32, v33
    v_max_f32 v36, v36, v38
    v_max_f32 v37, v37, v39
    v_min3_f32 v40, v36, v37, v40
    v_cvt_pk_bf16_f32 v29, v36, v37
    v_lshlrev_b32 v32, 16, v22
    v_and_b32 v33, 0xffff0000, v22
    v_pk_mul_f32 v[34:35], v[32:33], s[70:71]
    v_pk_add_f32 v[32:33], v[32:33], 1.0 op_sel_hi:[1,0]
    v_exp_f32 v34, v34 clamp
    v_exp_f32 v35, v35 clamp
    v_lshlrev_b32 v36, 16, v23
    v_and_b32 v37, 0xffff0000, v23
    v_pk_mul_f32 v[38:39], v[36:37], s[70:71]
    v_pk_add_f32 v[36:37], v[36:37], 1.0 op_sel_hi:[1,0]
    v_exp_f32 v38, v38 clamp
    v_exp_f32 v39, v39 clamp
    v_max_f32 v32, v32, v34
    v_max_f32 v33, v33, v35
    v_min3_f32 v40, v32, v33, v40
    v_cvt_pk_bf16_f32 v30, v32, v33
    v_max_f32 v36, v36, v38
    v_max_f32 v37, v37, v39
    v_min3_f32 v40, v36, v37, v40
    v_cvt_pk_bf16_f32 v31, v36, v37
    v_cmp_gt_f32 vcc, 0x3a800000, v40
    s_cbranch_vccz P_qd
    v_lshlrev_b32 v32, 16, v24
    v_and_b32 v33, 0xffff0000, v24
    v_add_f32 v32, s47, v32
    v_add_f32 v33, s47, v33
    v_cvt_pk_bf16_f32 v24, v32, v33
    v_lshlrev_b32 v32, 16, v25
    v_and_b32 v33, 0xffff0000, v25
    v_add_f32 v32, s47, v32
    v_add_f32 v33, s47, v33
    v_cvt_pk_bf16_f32 v25, v32, v33
    v_lshlrev_b32 v32, 16, v26
    v_and_b32 v33, 0xffff0000, v26
    v_add_f32 v32, s47, v32
    v_add_f32 v33, s47, v33
    v_cvt_pk_bf16_f32 v26, v32, v33
    v_lshlrev_b32 v32, 16, v27
    v_and_b32 v33, 0xffff0000, v27
    v_add_f32 v32, s47, v32
    v_add_f32 v33, s47, v33
    v_cvt_pk_bf16_f32 v27, v32, v33
    v_lshlrev_b32 v32, 16, v28
    v_and_b32 v33, 0xffff0000, v28
    v_add_f32 v32, s47, v32
    v_add_f32 v33, s47, v33
    v_cvt_pk_bf16_f32 v28, v32, v33
    v_lshlrev_b32 v32, 16, v29
    v_and_b32 v33, 0xffff0000, v29
    v_add_f32 v32, s47, v32
    v_add_f32 v33, s47, v33
    v_cvt_pk_bf16_f32 v29, v32, v33
    v_lshlrev_b32 v32, 16, v30
    v_and_b32 v33, 0xffff0000, v30
    v_add_f32 v32, s47, v32
    v_add_f32 v33, s47, v33
    v_cvt_pk_bf16_f32 v30, v32, v33
    v_lshlrev_b32 v32, 16, v31
    v_and_b32 v33, 0xffff0000, v31
    v_add_f32 v32, s47, v32
    v_add_f32 v33, s47, v33
    v_cvt_pk_bf16_f32 v31, v32, v33
P_qd:
    s_lshr_b32 s49, s44, 1
    s_lshl_b32 s66, s49, 11
    s_add_u32 s66, s66, 159744
    v_add_u32 v10, s66, v9
    s_lshl_b32 s66, s49, 6
    s_add_u32 s66, s66, 159488
    v_lshrrev_b32 v11, 4, v2
    v_lshlrev_b32 v11, 4, v11
    v_add_u32 v11, s66, v11
    s_and_b32 s66, s44, 1
    s_lshl_b32 s66, s66, 2
    s_lshl_b32 s67, s45, 1
    s_add_u32 s66, s66, s67
    s_lshl_b32 s67, s4, 3
    s_add_u32 s66, s66, s67
    s_lshl_b32 s66, s66, 5
    s_lshl_b32 s67, s5, 1
    s_add_u32 s66, s66, s67
    s_add_u32 s66, s66, s49
    s_lshl_b32 s68, s66, 10
    s_add_u32 s69, s68, 32768
    s_sleep 8
    s_lshr_b32 s57, s4, 3
    s_xor_b32 s57, s57, s4
    s_and_b32 s57, s57, 1
    s_lshl_b32 s57, s57, 13
    s_cmp_eq_u32 s3, 0
    s_cselect_b32 s76, 0x20000, 0
    s_lshr_b32 s66, s44, 1
    s_lshl_b32 s67, s66, 11
    s_lshl_b32 s66, s66, 6
    s_and_b32 s59, s44, 1
    s_lshl_b32 s59, s59, 3
    s_add_u32 s66, s66, s59
    s_add_u32 s67, s67, s59
    s_add_u32 s66, s66, 159488
    s_add_u32 s67, s67, 159744
    v_add_u32 v12, s67, v9
    v_lshrrev_b32 v13, 4, v2
    v_lshlrev_b32 v13, 4, v13
    v_add_u32 v13, s66, v13
    v_mov_b32 v236, 0
    s_xor_b32 s66, s57, 0
    buffer_load_dwordx4 v[160:163], v132, s[16:19], s66 offen offset:0 sc1
    s_xor_b32 s66, s57, 0
    buffer_load_dwordx4 v[164:167], v132, s[16:19], s66 offen offset:1024 sc1
    s_xor_b32 s66, s57, 0
    buffer_load_dwordx4 v[168:171], v132, s[16:19], s66 offen offset:2048 sc1
    s_xor_b32 s66, s57, 0
    buffer_load_dwordx4 v[172:175], v132, s[16:19], s66 offen offset:3072 sc1
    s_xor_b32 s66, s57, 4096
    buffer_load_dwordx4 v[176:179], v132, s[16:19], s66 offen offset:0 sc1
    s_xor_b32 s66, s57, 4096
    buffer_load_dwordx4 v[180:183], v132, s[16:19], s66 offen offset:1024 sc1
    s_xor_b32 s66, s57, 4096
    buffer_load_dwordx4 v[184:187], v132, s[16:19], s66 offen offset:2048 sc1
    s_xor_b32 s66, s57, 4096
    buffer_load_dwordx4 v[188:191], v132, s[16:19], s66 offen offset:3072 sc1
    s_xor_b32 s66, s57, 8192
    buffer_load_dwordx4 v[192:195], v132, s[16:19], s66 offen offset:0 sc1
    s_waitcnt vmcnt(8)
    v_max_u32 v14, v160, v161
    v_max3_u32 v14, v14, v162, v163
    v_mfma_f32_16x16x32_bf16 v[224:227], v[136:139], v[160:163], 0
    v_mfma_f32_16x16x32_bf16 v[228:231], v[140:143], v[160:163], 0
    s_xor_b32 s66, s57, 8192
    buffer_load_dwordx4 v[196:199], v132, s[16:19], s66 offen offset:1024 sc1
    s_waitcnt vmcnt(8)
    v_max3_u32 v14, v14, v164, v165
    v_max3_u32 v14, v14, v166, v167
    v_mfma_f32_16x16x32_bf16 v[224:227], v[136:139], v[164:167], v[224:227]
    v_mfma_f32_16x16x32_bf16 v[228:231], v[140:143], v[164:167], v[228:231]
    s_xor_b32 s66, s57, 8192
    buffer_load_dwordx4 v[200:203], v132, s[16:19], s66 offen offset:2048 sc1
    s_waitcnt vmcnt(8)
    v_max3_u32 v14, v14, v168, v169
    v_max3_u32 v14, v14, v170, v171
    v_mfma_f32_16x16x32_bf16 v[224:227], v[136:139], v[168:171], v[224:227]
    v_mfma_f32_16x16x32_bf16 v[228:231], v[140:143], v[168:171], v[228:231]
    s_xor_b32 s66, s57, 8192
    buffer_load_dwordx4 v[204:207], v132, s[16:19], s66 offen offset:3072 sc1
    s_waitcnt vmcnt(8)
    v_max3_u32 v14, v14, v172, v173
    v_max3_u32 v14, v14, v174, v175
    v_mfma_f32_16x16x32_bf16 v[224:227], v[136:139], v[172:175], v[224:227]
    v_mfma_f32_16x16x32_bf16 v[228:231], v[140:143], v[172:175], v[228:231]
    s_xor_b32 s66, s57, 12288
    buffer_load_dwordx4 v[208:211], v132, s[16:19], s66 offen offset:0 sc1
    s_waitcnt vmcnt(8)
    v_max3_u32 v14, v14, v176, v177
    v_max3_u32 v14, v14, v178, v179
    v_mfma_f32_16x16x32_bf16 v[224:227], v[136:139], v[176:179], v[224:227]
    v_mfma_f32_16x16x32_bf16 v[228:231], v[140:143], v[176:179], v[228:231]
    s_xor_b32 s66, s57, 12288
    buffer_load_dwordx4 v[212:215], v132, s[16:19], s66 offen offset:1024 sc1
    s_waitcnt vmcnt(8)
    v_max3_u32 v14, v14, v180, v181
    v_max3_u32 v14, v14, v182, v183
    v_mfma_f32_16x16x32_bf16 v[224:227], v[136:139], v[180:183], v[224:227]
    v_mfma_f32_16x16x32_bf16 v[228:231], v[140:143], v[180:183], v[228:231]
    s_xor_b32 s66, s57, 12288
    buffer_load_dwordx4 v[216:219], v132, s[16:19], s66 offen offset:2048 sc1
    s_waitcnt vmcnt(8)
    v_max3_u32 v14, v14, v184, v185
    v_max3_u32 v14, v14, v186, v187
    v_mfma_f32_16x16x32_bf16 v[224:227], v[136:139], v[184:187], v[224:227]
    v_mfma_f32_16x16x32_bf16 v[228:231], v[140:143], v[184:187], v[228:231]
    s_xor_b32 s66, s57, 12288
    buffer_load_dwordx4 v[220:223], v132, s[16:19], s66 offen offset:3072 sc1
    s_waitcnt vmcnt(8)
    v_max3_u32 v14, v14, v188, v189
    v_max3_u32 v14, v14, v190, v191
    v_mfma_f32_16x16x32_bf16 v[224:227], v[136:139], v[188:191], v[224:227]
    v_mfma_f32_16x16x32_bf16 v[228:231], v[140:143], v[188:191], v[228:231]
    buffer_load_dwordx4 v[232:235], v133, s[16:19], 0 offen sc1
    s_waitcnt vmcnt(8)
    v_max3_u32 v14, v14, v192, v193
    v_max3_u32 v14, v14, v194, v195
    v_mfma_f32_16x16x32_bf16 v[224:227], v[136:139], v[192:195], v[224:227]
    v_mfma_f32_16x16x32_bf16 v[228:231], v[140:143], v[192:195], v[228:231]
    s_bitcmp1_b32 s76, 17
    s_cbranch_scc0 P_i17
    buffer_load_dword v236, v134, s[16:19], 0 offen sc1
P_i17:
    buffer_load_dwordx4 v[144:147], v156, s[8:11], 0 offen offset:0
    buffer_load_dwordx4 v[148:151], v156, s[8:11], 0 offen offset:64
    s_waitcnt vmcnt(9)
    v_max3_u32 v14, v14, v196, v197
    v_max3_u32 v14, v14, v198, v199
    v_mfma_f32_16x16x32_bf16 v[224:227], v[136:139], v[196:199], v[224:227]
    v_mfma_f32_16x16x32_bf16 v[228:231], v[140:143], v[196:199], v[228:231]
    s_waitcnt vmcnt(8)
    v_max3_u32 v14, v14, v200, v201
    v_max3_u32 v14, v14, v202, v203
    v_mfma_f32_16x16x32_bf16 v[224:227], v[136:139], v[200:203], v[224:227]
    v_mfma_f32_16x16x32_bf16 v[228:231], v[140:143], v[200:203], v[228:231]
    s_waitcnt vmcnt(7)
    v_max3_u32 v14, v14, v204, v205
    v_max3_u32 v14, v14, v206, v207
    v_mfma_f32_16x16x32_bf16 v[224:227], v[136:139], v[204:207], v[224:227]
    v_mfma_f32_16x16x32_bf16 v[228:231], v[140:143], v[204:207], v[228:231]
    s_waitcnt vmcnt(6)
    v_max3_u32 v14, v14, v208, v209
    v_max3_u32 v14, v14, v210, v211
    v_mfma_f32_16x16x32_bf16 v[224:227], v[136:139], v[208:211], v[224:227]
    v_mfma_f32_16x16x32_bf16 v[228:231], v[140:143], v[208:211], v[228:231]
    s_waitcnt vmcnt(5)
    v_max3_u32 v14, v14, v212, v213
    v_max3_u32 v14, v14, v214, v215
    v_mfma_f32_16x16x32_bf16 v[224:227], v[136:139], v[212:215], v[224:227]
    v_mfma_f32_16x16x32_bf16 v[228:231], v[140:143], v[212:215], v[228:231]
    s_waitcnt vmcnt(4)
    v_max3_u32 v14, v14, v216, v217
    v_max3_u32 v14, v14, v218, v219
    v_mfma_f32_16x16x32_bf16 v[224:227], v[136:139], v[216:219], v[224:227]
    v_mfma_f32_16x16x32_bf16 v[228:231], v[140:143], v[216:219], v[228:231]
    s_waitcnt vmcnt(3)
    v_max3_u32 v14, v14, v220, v221
    v_max3_u32 v14, v14, v222, v223
    v_mfma_f32_16x16x32_bf16 v[224:227], v[136:139], v[220:223], v[224:227]
    v_mfma_f32_16x16x32_bf16 v[228:231], v[140:143], v[220:223], v[228:231]
    s_waitcnt vmcnt(2)
    v_max3_u32 v14, v14, v232, v233
    v_max3_u32 v14, v14, v234, v235
    s_waitcnt vmcnt(2)
    v_max_u32 v14, v14, v236
    v_cmp_eq_u32 vcc, -1, v14
    s_cbranch_vccnz P_slow
P_h1ok:
    v_add_f32_dpp v232, v232, v232 quad_perm:[1,0,3,2] row_mask:0xf bank_mask:0xf
    v_add_f32_dpp v233, v233, v233 quad_perm:[1,0,3,2] row_mask:0xf bank_mask:0xf
    v_add_f32_dpp v234, v234, v234 quad_perm:[1,0,3,2] row_mask:0xf bank_mask:0xf
    v_add_f32_dpp v235, v235, v235 quad_perm:[1,0,3,2] row_mask:0xf bank_mask:0xf
    v_add_f32_dpp v232, v232, v232 quad_perm:[2,3,0,1] row_mask:0xf bank_mask:0xf
    v_add_f32_dpp v233, v233, v233 quad_perm:[2,3,0,1] row_mask:0xf bank_mask:0xf
    v_add_f32_dpp v234, v234, v234 quad_perm:[2,3,0,1] row_mask:0xf bank_mask:0xf
    v_add_f32_dpp v235, v235, v235 quad_perm:[2,3,0,1] row_mask:0xf bank_mask:0xf
    v_add_f32_dpp v232, v232, v232 row_half_mirror row_mask:0xf bank_mask:0xf
    v_add_f32_dpp v233, v233, v233 row_half_mirror row_mask:0xf bank_mask:0xf
    v_add_f32_dpp v234, v234, v234 row_half_mirror row_mask:0xf bank_mask:0xf
    v_add_f32_dpp v235, v235, v235 row_half_mirror row_mask:0xf bank_mask:0xf
    v_add_f32_dpp v232, v232, v232 row_mirror row_mask:0xf bank_mask:0xf
    v_add_f32_dpp v233, v233, v233 row_mirror row_mask:0xf bank_mask:0xf
    v_add_f32_dpp v234, v234, v234 row_mirror row_mask:0xf bank_mask:0xf
    v_add_f32_dpp v235, v235, v235 row_mirror row_mask:0xf bank_mask:0xf
    v_cvt_pk_bf16_f32 v224, v224, v225
    v_cvt_pk_bf16_f32 v225, v226, v227
    v_cvt_pk_bf16_f32 v226, v228, v229
    v_cvt_pk_bf16_f32 v227, v230, v231
    ds_write_b64 v12, v[224:225]
    ds_write_b64 v12, v[226:227] offset:1024
    v_cvt_pk_bf16_f32 v232, v232, v233
    v_cvt_pk_bf16_f32 v233, v234, v235
    ds_write_b64 v13, v[232:233]
    s_branch POST
P_slow:
    s_mov_b32 s59, 0
P_retry:
    s_mov_b32 s76, 0
    v_max_u32 v14, v160, v161
    v_max3_u32 v14, v14, v162, v163
    v_cmp_eq_u32 vcc, -1, v14
    s_cbranch_vccz P_rc0
    s_xor_b32 s66, s57, 0
    buffer_load_dwordx4 v[160:163], v132, s[16:19], s66 offen offset:0 sc1
    s_mov_b32 s76, 1
P_rc0:
    v_max_u32 v14, v164, v165
    v_max3_u32 v14, v14, v166, v167
    v_cmp_eq_u32 vcc, -1, v14
    s_cbranch_vccz P_rc1
    s_xor_b32 s66, s57, 0
    buffer_load_dwordx4 v[164:167], v132, s[16:19], s66 offen offset:1024 sc1
    s_mov_b32 s76, 1
P_rc1:
    v_max_u32 v14, v168, v169
    v_max3_u32 v14, v14, v170, v171
    v_cmp_eq_u32 vcc, -1, v14
    s_cbranch_vccz P_rc2
    s_xor_b32 s66, s57, 0
    buffer_load_dwordx4 v[168:171], v132, s[16:19], s66 offen offset:2048 sc1
    s_mov_b32 s76, 1
P_rc2:
    v_max_u32 v14, v172, v173
    v_max3_u32 v14, v14, v174, v175
    v_cmp_eq_u32 vcc, -1, v14
    s_cbranch_vccz P_rc3
    s_xor_b32 s66, s57, 0
    buffer_load_dwordx4 v[172:175], v132, s[16:19], s66 offen offset:3072 sc1
    s_mov_b32 s76, 1
P_rc3:
    v_max_u32 v14, v176, v177
    v_max3_u32 v14, v14, v178, v179
    v_cmp_eq_u32 vcc, -1, v14
    s_cbranch_vccz P_rc4
    s_xor_b32 s66, s57, 4096
    buffer_load_dwordx4 v[176:179], v132, s[16:19], s66 offen offset:0 sc1
    s_mov_b32 s76, 1
P_rc4:
    v_max_u32 v14, v180, v181
    v_max3_u32 v14, v14, v182, v183
    v_cmp_eq_u32 vcc, -1, v14
    s_cbranch_vccz P_rc5
    s_xor_b32 s66, s57, 4096
    buffer_load_dwordx4 v[180:183], v132, s[16:19], s66 offen offset:1024 sc1
    s_mov_b32 s76, 1
P_rc5:
    v_max_u32 v14, v184, v185
    v_max3_u32 v14, v14, v186, v187
    v_cmp_eq_u32 vcc, -1, v14
    s_cbranch_vccz P_rc6
    s_xor_b32 s66, s57, 4096
    buffer_load_dwordx4 v[184:187], v132, s[16:19], s66 offen offset:2048 sc1
    s_mov_b32 s76, 1
P_rc6:
    v_max_u32 v14, v188, v189
    v_max3_u32 v14, v14, v190, v191
    v_cmp_eq_u32 vcc, -1, v14
    s_cbranch_vccz P_rc7
    s_xor_b32 s66, s57, 4096
    buffer_load_dwordx4 v[188:191], v132, s[16:19], s66 offen offset:3072 sc1
    s_mov_b32 s76, 1
P_rc7:
    v_max_u32 v14, v192, v193
    v_max3_u32 v14, v14, v194, v195
    v_cmp_eq_u32 vcc, -1, v14
    s_cbranch_vccz P_rc8
    s_xor_b32 s66, s57, 8192
    buffer_load_dwordx4 v[192:195], v132, s[16:19], s66 offen offset:0 sc1
    s_mov_b32 s76, 1
P_rc8:
    v_max_u32 v14, v196, v197
    v_max3_u32 v14, v14, v198, v199
    v_cmp_eq_u32 vcc, -1, v14
    s_cbranch_vccz P_rc9
    s_xor_b32 s66, s57, 8192
    buffer_load_dwordx4 v[196:199], v132, s[16:19], s66 offen offset:1024 sc1
    s_mov_b32 s76, 1
P_rc9:
    v_max_u32 v14, v200, v201
    v_max3_u32 v14, v14, v202, v203
    v_cmp_eq_u32 vcc, -1, v14
    s_cbranch_vccz P_rc10
    s_xor_b32 s66, s57, 8192
    buffer_load_dwordx4 v[200:203], v132, s[16:19], s66 offen offset:2048 sc1
    s_mov_b32 s76, 1
P_rc10:
    v_max_u32 v14, v204, v205
    v_max3_u32 v14, v14, v206, v207
    v_cmp_eq_u32 vcc, -1, v14
    s_cbranch_vccz P_rc11
    s_xor_b32 s66, s57, 8192
    buffer_load_dwordx4 v[204:207], v132, s[16:19], s66 offen offset:3072 sc1
    s_mov_b32 s76, 1
P_rc11:
    v_max_u32 v14, v208, v209
    v_max3_u32 v14, v14, v210, v211
    v_cmp_eq_u32 vcc, -1, v14
    s_cbranch_vccz P_rc12
    s_xor_b32 s66, s57, 12288
    buffer_load_dwordx4 v[208:211], v132, s[16:19], s66 offen offset:0 sc1
    s_mov_b32 s76, 1
P_rc12:
    v_max_u32 v14, v212, v213
    v_max3_u32 v14, v14, v214, v215
    v_cmp_eq_u32 vcc, -1, v14
    s_cbranch_vccz P_rc13
    s_xor_b32 s66, s57, 12288
    buffer_load_dwordx4 v[212:215], v132, s[16:19], s66 offen offset:1024 sc1
    s_mov_b32 s76, 1
P_rc13:
    v_max_u32 v14, v216, v217
    v_max3_u32 v14, v14, v218, v219
    v_cmp_eq_u32 vcc, -1, v14
    s_cbranch_vccz P_rc14
    s_xor_b32 s66, s57, 12288
    buffer_load_dwordx4 v[216:219], v132, s[16:19], s66 offen offset:2048 sc1
    s_mov_b32 s76, 1
P_rc14:
    v_max_u32 v14, v220, v221
    v_max3_u32 v14, v14, v222, v223
    v_cmp_eq_u32 vcc, -1, v14
    s_cbranch_vccz P_rc15
    s_xor_b32 s66, s57, 12288
    buffer_load_dwordx4 v[220:223], v132, s[16:19], s66 offen offset:3072 sc1
    s_mov_b32 s76, 1
P_rc15:
    v_max_u32 v14, v232, v233
    v_max3_u32 v14, v14, v234, v235
    v_cmp_eq_u32 vcc, -1, v14
    s_cbranch_vccz P_rc16
    buffer_load_dwordx4 v[232:235], v133, s[16:19], 0 offen sc1
    s_mov_b32 s76, 1
P_rc16:
    v_cmp_eq_u32 vcc, -1, v236
    s_cbranch_vccz P_rc17
    buffer_load_dword v236, v134, s[16:19], 0 offen sc1
    s_mov_b32 s76, 1
P_rc17:
    s_add_u32 s59, s59, 1
    s_cmp_ge_u32 s59, 200000
    s_cselect_b32 s76, 0, s76
    s_waitcnt vmcnt(0)
    s_cmp_lg_u32 s76, 0
    s_cbranch_scc1 P_retry
    v_mfma_f32_16x16x32_bf16 v[224:227], v[136:139], v[160:163], 0
    v_mfma_f32_16x16x32_bf16 v[228:231], v[140:143], v[160:163], 0
    v_mfma_f32_16x16x32_bf16 v[224:227], v[136:139], v[164:167], v[224:227]
    v_mfma_f32_16x16x32_bf16 v[228:231], v[140:143], v[164:167], v[228:231]
    v_mfma_f32_16x16x32_bf16 v[224:227], v[136:139], v[168:171], v[224:227]
    v_mfma_f32_16x16x32_bf16 v[228:231], v[140:143], v[168:171], v[228:231]
    v_mfma_f32_16x16x32_bf16 v[224:227], v[136:139], v[172:175], v[224:227]
    v_mfma_f32_16x16x32_bf16 v[228:231], v[140:143], v[172:175], v[228:231]
    v_mfma_f32_16x16x32_bf16 v[224:227], v[136:139], v[176:179], v[224:227]
    v_mfma_f32_16x16x32_bf16 v[228:231], v[140:143], v[176:179], v[228:231]
    v_mfma_f32_16x16x32_bf16 v[224:227], v[136:139], v[180:183], v[224:227]
    v_mfma_f32_16x16x32_bf16 v[228:231], v[140:143], v[180:183], v[228:231]
    v_mfma_f32_16x16x32_bf16 v[224:227], v[136:139], v[184:187], v[224:227]
    v_mfma_f32_16x16x32_bf16 v[228:231], v[140:143], v[184:187], v[228:231]
    v_mfma_f32_16x16x32_bf16 v[224:227], v[136:139], v[188:191], v[224:227]
    v_mfma_f32_16x16x32_bf16 v[228:231], v[140:143], v[188:191], v[228:231]
    v_mfma_f32_16x16x32_bf16 v[224:227], v[136:139], v[192:195], v[224:227]
    v_mfma_f32_16x16x32_bf16 v[228:231], v[140:143], v[192:195], v[228:231]
    v_mfma_f32_16x16x32_bf16 v[224:227], v[136:139], v[196:199], v[224:227]
    v_mfma_f32_16x16x32_bf16 v[228:231], v[140:143], v[196:199], v[228:231]
    v_mfma_f32_16x16x32_bf16 v[224:227], v[136:139], v[200:203], v[224:227]
    v_mfma_f32_16x16x32_bf16 v[228:231], v[140:143], v[200:203], v[228:231]
    v_mfma_f32_16x16x32_bf16 v[224:227], v[136:139], v[204:207], v[224:227]
    v_mfma_f32_16x16x32_bf16 v[228:231], v[140:143], v[204:207], v[228:231]
    v_mfma_f32_16x16x32_bf16 v[224:227], v[136:139], v[208:211], v[224:227]
    v_mfma_f32_16x16x32_bf16 v[228:231], v[140:143], v[208:211], v[228:231]
    v_mfma_f32_16x16x32_bf16 v[224:227], v[136:139], v[212:215], v[224:227]
    v_mfma_f32_16x16x32_bf16 v[228:231], v[140:143], v[212:215], v[228:231]
    v_mfma_f32_16x16x32_bf16 v[224:227], v[136:139], v[216:219], v[224:227]
    v_mfma_f32_16x16x32_bf16 v[228:231], v[140:143], v[216:219], v[228:231]
    v_mfma_f32_16x16x32_bf16 v[224:227], v[136:139], v[220:223], v[224:227]
    v_mfma_f32_16x16x32_bf16 v[228:231], v[140:143], v[220:223], v[228:231]
    s_branch P_h1ok
HELP:
    v_lshlrev_b32 v9, 4, v2
    s_lshl_b32 s52, s5, 2
    s_add_u32 s52, s52, s44
    s_lshl_b32 s53, s52, 10
    s_lshl_b32 s66, s4, 6
    s_add_u32 s53, s53, s66
    s_add_u32 s53, s53, 5242880
    s_lshl_b32 s52, s52, 4
    s_add_u32 s52, s52, s4
    s_lshl_b32 s52, s52, 10
    s_add_u32 s52, s52, 4194304
    s_lshl_b32 s55, s73, 2
    s_add_u32 s55, s55, s44
    s_lshl_b32 s55, s55, 6
    s_add_u32 s55, s55, s79
    s_lshl_b32 s55, s55, 8
    s_add_u32 s55, s55, 5832704
    s_cmp_ge_u32 s44, 2
    s_cbranch_scc1 WORK
    s_waitcnt vmcnt(5)
    s_barrier
    s_add_u32 s71, s76, 2
    s_and_b32 s71, s71, 15
    s_lshl_b32 s70, s71, 7
    s_mul_i32 s71, s71, 393216
    s_add_u32 m0, s72, 106496
    s_add_u32 s66, s71, 2048
    buffer_load_dwordx4 v5, s[12:15], s66 offen lds
    s_add_u32 m0, s72, 108544
    s_add_u32 s66, s71, 100352
    buffer_load_dwordx4 v5, s[12:15], s66 offen lds
    s_add_u32 m0, s72, 110592
    s_add_u32 s66, s71, 198656
    buffer_load_dwordx4 v5, s[12:15], s66 offen lds
    s_add_u32 m0, s72, 112640
    s_add_u32 s66, s71, 296960
    buffer_load_dwordx4 v5, s[12:15], s66 offen lds
    s_add_u32 m0, s72, 81920
    s_add_u32 s66, s70, 0
    buffer_load_dwordx4 v4, s[8:11], s66 offen lds
    s_add_u32 m0, s72, 83968
    s_add_u32 s66, s70, 32768
    buffer_load_dwordx4 v4, s[8:11], s66 offen lds
    s_add_u32 m0, s72, 86016
    s_add_u32 s66, s70, 65536
    buffer_load_dwordx4 v4, s[8:11], s66 offen lds
    s_add_u32 m0, s72, 88064
    s_add_u32 s66, s70, 98304
    buffer_load_dwordx4 v4, s[8:11], s66 offen lds
    s_add_u32 m0, s72, 90112
    s_add_u32 s66, s70, 131072
    buffer_load_dwordx4 v4, s[8:11], s66 offen lds
    s_add_u32 m0, s72, 92160
    s_add_u32 s66, s70, 163840
    buffer_load_dwordx4 v4, s[8:11], s66 offen lds
    s_add_u32 m0, s72, 94208
    s_add_u32 s66, s70, 196608
    buffer_load_dwordx4 v4, s[8:11], s66 offen lds
    s_add_u32 m0, s72, 96256
    s_add_u32 s66, s70, 229376
    buffer_load_dwordx4 v4, s[8:11], s66 offen lds
    s_add_u32 m0, s72, 114688
    s_add_u32 s66, s71, 4096
    buffer_load_dwordx4 v5, s[12:15], s66 offen lds
    s_add_u32 m0, s72, 116736
    s_add_u32 s66, s71, 102400
    buffer_load_dwordx4 v5, s[12:15], s66 offen lds
    s_add_u32 m0, s72, 118784
    s_add_u32 s66, s71, 200704
    buffer_load_dwordx4 v5, s[12:15], s66 offen lds
    s_add_u32 m0, s72, 120832
    s_add_u32 s66, s71, 299008
    buffer_load_dwordx4 v5, s[12:15], s66 offen lds
    s_add_u32 m0, s72, 98304
    s_add_u32 s66, s71, 0
    buffer_load_dwordx4 v5, s[12:15], s66 offen lds
    s_add_u32 m0, s72, 100352
    s_add_u32 s66, s71, 98304
    buffer_load_dwordx4 v5, s[12:15], s66 offen lds
    s_add_u32 m0, s72, 102400
    s_add_u32 s66, s71, 196608
    buffer_load_dwordx4 v5, s[12:15], s66 offen lds
    s_add_u32 m0, s72, 104448
    s_add_u32 s66, s71, 294912
    buffer_load_dwordx4 v5, s[12:15], s66 offen lds
    s_waitcnt vmcnt(20)
    s_barrier
    s_add_u32 s71, s76, 3
    s_and_b32 s71, s71, 15
    s_lshl_b32 s70, s71, 7
    s_mul_i32 s71, s71, 393216
    s_add_u32 m0, s72, 24576
    s_add_u32 s66, s71, 2048
    buffer_load_dwordx4 v5, s[12:15], s66 offen lds
    s_add_u32 m0, s72, 26624
    s_add_u32 s66, s71, 100352
    buffer_load_dwordx4 v5, s[12:15], s66 offen lds
    s_add_u32 m0, s72, 28672
    s_add_u32 s66, s71, 198656
    buffer_load_dwordx4 v5, s[12:15], s66 offen lds
    s_add_u32 m0, s72, 30720
    s_add_u32 s66, s71, 296960
    buffer_load_dwordx4 v5, s[12:15], s66 offen lds
    s_add_u32 m0, s72, 0
    s_add_u32 s66, s70, 0
    buffer_load_dwordx4 v4, s[8:11], s66 offen lds
    s_add_u32 m0, s72, 2048
    s_add_u32 s66, s70, 32768
    buffer_load_dwordx4 v4, s[8:11], s66 offen lds
    s_add_u32 m0, s72, 4096
    s_add_u32 s66, s70, 65536
    buffer_load_dwordx4 v4, s[8:11], s66 offen lds
    s_add_u32 m0, s72, 6144
    s_add_u32 s66, s70, 98304
    buffer_load_dwordx4 v4, s[8:11], s66 offen lds
    s_add_u32 m0, s72, 8192
    s_add_u32 s66, s70, 131072
    buffer_load_dwordx4 v4, s[8:11], s66 offen lds
    s_add_u32 m0, s72, 10240
    s_add_u32 s66, s70, 163840
    buffer_load_dwordx4 v4, s[8:11], s66 offen lds
    s_add_u32 m0, s72, 12288
    s_add_u32 s66, s70, 196608
    buffer_load_dwordx4 v4, s[8:11], s66 offen lds
    s_add_u32 m0, s72, 14336
    s_add_u32 s66, s70, 229376
    buffer_load_dwordx4 v4, s[8:11], s66 offen lds
    s_add_u32 m0, s72, 32768
    s_add_u32 s66, s71, 4096
    buffer_load_dwordx4 v5, s[12:15], s66 offen lds
    s_add_u32 m0, s72, 34816
    s_add_u32 s66, s71, 102400
    buffer_load_dwordx4 v5, s[12:15], s66 offen lds
    s_add_u32 m0, s72, 36864
    s_add_u32 s66, s71, 200704
    buffer_load_dwordx4 v5, s[12:15], s66 offen lds
    s_add_u32 m0, s72, 38912
    s_add_u32 s66, s71, 299008
    buffer_load_dwordx4 v5, s[12:15], s66 offen lds
    s_add_u32 m0, s72, 16384
    s_add_u32 s66, s71, 0
    buffer_load_dwordx4 v5, s[12:15], s66 offen lds
    s_add_u32 m0, s72, 18432
    s_add_u32 s66, s71, 98304
    buffer_load_dwordx4 v5, s[12:15], s66 offen lds
    s_add_u32 m0, s72, 20480
    s_add_u32 s66, s71, 196608
    buffer_load_dwordx4 v5, s[12:15], s66 offen lds
    s_add_u32 m0, s72, 22528
    s_add_u32 s66, s71, 294912
    buffer_load_dwordx4 v5, s[12:15], s66 offen lds
    s_waitcnt vmcnt(20)
    s_barrier
    s_add_u32 s71, s76, 4
    s_and_b32 s71, s71, 15
    s_lshl_b32 s70, s71, 7
    s_mul_i32 s71, s71, 393216
    s_add_u32 m0, s72, 65536
    s_add_u32 s66, s71, 2048
    buffer_load_dwordx4 v5, s[12:15], s66 offen lds
    s_add_u32 m0, s72, 67584
    s_add_u32 s66, s71, 100352
    buffer_load_dwordx4 v5, s[12:15], s66 offen lds
    s_add_u32 m0, s72, 69632
    s_add_u32 s66, s71, 198656
    buffer_load_dwordx4 v5, s[12:15], s66 offen lds
    s_add_u32 m0, s72, 71680
    s_add_u32 s66, s71, 296960
    buffer_load_dwordx4 v5, s[12:15], s66 offen lds
    s_add_u32 m0, s72, 40960
    s_add_u32 s66, s70, 0
    buffer_load_dwordx4 v4, s[8:11], s66 offen lds
    s_add_u32 m0, s72, 43008
    s_add_u32 s66, s70, 32768
    buffer_load_dwordx4 v4, s[8:11], s66 offen lds
    s_add_u32 m0, s72, 45056
    s_add_u32 s66, s70, 65536
    buffer_load_dwordx4 v4, s[8:11], s66 offen lds
    s_add_u32 m0, s72, 47104
    s_add_u32 s66, s70, 98304
    buffer_load_dwordx4 v4, s[8:11], s66 offen lds
    s_add_u32 m0, s72, 49152
    s_add_u32 s66, s70, 131072
    buffer_load_dwordx4 v4, s[8:11], s66 offen lds
    s_add_u32 m0, s72, 51200
    s_add_u32 s66, s70, 163840
    buffer_load_dwordx4 v4, s[8:11], s66 offen lds
    s_add_u32 m0, s72, 53248
    s_add_u32 s66, s70, 196608
    buffer_load_dwordx4 v4, s[8:11], s66 offen lds
    s_add_u32 m0, s72, 55296
    s_add_u32 s66, s70, 229376
    buffer_load_dwordx4 v4, s[8:11], s66 offen lds
    s_add_u32 m0, s72, 73728
    s_add_u32 s66, s71, 4096
    buffer_load_dwordx4 v5, s[12:15], s66 offen lds
    s_add_u32 m0, s72, 75776
    s_add_u32 s66, s71, 102400
    buffer_load_dwordx4 v5, s[12:15], s66 offen lds
    s_add_u32 m0, s72, 77824
    s_add_u32 s66, s71, 200704
    buffer_load_dwordx4 v5, s[12:15], s66 offen lds
    s_add_u32 m0, s72, 79872
    s_add_u32 s66, s71, 299008
    buffer_load_dwordx4 v5, s[12:15], s66 offen lds
    s_add_u32 m0, s72, 57344
    s_add_u32 s66, s71, 0
    buffer_load_dwordx4 v5, s[12:15], s66 offen lds
    s_add_u32 m0, s72, 59392
    s_add_u32 s66, s71, 98304
    buffer_load_dwordx4 v5, s[12:15], s66 offen lds
    s_add_u32 m0, s72, 61440
    s_add_u32 s66, s71, 196608
    buffer_load_dwordx4 v5, s[12:15], s66 offen lds
    s_add_u32 m0, s72, 63488
    s_add_u32 s66, s71, 294912
    buffer_load_dwordx4 v5, s[12:15], s66 offen lds
    s_waitcnt vmcnt(20)
    s_barrier
    s_add_u32 s71, s76, 5
    s_and_b32 s71, s71, 15
    s_lshl_b32 s70, s71, 7
    s_mul_i32 s71, s71, 393216
    s_add_u32 m0, s72, 106496
    s_add_u32 s66, s71, 2048
    buffer_load_dwordx4 v5, s[12:15], s66 offen lds
    s_add_u32 m0, s72, 108544
    s_add_u32 s66, s71, 100352
    buffer_load_dwordx4 v5, s[12:15], s66 offen lds
    s_add_u32 m0, s72, 110592
    s_add_u32 s66, s71, 198656
    buffer_load_dwordx4 v5, s[12:15], s66 offen lds
    s_add_u32 m0, s72, 112640
    s_add_u32 s66, s71, 296960
    buffer_load_dwordx4 v5, s[12:15], s66 offen lds
    s_add_u32 m0, s72, 81920
    s_add_u32 s66, s70, 0
    buffer_load_dwordx4 v4, s[8:11], s66 offen lds
    s_add_u32 m0, s72, 83968
    s_add_u32 s66, s70, 32768
    buffer_load_dwordx4 v4, s[8:11], s66 offen lds
    s_add_u32 m0, s72, 86016
    s_add_u32 s66, s70, 65536
    buffer_load_dwordx4 v4, s[8:11], s66 offen lds
    s_add_u32 m0, s72, 88064
    s_add_u32 s66, s70, 98304
    buffer_load_dwordx4 v4, s[8:11], s66 offen lds
    s_add_u32 m0, s72, 90112
    s_add_u32 s66, s70, 131072
    buffer_load_dwordx4 v4, s[8:11], s66 offen lds
    s_add_u32 m0, s72, 92160
    s_add_u32 s66, s70, 163840
    buffer_load_dwordx4 v4, s[8:11], s66 offen lds
    s_add_u32 m0, s72, 94208
    s_add_u32 s66, s70, 196608
    buffer_load_dwordx4 v4, s[8:11], s66 offen lds
    s_add_u32 m0, s72, 96256
    s_add_u32 s66, s70, 229376
    buffer_load_dwordx4 v4, s[8:11], s66 offen lds
    s_add_u32 m0, s72, 114688
    s_add_u32 s66, s71, 4096
    buffer_load_dwordx4 v5, s[12:15], s66 offen lds
    s_add_u32 m0, s72, 116736
    s_add_u32 s66, s71, 102400
    buffer_load_dwordx4 v5, s[12:15], s66 offen lds
    s_add_u32 m0, s72, 118784
    s_add_u32 s66, s71, 200704
    buffer_load_dwordx4 v5, s[12:15], s66 offen lds
    s_add_u32 m0, s72, 120832
    s_add_u32 s66, s71, 299008
    buffer_load_dwordx4 v5, s[12:15], s66 offen lds
    s_add_u32 m0, s72, 98304
    s_add_u32 s66, s71, 0
    buffer_load_dwordx4 v5, s[12:15], s66 offen lds
    s_add_u32 m0, s72, 100352
    s_add_u32 s66, s71, 98304
    buffer_load_dwordx4 v5, s[12:15], s66 offen lds
    s_add_u32 m0, s72, 102400
    s_add_u32 s66, s71, 196608
    buffer_load_dwordx4 v5, s[12:15], s66 offen lds
    s_add_u32 m0, s72, 104448
    s_add_u32 s66, s71, 294912
    buffer_load_dwordx4 v5, s[12:15], s66 offen lds
    s_waitcnt vmcnt(20)
    s_barrier
    s_add_u32 s71, s76, 6
    s_and_b32 s71, s71, 15
    s_lshl_b32 s70, s71, 7
    s_mul_i32 s71, s71, 393216
    s_add_u32 m0, s72, 24576
    s_add_u32 s66, s71, 2048
    buffer_load_dwordx4 v5, s[12:15], s66 offen lds
    s_add_u32 m0, s72, 26624
    s_add_u32 s66, s71, 100352
    buffer_load_dwordx4 v5, s[12:15], s66 offen lds
    s_add_u32 m0, s72, 28672
    s_add_u32 s66, s71, 198656
    buffer_load_dwordx4 v5, s[12:15], s66 offen lds
    s_add_u32 m0, s72, 30720
    s_add_u32 s66, s71, 296960
    buffer_load_dwordx4 v5, s[12:15], s66 offen lds
    s_add_u32 m0, s72, 0
    s_add_u32 s66, s70, 0
    buffer_load_dwordx4 v4, s[8:11], s66 offen lds
    s_add_u32 m0, s72, 2048
    s_add_u32 s66, s70, 32768
    buffer_load_dwordx4 v4, s[8:11], s66 offen lds
    s_add_u32 m0, s72, 4096
    s_add_u32 s66, s70, 65536
    buffer_load_dwordx4 v4, s[8:11], s66 offen lds
    s_add_u32 m0, s72, 6144
    s_add_u32 s66, s70, 98304
    buffer_load_dwordx4 v4, s[8:11], s66 offen lds
    s_add_u32 m0, s72, 8192
    s_add_u32 s66, s70, 131072
    buffer_load_dwordx4 v4, s[8:11], s66 offen lds
    s_add_u32 m0, s72, 10240
    s_add_u32 s66, s70, 163840
    buffer_load_dwordx4 v4, s[8:11], s66 offen lds
    s_add_u32 m0, s72, 12288
    s_add_u32 s66, s70, 196608
    buffer_load_dwordx4 v4, s[8:11], s66 offen lds
    s_add_u32 m0, s72, 14336
    s_add_u32 s66, s70, 229376
    buffer_load_dwordx4 v4, s[8:11], s66 offen lds
    s_add_u32 m0, s72, 32768
    s_add_u32 s66, s71, 4096
    buffer_load_dwordx4 v5, s[12:15], s66 offen lds
    s_add_u32 m0, s72, 34816
    s_add_u32 s66, s71, 102400
    buffer_load_dwordx4 v5, s[12:15], s66 offen lds
    s_add_u32 m0, s72, 36864
    s_add_u32 s66, s71, 200704
    buffer_load_dwordx4 v5, s[12:15], s66 offen lds
    s_add_u32 m0, s72, 38912
    s_add_u32 s66, s71, 299008
    buffer_load_dwordx4 v5, s[12:15], s66 offen lds
    s_add_u32 m0, s72, 16384
    s_add_u32 s66, s71, 0
    buffer_load_dwordx4 v5, s[12:15], s66 offen lds
    s_add_u32 m0, s72, 18432
    s_add_u32 s66, s71, 98304
    buffer_load_dwordx4 v5, s[12:15], s66 offen lds
    s_add_u32 m0, s72, 20480
    s_add_u32 s66, s71, 196608
    buffer_load_dwordx4 v5, s[12:15], s66 offen lds
    s_add_u32 m0, s72, 22528
    s_add_u32 s66, s71, 294912
    buffer_load_dwordx4 v5, s[12:15], s66 offen lds
    s_waitcnt vmcnt(20)
    s_barrier
    s_add_u32 s71, s76, 7
    s_and_b32 s71, s71, 15
    s_lshl_b32 s70, s71, 7
    s_mul_i32 s71, s71, 393216
    s_add_u32 m0, s72, 65536
    s_add_u32 s66, s71, 2048
    buffer_load_dwordx4 v5, s[12:15], s66 offen lds
    s_add_u32 m0, s72, 67584
    s_add_u32 s66, s71, 100352
    buffer_load_dwordx4 v5, s[12:15], s66 offen lds
    s_add_u32 m0, s72, 69632
    s_add_u32 s66, s71, 198656
    buffer_load_dwordx4 v5, s[12:15], s66 offen lds
    s_add_u32 m0, s72, 71680
    s_add_u32 s66, s71, 296960
    buffer_load_dwordx4 v5, s[12:15], s66 offen lds
    s_add_u32 m0, s72, 40960
    s_add_u32 s66, s70, 0
    buffer_load_dwordx4 v4, s[8:11], s66 offen lds
    s_add_u32 m0, s72, 43008
    s_add_u32 s66, s70, 32768
    buffer_load_dwordx4 v4, s[8:11], s66 offen lds
    s_add_u32 m0, s72, 45056
    s_add_u32 s66, s70, 65536
    buffer_load_dwordx4 v4, s[8:11], s66 offen lds
    s_add_u32 m0, s72, 47104
    s_add_u32 s66, s70, 98304
    buffer_load_dwordx4 v4, s[8:11], s66 offen lds
    s_add_u32 m0, s72, 49152
    s_add_u32 s66, s70, 131072
    buffer_load_dwordx4 v4, s[8:11], s66 offen lds
    s_add_u32 m0, s72, 51200
    s_add_u32 s66, s70, 163840
    buffer_load_dwordx4 v4, s[8:11], s66 offen lds
    s_add_u32 m0, s72, 53248
    s_add_u32 s66, s70, 196608
    buffer_load_dwordx4 v4, s[8:11], s66 offen lds
    s_add_u32 m0, s72, 55296
    s_add_u32 s66, s70, 229376
    buffer_load_dwordx4 v4, s[8:11], s66 offen lds
    s_add_u32 m0, s72, 73728
    s_add_u32 s66, s71, 4096
    buffer_load_dwordx4 v5, s[12:15], s66 offen lds
    s_add_u32 m0, s72, 75776
    s_add_u32 s66, s71, 102400
    buffer_load_dwordx4 v5, s[12:15], s66 offen lds
    s_add_u32 m0, s72, 77824
    s_add_u32 s66, s71, 200704
    buffer_load_dwordx4 v5, s[12:15], s66 offen lds
    s_add_u32 m0, s72, 79872
    s_add_u32 s66, s71, 299008
    buffer_load_dwordx4 v5, s[12:15], s66 offen lds
    s_add_u32 m0, s72, 57344
    s_add_u32 s66, s71, 0
    buffer_load_dwordx4 v5, s[12:15], s66 offen lds
    s_add_u32 m0, s72, 59392
    s_add_u32 s66, s71, 98304
    buffer_load_dwordx4 v5, s[12:15], s66 offen lds
    s_add_u32 m0, s72, 61440
    s_add_u32 s66, s71, 196608
    buffer_load_dwordx4 v5, s[12:15], s66 offen lds
    s_add_u32 m0, s72, 63488
    s_add_u32 s66, s71, 294912
    buffer_load_dwordx4 v5, s[12:15], s66 offen lds
    s_waitcnt vmcnt(20)
    s_barrier
    s_add_u32 s71, s76, 8
    s_and_b32 s71, s71, 15
    s_lshl_b32 s70, s71, 7
    s_mul_i32 s71, s71, 393216
    s_add_u32 m0, s72, 106496
    s_add_u32 s66, s71, 2048
    buffer_load_dwordx4 v5, s[12:15], s66 offen lds
    s_add_u32 m0, s72, 108544
    s_add_u32 s66, s71, 100352
    buffer_load_dwordx4 v5, s[12:15], s66 offen lds
    s_add_u32 m0, s72, 110592
    s_add_u32 s66, s71, 198656
    buffer_load_dwordx4 v5, s[12:15], s66 offen lds
    s_add_u32 m0, s72, 112640
    s_add_u32 s66, s71, 296960
    buffer_load_dwordx4 v5, s[12:15], s66 offen lds
    s_add_u32 m0, s72, 81920
    s_add_u32 s66, s70, 0
    buffer_load_dwordx4 v4, s[8:11], s66 offen lds
    s_add_u32 m0, s72, 83968
    s_add_u32 s66, s70, 32768
    buffer_load_dwordx4 v4, s[8:11], s66 offen lds
    s_add_u32 m0, s72, 86016
    s_add_u32 s66, s70, 65536
    buffer_load_dwordx4 v4, s[8:11], s66 offen lds
    s_add_u32 m0, s72, 88064
    s_add_u32 s66, s70, 98304
    buffer_load_dwordx4 v4, s[8:11], s66 offen lds
    s_add_u32 m0, s72, 90112
    s_add_u32 s66, s70, 131072
    buffer_load_dwordx4 v4, s[8:11], s66 offen lds
    s_add_u32 m0, s72, 92160
    s_add_u32 s66, s70, 163840
    buffer_load_dwordx4 v4, s[8:11], s66 offen lds
    s_add_u32 m0, s72, 94208
    s_add_u32 s66, s70, 196608
    buffer_load_dwordx4 v4, s[8:11], s66 offen lds
    s_add_u32 m0, s72, 96256
    s_add_u32 s66, s70, 229376
    buffer_load_dwordx4 v4, s[8:11], s66 offen lds
    s_add_u32 m0, s72, 114688
    s_add_u32 s66, s71, 4096
    buffer_load_dwordx4 v5, s[12:15], s66 offen lds
    s_add_u32 m0, s72, 116736
    s_add_u32 s66, s71, 102400
    buffer_load_dwordx4 v5, s[12:15], s66 offen lds
    s_add_u32 m0, s72, 118784
    s_add_u32 s66, s71, 200704
    buffer_load_dwordx4 v5, s[12:15], s66 offen lds
    s_add_u32 m0, s72, 120832
    s_add_u32 s66, s71, 299008
    buffer_load_dwordx4 v5, s[12:15], s66 offen lds
    s_add_u32 m0, s72, 98304
    s_add_u32 s66, s71, 0
    buffer_load_dwordx4 v5, s[12:15], s66 offen lds
    s_add_u32 m0, s72, 100352
    s_add_u32 s66, s71, 98304
    buffer_load_dwordx4 v5, s[12:15], s66 offen lds
    s_add_u32 m0, s72, 102400
    s_add_u32 s66, s71, 196608
    buffer_load_dwordx4 v5, s[12:15], s66 offen lds
    s_add_u32 m0, s72, 104448
    s_add_u32 s66, s71, 294912
    buffer_load_dwordx4 v5, s[12:15], s66 offen lds
    s_waitcnt vmcnt(20)
    s_barrier
    s_add_u32 s71, s76, 9
    s_and_b32 s71, s71, 15
    s_lshl_b32 s70, s71, 7
    s_mul_i32 s71, s71, 393216
    s_add_u32 m0, s72, 24576
    s_add_u32 s66, s71, 2048
    buffer_load_dwordx4 v5, s[12:15], s66 offen lds
    s_add_u32 m0, s72, 26624
    s_add_u32 s66, s71, 100352
    buffer_load_dwordx4 v5, s[12:15], s66 offen lds
    s_add_u32 m0, s72, 28672
    s_add_u32 s66, s71, 198656
    buffer_load_dwordx4 v5, s[12:15], s66 offen lds
    s_add_u32 m0, s72, 30720
    s_add_u32 s66, s71, 296960
    buffer_load_dwordx4 v5, s[12:15], s66 offen lds
    s_add_u32 m0, s72, 0
    s_add_u32 s66, s70, 0
    buffer_load_dwordx4 v4, s[8:11], s66 offen lds
    s_add_u32 m0, s72, 2048
    s_add_u32 s66, s70, 32768
    buffer_load_dwordx4 v4, s[8:11], s66 offen lds
    s_add_u32 m0, s72, 4096
    s_add_u32 s66, s70, 65536
    buffer_load_dwordx4 v4, s[8:11], s66 offen lds
    s_add_u32 m0, s72, 6144
    s_add_u32 s66, s70, 98304
    buffer_load_dwordx4 v4, s[8:11], s66 offen lds
    s_add_u32 m0, s72, 8192
    s_add_u32 s66, s70, 131072
    buffer_load_dwordx4 v4, s[8:11], s66 offen lds
    s_add_u32 m0, s72, 10240
    s_add_u32 s66, s70, 163840
    buffer_load_dwordx4 v4, s[8:11], s66 offen lds
    s_add_u32 m0, s72, 12288
    s_add_u32 s66, s70, 196608
    buffer_load_dwordx4 v4, s[8:11], s66 offen lds
    s_add_u32 m0, s72, 14336
    s_add_u32 s66, s70, 229376
    buffer_load_dwordx4 v4, s[8:11], s66 offen lds
    s_add_u32 m0, s72, 32768
    s_add_u32 s66, s71, 4096
    buffer_load_dwordx4 v5, s[12:15], s66 offen lds
    s_add_u32 m0, s72, 34816
    s_add_u32 s66, s71, 102400
    buffer_load_dwordx4 v5, s[12:15], s66 offen lds
    s_add_u32 m0, s72, 36864
    s_add_u32 s66, s71, 200704
    buffer_load_dwordx4 v5, s[12:15], s66 offen lds
    s_add_u32 m0, s72, 38912
    s_add_u32 s66, s71, 299008
    buffer_load_dwordx4 v5, s[12:15], s66 offen lds
    s_add_u32 m0, s72, 16384
    s_add_u32 s66, s71, 0
    buffer_load_dwordx4 v5, s[12:15], s66 offen lds
    s_add_u32 m0, s72, 18432
    s_add_u32 s66, s71, 98304
    buffer_load_dwordx4 v5, s[12:15], s66 offen lds
    s_add_u32 m0, s72, 20480
    s_add_u32 s66, s71, 196608
    buffer_load_dwordx4 v5, s[12:15], s66 offen lds
    s_add_u32 m0, s72, 22528
    s_add_u32 s66, s71, 294912
    buffer_load_dwordx4 v5, s[12:15], s66 offen lds
    s_waitcnt vmcnt(20)
    s_barrier
    s_add_u32 s71, s76, 10
    s_and_b32 s71, s71, 15
    s_lshl_b32 s70, s71, 7
    s_mul_i32 s71, s71, 393216
    s_add_u32 m0, s72, 65536
    s_add_u32 s66, s71, 2048
    buffer_load_dwordx4 v5, s[12:15], s66 offen lds
    s_add_u32 m0, s72, 67584
    s_add_u32 s66, s71, 100352
    buffer_load_dwordx4 v5, s[12:15], s66 offen lds
    s_add_u32 m0, s72, 69632
    s_add_u32 s66, s71, 198656
    buffer_load_dwordx4 v5, s[12:15], s66 offen lds
    s_add_u32 m0, s72, 71680
    s_add_u32 s66, s71, 296960
    buffer_load_dwordx4 v5, s[12:15], s66 offen lds
    s_add_u32 m0, s72, 40960
    s_add_u32 s66, s70, 0
    buffer_load_dwordx4 v4, s[8:11], s66 offen lds
    s_add_u32 m0, s72, 43008
    s_add_u32 s66, s70, 32768
    buffer_load_dwordx4 v4, s[8:11], s66 offen lds
    s_add_u32 m0, s72, 45056
    s_add_u32 s66, s70, 65536
    buffer_load_dwordx4 v4, s[8:11], s66 offen lds
    s_add_u32 m0, s72, 47104
    s_add_u32 s66, s70, 98304
    buffer_load_dwordx4 v4, s[8:11], s66 offen lds
    s_add_u32 m0, s72, 49152
    s_add_u32 s66, s70, 131072
    buffer_load_dwordx4 v4, s[8:11], s66 offen lds
    s_add_u32 m0, s72, 51200
    s_add_u32 s66, s70, 163840
    buffer_load_dwordx4 v4, s[8:11], s66 offen lds
    s_add_u32 m0, s72, 53248
    s_add_u32 s66, s70, 196608
    buffer_load_dwordx4 v4, s[8:11], s66 offen lds
    s_add_u32 m0, s72, 55296
    s_add_u32 s66, s70, 229376
    buffer_load_dwordx4 v4, s[8:11], s66 offen lds
    s_add_u32 m0, s72, 73728
    s_add_u32 s66, s71, 4096
    buffer_load_dwordx4 v5, s[12:15], s66 offen lds
    s_add_u32 m0, s72, 75776
    s_add_u32 s66, s71, 102400
    buffer_load_dwordx4 v5, s[12:15], s66 offen lds
    s_add_u32 m0, s72, 77824
    s_add_u32 s66, s71, 200704
    buffer_load_dwordx4 v5, s[12:15], s66 offen lds
    s_add_u32 m0, s72, 79872
    s_add_u32 s66, s71, 299008
    buffer_load_dwordx4 v5, s[12:15], s66 offen lds
    s_add_u32 m0, s72, 57344
    s_add_u32 s66, s71, 0
    buffer_load_dwordx4 v5, s[12:15], s66 offen lds
    s_add_u32 m0, s72, 59392
    s_add_u32 s66, s71, 98304
    buffer_load_dwordx4 v5, s[12:15], s66 offen lds
    s_add_u32 m0, s72, 61440
    s_add_u32 s66, s71, 196608
    buffer_load_dwordx4 v5, s[12:15], s66 offen lds
    s_add_u32 m0, s72, 63488
    s_add_u32 s66, s71, 294912
    buffer_load_dwordx4 v5, s[12:15], s66 offen lds
    s_waitcnt vmcnt(20)
    s_barrier
    s_add_u32 s71, s76, 11
    s_and_b32 s71, s71, 15
    s_lshl_b32 s70, s71, 7
    s_mul_i32 s71, s71, 393216
    s_add_u32 m0, s72, 106496
    s_add_u32 s66, s71, 2048
    buffer_load_dwordx4 v5, s[12:15], s66 offen lds
    s_add_u32 m0, s72, 108544
    s_add_u32 s66, s71, 100352
    buffer_load_dwordx4 v5, s[12:15], s66 offen lds
    s_add_u32 m0, s72, 110592
    s_add_u32 s66, s71, 198656
    buffer_load_dwordx4 v5, s[12:15], s66 offen lds
    s_add_u32 m0, s72, 112640
    s_add_u32 s66, s71, 296960
    buffer_load_dwordx4 v5, s[12:15], s66 offen lds
    s_add_u32 m0, s72, 81920
    s_add_u32 s66, s70, 0
    buffer_load_dwordx4 v4, s[8:11], s66 offen lds
    s_add_u32 m0, s72, 83968
    s_add_u32 s66, s70, 32768
    buffer_load_dwordx4 v4, s[8:11], s66 offen lds
    s_add_u32 m0, s72, 86016
    s_add_u32 s66, s70, 65536
    buffer_load_dwordx4 v4, s[8:11], s66 offen lds
    s_add_u32 m0, s72, 88064
    s_add_u32 s66, s70, 98304
    buffer_load_dwordx4 v4, s[8:11], s66 offen lds
    s_add_u32 m0, s72, 90112
    s_add_u32 s66, s70, 131072
    buffer_load_dwordx4 v4, s[8:11], s66 offen lds
    s_add_u32 m0, s72, 92160
    s_add_u32 s66, s70, 163840
    buffer_load_dwordx4 v4, s[8:11], s66 offen lds
    s_add_u32 m0, s72, 94208
    s_add_u32 s66, s70, 196608
    buffer_load_dwordx4 v4, s[8:11], s66 offen lds
    s_add_u32 m0, s72, 96256
    s_add_u32 s66, s70, 229376
    buffer_load_dwordx4 v4, s[8:11], s66 offen lds
    s_add_u32 m0, s72, 114688
    s_add_u32 s66, s71, 4096
    buffer_load_dwordx4 v5, s[12:15], s66 offen lds
    s_add_u32 m0, s72, 116736
    s_add_u32 s66, s71, 102400
    buffer_load_dwordx4 v5, s[12:15], s66 offen lds
    s_add_u32 m0, s72, 118784
    s_add_u32 s66, s71, 200704
    buffer_load_dwordx4 v5, s[12:15], s66 offen lds
    s_add_u32 m0, s72, 120832
    s_add_u32 s66, s71, 299008
    buffer_load_dwordx4 v5, s[12:15], s66 offen lds
    s_add_u32 m0, s72, 98304
    s_add_u32 s66, s71, 0
    buffer_load_dwordx4 v5, s[12:15], s66 offen lds
    s_add_u32 m0, s72, 100352
    s_add_u32 s66, s71, 98304
    buffer_load_dwordx4 v5, s[12:15], s66 offen lds
    s_add_u32 m0, s72, 102400
    s_add_u32 s66, s71, 196608
    buffer_load_dwordx4 v5, s[12:15], s66 offen lds
    s_add_u32 m0, s72, 104448
    s_add_u32 s66, s71, 294912
    buffer_load_dwordx4 v5, s[12:15], s66 offen lds
    s_waitcnt vmcnt(20)
    s_barrier
    s_add_u32 s71, s76, 12
    s_and_b32 s71, s71, 15
    s_lshl_b32 s70, s71, 7
    s_mul_i32 s71, s71, 393216
    s_add_u32 m0, s72, 24576
    s_add_u32 s66, s71, 2048
    buffer_load_dwordx4 v5, s[12:15], s66 offen lds
    s_add_u32 m0, s72, 26624
    s_add_u32 s66, s71, 100352
    buffer_load_dwordx4 v5, s[12:15], s66 offen lds
    s_add_u32 m0, s72, 28672
    s_add_u32 s66, s71, 198656
    buffer_load_dwordx4 v5, s[12:15], s66 offen lds
    s_add_u32 m0, s72, 30720
    s_add_u32 s66, s71, 296960
    buffer_load_dwordx4 v5, s[12:15], s66 offen lds
    s_add_u32 m0, s72, 0
    s_add_u32 s66, s70, 0
    buffer_load_dwordx4 v4, s[8:11], s66 offen lds
    s_add_u32 m0, s72, 2048
    s_add_u32 s66, s70, 32768
    buffer_load_dwordx4 v4, s[8:11], s66 offen lds
    s_add_u32 m0, s72, 4096
    s_add_u32 s66, s70, 65536
    buffer_load_dwordx4 v4, s[8:11], s66 offen lds
    s_add_u32 m0, s72, 6144
    s_add_u32 s66, s70, 98304
    buffer_load_dwordx4 v4, s[8:11], s66 offen lds
    s_add_u32 m0, s72, 8192
    s_add_u32 s66, s70, 131072
    buffer_load_dwordx4 v4, s[8:11], s66 offen lds
    s_add_u32 m0, s72, 10240
    s_add_u32 s66, s70, 163840
    buffer_load_dwordx4 v4, s[8:11], s66 offen lds
    s_add_u32 m0, s72, 12288
    s_add_u32 s66, s70, 196608
    buffer_load_dwordx4 v4, s[8:11], s66 offen lds
    s_add_u32 m0, s72, 14336
    s_add_u32 s66, s70, 229376
    buffer_load_dwordx4 v4, s[8:11], s66 offen lds
    s_add_u32 m0, s72, 32768
    s_add_u32 s66, s71, 4096
    buffer_load_dwordx4 v5, s[12:15], s66 offen lds
    s_add_u32 m0, s72, 34816
    s_add_u32 s66, s71, 102400
    buffer_load_dwordx4 v5, s[12:15], s66 offen lds
    s_add_u32 m0, s72, 36864
    s_add_u32 s66, s71, 200704
    buffer_load_dwordx4 v5, s[12:15], s66 offen lds
    s_add_u32 m0, s72, 38912
    s_add_u32 s66, s71, 299008
    buffer_load_dwordx4 v5, s[12:15], s66 offen lds
    s_add_u32 m0, s72, 16384
    s_add_u32 s66, s71, 0
    buffer_load_dwordx4 v5, s[12:15], s66 offen lds
    s_add_u32 m0, s72, 18432
    s_add_u32 s66, s71, 98304
    buffer_load_dwordx4 v5, s[12:15], s66 offen lds
    s_add_u32 m0, s72, 20480
    s_add_u32 s66, s71, 196608
    buffer_load_dwordx4 v5, s[12:15], s66 offen lds
    s_add_u32 m0, s72, 22528
    s_add_u32 s66, s71, 294912
    buffer_load_dwordx4 v5, s[12:15], s66 offen lds
    s_waitcnt vmcnt(20)
    s_barrier
    s_add_u32 s71, s76, 13
    s_and_b32 s71, s71, 15
    s_lshl_b32 s70, s71, 7
    s_mul_i32 s71, s71, 393216
    s_add_u32 m0, s72, 65536
    s_add_u32 s66, s71, 2048
    buffer_load_dwordx4 v5, s[12:15], s66 offen lds
    s_add_u32 m0, s72, 67584
    s_add_u32 s66, s71, 100352
    buffer_load_dwordx4 v5, s[12:15], s66 offen lds
    s_add_u32 m0, s72, 69632
    s_add_u32 s66, s71, 198656
    buffer_load_dwordx4 v5, s[12:15], s66 offen lds
    s_add_u32 m0, s72, 71680
    s_add_u32 s66, s71, 296960
    buffer_load_dwordx4 v5, s[12:15], s66 offen lds
    s_add_u32 m0, s72, 40960
    s_add_u32 s66, s70, 0
    buffer_load_dwordx4 v4, s[8:11], s66 offen lds
    s_add_u32 m0, s72, 43008
    s_add_u32 s66, s70, 32768
    buffer_load_dwordx4 v4, s[8:11], s66 offen lds
    s_add_u32 m0, s72, 45056
    s_add_u32 s66, s70, 65536
    buffer_load_dwordx4 v4, s[8:11], s66 offen lds
    s_add_u32 m0, s72, 47104
    s_add_u32 s66, s70, 98304
    buffer_load_dwordx4 v4, s[8:11], s66 offen lds
    s_add_u32 m0, s72, 49152
    s_add_u32 s66, s70, 131072
    buffer_load_dwordx4 v4, s[8:11], s66 offen lds
    s_add_u32 m0, s72, 51200
    s_add_u32 s66, s70, 163840
    buffer_load_dwordx4 v4, s[8:11], s66 offen lds
    s_add_u32 m0, s72, 53248
    s_add_u32 s66, s70, 196608
    buffer_load_dwordx4 v4, s[8:11], s66 offen lds
    s_add_u32 m0, s72, 55296
    s_add_u32 s66, s70, 229376
    buffer_load_dwordx4 v4, s[8:11], s66 offen lds
    s_add_u32 m0, s72, 73728
    s_add_u32 s66, s71, 4096
    buffer_load_dwordx4 v5, s[12:15], s66 offen lds
    s_add_u32 m0, s72, 75776
    s_add_u32 s66, s71, 102400
    buffer_load_dwordx4 v5, s[12:15], s66 offen lds
    s_add_u32 m0, s72, 77824
    s_add_u32 s66, s71, 200704
    buffer_load_dwordx4 v5, s[12:15], s66 offen lds
    s_add_u32 m0, s72, 79872
    s_add_u32 s66, s71, 299008
    buffer_load_dwordx4 v5, s[12:15], s66 offen lds
    s_add_u32 m0, s72, 57344
    s_add_u32 s66, s71, 0
    buffer_load_dwordx4 v5, s[12:15], s66 offen lds
    s_add_u32 m0, s72, 59392
    s_add_u32 s66, s71, 98304
    buffer_load_dwordx4 v5, s[12:15], s66 offen lds
    s_add_u32 m0, s72, 61440
    s_add_u32 s66, s71, 196608
    buffer_load_dwordx4 v5, s[12:15], s66 offen lds
    s_add_u32 m0, s72, 63488
    s_add_u32 s66, s71, 294912
    buffer_load_dwordx4 v5, s[12:15], s66 offen lds
    s_waitcnt vmcnt(20)
    s_barrier
    s_add_u32 s71, s76, 14
    s_and_b32 s71, s71, 15
    s_lshl_b32 s70, s71, 7
    s_mul_i32 s71, s71, 393216
    s_add_u32 m0, s72, 106496
    s_add_u32 s66, s71, 2048
    buffer_load_dwordx4 v5, s[12:15], s66 offen lds
    s_add_u32 m0, s72, 108544
    s_add_u32 s66, s71, 100352
    buffer_load_dwordx4 v5, s[12:15], s66 offen lds
    s_add_u32 m0, s72, 110592
    s_add_u32 s66, s71, 198656
    buffer_load_dwordx4 v5, s[12:15], s66 offen lds
    s_add_u32 m0, s72, 112640
    s_add_u32 s66, s71, 296960
    buffer_load_dwordx4 v5, s[12:15], s66 offen lds
    s_add_u32 m0, s72, 81920
    s_add_u32 s66, s70, 0
    buffer_load_dwordx4 v4, s[8:11], s66 offen lds
    s_add_u32 m0, s72, 83968
    s_add_u32 s66, s70, 32768
    buffer_load_dwordx4 v4, s[8:11], s66 offen lds
    s_add_u32 m0, s72, 86016
    s_add_u32 s66, s70, 65536
    buffer_load_dwordx4 v4, s[8:11], s66 offen lds
    s_add_u32 m0, s72, 88064
    s_add_u32 s66, s70, 98304
    buffer_load_dwordx4 v4, s[8:11], s66 offen lds
    s_add_u32 m0, s72, 90112
    s_add_u32 s66, s70, 131072
    buffer_load_dwordx4 v4, s[8:11], s66 offen lds
    s_add_u32 m0, s72, 92160
    s_add_u32 s66, s70, 163840
    buffer_load_dwordx4 v4, s[8:11], s66 offen lds
    s_add_u32 m0, s72, 94208
    s_add_u32 s66, s70, 196608
    buffer_load_dwordx4 v4, s[8:11], s66 offen lds
    s_add_u32 m0, s72, 96256
    s_add_u32 s66, s70, 229376
    buffer_load_dwordx4 v4, s[8:11], s66 offen lds
    s_add_u32 m0, s72, 114688
    s_add_u32 s66, s71, 4096
    buffer_load_dwordx4 v5, s[12:15], s66 offen lds
    s_add_u32 m0, s72, 116736
    s_add_u32 s66, s71, 102400
    buffer_load_dwordx4 v5, s[12:15], s66 offen lds
    s_add_u32 m0, s72, 118784
    s_add_u32 s66, s71, 200704
    buffer_load_dwordx4 v5, s[12:15], s66 offen lds
    s_add_u32 m0, s72, 120832
    s_add_u32 s66, s71, 299008
    buffer_load_dwordx4 v5, s[12:15], s66 offen lds
    s_add_u32 m0, s72, 98304
    s_add_u32 s66, s71, 0
    buffer_load_dwordx4 v5, s[12:15], s66 offen lds
    s_add_u32 m0, s72, 100352
    s_add_u32 s66, s71, 98304
    buffer_load_dwordx4 v5, s[12:15], s66 offen lds
    s_add_u32 m0, s72, 102400
    s_add_u32 s66, s71, 196608
    buffer_load_dwordx4 v5, s[12:15], s66 offen lds
    s_add_u32 m0, s72, 104448
    s_add_u32 s66, s71, 294912
    buffer_load_dwordx4 v5, s[12:15], s66 offen lds
    s_add_u32 s71, s76, 15
    s_and_b32 s71, s71, 15
    s_lshl_b32 s70, s71, 7
    s_mul_i32 s71, s71, 393216
    s_add_u32 m0, s72, 139264
    s_add_u32 s66, s71, 2048
    buffer_load_dwordx4 v5, s[12:15], s66 offen lds
    s_add_u32 m0, s72, 141312
    s_add_u32 s66, s71, 100352
    buffer_load_dwordx4 v5, s[12:15], s66 offen lds
    s_add_u32 m0, s72, 143360
    s_add_u32 s66, s71, 198656
    buffer_load_dwordx4 v5, s[12:15], s66 offen lds
    s_add_u32 m0, s72, 145408
    s_add_u32 s66, s71, 296960
    buffer_load_dwordx4 v5, s[12:15], s66 offen lds
    s_waitcnt vmcnt(24)
    s_barrier
    s_add_u32 s71, s76, 15
    s_and_b32 s71, s71, 15
    s_lshl_b32 s70, s71, 7
    s_mul_i32 s71, s71, 393216
    s_add_u32 m0, s72, 122880
    s_add_u32 s66, s70, 0
    buffer_load_dwordx4 v4, s[8:11], s66 offen lds
    s_add_u32 m0, s72, 124928
    s_add_u32 s66, s70, 32768
    buffer_load_dwordx4 v4, s[8:11], s66 offen lds
    s_add_u32 m0, s72, 126976
    s_add_u32 s66, s70, 65536
    buffer_load_dwordx4 v4, s[8:11], s66 offen lds
    s_add_u32 m0, s72, 129024
    s_add_u32 s66, s70, 98304
    buffer_load_dwordx4 v4, s[8:11], s66 offen lds
    s_add_u32 m0, s72, 131072
    s_add_u32 s66, s70, 131072
    buffer_load_dwordx4 v4, s[8:11], s66 offen lds
    s_add_u32 m0, s72, 133120
    s_add_u32 s66, s70, 163840
    buffer_load_dwordx4 v4, s[8:11], s66 offen lds
    s_add_u32 m0, s72, 135168
    s_add_u32 s66, s70, 196608
    buffer_load_dwordx4 v4, s[8:11], s66 offen lds
    s_add_u32 m0, s72, 137216
    s_add_u32 s66, s70, 229376
    buffer_load_dwordx4 v4, s[8:11], s66 offen lds
    s_add_u32 s71, s76, 15
    s_and_b32 s71, s71, 15
    s_lshl_b32 s70, s71, 7
    s_mul_i32 s71, s71, 393216
    s_add_u32 m0, s72, 147456
    s_add_u32 s66, s71, 4096
    buffer_load_dwordx4 v5, s[12:15], s66 offen lds
    s_add_u32 m0, s72, 149504
    s_add_u32 s66, s71, 102400
    buffer_load_dwordx4 v5, s[12:15], s66 offen lds
    s_add_u32 m0, s72, 151552
    s_add_u32 s66, s71, 200704
    buffer_load_dwordx4 v5, s[12:15], s66 offen lds
    s_add_u32 m0, s72, 153600
    s_add_u32 s66, s71, 299008
    buffer_load_dwordx4 v5, s[12:15], s66 offen lds
    s_add_u32 m0, s72, 16384
    s_add_u32 s66, s71, 0
    buffer_load_dwordx4 v5, s[12:15], s66 offen lds
    s_add_u32 m0, s72, 18432
    s_add_u32 s66, s71, 98304
    buffer_load_dwordx4 v5, s[12:15], s66 offen lds
    s_add_u32 m0, s72, 20480
    s_add_u32 s66, s71, 196608
    buffer_load_dwordx4 v5, s[12:15], s66 offen lds
    s_add_u32 m0, s72, 22528
    s_add_u32 s66, s71, 294912
    buffer_load_dwordx4 v5, s[12:15], s66 offen lds
    s_waitcnt vmcnt(20)
    s_barrier
    v_lshrrev_b32 v10, 5, v2
    v_and_b32 v11, 31, v2
    v_lshlrev_b32 v12, 3, v10
    s_lshl_b32 s66, s79, 6
    s_lshl_b32 s67, s44, 4
    s_add_u32 s66, s66, s67
    v_add_u32 v12, s66, v12
    v_lshlrev_b32 v12, 11, v12
    v_lshl_add_u32 v12, v11, 4, v12
    s_lshl_b32 s66, s73, 9
    v_add_u32 v7, s66, v12
    s_lshl_b32 s66, s2, 2
    s_add_u32 s66, s66, s44
    s_lshl_b32 s66, s66, 11
    buffer_load_dwordx4 v[240:243], v9, s[20:23], s66 offen offset:0
    buffer_load_dwordx4 v[240:243], v9, s[20:23], s66 offen offset:1024
    s_mov_b32 s66, 0
    buffer_load_dwordx4 v[160:163], v7, s[32:35], s66 offen
    s_mov_b32 s66, 2048
    buffer_load_dwordx4 v[164:167], v7, s[32:35], s66 offen
    s_mov_b32 s66, 4096
    buffer_load_dwordx4 v[168:171], v7, s[32:35], s66 offen
    s_mov_b32 s66, 6144
    buffer_load_dwordx4 v[172:175], v7, s[32:35], s66 offen
    s_mov_b32 s66, 8192
    buffer_load_dwordx4 v[176:179], v7, s[32:35], s66 offen
    s_mov_b32 s66, 10240
    buffer_load_dwordx4 v[180:183], v7, s[32:35], s66 offen
    s_mov_b32 s66, 12288
    buffer_load_dwordx4 v[184:187], v7, s[32:35], s66 offen
    s_mov_b32 s66, 14336
    buffer_load_dwordx4 v[188:191], v7, s[32:35], s66 offen
    s_waitcnt vmcnt(10)
    s_branch H_b14
WORK:
    v_mov_b32 v14, 0
    v_lshlrev_b32 v8, 5, v2
    v_add_u32 v8, 6127616, v8
    s_lshl_b32 s66, s2, 2
    s_add_u32 s66, s66, s44
    s_cmp_lg_u32 s66, 2
    s_cbranch_scc1 W_nn
    s_movk_i32 s66, 0
    buffer_load_dword v72, v8, s[16:19], s66 offen offset:4 sc1
    s_movk_i32 s66, 2048
    buffer_load_dword v73, v8, s[16:19], s66 offen offset:4 sc1
    s_movk_i32 s66, 4096
    buffer_load_dword v74, v8, s[16:19], s66 offen offset:4 sc1
    s_movk_i32 s66, 6144
    buffer_load_dword v75, v8, s[16:19], s66 offen offset:4 sc1
    s_memrealtime s[66:67]
    s_waitcnt vmcnt(0) lgkmcnt(0)
    s_or_b32 s66, s66, 1
W_nl:
    s_add_u32 s66, s66, 2
    v_cmp_eq_u32 vcc, s66, v72
    v_cmp_eq_u32 s[68:69], s66, v73
    s_or_b64 vcc, vcc, s[68:69]
    v_cmp_eq_u32 s[68:69], s66, v74
    s_or_b64 vcc, vcc, s[68:69]
    v_cmp_eq_u32 s[68:69], s66, v75
    s_or_b64 vcc, vcc, s[68:69]
    s_cbranch_vccnz W_nl
    v_mov_b32 v10, 0
    v_mov_b32 v11, s66
    s_mov_b64 exec, 1
    buffer_store_dword v11, v10, s[40:43], 0 offen sc0 sc1
    s_mov_b64 exec, -1
W_nn:
    s_and_b32 s48, s44, 1
    s_mov_b32 s68, s12
    s_mov_b32 s69, s13
    s_bitcmp0_b32 s64, 1
    s_cselect_b32 s70, 0x600000, 0
    s_mov_b32 s71, 0x00020000
    v_lshrrev_b32 v10, 3, v2
    v_lshlrev_b32 v10, 11, v10
    v_and_b32 v11, 7, v2
    v_lshl_add_u32 v10, v11, 4, v10
    s_lshl_b32 s66, s65, 1
    s_add_u32 s66, s66, s48
    s_mul_i32 s66, s66, 98304
    s_lshr_b32 s67, s64, 2
    s_lshl_b32 s67, s67, 10
    s_add_u32 s66, s66, s67
    s_add_u32 s66, s66, 384
    buffer_load_dwordx4 v[224:227], v10, s[68:71], s66 offen
    s_add_u32 s66, s66, 16384
    buffer_load_dwordx4 v[228:231], v10, s[68:71], s66 offen
    s_add_u32 s66, s66, 16384
    buffer_load_dwordx4 v[232:235], v10, s[68:71], s66 offen
    s_add_u32 s66, s66, 16384
    buffer_load_dwordx4 v[236:239], v10, s[68:71], s66 offen
    s_add_u32 s66, s66, 16384
    buffer_load_dwordx4 v[240:243], v10, s[68:71], s66 offen
    s_add_u32 s66, s66, 16384
    buffer_load_dwordx4 v[244:247], v10, s[68:71], s66 offen
    s_waitcnt vmcnt(11)
    s_barrier
    s_lshl_b32 s50, s4, 7
    s_lshl_b32 s66, s5, 3
    s_add_u32 s50, s50, s66
    s_lshl_b32 s66, s48, 2
    s_add_u32 s50, s50, s66
    s_lshl_b32 s66, s50, 11
    s_add_u32 s67, s66, 4096
    buffer_load_dwordx4 v[16:19], v9, s[8:11], s66 offen offset:0
    buffer_load_dwordx4 v[20:23], v9, s[8:11], s66 offen offset:1024
    buffer_load_dwordx4 v[24:27], v9, s[8:11], s66 offen offset:2048
    buffer_load_dwordx4 v[28:31], v9, s[8:11], s66 offen offset:3072
    buffer_load_dwordx4 v[32:35], v9, s[8:11], s67 offen offset:0
    buffer_load_dwordx4 v[36:39], v9, s[8:11], s67 offen offset:1024
    buffer_load_dwordx4 v[40:43], v9, s[8:11], s67 offen offset:2048
    buffer_load_dwordx4 v[44:47], v9, s[8:11], s67 offen offset:3072
    s_lshl_b32 s66, s48, 11
    s_add_u32 m0, s66, 159744
    s_nop 0
    buffer_load_dwordx4 v9, s[24:27], 0 offen offset:0 lds
    buffer_load_dwordx4 v9, s[24:27], 0 offen offset:1024 lds
    s_lshl_b32 s66, s79, 2
    s_add_u32 s66, s66, s73
    s_and_b32 s51, s66, 15
    s_lshr_b32 s67, s66, 4
    s_lshl_b32 s54, s67, 5
    s_lshl_b32 s66, s48, 4
    s_add_u32 s54, s54, s66
    s_add_u32 s54, s54, s51
    s_lshl_b32 s54, s54, 10
    s_add_u32 s54, s54, 5308416
    s_lshl_b32 s51, s51, 6
    v_lshrrev_b32 v10, 5, v2
    v_and_b32 v11, 31, v2
    v_lshlrev_b32 v12, 5, v10
    v_add_u32 v12, s51, v12
    v_mul_u32_u24 v12, 7168, v12
    v_lshl_add_u32 v12, v11, 4, v12
    s_lshl_b32 s67, s67, 9
    v_add_u32 v6, s67, v12
    v_mov_b32 v72, -1
    v_mov_b32 v73, -1
    v_mov_b32 v74, -1
    v_mov_b32 v75, -1
    v_and_b32 v12, 3, v2
    v_lshlrev_b32 v12, 4, v12
    v_add_u32 v12, s53, v12
    s_add_u32 s66, s53, 4294965248
    v_subrev_u32 v13, 4, v2
    v_cmp_gt_u32 vcc, 4, v13
    v_lshlrev_b32 v13, 4, v13
    v_add_u32 v13, s66, v13
    v_cndmask_b32 v12, v12, v13, vcc
    s_add_u32 s66, s55, 0
    v_subrev_u32 v13, 24, v2
    v_cmp_gt_u32 vcc, 16, v13
    v_lshlrev_b32 v13, 4, v13
    v_add_u32 v13, s66, v13
    v_cndmask_b32 v12, v12, v13, vcc
    s_add_u32 s66, s55, 4294934528
    v_subrev_u32 v13, 40, v2
    v_cmp_gt_u32 vcc, 16, v13
    v_lshlrev_b32 v13, 4, v13
    v_add_u32 v13, s66, v13
    v_cndmask_b32 v12, v12, v13, vcc
    s_sub_u32 s66, s52, 32768
    buffer_store_dwordx4 v[72:75], v9, s[16:19], s52 offen sc0 sc1
    buffer_store_dwordx4 v[72:75], v9, s[16:19], s66 offen sc0 sc1
    buffer_store_dwordx4 v[72:75], v9, s[16:19], s54 offen sc0 sc1
    buffer_store_dwordx4 v[72:75], v12, s[16:19], 0 offen sc0 sc1
    s_waitcnt vmcnt(20)
    s_barrier
    s_waitcnt vmcnt(4)
    s_barrier
    s_cmp_lg_u32 s48, 0
    s_cbranch_scc1 W_k1
    buffer_load_dword v15, v14, s[40:43], 0 offen sc1
W_k1:
    v_add_u32 v10, 159744, v9
    v_bfe_u32 v3, v2, 4, 1
    v_lshrrev_b32 v11, 5, v2
    v_lshl_add_u32 v3, v3, 1, v11
    s_mov_b32 s67, 0xffff0000
    s_mov_b32 s68, 0x00010001
    s_mov_b32 s69, 0x00010001
    ds_read_b128 v[48:51], v10 offset:0
    ds_read_b128 v[52:55], v10 offset:1024
    v_mov_b32 v72, 0
    v_mov_b32 v73, 0
    v_mov_b32 v74, 0
    v_mov_b32 v75, 0
    s_waitcnt lgkmcnt(0)
    v_dot2_f32_bf16 v72, v16, v48, v72
    v_dot2_f32_bf16 v73, v24, v48, v73
    v_dot2_f32_bf16 v74, v32, v48, v74
    v_dot2_f32_bf16 v75, v40, v48, v75
    v_dot2_f32_bf16 v72, v17, v49, v72
    v_dot2_f32_bf16 v73, v25, v49, v73
    v_dot2_f32_bf16 v74, v33, v49, v74
    v_dot2_f32_bf16 v75, v41, v49, v75
    v_dot2_f32_bf16 v72, v18, v50, v72
    v_dot2_f32_bf16 v73, v26, v50, v73
    v_dot2_f32_bf16 v74, v34, v50, v74
    v_dot2_f32_bf16 v75, v42, v50, v75
    v_dot2_f32_bf16 v72, v19, v51, v72
    v_dot2_f32_bf16 v73, v27, v51, v73
    v_dot2_f32_bf16 v74, v35, v51, v74
    v_dot2_f32_bf16 v75, v43, v51, v75
    v_dot2_f32_bf16 v72, v20, v52, v72
    v_dot2_f32_bf16 v73, v28, v52, v73
    v_dot2_f32_bf16 v74, v36, v52, v74
    v_dot2_f32_bf16 v75, v44, v52, v75
    v_dot2_f32_bf16 v72, v21, v53, v72
    v_dot2_f32_bf16 v73, v29, v53, v73
    v_dot2_f32_bf16 v74, v37, v53, v74
    v_dot2_f32_bf16 v75, v45, v53, v75
    v_dot2_f32_bf16 v72, v22, v54, v72
    v_dot2_f32_bf16 v73, v30, v54, v73
    v_dot2_f32_bf16 v74, v38, v54, v74
    v_dot2_f32_bf16 v75, v46, v54, v75
    v_dot2_f32_bf16 v72, v23, v55, v72
    v_dot2_f32_bf16 v73, v31, v55, v73
    v_dot2_f32_bf16 v74, v39, v55, v74
    v_dot2_f32_bf16 v75, v47, v55, v75
    s_nop 2
    ds_read_b128 v[48:51], v10 offset:2048
    ds_read_b128 v[52:55], v10 offset:3072
    s_nop 1
    v_permlane32_swap_b32 v72, v73
    v_permlane32_swap_b32 v74, v75
    v_add_f32 v72, v72, v73
    v_add_f32 v74, v74, v75
    s_nop 1
    v_permlane16_swap_b32 v72, v74
    v_add_f32 v72, v72, v74
    s_nop 1
    v_add_f32_dpp v72, v72, v72 quad_perm:[1,0,3,2] row_mask:0xf bank_mask:0xf
    s_nop 1
    v_add_f32_dpp v72, v72, v72 quad_perm:[2,3,0,1] row_mask:0xf bank_mask:0xf
    s_nop 1
    v_add_f32_dpp v72, v72, v72 row_half_mirror row_mask:0xf bank_mask:0xf
    s_nop 1
    v_add_f32_dpp v72, v72, v72 row_mirror row_mask:0xf bank_mask:0xf
    s_sub_u32 s66, 34815, s50
    v_cvt_pk_bf16_f32 v72, 0, v72
    v_sub_u32 v73, s66, v3
    v_ashrrev_i32 v76, 31, v72
    v_or_b32 v76, 0x80000000, v76
    v_xor_b32 v72, v72, v76
    v_and_or_b32 v72, v72, s67, v73
    v_mov_b32 v10, 155680
    s_mov_b64 exec, s[68:69]
    ds_max_u32 v10, v72
    s_mov_b64 exec, -1
    s_waitcnt vmcnt(0)
    s_waitcnt lgkmcnt(0)
    s_barrier
    s_cmp_lg_u32 s48, 0
    s_cbranch_scc1 W_k2
    v_mov_b32 v10, 155680
    ds_read_b32 v12, v10
    s_waitcnt vmcnt(0)
    s_mov_b32 s67, 0
W_ts:
    v_cmp_eq_u32 vcc, 0, v15
    s_cbranch_vccz W_tok
    s_add_u32 s67, s67, 1
    s_cmp_ge_u32 s67, 200000
    s_cbranch_scc1 W_tok
    s_sleep 4
    buffer_load_dword v15, v14, s[40:43], 0 offen sc1
    s_waitcnt vmcnt(0)
    s_branch W_ts
W_tok:
    s_lshl_b32 s66, s2, 5
    s_add_u32 s66, s66, 6127616
    v_mov_b32 v10, s66
    v_mov_b32 v13, v15
    s_waitcnt lgkmcnt(0)
    s_mov_b64 exec, 1
    buffer_store_dwordx2 v[12:13], v10, s[16:19], 0 offen sc0 sc1
    s_mov_b64 exec, -1
W_k2:
    v_mov_b32 v224, -1
    v_mov_b32 v225, -1
    v_mov_b32 v226, -1
    v_mov_b32 v227, -1
    s_lshl_b32 s67, s4, 3
    s_lshl_b32 s66, s48, 2
    s_add_u32 s67, s67, s66
    s_lshl_b32 s67, s67, 15
    s_lshl_b32 s66, s5, 11
    s_add_u32 s67, s67, s66
    s_add_u32 s66, s67, 0
    buffer_store_dwordx4 v[224:227], v9, s[16:19], s66 offen offset:0 sc0 sc1
    s_add_u32 s66, s67, 0
    buffer_store_dwordx4 v[224:227], v9, s[16:19], s66 offen offset:1024 sc0 sc1
    s_add_u32 s66, s67, 32768
    buffer_store_dwordx4 v[224:227], v9, s[16:19], s66 offen offset:0 sc0 sc1
    s_add_u32 s66, s67, 32768
    buffer_store_dwordx4 v[224:227], v9, s[16:19], s66 offen offset:1024 sc0 sc1
    s_add_u32 s66, s67, 65536
    buffer_store_dwordx4 v[224:227], v9, s[16:19], s66 offen offset:0 sc0 sc1
    s_add_u32 s66, s67, 65536
    buffer_store_dwordx4 v[224:227], v9, s[16:19], s66 offen offset:1024 sc0 sc1
    s_add_u32 s66, s67, 98304
    buffer_store_dwordx4 v[224:227], v9, s[16:19], s66 offen offset:0 sc0 sc1
    s_add_u32 s66, s67, 98304
    buffer_store_dwordx4 v[224:227], v9, s[16:19], s66 offen offset:1024 sc0 sc1
    v_lshlrev_b32 v56, 16, v48
    v_and_b32 v57, 0xffff0000, v48
    v_lshlrev_b32 v58, 16, v49
    v_and_b32 v59, 0xffff0000, v49
    v_lshlrev_b32 v60, 16, v50
    v_and_b32 v61, 0xffff0000, v50
    v_lshlrev_b32 v62, 16, v51
    v_and_b32 v63, 0xffff0000, v51
    v_lshlrev_b32 v64, 16, v52
    v_and_b32 v65, 0xffff0000, v52
    v_lshlrev_b32 v66, 16, v53
    v_and_b32 v67, 0xffff0000, v53
    v_lshlrev_b32 v68, 16, v54
    v_and_b32 v69, 0xffff0000, v54
    v_lshlrev_b32 v70, 16, v55
    v_and_b32 v71, 0xffff0000, v55
    v_mov_b32 v76, 0
    v_lshlrev_b32 v72, 16, v16
    v_and_b32 v73, 0xffff0000, v16
    v_mul_f32 v72, v72, v56
    v_mul_f32 v73, v73, v57
    v_cvt_pk_bf16_f32 v72, 0, v72
    v_cvt_pk_bf16_f32 v73, 0, v73
    v_add_f32 v76, v76, v72
    v_add_f32 v76, v76, v73
    v_lshlrev_b32 v72, 16, v17
    v_and_b32 v73, 0xffff0000, v17
    v_mul_f32 v72, v72, v58
    v_mul_f32 v73, v73, v59
    v_cvt_pk_bf16_f32 v72, 0, v72
    v_cvt_pk_bf16_f32 v73, 0, v73
    v_add_f32 v76, v76, v72
    v_add_f32 v76, v76, v73
    v_lshlrev_b32 v72, 16, v18
    v_and_b32 v73, 0xffff0000, v18
    v_mul_f32 v72, v72, v60
    v_mul_f32 v73, v73, v61
    v_cvt_pk_bf16_f32 v72, 0, v72
    v_cvt_pk_bf16_f32 v73, 0, v73
    v_add_f32 v76, v76, v72
    v_add_f32 v76, v76, v73
    v_lshlrev_b32 v72, 16, v19
    v_and_b32 v73, 0xffff0000, v19
    v_mul_f32 v72, v72, v62
    v_mul_f32 v73, v73, v63
    v_cvt_pk_bf16_f32 v72, 0, v72
    v_cvt_pk_bf16_f32 v73, 0, v73
    v_add_f32 v76, v76, v72
    v_add_f32 v76, v76, v73
    v_lshlrev_b32 v72, 16, v20
    v_and_b32 v73, 0xffff0000, v20
    v_mul_f32 v72, v72, v64
    v_mul_f32 v73, v73, v65
    v_cvt_pk_bf16_f32 v72, 0, v72
    v_cvt_pk_bf16_f32 v73, 0, v73
    v_add_f32 v76, v76, v72
    v_add_f32 v76, v76, v73
    v_lshlrev_b32 v72, 16, v21
    v_and_b32 v73, 0xffff0000, v21
    v_mul_f32 v72, v72, v66
    v_mul_f32 v73, v73, v67
    v_cvt_pk_bf16_f32 v72, 0, v72
    v_cvt_pk_bf16_f32 v73, 0, v73
    v_add_f32 v76, v76, v72
    v_add_f32 v76, v76, v73
    v_lshlrev_b32 v72, 16, v22
    v_and_b32 v73, 0xffff0000, v22
    v_mul_f32 v72, v72, v68
    v_mul_f32 v73, v73, v69
    v_cvt_pk_bf16_f32 v72, 0, v72
    v_cvt_pk_bf16_f32 v73, 0, v73
    v_add_f32 v76, v76, v72
    v_add_f32 v76, v76, v73
    v_lshlrev_b32 v72, 16, v23
    v_and_b32 v73, 0xffff0000, v23
    v_mul_f32 v72, v72, v70
    v_mul_f32 v73, v73, v71
    v_cvt_pk_bf16_f32 v72, 0, v72
    v_cvt_pk_bf16_f32 v73, 0, v73
    v_add_f32 v76, v76, v72
    v_add_f32 v76, v76, v73
    s_barrier
    s_mov_b32 s66, 0
    buffer_load_dwordx4 v[96:99], v6, s[28:31], s66 offen
    s_mov_b32 s66, 7168
    buffer_load_dwordx4 v[100:103], v6, s[28:31], s66 offen
    s_mov_b32 s66, 14336
    buffer_load_dwordx4 v[104:107], v6, s[28:31], s66 offen
    s_mov_b32 s66, 21504
    buffer_load_dwordx4 v[108:111], v6, s[28:31], s66 offen
    s_mov_b32 s66, 28672
    buffer_load_dwordx4 v[112:115], v6, s[28:31], s66 offen
    s_mov_b32 s66, 35840
    buffer_load_dwordx4 v[116:119], v6, s[28:31], s66 offen
    s_mov_b32 s66, 43008
    buffer_load_dwordx4 v[120:123], v6, s[28:31], s66 offen
    s_mov_b32 s66, 50176
    buffer_load_dwordx4 v[124:127], v6, s[28:31], s66 offen
    v_mov_b32 v77, 0
    v_lshlrev_b32 v72, 16, v24
    v_and_b32 v73, 0xffff0000, v24
    v_mul_f32 v72, v72, v56
    v_mul_f32 v73, v73, v57
    v_cvt_pk_bf16_f32 v72, 0, v72
    v_cvt_pk_bf16_f32 v73, 0, v73
    v_add_f32 v77, v77, v72
    v_add_f32 v77, v77, v73
    v_lshlrev_b32 v72, 16, v25
    v_and_b32 v73, 0xffff0000, v25
    v_mul_f32 v72, v72, v58
    v_mul_f32 v73, v73, v59
    v_cvt_pk_bf16_f32 v72, 0, v72
    v_cvt_pk_bf16_f32 v73, 0, v73
    v_add_f32 v77, v77, v72
    v_add_f32 v77, v77, v73
    v_lshlrev_b32 v72, 16, v26
    v_and_b32 v73, 0xffff0000, v26
    v_mul_f32 v72, v72, v60
    v_mul_f32 v73, v73, v61
    v_cvt_pk_bf16_f32 v72, 0, v72
    v_cvt_pk_bf16_f32 v73, 0, v73
    v_add_f32 v77, v77, v72
    v_add_f32 v77, v77, v73
    v_lshlrev_b32 v72, 16, v27
    v_and_b32 v73, 0xffff0000, v27
    v_mul_f32 v72, v72, v62
    v_mul_f32 v73, v73, v63
    v_cvt_pk_bf16_f32 v72, 0, v72
    v_cvt_pk_bf16_f32 v73, 0, v73
    v_add_f32 v77, v77, v72
    v_add_f32 v77, v77, v73
    v_lshlrev_b32 v72, 16, v28
    v_and_b32 v73, 0xffff0000, v28
    v_mul_f32 v72, v72, v64
    v_mul_f32 v73, v73, v65
    v_cvt_pk_bf16_f32 v72, 0, v72
    v_cvt_pk_bf16_f32 v73, 0, v73
    v_add_f32 v77, v77, v72
    v_add_f32 v77, v77, v73
    v_lshlrev_b32 v72, 16, v29
    v_and_b32 v73, 0xffff0000, v29
    v_mul_f32 v72, v72, v66
    v_mul_f32 v73, v73, v67
    v_cvt_pk_bf16_f32 v72, 0, v72
    v_cvt_pk_bf16_f32 v73, 0, v73
    v_add_f32 v77, v77, v72
    v_add_f32 v77, v77, v73
    v_lshlrev_b32 v72, 16, v30
    v_and_b32 v73, 0xffff0000, v30
    v_mul_f32 v72, v72, v68
    v_mul_f32 v73, v73, v69
    v_cvt_pk_bf16_f32 v72, 0, v72
    v_cvt_pk_bf16_f32 v73, 0, v73
    v_add_f32 v77, v77, v72
    v_add_f32 v77, v77, v73
    v_lshlrev_b32 v72, 16, v31
    v_and_b32 v73, 0xffff0000, v31
    v_mul_f32 v72, v72, v70
    v_mul_f32 v73, v73, v71
    v_cvt_pk_bf16_f32 v72, 0, v72
    v_cvt_pk_bf16_f32 v73, 0, v73
    v_add_f32 v77, v77, v72
    v_add_f32 v77, v77, v73
    v_mov_b32 v78, 0
    v_lshlrev_b32 v72, 16, v32
    v_and_b32 v73, 0xffff0000, v32
    v_mul_f32 v72, v72, v56
    v_mul_f32 v73, v73, v57
    v_cvt_pk_bf16_f32 v72, 0, v72
    v_cvt_pk_bf16_f32 v73, 0, v73
    v_add_f32 v78, v78, v72
    v_add_f32 v78, v78, v73
    v_lshlrev_b32 v72, 16, v33
    v_and_b32 v73, 0xffff0000, v33
    v_mul_f32 v72, v72, v58
    v_mul_f32 v73, v73, v59
    v_cvt_pk_bf16_f32 v72, 0, v72
    v_cvt_pk_bf16_f32 v73, 0, v73
    v_add_f32 v78, v78, v72
    v_add_f32 v78, v78, v73
    v_lshlrev_b32 v72, 16, v34
    v_and_b32 v73, 0xffff0000, v34
    v_mul_f32 v72, v72, v60
    v_mul_f32 v73, v73, v61
    v_cvt_pk_bf16_f32 v72, 0, v72
    v_cvt_pk_bf16_f32 v73, 0, v73
    v_add_f32 v78, v78, v72
    v_add_f32 v78, v78, v73
    v_lshlrev_b32 v72, 16, v35
    v_and_b32 v73, 0xffff0000, v35
    v_mul_f32 v72, v72, v62
    v_mul_f32 v73, v73, v63
    v_cvt_pk_bf16_f32 v72, 0, v72
    v_cvt_pk_bf16_f32 v73, 0, v73
    v_add_f32 v78, v78, v72
    v_add_f32 v78, v78, v73
    v_lshlrev_b32 v72, 16, v36
    v_and_b32 v73, 0xffff0000, v36
    v_mul_f32 v72, v72, v64
    v_mul_f32 v73, v73, v65
    v_cvt_pk_bf16_f32 v72, 0, v72
    v_cvt_pk_bf16_f32 v73, 0, v73
    v_add_f32 v78, v78, v72
    v_add_f32 v78, v78, v73
    v_lshlrev_b32 v72, 16, v37
    v_and_b32 v73, 0xffff0000, v37
    v_mul_f32 v72, v72, v66
    v_mul_f32 v73, v73, v67
    v_cvt_pk_bf16_f32 v72, 0, v72
    v_cvt_pk_bf16_f32 v73, 0, v73
    v_add_f32 v78, v78, v72
    v_add_f32 v78, v78, v73
    v_lshlrev_b32 v72, 16, v38
    v_and_b32 v73, 0xffff0000, v38
    v_mul_f32 v72, v72, v68
    v_mul_f32 v73, v73, v69
    v_cvt_pk_bf16_f32 v72, 0, v72
    v_cvt_pk_bf16_f32 v73, 0, v73
    v_add_f32 v78, v78, v72
    v_add_f32 v78, v78, v73
    v_lshlrev_b32 v72, 16, v39
    v_and_b32 v73, 0xffff0000, v39
    v_mul_f32 v72, v72, v70
    v_mul_f32 v73, v73, v71
    v_cvt_pk_bf16_f32 v72, 0, v72
    v_cvt_pk_bf16_f32 v73, 0, v73
    v_add_f32 v78, v78, v72
    v_add_f32 v78, v78, v73
    s_barrier
    s_cmp_lg_u32 s48, 0
    s_cbranch_scc1 W_k4
    s_movk_i32 s66, 0
    buffer_load_dwordx2 v[80:81], v8, s[16:19], s66 offen sc1
    s_movk_i32 s66, 2048
    buffer_load_dwordx2 v[82:83], v8, s[16:19], s66 offen sc1
    s_movk_i32 s66, 4096
    buffer_load_dwordx2 v[84:85], v8, s[16:19], s66 offen sc1
    s_movk_i32 s66, 6144
    buffer_load_dwordx2 v[86:87], v8, s[16:19], s66 offen sc1
W_k4:
    v_mov_b32 v79, 0
    v_lshlrev_b32 v72, 16, v40
    v_and_b32 v73, 0xffff0000, v40
    v_mul_f32 v72, v72, v56
    v_mul_f32 v73, v73, v57
    v_cvt_pk_bf16_f32 v72, 0, v72
    v_cvt_pk_bf16_f32 v73, 0, v73
    v_add_f32 v79, v79, v72
    v_add_f32 v79, v79, v73
    v_lshlrev_b32 v72, 16, v41
    v_and_b32 v73, 0xffff0000, v41
    v_mul_f32 v72, v72, v58
    v_mul_f32 v73, v73, v59
    v_cvt_pk_bf16_f32 v72, 0, v72
    v_cvt_pk_bf16_f32 v73, 0, v73
    v_add_f32 v79, v79, v72
    v_add_f32 v79, v79, v73
    v_lshlrev_b32 v72, 16, v42
    v_and_b32 v73, 0xffff0000, v42
    v_mul_f32 v72, v72, v60
    v_mul_f32 v73, v73, v61
    v_cvt_pk_bf16_f32 v72, 0, v72
    v_cvt_pk_bf16_f32 v73, 0, v73
    v_add_f32 v79, v79, v72
    v_add_f32 v79, v79, v73
    v_lshlrev_b32 v72, 16, v43
    v_and_b32 v73, 0xffff0000, v43
    v_mul_f32 v72, v72, v62
    v_mul_f32 v73, v73, v63
    v_cvt_pk_bf16_f32 v72, 0, v72
    v_cvt_pk_bf16_f32 v73, 0, v73
    v_add_f32 v79, v79, v72
    v_add_f32 v79, v79, v73
    v_lshlrev_b32 v72, 16, v44
    v_and_b32 v73, 0xffff0000, v44
    v_mul_f32 v72, v72, v64
    v_mul_f32 v73, v73, v65
    v_cvt_pk_bf16_f32 v72, 0, v72
    v_cvt_pk_bf16_f32 v73, 0, v73
    v_add_f32 v79, v79, v72
    v_add_f32 v79, v79, v73
    v_lshlrev_b32 v72, 16, v45
    v_and_b32 v73, 0xffff0000, v45
    v_mul_f32 v72, v72, v66
    v_mul_f32 v73, v73, v67
    v_cvt_pk_bf16_f32 v72, 0, v72
    v_cvt_pk_bf16_f32 v73, 0, v73
    v_add_f32 v79, v79, v72
    v_add_f32 v79, v79, v73
    v_lshlrev_b32 v72, 16, v46
    v_and_b32 v73, 0xffff0000, v46
    v_mul_f32 v72, v72, v68
    v_mul_f32 v73, v73, v69
    v_cvt_pk_bf16_f32 v72, 0, v72
    v_cvt_pk_bf16_f32 v73, 0, v73
    v_add_f32 v79, v79, v72
    v_add_f32 v79, v79, v73
    v_lshlrev_b32 v72, 16, v47
    v_and_b32 v73, 0xffff0000, v47
    v_mul_f32 v72, v72, v70
    v_mul_f32 v73, v73, v71
    v_cvt_pk_bf16_f32 v72, 0, v72
    v_cvt_pk_bf16_f32 v73, 0, v73
    v_add_f32 v79, v79, v72
    v_add_f32 v79, v79, v73
    s_nop 1
    v_permlane32_swap_b32 v76, v77
    v_permlane32_swap_b32 v78, v79
    v_add_f32 v76, v76, v77
    v_add_f32 v78, v78, v79
    s_nop 1
    v_permlane16_swap_b32 v76, v78
    v_add_f32 v76, v76, v78
    s_nop 1
    v_add_f32_dpp v76, v76, v76 quad_perm:[1,0,3,2] row_mask:0xf bank_mask:0xf
    s_nop 1
    v_add_f32_dpp v76, v76, v76 quad_perm:[2,3,0,1] row_mask:0xf bank_mask:0xf
    s_nop 1
    v_add_f32_dpp v76, v76, v76 row_half_mirror row_mask:0xf bank_mask:0xf
    s_nop 1
    v_add_f32_dpp v76, v76, v76 row_mirror row_mask:0xf bank_mask:0xf
    v_cvt_pk_bf16_f32 v76, 0, v76
    v_mul_f32 v76, s46, v76
    v_exp_f32 v76, -v76
    s_lshl_b32 s66, s50, 4
    v_add_f32 v76, 1.0, v76
    v_rcp_f32 v76, v76
    s_add_u32 s66, s66, 6094848
    v_cvt_pk_bf16_f32 v76, 0, v76
    v_lshlrev_b32 v10, 2, v3
    s_mov_b32 exec_lo, 0x00010001
    s_mov_b32 exec_hi, 0x00010001
    buffer_store_dword v76, v10, s[16:19], s66 offen sc0 sc1
    s_mov_b64 exec, -1
    s_barrier
    s_mov_b32 s66, 57344
    buffer_load_dwordx4 v[128:131], v6, s[28:31], s66 offen
    s_mov_b32 s66, 64512
    buffer_load_dwordx4 v[132:135], v6, s[28:31], s66 offen
    s_mov_b32 s66, 71680
    buffer_load_dwordx4 v[136:139], v6, s[28:31], s66 offen
    s_mov_b32 s66, 78848
    buffer_load_dwordx4 v[140:143], v6, s[28:31], s66 offen
    s_mov_b32 s66, 86016
    buffer_load_dwordx4 v[144:147], v6, s[28:31], s66 offen
    s_mov_b32 s66, 93184
    buffer_load_dwordx4 v[148:151], v6, s[28:31], s66 offen
    s_mov_b32 s66, 100352
    buffer_load_dwordx4 v[152:155], v6, s[28:31], s66 offen
    s_mov_b32 s66, 107520
    buffer_load_dwordx4 v[156:159], v6, s[28:31], s66 offen
    s_cmp_lg_u32 s48, 0
    s_cbranch_scc1 W_c5
    s_waitcnt vmcnt(9)
    s_mov_b32 s67, 0
W_cs:
    v_xor_b32 v10, v81, v15
    v_xor_b32 v11, v83, v15
    v_or_b32 v10, v10, v11
    v_xor_b32 v11, v85, v15
    v_or_b32 v10, v10, v11
    v_xor_b32 v11, v87, v15
    v_or_b32 v10, v10, v11
    v_cmp_ne_u32 vcc, 0, v10
    s_cbranch_vccz W_cok
    s_add_u32 s67, s67, 1
    s_cmp_ge_u32 s67, 200000
    s_cbranch_scc1 W_cok
    s_sleep 4
    s_movk_i32 s66, 0
    buffer_load_dwordx2 v[80:81], v8, s[16:19], s66 offen sc1
    s_movk_i32 s66, 2048
    buffer_load_dwordx2 v[82:83], v8, s[16:19], s66 offen sc1
    s_movk_i32 s66, 4096
    buffer_load_dwordx2 v[84:85], v8, s[16:19], s66 offen sc1
    s_movk_i32 s66, 6144
    buffer_load_dwordx2 v[86:87], v8, s[16:19], s66 offen sc1
    s_waitcnt vmcnt(0)
    s_branch W_cs
W_cok:
    v_max_u32 v12, v80, v82
    v_max3_u32 v12, v12, v84, v86
    s_nop 1
    s_nop 1
    v_max_u32_dpp v12, v12, v12 quad_perm:[1,0,3,2] row_mask:0xf bank_mask:0xf
    s_nop 1
    v_max_u32_dpp v12, v12, v12 quad_perm:[2,3,0,1] row_mask:0xf bank_mask:0xf
    s_nop 1
    v_max_u32_dpp v12, v12, v12 row_half_mirror row_mask:0xf bank_mask:0xf
    s_nop 1
    v_max_u32_dpp v12, v12, v12 row_mirror row_mask:0xf bank_mask:0xf
    s_nop 1
    v_readlane_b32 s68, v12, 0
    v_readlane_b32 s69, v12, 16
    v_readlane_b32 s70, v12, 32
    v_readlane_b32 s71, v12, 48
    s_nop 1
    v_mov_b32 v12, s68
    v_max_u32 v12, s69, v12
    v_max_u32 v12, s70, v12
    v_max_u32 v12, s71, v12
    v_mov_b32 v10, 155684
    ds_write_b32 v10, v12
W_c5:
    s_waitcnt lgkmcnt(0)
    s_barrier
    v_mov_b32 v10, 155684
    ds_read_b32 v11, v10
    v_lshrrev_b32 v10, 5, v2
    v_lshlrev_b32 v10, 6, v10
    s_waitcnt lgkmcnt(0)
    v_readfirstlane_b32 s66, v11
    s_and_b32 s66, s66, 0x7ff
    s_sub_u32 s66, 2047, s66
    s_lshl_b32 s66, s66, 10
    s_add_u32 s66, s66, s51
    s_lshl_b32 s66, s66, 1
    buffer_load_dwordx4 v[80:83], v10, s[8:11], s66 offen offset:0
    buffer_load_dwordx4 v[84:87], v10, s[8:11], s66 offen offset:16
    buffer_load_dwordx4 v[88:91], v10, s[8:11], s66 offen offset:32
    buffer_load_dwordx4 v[92:95], v10, s[8:11], s66 offen offset:48
    s_barrier
    s_mov_b32 s66, 114688
    buffer_load_dwordx4 v[160:163], v6, s[28:31], s66 offen
    s_mov_b32 s66, 121856
    buffer_load_dwordx4 v[164:167], v6, s[28:31], s66 offen
    s_mov_b32 s66, 129024
    buffer_load_dwordx4 v[168:171], v6, s[28:31], s66 offen
    s_mov_b32 s66, 136192
    buffer_load_dwordx4 v[172:175], v6, s[28:31], s66 offen
    s_mov_b32 s66, 143360
    buffer_load_dwordx4 v[176:179], v6, s[28:31], s66 offen
    s_mov_b32 s66, 150528
    buffer_load_dwordx4 v[180:183], v6, s[28:31], s66 offen
    s_mov_b32 s66, 157696
    buffer_load_dwordx4 v[184:187], v6, s[28:31], s66 offen
    s_mov_b32 s66, 164864
    buffer_load_dwordx4 v[188:191], v6, s[28:31], s66 offen
    s_waitcnt vmcnt(8)
    v_mov_b32 v64, 0
    v_mov_b32 v65, 0
    v_mov_b32 v66, 0
    v_mov_b32 v67, 0
    v_mov_b32 v68, 0
    v_mov_b32 v69, 0
    v_mov_b32 v70, 0
    v_mov_b32 v71, 0
    v_lshlrev_b32 v72, 16, v80
    v_lshlrev_b32 v73, 16, v96
    v_and_b32 v74, 0xffff0000, v96
    v_fmac_f32 v64, v73, v72
    v_fmac_f32 v65, v74, v72
    v_lshlrev_b32 v73, 16, v97
    v_and_b32 v74, 0xffff0000, v97
    v_fmac_f32 v66, v73, v72
    v_fmac_f32 v67, v74, v72
    v_lshlrev_b32 v73, 16, v98
    v_and_b32 v74, 0xffff0000, v98
    v_fmac_f32 v68, v73, v72
    v_fmac_f32 v69, v74, v72
    v_lshlrev_b32 v73, 16, v99
    v_and_b32 v74, 0xffff0000, v99
    v_fmac_f32 v70, v73, v72
    v_fmac_f32 v71, v74, v72
    v_and_b32 v72, 0xffff0000, v80
    v_lshlrev_b32 v73, 16, v100
    v_and_b32 v74, 0xffff0000, v100
    v_fmac_f32 v64, v73, v72
    v_fmac_f32 v65, v74, v72
    v_lshlrev_b32 v73, 16, v101
    v_and_b32 v74, 0xffff0000, v101
    v_fmac_f32 v66, v73, v72
    v_fmac_f32 v67, v74, v72
    v_lshlrev_b32 v73, 16, v102
    v_and_b32 v74, 0xffff0000, v102
    v_fmac_f32 v68, v73, v72
    v_fmac_f32 v69, v74, v72
    v_lshlrev_b32 v73, 16, v103
    v_and_b32 v74, 0xffff0000, v103
    v_fmac_f32 v70, v73, v72
    v_fmac_f32 v71, v74, v72
    v_lshlrev_b32 v72, 16, v81
    v_lshlrev_b32 v73, 16, v104
    v_and_b32 v74, 0xffff0000, v104
    v_fmac_f32 v64, v73, v72
    v_fmac_f32 v65, v74, v72
    v_lshlrev_b32 v73, 16, v105
    v_and_b32 v74, 0xffff0000, v105
    v_fmac_f32 v66, v73, v72
    v_fmac_f32 v67, v74, v72
    v_lshlrev_b32 v73, 16, v106
    v_and_b32 v74, 0xffff0000, v106
    v_fmac_f32 v68, v73, v72
    v_fmac_f32 v69, v74, v72
    v_lshlrev_b32 v73, 16, v107
    v_and_b32 v74, 0xffff0000, v107
    v_fmac_f32 v70, v73, v72
    v_fmac_f32 v71, v74, v72
    v_and_b32 v72, 0xffff0000, v81
    v_lshlrev_b32 v73, 16, v108
    v_and_b32 v74, 0xffff0000, v108
    v_fmac_f32 v64, v73, v72
    v_fmac_f32 v65, v74, v72
    v_lshlrev_b32 v73, 16, v109
    v_and_b32 v74, 0xffff0000, v109
    v_fmac_f32 v66, v73, v72
    v_fmac_f32 v67, v74, v72
    v_lshlrev_b32 v73, 16, v110
    v_and_b32 v74, 0xffff0000, v110
    v_fmac_f32 v68, v73, v72
    v_fmac_f32 v69, v74, v72
    v_lshlrev_b32 v73, 16, v111
    v_and_b32 v74, 0xffff0000, v111
    v_fmac_f32 v70, v73, v72
    v_fmac_f32 v71, v74, v72
    v_lshlrev_b32 v72, 16, v82
    v_lshlrev_b32 v73, 16, v112
    v_and_b32 v74, 0xffff0000, v112
    v_fmac_f32 v64, v73, v72
    v_fmac_f32 v65, v74, v72
    v_lshlrev_b32 v73, 16, v113
    v_and_b32 v74, 0xffff0000, v113
    v_fmac_f32 v66, v73, v72
    v_fmac_f32 v67, v74, v72
    v_lshlrev_b32 v73, 16, v114
    v_and_b32 v74, 0xffff0000, v114
    v_fmac_f32 v68, v73, v72
    v_fmac_f32 v69, v74, v72
    v_lshlrev_b32 v73, 16, v115
    v_and_b32 v74, 0xffff0000, v115
    v_fmac_f32 v70, v73, v72
    v_fmac_f32 v71, v74, v72
    v_and_b32 v72, 0xffff0000, v82
    v_lshlrev_b32 v73, 16, v116
    v_and_b32 v74, 0xffff0000, v116
    v_fmac_f32 v64, v73, v72
    v_fmac_f32 v65, v74, v72
    v_lshlrev_b32 v73, 16, v117
    v_and_b32 v74, 0xffff0000, v117
    v_fmac_f32 v66, v73, v72
    v_fmac_f32 v67, v74, v72
    v_lshlrev_b32 v73, 16, v118
    v_and_b32 v74, 0xffff0000, v118
    v_fmac_f32 v68, v73, v72
    v_fmac_f32 v69, v74, v72
    v_lshlrev_b32 v73, 16, v119
    v_and_b32 v74, 0xffff0000, v119
    v_fmac_f32 v70, v73, v72
    v_fmac_f32 v71, v74, v72
    s_barrier
    v_lshlrev_b32 v72, 16, v83
    v_lshlrev_b32 v73, 16, v120
    v_and_b32 v74, 0xffff0000, v120
    v_fmac_f32 v64, v73, v72
    v_fmac_f32 v65, v74, v72
    v_lshlrev_b32 v73, 16, v121
    v_and_b32 v74, 0xffff0000, v121
    v_fmac_f32 v66, v73, v72
    v_fmac_f32 v67, v74, v72
    v_lshlrev_b32 v73, 16, v122
    v_and_b32 v74, 0xffff0000, v122
    v_fmac_f32 v68, v73, v72
    v_fmac_f32 v69, v74, v72
    v_lshlrev_b32 v73, 16, v123
    v_and_b32 v74, 0xffff0000, v123
    v_fmac_f32 v70, v73, v72
    v_fmac_f32 v71, v74, v72
    v_and_b32 v72, 0xffff0000, v83
    v_lshlrev_b32 v73, 16, v124
    v_and_b32 v74, 0xffff0000, v124
    v_fmac_f32 v64, v73, v72
    v_fmac_f32 v65, v74, v72
    v_lshlrev_b32 v73, 16, v125
    v_and_b32 v74, 0xffff0000, v125
    v_fmac_f32 v66, v73, v72
    v_fmac_f32 v67, v74, v72
    v_lshlrev_b32 v73, 16, v126
    v_and_b32 v74, 0xffff0000, v126
    v_fmac_f32 v68, v73, v72
    v_fmac_f32 v69, v74, v72
    v_lshlrev_b32 v73, 16, v127
    v_and_b32 v74, 0xffff0000, v127
    v_fmac_f32 v70, v73, v72
    v_fmac_f32 v71, v74, v72
    v_lshlrev_b32 v72, 16, v84
    v_lshlrev_b32 v73, 16, v128
    v_and_b32 v74, 0xffff0000, v128
    v_fmac_f32 v64, v73, v72
    v_fmac_f32 v65, v74, v72
    v_lshlrev_b32 v73, 16, v129
    v_and_b32 v74, 0xffff0000, v129
    v_fmac_f32 v66, v73, v72
    v_fmac_f32 v67, v74, v72
    v_lshlrev_b32 v73, 16, v130
    v_and_b32 v74, 0xffff0000, v130
    v_fmac_f32 v68, v73, v72
    v_fmac_f32 v69, v74, v72
    v_lshlrev_b32 v73, 16, v131
    v_and_b32 v74, 0xffff0000, v131
    v_fmac_f32 v70, v73, v72
    v_fmac_f32 v71, v74, v72
    v_and_b32 v72, 0xffff0000, v84
    v_lshlrev_b32 v73, 16, v132
    v_and_b32 v74, 0xffff0000, v132
    v_fmac_f32 v64, v73, v72
    v_fmac_f32 v65, v74, v72
    v_lshlrev_b32 v73, 16, v133
    v_and_b32 v74, 0xffff0000, v133
    v_fmac_f32 v66, v73, v72
    v_fmac_f32 v67, v74, v72
    v_lshlrev_b32 v73, 16, v134
    v_and_b32 v74, 0xffff0000, v134
    v_fmac_f32 v68, v73, v72
    v_fmac_f32 v69, v74, v72
    v_lshlrev_b32 v73, 16, v135
    v_and_b32 v74, 0xffff0000, v135
    v_fmac_f32 v70, v73, v72
    v_fmac_f32 v71, v74, v72
    v_lshlrev_b32 v72, 16, v85
    v_lshlrev_b32 v73, 16, v136
    v_and_b32 v74, 0xffff0000, v136
    v_fmac_f32 v64, v73, v72
    v_fmac_f32 v65, v74, v72
    v_lshlrev_b32 v73, 16, v137
    v_and_b32 v74, 0xffff0000, v137
    v_fmac_f32 v66, v73, v72
    v_fmac_f32 v67, v74, v72
    v_lshlrev_b32 v73, 16, v138
    v_and_b32 v74, 0xffff0000, v138
    v_fmac_f32 v68, v73, v72
    v_fmac_f32 v69, v74, v72
    v_lshlrev_b32 v73, 16, v139
    v_and_b32 v74, 0xffff0000, v139
    v_fmac_f32 v70, v73, v72
    v_fmac_f32 v71, v74, v72
    v_and_b32 v72, 0xffff0000, v85
    v_lshlrev_b32 v73, 16, v140
    v_and_b32 v74, 0xffff0000, v140
    v_fmac_f32 v64, v73, v72
    v_fmac_f32 v65, v74, v72
    v_lshlrev_b32 v73, 16, v141
    v_and_b32 v74, 0xffff0000, v141
    v_fmac_f32 v66, v73, v72
    v_fmac_f32 v67, v74, v72
    v_lshlrev_b32 v73, 16, v142
    v_and_b32 v74, 0xffff0000, v142
    v_fmac_f32 v68, v73, v72
    v_fmac_f32 v69, v74, v72
    v_lshlrev_b32 v73, 16, v143
    v_and_b32 v74, 0xffff0000, v143
    v_fmac_f32 v70, v73, v72
    v_fmac_f32 v71, v74, v72
    s_barrier
    s_mov_b32 s66, 172032
    buffer_load_dwordx4 v[192:195], v6, s[28:31], s66 offen
    s_mov_b32 s66, 179200
    buffer_load_dwordx4 v[196:199], v6, s[28:31], s66 offen
    s_mov_b32 s66, 186368
    buffer_load_dwordx4 v[200:203], v6, s[28:31], s66 offen
    s_mov_b32 s66, 193536
    buffer_load_dwordx4 v[204:207], v6, s[28:31], s66 offen
    s_mov_b32 s66, 200704
    buffer_load_dwordx4 v[208:211], v6, s[28:31], s66 offen
    s_mov_b32 s66, 207872
    buffer_load_dwordx4 v[212:215], v6, s[28:31], s66 offen
    s_mov_b32 s66, 215040
    buffer_load_dwordx4 v[216:219], v6, s[28:31], s66 offen
    s_mov_b32 s66, 222208
    buffer_load_dwordx4 v[220:223], v6, s[28:31], s66 offen
    v_lshlrev_b32 v72, 16, v86
    v_lshlrev_b32 v73, 16, v144
    v_and_b32 v74, 0xffff0000, v144
    v_fmac_f32 v64, v73, v72
    v_fmac_f32 v65, v74, v72
    v_lshlrev_b32 v73, 16, v145
    v_and_b32 v74, 0xffff0000, v145
    v_fmac_f32 v66, v73, v72
    v_fmac_f32 v67, v74, v72
    v_lshlrev_b32 v73, 16, v146
    v_and_b32 v74, 0xffff0000, v146
    v_fmac_f32 v68, v73, v72
    v_fmac_f32 v69, v74, v72
    v_lshlrev_b32 v73, 16, v147
    v_and_b32 v74, 0xffff0000, v147
    v_fmac_f32 v70, v73, v72
    v_fmac_f32 v71, v74, v72
    v_and_b32 v72, 0xffff0000, v86
    v_lshlrev_b32 v73, 16, v148
    v_and_b32 v74, 0xffff0000, v148
    v_fmac_f32 v64, v73, v72
    v_fmac_f32 v65, v74, v72
    v_lshlrev_b32 v73, 16, v149
    v_and_b32 v74, 0xffff0000, v149
    v_fmac_f32 v66, v73, v72
    v_fmac_f32 v67, v74, v72
    v_lshlrev_b32 v73, 16, v150
    v_and_b32 v74, 0xffff0000, v150
    v_fmac_f32 v68, v73, v72
    v_fmac_f32 v69, v74, v72
    v_lshlrev_b32 v73, 16, v151
    v_and_b32 v74, 0xffff0000, v151
    v_fmac_f32 v70, v73, v72
    v_fmac_f32 v71, v74, v72
    v_lshlrev_b32 v72, 16, v87
    v_lshlrev_b32 v73, 16, v152
    v_and_b32 v74, 0xffff0000, v152
    v_fmac_f32 v64, v73, v72
    v_fmac_f32 v65, v74, v72
    v_lshlrev_b32 v73, 16, v153
    v_and_b32 v74, 0xffff0000, v153
    v_fmac_f32 v66, v73, v72
    v_fmac_f32 v67, v74, v72
    v_lshlrev_b32 v73, 16, v154
    v_and_b32 v74, 0xffff0000, v154
    v_fmac_f32 v68, v73, v72
    v_fmac_f32 v69, v74, v72
    v_lshlrev_b32 v73, 16, v155
    v_and_b32 v74, 0xffff0000, v155
    v_fmac_f32 v70, v73, v72
    v_fmac_f32 v71, v74, v72
    v_and_b32 v72, 0xffff0000, v87
    v_lshlrev_b32 v73, 16, v156
    v_and_b32 v74, 0xffff0000, v156
    v_fmac_f32 v64, v73, v72
    v_fmac_f32 v65, v74, v72
    v_lshlrev_b32 v73, 16, v157
    v_and_b32 v74, 0xffff0000, v157
    v_fmac_f32 v66, v73, v72
    v_fmac_f32 v67, v74, v72
    v_lshlrev_b32 v73, 16, v158
    v_and_b32 v74, 0xffff0000, v158
    v_fmac_f32 v68, v73, v72
    v_fmac_f32 v69, v74, v72
    v_lshlrev_b32 v73, 16, v159
    v_and_b32 v74, 0xffff0000, v159
    v_fmac_f32 v70, v73, v72
    v_fmac_f32 v71, v74, v72
    s_waitcnt vmcnt(15)
    v_lshlrev_b32 v72, 16, v88
    v_lshlrev_b32 v73, 16, v160
    v_and_b32 v74, 0xffff0000, v160
    v_fmac_f32 v64, v73, v72
    v_fmac_f32 v65, v74, v72
    v_lshlrev_b32 v73, 16, v161
    v_and_b32 v74, 0xffff0000, v161
    v_fmac_f32 v66, v73, v72
    v_fmac_f32 v67, v74, v72
    v_lshlrev_b32 v73, 16, v162
    v_and_b32 v74, 0xffff0000, v162
    v_fmac_f32 v68, v73, v72
    v_fmac_f32 v69, v74, v72
    v_lshlrev_b32 v73, 16, v163
    v_and_b32 v74, 0xffff0000, v163
    v_fmac_f32 v70, v73, v72
    v_fmac_f32 v71, v74, v72
    s_waitcnt vmcnt(14)
    v_and_b32 v72, 0xffff0000, v88
    v_lshlrev_b32 v73, 16, v164
    v_and_b32 v74, 0xffff0000, v164
    v_fmac_f32 v64, v73, v72
    v_fmac_f32 v65, v74, v72
    v_lshlrev_b32 v73, 16, v165
    v_and_b32 v74, 0xffff0000, v165
    v_fmac_f32 v66, v73, v72
    v_fmac_f32 v67, v74, v72
    v_lshlrev_b32 v73, 16, v166
    v_and_b32 v74, 0xffff0000, v166
    v_fmac_f32 v68, v73, v72
    v_fmac_f32 v69, v74, v72
    v_lshlrev_b32 v73, 16, v167
    v_and_b32 v74, 0xffff0000, v167
    v_fmac_f32 v70, v73, v72
    v_fmac_f32 v71, v74, v72
    s_barrier
    s_waitcnt vmcnt(13)
    v_lshlrev_b32 v72, 16, v89
    v_lshlrev_b32 v73, 16, v168
    v_and_b32 v74, 0xffff0000, v168
    v_fmac_f32 v64, v73, v72
    v_fmac_f32 v65, v74, v72
    v_lshlrev_b32 v73, 16, v169
    v_and_b32 v74, 0xffff0000, v169
    v_fmac_f32 v66, v73, v72
    v_fmac_f32 v67, v74, v72
    v_lshlrev_b32 v73, 16, v170
    v_and_b32 v74, 0xffff0000, v170
    v_fmac_f32 v68, v73, v72
    v_fmac_f32 v69, v74, v72
    v_lshlrev_b32 v73, 16, v171
    v_and_b32 v74, 0xffff0000, v171
    v_fmac_f32 v70, v73, v72
    v_fmac_f32 v71, v74, v72
    s_waitcnt vmcnt(12)
    v_and_b32 v72, 0xffff0000, v89
    v_lshlrev_b32 v73, 16, v172
    v_and_b32 v74, 0xffff0000, v172
    v_fmac_f32 v64, v73, v72
    v_fmac_f32 v65, v74, v72
    v_lshlrev_b32 v73, 16, v173
    v_and_b32 v74, 0xffff0000, v173
    v_fmac_f32 v66, v73, v72
    v_fmac_f32 v67, v74, v72
    v_lshlrev_b32 v73, 16, v174
    v_and_b32 v74, 0xffff0000, v174
    v_fmac_f32 v68, v73, v72
    v_fmac_f32 v69, v74, v72
    v_lshlrev_b32 v73, 16, v175
    v_and_b32 v74, 0xffff0000, v175
    v_fmac_f32 v70, v73, v72
    v_fmac_f32 v71, v74, v72
    s_waitcnt vmcnt(11)
    v_lshlrev_b32 v72, 16, v90
    v_lshlrev_b32 v73, 16, v176
    v_and_b32 v74, 0xffff0000, v176
    v_fmac_f32 v64, v73, v72
    v_fmac_f32 v65, v74, v72
    v_lshlrev_b32 v73, 16, v177
    v_and_b32 v74, 0xffff0000, v177
    v_fmac_f32 v66, v73, v72
    v_fmac_f32 v67, v74, v72
    v_lshlrev_b32 v73, 16, v178
    v_and_b32 v74, 0xffff0000, v178
    v_fmac_f32 v68, v73, v72
    v_fmac_f32 v69, v74, v72
    v_lshlrev_b32 v73, 16, v179
    v_and_b32 v74, 0xffff0000, v179
    v_fmac_f32 v70, v73, v72
    v_fmac_f32 v71, v74, v72
    s_waitcnt vmcnt(10)
    v_and_b32 v72, 0xffff0000, v90
    v_lshlrev_b32 v73, 16, v180
    v_and_b32 v74, 0xffff0000, v180
    v_fmac_f32 v64, v73, v72
    v_fmac_f32 v65, v74, v72
    v_lshlrev_b32 v73, 16, v181
    v_and_b32 v74, 0xffff0000, v181
    v_fmac_f32 v66, v73, v72
    v_fmac_f32 v67, v74, v72
    v_lshlrev_b32 v73, 16, v182
    v_and_b32 v74, 0xffff0000, v182
    v_fmac_f32 v68, v73, v72
    v_fmac_f32 v69, v74, v72
    v_lshlrev_b32 v73, 16, v183
    v_and_b32 v74, 0xffff0000, v183
    v_fmac_f32 v70, v73, v72
    v_fmac_f32 v71, v74, v72
    s_barrier
    s_waitcnt vmcnt(9)
    v_lshlrev_b32 v72, 16, v91
    v_lshlrev_b32 v73, 16, v184
    v_and_b32 v74, 0xffff0000, v184
    v_fmac_f32 v64, v73, v72
    v_fmac_f32 v65, v74, v72
    v_lshlrev_b32 v73, 16, v185
    v_and_b32 v74, 0xffff0000, v185
    v_fmac_f32 v66, v73, v72
    v_fmac_f32 v67, v74, v72
    v_lshlrev_b32 v73, 16, v186
    v_and_b32 v74, 0xffff0000, v186
    v_fmac_f32 v68, v73, v72
    v_fmac_f32 v69, v74, v72
    v_lshlrev_b32 v73, 16, v187
    v_and_b32 v74, 0xffff0000, v187
    v_fmac_f32 v70, v73, v72
    v_fmac_f32 v71, v74, v72
    s_waitcnt vmcnt(8)
    v_and_b32 v72, 0xffff0000, v91
    v_lshlrev_b32 v73, 16, v188
    v_and_b32 v74, 0xffff0000, v188
    v_fmac_f32 v64, v73, v72
    v_fmac_f32 v65, v74, v72
    v_lshlrev_b32 v73, 16, v189
    v_and_b32 v74, 0xffff0000, v189
    v_fmac_f32 v66, v73, v72
    v_fmac_f32 v67, v74, v72
    v_lshlrev_b32 v73, 16, v190
    v_and_b32 v74, 0xffff0000, v190
    v_fmac_f32 v68, v73, v72
    v_fmac_f32 v69, v74, v72
    v_lshlrev_b32 v73, 16, v191
    v_and_b32 v74, 0xffff0000, v191
    v_fmac_f32 v70, v73, v72
    v_fmac_f32 v71, v74, v72
    s_waitcnt vmcnt(7)
    v_lshlrev_b32 v72, 16, v92
    v_lshlrev_b32 v73, 16, v192
    v_and_b32 v74, 0xffff0000, v192
    v_fmac_f32 v64, v73, v72
    v_fmac_f32 v65, v74, v72
    v_lshlrev_b32 v73, 16, v193
    v_and_b32 v74, 0xffff0000, v193
    v_fmac_f32 v66, v73, v72
    v_fmac_f32 v67, v74, v72
    v_lshlrev_b32 v73, 16, v194
    v_and_b32 v74, 0xffff0000, v194
    v_fmac_f32 v68, v73, v72
    v_fmac_f32 v69, v74, v72
    v_lshlrev_b32 v73, 16, v195
    v_and_b32 v74, 0xffff0000, v195
    v_fmac_f32 v70, v73, v72
    v_fmac_f32 v71, v74, v72
    s_waitcnt vmcnt(6)
    v_and_b32 v72, 0xffff0000, v92
    v_lshlrev_b32 v73, 16, v196
    v_and_b32 v74, 0xffff0000, v196
    v_fmac_f32 v64, v73, v72
    v_fmac_f32 v65, v74, v72
    v_lshlrev_b32 v73, 16, v197
    v_and_b32 v74, 0xffff0000, v197
    v_fmac_f32 v66, v73, v72
    v_fmac_f32 v67, v74, v72
    v_lshlrev_b32 v73, 16, v198
    v_and_b32 v74, 0xffff0000, v198
    v_fmac_f32 v68, v73, v72
    v_fmac_f32 v69, v74, v72
    v_lshlrev_b32 v73, 16, v199
    v_and_b32 v74, 0xffff0000, v199
    v_fmac_f32 v70, v73, v72
    v_fmac_f32 v71, v74, v72
    s_waitcnt vmcnt(5)
    v_lshlrev_b32 v72, 16, v93
    v_lshlrev_b32 v73, 16, v200
    v_and_b32 v74, 0xffff0000, v200
    v_fmac_f32 v64, v73, v72
    v_fmac_f32 v65, v74, v72
    v_lshlrev_b32 v73, 16, v201
    v_and_b32 v74, 0xffff0000, v201
    v_fmac_f32 v66, v73, v72
    v_fmac_f32 v67, v74, v72
    v_lshlrev_b32 v73, 16, v202
    v_and_b32 v74, 0xffff0000, v202
    v_fmac_f32 v68, v73, v72
    v_fmac_f32 v69, v74, v72
    v_lshlrev_b32 v73, 16, v203
    v_and_b32 v74, 0xffff0000, v203
    v_fmac_f32 v70, v73, v72
    v_fmac_f32 v71, v74, v72
    s_waitcnt vmcnt(4)
    v_and_b32 v72, 0xffff0000, v93
    v_lshlrev_b32 v73, 16, v204
    v_and_b32 v74, 0xffff0000, v204
    v_fmac_f32 v64, v73, v72
    v_fmac_f32 v65, v74, v72
    v_lshlrev_b32 v73, 16, v205
    v_and_b32 v74, 0xffff0000, v205
    v_fmac_f32 v66, v73, v72
    v_fmac_f32 v67, v74, v72
    v_lshlrev_b32 v73, 16, v206
    v_and_b32 v74, 0xffff0000, v206
    v_fmac_f32 v68, v73, v72
    v_fmac_f32 v69, v74, v72
    v_lshlrev_b32 v73, 16, v207
    v_and_b32 v74, 0xffff0000, v207
    v_fmac_f32 v70, v73, v72
    v_fmac_f32 v71, v74, v72
    s_barrier
    s_waitcnt vmcnt(3)
    v_lshlrev_b32 v72, 16, v94
    v_lshlrev_b32 v73, 16, v208
    v_and_b32 v74, 0xffff0000, v208
    v_fmac_f32 v64, v73, v72
    v_fmac_f32 v65, v74, v72
    v_lshlrev_b32 v73, 16, v209
    v_and_b32 v74, 0xffff0000, v209
    v_fmac_f32 v66, v73, v72
    v_fmac_f32 v67, v74, v72
    v_lshlrev_b32 v73, 16, v210
    v_and_b32 v74, 0xffff0000, v210
    v_fmac_f32 v68, v73, v72
    v_fmac_f32 v69, v74, v72
    v_lshlrev_b32 v73, 16, v211
    v_and_b32 v74, 0xffff0000, v211
    v_fmac_f32 v70, v73, v72
    v_fmac_f32 v71, v74, v72
    s_waitcnt vmcnt(2)
    v_and_b32 v72, 0xffff0000, v94
    v_lshlrev_b32 v73, 16, v212
    v_and_b32 v74, 0xffff0000, v212
    v_fmac_f32 v64, v73, v72
    v_fmac_f32 v65, v74, v72
    v_lshlrev_b32 v73, 16, v213
    v_and_b32 v74, 0xffff0000, v213
    v_fmac_f32 v66, v73, v72
    v_fmac_f32 v67, v74, v72
    v_lshlrev_b32 v73, 16, v214
    v_and_b32 v74, 0xffff0000, v214
    v_fmac_f32 v68, v73, v72
    v_fmac_f32 v69, v74, v72
    v_lshlrev_b32 v73, 16, v215
    v_and_b32 v74, 0xffff0000, v215
    v_fmac_f32 v70, v73, v72
    v_fmac_f32 v71, v74, v72
    s_waitcnt vmcnt(1)
    v_lshlrev_b32 v72, 16, v95
    v_lshlrev_b32 v73, 16, v216
    v_and_b32 v74, 0xffff0000, v216
    v_fmac_f32 v64, v73, v72
    v_fmac_f32 v65, v74, v72
    v_lshlrev_b32 v73, 16, v217
    v_and_b32 v74, 0xffff0000, v217
    v_fmac_f32 v66, v73, v72
    v_fmac_f32 v67, v74, v72
    v_lshlrev_b32 v73, 16, v218
    v_and_b32 v74, 0xffff0000, v218
    v_fmac_f32 v68, v73, v72
    v_fmac_f32 v69, v74, v72
    v_lshlrev_b32 v73, 16, v219
    v_and_b32 v74, 0xffff0000, v219
    v_fmac_f32 v70, v73, v72
    v_fmac_f32 v71, v74, v72
    s_waitcnt vmcnt(0)
    v_and_b32 v72, 0xffff0000, v95
    v_lshlrev_b32 v73, 16, v220
    v_and_b32 v74, 0xffff0000, v220
    v_fmac_f32 v64, v73, v72
    v_fmac_f32 v65, v74, v72
    v_lshlrev_b32 v73, 16, v221
    v_and_b32 v74, 0xffff0000, v221
    v_fmac_f32 v66, v73, v72
    v_fmac_f32 v67, v74, v72
    v_lshlrev_b32 v73, 16, v222
    v_and_b32 v74, 0xffff0000, v222
    v_fmac_f32 v68, v73, v72
    v_fmac_f32 v69, v74, v72
    v_lshlrev_b32 v73, 16, v223
    v_and_b32 v74, 0xffff0000, v223
    v_fmac_f32 v70, v73, v72
    v_fmac_f32 v71, v74, v72
    v_and_b32 v76, 31, v2
    v_lshrrev_b32 v77, 5, v2
    v_lshl_add_u32 v76, v76, 1, v77
    v_permlane32_swap_b32 v64, v68
    v_permlane32_swap_b32 v65, v69
    v_permlane32_swap_b32 v66, v70
    v_permlane32_swap_b32 v67, v71
    v_lshlrev_b32 v76, 4, v76
    v_add_f32 v64, v64, v68
    v_add_f32 v65, v65, v69
    v_add_f32 v66, v66, v70
    v_add_f32 v67, v67, v71
    buffer_store_dwordx4 v[64:67], v76, s[16:19], s54 offen sc0 sc1
    s_barrier
    v_lshrrev_b32 v10, 5, v2
    v_and_b32 v11, 31, v2
    v_lshlrev_b32 v12, 3, v10
    s_lshl_b32 s66, s79, 6
    s_lshl_b32 s67, s44, 4
    s_add_u32 s66, s66, s67
    v_add_u32 v12, s66, v12
    v_lshlrev_b32 v12, 11, v12
    v_lshl_add_u32 v12, v11, 4, v12
    s_lshl_b32 s66, s73, 9
    v_add_u32 v7, s66, v12
    s_lshl_b32 s66, s2, 2
    s_add_u32 s66, s66, s44
    s_lshl_b32 s66, s66, 11
    buffer_load_dwordx4 v[240:243], v9, s[20:23], s66 offen offset:0
    buffer_load_dwordx4 v[240:243], v9, s[20:23], s66 offen offset:1024
    s_mov_b32 s66, 0
    buffer_load_dwordx4 v[160:163], v7, s[32:35], s66 offen
    s_mov_b32 s66, 2048
    buffer_load_dwordx4 v[164:167], v7, s[32:35], s66 offen
    s_mov_b32 s66, 4096
    buffer_load_dwordx4 v[168:171], v7, s[32:35], s66 offen
    s_mov_b32 s66, 6144
    buffer_load_dwordx4 v[172:175], v7, s[32:35], s66 offen
    s_mov_b32 s66, 8192
    buffer_load_dwordx4 v[176:179], v7, s[32:35], s66 offen
    s_mov_b32 s66, 10240
    buffer_load_dwordx4 v[180:183], v7, s[32:35], s66 offen
    s_mov_b32 s66, 12288
    buffer_load_dwordx4 v[184:187], v7, s[32:35], s66 offen
    s_mov_b32 s66, 14336
    buffer_load_dwordx4 v[188:191], v7, s[32:35], s66 offen
H_b14:
    s_barrier
    s_setprio 3
    v_lshlrev_b32 v9, 4, v2
    v_lshrrev_b32 v159, 3, v2
    s_lshl_b32 s67, s44, 3
    v_add_u32 v159, s67, v159
    v_lshlrev_b32 v159, 11, v159
    v_lshrrev_b32 v131, 4, v2
    v_lshlrev_b32 v131, 1, v131
    v_and_b32 v135, 7, v2
    v_xor_b32 v131, v131, v135
    v_lshl_add_u32 v159, v131, 4, v159
    s_lshl_b32 s66, s7, 7
    v_add_u32 v135, s66, v159
    s_lshl_b32 s66, s6, 7
    s_lshl_b32 s67, s44, 5
    s_add_u32 s66, s66, s67
    s_lshl_b32 s67, s45, 4
    s_add_u32 s66, s66, s67
    v_and_b32 v157, 15, v2
    v_add_u32 v157, s66, v157
    v_lshlrev_b32 v156, 11, v157
    v_bfe_u32 v159, v2, 4, 1
    v_lshl_add_u32 v156, v159, 5, v156
    v_lshrrev_b32 v159, 5, v2
    v_lshl_add_u32 v156, v159, 4, v156
    s_lshl_b32 s66, s7, 7
    v_add_u32 v156, s66, v156
    v_lshrrev_b32 v158, 2, v157
    v_lshlrev_b32 v158, 6, v158
    v_and_b32 v159, 3, v2
    v_lshl_add_u32 v158, v159, 2, v158
    s_lshl_b32 s50, s6, 1
    s_and_b32 s50, s50, 6
    s_add_u32 s50, s50, s7
    s_and_b32 s50, s50, 7
    s_lshl_b32 s50, s50, 18
    s_mov_b32 s70, 0x3fb8aa3b
    s_mov_b32 s71, 0x3fb8aa3b
    s_and_b32 s66, s44, 2
    s_lshl_b32 s67, s66, 2
    s_add_u32 s67, s67, 155648
    v_mov_b32 v10, s67
    s_lshl_b32 s66, s66, 12
    s_and_b32 s67, s44, 1
    s_lshl_b32 s67, s67, 10
    v_add_u32 v11, s66, v9
    v_add_u32 v12, s67, v11
    v_add_u32 v11, 65536, v11
    v_mov_b32 v204, 0x3f803f80
    v_mov_b32 v205, 0x3f803f80
    v_mov_b32 v206, 0x3f803f80
    v_mov_b32 v207, 0x3f803f80
H_fk:
    ds_read_b64 v[14:15], v10
    s_waitcnt lgkmcnt(0)
    v_min_u32 v14, v14, v15
    v_cmp_eq_u32 vcc, 0, v14
    s_cbranch_vccnz H_fk
    ds_read_b128 v[16:19], v12 offset:0
    ds_read_b128 v[20:23], v12 offset:2048
    ds_read_b128 v[24:27], v12 offset:4096
    ds_read_b128 v[28:31], v12 offset:6144
    s_waitcnt lgkmcnt(3)
    v_lshlrev_b32 v72, 16, v16
    v_and_b32 v73, 0xffff0000, v16
    v_pk_mul_f32 v[74:75], v[72:73], s[70:71]
    v_pk_add_f32 v[72:73], v[72:73], 1.0 op_sel_hi:[1,0]
    v_exp_f32 v74, v74 clamp
    v_exp_f32 v75, v75 clamp
    v_lshlrev_b32 v76, 16, v17
    v_and_b32 v77, 0xffff0000, v17
    v_pk_mul_f32 v[78:79], v[76:77], s[70:71]
    v_pk_add_f32 v[76:77], v[76:77], 1.0 op_sel_hi:[1,0]
    v_exp_f32 v78, v78 clamp
    v_exp_f32 v79, v79 clamp
    v_max_f32 v72, v72, v74
    v_max_f32 v73, v73, v75
    v_cvt_pk_bf16_f32 v32, v72, v73
    v_max_f32 v76, v76, v78
    v_max_f32 v77, v77, v79
    v_cvt_pk_bf16_f32 v33, v76, v77
    v_lshlrev_b32 v72, 16, v18
    v_and_b32 v73, 0xffff0000, v18
    v_pk_mul_f32 v[74:75], v[72:73], s[70:71]
    v_pk_add_f32 v[72:73], v[72:73], 1.0 op_sel_hi:[1,0]
    v_exp_f32 v74, v74 clamp
    v_exp_f32 v75, v75 clamp
    v_lshlrev_b32 v76, 16, v19
    v_and_b32 v77, 0xffff0000, v19
    v_pk_mul_f32 v[78:79], v[76:77], s[70:71]
    v_pk_add_f32 v[76:77], v[76:77], 1.0 op_sel_hi:[1,0]
    v_exp_f32 v78, v78 clamp
    v_exp_f32 v79, v79 clamp
    v_max_f32 v72, v72, v74
    v_max_f32 v73, v73, v75
    v_cvt_pk_bf16_f32 v34, v72, v73
    v_max_f32 v76, v76, v78
    v_max_f32 v77, v77, v79
    v_cvt_pk_bf16_f32 v35, v76, v77
    s_waitcnt lgkmcnt(2)
    v_lshlrev_b32 v72, 16, v20
    v_and_b32 v73, 0xffff0000, v20
    v_pk_mul_f32 v[74:75], v[72:73], s[70:71]
    v_pk_add_f32 v[72:73], v[72:73], 1.0 op_sel_hi:[1,0]
    v_exp_f32 v74, v74 clamp
    v_exp_f32 v75, v75 clamp
    v_lshlrev_b32 v76, 16, v21
    v_and_b32 v77, 0xffff0000, v21
    v_pk_mul_f32 v[78:79], v[76:77], s[70:71]
    v_pk_add_f32 v[76:77], v[76:77], 1.0 op_sel_hi:[1,0]
    v_exp_f32 v78, v78 clamp
    v_exp_f32 v79, v79 clamp
    v_max_f32 v72, v72, v74
    v_max_f32 v73, v73, v75
    v_cvt_pk_bf16_f32 v36, v72, v73
    v_max_f32 v76, v76, v78
    v_max_f32 v77, v77, v79
    v_cvt_pk_bf16_f32 v37, v76, v77
    v_lshlrev_b32 v72, 16, v22
    v_and_b32 v73, 0xffff0000, v22
    v_pk_mul_f32 v[74:75], v[72:73], s[70:71]
    v_pk_add_f32 v[72:73], v[72:73], 1.0 op_sel_hi:[1,0]
    v_exp_f32 v74, v74 clamp
    v_exp_f32 v75, v75 clamp
    v_lshlrev_b32 v76, 16, v23
    v_and_b32 v77, 0xffff0000, v23
    v_pk_mul_f32 v[78:79], v[76:77], s[70:71]
    v_pk_add_f32 v[76:77], v[76:77], 1.0 op_sel_hi:[1,0]
    v_exp_f32 v78, v78 clamp
    v_exp_f32 v79, v79 clamp
    v_max_f32 v72, v72, v74
    v_max_f32 v73, v73, v75
    v_cvt_pk_bf16_f32 v38, v72, v73
    v_max_f32 v76, v76, v78
    v_max_f32 v77, v77, v79
    v_cvt_pk_bf16_f32 v39, v76, v77
    s_waitcnt lgkmcnt(1)
    v_lshlrev_b32 v72, 16, v24
    v_and_b32 v73, 0xffff0000, v24
    v_pk_mul_f32 v[74:75], v[72:73], s[70:71]
    v_pk_add_f32 v[72:73], v[72:73], 1.0 op_sel_hi:[1,0]
    v_exp_f32 v74, v74 clamp
    v_exp_f32 v75, v75 clamp
    v_lshlrev_b32 v76, 16, v25
    v_and_b32 v77, 0xffff0000, v25
    v_pk_mul_f32 v[78:79], v[76:77], s[70:71]
    v_pk_add_f32 v[76:77], v[76:77], 1.0 op_sel_hi:[1,0]
    v_exp_f32 v78, v78 clamp
    v_exp_f32 v79, v79 clamp
    v_max_f32 v72, v72, v74
    v_max_f32 v73, v73, v75
    v_cvt_pk_bf16_f32 v40, v72, v73
    v_max_f32 v76, v76, v78
    v_max_f32 v77, v77, v79
    v_cvt_pk_bf16_f32 v41, v76, v77
    v_lshlrev_b32 v72, 16, v26
    v_and_b32 v73, 0xffff0000, v26
    v_pk_mul_f32 v[74:75], v[72:73], s[70:71]
    v_pk_add_f32 v[72:73], v[72:73], 1.0 op_sel_hi:[1,0]
    v_exp_f32 v74, v74 clamp
    v_exp_f32 v75, v75 clamp
    v_lshlrev_b32 v76, 16, v27
    v_and_b32 v77, 0xffff0000, v27
    v_pk_mul_f32 v[78:79], v[76:77], s[70:71]
    v_pk_add_f32 v[76:77], v[76:77], 1.0 op_sel_hi:[1,0]
    v_exp_f32 v78, v78 clamp
    v_exp_f32 v79, v79 clamp
    v_max_f32 v72, v72, v74
    v_max_f32 v73, v73, v75
    v_cvt_pk_bf16_f32 v42, v72, v73
    v_max_f32 v76, v76, v78
    v_max_f32 v77, v77, v79
    v_cvt_pk_bf16_f32 v43, v76, v77
    s_waitcnt lgkmcnt(0)
    v_lshlrev_b32 v72, 16, v28
    v_and_b32 v73, 0xffff0000, v28
    v_pk_mul_f32 v[74:75], v[72:73], s[70:71]
    v_pk_add_f32 v[72:73], v[72:73], 1.0 op_sel_hi:[1,0]
    v_exp_f32 v74, v74 clamp
    v_exp_f32 v75, v75 clamp
    v_lshlrev_b32 v76, 16, v29
    v_and_b32 v77, 0xffff0000, v29
    v_pk_mul_f32 v[78:79], v[76:77], s[70:71]
    v_pk_add_f32 v[76:77], v[76:77], 1.0 op_sel_hi:[1,0]
    v_exp_f32 v78, v78 clamp
    v_exp_f32 v79, v79 clamp
    v_max_f32 v72, v72, v74
    v_max_f32 v73, v73, v75
    v_cvt_pk_bf16_f32 v44, v72, v73
    v_max_f32 v76, v76, v78
    v_max_f32 v77, v77, v79
    v_cvt_pk_bf16_f32 v45, v76, v77
    v_lshlrev_b32 v72, 16, v30
    v_and_b32 v73, 0xffff0000, v30
    v_pk_mul_f32 v[74:75], v[72:73], s[70:71]
    v_pk_add_f32 v[72:73], v[72:73], 1.0 op_sel_hi:[1,0]
    v_exp_f32 v74, v74 clamp
    v_exp_f32 v75, v75 clamp
    v_lshlrev_b32 v76, 16, v31
    v_and_b32 v77, 0xffff0000, v31
    v_pk_mul_f32 v[78:79], v[76:77], s[70:71]
    v_pk_add_f32 v[76:77], v[76:77], 1.0 op_sel_hi:[1,0]
    v_exp_f32 v78, v78 clamp
    v_exp_f32 v79, v79 clamp
    v_max_f32 v72, v72, v74
    v_max_f32 v73, v73, v75
    v_cvt_pk_bf16_f32 v46, v72, v73
    v_max_f32 v76, v76, v78
    v_max_f32 v77, v77, v79
    v_cvt_pk_bf16_f32 v47, v76, v77
H_fv:
    ds_read_b64 v[14:15], v10 offset:16
    s_waitcnt lgkmcnt(0)
    v_min_u32 v13, v14, v15
    v_cmp_eq_u32 vcc, 0, v13
    s_cbranch_vccnz H_fv
    ds_read_b128 v[208:211], v11 offset:0
    ds_read_b128 v[212:215], v11 offset:1024
    ds_read_b128 v[216:219], v11 offset:2048
    ds_read_b128 v[220:223], v11 offset:3072
    ds_read_b128 v[224:227], v11 offset:4096
    ds_read_b128 v[228:231], v11 offset:5120
    ds_read_b128 v[232:235], v11 offset:6144
    ds_read_b128 v[236:239], v11 offset:7168
    v_max_u32 v13, v14, v15
    v_cmp_eq_u32 vcc, 2, v13
    s_cbranch_vccz H_ne
    v_lshlrev_b32 v72, 16, v32
    v_and_b32 v73, 0xffff0000, v32
    v_add_f32 v72, s47, v72
    v_add_f32 v73, s47, v73
    v_cvt_pk_bf16_f32 v32, v72, v73
    v_lshlrev_b32 v72, 16, v33
    v_and_b32 v73, 0xffff0000, v33
    v_add_f32 v72, s47, v72
    v_add_f32 v73, s47, v73
    v_cvt_pk_bf16_f32 v33, v72, v73
    v_lshlrev_b32 v72, 16, v34
    v_and_b32 v73, 0xffff0000, v34
    v_add_f32 v72, s47, v72
    v_add_f32 v73, s47, v73
    v_cvt_pk_bf16_f32 v34, v72, v73
    v_lshlrev_b32 v72, 16, v35
    v_and_b32 v73, 0xffff0000, v35
    v_add_f32 v72, s47, v72
    v_add_f32 v73, s47, v73
    v_cvt_pk_bf16_f32 v35, v72, v73
    v_lshlrev_b32 v72, 16, v36
    v_and_b32 v73, 0xffff0000, v36
    v_add_f32 v72, s47, v72
    v_add_f32 v73, s47, v73
    v_cvt_pk_bf16_f32 v36, v72, v73
    v_lshlrev_b32 v72, 16, v37
    v_and_b32 v73, 0xffff0000, v37
    v_add_f32 v72, s47, v72
    v_add_f32 v73, s47, v73
    v_cvt_pk_bf16_f32 v37, v72, v73
    v_lshlrev_b32 v72, 16, v38
    v_and_b32 v73, 0xffff0000, v38
    v_add_f32 v72, s47, v72
    v_add_f32 v73, s47, v73
    v_cvt_pk_bf16_f32 v38, v72, v73
    v_lshlrev_b32 v72, 16, v39
    v_and_b32 v73, 0xffff0000, v39
    v_add_f32 v72, s47, v72
    v_add_f32 v73, s47, v73
    v_cvt_pk_bf16_f32 v39, v72, v73
    v_lshlrev_b32 v72, 16, v40
    v_and_b32 v73, 0xffff0000, v40
    v_add_f32 v72, s47, v72
    v_add_f32 v73, s47, v73
    v_cvt_pk_bf16_f32 v40, v72, v73
    v_lshlrev_b32 v72, 16, v41
    v_and_b32 v73, 0xffff0000, v41
    v_add_f32 v72, s47, v72
    v_add_f32 v73, s47, v73
    v_cvt_pk_bf16_f32 v41, v72, v73
    v_lshlrev_b32 v72, 16, v42
    v_and_b32 v73, 0xffff0000, v42
    v_add_f32 v72, s47, v72
    v_add_f32 v73, s47, v73
    v_cvt_pk_bf16_f32 v42, v72, v73
    v_lshlrev_b32 v72, 16, v43
    v_and_b32 v73, 0xffff0000, v43
    v_add_f32 v72, s47, v72
    v_add_f32 v73, s47, v73
    v_cvt_pk_bf16_f32 v43, v72, v73
    v_lshlrev_b32 v72, 16, v44
    v_and_b32 v73, 0xffff0000, v44
    v_add_f32 v72, s47, v72
    v_add_f32 v73, s47, v73
    v_cvt_pk_bf16_f32 v44, v72, v73
    v_lshlrev_b32 v72, 16, v45
    v_and_b32 v73, 0xffff0000, v45
    v_add_f32 v72, s47, v72
    v_add_f32 v73, s47, v73
    v_cvt_pk_bf16_f32 v45, v72, v73
    v_lshlrev_b32 v72, 16, v46
    v_and_b32 v73, 0xffff0000, v46
    v_add_f32 v72, s47, v72
    v_add_f32 v73, s47, v73
    v_cvt_pk_bf16_f32 v46, v72, v73
    v_lshlrev_b32 v72, 16, v47
    v_and_b32 v73, 0xffff0000, v47
    v_add_f32 v72, s47, v72
    v_add_f32 v73, s47, v73
    v_cvt_pk_bf16_f32 v47, v72, v73
H_ne:
    s_nop 0
    v_mfma_f32_16x16x32_bf16 v[200:203], v[32:35], v[204:207], 0
    s_waitcnt lgkmcnt(7)
    v_mfma_f32_16x16x32_bf16 v[192:195], v[32:35], v[208:211], 0
    s_waitcnt lgkmcnt(6)
    v_mfma_f32_16x16x32_bf16 v[196:199], v[32:35], v[212:215], 0
    v_mfma_f32_16x16x32_bf16 v[200:203], v[36:39], v[204:207], v[200:203]
    s_waitcnt lgkmcnt(5)
    v_mfma_f32_16x16x32_bf16 v[192:195], v[36:39], v[216:219], v[192:195]
    s_waitcnt lgkmcnt(4)
    v_mfma_f32_16x16x32_bf16 v[196:199], v[36:39], v[220:223], v[196:199]
    v_mfma_f32_16x16x32_bf16 v[200:203], v[40:43], v[204:207], v[200:203]
    s_waitcnt lgkmcnt(3)
    v_mfma_f32_16x16x32_bf16 v[192:195], v[40:43], v[224:227], v[192:195]
    s_waitcnt lgkmcnt(2)
    v_mfma_f32_16x16x32_bf16 v[196:199], v[40:43], v[228:231], v[196:199]
    v_mfma_f32_16x16x32_bf16 v[200:203], v[44:47], v[204:207], v[200:203]
    s_waitcnt lgkmcnt(1)
    v_mfma_f32_16x16x32_bf16 v[192:195], v[44:47], v[232:235], v[192:195]
    s_waitcnt lgkmcnt(0)
    v_mfma_f32_16x16x32_bf16 v[196:199], v[44:47], v[236:239], v[196:199]
    v_lshrrev_b32 v13, 4, v2
    v_lshlrev_b32 v13, 4, v13
    v_and_b32 v14, 15, v2
    v_cmp_eq_u32 s[68:69], 0, v14
    s_lshl_b32 s66, s44, 11
    s_add_u32 s66, s66, 139264
    v_add_u32 v3, s66, v9
    s_waitcnt vmcnt(10)
    s_nop 1
    v_cvt_pk_bf16_f32 v72, v192, v193
    v_cvt_pk_bf16_f32 v73, v194, v195
    v_cvt_pk_bf16_f32 v74, v196, v197
    v_cvt_pk_bf16_f32 v75, v198, v199
    buffer_store_dwordx4 v[72:75], v9, s[16:19], s52 offen sc0 sc1
    s_mov_b64 exec, s[68:69]
    buffer_store_dwordx4 v[200:203], v13, s[16:19], s53 offen sc0 sc1
    s_mov_b64 exec, -1
    s_lshr_b32 s62, s79, 2
    s_lshl_b32 s62, s62, 15
    s_and_b32 s66, s79, 3
    s_lshl_b32 s66, s66, 8
    s_add_u32 s62, s62, s66
    s_lshl_b32 s66, s44, 6
    s_add_u32 s62, s62, s66
    s_add_u32 s62, s62, 5308416
    s_add_u32 s63, s62, 16384
    v_lshrrev_b32 v8, 2, v2
    v_lshlrev_b32 v8, 10, v8
    v_and_b32 v13, 3, v2
    v_lshl_add_u32 v8, v13, 4, v8
    s_setprio 0
    s_barrier
    ds_read_b128 v[16:19], v3
    ds_read_b128 v[20:23], v3 offset:1024
    s_add_u32 s67, s50, 0
    s_and_b32 s67, s67, 0x1fffff
    s_add_u32 m0, s72, 0
    s_add_u32 s66, s67, 0
    buffer_load_dwordx4 v135, s[20:23], s66 offen lds
    s_add_u32 m0, s72, 4096
    s_add_u32 s66, s67, 65536
    buffer_load_dwordx4 v135, s[20:23], s66 offen lds
    s_add_u32 s67, s50, 0
    s_and_b32 s67, s67, 0x1fffff
    s_add_u32 m0, s72, 65536
    s_add_u32 s66, s67, 131072
    buffer_load_dwordx4 v135, s[20:23], s66 offen lds
    s_add_u32 m0, s72, 69632
    s_add_u32 s66, s67, 196608
    buffer_load_dwordx4 v135, s[20:23], s66 offen lds
    s_add_u32 s67, s50, 262144
    s_and_b32 s67, s67, 0x1fffff
    s_add_u32 m0, s72, 8192
    s_add_u32 s66, s67, 0
    buffer_load_dwordx4 v135, s[20:23], s66 offen lds
    s_add_u32 m0, s72, 12288
    s_add_u32 s66, s67, 65536
    buffer_load_dwordx4 v135, s[20:23], s66 offen lds
    s_add_u32 s67, s50, 262144
    s_and_b32 s67, s67, 0x1fffff
    s_add_u32 m0, s72, 73728
    s_add_u32 s66, s67, 131072
    buffer_load_dwordx4 v135, s[20:23], s66 offen lds
    s_add_u32 m0, s72, 77824
    s_add_u32 s66, s67, 196608
    buffer_load_dwordx4 v135, s[20:23], s66 offen lds
    s_waitcnt lgkmcnt(0)
    v_lshlrev_b32 v32, 16, v16
    v_and_b32 v33, 0xffff0000, v16
    v_pk_mul_f32 v[34:35], v[32:33], s[70:71]
    v_pk_add_f32 v[32:33], v[32:33], 1.0 op_sel_hi:[1,0]
    v_exp_f32 v34, v34 clamp
    v_exp_f32 v35, v35 clamp
    v_lshlrev_b32 v36, 16, v17
    v_and_b32 v37, 0xffff0000, v17
    v_pk_mul_f32 v[38:39], v[36:37], s[70:71]
    v_pk_add_f32 v[36:37], v[36:37], 1.0 op_sel_hi:[1,0]
    v_exp_f32 v38, v38 clamp
    v_exp_f32 v39, v39 clamp
    v_max_f32 v32, v32, v34
    v_max_f32 v33, v33, v35
    v_min_f32 v40, v32, v33
    v_cvt_pk_bf16_f32 v24, v32, v33
    v_max_f32 v36, v36, v38
    v_max_f32 v37, v37, v39
    v_min3_f32 v40, v36, v37, v40
    v_cvt_pk_bf16_f32 v25, v36, v37
    v_lshlrev_b32 v32, 16, v18
    v_and_b32 v33, 0xffff0000, v18
    v_pk_mul_f32 v[34:35], v[32:33], s[70:71]
    v_pk_add_f32 v[32:33], v[32:33], 1.0 op_sel_hi:[1,0]
    v_exp_f32 v34, v34 clamp
    v_exp_f32 v35, v35 clamp
    v_lshlrev_b32 v36, 16, v19
    v_and_b32 v37, 0xffff0000, v19
    v_pk_mul_f32 v[38:39], v[36:37], s[70:71]
    v_pk_add_f32 v[36:37], v[36:37], 1.0 op_sel_hi:[1,0]
    v_exp_f32 v38, v38 clamp
    v_exp_f32 v39, v39 clamp
    v_max_f32 v32, v32, v34
    v_max_f32 v33, v33, v35
    v_min3_f32 v40, v32, v33, v40
    v_cvt_pk_bf16_f32 v26, v32, v33
    v_max_f32 v36, v36, v38
    v_max_f32 v37, v37, v39
    v_min3_f32 v40, v36, v37, v40
    v_cvt_pk_bf16_f32 v27, v36, v37
    v_lshlrev_b32 v32, 16, v20
    v_and_b32 v33, 0xffff0000, v20
    v_pk_mul_f32 v[34:35], v[32:33], s[70:71]
    v_pk_add_f32 v[32:33], v[32:33], 1.0 op_sel_hi:[1,0]
    v_exp_f32 v34, v34 clamp
    v_exp_f32 v35, v35 clamp
    v_lshlrev_b32 v36, 16, v21
    v_and_b32 v37, 0xffff0000, v21
    v_pk_mul_f32 v[38:39], v[36:37], s[70:71]
    v_pk_add_f32 v[36:37], v[36:37], 1.0 op_sel_hi:[1,0]
    v_exp_f32 v38, v38 clamp
    v_exp_f32 v39, v39 clamp
    v_max_f32 v32, v32, v34
    v_max_f32 v33, v33, v35
    v_min3_f32 v40, v32, v33, v40
    v_cvt_pk_bf16_f32 v28, v32, v33
    v_max_f32 v36, v36, v38
    v_max_f32 v37, v37, v39
    v_min3_f32 v40, v36, v37, v40
    v_cvt_pk_bf16_f32 v29, v36, v37
    v_lshlrev_b32 v32, 16, v22
    v_and_b32 v33, 0xffff0000, v22
    v_pk_mul_f32 v[34:35], v[32:33], s[70:71]
    v_pk_add_f32 v[32:33], v[32:33], 1.0 op_sel_hi:[1,0]
    v_exp_f32 v34, v34 clamp
    v_exp_f32 v35, v35 clamp
    v_lshlrev_b32 v36, 16, v23
    v_and_b32 v37, 0xffff0000, v23
    v_pk_mul_f32 v[38:39], v[36:37], s[70:71]
    v_pk_add_f32 v[36:37], v[36:37], 1.0 op_sel_hi:[1,0]
    v_exp_f32 v38, v38 clamp
    v_exp_f32 v39, v39 clamp
    v_max_f32 v32, v32, v34
    v_max_f32 v33, v33, v35
    v_min3_f32 v40, v32, v33, v40
    v_cvt_pk_bf16_f32 v30, v32, v33
    v_max_f32 v36, v36, v38
    v_max_f32 v37, v37, v39
    v_min3_f32 v40, v36, v37, v40
    v_cvt_pk_bf16_f32 v31, v36, v37
    v_cmp_gt_f32 vcc, 0x3a800000, v40
    s_cbranch_vccz P_qh
    v_lshlrev_b32 v32, 16, v24
    v_and_b32 v33, 0xffff0000, v24
    v_add_f32 v32, s47, v32
    v_add_f32 v33, s47, v33
    v_cvt_pk_bf16_f32 v24, v32, v33
    v_lshlrev_b32 v32, 16, v25
    v_and_b32 v33, 0xffff0000, v25
    v_add_f32 v32, s47, v32
    v_add_f32 v33, s47, v33
    v_cvt_pk_bf16_f32 v25, v32, v33
    v_lshlrev_b32 v32, 16, v26
    v_and_b32 v33, 0xffff0000, v26
    v_add_f32 v32, s47, v32
    v_add_f32 v33, s47, v33
    v_cvt_pk_bf16_f32 v26, v32, v33
    v_lshlrev_b32 v32, 16, v27
    v_and_b32 v33, 0xffff0000, v27
    v_add_f32 v32, s47, v32
    v_add_f32 v33, s47, v33
    v_cvt_pk_bf16_f32 v27, v32, v33
    v_lshlrev_b32 v32, 16, v28
    v_and_b32 v33, 0xffff0000, v28
    v_add_f32 v32, s47, v32
    v_add_f32 v33, s47, v33
    v_cvt_pk_bf16_f32 v28, v32, v33
    v_lshlrev_b32 v32, 16, v29
    v_and_b32 v33, 0xffff0000, v29
    v_add_f32 v32, s47, v32
    v_add_f32 v33, s47, v33
    v_cvt_pk_bf16_f32 v29, v32, v33
    v_lshlrev_b32 v32, 16, v30
    v_and_b32 v33, 0xffff0000, v30
    v_add_f32 v32, s47, v32
    v_add_f32 v33, s47, v33
    v_cvt_pk_bf16_f32 v30, v32, v33
    v_lshlrev_b32 v32, 16, v31
    v_and_b32 v33, 0xffff0000, v31
    v_add_f32 v32, s47, v32
    v_add_f32 v33, s47, v33
    v_cvt_pk_bf16_f32 v31, v32, v33
P_qh:
    s_lshr_b32 s49, s44, 1
    s_lshl_b32 s66, s49, 11
    s_add_u32 s66, s66, 159744
    v_add_u32 v10, s66, v9
    s_lshl_b32 s66, s49, 6
    s_add_u32 s66, s66, 159488
    v_lshrrev_b32 v11, 4, v2
    v_lshlrev_b32 v11, 4, v11
    v_add_u32 v11, s66, v11
    s_and_b32 s66, s44, 1
    s_lshl_b32 s66, s66, 2
    s_lshl_b32 s67, s45, 1
    s_add_u32 s66, s66, s67
    s_lshl_b32 s67, s4, 3
    s_add_u32 s66, s66, s67
    s_lshl_b32 s66, s66, 5
    s_lshl_b32 s67, s5, 1
    s_add_u32 s66, s66, s67
    s_add_u32 s66, s66, s49
    s_lshl_b32 s68, s66, 10
    s_add_u32 s69, s68, 32768
    buffer_load_dwordx4 v[88:91], v8, s[16:19], s62 offen sc1
    buffer_load_dwordx4 v[92:95], v8, s[16:19], s63 offen sc1
    buffer_load_dwordx4 v[144:147], v156, s[8:11], 0 offen offset:0
    buffer_load_dwordx4 v[148:151], v156, s[8:11], 0 offen offset:64
POST:
    s_waitcnt lgkmcnt(0)
    s_barrier
    s_mov_b32 s66, 6094848
    buffer_load_dword v152, v158, s[16:19], s66 offen sc1
    ds_read_b128 v[40:43], v11
    ds_read_b128 v[32:35], v10
    ds_read_b128 v[36:39], v10 offset:1024
    v_mov_b32 v3, 155684
    ds_read_b32 v4, v3
    s_waitcnt lgkmcnt(3)
    v_mfma_f32_16x16x32_bf16 v[60:63], v[40:43], v[24:27], 0
    v_mfma_f32_16x16x32_bf16 v[64:67], v[40:43], v[28:31], 0
    s_waitcnt lgkmcnt(1)
    v_mfma_f32_16x16x32_bf16 v[44:47], v[32:35], v[24:27], 0
    v_mfma_f32_16x16x32_bf16 v[48:51], v[36:39], v[24:27], 0
    v_mfma_f32_16x16x32_bf16 v[52:55], v[32:35], v[28:31], 0
    v_mfma_f32_16x16x32_bf16 v[56:59], v[36:39], v[28:31], 0
    s_nop 3
    v_cvt_pk_bf16_f32 v60, 0, v60
    v_cvt_pk_bf16_f32 v64, 0, v64
    v_add_f32 v60, s47, v60
    v_add_f32 v64, s47, v64
    v_cvt_pk_bf16_f32 v60, 0, v60
    v_cvt_pk_bf16_f32 v64, 0, v64
    v_rcp_f32 v60, v60
    v_rcp_f32 v64, v64
    v_cvt_pk_bf16_f32 v44, 0, v44
    v_cvt_pk_bf16_f32 v45, 0, v45
    v_cvt_pk_bf16_f32 v46, 0, v46
    v_cvt_pk_bf16_f32 v47, 0, v47
    v_cvt_pk_bf16_f32 v48, 0, v48
    v_cvt_pk_bf16_f32 v49, 0, v49
    v_cvt_pk_bf16_f32 v50, 0, v50
    v_cvt_pk_bf16_f32 v51, 0, v51
    v_pk_mul_f32 v[44:45], v[44:45], v[60:61] op_sel_hi:[1,0]
    v_pk_mul_f32 v[46:47], v[46:47], v[60:61] op_sel_hi:[1,0]
    v_pk_mul_f32 v[48:49], v[48:49], v[60:61] op_sel_hi:[1,0]
    v_pk_mul_f32 v[50:51], v[50:51], v[60:61] op_sel_hi:[1,0]
    v_cvt_pk_bf16_f32 v32, v44, v45
    v_cvt_pk_bf16_f32 v33, v46, v47
    v_cvt_pk_bf16_f32 v34, v48, v49
    v_cvt_pk_bf16_f32 v35, v50, v51
    buffer_store_dwordx4 v[32:35], v9, s[16:19], s68 offen sc0 sc1
    v_cvt_pk_bf16_f32 v52, 0, v52
    v_cvt_pk_bf16_f32 v53, 0, v53
    v_cvt_pk_bf16_f32 v54, 0, v54
    v_cvt_pk_bf16_f32 v55, 0, v55
    v_cvt_pk_bf16_f32 v56, 0, v56
    v_cvt_pk_bf16_f32 v57, 0, v57
    v_cvt_pk_bf16_f32 v58, 0, v58
    v_cvt_pk_bf16_f32 v59, 0, v59
    v_pk_mul_f32 v[52:53], v[52:53], v[64:65] op_sel_hi:[1,0]
    v_pk_mul_f32 v[54:55], v[54:55], v[64:65] op_sel_hi:[1,0]
    v_pk_mul_f32 v[56:57], v[56:57], v[64:65] op_sel_hi:[1,0]
    v_pk_mul_f32 v[58:59], v[58:59], v[64:65] op_sel_hi:[1,0]
    v_cvt_pk_bf16_f32 v36, v52, v53
    v_cvt_pk_bf16_f32 v37, v54, v55
    v_cvt_pk_bf16_f32 v38, v56, v57
    v_cvt_pk_bf16_f32 v39, v58, v59
    buffer_store_dwordx4 v[36:39], v9, s[16:19], s69 offen sc0 sc1
    s_waitcnt lgkmcnt(0)
    v_readfirstlane_b32 s74, v4
    s_waitcnt vmcnt(7)
    s_barrier
    s_cmp_eq_u32 s45, 0
    s_cbranch_scc0 Q_hg
    s_add_u32 s67, s50, 524288
    s_and_b32 s67, s67, 0x1fffff
    s_add_u32 m0, s72, 16384
    s_add_u32 s66, s67, 0
    buffer_load_dwordx4 v135, s[20:23], s66 offen lds
    s_add_u32 m0, s72, 20480
    s_add_u32 s66, s67, 65536
    buffer_load_dwordx4 v135, s[20:23], s66 offen lds
    s_add_u32 s67, s50, 524288
    s_and_b32 s67, s67, 0x1fffff
    s_add_u32 m0, s72, 81920
    s_add_u32 s66, s67, 131072
    buffer_load_dwordx4 v135, s[20:23], s66 offen lds
    s_add_u32 m0, s72, 86016
    s_add_u32 s66, s67, 196608
    buffer_load_dwordx4 v135, s[20:23], s66 offen lds
    s_add_u32 s67, s50, 786432
    s_and_b32 s67, s67, 0x1fffff
    s_add_u32 m0, s72, 24576
    s_add_u32 s66, s67, 0
    buffer_load_dwordx4 v135, s[20:23], s66 offen lds
    s_add_u32 m0, s72, 28672
    s_add_u32 s66, s67, 65536
    buffer_load_dwordx4 v135, s[20:23], s66 offen lds
    s_add_u32 s67, s50, 786432
    s_and_b32 s67, s67, 0x1fffff
    s_add_u32 m0, s72, 90112
    s_add_u32 s66, s67, 131072
    buffer_load_dwordx4 v135, s[20:23], s66 offen lds
    s_add_u32 m0, s72, 94208
    s_add_u32 s66, s67, 196608
    buffer_load_dwordx4 v135, s[20:23], s66 offen lds
    s_add_u32 s67, s50, 1048576
    s_and_b32 s67, s67, 0x1fffff
    s_add_u32 m0, s72, 32768
    s_add_u32 s66, s67, 0
    buffer_load_dwordx4 v135, s[20:23], s66 offen lds
    s_add_u32 m0, s72, 36864
    s_add_u32 s66, s67, 65536
    buffer_load_dwordx4 v135, s[20:23], s66 offen lds
    s_add_u32 s67, s50, 1048576
    s_and_b32 s67, s67, 0x1fffff
    s_add_u32 m0, s72, 98304
    s_add_u32 s66, s67, 131072
    buffer_load_dwordx4 v135, s[20:23], s66 offen lds
    s_add_u32 m0, s72, 102400
    s_add_u32 s66, s67, 196608
    buffer_load_dwordx4 v135, s[20:23], s66 offen lds
    s_add_u32 s67, s50, 1310720
    s_and_b32 s67, s67, 0x1fffff
    s_add_u32 m0, s72, 40960
    s_add_u32 s66, s67, 0
    buffer_load_dwordx4 v135, s[20:23], s66 offen lds
    s_add_u32 m0, s72, 45056
    s_add_u32 s66, s67, 65536
    buffer_load_dwordx4 v135, s[20:23], s66 offen lds
    s_add_u32 s67, s50, 1310720
    s_and_b32 s67, s67, 0x1fffff
    s_add_u32 m0, s72, 106496
    s_add_u32 s66, s67, 131072
    buffer_load_dwordx4 v135, s[20:23], s66 offen lds
    s_add_u32 m0, s72, 110592
    s_add_u32 s66, s67, 196608
    buffer_load_dwordx4 v135, s[20:23], s66 offen lds
    s_add_u32 s67, s50, 1572864
    s_and_b32 s67, s67, 0x1fffff
    s_add_u32 m0, s72, 49152
    s_add_u32 s66, s67, 0
    buffer_load_dwordx4 v135, s[20:23], s66 offen lds
    s_add_u32 m0, s72, 53248
    s_add_u32 s66, s67, 65536
    buffer_load_dwordx4 v135, s[20:23], s66 offen lds
    s_add_u32 s67, s50, 1572864
    s_and_b32 s67, s67, 0x1fffff
    s_add_u32 m0, s72, 114688
    s_add_u32 s66, s67, 131072
    buffer_load_dwordx4 v135, s[20:23], s66 offen lds
    s_add_u32 m0, s72, 118784
    s_add_u32 s66, s67, 196608
    buffer_load_dwordx4 v135, s[20:23], s66 offen lds
    s_add_u32 s67, s50, 1835008
    s_and_b32 s67, s67, 0x1fffff
    s_add_u32 m0, s72, 57344
    s_add_u32 s66, s67, 0
    buffer_load_dwordx4 v135, s[20:23], s66 offen lds
    s_add_u32 m0, s72, 61440
    s_add_u32 s66, s67, 65536
    buffer_load_dwordx4 v135, s[20:23], s66 offen lds
    s_add_u32 s67, s50, 1835008
    s_and_b32 s67, s67, 0x1fffff
    s_add_u32 m0, s72, 122880
    s_add_u32 s66, s67, 131072
    buffer_load_dwordx4 v135, s[20:23], s66 offen lds
    s_add_u32 m0, s72, 126976
    s_add_u32 s66, s67, 196608
    buffer_load_dwordx4 v135, s[20:23], s66 offen lds
    s_waitcnt vmcnt(26)
    s_branch Q_hd
Q_hg:
    s_waitcnt vmcnt(5)
    s_mov_b32 s59, 0
Q_hchk:
    v_max3_u32 v5, v88, v89, v90
    v_max3_u32 v5, v5, v91, v92
    v_max3_u32 v5, v5, v93, v94
    v_max_u32 v5, v5, v95
    v_cmp_eq_u32 vcc, -1, v5
    s_cbranch_vccz Q_hok
    s_add_u32 s59, s59, 1
    s_cmp_ge_u32 s59, 200000
    s_cbranch_scc1 Q_hok
    s_sleep 4
    buffer_load_dwordx4 v[88:91], v8, s[16:19], s62 offen sc1
    buffer_load_dwordx4 v[92:95], v8, s[16:19], s63 offen sc1
    s_waitcnt vmcnt(0)
    s_branch Q_hchk
Q_hok:
    v_permlane16_swap_b32 v88, v90
    v_permlane16_swap_b32 v89, v91
    v_permlane16_swap_b32 v92, v94
    v_permlane16_swap_b32 v93, v95
    v_add_f32 v88, v88, v90
    v_add_f32 v89, v89, v91
    v_add_f32 v92, v92, v94
    v_add_f32 v93, v93, v95
    v_and_b32 v5, 3, v2
    v_lshlrev_b32 v5, 3, v5
    v_permlane32_swap_b32 v88, v89
    v_permlane32_swap_b32 v92, v93
    v_bfe_u32 v6, v2, 4, 1
    v_lshl_add_u32 v5, v6, 2, v5
    v_add_f32 v88, v88, v89
    v_add_f32 v92, v92, v93
    v_lshrrev_b32 v6, 5, v2
    v_lshl_add_u32 v5, v6, 1, v5
    v_add_f32_dpp v88, v88, v88 row_ror:4 row_mask:0xf bank_mask:0xf
    v_add_f32_dpp v92, v92, v92 row_ror:4 row_mask:0xf bank_mask:0xf
    s_nop 0
    v_add_f32_dpp v88, v88, v88 row_ror:8 row_mask:0xf bank_mask:0xf
    v_add_f32_dpp v92, v92, v92 row_ror:8 row_mask:0xf bank_mask:0xf
    s_nop 0
    s_lshl_b32 s66, s44, 5
    s_add_u32 s66, s66, 155712
    v_cvt_pk_bf16_f32 v88, 0, v88
    v_cvt_pk_bf16_f32 v92, 0, v92
    v_mul_f32 v89, s46, v88
    v_exp_f32 v89, -v89
    v_add_u32 v5, s66, v5
    v_add_f32 v89, 1.0, v89
    v_rcp_f32 v89, v89
    v_lshlrev_b32 v6, 4, v6
    v_mul_f32 v89, v89, v88
    v_cvt_pk_bf16_f32 v89, 0, v89
    v_add_u32 v6, s66, v6
    v_mul_f32 v89, v89, v92
    v_cvt_pk_bf16_f32 v89, v89, v89
    ds_write_b16 v5, v89
    ds_read_b128 v[92:95], v6
    v_mov_b32 v64, 0
    v_mov_b32 v65, 0
    v_mov_b32 v66, 0
    v_mov_b32 v67, 0
    v_mov_b32 v68, 0
    v_mov_b32 v69, 0
    v_mov_b32 v70, 0
    v_mov_b32 v71, 0
    s_waitcnt lgkmcnt(0)
    v_and_b32 v72, 0xffff, v92
    v_lshlrev_b32 v73, 16, v92
    v_dot2_f32_bf16 v64, v160, v72, v64
    v_dot2_f32_bf16 v65, v160, v73, v65
    v_dot2_f32_bf16 v66, v161, v72, v66
    v_dot2_f32_bf16 v67, v161, v73, v67
    v_dot2_f32_bf16 v68, v162, v72, v68
    v_dot2_f32_bf16 v69, v162, v73, v69
    v_dot2_f32_bf16 v70, v163, v72, v70
    v_dot2_f32_bf16 v71, v163, v73, v71
    v_lshrrev_b32 v72, 16, v92
    v_and_b32 v73, 0xffff0000, v92
    v_dot2_f32_bf16 v64, v164, v72, v64
    v_dot2_f32_bf16 v65, v164, v73, v65
    v_dot2_f32_bf16 v66, v165, v72, v66
    v_dot2_f32_bf16 v67, v165, v73, v67
    v_dot2_f32_bf16 v68, v166, v72, v68
    v_dot2_f32_bf16 v69, v166, v73, v69
    v_dot2_f32_bf16 v70, v167, v72, v70
    v_dot2_f32_bf16 v71, v167, v73, v71
    v_and_b32 v72, 0xffff, v93
    v_lshlrev_b32 v73, 16, v93
    v_dot2_f32_bf16 v64, v168, v72, v64
    v_dot2_f32_bf16 v65, v168, v73, v65
    v_dot2_f32_bf16 v66, v169, v72, v66
    v_dot2_f32_bf16 v67, v169, v73, v67
    v_dot2_f32_bf16 v68, v170, v72, v68
    v_dot2_f32_bf16 v69, v170, v73, v69
    v_dot2_f32_bf16 v70, v171, v72, v70
    v_dot2_f32_bf16 v71, v171, v73, v71
    v_lshrrev_b32 v72, 16, v93
    v_and_b32 v73, 0xffff0000, v93
    v_dot2_f32_bf16 v64, v172, v72, v64
    v_dot2_f32_bf16 v65, v172, v73, v65
    v_dot2_f32_bf16 v66, v173, v72, v66
    v_dot2_f32_bf16 v67, v173, v73, v67
    v_dot2_f32_bf16 v68, v174, v72, v68
    v_dot2_f32_bf16 v69, v174, v73, v69
    v_dot2_f32_bf16 v70, v175, v72, v70
    v_dot2_f32_bf16 v71, v175, v73, v71
    v_and_b32 v72, 0xffff, v94
    v_lshlrev_b32 v73, 16, v94
    v_dot2_f32_bf16 v64, v176, v72, v64
    v_dot2_f32_bf16 v65, v176, v73, v65
    v_dot2_f32_bf16 v66, v177, v72, v66
    v_dot2_f32_bf16 v67, v177, v73, v67
    v_dot2_f32_bf16 v68, v178, v72, v68
    v_dot2_f32_bf16 v69, v178, v73, v69
    v_dot2_f32_bf16 v70, v179, v72, v70
    v_dot2_f32_bf16 v71, v179, v73, v71
    v_lshrrev_b32 v72, 16, v94
    v_and_b32 v73, 0xffff0000, v94
    v_dot2_f32_bf16 v64, v180, v72, v64
    v_dot2_f32_bf16 v65, v180, v73, v65
    v_dot2_f32_bf16 v66, v181, v72, v66
    v_dot2_f32_bf16 v67, v181, v73, v67
    v_dot2_f32_bf16 v68, v182, v72, v68
    v_dot2_f32_bf16 v69, v182, v73, v69
    v_dot2_f32_bf16 v70, v183, v72, v70
    v_dot2_f32_bf16 v71, v183, v73, v71
    v_and_b32 v72, 0xffff, v95
    v_lshlrev_b32 v73, 16, v95
    v_dot2_f32_bf16 v64, v184, v72, v64
    v_dot2_f32_bf16 v65, v184, v73, v65
    v_dot2_f32_bf16 v66, v185, v72, v66
    v_dot2_f32_bf16 v67, v185, v73, v67
    v_dot2_f32_bf16 v68, v186, v72, v68
    v_dot2_f32_bf16 v69, v186, v73, v69
    v_dot2_f32_bf16 v70, v187, v72, v70
    v_dot2_f32_bf16 v71, v187, v73, v71
    v_lshrrev_b32 v72, 16, v95
    v_and_b32 v73, 0xffff0000, v95
    v_dot2_f32_bf16 v64, v188, v72, v64
    v_dot2_f32_bf16 v65, v188, v73, v65
    v_dot2_f32_bf16 v66, v189, v72, v66
    v_dot2_f32_bf16 v67, v189, v73, v67
    v_dot2_f32_bf16 v68, v190, v72, v68
    v_dot2_f32_bf16 v69, v190, v73, v69
    v_dot2_f32_bf16 v70, v191, v72, v70
    v_dot2_f32_bf16 v71, v191, v73, v71
    v_and_b32 v76, 31, v2
    v_lshrrev_b32 v77, 5, v2
    v_lshl_add_u32 v76, v76, 1, v77
    v_permlane32_swap_b32 v64, v68
    v_permlane32_swap_b32 v65, v69
    v_permlane32_swap_b32 v66, v70
    v_permlane32_swap_b32 v67, v71
    v_lshlrev_b32 v76, 4, v76
    v_add_f32 v64, v64, v68
    v_add_f32 v65, v65, v69
    v_add_f32 v66, v66, v70
    v_add_f32 v67, v67, v71
    s_add_u32 s66, s72, 147456
    v_add_u32 v76, s66, v76
    ds_write_b128 v76, v[64:67]
    s_waitcnt vmcnt(2) lgkmcnt(0)
Q_hd:
    s_and_b32 s75, s74, 0x7ff
    s_sub_u32 s75, 2047, s75
    s_lshl_b32 s66, s6, 3
    s_lshl_b32 s67, s44, 1
    s_add_u32 s66, s66, s67
    s_lshl_b32 s66, s66, 15
    s_lshl_b32 s67, s45, 11
    s_add_u32 s66, s66, s67
    v_add_u32 v3, s66, v9
    v_add_u32 v4, 32768, v3
    s_lshr_b32 s63, s50, 6
    v_lshrrev_b32 v5, 4, v2
    v_bfe_u32 v6, v2, 2, 2
    v_lshl_add_u32 v8, v5, 2, v6
    v_bfe_u32 v6, v8, 1, 2
    v_lshlrev_b32 v8, 7, v8
    v_and_b32 v5, 3, v2
    v_lshl_add_u32 v8, v5, 3, v8
    s_lshl_b32 s66, s45, 16
    v_add_u32 v8, s66, v8
    v_xor_b32 v5, 0, v6
    v_lshl_add_u32 v10, v5, 5, v8
    v_xor_b32 v5, 1, v6
    v_lshl_add_u32 v11, v5, 5, v8
    v_xor_b32 v5, 2, v6
    v_lshl_add_u32 v12, v5, 5, v8
    v_xor_b32 v5, 3, v6
    v_lshl_add_u32 v13, v5, 5, v8
    s_lshr_b32 s66, s75, 7
    s_cmp_eq_u32 s66, s6
    s_cselect_b32 s51, 1, 0
    s_barrier
    s_add_u32 s66, s63, 0
    s_and_b32 s66, s66, 0x7fff
    buffer_load_dwordx4 v[96:99], v3, s[16:19], s66 offen offset:0 sc1
    buffer_load_dwordx4 v[100:103], v4, s[16:19], s66 offen offset:0 sc1
    buffer_load_dwordx4 v[104:107], v3, s[16:19], s66 offen offset:1024 sc1
    buffer_load_dwordx4 v[108:111], v4, s[16:19], s66 offen offset:1024 sc1
    s_cmp_eq_u32 s45, 0
    s_cbranch_scc1 Q_ny4
    s_lshl_b32 s66, s44, 8
    s_add_u32 s66, s66, 147456
    v_lshlrev_b32 v5, 2, v2
    v_add_u32 v6, s66, v5
    ds_read_b32 v64, v6 offset:0
    ds_read_b32 v65, v6 offset:1024
    ds_read_b32 v66, v6 offset:2048
    ds_read_b32 v67, v6 offset:3072
    s_waitcnt lgkmcnt(0)
    v_add_f32 v64, v64, v65
    v_add_f32 v66, v66, v67
    v_add_f32 v64, v64, v66
    buffer_store_dword v64, v5, s[16:19], s55 offen sc0 sc1
Q_ny4:
    v_sub_f32 v153, 1.0, v152
    v_cvt_pk_bf16_f32 v153, 0, v153
    v_lshlrev_b32 v16, 16, v144
    v_and_b32 v17, 0xffff0000, v144
    v_lshlrev_b32 v18, 16, v145
    v_and_b32 v19, 0xffff0000, v145
    v_lshlrev_b32 v20, 16, v146
    v_and_b32 v21, 0xffff0000, v146
    v_lshlrev_b32 v22, 16, v147
    v_and_b32 v23, 0xffff0000, v147
    v_lshlrev_b32 v24, 16, v148
    v_and_b32 v25, 0xffff0000, v148
    v_lshlrev_b32 v26, 16, v149
    v_and_b32 v27, 0xffff0000, v149
    v_lshlrev_b32 v28, 16, v150
    v_and_b32 v29, 0xffff0000, v150
    v_lshlrev_b32 v30, 16, v151
    v_and_b32 v31, 0xffff0000, v151
    v_mul_f32 v16, v16, v153
    v_mul_f32 v17, v17, v153
    v_mul_f32 v18, v18, v153
    v_mul_f32 v19, v19, v153
    v_mul_f32 v20, v20, v153
    v_mul_f32 v21, v21, v153
    v_mul_f32 v22, v22, v153
    v_mul_f32 v23, v23, v153
    v_mul_f32 v24, v24, v153
    v_mul_f32 v25, v25, v153
    v_mul_f32 v26, v26, v153
    v_mul_f32 v27, v27, v153
    v_mul_f32 v28, v28, v153
    v_mul_f32 v29, v29, v153
    v_mul_f32 v30, v30, v153
    v_mul_f32 v31, v31, v153
    v_cvt_pk_bf16_f32 v16, 0, v16
    v_cvt_pk_bf16_f32 v17, 0, v17
    v_cvt_pk_bf16_f32 v18, 0, v18
    v_cvt_pk_bf16_f32 v19, 0, v19
    v_cvt_pk_bf16_f32 v20, 0, v20
    v_cvt_pk_bf16_f32 v21, 0, v21
    v_cvt_pk_bf16_f32 v22, 0, v22
    v_cvt_pk_bf16_f32 v23, 0, v23
    v_cvt_pk_bf16_f32 v24, 0, v24
    v_cvt_pk_bf16_f32 v25, 0, v25
    v_cvt_pk_bf16_f32 v26, 0, v26
    v_cvt_pk_bf16_f32 v27, 0, v27
    v_cvt_pk_bf16_f32 v28, 0, v28
    v_cvt_pk_bf16_f32 v29, 0, v29
    v_cvt_pk_bf16_f32 v30, 0, v30
    v_cvt_pk_bf16_f32 v31, 0, v31
    s_add_u32 s66, s63, 4096
    s_and_b32 s66, s66, 0x7fff
    buffer_load_dwordx4 v[112:115], v3, s[16:19], s66 offen offset:0 sc1
    buffer_load_dwordx4 v[116:119], v4, s[16:19], s66 offen offset:0 sc1
    buffer_load_dwordx4 v[120:123], v3, s[16:19], s66 offen offset:1024 sc1
    buffer_load_dwordx4 v[124:127], v4, s[16:19], s66 offen offset:1024 sc1
    ds_read_b64_tr_b16 v[192:193], v10 offset:0
    ds_read_b64_tr_b16 v[194:195], v10 offset:2048
    ds_read_b64_tr_b16 v[196:197], v11 offset:0
    ds_read_b64_tr_b16 v[198:199], v11 offset:2048
    ds_read_b64_tr_b16 v[200:201], v12 offset:0
    ds_read_b64_tr_b16 v[202:203], v12 offset:2048
    ds_read_b64_tr_b16 v[204:205], v13 offset:0
    ds_read_b64_tr_b16 v[206:207], v13 offset:2048
    s_waitcnt vmcnt(4)
    v_max3_u32 v5, v96, v97, v98
    v_max3_u32 v5, v5, v99, v100
    v_max3_u32 v5, v5, v101, v102
    v_max3_u32 v5, v5, v103, v104
    v_max3_u32 v5, v5, v105, v106
    v_max3_u32 v5, v5, v107, v108
    v_max3_u32 v5, v5, v109, v110
    v_max_u32 v5, v5, v111
    v_cmp_eq_u32 vcc, -1, v5
    s_cbranch_vccnz Q_rt0
Q_go0:
    s_add_u32 s66, s63, 8192
    s_and_b32 s66, s66, 0x7fff
    s_waitcnt lgkmcnt(6)
    v_mfma_f32_16x16x32_bf16 v[224:227], v[192:195], v[96:99], 0
    buffer_load_dwordx4 v[128:131], v3, s[16:19], s66 offen offset:0 sc1
    v_mfma_f32_16x16x32_bf16 v[240:243], v[192:195], v[100:103], 0
    ds_read_b64_tr_b16 v[208:209], v10 offset:4096
    s_waitcnt lgkmcnt(5)
    v_mfma_f32_16x16x32_bf16 v[228:231], v[196:199], v[96:99], 0
    ds_read_b64_tr_b16 v[210:211], v10 offset:6144
    buffer_load_dwordx4 v[132:135], v4, s[16:19], s66 offen offset:0 sc1
    v_mfma_f32_16x16x32_bf16 v[244:247], v[196:199], v[100:103], 0
    ds_read_b64_tr_b16 v[212:213], v11 offset:4096
    s_waitcnt lgkmcnt(5)
    v_mfma_f32_16x16x32_bf16 v[232:235], v[200:203], v[96:99], 0
    ds_read_b64_tr_b16 v[214:215], v11 offset:6144
    buffer_load_dwordx4 v[136:139], v3, s[16:19], s66 offen offset:1024 sc1
    v_mfma_f32_16x16x32_bf16 v[248:251], v[200:203], v[100:103], 0
    ds_read_b64_tr_b16 v[216:217], v12 offset:4096
    s_waitcnt lgkmcnt(5)
    v_mfma_f32_16x16x32_bf16 v[236:239], v[204:207], v[96:99], 0
    ds_read_b64_tr_b16 v[218:219], v12 offset:6144
    buffer_load_dwordx4 v[140:143], v4, s[16:19], s66 offen offset:1024 sc1
    v_mfma_f32_16x16x32_bf16 v[252:255], v[204:207], v[100:103], 0
    ds_read_b64_tr_b16 v[220:221], v13 offset:4096
    ds_read_b64_tr_b16 v[222:223], v13 offset:6144
    s_waitcnt lgkmcnt(6)
    v_mfma_f32_16x16x32_bf16 v[224:227], v[208:211], v[104:107], v[224:227]
    v_mfma_f32_16x16x32_bf16 v[240:243], v[208:211], v[108:111], v[240:243]
    ds_read_b64_tr_b16 v[192:193], v10 offset:8192
    s_waitcnt lgkmcnt(5)
    v_mfma_f32_16x16x32_bf16 v[228:231], v[212:215], v[104:107], v[228:231]
    ds_read_b64_tr_b16 v[194:195], v10 offset:10240
    s_waitcnt vmcnt(4)
    v_max3_u32 v5, v112, v113, v114
    v_mfma_f32_16x16x32_bf16 v[244:247], v[212:215], v[108:111], v[244:247]
    ds_read_b64_tr_b16 v[196:197], v11 offset:8192
    v_max3_u32 v5, v5, v115, v116
    s_waitcnt lgkmcnt(5)
    v_mfma_f32_16x16x32_bf16 v[232:235], v[216:219], v[104:107], v[232:235]
    ds_read_b64_tr_b16 v[198:199], v11 offset:10240
    v_max3_u32 v5, v5, v117, v118
    v_mfma_f32_16x16x32_bf16 v[248:251], v[216:219], v[108:111], v[248:251]
    ds_read_b64_tr_b16 v[200:201], v12 offset:8192
    v_max3_u32 v5, v5, v119, v120
    v_max3_u32 v5, v5, v121, v122
    s_waitcnt lgkmcnt(5)
    v_mfma_f32_16x16x32_bf16 v[236:239], v[220:223], v[104:107], v[236:239]
    ds_read_b64_tr_b16 v[202:203], v12 offset:10240
    v_max3_u32 v5, v5, v123, v124
    v_max3_u32 v5, v5, v125, v126
    v_mfma_f32_16x16x32_bf16 v[252:255], v[220:223], v[108:111], v[252:255]
    ds_read_b64_tr_b16 v[204:205], v13 offset:8192
    ds_read_b64_tr_b16 v[206:207], v13 offset:10240
    v_max_u32 v5, v5, v127
    v_cmp_eq_u32 vcc, -1, v5
    s_cbranch_vccnz Q_rt1
Q_go1:
    s_add_u32 s66, s63, 12288
    s_and_b32 s66, s66, 0x7fff
    s_waitcnt lgkmcnt(6)
    v_mfma_f32_16x16x32_bf16 v[224:227], v[192:195], v[112:115], v[224:227]
    buffer_load_dwordx4 v[96:99], v3, s[16:19], s66 offen offset:0 sc1
    v_mfma_f32_16x16x32_bf16 v[240:243], v[192:195], v[116:119], v[240:243]
    ds_read_b64_tr_b16 v[208:209], v10 offset:12288
    s_waitcnt lgkmcnt(5)
    v_mfma_f32_16x16x32_bf16 v[228:231], v[196:199], v[112:115], v[228:231]
    ds_read_b64_tr_b16 v[210:211], v10 offset:14336
    buffer_load_dwordx4 v[100:103], v4, s[16:19], s66 offen offset:0 sc1
    v_mfma_f32_16x16x32_bf16 v[244:247], v[196:199], v[116:119], v[244:247]
    ds_read_b64_tr_b16 v[212:213], v11 offset:12288
    s_waitcnt lgkmcnt(5)
    v_mfma_f32_16x16x32_bf16 v[232:235], v[200:203], v[112:115], v[232:235]
    ds_read_b64_tr_b16 v[214:215], v11 offset:14336
    buffer_load_dwordx4 v[104:107], v3, s[16:19], s66 offen offset:1024 sc1
    v_mfma_f32_16x16x32_bf16 v[248:251], v[200:203], v[116:119], v[248:251]
    ds_read_b64_tr_b16 v[216:217], v12 offset:12288
    s_waitcnt lgkmcnt(5)
    v_mfma_f32_16x16x32_bf16 v[236:239], v[204:207], v[112:115], v[236:239]
    ds_read_b64_tr_b16 v[218:219], v12 offset:14336
    buffer_load_dwordx4 v[108:111], v4, s[16:19], s66 offen offset:1024 sc1
    v_mfma_f32_16x16x32_bf16 v[252:255], v[204:207], v[116:119], v[252:255]
    ds_read_b64_tr_b16 v[220:221], v13 offset:12288
    ds_read_b64_tr_b16 v[222:223], v13 offset:14336
    s_barrier
    s_waitcnt lgkmcnt(6)
    v_mfma_f32_16x16x32_bf16 v[224:227], v[208:211], v[120:123], v[224:227]
    v_mfma_f32_16x16x32_bf16 v[240:243], v[208:211], v[124:127], v[240:243]
    ds_read_b64_tr_b16 v[192:193], v10 offset:16384
    s_waitcnt lgkmcnt(5)
    v_mfma_f32_16x16x32_bf16 v[228:231], v[212:215], v[120:123], v[228:231]
    ds_read_b64_tr_b16 v[194:195], v10 offset:18432
    s_waitcnt vmcnt(4)
    v_max3_u32 v5, v128, v129, v130
    v_mfma_f32_16x16x32_bf16 v[244:247], v[212:215], v[124:127], v[244:247]
    ds_read_b64_tr_b16 v[196:197], v11 offset:16384
    v_max3_u32 v5, v5, v131, v132
    s_waitcnt lgkmcnt(5)
    v_mfma_f32_16x16x32_bf16 v[232:235], v[216:219], v[120:123], v[232:235]
    ds_read_b64_tr_b16 v[198:199], v11 offset:18432
    v_max3_u32 v5, v5, v133, v134
    v_mfma_f32_16x16x32_bf16 v[248:251], v[216:219], v[124:127], v[248:251]
    ds_read_b64_tr_b16 v[200:201], v12 offset:16384
    v_max3_u32 v5, v5, v135, v136
    v_max3_u32 v5, v5, v137, v138
    s_waitcnt lgkmcnt(5)
    v_mfma_f32_16x16x32_bf16 v[236:239], v[220:223], v[120:123], v[236:239]
    ds_read_b64_tr_b16 v[202:203], v12 offset:18432
    v_max3_u32 v5, v5, v139, v140
    v_max3_u32 v5, v5, v141, v142
    v_mfma_f32_16x16x32_bf16 v[252:255], v[220:223], v[124:127], v[252:255]
    ds_read_b64_tr_b16 v[204:205], v13 offset:16384
    ds_read_b64_tr_b16 v[206:207], v13 offset:18432
    v_max_u32 v5, v5, v143
    v_cmp_eq_u32 vcc, -1, v5
    s_cbranch_vccnz Q_rt2
Q_go2:
    s_add_u32 s66, s63, 16384
    s_and_b32 s66, s66, 0x7fff
    s_waitcnt lgkmcnt(6)
    v_mfma_f32_16x16x32_bf16 v[224:227], v[192:195], v[128:131], v[224:227]
    buffer_load_dwordx4 v[112:115], v3, s[16:19], s66 offen offset:0 sc1
    v_mfma_f32_16x16x32_bf16 v[240:243], v[192:195], v[132:135], v[240:243]
    ds_read_b64_tr_b16 v[208:209], v10 offset:20480
    s_waitcnt lgkmcnt(5)
    v_mfma_f32_16x16x32_bf16 v[228:231], v[196:199], v[128:131], v[228:231]
    ds_read_b64_tr_b16 v[210:211], v10 offset:22528
    buffer_load_dwordx4 v[116:119], v4, s[16:19], s66 offen offset:0 sc1
    v_mfma_f32_16x16x32_bf16 v[244:247], v[196:199], v[132:135], v[244:247]
    ds_read_b64_tr_b16 v[212:213], v11 offset:20480
    s_waitcnt lgkmcnt(5)
    v_mfma_f32_16x16x32_bf16 v[232:235], v[200:203], v[128:131], v[232:235]
    ds_read_b64_tr_b16 v[214:215], v11 offset:22528
    buffer_load_dwordx4 v[120:123], v3, s[16:19], s66 offen offset:1024 sc1
    v_mfma_f32_16x16x32_bf16 v[248:251], v[200:203], v[132:135], v[248:251]
    ds_read_b64_tr_b16 v[216:217], v12 offset:20480
    s_waitcnt lgkmcnt(5)
    v_mfma_f32_16x16x32_bf16 v[236:239], v[204:207], v[128:131], v[236:239]
    ds_read_b64_tr_b16 v[218:219], v12 offset:22528
    buffer_load_dwordx4 v[124:127], v4, s[16:19], s66 offen offset:1024 sc1
    v_mfma_f32_16x16x32_bf16 v[252:255], v[204:207], v[132:135], v[252:255]
    ds_read_b64_tr_b16 v[220:221], v13 offset:20480
    ds_read_b64_tr_b16 v[222:223], v13 offset:22528
    s_waitcnt lgkmcnt(6)
    v_mfma_f32_16x16x32_bf16 v[224:227], v[208:211], v[136:139], v[224:227]
    v_mfma_f32_16x16x32_bf16 v[240:243], v[208:211], v[140:143], v[240:243]
    ds_read_b64_tr_b16 v[192:193], v10 offset:24576
    s_waitcnt lgkmcnt(5)
    v_mfma_f32_16x16x32_bf16 v[228:231], v[212:215], v[136:139], v[228:231]
    ds_read_b64_tr_b16 v[194:195], v10 offset:26624
    s_waitcnt vmcnt(4)
    v_max3_u32 v5, v96, v97, v98
    v_mfma_f32_16x16x32_bf16 v[244:247], v[212:215], v[140:143], v[244:247]
    ds_read_b64_tr_b16 v[196:197], v11 offset:24576
    v_max3_u32 v5, v5, v99, v100
    s_waitcnt lgkmcnt(5)
    v_mfma_f32_16x16x32_bf16 v[232:235], v[216:219], v[136:139], v[232:235]
    ds_read_b64_tr_b16 v[198:199], v11 offset:26624
    v_max3_u32 v5, v5, v101, v102
    v_mfma_f32_16x16x32_bf16 v[248:251], v[216:219], v[140:143], v[248:251]
    ds_read_b64_tr_b16 v[200:201], v12 offset:24576
    v_max3_u32 v5, v5, v103, v104
    v_max3_u32 v5, v5, v105, v106
    s_waitcnt lgkmcnt(5)
    v_mfma_f32_16x16x32_bf16 v[236:239], v[220:223], v[136:139], v[236:239]
    ds_read_b64_tr_b16 v[202:203], v12 offset:26624
    v_max3_u32 v5, v5, v107, v108
    v_max3_u32 v5, v5, v109, v110
    v_mfma_f32_16x16x32_bf16 v[252:255], v[220:223], v[140:143], v[252:255]
    ds_read_b64_tr_b16 v[204:205], v13 offset:24576
    ds_read_b64_tr_b16 v[206:207], v13 offset:26624
    v_max_u32 v5, v5, v111
    v_cmp_eq_u32 vcc, -1, v5
    s_cbranch_vccnz Q_rt3
Q_go3:
    s_add_u32 s66, s63, 20480
    s_and_b32 s66, s66, 0x7fff
    s_waitcnt lgkmcnt(6)
    v_mfma_f32_16x16x32_bf16 v[224:227], v[192:195], v[96:99], v[224:227]
    buffer_load_dwordx4 v[128:131], v3, s[16:19], s66 offen offset:0 sc1
    v_mfma_f32_16x16x32_bf16 v[240:243], v[192:195], v[100:103], v[240:243]
    ds_read_b64_tr_b16 v[208:209], v10 offset:28672
    s_waitcnt lgkmcnt(5)
    v_mfma_f32_16x16x32_bf16 v[228:231], v[196:199], v[96:99], v[228:231]
    ds_read_b64_tr_b16 v[210:211], v10 offset:30720
    buffer_load_dwordx4 v[132:135], v4, s[16:19], s66 offen offset:0 sc1
    v_mfma_f32_16x16x32_bf16 v[244:247], v[196:199], v[100:103], v[244:247]
    ds_read_b64_tr_b16 v[212:213], v11 offset:28672
    s_waitcnt lgkmcnt(5)
    v_mfma_f32_16x16x32_bf16 v[232:235], v[200:203], v[96:99], v[232:235]
    ds_read_b64_tr_b16 v[214:215], v11 offset:30720
    buffer_load_dwordx4 v[136:139], v3, s[16:19], s66 offen offset:1024 sc1
    v_mfma_f32_16x16x32_bf16 v[248:251], v[200:203], v[100:103], v[248:251]
    ds_read_b64_tr_b16 v[216:217], v12 offset:28672
    s_waitcnt lgkmcnt(5)
    v_mfma_f32_16x16x32_bf16 v[236:239], v[204:207], v[96:99], v[236:239]
    ds_read_b64_tr_b16 v[218:219], v12 offset:30720
    buffer_load_dwordx4 v[140:143], v4, s[16:19], s66 offen offset:1024 sc1
    v_mfma_f32_16x16x32_bf16 v[252:255], v[204:207], v[100:103], v[252:255]
    ds_read_b64_tr_b16 v[220:221], v13 offset:28672
    ds_read_b64_tr_b16 v[222:223], v13 offset:30720
    s_waitcnt lgkmcnt(6)
    v_mfma_f32_16x16x32_bf16 v[224:227], v[208:211], v[104:107], v[224:227]
    v_mfma_f32_16x16x32_bf16 v[240:243], v[208:211], v[108:111], v[240:243]
    ds_read_b64_tr_b16 v[192:193], v10 offset:32768
    s_waitcnt lgkmcnt(5)
    v_mfma_f32_16x16x32_bf16 v[228:231], v[212:215], v[104:107], v[228:231]
    ds_read_b64_tr_b16 v[194:195], v10 offset:34816
    s_waitcnt vmcnt(4)
    v_max3_u32 v5, v112, v113, v114
    v_mfma_f32_16x16x32_bf16 v[244:247], v[212:215], v[108:111], v[244:247]
    ds_read_b64_tr_b16 v[196:197], v11 offset:32768
    v_max3_u32 v5, v5, v115, v116
    s_waitcnt lgkmcnt(5)
    v_mfma_f32_16x16x32_bf16 v[232:235], v[216:219], v[104:107], v[232:235]
    ds_read_b64_tr_b16 v[198:199], v11 offset:34816
    v_max3_u32 v5, v5, v117, v118
    v_mfma_f32_16x16x32_bf16 v[248:251], v[216:219], v[108:111], v[248:251]
    ds_read_b64_tr_b16 v[200:201], v12 offset:32768
    v_max3_u32 v5, v5, v119, v120
    v_max3_u32 v5, v5, v121, v122
    s_waitcnt lgkmcnt(5)
    v_mfma_f32_16x16x32_bf16 v[236:239], v[220:223], v[104:107], v[236:239]
    ds_read_b64_tr_b16 v[202:203], v12 offset:34816
    v_max3_u32 v5, v5, v123, v124
    v_max3_u32 v5, v5, v125, v126
    v_mfma_f32_16x16x32_bf16 v[252:255], v[220:223], v[108:111], v[252:255]
    ds_read_b64_tr_b16 v[204:205], v13 offset:32768
    ds_read_b64_tr_b16 v[206:207], v13 offset:34816
    v_max_u32 v5, v5, v127
    v_cmp_eq_u32 vcc, -1, v5
    s_cbranch_vccnz Q_rt4
Q_go4:
    s_cmp_eq_u32 s51, 0
    s_cbranch_scc1 Q_ny0
    s_lshl_b32 s64, s7, 14
    s_lshl_b32 s66, s3, 11
    s_add_u32 s64, s64, s66
    s_add_u32 s64, s64, 5832704
    buffer_load_dwordx4 v[32:35], v9, s[16:19], s64 offen offset:0 sc1
    buffer_load_dwordx4 v[36:39], v9, s[16:19], s64 offen offset:1024 sc1
Q_ny0:
    s_add_u32 s66, s63, 24576
    s_and_b32 s66, s66, 0x7fff
    s_waitcnt lgkmcnt(6)
    v_mfma_f32_16x16x32_bf16 v[224:227], v[192:195], v[112:115], v[224:227]
    buffer_load_dwordx4 v[96:99], v3, s[16:19], s66 offen offset:0 sc1
    v_mfma_f32_16x16x32_bf16 v[240:243], v[192:195], v[116:119], v[240:243]
    ds_read_b64_tr_b16 v[208:209], v10 offset:36864
    s_waitcnt lgkmcnt(5)
    v_mfma_f32_16x16x32_bf16 v[228:231], v[196:199], v[112:115], v[228:231]
    ds_read_b64_tr_b16 v[210:211], v10 offset:38912
    buffer_load_dwordx4 v[100:103], v4, s[16:19], s66 offen offset:0 sc1
    v_mfma_f32_16x16x32_bf16 v[244:247], v[196:199], v[116:119], v[244:247]
    ds_read_b64_tr_b16 v[212:213], v11 offset:36864
    s_waitcnt lgkmcnt(5)
    v_mfma_f32_16x16x32_bf16 v[232:235], v[200:203], v[112:115], v[232:235]
    ds_read_b64_tr_b16 v[214:215], v11 offset:38912
    buffer_load_dwordx4 v[104:107], v3, s[16:19], s66 offen offset:1024 sc1
    v_mfma_f32_16x16x32_bf16 v[248:251], v[200:203], v[116:119], v[248:251]
    ds_read_b64_tr_b16 v[216:217], v12 offset:36864
    s_waitcnt lgkmcnt(5)
    v_mfma_f32_16x16x32_bf16 v[236:239], v[204:207], v[112:115], v[236:239]
    ds_read_b64_tr_b16 v[218:219], v12 offset:38912
    buffer_load_dwordx4 v[108:111], v4, s[16:19], s66 offen offset:1024 sc1
    v_mfma_f32_16x16x32_bf16 v[252:255], v[204:207], v[116:119], v[252:255]
    ds_read_b64_tr_b16 v[220:221], v13 offset:36864
    ds_read_b64_tr_b16 v[222:223], v13 offset:38912
    s_waitcnt lgkmcnt(6)
    v_mfma_f32_16x16x32_bf16 v[224:227], v[208:211], v[120:123], v[224:227]
    v_mfma_f32_16x16x32_bf16 v[240:243], v[208:211], v[124:127], v[240:243]
    ds_read_b64_tr_b16 v[192:193], v10 offset:40960
    s_waitcnt lgkmcnt(5)
    v_mfma_f32_16x16x32_bf16 v[228:231], v[212:215], v[120:123], v[228:231]
    ds_read_b64_tr_b16 v[194:195], v10 offset:43008
    s_waitcnt vmcnt(4)
    v_max3_u32 v5, v128, v129, v130
    v_mfma_f32_16x16x32_bf16 v[244:247], v[212:215], v[124:127], v[244:247]
    ds_read_b64_tr_b16 v[196:197], v11 offset:40960
    v_max3_u32 v5, v5, v131, v132
    s_waitcnt lgkmcnt(5)
    v_mfma_f32_16x16x32_bf16 v[232:235], v[216:219], v[120:123], v[232:235]
    ds_read_b64_tr_b16 v[198:199], v11 offset:43008
    v_max3_u32 v5, v5, v133, v134
    v_mfma_f32_16x16x32_bf16 v[248:251], v[216:219], v[124:127], v[248:251]
    ds_read_b64_tr_b16 v[200:201], v12 offset:40960
    v_max3_u32 v5, v5, v135, v136
    v_max3_u32 v5, v5, v137, v138
    s_waitcnt lgkmcnt(5)
    v_mfma_f32_16x16x32_bf16 v[236:239], v[220:223], v[120:123], v[236:239]
    ds_read_b64_tr_b16 v[202:203], v12 offset:43008
    v_max3_u32 v5, v5, v139, v140
    v_max3_u32 v5, v5, v141, v142
    v_mfma_f32_16x16x32_bf16 v[252:255], v[220:223], v[124:127], v[252:255]
    ds_read_b64_tr_b16 v[204:205], v13 offset:40960
    ds_read_b64_tr_b16 v[206:207], v13 offset:43008
    v_max_u32 v5, v5, v143
    v_cmp_eq_u32 vcc, -1, v5
    s_cbranch_vccnz Q_rt5
Q_go5:
    s_add_u32 s66, s63, 28672
    s_and_b32 s66, s66, 0x7fff
    s_waitcnt lgkmcnt(6)
    v_mfma_f32_16x16x32_bf16 v[224:227], v[192:195], v[128:131], v[224:227]
    buffer_load_dwordx4 v[112:115], v3, s[16:19], s66 offen offset:0 sc1
    v_mfma_f32_16x16x32_bf16 v[240:243], v[192:195], v[132:135], v[240:243]
    ds_read_b64_tr_b16 v[208:209], v10 offset:45056
    s_waitcnt lgkmcnt(5)
    v_mfma_f32_16x16x32_bf16 v[228:231], v[196:199], v[128:131], v[228:231]
    ds_read_b64_tr_b16 v[210:211], v10 offset:47104
    buffer_load_dwordx4 v[116:119], v4, s[16:19], s66 offen offset:0 sc1
    v_mfma_f32_16x16x32_bf16 v[244:247], v[196:199], v[132:135], v[244:247]
    ds_read_b64_tr_b16 v[212:213], v11 offset:45056
    s_waitcnt lgkmcnt(5)
    v_mfma_f32_16x16x32_bf16 v[232:235], v[200:203], v[128:131], v[232:235]
    ds_read_b64_tr_b16 v[214:215], v11 offset:47104
    buffer_load_dwordx4 v[120:123], v3, s[16:19], s66 offen offset:1024 sc1
    v_mfma_f32_16x16x32_bf16 v[248:251], v[200:203], v[132:135], v[248:251]
    ds_read_b64_tr_b16 v[216:217], v12 offset:45056
    s_waitcnt lgkmcnt(5)
    v_mfma_f32_16x16x32_bf16 v[236:239], v[204:207], v[128:131], v[236:239]
    ds_read_b64_tr_b16 v[218:219], v12 offset:47104
    buffer_load_dwordx4 v[124:127], v4, s[16:19], s66 offen offset:1024 sc1
    v_mfma_f32_16x16x32_bf16 v[252:255], v[204:207], v[132:135], v[252:255]
    ds_read_b64_tr_b16 v[220:221], v13 offset:45056
    ds_read_b64_tr_b16 v[222:223], v13 offset:47104
    s_waitcnt lgkmcnt(6)
    v_mfma_f32_16x16x32_bf16 v[224:227], v[208:211], v[136:139], v[224:227]
    v_mfma_f32_16x16x32_bf16 v[240:243], v[208:211], v[140:143], v[240:243]
    ds_read_b64_tr_b16 v[192:193], v10 offset:49152
    s_waitcnt lgkmcnt(5)
    v_mfma_f32_16x16x32_bf16 v[228:231], v[212:215], v[136:139], v[228:231]
    ds_read_b64_tr_b16 v[194:195], v10 offset:51200
    s_waitcnt vmcnt(4)
    v_max3_u32 v5, v96, v97, v98
    v_mfma_f32_16x16x32_bf16 v[244:247], v[212:215], v[140:143], v[244:247]
    ds_read_b64_tr_b16 v[196:197], v11 offset:49152
    v_max3_u32 v5, v5, v99, v100
    s_waitcnt lgkmcnt(5)
    v_mfma_f32_16x16x32_bf16 v[232:235], v[216:219], v[136:139], v[232:235]
    ds_read_b64_tr_b16 v[198:199], v11 offset:51200
    v_max3_u32 v5, v5, v101, v102
    v_mfma_f32_16x16x32_bf16 v[248:251], v[216:219], v[140:143], v[248:251]
    ds_read_b64_tr_b16 v[200:201], v12 offset:49152
    v_max3_u32 v5, v5, v103, v104
    v_max3_u32 v5, v5, v105, v106
    s_waitcnt lgkmcnt(5)
    v_mfma_f32_16x16x32_bf16 v[236:239], v[220:223], v[136:139], v[236:239]
    ds_read_b64_tr_b16 v[202:203], v12 offset:51200
    v_max3_u32 v5, v5, v107, v108
    v_max3_u32 v5, v5, v109, v110
    v_mfma_f32_16x16x32_bf16 v[252:255], v[220:223], v[140:143], v[252:255]
    ds_read_b64_tr_b16 v[204:205], v13 offset:49152
    ds_read_b64_tr_b16 v[206:207], v13 offset:51200
    v_max_u32 v5, v5, v111
    v_cmp_eq_u32 vcc, -1, v5
    s_cbranch_vccnz Q_rt6
Q_go6:
    s_waitcnt lgkmcnt(6)
    v_mfma_f32_16x16x32_bf16 v[224:227], v[192:195], v[96:99], v[224:227]
    v_mfma_f32_16x16x32_bf16 v[240:243], v[192:195], v[100:103], v[240:243]
    ds_read_b64_tr_b16 v[208:209], v10 offset:53248
    s_waitcnt lgkmcnt(5)
    v_mfma_f32_16x16x32_bf16 v[228:231], v[196:199], v[96:99], v[228:231]
    ds_read_b64_tr_b16 v[210:211], v10 offset:55296
    v_mfma_f32_16x16x32_bf16 v[244:247], v[196:199], v[100:103], v[244:247]
    ds_read_b64_tr_b16 v[212:213], v11 offset:53248
    s_waitcnt lgkmcnt(5)
    v_mfma_f32_16x16x32_bf16 v[232:235], v[200:203], v[96:99], v[232:235]
    ds_read_b64_tr_b16 v[214:215], v11 offset:55296
    v_mfma_f32_16x16x32_bf16 v[248:251], v[200:203], v[100:103], v[248:251]
    ds_read_b64_tr_b16 v[216:217], v12 offset:53248
    s_waitcnt lgkmcnt(5)
    v_mfma_f32_16x16x32_bf16 v[236:239], v[204:207], v[96:99], v[236:239]
    ds_read_b64_tr_b16 v[218:219], v12 offset:55296
    v_mfma_f32_16x16x32_bf16 v[252:255], v[204:207], v[100:103], v[252:255]
    ds_read_b64_tr_b16 v[220:221], v13 offset:53248
    ds_read_b64_tr_b16 v[222:223], v13 offset:55296
    s_waitcnt lgkmcnt(6)
    v_mfma_f32_16x16x32_bf16 v[224:227], v[208:211], v[104:107], v[224:227]
    v_mfma_f32_16x16x32_bf16 v[240:243], v[208:211], v[108:111], v[240:243]
    ds_read_b64_tr_b16 v[192:193], v10 offset:57344
    s_waitcnt lgkmcnt(5)
    v_mfma_f32_16x16x32_bf16 v[228:231], v[212:215], v[104:107], v[228:231]
    ds_read_b64_tr_b16 v[194:195], v10 offset:59392
    s_waitcnt vmcnt(0)
    v_max3_u32 v5, v112, v113, v114
    v_mfma_f32_16x16x32_bf16 v[244:247], v[212:215], v[108:111], v[244:247]
    ds_read_b64_tr_b16 v[196:197], v11 offset:57344
    v_max3_u32 v5, v5, v115, v116
    s_waitcnt lgkmcnt(5)
    v_mfma_f32_16x16x32_bf16 v[232:235], v[216:219], v[104:107], v[232:235]
    ds_read_b64_tr_b16 v[198:199], v11 offset:59392
    v_max3_u32 v5, v5, v117, v118
    v_mfma_f32_16x16x32_bf16 v[248:251], v[216:219], v[108:111], v[248:251]
    ds_read_b64_tr_b16 v[200:201], v12 offset:57344
    v_max3_u32 v5, v5, v119, v120
    v_max3_u32 v5, v5, v121, v122
    s_waitcnt lgkmcnt(5)
    v_mfma_f32_16x16x32_bf16 v[236:239], v[220:223], v[104:107], v[236:239]
    ds_read_b64_tr_b16 v[202:203], v12 offset:59392
    v_max3_u32 v5, v5, v123, v124
    v_max3_u32 v5, v5, v125, v126
    v_mfma_f32_16x16x32_bf16 v[252:255], v[220:223], v[108:111], v[252:255]
    ds_read_b64_tr_b16 v[204:205], v13 offset:57344
    ds_read_b64_tr_b16 v[206:207], v13 offset:59392
    v_max_u32 v5, v5, v127
    v_cmp_eq_u32 vcc, -1, v5
    s_cbranch_vccnz Q_rt7
Q_go7:
    s_waitcnt lgkmcnt(6)
    v_mfma_f32_16x16x32_bf16 v[224:227], v[192:195], v[112:115], v[224:227]
    v_mfma_f32_16x16x32_bf16 v[240:243], v[192:195], v[116:119], v[240:243]
    ds_read_b64_tr_b16 v[208:209], v10 offset:61440
    s_waitcnt lgkmcnt(5)
    v_mfma_f32_16x16x32_bf16 v[228:231], v[196:199], v[112:115], v[228:231]
    ds_read_b64_tr_b16 v[210:211], v10 offset:63488
    v_mfma_f32_16x16x32_bf16 v[244:247], v[196:199], v[116:119], v[244:247]
    ds_read_b64_tr_b16 v[212:213], v11 offset:61440
    s_waitcnt lgkmcnt(5)
    v_mfma_f32_16x16x32_bf16 v[232:235], v[200:203], v[112:115], v[232:235]
    ds_read_b64_tr_b16 v[214:215], v11 offset:63488
    v_mfma_f32_16x16x32_bf16 v[248:251], v[200:203], v[116:119], v[248:251]
    ds_read_b64_tr_b16 v[216:217], v12 offset:61440
    s_waitcnt lgkmcnt(5)
    v_mfma_f32_16x16x32_bf16 v[236:239], v[204:207], v[112:115], v[236:239]
    ds_read_b64_tr_b16 v[218:219], v12 offset:63488
    v_mfma_f32_16x16x32_bf16 v[252:255], v[204:207], v[116:119], v[252:255]
    ds_read_b64_tr_b16 v[220:221], v13 offset:61440
    ds_read_b64_tr_b16 v[222:223], v13 offset:63488
    s_waitcnt lgkmcnt(6)
    v_mfma_f32_16x16x32_bf16 v[224:227], v[208:211], v[120:123], v[224:227]
    v_mfma_f32_16x16x32_bf16 v[240:243], v[208:211], v[124:127], v[240:243]
    s_waitcnt lgkmcnt(4)
    v_mfma_f32_16x16x32_bf16 v[228:231], v[212:215], v[120:123], v[228:231]
    v_mfma_f32_16x16x32_bf16 v[244:247], v[212:215], v[124:127], v[244:247]
    s_waitcnt lgkmcnt(2)
    v_mfma_f32_16x16x32_bf16 v[232:235], v[216:219], v[120:123], v[232:235]
    v_mfma_f32_16x16x32_bf16 v[248:251], v[216:219], v[124:127], v[248:251]
    s_waitcnt lgkmcnt(0)
    v_mfma_f32_16x16x32_bf16 v[236:239], v[220:223], v[120:123], v[236:239]
    v_mfma_f32_16x16x32_bf16 v[252:255], v[220:223], v[124:127], v[252:255]
    s_cmp_eq_u32 s51, 0
    s_cbranch_scc1 Q_ny1
    s_mov_b32 s59, 0
Q_ychk:
    s_waitcnt vmcnt(0)
    v_max3_u32 v5, v32, v33, v34
    v_max3_u32 v5, v5, v35, v36
    v_max3_u32 v5, v5, v37, v38
    v_max_u32 v5, v5, v39
    v_cmp_eq_u32 vcc, -1, v5
    s_cbranch_vccz Q_yok
    s_add_u32 s59, s59, 1
    s_cmp_ge_u32 s59, 200000
    s_cbranch_scc1 Q_yok
    s_sleep 4
    buffer_load_dwordx4 v[32:35], v9, s[16:19], s64 offen offset:0 sc1
    buffer_load_dwordx4 v[36:39], v9, s[16:19], s64 offen offset:1024 sc1
    s_branch Q_ychk
Q_yok:
    v_add_f32 v32, v32, v36
    v_add_f32 v33, v33, v37
    v_add_f32 v34, v34, v38
    v_add_f32 v35, v35, v39
    s_nop 1
    v_permlane16_swap_b32 v32, v34
    v_permlane16_swap_b32 v33, v35
    v_add_f32 v32, v32, v34
    v_add_f32 v33, v33, v35
    v_and_b32 v5, 15, v2
    v_lshlrev_b32 v5, 4, v5
    v_permlane32_swap_b32 v32, v33
    v_bfe_u32 v6, v2, 4, 1
    v_lshl_add_u32 v5, v6, 3, v5
    v_lshrrev_b32 v6, 5, v2
    v_lshl_add_u32 v5, v6, 2, v5
    v_add_f32 v32, v32, v33
    s_lshl_b32 s66, s3, 8
    s_add_u32 s66, s66, 156992
    v_add_u32 v5, s66, v5
    ds_write_b32 v5, v32
Q_ny1:
    s_lshl_b32 s66, s3, 12
    v_add_u32 v5, s66, v9
    s_xor_b32 s66, s66, 16384
    v_add_u32 v6, s66, v9
    s_waitcnt lgkmcnt(0)
    s_barrier
    s_cmp_eq_u32 s45, 0
    s_cbranch_scc1 Q_x0
    ds_write_b128 v5, v[224:227] offset:0
    ds_write_b128 v5, v[228:231] offset:1024
    ds_write_b128 v5, v[232:235] offset:2048
    ds_write_b128 v5, v[236:239] offset:3072
    v_mov_b32 v224, v240
    v_mov_b32 v225, v241
    v_mov_b32 v226, v242
    v_mov_b32 v227, v243
    v_mov_b32 v228, v244
    v_mov_b32 v229, v245
    v_mov_b32 v230, v246
    v_mov_b32 v231, v247
    v_mov_b32 v232, v248
    v_mov_b32 v233, v249
    v_mov_b32 v234, v250
    v_mov_b32 v235, v251
    v_mov_b32 v236, v252
    v_mov_b32 v237, v253
    v_mov_b32 v238, v254
    v_mov_b32 v239, v255
    s_branch Q_x1
Q_x0:
    ds_write_b128 v5, v[240:243] offset:0
    ds_write_b128 v5, v[244:247] offset:1024
    ds_write_b128 v5, v[248:251] offset:2048
    ds_write_b128 v5, v[252:255] offset:3072
Q_x1:
    s_cmp_eq_u32 s51, 0
    s_cbranch_scc1 Q_ny2
    s_cmp_lg_u32 s3, 0
    s_cbranch_scc1 Q_ny2
    v_lshlrev_b32 v8, 2, v2
    v_add_u32 v8, 156992, v8
    ds_read_b32 v32, v8 offset:0
    ds_read_b32 v33, v8 offset:256
    ds_read_b32 v34, v8 offset:512
    ds_read_b32 v35, v8 offset:768
    ds_read_b32 v36, v8 offset:1024
    ds_read_b32 v37, v8 offset:1280
    ds_read_b32 v38, v8 offset:1536
    ds_read_b32 v39, v8 offset:1792
    s_and_b32 s66, s74, 0xffff0000
    s_xor_b32 s67, s66, 0x80000000
    s_not_b32 s68, s66
    s_and_b32 s68, s68, 0xffff0000
    s_cmp_ge_u32 s66, 0x80000000
    s_cselect_b32 s66, s67, s68
    v_mov_b32 v40, s66
    v_mul_f32 v40, s46, v40
    v_exp_f32 v40, -v40
    s_nop 0
    v_add_f32 v40, 1.0, v40
    v_rcp_f32 v40, v40
    s_nop 0
    v_cvt_pk_bf16_f32 v40, 0, v40
    s_waitcnt lgkmcnt(0)
    v_add_f32 v32, v32, v33
    v_add_f32 v32, v32, v34
    v_add_f32 v32, v32, v35
    v_add_f32 v32, v32, v36
    v_add_f32 v32, v32, v37
    v_add_f32 v32, v32, v38
    v_add_f32 v32, v32, v39
    v_cvt_pk_bf16_f32 v32, 0, v32
    v_mul_f32 v32, v32, v40
    v_cvt_pk_bf16_f32 v32, 0, v32
    ds_write_b32 v8, v32 offset:2048
Q_ny2:
    s_waitcnt lgkmcnt(0)
    s_barrier
    ds_read_b128 v[240:243], v6 offset:0
    ds_read_b128 v[244:247], v6 offset:1024
    ds_read_b128 v[248:251], v6 offset:2048
    ds_read_b128 v[252:255], v6 offset:3072
    v_cmp_eq_u32 vcc, s75, v157
    s_and_saveexec_b64 s[68:69], vcc
    s_cbranch_execz Q_nr
    v_bfe_u32 v8, v2, 4, 1
    v_lshlrev_b32 v8, 6, v8
    v_lshrrev_b32 v5, 5, v2
    v_lshl_add_u32 v8, v5, 5, v8
    v_add_u32 v8, 159040, v8
    ds_read_b128 v[40:43], v8 offset:0
    ds_read_b128 v[44:47], v8 offset:16
    ds_read_b128 v[48:51], v8 offset:128
    ds_read_b128 v[52:55], v8 offset:144
    s_waitcnt lgkmcnt(0)
    v_lshlrev_b32 v16, 16, v144
    v_and_b32 v17, 0xffff0000, v144
    v_lshlrev_b32 v18, 16, v145
    v_and_b32 v19, 0xffff0000, v145
    v_lshlrev_b32 v20, 16, v146
    v_and_b32 v21, 0xffff0000, v146
    v_lshlrev_b32 v22, 16, v147
    v_and_b32 v23, 0xffff0000, v147
    v_lshlrev_b32 v24, 16, v148
    v_and_b32 v25, 0xffff0000, v148
    v_lshlrev_b32 v26, 16, v149
    v_and_b32 v27, 0xffff0000, v149
    v_lshlrev_b32 v28, 16, v150
    v_and_b32 v29, 0xffff0000, v150
    v_lshlrev_b32 v30, 16, v151
    v_and_b32 v31, 0xffff0000, v151
    v_add_f32 v16, v16, v40
    v_cvt_pk_bf16_f32 v16, 0, v16
    v_mul_f32 v16, v16, v153
    v_cvt_pk_bf16_f32 v16, 0, v16
    v_add_f32 v17, v17, v41
    v_cvt_pk_bf16_f32 v17, 0, v17
    v_mul_f32 v17, v17, v153
    v_cvt_pk_bf16_f32 v17, 0, v17
    v_add_f32 v18, v18, v42
    v_cvt_pk_bf16_f32 v18, 0, v18
    v_mul_f32 v18, v18, v153
    v_cvt_pk_bf16_f32 v18, 0, v18
    v_add_f32 v19, v19, v43
    v_cvt_pk_bf16_f32 v19, 0, v19
    v_mul_f32 v19, v19, v153
    v_cvt_pk_bf16_f32 v19, 0, v19
    v_add_f32 v20, v20, v44
    v_cvt_pk_bf16_f32 v20, 0, v20
    v_mul_f32 v20, v20, v153
    v_cvt_pk_bf16_f32 v20, 0, v20
    v_add_f32 v21, v21, v45
    v_cvt_pk_bf16_f32 v21, 0, v21
    v_mul_f32 v21, v21, v153
    v_cvt_pk_bf16_f32 v21, 0, v21
    v_add_f32 v22, v22, v46
    v_cvt_pk_bf16_f32 v22, 0, v22
    v_mul_f32 v22, v22, v153
    v_cvt_pk_bf16_f32 v22, 0, v22
    v_add_f32 v23, v23, v47
    v_cvt_pk_bf16_f32 v23, 0, v23
    v_mul_f32 v23, v23, v153
    v_cvt_pk_bf16_f32 v23, 0, v23
    v_add_f32 v24, v24, v48
    v_cvt_pk_bf16_f32 v24, 0, v24
    v_mul_f32 v24, v24, v153
    v_cvt_pk_bf16_f32 v24, 0, v24
    v_add_f32 v25, v25, v49
    v_cvt_pk_bf16_f32 v25, 0, v25
    v_mul_f32 v25, v25, v153
    v_cvt_pk_bf16_f32 v25, 0, v25
    v_add_f32 v26, v26, v50
    v_cvt_pk_bf16_f32 v26, 0, v26
    v_mul_f32 v26, v26, v153
    v_cvt_pk_bf16_f32 v26, 0, v26
    v_add_f32 v27, v27, v51
    v_cvt_pk_bf16_f32 v27, 0, v27
    v_mul_f32 v27, v27, v153
    v_cvt_pk_bf16_f32 v27, 0, v27
    v_add_f32 v28, v28, v52
    v_cvt_pk_bf16_f32 v28, 0, v28
    v_mul_f32 v28, v28, v153
    v_cvt_pk_bf16_f32 v28, 0, v28
    v_add_f32 v29, v29, v53
    v_cvt_pk_bf16_f32 v29, 0, v29
    v_mul_f32 v29, v29, v153
    v_cvt_pk_bf16_f32 v29, 0, v29
    v_add_f32 v30, v30, v54
    v_cvt_pk_bf16_f32 v30, 0, v30
    v_mul_f32 v30, v30, v153
    v_cvt_pk_bf16_f32 v30, 0, v30
    v_add_f32 v31, v31, v55
    v_cvt_pk_bf16_f32 v31, 0, v31
    v_mul_f32 v31, v31, v153
    v_cvt_pk_bf16_f32 v31, 0, v31
Q_nr:
    s_mov_b64 exec, s[68:69]
    v_mov_b32 v154, v152
    v_mov_b32 v155, v152
    s_waitcnt lgkmcnt(3)
    v_pk_add_f32 v[224:225], v[224:225], v[240:241]
    v_pk_add_f32 v[226:227], v[226:227], v[242:243]
    v_cvt_pk_bf16_f32 v40, v224, v225
    v_cvt_pk_bf16_f32 v41, v226, v227
    s_waitcnt lgkmcnt(2)
    v_pk_add_f32 v[228:229], v[228:229], v[244:245]
    v_pk_add_f32 v[230:231], v[230:231], v[246:247]
    v_cvt_pk_bf16_f32 v42, v228, v229
    v_cvt_pk_bf16_f32 v43, v230, v231
    s_waitcnt lgkmcnt(1)
    v_pk_add_f32 v[232:233], v[232:233], v[248:249]
    v_pk_add_f32 v[234:235], v[234:235], v[250:251]
    v_cvt_pk_bf16_f32 v44, v232, v233
    v_cvt_pk_bf16_f32 v45, v234, v235
    s_waitcnt lgkmcnt(0)
    v_pk_add_f32 v[236:237], v[236:237], v[252:253]
    v_pk_add_f32 v[238:239], v[238:239], v[254:255]
    v_cvt_pk_bf16_f32 v46, v236, v237
    v_cvt_pk_bf16_f32 v47, v238, v239
    s_nop 0
    v_permlane16_swap_b32 v40, v42
    v_permlane16_swap_b32 v41, v43
    v_permlane16_swap_b32 v44, v46
    v_permlane16_swap_b32 v45, v47
    v_lshlrev_b32 v224, 16, v40
    v_and_b32 v225, 0xffff0000, v40
    v_lshlrev_b32 v226, 16, v41
    v_and_b32 v227, 0xffff0000, v41
    v_lshlrev_b32 v228, 16, v42
    v_and_b32 v229, 0xffff0000, v42
    v_lshlrev_b32 v230, 16, v43
    v_and_b32 v231, 0xffff0000, v43
    v_pk_mul_f32 v[224:225], v[224:225], v[154:155]
    v_pk_mul_f32 v[226:227], v[226:227], v[154:155]
    v_pk_mul_f32 v[228:229], v[228:229], v[154:155]
    v_pk_mul_f32 v[230:231], v[230:231], v[154:155]
    v_cvt_pk_bf16_f32 v224, 0, v224
    v_cvt_pk_bf16_f32 v225, 0, v225
    v_cvt_pk_bf16_f32 v226, 0, v226
    v_cvt_pk_bf16_f32 v227, 0, v227
    v_cvt_pk_bf16_f32 v228, 0, v228
    v_cvt_pk_bf16_f32 v229, 0, v229
    v_cvt_pk_bf16_f32 v230, 0, v230
    v_cvt_pk_bf16_f32 v231, 0, v231
    v_pk_add_f32 v[224:225], v[224:225], v[16:17]
    v_pk_add_f32 v[226:227], v[226:227], v[18:19]
    v_pk_add_f32 v[228:229], v[228:229], v[20:21]
    v_pk_add_f32 v[230:231], v[230:231], v[22:23]
    v_cvt_pk_bf16_f32 v48, v224, v225
    v_cvt_pk_bf16_f32 v49, v226, v227
    v_cvt_pk_bf16_f32 v50, v228, v229
    v_cvt_pk_bf16_f32 v51, v230, v231
    buffer_store_dwordx4 v[48:51], v156, s[36:39], 0 offen offset:0 nt
    v_lshlrev_b32 v232, 16, v44
    v_and_b32 v233, 0xffff0000, v44
    v_lshlrev_b32 v234, 16, v45
    v_and_b32 v235, 0xffff0000, v45
    v_lshlrev_b32 v236, 16, v46
    v_and_b32 v237, 0xffff0000, v46
    v_lshlrev_b32 v238, 16, v47
    v_and_b32 v239, 0xffff0000, v47
    v_pk_mul_f32 v[232:233], v[232:233], v[154:155]
    v_pk_mul_f32 v[234:235], v[234:235], v[154:155]
    v_pk_mul_f32 v[236:237], v[236:237], v[154:155]
    v_pk_mul_f32 v[238:239], v[238:239], v[154:155]
    v_cvt_pk_bf16_f32 v232, 0, v232
    v_cvt_pk_bf16_f32 v233, 0, v233
    v_cvt_pk_bf16_f32 v234, 0, v234
    v_cvt_pk_bf16_f32 v235, 0, v235
    v_cvt_pk_bf16_f32 v236, 0, v236
    v_cvt_pk_bf16_f32 v237, 0, v237
    v_cvt_pk_bf16_f32 v238, 0, v238
    v_cvt_pk_bf16_f32 v239, 0, v239
    v_pk_add_f32 v[232:233], v[232:233], v[24:25]
    v_pk_add_f32 v[234:235], v[234:235], v[26:27]
    v_pk_add_f32 v[236:237], v[236:237], v[28:29]
    v_pk_add_f32 v[238:239], v[238:239], v[30:31]
    v_cvt_pk_bf16_f32 v52, v232, v233
    v_cvt_pk_bf16_f32 v53, v234, v235
    v_cvt_pk_bf16_f32 v54, v236, v237
    v_cvt_pk_bf16_f32 v55, v238, v239
    buffer_store_dwordx4 v[52:55], v156, s[36:39], 0 offen offset:64 nt
END:
    s_endpgm
Q_rt0:
    s_mov_b32 s59, 0
    s_add_u32 s67, s63, 0
    s_and_b32 s67, s67, 0x7fff
Q_rl0:
    s_waitcnt vmcnt(0)
    s_add_u32 s59, s59, 1
    s_cmp_ge_u32 s59, 200000
    s_cbranch_scc1 Q_rd0
    s_sleep 1
    buffer_load_dwordx4 v[96:99], v3, s[16:19], s67 offen offset:0 sc1
    buffer_load_dwordx4 v[100:103], v4, s[16:19], s67 offen offset:0 sc1
    buffer_load_dwordx4 v[104:107], v3, s[16:19], s67 offen offset:1024 sc1
    buffer_load_dwordx4 v[108:111], v4, s[16:19], s67 offen offset:1024 sc1
    s_waitcnt vmcnt(0)
    v_max3_u32 v5, v96, v97, v98
    v_max3_u32 v5, v5, v99, v100
    v_max3_u32 v5, v5, v101, v102
    v_max3_u32 v5, v5, v103, v104
    v_max3_u32 v5, v5, v105, v106
    v_max3_u32 v5, v5, v107, v108
    v_max3_u32 v5, v5, v109, v110
    v_max_u32 v5, v5, v111
    v_cmp_eq_u32 vcc, -1, v5
    s_cbranch_vccnz Q_rl0
Q_rd0:
    s_add_u32 s67, s63, 4096
    s_and_b32 s67, s67, 0x7fff
    buffer_load_dwordx4 v[112:115], v3, s[16:19], s67 offen offset:0 sc1
    buffer_load_dwordx4 v[116:119], v4, s[16:19], s67 offen offset:0 sc1
    buffer_load_dwordx4 v[120:123], v3, s[16:19], s67 offen offset:1024 sc1
    buffer_load_dwordx4 v[124:127], v4, s[16:19], s67 offen offset:1024 sc1
    s_branch Q_go0
Q_rt1:
    s_mov_b32 s59, 0
    s_add_u32 s67, s63, 4096
    s_and_b32 s67, s67, 0x7fff
Q_rl1:
    s_waitcnt vmcnt(0)
    s_add_u32 s59, s59, 1
    s_cmp_ge_u32 s59, 200000
    s_cbranch_scc1 Q_rd1
    s_sleep 1
    buffer_load_dwordx4 v[112:115], v3, s[16:19], s67 offen offset:0 sc1
    buffer_load_dwordx4 v[116:119], v4, s[16:19], s67 offen offset:0 sc1
    buffer_load_dwordx4 v[120:123], v3, s[16:19], s67 offen offset:1024 sc1
    buffer_load_dwordx4 v[124:127], v4, s[16:19], s67 offen offset:1024 sc1
    s_waitcnt vmcnt(0)
    v_max3_u32 v5, v112, v113, v114
    v_max3_u32 v5, v5, v115, v116
    v_max3_u32 v5, v5, v117, v118
    v_max3_u32 v5, v5, v119, v120
    v_max3_u32 v5, v5, v121, v122
    v_max3_u32 v5, v5, v123, v124
    v_max3_u32 v5, v5, v125, v126
    v_max_u32 v5, v5, v127
    v_cmp_eq_u32 vcc, -1, v5
    s_cbranch_vccnz Q_rl1
Q_rd1:
    s_add_u32 s67, s63, 8192
    s_and_b32 s67, s67, 0x7fff
    buffer_load_dwordx4 v[128:131], v3, s[16:19], s67 offen offset:0 sc1
    buffer_load_dwordx4 v[132:135], v4, s[16:19], s67 offen offset:0 sc1
    buffer_load_dwordx4 v[136:139], v3, s[16:19], s67 offen offset:1024 sc1
    buffer_load_dwordx4 v[140:143], v4, s[16:19], s67 offen offset:1024 sc1
    s_branch Q_go1
Q_rt2:
    s_mov_b32 s59, 0
    s_add_u32 s67, s63, 8192
    s_and_b32 s67, s67, 0x7fff
Q_rl2:
    s_waitcnt vmcnt(0)
    s_add_u32 s59, s59, 1
    s_cmp_ge_u32 s59, 200000
    s_cbranch_scc1 Q_rd2
    s_sleep 1
    buffer_load_dwordx4 v[128:131], v3, s[16:19], s67 offen offset:0 sc1
    buffer_load_dwordx4 v[132:135], v4, s[16:19], s67 offen offset:0 sc1
    buffer_load_dwordx4 v[136:139], v3, s[16:19], s67 offen offset:1024 sc1
    buffer_load_dwordx4 v[140:143], v4, s[16:19], s67 offen offset:1024 sc1
    s_waitcnt vmcnt(0)
    v_max3_u32 v5, v128, v129, v130
    v_max3_u32 v5, v5, v131, v132
    v_max3_u32 v5, v5, v133, v134
    v_max3_u32 v5, v5, v135, v136
    v_max3_u32 v5, v5, v137, v138
    v_max3_u32 v5, v5, v139, v140
    v_max3_u32 v5, v5, v141, v142
    v_max_u32 v5, v5, v143
    v_cmp_eq_u32 vcc, -1, v5
    s_cbranch_vccnz Q_rl2
Q_rd2:
    s_add_u32 s67, s63, 12288
    s_and_b32 s67, s67, 0x7fff
    buffer_load_dwordx4 v[96:99], v3, s[16:19], s67 offen offset:0 sc1
    buffer_load_dwordx4 v[100:103], v4, s[16:19], s67 offen offset:0 sc1
    buffer_load_dwordx4 v[104:107], v3, s[16:19], s67 offen offset:1024 sc1
    buffer_load_dwordx4 v[108:111], v4, s[16:19], s67 offen offset:1024 sc1
    s_branch Q_go2
Q_rt3:
    s_mov_b32 s59, 0
    s_add_u32 s67, s63, 12288
    s_and_b32 s67, s67, 0x7fff
Q_rl3:
    s_waitcnt vmcnt(0)
    s_add_u32 s59, s59, 1
    s_cmp_ge_u32 s59, 200000
    s_cbranch_scc1 Q_rd3
    s_sleep 1
    buffer_load_dwordx4 v[96:99], v3, s[16:19], s67 offen offset:0 sc1
    buffer_load_dwordx4 v[100:103], v4, s[16:19], s67 offen offset:0 sc1
    buffer_load_dwordx4 v[104:107], v3, s[16:19], s67 offen offset:1024 sc1
    buffer_load_dwordx4 v[108:111], v4, s[16:19], s67 offen offset:1024 sc1
    s_waitcnt vmcnt(0)
    v_max3_u32 v5, v96, v97, v98
    v_max3_u32 v5, v5, v99, v100
    v_max3_u32 v5, v5, v101, v102
    v_max3_u32 v5, v5, v103, v104
    v_max3_u32 v5, v5, v105, v106
    v_max3_u32 v5, v5, v107, v108
    v_max3_u32 v5, v5, v109, v110
    v_max_u32 v5, v5, v111
    v_cmp_eq_u32 vcc, -1, v5
    s_cbranch_vccnz Q_rl3
Q_rd3:
    s_add_u32 s67, s63, 16384
    s_and_b32 s67, s67, 0x7fff
    buffer_load_dwordx4 v[112:115], v3, s[16:19], s67 offen offset:0 sc1
    buffer_load_dwordx4 v[116:119], v4, s[16:19], s67 offen offset:0 sc1
    buffer_load_dwordx4 v[120:123], v3, s[16:19], s67 offen offset:1024 sc1
    buffer_load_dwordx4 v[124:127], v4, s[16:19], s67 offen offset:1024 sc1
    s_branch Q_go3
Q_rt4:
    s_mov_b32 s59, 0
    s_add_u32 s67, s63, 16384
    s_and_b32 s67, s67, 0x7fff
Q_rl4:
    s_waitcnt vmcnt(0)
    s_add_u32 s59, s59, 1
    s_cmp_ge_u32 s59, 200000
    s_cbranch_scc1 Q_rd4
    s_sleep 1
    buffer_load_dwordx4 v[112:115], v3, s[16:19], s67 offen offset:0 sc1
    buffer_load_dwordx4 v[116:119], v4, s[16:19], s67 offen offset:0 sc1
    buffer_load_dwordx4 v[120:123], v3, s[16:19], s67 offen offset:1024 sc1
    buffer_load_dwordx4 v[124:127], v4, s[16:19], s67 offen offset:1024 sc1
    s_waitcnt vmcnt(0)
    v_max3_u32 v5, v112, v113, v114
    v_max3_u32 v5, v5, v115, v116
    v_max3_u32 v5, v5, v117, v118
    v_max3_u32 v5, v5, v119, v120
    v_max3_u32 v5, v5, v121, v122
    v_max3_u32 v5, v5, v123, v124
    v_max3_u32 v5, v5, v125, v126
    v_max_u32 v5, v5, v127
    v_cmp_eq_u32 vcc, -1, v5
    s_cbranch_vccnz Q_rl4
Q_rd4:
    s_add_u32 s67, s63, 20480
    s_and_b32 s67, s67, 0x7fff
    buffer_load_dwordx4 v[128:131], v3, s[16:19], s67 offen offset:0 sc1
    buffer_load_dwordx4 v[132:135], v4, s[16:19], s67 offen offset:0 sc1
    buffer_load_dwordx4 v[136:139], v3, s[16:19], s67 offen offset:1024 sc1
    buffer_load_dwordx4 v[140:143], v4, s[16:19], s67 offen offset:1024 sc1
    s_branch Q_go4
Q_rt5:
    s_mov_b32 s59, 0
    s_add_u32 s67, s63, 20480
    s_and_b32 s67, s67, 0x7fff
Q_rl5:
    s_waitcnt vmcnt(0)
    s_add_u32 s59, s59, 1
    s_cmp_ge_u32 s59, 200000
    s_cbranch_scc1 Q_rd5
    s_sleep 1
    buffer_load_dwordx4 v[128:131], v3, s[16:19], s67 offen offset:0 sc1
    buffer_load_dwordx4 v[132:135], v4, s[16:19], s67 offen offset:0 sc1
    buffer_load_dwordx4 v[136:139], v3, s[16:19], s67 offen offset:1024 sc1
    buffer_load_dwordx4 v[140:143], v4, s[16:19], s67 offen offset:1024 sc1
    s_waitcnt vmcnt(0)
    v_max3_u32 v5, v128, v129, v130
    v_max3_u32 v5, v5, v131, v132
    v_max3_u32 v5, v5, v133, v134
    v_max3_u32 v5, v5, v135, v136
    v_max3_u32 v5, v5, v137, v138
    v_max3_u32 v5, v5, v139, v140
    v_max3_u32 v5, v5, v141, v142
    v_max_u32 v5, v5, v143
    v_cmp_eq_u32 vcc, -1, v5
    s_cbranch_vccnz Q_rl5
Q_rd5:
    s_add_u32 s67, s63, 24576
    s_and_b32 s67, s67, 0x7fff
    buffer_load_dwordx4 v[96:99], v3, s[16:19], s67 offen offset:0 sc1
    buffer_load_dwordx4 v[100:103], v4, s[16:19], s67 offen offset:0 sc1
    buffer_load_dwordx4 v[104:107], v3, s[16:19], s67 offen offset:1024 sc1
    buffer_load_dwordx4 v[108:111], v4, s[16:19], s67 offen offset:1024 sc1
    s_branch Q_go5
Q_rt6:
    s_mov_b32 s59, 0
    s_add_u32 s67, s63, 24576
    s_and_b32 s67, s67, 0x7fff
Q_rl6:
    s_waitcnt vmcnt(0)
    s_add_u32 s59, s59, 1
    s_cmp_ge_u32 s59, 200000
    s_cbranch_scc1 Q_rd6
    s_sleep 1
    buffer_load_dwordx4 v[96:99], v3, s[16:19], s67 offen offset:0 sc1
    buffer_load_dwordx4 v[100:103], v4, s[16:19], s67 offen offset:0 sc1
    buffer_load_dwordx4 v[104:107], v3, s[16:19], s67 offen offset:1024 sc1
    buffer_load_dwordx4 v[108:111], v4, s[16:19], s67 offen offset:1024 sc1
    s_waitcnt vmcnt(0)
    v_max3_u32 v5, v96, v97, v98
    v_max3_u32 v5, v5, v99, v100
    v_max3_u32 v5, v5, v101, v102
    v_max3_u32 v5, v5, v103, v104
    v_max3_u32 v5, v5, v105, v106
    v_max3_u32 v5, v5, v107, v108
    v_max3_u32 v5, v5, v109, v110
    v_max_u32 v5, v5, v111
    v_cmp_eq_u32 vcc, -1, v5
    s_cbranch_vccnz Q_rl6
Q_rd6:
    s_add_u32 s67, s63, 28672
    s_and_b32 s67, s67, 0x7fff
    buffer_load_dwordx4 v[112:115], v3, s[16:19], s67 offen offset:0 sc1
    buffer_load_dwordx4 v[116:119], v4, s[16:19], s67 offen offset:0 sc1
    buffer_load_dwordx4 v[120:123], v3, s[16:19], s67 offen offset:1024 sc1
    buffer_load_dwordx4 v[124:127], v4, s[16:19], s67 offen offset:1024 sc1
    s_branch Q_go6
Q_rt7:
    s_mov_b32 s59, 0
    s_add_u32 s67, s63, 28672
    s_and_b32 s67, s67, 0x7fff
Q_rl7:
    s_waitcnt vmcnt(0)
    s_add_u32 s59, s59, 1
    s_cmp_ge_u32 s59, 200000
    s_cbranch_scc1 Q_rd7
    s_sleep 1
    buffer_load_dwordx4 v[112:115], v3, s[16:19], s67 offen offset:0 sc1
    buffer_load_dwordx4 v[116:119], v4, s[16:19], s67 offen offset:0 sc1
    buffer_load_dwordx4 v[120:123], v3, s[16:19], s67 offen offset:1024 sc1
    buffer_load_dwordx4 v[124:127], v4, s[16:19], s67 offen offset:1024 sc1
    s_waitcnt vmcnt(0)
    v_max3_u32 v5, v112, v113, v114
    v_max3_u32 v5, v5, v115, v116
    v_max3_u32 v5, v5, v117, v118
    v_max3_u32 v5, v5, v119, v120
    v_max3_u32 v5, v5, v121, v122
    v_max3_u32 v5, v5, v123, v124
    v_max3_u32 v5, v5, v125, v126
    v_max_u32 v5, v5, v127
    v_cmp_eq_u32 vcc, -1, v5
    s_cbranch_vccnz Q_rl7
Q_rd7:
    s_branch Q_go7
CODE_END:
.section .rodata,"a"
.p2align 6
.amdhsa_kernel gated_mix__linear_attn_block__moe_arch_mod__prompt_kernel
  .amdhsa_next_free_vgpr 256
  .amdhsa_next_free_sgpr 102
  .amdhsa_accum_offset 256
  .amdhsa_group_segment_fixed_size 0
  .amdhsa_kernarg_size 96
  .amdhsa_user_sgpr_count 2
  .amdhsa_user_sgpr_kernarg_segment_ptr 1
  .amdhsa_system_sgpr_workgroup_id_x 1
.end_amdhsa_kernel
```

```asm
; @launch grid=(256,1,1) block=(512,1,1) lds=163840
.amdgcn_target "amdgcn-amd-amdhsa--gfx950"
.text
.globl gated_mix__linear_attn_block__moe_arch_mod__prompt_kernel
.p2align 8
.type gated_mix__linear_attn_block__moe_arch_mod__prompt_kernel,@function
gated_mix__linear_attn_block__moe_arch_mod__prompt_kernel:
    s_load_dwordx2 s[12:13], s[0:1], 8
    s_load_dwordx2 s[8:9], s[0:1], 0
    s_getpc_b64 s[64:65]
PC0:
    v_min_u32 v1, 15, v0
    v_lshlrev_b32 v1, 6, v1
    global_load_dword v246, v1, s[64:65]
    s_cmp_ge_u32 s2, 256
    s_cbranch_scc1 END
    v_lshrrev_b32 v1, 6, v0
    v_and_b32 v2, 63, v0
    s_load_dwordx8 s[48:55], s[0:1], 32
    v_readfirstlane_b32 s3, v1
    s_load_dwordx8 s[56:63], s[0:1], 64
    s_load_dwordx2 s[20:21], s[0:1], 16
    s_and_b32 s66, s2, 0xf8
    v_and_b32 v1, 31, v0
    v_lshl_add_u32 v1, s66, 2, v1
    v_lshlrev_b32 v1, 6, v1
    v_min_u32 v1, CODE_END-PC0-4, v1
    global_load_dword v247, v1, s[64:65]
    s_and_b32 s64, s2, 7
    s_lshr_b32 s65, s2, 3
    s_and_b32 s44, s3, 3
    s_lshr_b32 s45, s3, 2
    s_and_b32 s66, s64, 6
    s_lshl_b32 s5, s66, 1
    s_add_u32 s76, s66, s65
    s_lshl_b32 s76, s76, 1
    s_lshr_b32 s66, s65, 3
    s_add_u32 s5, s5, s66
    v_lshrrev_b32 v6, 3, v2
    v_lshl_add_u32 v6, s44, 3, v6
    v_lshrrev_b32 v8, 4, v2
    v_and_b32 v10, 7, v2
    s_and_b32 s67, s44, 1
    v_mul_u32_u24 v7, 6144, v6
    v_and_b32 v9, 1, v8
    v_lshl_add_u32 v9, v9, 1, s67
    v_lshlrev_b32 v9, 1, v9
    v_xor_b32 v9, v9, v10
    v_lshl_add_u32 v7, v9, 4, v7
    v_lshl_add_u32 v5, s5, 7, v7
    s_mov_b32 s14, 0x600000
    s_mov_b32 s15, 0x00020000
    s_lshl_b32 s72, s44, 10
    s_lshl_b32 s66, s45, 12
    s_add_u32 s69, s72, s66
    s_add_u32 s68, s69, s66
    s_and_b32 s70, s76, 15
    s_lshl_b32 s71, s70, 1
    s_add_u32 s71, s71, s45
    s_mul_i32 s71, s71, 196608
    s_waitcnt lgkmcnt(0)
    s_add_u32 m0, s69, 24576
    s_add_u32 s66, s71, 2048
    buffer_load_dwordx4 v5, s[12:15], s66 offen lds
    s_add_u32 m0, s69, 32768
    s_add_u32 s66, s71, 4096
    buffer_load_dwordx4 v5, s[12:15], s66 offen lds
    s_add_u32 m0, s69, 16384
    s_add_u32 s66, s71, 0
    buffer_load_dwordx4 v5, s[12:15], s66 offen lds
    s_and_b32 s4, s64, 1
    s_lshl_b32 s4, s4, 3
    s_and_b32 s66, s65, 7
    s_add_u32 s4, s4, s66
    v_lshl_add_u32 v7, s4, 7, v6
    v_lshlrev_b32 v7, 11, v7
    v_lshl_add_u32 v9, s67, 2, v8
    v_xor_b32 v9, v9, v10
    v_lshl_add_u32 v4, v9, 4, v7
    s_mov_b32 s10, 0x400000
    s_mov_b32 s11, 0x00020000
    s_lshl_b32 s70, s70, 7
    s_lshl_b32 s66, s45, 17
    s_add_u32 s70, s70, s66
    s_add_u32 m0, s68, 0
    s_add_u32 s66, s70, 0
    buffer_load_dwordx4 v4, s[8:11], s66 offen lds
    s_add_u32 m0, s68, 4096
    s_add_u32 s66, s70, 65536
    buffer_load_dwordx4 v4, s[8:11], s66 offen lds
    s_barrier
    s_add_u32 s70, s76, 1
    s_and_b32 s70, s70, 15
    s_lshl_b32 s71, s70, 1
    s_add_u32 s71, s71, s45
    s_mul_i32 s71, s71, 196608
    s_add_u32 m0, s69, 65536
    s_add_u32 s66, s71, 2048
    buffer_load_dwordx4 v5, s[12:15], s66 offen lds
    s_add_u32 m0, s69, 73728
    s_add_u32 s66, s71, 4096
    buffer_load_dwordx4 v5, s[12:15], s66 offen lds
    s_add_u32 m0, s69, 57344
    s_add_u32 s66, s71, 0
    buffer_load_dwordx4 v5, s[12:15], s66 offen lds
    s_lshl_b32 s70, s70, 7
    s_lshl_b32 s66, s45, 17
    s_add_u32 s70, s70, s66
    s_add_u32 m0, s68, 40960
    s_add_u32 s66, s70, 0
    buffer_load_dwordx4 v4, s[8:11], s66 offen lds
    s_add_u32 m0, s68, 45056
    s_add_u32 s66, s70, 65536
    buffer_load_dwordx4 v4, s[8:11], s66 offen lds
    s_mov_b32 s16, s62
    s_mov_b32 s17, s63
    s_mov_b32 s32, s54
    s_mov_b32 s33, s55
    s_mov_b32 s36, s58
    s_mov_b32 s37, s59
    s_mov_b32 s40, s60
    s_mov_b32 s41, s61
    s_mov_b32 s18, 0x10000000
    s_mov_b32 s19, 0x00020000
    s_mov_b32 s34, 0x700000
    s_mov_b32 s35, 0x00020000
    s_mov_b32 s38, 0x400000
    s_mov_b32 s39, 0x00020000
    s_mov_b32 s42, 0x100
    s_mov_b32 s43, 0x00020000
    s_mov_b32 s22, 0x200000
    s_mov_b32 s23, 0x00020000
    s_bitcmp0_b32 s44, 0
    s_cselect_b32 s24, s48, s56
    s_cselect_b32 s25, s49, s57
    s_mov_b32 s26, 0x800
    s_mov_b32 s27, 0x00020000
    s_bitcmp0_b32 s44, 0
    s_cselect_b32 s28, s50, s52
    s_cselect_b32 s29, s51, s53
    s_mov_b32 s30, 0x700000
    s_mov_b32 s31, 0x00020000
    s_lshr_b32 s66, s64, 2
    s_lshl_b32 s66, s66, 1
    s_and_b32 s67, s64, 1
    s_add_u32 s66, s66, s67
    s_lshl_b32 s67, s65, 2
    s_add_u32 s66, s66, s67
    s_add_u32 s66, s66, 96
    s_bitcmp0_b32 s64, 1
    s_cselect_b32 s67, 32, 0
    s_add_u32 s66, s66, s67
    s_cmp_lt_u32 s65, 24
    s_cselect_b32 s67, s2, s66
    s_cmp_ge_u32 s67, 224
    s_cselect_b32 s30, 0, s30
    s_cselect_b32 s34, 0, s34
    s_lshr_b32 s79, s67, 2
    s_and_b32 s73, s67, 3
    s_and_b32 s6, s64, 3
    s_lshl_b32 s6, s6, 2
    s_and_b32 s66, s65, 3
    s_add_u32 s6, s6, s66
    s_lshr_b32 s7, s64, 2
    s_lshl_b32 s7, s7, 3
    s_lshr_b32 s66, s65, 2
    s_add_u32 s7, s7, s66
    s_mov_b32 s46, 0x3fb8aa3b
    s_mov_b32 s47, 0x358637bd
    s_cmp_ge_u32 s3, 4
    s_cbranch_scc1 HELP
    s_and_b32 s48, s3, 1
    s_lshr_b32 s49, s3, 1
    v_and_b32 v3, 15, v2
    s_lshl_b32 s66, s48, 6
    v_add_u32 v3, s66, v3
    v_lshlrev_b32 v3, 7, v3
    v_bfe_u32 v9, v2, 1, 3
    v_lshrrev_b32 v15, 4, v2
    v_xor_b32 v9, v9, v15
    v_xor_b32 v12, 0, v9
    v_lshl_add_u32 v4, v12, 4, v3
    v_xor_b32 v12, 4, v9
    v_lshl_add_u32 v5, v12, 4, v3
    v_bfe_u32 v12, v2, 2, 2
    v_lshl_add_u32 v13, v15, 3, v12
    v_lshlrev_b32 v13, 7, v13
    v_lshrrev_b32 v12, 1, v12
    v_xor_b32 v12, s49, v12
    v_lshl_add_u32 v13, v12, 6, v13
    v_and_b32 v12, 3, v2
    v_lshl_add_u32 v13, v12, 3, v13
    v_add_u32 v13, 16384, v13
    v_and_b32 v12, 1, v15
    v_xor_b32 v14, 0, v12
    v_lshl_add_u32 v6, v14, 5, v13
    v_xor_b32 v14, 1, v12
    v_lshl_add_u32 v7, v14, 5, v13
    v_mov_b32 v8, v4
    v_mov_b32 v9, v5
    v_mov_b32 v10, v6
    v_mov_b32 v11, v7
    v_mov_b32 v96, 0
    v_mov_b32 v97, 0
    v_mov_b32 v98, 0
    v_mov_b32 v99, 0
    v_mov_b32 v100, 0
    v_mov_b32 v101, 0
    v_mov_b32 v102, 0
    v_mov_b32 v103, 0
    v_mov_b32 v104, 0
    v_mov_b32 v105, 0
    v_mov_b32 v106, 0
    v_mov_b32 v107, 0
    v_mov_b32 v108, 0
    v_mov_b32 v109, 0
    v_mov_b32 v110, 0
    v_mov_b32 v111, 0
    v_mov_b32 v112, 0
    v_mov_b32 v113, 0
    v_mov_b32 v114, 0
    v_mov_b32 v115, 0
    v_mov_b32 v116, 0
    v_mov_b32 v117, 0
    v_mov_b32 v118, 0
    v_mov_b32 v119, 0
    v_mov_b32 v120, 0
    v_mov_b32 v121, 0
    v_mov_b32 v122, 0
    v_mov_b32 v123, 0
    v_mov_b32 v124, 0
    v_mov_b32 v125, 0
    v_mov_b32 v126, 0
    v_mov_b32 v127, 0
    v_mov_b32 v128, 0
    v_mov_b32 v129, 0
    v_mov_b32 v130, 0
    v_mov_b32 v131, 0
    v_mov_b32 v132, 0
    v_mov_b32 v133, 0
    v_mov_b32 v134, 0
    v_mov_b32 v135, 0
    v_mov_b32 v136, 0
    v_mov_b32 v137, 0
    v_mov_b32 v138, 0
    v_mov_b32 v139, 0
    v_mov_b32 v140, 0
    v_mov_b32 v141, 0
    v_mov_b32 v142, 0
    v_mov_b32 v143, 0
    v_mov_b32 v144, 0
    v_mov_b32 v145, 0
    v_mov_b32 v146, 0
    v_mov_b32 v147, 0
    v_mov_b32 v148, 0
    v_mov_b32 v149, 0
    v_mov_b32 v150, 0
    v_mov_b32 v151, 0
    v_mov_b32 v152, 0
    v_mov_b32 v153, 0
    v_mov_b32 v154, 0
    v_mov_b32 v155, 0
    v_mov_b32 v156, 0
    v_mov_b32 v157, 0
    v_mov_b32 v158, 0
    v_mov_b32 v159, 0
    v_mov_b32 v160, 0
    v_mov_b32 v161, 0
    v_mov_b32 v162, 0
    v_mov_b32 v163, 0
    v_mov_b32 v164, 0
    v_mov_b32 v165, 0
    v_mov_b32 v166, 0
    v_mov_b32 v167, 0
    v_mov_b32 v168, 0
    v_mov_b32 v169, 0
    v_mov_b32 v170, 0
    v_mov_b32 v171, 0
    v_mov_b32 v172, 0
    v_mov_b32 v173, 0
    v_mov_b32 v174, 0
    v_mov_b32 v175, 0
    v_mov_b32 v176, 0
    v_mov_b32 v177, 0
    v_mov_b32 v178, 0
    v_mov_b32 v179, 0
    v_mov_b32 v180, 0
    v_mov_b32 v181, 0
    v_mov_b32 v182, 0
    v_mov_b32 v183, 0
    v_mov_b32 v184, 0
    v_mov_b32 v185, 0
    v_mov_b32 v186, 0
    v_mov_b32 v187, 0
    v_mov_b32 v188, 0
    v_mov_b32 v189, 0
    v_mov_b32 v190, 0
    v_mov_b32 v191, 0
    v_lshlrev_b32 v12, 2, v2
    v_and_b32 v12, 63, v12
    v_add_u32 v12, 155648, v12
    ds_write_b32 v12, v96
    s_mov_b32 s70, 0x3fb8aa3b
    s_mov_b32 s71, 0x3fb8aa3b
    v_lshrrev_b32 v12, 3, v2
    s_lshl_b32 s67, s44, 3
    v_add_u32 v12, s67, v12
    v_lshlrev_b32 v12, 11, v12
    v_lshrrev_b32 v13, 4, v2
    v_lshlrev_b32 v13, 1, v13
    v_and_b32 v250, 7, v2
    v_xor_b32 v13, v13, v250
    v_lshl_add_u32 v12, v13, 4, v12
    s_lshl_b32 s66, s7, 7
    v_add_u32 v250, s66, v12
    s_lshl_b32 s66, s6, 7
    s_lshl_b32 s67, s44, 5
    s_add_u32 s66, s66, s67
    s_lshl_b32 s67, s45, 4
    s_add_u32 s66, s66, s67
    v_and_b32 v252, 15, v2
    v_add_u32 v252, s66, v252
    v_lshlrev_b32 v251, 11, v252
    v_bfe_u32 v12, v2, 4, 1
    v_lshl_add_u32 v251, v12, 5, v251
    v_lshrrev_b32 v12, 5, v2
    v_lshl_add_u32 v251, v12, 4, v251
    s_lshl_b32 s66, s7, 7
    v_add_u32 v251, s66, v251
    v_lshrrev_b32 v253, 2, v252
    v_lshlrev_b32 v253, 6, v253
    v_and_b32 v12, 3, v2
    v_lshl_add_u32 v253, v12, 2, v253
    s_lshl_b32 s66, s6, 1
    s_and_b32 s66, s66, 6
    s_lshl_b32 s67, s7, 2
    s_add_u32 s66, s66, s67
    s_and_b32 s66, s66, 7
    s_lshl_b32 s52, s66, 18
    s_lshr_b32 s49, s44, 1
    s_and_b32 s66, s44, 1
    s_lshl_b32 s66, s66, 2
    s_lshl_b32 s67, s45, 1
    s_add_u32 s66, s66, s67
    s_lshl_b32 s67, s4, 3
    s_add_u32 s66, s66, s67
    s_lshl_b32 s66, s66, 5
    s_lshl_b32 s67, s5, 1
    s_add_u32 s66, s66, s67
    s_add_u32 s66, s66, s49
    s_lshl_b32 s60, s66, 10
    s_add_u32 s61, s60, 32768
    s_lshl_b32 s58, s5, 2
    s_add_u32 s58, s58, s44
    s_lshl_b32 s66, s58, 14
    s_add_u32 s66, s66, 4194304
    v_lshlrev_b32 v12, 4, v2
    v_add_u32 v248, s66, v12
    s_lshl_b32 s66, s58, 10
    s_add_u32 s66, s66, 5242880
    v_and_b32 v12, 15, v2
    v_lshlrev_b32 v12, 6, v12
    v_lshrrev_b32 v13, 4, v2
    v_lshl_add_u32 v12, v13, 4, v12
    v_add_u32 v249, s66, v12
    s_lshr_b32 s57, s4, 3
    s_xor_b32 s57, s57, s4
    s_and_b32 s57, s57, 1
    s_lshl_b32 s57, s57, 13
    v_bfe_u32 v12, v2, 2, 2
    v_cmp_eq_u32 vcc, v12, v13
    v_mov_b32 v13, 0x3f80
    v_and_b32 v12, 1, v2
    v_lshlrev_b32 v12, 4, v12
    v_lshlrev_b32 v12, v12, v13
    v_cndmask_b32 v12, 0, v12, vcc
    v_and_b32 v13, 2, v2
    v_cmp_eq_u32 vcc, 0, v13
    s_nop 1
    v_cndmask_b32 v254, 0, v12, vcc
    v_cndmask_b32 v255, v12, 0, vcc
    s_mov_b32 s50, 0
    s_mov_b32 s51, 0
    s_waitcnt vmcnt(5) lgkmcnt(0)
    s_barrier
    ds_read_b64_tr_b16 v[32:33], v10 offset:0
    ds_read_b64_tr_b16 v[34:35], v10 offset:512
    ds_read_b128 v[16:19], v8 offset:0
    ds_read_b128 v[20:23], v8 offset:2048
    ds_read_b128 v[24:27], v8 offset:4096
    ds_read_b128 v[28:31], v8 offset:6144
    ds_read_b64_tr_b16 v[36:37], v11 offset:0
    ds_read_b64_tr_b16 v[38:39], v11 offset:512
    ds_read_b64_tr_b16 v[40:41], v10 offset:8192
    ds_read_b64_tr_b16 v[42:43], v10 offset:8704
    ds_read_b64_tr_b16 v[44:45], v11 offset:8192
    ds_read_b64_tr_b16 v[46:47], v11 offset:8704
    ds_read_b64_tr_b16 v[48:49], v10 offset:16384
    ds_read_b64_tr_b16 v[50:51], v10 offset:16896
    ds_read_b64_tr_b16 v[52:53], v11 offset:16384
    ds_read_b64_tr_b16 v[54:55], v11 offset:16896
.p2align 6
LOOP:
    s_waitcnt lgkmcnt(13)
    v_mfma_f32_16x16x32_bf16 v[96:99], v[32:35], v[16:19], v[96:99]
    ds_read_b64_tr_b16 v[72:73], v10 offset:4096
    s_waitcnt lgkmcnt(13)
    v_mfma_f32_16x16x32_bf16 v[104:107], v[32:35], v[20:23], v[104:107]
    ds_read_b64_tr_b16 v[74:75], v10 offset:4608
    s_waitcnt lgkmcnt(13)
    v_mfma_f32_16x16x32_bf16 v[112:115], v[32:35], v[24:27], v[112:115]
    ds_read_b128 v[56:59], v9 offset:0
    s_waitcnt lgkmcnt(13)
    v_mfma_f32_16x16x32_bf16 v[120:123], v[32:35], v[28:31], v[120:123]
    ds_read_b128 v[60:63], v9 offset:2048
    s_waitcnt lgkmcnt(12)
    v_mfma_f32_16x16x32_bf16 v[124:127], v[36:39], v[28:31], v[124:127]
    ds_read_b128 v[64:67], v9 offset:4096
    v_mfma_f32_16x16x32_bf16 v[116:119], v[36:39], v[24:27], v[116:119]
    ds_read_b128 v[68:71], v9 offset:6144
    v_mfma_f32_16x16x32_bf16 v[108:111], v[36:39], v[20:23], v[108:111]
    ds_read_b64_tr_b16 v[76:77], v11 offset:4096
    v_mfma_f32_16x16x32_bf16 v[100:103], v[36:39], v[16:19], v[100:103]
    ds_read_b64_tr_b16 v[78:79], v11 offset:4608
    s_waitcnt lgkmcnt(14)
    v_mfma_f32_16x16x32_bf16 v[128:131], v[16:19], v[40:43], v[128:131]
    ds_read_b64_tr_b16 v[80:81], v10 offset:12288
    v_mfma_f32_16x16x32_bf16 v[136:139], v[20:23], v[40:43], v[136:139]
    ds_read_b64_tr_b16 v[82:83], v10 offset:12800
    v_mfma_f32_16x16x32_bf16 v[144:147], v[24:27], v[40:43], v[144:147]
    ds_read_b64_tr_b16 v[84:85], v11 offset:12288
    v_mfma_f32_16x16x32_bf16 v[152:155], v[28:31], v[40:43], v[152:155]
    ds_read_b64_tr_b16 v[86:87], v11 offset:12800
    s_waitcnt lgkmcnt(15)
    v_mfma_f32_16x16x32_bf16 v[156:159], v[28:31], v[44:47], v[156:159]
    ds_read_b64_tr_b16 v[88:89], v10 offset:20480
    v_mfma_f32_16x16x32_bf16 v[148:151], v[24:27], v[44:47], v[148:151]
    ds_read_b64_tr_b16 v[90:91], v10 offset:20992
    v_mfma_f32_16x16x32_bf16 v[140:143], v[20:23], v[44:47], v[140:143]
    ds_read_b64_tr_b16 v[92:93], v11 offset:20480
    v_mfma_f32_16x16x32_bf16 v[132:135], v[16:19], v[44:47], v[132:135]
    ds_read_b64_tr_b16 v[94:95], v11 offset:20992
    s_waitcnt lgkmcnt(15)
    v_mfma_f32_16x16x32_bf16 v[160:163], v[16:19], v[48:51], v[160:163]
    v_mfma_f32_16x16x32_bf16 v[168:171], v[20:23], v[48:51], v[168:171]
    v_mfma_f32_16x16x32_bf16 v[176:179], v[24:27], v[48:51], v[176:179]
    v_mfma_f32_16x16x32_bf16 v[184:187], v[28:31], v[48:51], v[184:187]
    s_waitcnt lgkmcnt(15)
    v_mfma_f32_16x16x32_bf16 v[188:191], v[28:31], v[52:55], v[188:191]
    v_mfma_f32_16x16x32_bf16 v[180:183], v[24:27], v[52:55], v[180:183]
    v_mfma_f32_16x16x32_bf16 v[172:175], v[20:23], v[52:55], v[172:175]
    v_mfma_f32_16x16x32_bf16 v[164:167], v[16:19], v[52:55], v[164:167]
    s_waitcnt lgkmcnt(13)
    v_mfma_f32_16x16x32_bf16 v[96:99], v[72:75], v[56:59], v[96:99]
    s_add_u32 s50, s50, 40960
    s_cmp_eq_u32 s50, 122880
    s_cselect_b32 s50, 0, s50
    s_waitcnt lgkmcnt(12)
    v_mfma_f32_16x16x32_bf16 v[104:107], v[72:75], v[60:63], v[104:107]
    v_add_u32 v8, s50, v4
    s_waitcnt lgkmcnt(11)
    v_mfma_f32_16x16x32_bf16 v[112:115], v[72:75], v[64:67], v[112:115]
    v_add_u32 v9, s50, v5
    s_waitcnt lgkmcnt(10)
    v_mfma_f32_16x16x32_bf16 v[120:123], v[72:75], v[68:71], v[120:123]
    v_add_u32 v10, s50, v6
    s_waitcnt lgkmcnt(8)
    v_mfma_f32_16x16x32_bf16 v[124:127], v[76:79], v[68:71], v[124:127]
    v_add_u32 v11, s50, v7
    v_mfma_f32_16x16x32_bf16 v[116:119], v[76:79], v[64:67], v[116:119]
    s_waitcnt vmcnt(0) lgkmcnt(0)
    s_barrier
    v_mfma_f32_16x16x32_bf16 v[108:111], v[76:79], v[60:63], v[108:111]
    ds_read_b64_tr_b16 v[32:33], v10 offset:0
    v_mfma_f32_16x16x32_bf16 v[100:103], v[76:79], v[56:59], v[100:103]
    ds_read_b64_tr_b16 v[34:35], v10 offset:512
    v_mfma_f32_16x16x32_bf16 v[128:131], v[56:59], v[80:83], v[128:131]
    ds_read_b128 v[16:19], v8 offset:0
    v_mfma_f32_16x16x32_bf16 v[136:139], v[60:63], v[80:83], v[136:139]
    ds_read_b128 v[20:23], v8 offset:2048
    v_mfma_f32_16x16x32_bf16 v[144:147], v[64:67], v[80:83], v[144:147]
    ds_read_b128 v[24:27], v8 offset:4096
    v_mfma_f32_16x16x32_bf16 v[152:155], v[68:71], v[80:83], v[152:155]
    ds_read_b128 v[28:31], v8 offset:6144
    v_mfma_f32_16x16x32_bf16 v[156:159], v[68:71], v[84:87], v[156:159]
    ds_read_b64_tr_b16 v[36:37], v11 offset:0
    v_mfma_f32_16x16x32_bf16 v[148:151], v[64:67], v[84:87], v[148:151]
    ds_read_b64_tr_b16 v[38:39], v11 offset:512
    v_mfma_f32_16x16x32_bf16 v[140:143], v[60:63], v[84:87], v[140:143]
    ds_read_b64_tr_b16 v[40:41], v10 offset:8192
    v_mfma_f32_16x16x32_bf16 v[132:135], v[56:59], v[84:87], v[132:135]
    ds_read_b64_tr_b16 v[42:43], v10 offset:8704
    v_mfma_f32_16x16x32_bf16 v[160:163], v[56:59], v[88:91], v[160:163]
    ds_read_b64_tr_b16 v[44:45], v11 offset:8192
    v_mfma_f32_16x16x32_bf16 v[168:171], v[60:63], v[88:91], v[168:171]
    ds_read_b64_tr_b16 v[46:47], v11 offset:8704
    v_mfma_f32_16x16x32_bf16 v[176:179], v[64:67], v[88:91], v[176:179]
    ds_read_b64_tr_b16 v[48:49], v10 offset:16384
    v_mfma_f32_16x16x32_bf16 v[184:187], v[68:71], v[88:91], v[184:187]
    ds_read_b64_tr_b16 v[50:51], v10 offset:16896
    v_mfma_f32_16x16x32_bf16 v[188:191], v[68:71], v[92:95], v[188:191]
    ds_read_b64_tr_b16 v[52:53], v11 offset:16384
    v_mfma_f32_16x16x32_bf16 v[180:183], v[64:67], v[92:95], v[180:183]
    ds_read_b64_tr_b16 v[54:55], v11 offset:16896
    v_mfma_f32_16x16x32_bf16 v[172:175], v[60:63], v[92:95], v[172:175]
    v_mfma_f32_16x16x32_bf16 v[164:167], v[56:59], v[92:95], v[164:167]
    s_add_u32 s51, s51, 1
    s_cmp_lt_u32 s51, 13
    s_cbranch_scc1 LOOP
    s_waitcnt lgkmcnt(13)
    v_mfma_f32_16x16x32_bf16 v[96:99], v[32:35], v[16:19], v[96:99]
    ds_read_b64_tr_b16 v[72:73], v10 offset:12288
    v_add_u32 v12, 122880, v4
    s_waitcnt lgkmcnt(13)
    v_mfma_f32_16x16x32_bf16 v[104:107], v[32:35], v[20:23], v[104:107]
    ds_read_b64_tr_b16 v[74:75], v10 offset:12800
    v_add_u32 v13, 122880, v5
    s_waitcnt lgkmcnt(13)
    v_mfma_f32_16x16x32_bf16 v[112:115], v[32:35], v[24:27], v[112:115]
    ds_read_b128 v[56:59], v9 offset:0
    v_add_u32 v14, 114688, v6
    s_waitcnt lgkmcnt(13)
    v_mfma_f32_16x16x32_bf16 v[120:123], v[32:35], v[28:31], v[120:123]
    ds_read_b128 v[60:63], v9 offset:2048
    v_add_u32 v15, 114688, v7
    s_waitcnt lgkmcnt(12)
    v_mfma_f32_16x16x32_bf16 v[124:127], v[36:39], v[28:31], v[124:127]
    ds_read_b128 v[64:67], v9 offset:4096
    s_lshl_b32 s66, s3, 12
    v_mfma_f32_16x16x32_bf16 v[116:119], v[36:39], v[24:27], v[116:119]
    ds_read_b128 v[68:71], v9 offset:6144
    v_lshlrev_b32 v3, 4, v2
    v_mfma_f32_16x16x32_bf16 v[108:111], v[36:39], v[20:23], v[108:111]
    ds_read_b64_tr_b16 v[76:77], v11 offset:12288
    v_add_u32 v3, s66, v3
    v_mfma_f32_16x16x32_bf16 v[100:103], v[36:39], v[16:19], v[100:103]
    ds_read_b64_tr_b16 v[78:79], v11 offset:12800
    s_lshl_b32 s66, s3, 2
    s_waitcnt lgkmcnt(14)
    v_mfma_f32_16x16x32_bf16 v[128:131], v[16:19], v[40:43], v[128:131]
    ds_read_b64_tr_b16 v[80:81], v10 offset:20480
    s_add_u32 s66, s66, 155648
    v_mfma_f32_16x16x32_bf16 v[136:139], v[20:23], v[40:43], v[136:139]
    ds_read_b64_tr_b16 v[82:83], v10 offset:20992
    v_mov_b32 v1, s66
    v_mfma_f32_16x16x32_bf16 v[144:147], v[24:27], v[40:43], v[144:147]
    ds_read_b64_tr_b16 v[84:85], v11 offset:20480
    v_mov_b32 v0, 1
    v_mfma_f32_16x16x32_bf16 v[152:155], v[28:31], v[40:43], v[152:155]
    ds_read_b64_tr_b16 v[86:87], v11 offset:20992
    v_mov_b32 v88, v248
    s_waitcnt lgkmcnt(15)
    v_mfma_f32_16x16x32_bf16 v[156:159], v[28:31], v[44:47], v[156:159]
    v_mov_b32 v89, v249
    v_mfma_f32_16x16x32_bf16 v[148:151], v[24:27], v[44:47], v[148:151]
    v_mov_b32 v90, v250
    v_mfma_f32_16x16x32_bf16 v[140:143], v[20:23], v[44:47], v[140:143]
    v_mov_b32 v91, v251
    v_mfma_f32_16x16x32_bf16 v[132:135], v[16:19], v[44:47], v[132:135]
    v_mov_b32 v92, v252
    s_waitcnt lgkmcnt(14)
    v_mfma_f32_16x16x32_bf16 v[160:163], v[16:19], v[48:51], v[160:163]
    v_mov_b32 v93, v253
    v_mfma_f32_16x16x32_bf16 v[168:171], v[20:23], v[48:51], v[168:171]
    v_mov_b32 v94, v254
    v_mfma_f32_16x16x32_bf16 v[176:179], v[24:27], v[48:51], v[176:179]
    v_mov_b32 v95, v255
    v_mfma_f32_16x16x32_bf16 v[184:187], v[28:31], v[48:51], v[184:187]
    s_waitcnt lgkmcnt(12)
    v_mfma_f32_16x16x32_bf16 v[188:191], v[28:31], v[52:55], v[188:191]
    v_mfma_f32_16x16x32_bf16 v[180:183], v[24:27], v[52:55], v[180:183]
    v_mfma_f32_16x16x32_bf16 v[172:175], v[20:23], v[52:55], v[172:175]
    v_mfma_f32_16x16x32_bf16 v[164:167], v[16:19], v[52:55], v[164:167]
    s_waitcnt lgkmcnt(9)
    v_mfma_f32_16x16x32_bf16 v[128:131], v[56:59], v[72:75], v[128:131]
    s_waitcnt lgkmcnt(8)
    v_mfma_f32_16x16x32_bf16 v[136:139], v[60:63], v[72:75], v[136:139]
    s_waitcnt lgkmcnt(7)
    v_mfma_f32_16x16x32_bf16 v[144:147], v[64:67], v[72:75], v[144:147]
    s_waitcnt lgkmcnt(6)
    v_mfma_f32_16x16x32_bf16 v[152:155], v[68:71], v[72:75], v[152:155]
    s_waitcnt lgkmcnt(4)
    v_mfma_f32_16x16x32_bf16 v[156:159], v[68:71], v[76:79], v[156:159]
    v_mfma_f32_16x16x32_bf16 v[148:151], v[64:67], v[76:79], v[148:151]
    s_barrier
    v_mfma_f32_16x16x32_bf16 v[140:143], v[60:63], v[76:79], v[140:143]
    ds_read_b64_tr_b16 v[16:17], v10 offset:49152
    v_mfma_f32_16x16x32_bf16 v[132:135], v[56:59], v[76:79], v[132:135]
    ds_read_b64_tr_b16 v[18:19], v10 offset:49664
    s_waitcnt lgkmcnt(4)
    v_mfma_f32_16x16x32_bf16 v[160:163], v[56:59], v[80:83], v[160:163]
    ds_read_b128 v[192:195], v8 offset:40960
    v_mfma_f32_16x16x32_bf16 v[168:171], v[60:63], v[80:83], v[168:171]
    ds_read_b128 v[196:199], v8 offset:43008
    v_mfma_f32_16x16x32_bf16 v[176:179], v[64:67], v[80:83], v[176:179]
    ds_read_b128 v[200:203], v8 offset:45056
    v_mfma_f32_16x16x32_bf16 v[184:187], v[68:71], v[80:83], v[184:187]
    ds_read_b128 v[204:207], v8 offset:47104
    s_waitcnt lgkmcnt(6)
    v_mfma_f32_16x16x32_bf16 v[188:191], v[68:71], v[84:87], v[188:191]
    ds_read_b64_tr_b16 v[20:21], v11 offset:49152
    v_mfma_f32_16x16x32_bf16 v[180:183], v[64:67], v[84:87], v[180:183]
    ds_read_b64_tr_b16 v[22:23], v11 offset:49664
    v_mfma_f32_16x16x32_bf16 v[172:175], v[60:63], v[84:87], v[172:175]
    v_mfma_f32_16x16x32_bf16 v[164:167], v[56:59], v[84:87], v[164:167]
    s_waitcnt lgkmcnt(5)
    v_mfma_f32_16x16x32_bf16 v[128:131], v[192:195], v[16:19], v[128:131]
    ds_read_b64_tr_b16 v[24:25], v10 offset:53248
    ds_read_b64_tr_b16 v[26:27], v10 offset:53760
    s_waitcnt lgkmcnt(6)
    v_mfma_f32_16x16x32_bf16 v[136:139], v[196:199], v[16:19], v[136:139]
    ds_read_b128 v[208:211], v9 offset:40960
    ds_read_b128 v[212:215], v9 offset:43008
    s_waitcnt lgkmcnt(7)
    v_mfma_f32_16x16x32_bf16 v[144:147], v[200:203], v[16:19], v[144:147]
    ds_read_b128 v[216:219], v9 offset:45056
    s_waitcnt lgkmcnt(7)
    v_mfma_f32_16x16x32_bf16 v[152:155], v[204:207], v[16:19], v[152:155]
    ds_read_b128 v[220:223], v9 offset:47104
    s_waitcnt lgkmcnt(6)
    v_mfma_f32_16x16x32_bf16 v[156:159], v[204:207], v[20:23], v[156:159]
    ds_read_b64_tr_b16 v[28:29], v11 offset:53248
    v_mfma_f32_16x16x32_bf16 v[148:151], v[200:203], v[20:23], v[148:151]
    ds_read_b64_tr_b16 v[30:31], v11 offset:53760
    v_mfma_f32_16x16x32_bf16 v[140:143], v[196:199], v[20:23], v[140:143]
    v_mfma_f32_16x16x32_bf16 v[132:135], v[192:195], v[20:23], v[132:135]
    s_waitcnt lgkmcnt(5)
    v_mfma_f32_16x16x32_bf16 v[128:131], v[208:211], v[24:27], v[128:131]
    ds_read_b64_tr_b16 v[32:33], v10 offset:4096
    s_waitcnt lgkmcnt(5)
    v_mfma_f32_16x16x32_bf16 v[136:139], v[212:215], v[24:27], v[136:139]
    ds_read_b64_tr_b16 v[34:35], v10 offset:4608
    s_waitcnt lgkmcnt(5)
    v_mfma_f32_16x16x32_bf16 v[144:147], v[216:219], v[24:27], v[144:147]
    ds_read_b64_tr_b16 v[36:37], v11 offset:4096
    s_waitcnt lgkmcnt(5)
    v_mfma_f32_16x16x32_bf16 v[152:155], v[220:223], v[24:27], v[152:155]
    ds_read_b64_tr_b16 v[38:39], v11 offset:4608
    s_waitcnt lgkmcnt(4)
    v_mfma_f32_16x16x32_bf16 v[156:159], v[220:223], v[28:31], v[156:159]
    v_mfma_f32_16x16x32_bf16 v[148:151], v[216:219], v[28:31], v[148:151]
    v_mfma_f32_16x16x32_bf16 v[140:143], v[212:215], v[28:31], v[140:143]
    v_mfma_f32_16x16x32_bf16 v[132:135], v[208:211], v[28:31], v[132:135]
    s_waitcnt lgkmcnt(2)
    v_mfma_f32_16x16x32_bf16 v[96:99], v[32:35], v[56:59], v[96:99]
    v_mfma_f32_16x16x32_bf16 v[104:107], v[32:35], v[60:63], v[104:107]
    s_barrier
    v_mfma_f32_16x16x32_bf16 v[112:115], v[32:35], v[64:67], v[112:115]
    ds_read_b64_tr_b16 v[16:17], v14 offset:8192
    ds_read_b64_tr_b16 v[18:19], v14 offset:8704
    v_mfma_f32_16x16x32_bf16 v[120:123], v[32:35], v[68:71], v[120:123]
    ds_read_b128 v[224:227], v12 offset:0
    ds_read_b128 v[228:231], v12 offset:2048
    s_waitcnt lgkmcnt(4)
    v_mfma_f32_16x16x32_bf16 v[124:127], v[36:39], v[68:71], v[124:127]
    ds_read_b128 v[232:235], v12 offset:4096
    ds_read_b128 v[236:239], v12 offset:6144
    v_mfma_f32_16x16x32_bf16 v[116:119], v[36:39], v[64:67], v[116:119]
    ds_read_b64_tr_b16 v[20:21], v15 offset:8192
    ds_read_b64_tr_b16 v[22:23], v15 offset:8704
    v_mfma_f32_16x16x32_bf16 v[108:111], v[36:39], v[60:63], v[108:111]
    v_mfma_f32_16x16x32_bf16 v[100:103], v[36:39], v[56:59], v[100:103]
    s_waitcnt lgkmcnt(5)
    v_mfma_f32_16x16x32_bf16 v[128:131], v[224:227], v[16:19], v[128:131]
    ds_read_b64_tr_b16 v[24:25], v14 offset:12288
    ds_read_b64_tr_b16 v[26:27], v14 offset:12800
    s_waitcnt lgkmcnt(6)
    v_mfma_f32_16x16x32_bf16 v[136:139], v[228:231], v[16:19], v[136:139]
    ds_read_b128 v[240:243], v13 offset:0
    ds_read_b128 v[244:247], v13 offset:2048
    s_waitcnt lgkmcnt(7)
    v_mfma_f32_16x16x32_bf16 v[144:147], v[232:235], v[16:19], v[144:147]
    ds_read_b128 v[248:251], v13 offset:4096
    s_waitcnt lgkmcnt(7)
    v_mfma_f32_16x16x32_bf16 v[152:155], v[236:239], v[16:19], v[152:155]
    ds_read_b128 v[252:255], v13 offset:6144
    s_waitcnt lgkmcnt(6)
    v_mfma_f32_16x16x32_bf16 v[156:159], v[236:239], v[20:23], v[156:159]
    ds_read_b64_tr_b16 v[28:29], v15 offset:12288
    v_mfma_f32_16x16x32_bf16 v[148:151], v[232:235], v[20:23], v[148:151]
    ds_read_b64_tr_b16 v[30:31], v15 offset:12800
    v_mfma_f32_16x16x32_bf16 v[140:143], v[228:231], v[20:23], v[140:143]
    v_mfma_f32_16x16x32_bf16 v[132:135], v[224:227], v[20:23], v[132:135]
    s_waitcnt lgkmcnt(5)
    v_mfma_f32_16x16x32_bf16 v[128:131], v[240:243], v[24:27], v[128:131]
    ds_read_b64_tr_b16 v[32:33], v10 offset:57344
    s_waitcnt lgkmcnt(5)
    v_mfma_f32_16x16x32_bf16 v[136:139], v[244:247], v[24:27], v[136:139]
    ds_read_b64_tr_b16 v[34:35], v10 offset:57856
    s_waitcnt lgkmcnt(5)
    v_mfma_f32_16x16x32_bf16 v[144:147], v[248:251], v[24:27], v[144:147]
    ds_read_b64_tr_b16 v[36:37], v11 offset:57344
    s_waitcnt lgkmcnt(5)
    v_mfma_f32_16x16x32_bf16 v[152:155], v[252:255], v[24:27], v[152:155]
    ds_read_b64_tr_b16 v[38:39], v11 offset:57856
    s_waitcnt lgkmcnt(4)
    v_mfma_f32_16x16x32_bf16 v[156:159], v[252:255], v[28:31], v[156:159]
    v_mfma_f32_16x16x32_bf16 v[148:151], v[248:251], v[28:31], v[148:151]
    v_mfma_f32_16x16x32_bf16 v[140:143], v[244:247], v[28:31], v[140:143]
    v_mfma_f32_16x16x32_bf16 v[132:135], v[240:243], v[28:31], v[132:135]
    s_waitcnt lgkmcnt(2)
    v_mfma_f32_16x16x32_bf16 v[160:163], v[192:195], v[32:35], v[160:163]
    ds_read_b64_tr_b16 v[16:17], v10 offset:61440
    s_nop 5
    v_cvt_pk_bf16_f32 v40, v128, v129
    v_cvt_pk_bf16_f32 v41, v130, v131
    v_mfma_f32_16x16x32_bf16 v[168:171], v[196:199], v[32:35], v[168:171]
    ds_read_b64_tr_b16 v[18:19], v10 offset:61952
    v_cvt_pk_bf16_f32 v42, v136, v137
    v_cvt_pk_bf16_f32 v43, v138, v139
    ds_write_b128 v3, v[40:43] offset:0
    v_mfma_f32_16x16x32_bf16 v[176:179], v[200:203], v[32:35], v[176:179]
    ds_read_b64_tr_b16 v[20:21], v11 offset:61440
    v_cvt_pk_bf16_f32 v44, v132, v133
    v_cvt_pk_bf16_f32 v45, v134, v135
    v_cvt_pk_bf16_f32 v46, v140, v141
    v_mfma_f32_16x16x32_bf16 v[184:187], v[204:207], v[32:35], v[184:187]
    ds_read_b64_tr_b16 v[22:23], v11 offset:61952
    v_cvt_pk_bf16_f32 v47, v142, v143
    ds_write_b128 v3, v[44:47] offset:1024
    v_cvt_pk_bf16_f32 v48, v144, v145
    s_waitcnt lgkmcnt(6)
    v_mfma_f32_16x16x32_bf16 v[188:191], v[204:207], v[36:39], v[188:191]
    v_cvt_pk_bf16_f32 v49, v146, v147
    v_cvt_pk_bf16_f32 v50, v152, v153
    v_cvt_pk_bf16_f32 v51, v154, v155
    v_mfma_f32_16x16x32_bf16 v[180:183], v[200:203], v[36:39], v[180:183]
    ds_write_b128 v3, v[48:51] offset:2048
    v_cvt_pk_bf16_f32 v52, v148, v149
    v_cvt_pk_bf16_f32 v53, v150, v151
    v_mfma_f32_16x16x32_bf16 v[172:175], v[196:199], v[36:39], v[172:175]
    v_cvt_pk_bf16_f32 v54, v156, v157
    v_cvt_pk_bf16_f32 v55, v158, v159
    v_mfma_f32_16x16x32_bf16 v[164:167], v[192:195], v[36:39], v[164:167]
    ds_write_b128 v3, v[52:55] offset:3072
    ds_write_b32 v1, v0
    s_waitcnt lgkmcnt(7)
    v_mfma_f32_16x16x32_bf16 v[160:163], v[208:211], v[16:19], v[160:163]
    ds_read_b64_tr_b16 v[24:25], v14 offset:16384
    v_pk_max_u16 v72, v40, v41
    v_mfma_f32_16x16x32_bf16 v[168:171], v[212:215], v[16:19], v[168:171]
    ds_read_b64_tr_b16 v[26:27], v14 offset:16896
    v_pk_max_u16 v72, v72, v42
    v_mfma_f32_16x16x32_bf16 v[176:179], v[216:219], v[16:19], v[176:179]
    ds_read_b64_tr_b16 v[28:29], v15 offset:16384
    v_pk_max_u16 v72, v72, v43
    v_mfma_f32_16x16x32_bf16 v[184:187], v[220:223], v[16:19], v[184:187]
    ds_read_b64_tr_b16 v[30:31], v15 offset:16896
    v_pk_max_u16 v72, v72, v44
    s_waitcnt lgkmcnt(8)
    v_mfma_f32_16x16x32_bf16 v[188:191], v[220:223], v[20:23], v[188:191]
    v_pk_max_u16 v72, v72, v45
    v_mfma_f32_16x16x32_bf16 v[180:183], v[216:219], v[20:23], v[180:183]
    v_pk_max_u16 v72, v72, v46
    v_mfma_f32_16x16x32_bf16 v[172:175], v[212:215], v[20:23], v[172:175]
    v_pk_max_u16 v72, v72, v47
    v_mfma_f32_16x16x32_bf16 v[164:167], v[208:211], v[20:23], v[164:167]
    s_waitcnt lgkmcnt(2)
    v_mfma_f32_16x16x32_bf16 v[160:163], v[224:227], v[24:27], v[160:163]
    ds_read_b64_tr_b16 v[32:33], v14 offset:20480
    v_pk_max_u16 v72, v72, v48
    v_mfma_f32_16x16x32_bf16 v[168:171], v[228:231], v[24:27], v[168:171]
    ds_read_b64_tr_b16 v[34:35], v14 offset:20992
    v_pk_max_u16 v72, v72, v49
    v_mfma_f32_16x16x32_bf16 v[176:179], v[232:235], v[24:27], v[176:179]
    ds_read_b64_tr_b16 v[36:37], v15 offset:20480
    v_pk_max_u16 v72, v72, v50
    v_mfma_f32_16x16x32_bf16 v[184:187], v[236:239], v[24:27], v[184:187]
    ds_read_b64_tr_b16 v[38:39], v15 offset:20992
    v_pk_max_u16 v72, v72, v51
    s_waitcnt lgkmcnt(4)
    v_mfma_f32_16x16x32_bf16 v[188:191], v[236:239], v[28:31], v[188:191]
    v_pk_max_u16 v72, v72, v52
    v_mfma_f32_16x16x32_bf16 v[180:183], v[232:235], v[28:31], v[180:183]
    v_pk_max_u16 v72, v72, v53
    v_mfma_f32_16x16x32_bf16 v[172:175], v[228:231], v[28:31], v[172:175]
    v_pk_max_u16 v72, v72, v54
    v_mfma_f32_16x16x32_bf16 v[164:167], v[224:227], v[28:31], v[164:167]
    v_pk_max_u16 v72, v72, v55
    s_waitcnt lgkmcnt(2)
    v_mfma_f32_16x16x32_bf16 v[160:163], v[240:243], v[32:35], v[160:163]
    ds_read_b64_tr_b16 v[16:17], v10 offset:40960
    v_add_u32 v3, 65536, v3
    v_mfma_f32_16x16x32_bf16 v[168:171], v[244:247], v[32:35], v[168:171]
    ds_read_b64_tr_b16 v[18:19], v10 offset:41472
    v_lshrrev_b32 v73, 16, v72
    v_mfma_f32_16x16x32_bf16 v[176:179], v[248:251], v[32:35], v[176:179]
    ds_read_b64_tr_b16 v[20:21], v11 offset:40960
    v_and_b32 v72, 0xffff, v72
    v_mfma_f32_16x16x32_bf16 v[184:187], v[252:255], v[32:35], v[184:187]
    ds_read_b64_tr_b16 v[22:23], v11 offset:41472
    v_max_u32 v72, v72, v73
    s_waitcnt lgkmcnt(4)
    v_mfma_f32_16x16x32_bf16 v[188:191], v[252:255], v[36:39], v[188:191]
    v_cmp_lt_u32 vcc, 0xc0db, v72
    v_mfma_f32_16x16x32_bf16 v[180:183], v[248:251], v[36:39], v[180:183]
    s_cmp_lg_u64 vcc, 0
    v_mfma_f32_16x16x32_bf16 v[172:175], v[244:247], v[36:39], v[172:175]
    s_cselect_b32 s66, 2, 1
    v_mfma_f32_16x16x32_bf16 v[164:167], v[240:243], v[36:39], v[164:167]
    v_mov_b32 v0, s66
    s_waitcnt lgkmcnt(2)
    v_mfma_f32_16x16x32_bf16 v[96:99], v[16:19], v[192:195], v[96:99]
    ds_read_b64_tr_b16 v[24:25], v10 offset:45056
    s_nop 5
    v_cvt_pk_bf16_f32 v40, v160, v161
    v_cvt_pk_bf16_f32 v41, v162, v163
    v_mfma_f32_16x16x32_bf16 v[104:107], v[16:19], v[196:199], v[104:107]
    ds_read_b64_tr_b16 v[26:27], v10 offset:45568
    v_cvt_pk_bf16_f32 v42, v168, v169
    v_cvt_pk_bf16_f32 v43, v170, v171
    ds_write_b128 v3, v[40:43] offset:0
    v_mfma_f32_16x16x32_bf16 v[112:115], v[16:19], v[200:203], v[112:115]
    ds_read_b64_tr_b16 v[28:29], v11 offset:45056
    v_cvt_pk_bf16_f32 v44, v164, v165
    v_cvt_pk_bf16_f32 v45, v166, v167
    v_cvt_pk_bf16_f32 v46, v172, v173
    v_mfma_f32_16x16x32_bf16 v[120:123], v[16:19], v[204:207], v[120:123]
    ds_read_b64_tr_b16 v[30:31], v11 offset:45568
    v_cvt_pk_bf16_f32 v47, v174, v175
    ds_write_b128 v3, v[44:47] offset:1024
    v_cvt_pk_bf16_f32 v48, v176, v177
    s_waitcnt lgkmcnt(6)
    v_mfma_f32_16x16x32_bf16 v[124:127], v[20:23], v[204:207], v[124:127]
    v_cvt_pk_bf16_f32 v49, v178, v179
    v_cvt_pk_bf16_f32 v50, v184, v185
    v_cvt_pk_bf16_f32 v51, v186, v187
    v_mfma_f32_16x16x32_bf16 v[116:119], v[20:23], v[200:203], v[116:119]
    ds_write_b128 v3, v[48:51] offset:2048
    v_cvt_pk_bf16_f32 v52, v180, v181
    v_cvt_pk_bf16_f32 v53, v182, v183
    v_mfma_f32_16x16x32_bf16 v[108:111], v[20:23], v[196:199], v[108:111]
    v_cvt_pk_bf16_f32 v54, v188, v189
    v_cvt_pk_bf16_f32 v55, v190, v191
    v_mfma_f32_16x16x32_bf16 v[100:103], v[20:23], v[192:195], v[100:103]
    ds_write_b128 v3, v[52:55] offset:3072
    ds_write_b32 v1, v0 offset:16
    s_waitcnt lgkmcnt(7)
    v_mfma_f32_16x16x32_bf16 v[96:99], v[24:27], v[208:211], v[96:99]
    ds_read_b64_tr_b16 v[32:33], v6 offset:0
    v_lshlrev_b32 v9, 4, v2
    v_mov_b32 v136, 0
    v_mfma_f32_16x16x32_bf16 v[104:107], v[24:27], v[212:215], v[104:107]
    ds_read_b64_tr_b16 v[34:35], v6 offset:512
    v_mov_b32 v137, 0
    v_mfma_f32_16x16x32_bf16 v[112:115], v[24:27], v[216:219], v[112:115]
    ds_read_b64_tr_b16 v[36:37], v7 offset:0
    v_mov_b32 v140, 0
    v_mfma_f32_16x16x32_bf16 v[120:123], v[24:27], v[220:223], v[120:123]
    ds_read_b64_tr_b16 v[38:39], v7 offset:512
    v_mov_b32 v141, 0
    s_waitcnt lgkmcnt(8)
    v_mfma_f32_16x16x32_bf16 v[124:127], v[28:31], v[220:223], v[124:127]
    v_mov_b32 v138, v94
    v_mfma_f32_16x16x32_bf16 v[116:119], v[28:31], v[216:219], v[116:119]
    v_mov_b32 v139, v95
    v_mfma_f32_16x16x32_bf16 v[108:111], v[28:31], v[212:215], v[108:111]
    buffer_load_dwordx4 v[144:147], v91, s[8:11], 0 offen offset:0
    v_mfma_f32_16x16x32_bf16 v[100:103], v[28:31], v[208:211], v[100:103]
    buffer_load_dwordx4 v[148:151], v91, s[8:11], 0 offen offset:64
    s_waitcnt lgkmcnt(2)
    v_mfma_f32_16x16x32_bf16 v[96:99], v[32:35], v[224:227], v[96:99]
    ds_read_b64_tr_b16 v[16:17], v6 offset:4096
    v_mov_b32 v76, 155664
    v_mfma_f32_16x16x32_bf16 v[104:107], v[32:35], v[228:231], v[104:107]
    ds_read_b64_tr_b16 v[18:19], v6 offset:4608
    v_mfma_f32_16x16x32_bf16 v[112:115], v[32:35], v[232:235], v[112:115]
    ds_read_b64_tr_b16 v[20:21], v7 offset:4096
    v_mfma_f32_16x16x32_bf16 v[120:123], v[32:35], v[236:239], v[120:123]
    ds_read_b64_tr_b16 v[22:23], v7 offset:4608
    s_waitcnt lgkmcnt(4)
    v_mfma_f32_16x16x32_bf16 v[124:127], v[36:39], v[236:239], v[124:127]
    v_mfma_f32_16x16x32_bf16 v[116:119], v[36:39], v[232:235], v[116:119]
    v_mfma_f32_16x16x32_bf16 v[108:111], v[36:39], v[228:231], v[108:111]
    v_mfma_f32_16x16x32_bf16 v[100:103], v[36:39], v[224:227], v[100:103]
    s_waitcnt lgkmcnt(2)
    v_mfma_f32_16x16x32_bf16 v[96:99], v[16:19], v[240:243], v[96:99]
    ds_read_b128 v[72:75], v76
    v_mfma_f32_16x16x32_bf16 v[104:107], v[16:19], v[244:247], v[104:107]
    v_mfma_f32_16x16x32_bf16 v[112:115], v[16:19], v[248:251], v[112:115]
    v_mfma_f32_16x16x32_bf16 v[120:123], v[16:19], v[252:255], v[120:123]
    s_waitcnt lgkmcnt(1)
    v_mfma_f32_16x16x32_bf16 v[124:127], v[20:23], v[252:255], v[124:127]
    v_mfma_f32_16x16x32_bf16 v[116:119], v[20:23], v[248:251], v[116:119]
    v_mfma_f32_16x16x32_bf16 v[108:111], v[20:23], v[244:247], v[108:111]
    v_mfma_f32_16x16x32_bf16 v[100:103], v[20:23], v[240:243], v[100:103]
    s_nop 7
    v_cvt_pk_bf16_f32 v16, v96, v97
    v_cvt_pk_bf16_f32 v17, v98, v99
    v_cvt_pk_bf16_f32 v18, v100, v101
    v_cvt_pk_bf16_f32 v19, v102, v103
    v_cvt_pk_bf16_f32 v20, v104, v105
    v_cvt_pk_bf16_f32 v21, v106, v107
    v_cvt_pk_bf16_f32 v22, v108, v109
    v_cvt_pk_bf16_f32 v23, v110, v111
    v_cvt_pk_bf16_f32 v40, v112, v113
    v_cvt_pk_bf16_f32 v41, v114, v115
    v_cvt_pk_bf16_f32 v42, v116, v117
    v_cvt_pk_bf16_f32 v43, v118, v119
    v_cvt_pk_bf16_f32 v44, v120, v121
    v_cvt_pk_bf16_f32 v45, v122, v123
    v_cvt_pk_bf16_f32 v46, v124, v125
    v_cvt_pk_bf16_f32 v47, v126, v127
    s_lshl_b32 s66, s3, 11
    s_add_u32 s66, s66, 139264
    v_lshlrev_b32 v3, 4, v2
    v_add_u32 v3, s66, v3
C_qw:
    s_waitcnt lgkmcnt(0)
    v_min_u32 v72, v72, v73
    v_min3_u32 v72, v72, v74, v75
    v_cmp_eq_u32 vcc, 0, v72
    s_cbranch_vccz C_qg
    ds_read_b128 v[72:75], v76
    s_branch C_qw
C_qg:
    ds_write_b128 v3, v[40:43]
    ds_write_b128 v3, v[44:47] offset:1024
    s_waitcnt lgkmcnt(0)
    s_barrier
    v_lshlrev_b32 v32, 16, v16
    v_and_b32 v33, 0xffff0000, v16
    v_pk_mul_f32 v[34:35], v[32:33], s[70:71]
    v_pk_add_f32 v[32:33], v[32:33], 1.0 op_sel_hi:[1,0]
    v_exp_f32 v34, v34 clamp
    v_exp_f32 v35, v35 clamp
    v_lshlrev_b32 v36, 16, v17
    v_and_b32 v37, 0xffff0000, v17
    v_pk_mul_f32 v[38:39], v[36:37], s[70:71]
    v_pk_add_f32 v[36:37], v[36:37], 1.0 op_sel_hi:[1,0]
    v_exp_f32 v38, v38 clamp
    v_exp_f32 v39, v39 clamp
    v_max_f32 v32, v32, v34
    v_max_f32 v33, v33, v35
    v_min_f32 v40, v32, v33
    v_cvt_pk_bf16_f32 v24, v32, v33
    v_max_f32 v36, v36, v38
    v_max_f32 v37, v37, v39
    v_min3_f32 v40, v36, v37, v40
    v_cvt_pk_bf16_f32 v25, v36, v37
    v_lshlrev_b32 v32, 16, v18
    v_and_b32 v33, 0xffff0000, v18
    v_pk_mul_f32 v[34:35], v[32:33], s[70:71]
    v_pk_add_f32 v[32:33], v[32:33], 1.0 op_sel_hi:[1,0]
    v_exp_f32 v34, v34 clamp
    v_exp_f32 v35, v35 clamp
    v_lshlrev_b32 v36, 16, v19
    v_and_b32 v37, 0xffff0000, v19
    v_pk_mul_f32 v[38:39], v[36:37], s[70:71]
    v_pk_add_f32 v[36:37], v[36:37], 1.0 op_sel_hi:[1,0]
    v_exp_f32 v38, v38 clamp
    v_exp_f32 v39, v39 clamp
    v_max_f32 v32, v32, v34
    v_max_f32 v33, v33, v35
    v_min3_f32 v40, v32, v33, v40
    v_cvt_pk_bf16_f32 v26, v32, v33
    v_max_f32 v36, v36, v38
    v_max_f32 v37, v37, v39
    v_min3_f32 v40, v36, v37, v40
    v_cvt_pk_bf16_f32 v27, v36, v37
    v_lshlrev_b32 v32, 16, v20
    v_and_b32 v33, 0xffff0000, v20
    v_pk_mul_f32 v[34:35], v[32:33], s[70:71]
    v_pk_add_f32 v[32:33], v[32:33], 1.0 op_sel_hi:[1,0]
    v_exp_f32 v34, v34 clamp
    v_exp_f32 v35, v35 clamp
    v_lshlrev_b32 v36, 16, v21
    v_and_b32 v37, 0xffff0000, v21
    v_pk_mul_f32 v[38:39], v[36:37], s[70:71]
    v_pk_add_f32 v[36:37], v[36:37], 1.0 op_sel_hi:[1,0]
    v_exp_f32 v38, v38 clamp
    v_exp_f32 v39, v39 clamp
    v_max_f32 v32, v32, v34
    v_max_f32 v33, v33, v35
    v_min3_f32 v40, v32, v33, v40
    v_cvt_pk_bf16_f32 v28, v32, v33
    v_max_f32 v36, v36, v38
    v_max_f32 v37, v37, v39
    v_min3_f32 v40, v36, v37, v40
    v_cvt_pk_bf16_f32 v29, v36, v37
    v_lshlrev_b32 v32, 16, v22
    v_and_b32 v33, 0xffff0000, v22
    v_pk_mul_f32 v[34:35], v[32:33], s[70:71]
    v_pk_add_f32 v[32:33], v[32:33], 1.0 op_sel_hi:[1,0]
    v_exp_f32 v34, v34 clamp
    v_exp_f32 v35, v35 clamp
    v_lshlrev_b32 v36, 16, v23
    v_and_b32 v37, 0xffff0000, v23
    v_pk_mul_f32 v[38:39], v[36:37], s[70:71]
    v_pk_add_f32 v[36:37], v[36:37], 1.0 op_sel_hi:[1,0]
    v_exp_f32 v38, v38 clamp
    v_exp_f32 v39, v39 clamp
    v_max_f32 v32, v32, v34
    v_max_f32 v33, v33, v35
    v_min3_f32 v40, v32, v33, v40
    v_cvt_pk_bf16_f32 v30, v32, v33
    v_max_f32 v36, v36, v38
    v_max_f32 v37, v37, v39
    v_min3_f32 v40, v36, v37, v40
    v_cvt_pk_bf16_f32 v31, v36, v37
    v_cmp_gt_f32 vcc, 0x3a800000, v40
    s_cbranch_vccz P_qd
    v_lshlrev_b32 v32, 16, v24
    v_and_b32 v33, 0xffff0000, v24
    v_add_f32 v32, s47, v32
    v_add_f32 v33, s47, v33
    v_cvt_pk_bf16_f32 v24, v32, v33
    v_lshlrev_b32 v32, 16, v25
    v_and_b32 v33, 0xffff0000, v25
    v_add_f32 v32, s47, v32
    v_add_f32 v33, s47, v33
    v_cvt_pk_bf16_f32 v25, v32, v33
    v_lshlrev_b32 v32, 16, v26
    v_and_b32 v33, 0xffff0000, v26
    v_add_f32 v32, s47, v32
    v_add_f32 v33, s47, v33
    v_cvt_pk_bf16_f32 v26, v32, v33
    v_lshlrev_b32 v32, 16, v27
    v_and_b32 v33, 0xffff0000, v27
    v_add_f32 v32, s47, v32
    v_add_f32 v33, s47, v33
    v_cvt_pk_bf16_f32 v27, v32, v33
    v_lshlrev_b32 v32, 16, v28
    v_and_b32 v33, 0xffff0000, v28
    v_add_f32 v32, s47, v32
    v_add_f32 v33, s47, v33
    v_cvt_pk_bf16_f32 v28, v32, v33
    v_lshlrev_b32 v32, 16, v29
    v_and_b32 v33, 0xffff0000, v29
    v_add_f32 v32, s47, v32
    v_add_f32 v33, s47, v33
    v_cvt_pk_bf16_f32 v29, v32, v33
    v_lshlrev_b32 v32, 16, v30
    v_and_b32 v33, 0xffff0000, v30
    v_add_f32 v32, s47, v32
    v_add_f32 v33, s47, v33
    v_cvt_pk_bf16_f32 v30, v32, v33
    v_lshlrev_b32 v32, 16, v31
    v_and_b32 v33, 0xffff0000, v31
    v_add_f32 v32, s47, v32
    v_add_f32 v33, s47, v33
    v_cvt_pk_bf16_f32 v31, v32, v33
P_qd:
    buffer_load_dwordx4 v[232:235], v89, s[16:19], 0 offen sc1
    s_lshl_b32 s66, s49, 11
    s_add_u32 s66, s66, 159744
    v_add_u32 v10, s66, v9
    s_lshl_b32 s66, s49, 6
    s_add_u32 s66, s66, 159488
    v_lshrrev_b32 v11, 4, v2
    v_lshlrev_b32 v11, 4, v11
    v_add_u32 v11, s66, v11
    s_lshr_b32 s66, s44, 1
    s_lshl_b32 s67, s66, 11
    s_lshl_b32 s66, s66, 6
    s_and_b32 s59, s44, 1
    s_lshl_b32 s59, s59, 3
    s_add_u32 s66, s66, s59
    s_add_u32 s67, s67, s59
    s_add_u32 s66, s66, 159488
    s_add_u32 s67, s67, 159744
    v_add_u32 v12, s67, v9
    v_lshrrev_b32 v13, 4, v2
    v_lshlrev_b32 v13, 4, v13
    v_add_u32 v13, s66, v13
    s_mov_b32 s59, 0
P_z:
    s_add_u32 s59, s59, 1
    s_cmp_ge_u32 s59, 200000
    s_waitcnt vmcnt(0)
    s_cbranch_scc1 P_zk
    v_max_u32 v14, v232, v233
    v_max3_u32 v14, v14, v234, v235
    v_cmp_eq_u32 vcc, -1, v14
    s_cbranch_vccz P_zk
    buffer_load_dwordx4 v[232:235], v89, s[16:19], 0 offen sc1
    s_branch P_z
P_zk:
    s_xor_b32 s66, s57, 0
    buffer_load_dwordx4 v[160:163], v88, s[16:19], s66 offen offset:0 sc1
    s_xor_b32 s66, s57, 0
    buffer_load_dwordx4 v[164:167], v88, s[16:19], s66 offen offset:1024 sc1
    s_xor_b32 s66, s57, 0
    buffer_load_dwordx4 v[168:171], v88, s[16:19], s66 offen offset:2048 sc1
    s_xor_b32 s66, s57, 0
    buffer_load_dwordx4 v[172:175], v88, s[16:19], s66 offen offset:3072 sc1
    s_xor_b32 s66, s57, 4096
    buffer_load_dwordx4 v[176:179], v88, s[16:19], s66 offen offset:0 sc1
    s_xor_b32 s66, s57, 4096
    buffer_load_dwordx4 v[180:183], v88, s[16:19], s66 offen offset:1024 sc1
    s_xor_b32 s66, s57, 4096
    buffer_load_dwordx4 v[184:187], v88, s[16:19], s66 offen offset:2048 sc1
    s_xor_b32 s66, s57, 4096
    buffer_load_dwordx4 v[188:191], v88, s[16:19], s66 offen offset:3072 sc1
    s_xor_b32 s66, s57, 8192
    buffer_load_dwordx4 v[192:195], v88, s[16:19], s66 offen offset:0 sc1
    s_xor_b32 s66, s57, 8192
    buffer_load_dwordx4 v[196:199], v88, s[16:19], s66 offen offset:1024 sc1
    s_xor_b32 s66, s57, 8192
    buffer_load_dwordx4 v[200:203], v88, s[16:19], s66 offen offset:2048 sc1
    s_xor_b32 s66, s57, 8192
    buffer_load_dwordx4 v[204:207], v88, s[16:19], s66 offen offset:3072 sc1
    s_xor_b32 s66, s57, 12288
    buffer_load_dwordx4 v[208:211], v88, s[16:19], s66 offen offset:0 sc1
    s_xor_b32 s66, s57, 12288
    buffer_load_dwordx4 v[212:215], v88, s[16:19], s66 offen offset:1024 sc1
    s_xor_b32 s66, s57, 12288
    buffer_load_dwordx4 v[216:219], v88, s[16:19], s66 offen offset:2048 sc1
    s_xor_b32 s66, s57, 12288
    buffer_load_dwordx4 v[220:223], v88, s[16:19], s66 offen offset:3072 sc1
    v_add_f32_dpp v232, v232, v232 quad_perm:[1,0,3,2] row_mask:0xf bank_mask:0xf
    v_add_f32_dpp v233, v233, v233 quad_perm:[1,0,3,2] row_mask:0xf bank_mask:0xf
    v_add_f32_dpp v234, v234, v234 quad_perm:[1,0,3,2] row_mask:0xf bank_mask:0xf
    v_add_f32_dpp v235, v235, v235 quad_perm:[1,0,3,2] row_mask:0xf bank_mask:0xf
    v_add_f32_dpp v232, v232, v232 quad_perm:[2,3,0,1] row_mask:0xf bank_mask:0xf
    v_add_f32_dpp v233, v233, v233 quad_perm:[2,3,0,1] row_mask:0xf bank_mask:0xf
    v_add_f32_dpp v234, v234, v234 quad_perm:[2,3,0,1] row_mask:0xf bank_mask:0xf
    v_add_f32_dpp v235, v235, v235 quad_perm:[2,3,0,1] row_mask:0xf bank_mask:0xf
    v_add_f32_dpp v232, v232, v232 row_half_mirror row_mask:0xf bank_mask:0xf
    v_add_f32_dpp v233, v233, v233 row_half_mirror row_mask:0xf bank_mask:0xf
    v_add_f32_dpp v234, v234, v234 row_half_mirror row_mask:0xf bank_mask:0xf
    v_add_f32_dpp v235, v235, v235 row_half_mirror row_mask:0xf bank_mask:0xf
    v_add_f32_dpp v232, v232, v232 row_mirror row_mask:0xf bank_mask:0xf
    v_add_f32_dpp v233, v233, v233 row_mirror row_mask:0xf bank_mask:0xf
    v_add_f32_dpp v234, v234, v234 row_mirror row_mask:0xf bank_mask:0xf
    v_add_f32_dpp v235, v235, v235 row_mirror row_mask:0xf bank_mask:0xf
    v_cvt_pk_bf16_f32 v232, v232, v233
    v_cvt_pk_bf16_f32 v233, v234, v235
    ds_write_b64 v13, v[232:233]
    s_waitcnt vmcnt(15)
    v_max_u32 v14, v160, v161
    v_max3_u32 v14, v14, v162, v163
    v_mfma_f32_16x16x32_bf16 v[224:227], v[138:141], v[160:163], 0
    v_mfma_f32_16x16x32_bf16 v[228:231], v[136:139], v[160:163], 0
    s_waitcnt vmcnt(14)
    v_max3_u32 v14, v14, v164, v165
    v_max3_u32 v14, v14, v166, v167
    v_mfma_f32_16x16x32_bf16 v[224:227], v[138:141], v[164:167], v[224:227]
    v_mfma_f32_16x16x32_bf16 v[228:231], v[136:139], v[164:167], v[228:231]
    s_waitcnt vmcnt(13)
    v_max3_u32 v14, v14, v168, v169
    v_max3_u32 v14, v14, v170, v171
    v_mfma_f32_16x16x32_bf16 v[224:227], v[138:141], v[168:171], v[224:227]
    v_mfma_f32_16x16x32_bf16 v[228:231], v[136:139], v[168:171], v[228:231]
    s_waitcnt vmcnt(12)
    v_max3_u32 v14, v14, v172, v173
    v_max3_u32 v14, v14, v174, v175
    v_mfma_f32_16x16x32_bf16 v[224:227], v[138:141], v[172:175], v[224:227]
    v_mfma_f32_16x16x32_bf16 v[228:231], v[136:139], v[172:175], v[228:231]
    s_waitcnt vmcnt(11)
    v_max3_u32 v14, v14, v176, v177
    v_max3_u32 v14, v14, v178, v179
    v_mfma_f32_16x16x32_bf16 v[224:227], v[138:141], v[176:179], v[224:227]
    v_mfma_f32_16x16x32_bf16 v[228:231], v[136:139], v[176:179], v[228:231]
    s_waitcnt vmcnt(10)
    v_max3_u32 v14, v14, v180, v181
    v_max3_u32 v14, v14, v182, v183
    v_mfma_f32_16x16x32_bf16 v[224:227], v[138:141], v[180:183], v[224:227]
    v_mfma_f32_16x16x32_bf16 v[228:231], v[136:139], v[180:183], v[228:231]
    s_waitcnt vmcnt(9)
    v_max3_u32 v14, v14, v184, v185
    v_max3_u32 v14, v14, v186, v187
    v_mfma_f32_16x16x32_bf16 v[224:227], v[138:141], v[184:187], v[224:227]
    v_mfma_f32_16x16x32_bf16 v[228:231], v[136:139], v[184:187], v[228:231]
    s_waitcnt vmcnt(8)
    v_max3_u32 v14, v14, v188, v189
    v_max3_u32 v14, v14, v190, v191
    v_mfma_f32_16x16x32_bf16 v[224:227], v[138:141], v[188:191], v[224:227]
    v_mfma_f32_16x16x32_bf16 v[228:231], v[136:139], v[188:191], v[228:231]
    s_waitcnt vmcnt(7)
    v_max3_u32 v14, v14, v192, v193
    v_max3_u32 v14, v14, v194, v195
    v_mfma_f32_16x16x32_bf16 v[224:227], v[138:141], v[192:195], v[224:227]
    v_mfma_f32_16x16x32_bf16 v[228:231], v[136:139], v[192:195], v[228:231]
    s_waitcnt vmcnt(6)
    v_max3_u32 v14, v14, v196, v197
    v_max3_u32 v14, v14, v198, v199
    v_mfma_f32_16x16x32_bf16 v[224:227], v[138:141], v[196:199], v[224:227]
    v_mfma_f32_16x16x32_bf16 v[228:231], v[136:139], v[196:199], v[228:231]
    s_waitcnt vmcnt(5)
    v_max3_u32 v14, v14, v200, v201
    v_max3_u32 v14, v14, v202, v203
    v_mfma_f32_16x16x32_bf16 v[224:227], v[138:141], v[200:203], v[224:227]
    v_mfma_f32_16x16x32_bf16 v[228:231], v[136:139], v[200:203], v[228:231]
    s_waitcnt vmcnt(4)
    v_max3_u32 v14, v14, v204, v205
    v_max3_u32 v14, v14, v206, v207
    v_mfma_f32_16x16x32_bf16 v[224:227], v[138:141], v[204:207], v[224:227]
    v_mfma_f32_16x16x32_bf16 v[228:231], v[136:139], v[204:207], v[228:231]
    s_waitcnt vmcnt(3)
    v_max3_u32 v14, v14, v208, v209
    v_max3_u32 v14, v14, v210, v211
    v_mfma_f32_16x16x32_bf16 v[224:227], v[138:141], v[208:211], v[224:227]
    v_mfma_f32_16x16x32_bf16 v[228:231], v[136:139], v[208:211], v[228:231]
    s_waitcnt vmcnt(2)
    v_max3_u32 v14, v14, v212, v213
    v_max3_u32 v14, v14, v214, v215
    v_mfma_f32_16x16x32_bf16 v[224:227], v[138:141], v[212:215], v[224:227]
    v_mfma_f32_16x16x32_bf16 v[228:231], v[136:139], v[212:215], v[228:231]
    s_waitcnt vmcnt(1)
    v_max3_u32 v14, v14, v216, v217
    v_max3_u32 v14, v14, v218, v219
    v_mfma_f32_16x16x32_bf16 v[224:227], v[138:141], v[216:219], v[224:227]
    v_mfma_f32_16x16x32_bf16 v[228:231], v[136:139], v[216:219], v[228:231]
    s_waitcnt vmcnt(0)
    v_max3_u32 v14, v14, v220, v221
    v_max3_u32 v14, v14, v222, v223
    v_mfma_f32_16x16x32_bf16 v[224:227], v[138:141], v[220:223], v[224:227]
    v_mfma_f32_16x16x32_bf16 v[228:231], v[136:139], v[220:223], v[228:231]
    v_cmp_eq_u32 vcc, -1, v14
    s_cbranch_vccnz P_slow
P_h1ok:
    s_nop 5
    v_cvt_pk_bf16_f32 v224, v224, v225
    v_cvt_pk_bf16_f32 v225, v226, v227
    v_cvt_pk_bf16_f32 v226, v228, v229
    v_cvt_pk_bf16_f32 v227, v230, v231
    ds_write_b64 v12, v[224:225]
    ds_write_b64 v12, v[226:227] offset:1024
    s_branch POST
P_slow:
    s_mov_b32 s59, 0
P_retry:
    s_mov_b32 s76, 0
    v_max_u32 v14, v160, v161
    v_max3_u32 v14, v14, v162, v163
    v_cmp_eq_u32 vcc, -1, v14
    s_cbranch_vccz P_rc0
    s_xor_b32 s66, s57, 0
    buffer_load_dwordx4 v[160:163], v88, s[16:19], s66 offen offset:0 sc1
    s_mov_b32 s76, 1
P_rc0:
    v_max_u32 v14, v164, v165
    v_max3_u32 v14, v14, v166, v167
    v_cmp_eq_u32 vcc, -1, v14
    s_cbranch_vccz P_rc1
    s_xor_b32 s66, s57, 0
    buffer_load_dwordx4 v[164:167], v88, s[16:19], s66 offen offset:1024 sc1
    s_mov_b32 s76, 1
P_rc1:
    v_max_u32 v14, v168, v169
    v_max3_u32 v14, v14, v170, v171
    v_cmp_eq_u32 vcc, -1, v14
    s_cbranch_vccz P_rc2
    s_xor_b32 s66, s57, 0
    buffer_load_dwordx4 v[168:171], v88, s[16:19], s66 offen offset:2048 sc1
    s_mov_b32 s76, 1
P_rc2:
    v_max_u32 v14, v172, v173
    v_max3_u32 v14, v14, v174, v175
    v_cmp_eq_u32 vcc, -1, v14
    s_cbranch_vccz P_rc3
    s_xor_b32 s66, s57, 0
    buffer_load_dwordx4 v[172:175], v88, s[16:19], s66 offen offset:3072 sc1
    s_mov_b32 s76, 1
P_rc3:
    v_max_u32 v14, v176, v177
    v_max3_u32 v14, v14, v178, v179
    v_cmp_eq_u32 vcc, -1, v14
    s_cbranch_vccz P_rc4
    s_xor_b32 s66, s57, 4096
    buffer_load_dwordx4 v[176:179], v88, s[16:19], s66 offen offset:0 sc1
    s_mov_b32 s76, 1
P_rc4:
    v_max_u32 v14, v180, v181
    v_max3_u32 v14, v14, v182, v183
    v_cmp_eq_u32 vcc, -1, v14
    s_cbranch_vccz P_rc5
    s_xor_b32 s66, s57, 4096
    buffer_load_dwordx4 v[180:183], v88, s[16:19], s66 offen offset:1024 sc1
    s_mov_b32 s76, 1
P_rc5:
    v_max_u32 v14, v184, v185
    v_max3_u32 v14, v14, v186, v187
    v_cmp_eq_u32 vcc, -1, v14
    s_cbranch_vccz P_rc6
    s_xor_b32 s66, s57, 4096
    buffer_load_dwordx4 v[184:187], v88, s[16:19], s66 offen offset:2048 sc1
    s_mov_b32 s76, 1
P_rc6:
    v_max_u32 v14, v188, v189
    v_max3_u32 v14, v14, v190, v191
    v_cmp_eq_u32 vcc, -1, v14
    s_cbranch_vccz P_rc7
    s_xor_b32 s66, s57, 4096
    buffer_load_dwordx4 v[188:191], v88, s[16:19], s66 offen offset:3072 sc1
    s_mov_b32 s76, 1
P_rc7:
    v_max_u32 v14, v192, v193
    v_max3_u32 v14, v14, v194, v195
    v_cmp_eq_u32 vcc, -1, v14
    s_cbranch_vccz P_rc8
    s_xor_b32 s66, s57, 8192
    buffer_load_dwordx4 v[192:195], v88, s[16:19], s66 offen offset:0 sc1
    s_mov_b32 s76, 1
P_rc8:
    v_max_u32 v14, v196, v197
    v_max3_u32 v14, v14, v198, v199
    v_cmp_eq_u32 vcc, -1, v14
    s_cbranch_vccz P_rc9
    s_xor_b32 s66, s57, 8192
    buffer_load_dwordx4 v[196:199], v88, s[16:19], s66 offen offset:1024 sc1
    s_mov_b32 s76, 1
P_rc9:
    v_max_u32 v14, v200, v201
    v_max3_u32 v14, v14, v202, v203
    v_cmp_eq_u32 vcc, -1, v14
    s_cbranch_vccz P_rc10
    s_xor_b32 s66, s57, 8192
    buffer_load_dwordx4 v[200:203], v88, s[16:19], s66 offen offset:2048 sc1
    s_mov_b32 s76, 1
P_rc10:
    v_max_u32 v14, v204, v205
    v_max3_u32 v14, v14, v206, v207
    v_cmp_eq_u32 vcc, -1, v14
    s_cbranch_vccz P_rc11
    s_xor_b32 s66, s57, 8192
    buffer_load_dwordx4 v[204:207], v88, s[16:19], s66 offen offset:3072 sc1
    s_mov_b32 s76, 1
P_rc11:
    v_max_u32 v14, v208, v209
    v_max3_u32 v14, v14, v210, v211
    v_cmp_eq_u32 vcc, -1, v14
    s_cbranch_vccz P_rc12
    s_xor_b32 s66, s57, 12288
    buffer_load_dwordx4 v[208:211], v88, s[16:19], s66 offen offset:0 sc1
    s_mov_b32 s76, 1
P_rc12:
    v_max_u32 v14, v212, v213
    v_max3_u32 v14, v14, v214, v215
    v_cmp_eq_u32 vcc, -1, v14
    s_cbranch_vccz P_rc13
    s_xor_b32 s66, s57, 12288
    buffer_load_dwordx4 v[212:215], v88, s[16:19], s66 offen offset:1024 sc1
    s_mov_b32 s76, 1
P_rc13:
    v_max_u32 v14, v216, v217
    v_max3_u32 v14, v14, v218, v219
    v_cmp_eq_u32 vcc, -1, v14
    s_cbranch_vccz P_rc14
    s_xor_b32 s66, s57, 12288
    buffer_load_dwordx4 v[216:219], v88, s[16:19], s66 offen offset:2048 sc1
    s_mov_b32 s76, 1
P_rc14:
    v_max_u32 v14, v220, v221
    v_max3_u32 v14, v14, v222, v223
    v_cmp_eq_u32 vcc, -1, v14
    s_cbranch_vccz P_rc15
    s_xor_b32 s66, s57, 12288
    buffer_load_dwordx4 v[220:223], v88, s[16:19], s66 offen offset:3072 sc1
    s_mov_b32 s76, 1
P_rc15:
    s_add_u32 s59, s59, 1
    s_cmp_ge_u32 s59, 200000
    s_cselect_b32 s76, 0, s76
    s_waitcnt vmcnt(0)
    s_cmp_lg_u32 s76, 0
    s_cbranch_scc1 P_retry
    v_mfma_f32_16x16x32_bf16 v[224:227], v[138:141], v[160:163], 0
    v_mfma_f32_16x16x32_bf16 v[228:231], v[136:139], v[160:163], 0
    v_mfma_f32_16x16x32_bf16 v[224:227], v[138:141], v[164:167], v[224:227]
    v_mfma_f32_16x16x32_bf16 v[228:231], v[136:139], v[164:167], v[228:231]
    v_mfma_f32_16x16x32_bf16 v[224:227], v[138:141], v[168:171], v[224:227]
    v_mfma_f32_16x16x32_bf16 v[228:231], v[136:139], v[168:171], v[228:231]
    v_mfma_f32_16x16x32_bf16 v[224:227], v[138:141], v[172:175], v[224:227]
    v_mfma_f32_16x16x32_bf16 v[228:231], v[136:139], v[172:175], v[228:231]
    v_mfma_f32_16x16x32_bf16 v[224:227], v[138:141], v[176:179], v[224:227]
    v_mfma_f32_16x16x32_bf16 v[228:231], v[136:139], v[176:179], v[228:231]
    v_mfma_f32_16x16x32_bf16 v[224:227], v[138:141], v[180:183], v[224:227]
    v_mfma_f32_16x16x32_bf16 v[228:231], v[136:139], v[180:183], v[228:231]
    v_mfma_f32_16x16x32_bf16 v[224:227], v[138:141], v[184:187], v[224:227]
    v_mfma_f32_16x16x32_bf16 v[228:231], v[136:139], v[184:187], v[228:231]
    v_mfma_f32_16x16x32_bf16 v[224:227], v[138:141], v[188:191], v[224:227]
    v_mfma_f32_16x16x32_bf16 v[228:231], v[136:139], v[188:191], v[228:231]
    v_mfma_f32_16x16x32_bf16 v[224:227], v[138:141], v[192:195], v[224:227]
    v_mfma_f32_16x16x32_bf16 v[228:231], v[136:139], v[192:195], v[228:231]
    v_mfma_f32_16x16x32_bf16 v[224:227], v[138:141], v[196:199], v[224:227]
    v_mfma_f32_16x16x32_bf16 v[228:231], v[136:139], v[196:199], v[228:231]
    v_mfma_f32_16x16x32_bf16 v[224:227], v[138:141], v[200:203], v[224:227]
    v_mfma_f32_16x16x32_bf16 v[228:231], v[136:139], v[200:203], v[228:231]
    v_mfma_f32_16x16x32_bf16 v[224:227], v[138:141], v[204:207], v[224:227]
    v_mfma_f32_16x16x32_bf16 v[228:231], v[136:139], v[204:207], v[228:231]
    v_mfma_f32_16x16x32_bf16 v[224:227], v[138:141], v[208:211], v[224:227]
    v_mfma_f32_16x16x32_bf16 v[228:231], v[136:139], v[208:211], v[228:231]
    v_mfma_f32_16x16x32_bf16 v[224:227], v[138:141], v[212:215], v[224:227]
    v_mfma_f32_16x16x32_bf16 v[228:231], v[136:139], v[212:215], v[228:231]
    v_mfma_f32_16x16x32_bf16 v[224:227], v[138:141], v[216:219], v[224:227]
    v_mfma_f32_16x16x32_bf16 v[228:231], v[136:139], v[216:219], v[228:231]
    v_mfma_f32_16x16x32_bf16 v[224:227], v[138:141], v[220:223], v[224:227]
    v_mfma_f32_16x16x32_bf16 v[228:231], v[136:139], v[220:223], v[228:231]
    s_nop 1
    s_branch P_h1ok
HELP:
    v_lshlrev_b32 v9, 4, v2
    s_lshl_b32 s56, s5, 2
    s_add_u32 s56, s56, s44
    s_lshl_b32 s53, s56, 10
    s_lshl_b32 s66, s4, 6
    s_add_u32 s53, s53, s66
    s_add_u32 s53, s53, 5242880
    s_lshl_b32 s56, s56, 4
    s_add_u32 s56, s56, s4
    s_lshl_b32 s56, s56, 10
    s_add_u32 s56, s56, 4194304
    s_lshl_b32 s55, s73, 2
    s_add_u32 s55, s55, s44
    s_lshl_b32 s55, s55, 6
    s_add_u32 s55, s55, s79
    s_lshl_b32 s55, s55, 8
    s_add_u32 s55, s55, 5832704
    v_lshrrev_b32 v12, 3, v2
    s_lshl_b32 s67, s44, 3
    v_add_u32 v12, s67, v12
    v_lshlrev_b32 v12, 11, v12
    v_lshrrev_b32 v13, 4, v2
    v_lshlrev_b32 v13, 1, v13
    v_and_b32 v90, 7, v2
    v_xor_b32 v13, v13, v90
    v_lshl_add_u32 v12, v13, 4, v12
    s_lshl_b32 s66, s7, 7
    v_add_u32 v90, s66, v12
    s_lshl_b32 s66, s6, 7
    s_lshl_b32 s67, s44, 5
    s_add_u32 s66, s66, s67
    s_lshl_b32 s67, s45, 4
    s_add_u32 s66, s66, s67
    v_and_b32 v92, 15, v2
    v_add_u32 v92, s66, v92
    v_lshlrev_b32 v91, 11, v92
    v_bfe_u32 v12, v2, 4, 1
    v_lshl_add_u32 v91, v12, 5, v91
    v_lshrrev_b32 v12, 5, v2
    v_lshl_add_u32 v91, v12, 4, v91
    s_lshl_b32 s66, s7, 7
    v_add_u32 v91, s66, v91
    v_lshrrev_b32 v93, 2, v92
    v_lshlrev_b32 v93, 6, v93
    v_and_b32 v12, 3, v2
    v_lshl_add_u32 v93, v12, 2, v93
    s_lshl_b32 s66, s6, 1
    s_and_b32 s66, s66, 6
    s_lshl_b32 s67, s7, 2
    s_add_u32 s66, s66, s67
    s_and_b32 s66, s66, 7
    s_lshl_b32 s52, s66, 18
    s_lshr_b32 s49, s44, 1
    s_and_b32 s66, s44, 1
    s_lshl_b32 s66, s66, 2
    s_lshl_b32 s67, s45, 1
    s_add_u32 s66, s66, s67
    s_lshl_b32 s67, s4, 3
    s_add_u32 s66, s66, s67
    s_lshl_b32 s66, s66, 5
    s_lshl_b32 s67, s5, 1
    s_add_u32 s66, s66, s67
    s_add_u32 s66, s66, s49
    s_lshl_b32 s60, s66, 10
    s_add_u32 s61, s60, 32768
    v_lshrrev_b32 v10, 5, v2
    v_and_b32 v11, 31, v2
    v_lshlrev_b32 v12, 3, v10
    s_lshl_b32 s66, s79, 6
    s_lshl_b32 s67, s44, 4
    s_add_u32 s66, s66, s67
    v_add_u32 v12, s66, v12
    v_lshlrev_b32 v12, 11, v12
    v_lshl_add_u32 v12, v11, 4, v12
    s_lshl_b32 s66, s73, 9
    v_add_u32 v7, s66, v12
    s_lshr_b32 s62, s79, 2
    s_lshl_b32 s62, s62, 15
    s_and_b32 s66, s79, 3
    s_lshl_b32 s66, s66, 8
    s_add_u32 s62, s62, s66
    s_lshl_b32 s66, s44, 6
    s_add_u32 s62, s62, s66
    s_add_u32 s62, s62, 5308416
    s_add_u32 s63, s62, 16384
    v_lshrrev_b32 v1, 2, v2
    v_lshlrev_b32 v1, 10, v1
    v_and_b32 v13, 3, v2
    v_lshl_add_u32 v1, v13, 4, v1
    s_cmp_ge_u32 s44, 2
    s_cbranch_scc1 WORK
    s_waitcnt vmcnt(5)
    s_barrier
    s_add_u32 s71, s76, 2
    s_and_b32 s71, s71, 15
    s_lshl_b32 s70, s71, 7
    s_mul_i32 s71, s71, 393216
    s_add_u32 m0, s72, 106496
    s_add_u32 s66, s71, 2048
    buffer_load_dwordx4 v5, s[12:15], s66 offen lds
    s_add_u32 m0, s72, 108544
    s_add_u32 s66, s71, 100352
    buffer_load_dwordx4 v5, s[12:15], s66 offen lds
    s_add_u32 m0, s72, 110592
    s_add_u32 s66, s71, 198656
    buffer_load_dwordx4 v5, s[12:15], s66 offen lds
    s_add_u32 m0, s72, 112640
    s_add_u32 s66, s71, 296960
    buffer_load_dwordx4 v5, s[12:15], s66 offen lds
    s_add_u32 m0, s72, 81920
    s_add_u32 s66, s70, 0
    buffer_load_dwordx4 v4, s[8:11], s66 offen lds
    s_add_u32 m0, s72, 83968
    s_add_u32 s66, s70, 32768
    buffer_load_dwordx4 v4, s[8:11], s66 offen lds
    s_add_u32 m0, s72, 86016
    s_add_u32 s66, s70, 65536
    buffer_load_dwordx4 v4, s[8:11], s66 offen lds
    s_add_u32 m0, s72, 88064
    s_add_u32 s66, s70, 98304
    buffer_load_dwordx4 v4, s[8:11], s66 offen lds
    s_add_u32 m0, s72, 90112
    s_add_u32 s66, s70, 131072
    buffer_load_dwordx4 v4, s[8:11], s66 offen lds
    s_add_u32 m0, s72, 92160
    s_add_u32 s66, s70, 163840
    buffer_load_dwordx4 v4, s[8:11], s66 offen lds
    s_add_u32 m0, s72, 94208
    s_add_u32 s66, s70, 196608
    buffer_load_dwordx4 v4, s[8:11], s66 offen lds
    s_add_u32 m0, s72, 96256
    s_add_u32 s66, s70, 229376
    buffer_load_dwordx4 v4, s[8:11], s66 offen lds
    s_add_u32 m0, s72, 114688
    s_add_u32 s66, s71, 4096
    buffer_load_dwordx4 v5, s[12:15], s66 offen lds
    s_add_u32 m0, s72, 116736
    s_add_u32 s66, s71, 102400
    buffer_load_dwordx4 v5, s[12:15], s66 offen lds
    s_add_u32 m0, s72, 118784
    s_add_u32 s66, s71, 200704
    buffer_load_dwordx4 v5, s[12:15], s66 offen lds
    s_add_u32 m0, s72, 120832
    s_add_u32 s66, s71, 299008
    buffer_load_dwordx4 v5, s[12:15], s66 offen lds
    s_add_u32 m0, s72, 98304
    s_add_u32 s66, s71, 0
    buffer_load_dwordx4 v5, s[12:15], s66 offen lds
    s_add_u32 m0, s72, 100352
    s_add_u32 s66, s71, 98304
    buffer_load_dwordx4 v5, s[12:15], s66 offen lds
    s_add_u32 m0, s72, 102400
    s_add_u32 s66, s71, 196608
    buffer_load_dwordx4 v5, s[12:15], s66 offen lds
    s_add_u32 m0, s72, 104448
    s_add_u32 s66, s71, 294912
    buffer_load_dwordx4 v5, s[12:15], s66 offen lds
    s_waitcnt vmcnt(20)
    s_barrier
    s_add_u32 s71, s76, 3
    s_and_b32 s71, s71, 15
    s_lshl_b32 s70, s71, 7
    s_mul_i32 s71, s71, 393216
    s_add_u32 m0, s72, 24576
    s_add_u32 s66, s71, 2048
    buffer_load_dwordx4 v5, s[12:15], s66 offen lds
    s_add_u32 m0, s72, 26624
    s_add_u32 s66, s71, 100352
    buffer_load_dwordx4 v5, s[12:15], s66 offen lds
    s_add_u32 m0, s72, 28672
    s_add_u32 s66, s71, 198656
    buffer_load_dwordx4 v5, s[12:15], s66 offen lds
    s_add_u32 m0, s72, 30720
    s_add_u32 s66, s71, 296960
    buffer_load_dwordx4 v5, s[12:15], s66 offen lds
    s_add_u32 m0, s72, 0
    s_add_u32 s66, s70, 0
    buffer_load_dwordx4 v4, s[8:11], s66 offen lds
    s_add_u32 m0, s72, 2048
    s_add_u32 s66, s70, 32768
    buffer_load_dwordx4 v4, s[8:11], s66 offen lds
    s_add_u32 m0, s72, 4096
    s_add_u32 s66, s70, 65536
    buffer_load_dwordx4 v4, s[8:11], s66 offen lds
    s_add_u32 m0, s72, 6144
    s_add_u32 s66, s70, 98304
    buffer_load_dwordx4 v4, s[8:11], s66 offen lds
    s_add_u32 m0, s72, 8192
    s_add_u32 s66, s70, 131072
    buffer_load_dwordx4 v4, s[8:11], s66 offen lds
    s_add_u32 m0, s72, 10240
    s_add_u32 s66, s70, 163840
    buffer_load_dwordx4 v4, s[8:11], s66 offen lds
    s_add_u32 m0, s72, 12288
    s_add_u32 s66, s70, 196608
    buffer_load_dwordx4 v4, s[8:11], s66 offen lds
    s_add_u32 m0, s72, 14336
    s_add_u32 s66, s70, 229376
    buffer_load_dwordx4 v4, s[8:11], s66 offen lds
    s_add_u32 m0, s72, 32768
    s_add_u32 s66, s71, 4096
    buffer_load_dwordx4 v5, s[12:15], s66 offen lds
    s_add_u32 m0, s72, 34816
    s_add_u32 s66, s71, 102400
    buffer_load_dwordx4 v5, s[12:15], s66 offen lds
    s_add_u32 m0, s72, 36864
    s_add_u32 s66, s71, 200704
    buffer_load_dwordx4 v5, s[12:15], s66 offen lds
    s_add_u32 m0, s72, 38912
    s_add_u32 s66, s71, 299008
    buffer_load_dwordx4 v5, s[12:15], s66 offen lds
    s_add_u32 m0, s72, 16384
    s_add_u32 s66, s71, 0
    buffer_load_dwordx4 v5, s[12:15], s66 offen lds
    s_add_u32 m0, s72, 18432
    s_add_u32 s66, s71, 98304
    buffer_load_dwordx4 v5, s[12:15], s66 offen lds
    s_add_u32 m0, s72, 20480
    s_add_u32 s66, s71, 196608
    buffer_load_dwordx4 v5, s[12:15], s66 offen lds
    s_add_u32 m0, s72, 22528
    s_add_u32 s66, s71, 294912
    buffer_load_dwordx4 v5, s[12:15], s66 offen lds
    s_waitcnt vmcnt(20)
    s_barrier
    s_add_u32 s71, s76, 4
    s_and_b32 s71, s71, 15
    s_lshl_b32 s70, s71, 7
    s_mul_i32 s71, s71, 393216
    s_add_u32 m0, s72, 65536
    s_add_u32 s66, s71, 2048
    buffer_load_dwordx4 v5, s[12:15], s66 offen lds
    s_add_u32 m0, s72, 67584
    s_add_u32 s66, s71, 100352
    buffer_load_dwordx4 v5, s[12:15], s66 offen lds
    s_add_u32 m0, s72, 69632
    s_add_u32 s66, s71, 198656
    buffer_load_dwordx4 v5, s[12:15], s66 offen lds
    s_add_u32 m0, s72, 71680
    s_add_u32 s66, s71, 296960
    buffer_load_dwordx4 v5, s[12:15], s66 offen lds
    s_add_u32 m0, s72, 40960
    s_add_u32 s66, s70, 0
    buffer_load_dwordx4 v4, s[8:11], s66 offen lds
    s_add_u32 m0, s72, 43008
    s_add_u32 s66, s70, 32768
    buffer_load_dwordx4 v4, s[8:11], s66 offen lds
    s_add_u32 m0, s72, 45056
    s_add_u32 s66, s70, 65536
    buffer_load_dwordx4 v4, s[8:11], s66 offen lds
    s_add_u32 m0, s72, 47104
    s_add_u32 s66, s70, 98304
    buffer_load_dwordx4 v4, s[8:11], s66 offen lds
    s_add_u32 m0, s72, 49152
    s_add_u32 s66, s70, 131072
    buffer_load_dwordx4 v4, s[8:11], s66 offen lds
    s_add_u32 m0, s72, 51200
    s_add_u32 s66, s70, 163840
    buffer_load_dwordx4 v4, s[8:11], s66 offen lds
    s_add_u32 m0, s72, 53248
    s_add_u32 s66, s70, 196608
    buffer_load_dwordx4 v4, s[8:11], s66 offen lds
    s_add_u32 m0, s72, 55296
    s_add_u32 s66, s70, 229376
    buffer_load_dwordx4 v4, s[8:11], s66 offen lds
    s_add_u32 m0, s72, 73728
    s_add_u32 s66, s71, 4096
    buffer_load_dwordx4 v5, s[12:15], s66 offen lds
    s_add_u32 m0, s72, 75776
    s_add_u32 s66, s71, 102400
    buffer_load_dwordx4 v5, s[12:15], s66 offen lds
    s_add_u32 m0, s72, 77824
    s_add_u32 s66, s71, 200704
    buffer_load_dwordx4 v5, s[12:15], s66 offen lds
    s_add_u32 m0, s72, 79872
    s_add_u32 s66, s71, 299008
    buffer_load_dwordx4 v5, s[12:15], s66 offen lds
    s_add_u32 m0, s72, 57344
    s_add_u32 s66, s71, 0
    buffer_load_dwordx4 v5, s[12:15], s66 offen lds
    s_add_u32 m0, s72, 59392
    s_add_u32 s66, s71, 98304
    buffer_load_dwordx4 v5, s[12:15], s66 offen lds
    s_add_u32 m0, s72, 61440
    s_add_u32 s66, s71, 196608
    buffer_load_dwordx4 v5, s[12:15], s66 offen lds
    s_add_u32 m0, s72, 63488
    s_add_u32 s66, s71, 294912
    buffer_load_dwordx4 v5, s[12:15], s66 offen lds
    s_waitcnt vmcnt(20)
    s_barrier
    s_add_u32 s71, s76, 5
    s_and_b32 s71, s71, 15
    s_lshl_b32 s70, s71, 7
    s_mul_i32 s71, s71, 393216
    s_add_u32 m0, s72, 106496
    s_add_u32 s66, s71, 2048
    buffer_load_dwordx4 v5, s[12:15], s66 offen lds
    s_add_u32 m0, s72, 108544
    s_add_u32 s66, s71, 100352
    buffer_load_dwordx4 v5, s[12:15], s66 offen lds
    s_add_u32 m0, s72, 110592
    s_add_u32 s66, s71, 198656
    buffer_load_dwordx4 v5, s[12:15], s66 offen lds
    s_add_u32 m0, s72, 112640
    s_add_u32 s66, s71, 296960
    buffer_load_dwordx4 v5, s[12:15], s66 offen lds
    s_add_u32 m0, s72, 81920
    s_add_u32 s66, s70, 0
    buffer_load_dwordx4 v4, s[8:11], s66 offen lds
    s_add_u32 m0, s72, 83968
    s_add_u32 s66, s70, 32768
    buffer_load_dwordx4 v4, s[8:11], s66 offen lds
    s_add_u32 m0, s72, 86016
    s_add_u32 s66, s70, 65536
    buffer_load_dwordx4 v4, s[8:11], s66 offen lds
    s_add_u32 m0, s72, 88064
    s_add_u32 s66, s70, 98304
    buffer_load_dwordx4 v4, s[8:11], s66 offen lds
    s_add_u32 m0, s72, 90112
    s_add_u32 s66, s70, 131072
    buffer_load_dwordx4 v4, s[8:11], s66 offen lds
    s_add_u32 m0, s72, 92160
    s_add_u32 s66, s70, 163840
    buffer_load_dwordx4 v4, s[8:11], s66 offen lds
    s_add_u32 m0, s72, 94208
    s_add_u32 s66, s70, 196608
    buffer_load_dwordx4 v4, s[8:11], s66 offen lds
    s_add_u32 m0, s72, 96256
    s_add_u32 s66, s70, 229376
    buffer_load_dwordx4 v4, s[8:11], s66 offen lds
    s_add_u32 m0, s72, 114688
    s_add_u32 s66, s71, 4096
    buffer_load_dwordx4 v5, s[12:15], s66 offen lds
    s_add_u32 m0, s72, 116736
    s_add_u32 s66, s71, 102400
    buffer_load_dwordx4 v5, s[12:15], s66 offen lds
    s_add_u32 m0, s72, 118784
    s_add_u32 s66, s71, 200704
    buffer_load_dwordx4 v5, s[12:15], s66 offen lds
    s_add_u32 m0, s72, 120832
    s_add_u32 s66, s71, 299008
    buffer_load_dwordx4 v5, s[12:15], s66 offen lds
    s_add_u32 m0, s72, 98304
    s_add_u32 s66, s71, 0
    buffer_load_dwordx4 v5, s[12:15], s66 offen lds
    s_add_u32 m0, s72, 100352
    s_add_u32 s66, s71, 98304
    buffer_load_dwordx4 v5, s[12:15], s66 offen lds
    s_add_u32 m0, s72, 102400
    s_add_u32 s66, s71, 196608
    buffer_load_dwordx4 v5, s[12:15], s66 offen lds
    s_add_u32 m0, s72, 104448
    s_add_u32 s66, s71, 294912
    buffer_load_dwordx4 v5, s[12:15], s66 offen lds
    s_waitcnt vmcnt(20)
    s_barrier
    s_add_u32 s71, s76, 6
    s_and_b32 s71, s71, 15
    s_lshl_b32 s70, s71, 7
    s_mul_i32 s71, s71, 393216
    s_add_u32 m0, s72, 24576
    s_add_u32 s66, s71, 2048
    buffer_load_dwordx4 v5, s[12:15], s66 offen lds
    s_add_u32 m0, s72, 26624
    s_add_u32 s66, s71, 100352
    buffer_load_dwordx4 v5, s[12:15], s66 offen lds
    s_add_u32 m0, s72, 28672
    s_add_u32 s66, s71, 198656
    buffer_load_dwordx4 v5, s[12:15], s66 offen lds
    s_add_u32 m0, s72, 30720
    s_add_u32 s66, s71, 296960
    buffer_load_dwordx4 v5, s[12:15], s66 offen lds
    s_add_u32 m0, s72, 0
    s_add_u32 s66, s70, 0
    buffer_load_dwordx4 v4, s[8:11], s66 offen lds
    s_add_u32 m0, s72, 2048
    s_add_u32 s66, s70, 32768
    buffer_load_dwordx4 v4, s[8:11], s66 offen lds
    s_add_u32 m0, s72, 4096
    s_add_u32 s66, s70, 65536
    buffer_load_dwordx4 v4, s[8:11], s66 offen lds
    s_add_u32 m0, s72, 6144
    s_add_u32 s66, s70, 98304
    buffer_load_dwordx4 v4, s[8:11], s66 offen lds
    s_add_u32 m0, s72, 8192
    s_add_u32 s66, s70, 131072
    buffer_load_dwordx4 v4, s[8:11], s66 offen lds
    s_add_u32 m0, s72, 10240
    s_add_u32 s66, s70, 163840
    buffer_load_dwordx4 v4, s[8:11], s66 offen lds
    s_add_u32 m0, s72, 12288
    s_add_u32 s66, s70, 196608
    buffer_load_dwordx4 v4, s[8:11], s66 offen lds
    s_add_u32 m0, s72, 14336
    s_add_u32 s66, s70, 229376
    buffer_load_dwordx4 v4, s[8:11], s66 offen lds
    s_add_u32 m0, s72, 32768
    s_add_u32 s66, s71, 4096
    buffer_load_dwordx4 v5, s[12:15], s66 offen lds
    s_add_u32 m0, s72, 34816
    s_add_u32 s66, s71, 102400
    buffer_load_dwordx4 v5, s[12:15], s66 offen lds
    s_add_u32 m0, s72, 36864
    s_add_u32 s66, s71, 200704
    buffer_load_dwordx4 v5, s[12:15], s66 offen lds
    s_add_u32 m0, s72, 38912
    s_add_u32 s66, s71, 299008
    buffer_load_dwordx4 v5, s[12:15], s66 offen lds
    s_add_u32 m0, s72, 16384
    s_add_u32 s66, s71, 0
    buffer_load_dwordx4 v5, s[12:15], s66 offen lds
    s_add_u32 m0, s72, 18432
    s_add_u32 s66, s71, 98304
    buffer_load_dwordx4 v5, s[12:15], s66 offen lds
    s_add_u32 m0, s72, 20480
    s_add_u32 s66, s71, 196608
    buffer_load_dwordx4 v5, s[12:15], s66 offen lds
    s_add_u32 m0, s72, 22528
    s_add_u32 s66, s71, 294912
    buffer_load_dwordx4 v5, s[12:15], s66 offen lds
    s_waitcnt vmcnt(20)
    s_barrier
    s_add_u32 s71, s76, 7
    s_and_b32 s71, s71, 15
    s_lshl_b32 s70, s71, 7
    s_mul_i32 s71, s71, 393216
    s_add_u32 m0, s72, 65536
    s_add_u32 s66, s71, 2048
    buffer_load_dwordx4 v5, s[12:15], s66 offen lds
    s_add_u32 m0, s72, 67584
    s_add_u32 s66, s71, 100352
    buffer_load_dwordx4 v5, s[12:15], s66 offen lds
    s_add_u32 m0, s72, 69632
    s_add_u32 s66, s71, 198656
    buffer_load_dwordx4 v5, s[12:15], s66 offen lds
    s_add_u32 m0, s72, 71680
    s_add_u32 s66, s71, 296960
    buffer_load_dwordx4 v5, s[12:15], s66 offen lds
    s_add_u32 m0, s72, 40960
    s_add_u32 s66, s70, 0
    buffer_load_dwordx4 v4, s[8:11], s66 offen lds
    s_add_u32 m0, s72, 43008
    s_add_u32 s66, s70, 32768
    buffer_load_dwordx4 v4, s[8:11], s66 offen lds
    s_add_u32 m0, s72, 45056
    s_add_u32 s66, s70, 65536
    buffer_load_dwordx4 v4, s[8:11], s66 offen lds
    s_add_u32 m0, s72, 47104
    s_add_u32 s66, s70, 98304
    buffer_load_dwordx4 v4, s[8:11], s66 offen lds
    s_add_u32 m0, s72, 49152
    s_add_u32 s66, s70, 131072
    buffer_load_dwordx4 v4, s[8:11], s66 offen lds
    s_add_u32 m0, s72, 51200
    s_add_u32 s66, s70, 163840
    buffer_load_dwordx4 v4, s[8:11], s66 offen lds
    s_add_u32 m0, s72, 53248
    s_add_u32 s66, s70, 196608
    buffer_load_dwordx4 v4, s[8:11], s66 offen lds
    s_add_u32 m0, s72, 55296
    s_add_u32 s66, s70, 229376
    buffer_load_dwordx4 v4, s[8:11], s66 offen lds
    s_add_u32 m0, s72, 73728
    s_add_u32 s66, s71, 4096
    buffer_load_dwordx4 v5, s[12:15], s66 offen lds
    s_add_u32 m0, s72, 75776
    s_add_u32 s66, s71, 102400
    buffer_load_dwordx4 v5, s[12:15], s66 offen lds
    s_add_u32 m0, s72, 77824
    s_add_u32 s66, s71, 200704
    buffer_load_dwordx4 v5, s[12:15], s66 offen lds
    s_add_u32 m0, s72, 79872
    s_add_u32 s66, s71, 299008
    buffer_load_dwordx4 v5, s[12:15], s66 offen lds
    s_add_u32 m0, s72, 57344
    s_add_u32 s66, s71, 0
    buffer_load_dwordx4 v5, s[12:15], s66 offen lds
    s_add_u32 m0, s72, 59392
    s_add_u32 s66, s71, 98304
    buffer_load_dwordx4 v5, s[12:15], s66 offen lds
    s_add_u32 m0, s72, 61440
    s_add_u32 s66, s71, 196608
    buffer_load_dwordx4 v5, s[12:15], s66 offen lds
    s_add_u32 m0, s72, 63488
    s_add_u32 s66, s71, 294912
    buffer_load_dwordx4 v5, s[12:15], s66 offen lds
    s_waitcnt vmcnt(20)
    s_barrier
    s_add_u32 s71, s76, 8
    s_and_b32 s71, s71, 15
    s_lshl_b32 s70, s71, 7
    s_mul_i32 s71, s71, 393216
    s_add_u32 m0, s72, 106496
    s_add_u32 s66, s71, 2048
    buffer_load_dwordx4 v5, s[12:15], s66 offen lds
    s_add_u32 m0, s72, 108544
    s_add_u32 s66, s71, 100352
    buffer_load_dwordx4 v5, s[12:15], s66 offen lds
    s_add_u32 m0, s72, 110592
    s_add_u32 s66, s71, 198656
    buffer_load_dwordx4 v5, s[12:15], s66 offen lds
    s_add_u32 m0, s72, 112640
    s_add_u32 s66, s71, 296960
    buffer_load_dwordx4 v5, s[12:15], s66 offen lds
    s_add_u32 m0, s72, 81920
    s_add_u32 s66, s70, 0
    buffer_load_dwordx4 v4, s[8:11], s66 offen lds
    s_add_u32 m0, s72, 83968
    s_add_u32 s66, s70, 32768
    buffer_load_dwordx4 v4, s[8:11], s66 offen lds
    s_add_u32 m0, s72, 86016
    s_add_u32 s66, s70, 65536
    buffer_load_dwordx4 v4, s[8:11], s66 offen lds
    s_add_u32 m0, s72, 88064
    s_add_u32 s66, s70, 98304
    buffer_load_dwordx4 v4, s[8:11], s66 offen lds
    s_add_u32 m0, s72, 90112
    s_add_u32 s66, s70, 131072
    buffer_load_dwordx4 v4, s[8:11], s66 offen lds
    s_add_u32 m0, s72, 92160
    s_add_u32 s66, s70, 163840
    buffer_load_dwordx4 v4, s[8:11], s66 offen lds
    s_add_u32 m0, s72, 94208
    s_add_u32 s66, s70, 196608
    buffer_load_dwordx4 v4, s[8:11], s66 offen lds
    s_add_u32 m0, s72, 96256
    s_add_u32 s66, s70, 229376
    buffer_load_dwordx4 v4, s[8:11], s66 offen lds
    s_add_u32 m0, s72, 114688
    s_add_u32 s66, s71, 4096
    buffer_load_dwordx4 v5, s[12:15], s66 offen lds
    s_add_u32 m0, s72, 116736
    s_add_u32 s66, s71, 102400
    buffer_load_dwordx4 v5, s[12:15], s66 offen lds
    s_add_u32 m0, s72, 118784
    s_add_u32 s66, s71, 200704
    buffer_load_dwordx4 v5, s[12:15], s66 offen lds
    s_add_u32 m0, s72, 120832
    s_add_u32 s66, s71, 299008
    buffer_load_dwordx4 v5, s[12:15], s66 offen lds
    s_add_u32 m0, s72, 98304
    s_add_u32 s66, s71, 0
    buffer_load_dwordx4 v5, s[12:15], s66 offen lds
    s_add_u32 m0, s72, 100352
    s_add_u32 s66, s71, 98304
    buffer_load_dwordx4 v5, s[12:15], s66 offen lds
    s_add_u32 m0, s72, 102400
    s_add_u32 s66, s71, 196608
    buffer_load_dwordx4 v5, s[12:15], s66 offen lds
    s_add_u32 m0, s72, 104448
    s_add_u32 s66, s71, 294912
    buffer_load_dwordx4 v5, s[12:15], s66 offen lds
    s_waitcnt vmcnt(20)
    s_barrier
    s_add_u32 s71, s76, 9
    s_and_b32 s71, s71, 15
    s_lshl_b32 s70, s71, 7
    s_mul_i32 s71, s71, 393216
    s_add_u32 m0, s72, 24576
    s_add_u32 s66, s71, 2048
    buffer_load_dwordx4 v5, s[12:15], s66 offen lds
    s_add_u32 m0, s72, 26624
    s_add_u32 s66, s71, 100352
    buffer_load_dwordx4 v5, s[12:15], s66 offen lds
    s_add_u32 m0, s72, 28672
    s_add_u32 s66, s71, 198656
    buffer_load_dwordx4 v5, s[12:15], s66 offen lds
    s_add_u32 m0, s72, 30720
    s_add_u32 s66, s71, 296960
    buffer_load_dwordx4 v5, s[12:15], s66 offen lds
    s_add_u32 m0, s72, 0
    s_add_u32 s66, s70, 0
    buffer_load_dwordx4 v4, s[8:11], s66 offen lds
    s_add_u32 m0, s72, 2048
    s_add_u32 s66, s70, 32768
    buffer_load_dwordx4 v4, s[8:11], s66 offen lds
    s_add_u32 m0, s72, 4096
    s_add_u32 s66, s70, 65536
    buffer_load_dwordx4 v4, s[8:11], s66 offen lds
    s_add_u32 m0, s72, 6144
    s_add_u32 s66, s70, 98304
    buffer_load_dwordx4 v4, s[8:11], s66 offen lds
    s_add_u32 m0, s72, 8192
    s_add_u32 s66, s70, 131072
    buffer_load_dwordx4 v4, s[8:11], s66 offen lds
    s_add_u32 m0, s72, 10240
    s_add_u32 s66, s70, 163840
    buffer_load_dwordx4 v4, s[8:11], s66 offen lds
    s_add_u32 m0, s72, 12288
    s_add_u32 s66, s70, 196608
    buffer_load_dwordx4 v4, s[8:11], s66 offen lds
    s_add_u32 m0, s72, 14336
    s_add_u32 s66, s70, 229376
    buffer_load_dwordx4 v4, s[8:11], s66 offen lds
    s_add_u32 m0, s72, 32768
    s_add_u32 s66, s71, 4096
    buffer_load_dwordx4 v5, s[12:15], s66 offen lds
    s_add_u32 m0, s72, 34816
    s_add_u32 s66, s71, 102400
    buffer_load_dwordx4 v5, s[12:15], s66 offen lds
    s_add_u32 m0, s72, 36864
    s_add_u32 s66, s71, 200704
    buffer_load_dwordx4 v5, s[12:15], s66 offen lds
    s_add_u32 m0, s72, 38912
    s_add_u32 s66, s71, 299008
    buffer_load_dwordx4 v5, s[12:15], s66 offen lds
    s_add_u32 m0, s72, 16384
    s_add_u32 s66, s71, 0
    buffer_load_dwordx4 v5, s[12:15], s66 offen lds
    s_add_u32 m0, s72, 18432
    s_add_u32 s66, s71, 98304
    buffer_load_dwordx4 v5, s[12:15], s66 offen lds
    s_add_u32 m0, s72, 20480
    s_add_u32 s66, s71, 196608
    buffer_load_dwordx4 v5, s[12:15], s66 offen lds
    s_add_u32 m0, s72, 22528
    s_add_u32 s66, s71, 294912
    buffer_load_dwordx4 v5, s[12:15], s66 offen lds
    s_waitcnt vmcnt(20)
    s_barrier
    s_add_u32 s71, s76, 10
    s_and_b32 s71, s71, 15
    s_lshl_b32 s70, s71, 7
    s_mul_i32 s71, s71, 393216
    s_add_u32 m0, s72, 65536
    s_add_u32 s66, s71, 2048
    buffer_load_dwordx4 v5, s[12:15], s66 offen lds
    s_add_u32 m0, s72, 67584
    s_add_u32 s66, s71, 100352
    buffer_load_dwordx4 v5, s[12:15], s66 offen lds
    s_add_u32 m0, s72, 69632
    s_add_u32 s66, s71, 198656
    buffer_load_dwordx4 v5, s[12:15], s66 offen lds
    s_add_u32 m0, s72, 71680
    s_add_u32 s66, s71, 296960
    buffer_load_dwordx4 v5, s[12:15], s66 offen lds
    s_add_u32 m0, s72, 40960
    s_add_u32 s66, s70, 0
    buffer_load_dwordx4 v4, s[8:11], s66 offen lds
    s_add_u32 m0, s72, 43008
    s_add_u32 s66, s70, 32768
    buffer_load_dwordx4 v4, s[8:11], s66 offen lds
    s_add_u32 m0, s72, 45056
    s_add_u32 s66, s70, 65536
    buffer_load_dwordx4 v4, s[8:11], s66 offen lds
    s_add_u32 m0, s72, 47104
    s_add_u32 s66, s70, 98304
    buffer_load_dwordx4 v4, s[8:11], s66 offen lds
    s_add_u32 m0, s72, 49152
    s_add_u32 s66, s70, 131072
    buffer_load_dwordx4 v4, s[8:11], s66 offen lds
    s_add_u32 m0, s72, 51200
    s_add_u32 s66, s70, 163840
    buffer_load_dwordx4 v4, s[8:11], s66 offen lds
    s_add_u32 m0, s72, 53248
    s_add_u32 s66, s70, 196608
    buffer_load_dwordx4 v4, s[8:11], s66 offen lds
    s_add_u32 m0, s72, 55296
    s_add_u32 s66, s70, 229376
    buffer_load_dwordx4 v4, s[8:11], s66 offen lds
    s_add_u32 m0, s72, 73728
    s_add_u32 s66, s71, 4096
    buffer_load_dwordx4 v5, s[12:15], s66 offen lds
    s_add_u32 m0, s72, 75776
    s_add_u32 s66, s71, 102400
    buffer_load_dwordx4 v5, s[12:15], s66 offen lds
    s_add_u32 m0, s72, 77824
    s_add_u32 s66, s71, 200704
    buffer_load_dwordx4 v5, s[12:15], s66 offen lds
    s_add_u32 m0, s72, 79872
    s_add_u32 s66, s71, 299008
    buffer_load_dwordx4 v5, s[12:15], s66 offen lds
    s_add_u32 m0, s72, 57344
    s_add_u32 s66, s71, 0
    buffer_load_dwordx4 v5, s[12:15], s66 offen lds
    s_add_u32 m0, s72, 59392
    s_add_u32 s66, s71, 98304
    buffer_load_dwordx4 v5, s[12:15], s66 offen lds
    s_add_u32 m0, s72, 61440
    s_add_u32 s66, s71, 196608
    buffer_load_dwordx4 v5, s[12:15], s66 offen lds
    s_add_u32 m0, s72, 63488
    s_add_u32 s66, s71, 294912
    buffer_load_dwordx4 v5, s[12:15], s66 offen lds
    s_waitcnt vmcnt(20)
    s_barrier
    s_add_u32 s71, s76, 11
    s_and_b32 s71, s71, 15
    s_lshl_b32 s70, s71, 7
    s_mul_i32 s71, s71, 393216
    s_add_u32 m0, s72, 106496
    s_add_u32 s66, s71, 2048
    buffer_load_dwordx4 v5, s[12:15], s66 offen lds
    s_add_u32 m0, s72, 108544
    s_add_u32 s66, s71, 100352
    buffer_load_dwordx4 v5, s[12:15], s66 offen lds
    s_add_u32 m0, s72, 110592
    s_add_u32 s66, s71, 198656
    buffer_load_dwordx4 v5, s[12:15], s66 offen lds
    s_add_u32 m0, s72, 112640
    s_add_u32 s66, s71, 296960
    buffer_load_dwordx4 v5, s[12:15], s66 offen lds
    s_add_u32 m0, s72, 81920
    s_add_u32 s66, s70, 0
    buffer_load_dwordx4 v4, s[8:11], s66 offen lds
    s_add_u32 m0, s72, 83968
    s_add_u32 s66, s70, 32768
    buffer_load_dwordx4 v4, s[8:11], s66 offen lds
    s_add_u32 m0, s72, 86016
    s_add_u32 s66, s70, 65536
    buffer_load_dwordx4 v4, s[8:11], s66 offen lds
    s_add_u32 m0, s72, 88064
    s_add_u32 s66, s70, 98304
    buffer_load_dwordx4 v4, s[8:11], s66 offen lds
    s_add_u32 m0, s72, 90112
    s_add_u32 s66, s70, 131072
    buffer_load_dwordx4 v4, s[8:11], s66 offen lds
    s_add_u32 m0, s72, 92160
    s_add_u32 s66, s70, 163840
    buffer_load_dwordx4 v4, s[8:11], s66 offen lds
    s_add_u32 m0, s72, 94208
    s_add_u32 s66, s70, 196608
    buffer_load_dwordx4 v4, s[8:11], s66 offen lds
    s_add_u32 m0, s72, 96256
    s_add_u32 s66, s70, 229376
    buffer_load_dwordx4 v4, s[8:11], s66 offen lds
    s_add_u32 m0, s72, 114688
    s_add_u32 s66, s71, 4096
    buffer_load_dwordx4 v5, s[12:15], s66 offen lds
    s_add_u32 m0, s72, 116736
    s_add_u32 s66, s71, 102400
    buffer_load_dwordx4 v5, s[12:15], s66 offen lds
    s_add_u32 m0, s72, 118784
    s_add_u32 s66, s71, 200704
    buffer_load_dwordx4 v5, s[12:15], s66 offen lds
    s_add_u32 m0, s72, 120832
    s_add_u32 s66, s71, 299008
    buffer_load_dwordx4 v5, s[12:15], s66 offen lds
    s_add_u32 m0, s72, 98304
    s_add_u32 s66, s71, 0
    buffer_load_dwordx4 v5, s[12:15], s66 offen lds
    s_add_u32 m0, s72, 100352
    s_add_u32 s66, s71, 98304
    buffer_load_dwordx4 v5, s[12:15], s66 offen lds
    s_add_u32 m0, s72, 102400
    s_add_u32 s66, s71, 196608
    buffer_load_dwordx4 v5, s[12:15], s66 offen lds
    s_add_u32 m0, s72, 104448
    s_add_u32 s66, s71, 294912
    buffer_load_dwordx4 v5, s[12:15], s66 offen lds
    s_waitcnt vmcnt(20)
    s_barrier
    s_add_u32 s71, s76, 12
    s_and_b32 s71, s71, 15
    s_lshl_b32 s70, s71, 7
    s_mul_i32 s71, s71, 393216
    s_add_u32 m0, s72, 24576
    s_add_u32 s66, s71, 2048
    buffer_load_dwordx4 v5, s[12:15], s66 offen lds
    s_add_u32 m0, s72, 26624
    s_add_u32 s66, s71, 100352
    buffer_load_dwordx4 v5, s[12:15], s66 offen lds
    s_add_u32 m0, s72, 28672
    s_add_u32 s66, s71, 198656
    buffer_load_dwordx4 v5, s[12:15], s66 offen lds
    s_add_u32 m0, s72, 30720
    s_add_u32 s66, s71, 296960
    buffer_load_dwordx4 v5, s[12:15], s66 offen lds
    s_add_u32 m0, s72, 0
    s_add_u32 s66, s70, 0
    buffer_load_dwordx4 v4, s[8:11], s66 offen lds
    s_add_u32 m0, s72, 2048
    s_add_u32 s66, s70, 32768
    buffer_load_dwordx4 v4, s[8:11], s66 offen lds
    s_add_u32 m0, s72, 4096
    s_add_u32 s66, s70, 65536
    buffer_load_dwordx4 v4, s[8:11], s66 offen lds
    s_add_u32 m0, s72, 6144
    s_add_u32 s66, s70, 98304
    buffer_load_dwordx4 v4, s[8:11], s66 offen lds
    s_add_u32 m0, s72, 8192
    s_add_u32 s66, s70, 131072
    buffer_load_dwordx4 v4, s[8:11], s66 offen lds
    s_add_u32 m0, s72, 10240
    s_add_u32 s66, s70, 163840
    buffer_load_dwordx4 v4, s[8:11], s66 offen lds
    s_add_u32 m0, s72, 12288
    s_add_u32 s66, s70, 196608
    buffer_load_dwordx4 v4, s[8:11], s66 offen lds
    s_add_u32 m0, s72, 14336
    s_add_u32 s66, s70, 229376
    buffer_load_dwordx4 v4, s[8:11], s66 offen lds
    s_add_u32 m0, s72, 32768
    s_add_u32 s66, s71, 4096
    buffer_load_dwordx4 v5, s[12:15], s66 offen lds
    s_add_u32 m0, s72, 34816
    s_add_u32 s66, s71, 102400
    buffer_load_dwordx4 v5, s[12:15], s66 offen lds
    s_add_u32 m0, s72, 36864
    s_add_u32 s66, s71, 200704
    buffer_load_dwordx4 v5, s[12:15], s66 offen lds
    s_add_u32 m0, s72, 38912
    s_add_u32 s66, s71, 299008
    buffer_load_dwordx4 v5, s[12:15], s66 offen lds
    s_add_u32 m0, s72, 16384
    s_add_u32 s66, s71, 0
    buffer_load_dwordx4 v5, s[12:15], s66 offen lds
    s_add_u32 m0, s72, 18432
    s_add_u32 s66, s71, 98304
    buffer_load_dwordx4 v5, s[12:15], s66 offen lds
    s_add_u32 m0, s72, 20480
    s_add_u32 s66, s71, 196608
    buffer_load_dwordx4 v5, s[12:15], s66 offen lds
    s_add_u32 m0, s72, 22528
    s_add_u32 s66, s71, 294912
    buffer_load_dwordx4 v5, s[12:15], s66 offen lds
    s_waitcnt vmcnt(20)
    s_barrier
    s_add_u32 s71, s76, 13
    s_and_b32 s71, s71, 15
    s_lshl_b32 s70, s71, 7
    s_mul_i32 s71, s71, 393216
    s_add_u32 m0, s72, 65536
    s_add_u32 s66, s71, 2048
    buffer_load_dwordx4 v5, s[12:15], s66 offen lds
    s_add_u32 m0, s72, 67584
    s_add_u32 s66, s71, 100352
    buffer_load_dwordx4 v5, s[12:15], s66 offen lds
    s_add_u32 m0, s72, 69632
    s_add_u32 s66, s71, 198656
    buffer_load_dwordx4 v5, s[12:15], s66 offen lds
    s_add_u32 m0, s72, 71680
    s_add_u32 s66, s71, 296960
    buffer_load_dwordx4 v5, s[12:15], s66 offen lds
    s_add_u32 m0, s72, 40960
    s_add_u32 s66, s70, 0
    buffer_load_dwordx4 v4, s[8:11], s66 offen lds
    s_add_u32 m0, s72, 43008
    s_add_u32 s66, s70, 32768
    buffer_load_dwordx4 v4, s[8:11], s66 offen lds
    s_add_u32 m0, s72, 45056
    s_add_u32 s66, s70, 65536
    buffer_load_dwordx4 v4, s[8:11], s66 offen lds
    s_add_u32 m0, s72, 47104
    s_add_u32 s66, s70, 98304
    buffer_load_dwordx4 v4, s[8:11], s66 offen lds
    s_add_u32 m0, s72, 49152
    s_add_u32 s66, s70, 131072
    buffer_load_dwordx4 v4, s[8:11], s66 offen lds
    s_add_u32 m0, s72, 51200
    s_add_u32 s66, s70, 163840
    buffer_load_dwordx4 v4, s[8:11], s66 offen lds
    s_add_u32 m0, s72, 53248
    s_add_u32 s66, s70, 196608
    buffer_load_dwordx4 v4, s[8:11], s66 offen lds
    s_add_u32 m0, s72, 55296
    s_add_u32 s66, s70, 229376
    buffer_load_dwordx4 v4, s[8:11], s66 offen lds
    s_add_u32 m0, s72, 73728
    s_add_u32 s66, s71, 4096
    buffer_load_dwordx4 v5, s[12:15], s66 offen lds
    s_add_u32 m0, s72, 75776
    s_add_u32 s66, s71, 102400
    buffer_load_dwordx4 v5, s[12:15], s66 offen lds
    s_add_u32 m0, s72, 77824
    s_add_u32 s66, s71, 200704
    buffer_load_dwordx4 v5, s[12:15], s66 offen lds
    s_add_u32 m0, s72, 79872
    s_add_u32 s66, s71, 299008
    buffer_load_dwordx4 v5, s[12:15], s66 offen lds
    s_add_u32 m0, s72, 57344
    s_add_u32 s66, s71, 0
    buffer_load_dwordx4 v5, s[12:15], s66 offen lds
    s_add_u32 m0, s72, 59392
    s_add_u32 s66, s71, 98304
    buffer_load_dwordx4 v5, s[12:15], s66 offen lds
    s_add_u32 m0, s72, 61440
    s_add_u32 s66, s71, 196608
    buffer_load_dwordx4 v5, s[12:15], s66 offen lds
    s_add_u32 m0, s72, 63488
    s_add_u32 s66, s71, 294912
    buffer_load_dwordx4 v5, s[12:15], s66 offen lds
    s_waitcnt vmcnt(20)
    s_barrier
    s_add_u32 s71, s76, 14
    s_and_b32 s71, s71, 15
    s_lshl_b32 s70, s71, 7
    s_mul_i32 s71, s71, 393216
    s_add_u32 m0, s72, 106496
    s_add_u32 s66, s71, 2048
    buffer_load_dwordx4 v5, s[12:15], s66 offen lds
    s_add_u32 m0, s72, 108544
    s_add_u32 s66, s71, 100352
    buffer_load_dwordx4 v5, s[12:15], s66 offen lds
    s_add_u32 m0, s72, 110592
    s_add_u32 s66, s71, 198656
    buffer_load_dwordx4 v5, s[12:15], s66 offen lds
    s_add_u32 m0, s72, 112640
    s_add_u32 s66, s71, 296960
    buffer_load_dwordx4 v5, s[12:15], s66 offen lds
    s_add_u32 m0, s72, 81920
    s_add_u32 s66, s70, 0
    buffer_load_dwordx4 v4, s[8:11], s66 offen lds
    s_add_u32 m0, s72, 83968
    s_add_u32 s66, s70, 32768
    buffer_load_dwordx4 v4, s[8:11], s66 offen lds
    s_add_u32 m0, s72, 86016
    s_add_u32 s66, s70, 65536
    buffer_load_dwordx4 v4, s[8:11], s66 offen lds
    s_add_u32 m0, s72, 88064
    s_add_u32 s66, s70, 98304
    buffer_load_dwordx4 v4, s[8:11], s66 offen lds
    s_add_u32 m0, s72, 90112
    s_add_u32 s66, s70, 131072
    buffer_load_dwordx4 v4, s[8:11], s66 offen lds
    s_add_u32 m0, s72, 92160
    s_add_u32 s66, s70, 163840
    buffer_load_dwordx4 v4, s[8:11], s66 offen lds
    s_add_u32 m0, s72, 94208
    s_add_u32 s66, s70, 196608
    buffer_load_dwordx4 v4, s[8:11], s66 offen lds
    s_add_u32 m0, s72, 96256
    s_add_u32 s66, s70, 229376
    buffer_load_dwordx4 v4, s[8:11], s66 offen lds
    s_add_u32 m0, s72, 114688
    s_add_u32 s66, s71, 4096
    buffer_load_dwordx4 v5, s[12:15], s66 offen lds
    s_add_u32 m0, s72, 116736
    s_add_u32 s66, s71, 102400
    buffer_load_dwordx4 v5, s[12:15], s66 offen lds
    s_add_u32 m0, s72, 118784
    s_add_u32 s66, s71, 200704
    buffer_load_dwordx4 v5, s[12:15], s66 offen lds
    s_add_u32 m0, s72, 120832
    s_add_u32 s66, s71, 299008
    buffer_load_dwordx4 v5, s[12:15], s66 offen lds
    s_add_u32 m0, s72, 98304
    s_add_u32 s66, s71, 0
    buffer_load_dwordx4 v5, s[12:15], s66 offen lds
    s_add_u32 m0, s72, 100352
    s_add_u32 s66, s71, 98304
    buffer_load_dwordx4 v5, s[12:15], s66 offen lds
    s_add_u32 m0, s72, 102400
    s_add_u32 s66, s71, 196608
    buffer_load_dwordx4 v5, s[12:15], s66 offen lds
    s_add_u32 m0, s72, 104448
    s_add_u32 s66, s71, 294912
    buffer_load_dwordx4 v5, s[12:15], s66 offen lds
    s_add_u32 s71, s76, 15
    s_and_b32 s71, s71, 15
    s_lshl_b32 s70, s71, 7
    s_mul_i32 s71, s71, 393216
    s_add_u32 m0, s72, 139264
    s_add_u32 s66, s71, 2048
    buffer_load_dwordx4 v5, s[12:15], s66 offen lds
    s_add_u32 m0, s72, 141312
    s_add_u32 s66, s71, 100352
    buffer_load_dwordx4 v5, s[12:15], s66 offen lds
    s_add_u32 m0, s72, 143360
    s_add_u32 s66, s71, 198656
    buffer_load_dwordx4 v5, s[12:15], s66 offen lds
    s_add_u32 m0, s72, 145408
    s_add_u32 s66, s71, 296960
    buffer_load_dwordx4 v5, s[12:15], s66 offen lds
    s_waitcnt vmcnt(24)
    s_barrier
    s_add_u32 s71, s76, 15
    s_and_b32 s71, s71, 15
    s_lshl_b32 s70, s71, 7
    s_mul_i32 s71, s71, 393216
    s_add_u32 m0, s72, 122880
    s_add_u32 s66, s70, 0
    buffer_load_dwordx4 v4, s[8:11], s66 offen lds
    s_add_u32 m0, s72, 124928
    s_add_u32 s66, s70, 32768
    buffer_load_dwordx4 v4, s[8:11], s66 offen lds
    s_add_u32 m0, s72, 126976
    s_add_u32 s66, s70, 65536
    buffer_load_dwordx4 v4, s[8:11], s66 offen lds
    s_add_u32 m0, s72, 129024
    s_add_u32 s66, s70, 98304
    buffer_load_dwordx4 v4, s[8:11], s66 offen lds
    s_add_u32 m0, s72, 131072
    s_add_u32 s66, s70, 131072
    buffer_load_dwordx4 v4, s[8:11], s66 offen lds
    s_add_u32 m0, s72, 133120
    s_add_u32 s66, s70, 163840
    buffer_load_dwordx4 v4, s[8:11], s66 offen lds
    s_add_u32 m0, s72, 135168
    s_add_u32 s66, s70, 196608
    buffer_load_dwordx4 v4, s[8:11], s66 offen lds
    s_add_u32 m0, s72, 137216
    s_add_u32 s66, s70, 229376
    buffer_load_dwordx4 v4, s[8:11], s66 offen lds
    s_add_u32 s71, s76, 15
    s_and_b32 s71, s71, 15
    s_lshl_b32 s70, s71, 7
    s_mul_i32 s71, s71, 393216
    s_add_u32 m0, s72, 147456
    s_add_u32 s66, s71, 4096
    buffer_load_dwordx4 v5, s[12:15], s66 offen lds
    s_add_u32 m0, s72, 149504
    s_add_u32 s66, s71, 102400
    buffer_load_dwordx4 v5, s[12:15], s66 offen lds
    s_add_u32 m0, s72, 151552
    s_add_u32 s66, s71, 200704
    buffer_load_dwordx4 v5, s[12:15], s66 offen lds
    s_add_u32 m0, s72, 153600
    s_add_u32 s66, s71, 299008
    buffer_load_dwordx4 v5, s[12:15], s66 offen lds
    s_add_u32 m0, s72, 16384
    s_add_u32 s66, s71, 0
    buffer_load_dwordx4 v5, s[12:15], s66 offen lds
    s_add_u32 m0, s72, 18432
    s_add_u32 s66, s71, 98304
    buffer_load_dwordx4 v5, s[12:15], s66 offen lds
    s_add_u32 m0, s72, 20480
    s_add_u32 s66, s71, 196608
    buffer_load_dwordx4 v5, s[12:15], s66 offen lds
    s_add_u32 m0, s72, 22528
    s_add_u32 s66, s71, 294912
    buffer_load_dwordx4 v5, s[12:15], s66 offen lds
    s_waitcnt vmcnt(20)
    s_barrier
    s_lshl_b32 s66, s2, 2
    s_add_u32 s66, s66, s44
    s_lshl_b32 s66, s66, 11
    buffer_load_dwordx4 v[240:243], v9, s[20:23], s66 offen offset:0
    buffer_load_dwordx4 v[240:243], v9, s[20:23], s66 offen offset:1024
    s_mov_b32 s66, 0
    buffer_load_dwordx4 v[160:163], v7, s[32:35], s66 offen
    s_mov_b32 s66, 2048
    buffer_load_dwordx4 v[164:167], v7, s[32:35], s66 offen
    s_mov_b32 s66, 4096
    buffer_load_dwordx4 v[168:171], v7, s[32:35], s66 offen
    s_mov_b32 s66, 6144
    buffer_load_dwordx4 v[172:175], v7, s[32:35], s66 offen
    s_mov_b32 s66, 8192
    buffer_load_dwordx4 v[176:179], v7, s[32:35], s66 offen
    s_mov_b32 s66, 10240
    buffer_load_dwordx4 v[180:183], v7, s[32:35], s66 offen
    s_mov_b32 s66, 12288
    buffer_load_dwordx4 v[184:187], v7, s[32:35], s66 offen
    s_mov_b32 s66, 14336
    buffer_load_dwordx4 v[188:191], v7, s[32:35], s66 offen
    s_waitcnt vmcnt(10)
    s_branch H_b14
WORK:
    v_mov_b32 v14, 0
    v_lshlrev_b32 v8, 5, v2
    v_add_u32 v8, 6127616, v8
    s_lshl_b32 s66, s2, 2
    s_add_u32 s66, s66, s44
    s_cmp_lg_u32 s66, 2
    s_cbranch_scc1 W_nn
    s_movk_i32 s66, 0
    buffer_load_dword v72, v8, s[16:19], s66 offen offset:4 sc1
    s_movk_i32 s66, 2048
    buffer_load_dword v73, v8, s[16:19], s66 offen offset:4 sc1
    s_movk_i32 s66, 4096
    buffer_load_dword v74, v8, s[16:19], s66 offen offset:4 sc1
    s_movk_i32 s66, 6144
    buffer_load_dword v75, v8, s[16:19], s66 offen offset:4 sc1
    s_memrealtime s[66:67]
    s_waitcnt vmcnt(0) lgkmcnt(0)
    s_or_b32 s66, s66, 1
W_nl:
    s_add_u32 s66, s66, 2
    v_cmp_eq_u32 vcc, s66, v72
    v_cmp_eq_u32 s[68:69], s66, v73
    s_or_b64 vcc, vcc, s[68:69]
    v_cmp_eq_u32 s[68:69], s66, v74
    s_or_b64 vcc, vcc, s[68:69]
    v_cmp_eq_u32 s[68:69], s66, v75
    s_or_b64 vcc, vcc, s[68:69]
    s_cbranch_vccnz W_nl
    v_mov_b32 v10, 0
    v_mov_b32 v11, s66
    s_mov_b64 exec, 1
    buffer_store_dword v11, v10, s[40:43], 0 offen sc0 sc1
    s_mov_b64 exec, -1
W_nn:
    s_and_b32 s48, s44, 1
    s_waitcnt vmcnt(5)
    s_barrier
    s_waitcnt vmcnt(0)
    s_barrier
    s_lshl_b32 s50, s4, 7
    s_lshl_b32 s66, s5, 3
    s_add_u32 s50, s50, s66
    s_lshl_b32 s66, s48, 2
    s_add_u32 s50, s50, s66
    s_lshl_b32 s66, s50, 11
    s_add_u32 s67, s66, 4096
    buffer_load_dwordx4 v[16:19], v9, s[8:11], s66 offen offset:0
    buffer_load_dwordx4 v[20:23], v9, s[8:11], s66 offen offset:1024
    buffer_load_dwordx4 v[24:27], v9, s[8:11], s66 offen offset:2048
    buffer_load_dwordx4 v[28:31], v9, s[8:11], s66 offen offset:3072
    buffer_load_dwordx4 v[32:35], v9, s[8:11], s67 offen offset:0
    buffer_load_dwordx4 v[36:39], v9, s[8:11], s67 offen offset:1024
    buffer_load_dwordx4 v[40:43], v9, s[8:11], s67 offen offset:2048
    buffer_load_dwordx4 v[44:47], v9, s[8:11], s67 offen offset:3072
    s_lshl_b32 s66, s48, 11
    s_add_u32 m0, s66, 159744
    s_nop 0
    buffer_load_dwordx4 v9, s[24:27], 0 offen offset:0 lds
    buffer_load_dwordx4 v9, s[24:27], 0 offen offset:1024 lds
    s_lshl_b32 s66, s79, 2
    s_add_u32 s66, s66, s73
    s_and_b32 s51, s66, 15
    s_lshr_b32 s67, s66, 4
    s_lshl_b32 s54, s67, 5
    s_lshl_b32 s66, s48, 4
    s_add_u32 s54, s54, s66
    s_add_u32 s54, s54, s51
    s_lshl_b32 s54, s54, 10
    s_add_u32 s54, s54, 5308416
    s_lshl_b32 s51, s51, 6
    v_lshrrev_b32 v10, 5, v2
    v_and_b32 v11, 31, v2
    v_lshlrev_b32 v12, 5, v10
    v_add_u32 v12, s51, v12
    v_mul_u32_u24 v12, 7168, v12
    v_lshl_add_u32 v12, v11, 4, v12
    s_lshl_b32 s67, s67, 9
    v_add_u32 v6, s67, v12
    v_mov_b32 v72, -1
    v_mov_b32 v73, -1
    v_mov_b32 v74, -1
    v_mov_b32 v75, -1
    v_and_b32 v12, 3, v2
    v_lshlrev_b32 v12, 4, v12
    v_add_u32 v12, s53, v12
    s_add_u32 s66, s53, 4294965248
    v_subrev_u32 v13, 4, v2
    v_cmp_gt_u32 vcc, 4, v13
    v_lshlrev_b32 v13, 4, v13
    v_add_u32 v13, s66, v13
    v_cndmask_b32 v12, v12, v13, vcc
    s_add_u32 s66, s55, 0
    v_subrev_u32 v13, 24, v2
    v_cmp_gt_u32 vcc, 16, v13
    v_lshlrev_b32 v13, 4, v13
    v_add_u32 v13, s66, v13
    v_cndmask_b32 v12, v12, v13, vcc
    s_add_u32 s66, s55, 4294934528
    v_subrev_u32 v13, 40, v2
    v_cmp_gt_u32 vcc, 16, v13
    v_lshlrev_b32 v13, 4, v13
    v_add_u32 v13, s66, v13
    v_cndmask_b32 v12, v12, v13, vcc
    s_sub_u32 s66, s56, 32768
    buffer_store_dwordx4 v[72:75], v9, s[16:19], s56 offen sc0 sc1
    buffer_store_dwordx4 v[72:75], v9, s[16:19], s66 offen sc0 sc1
    buffer_store_dwordx4 v[72:75], v9, s[16:19], s54 offen sc0 sc1
    buffer_store_dwordx4 v[72:75], v12, s[16:19], 0 offen sc0 sc1
    s_waitcnt vmcnt(4)
    s_barrier
    s_cmp_lg_u32 s48, 0
    s_cbranch_scc1 W_k1
    buffer_load_dword v15, v14, s[40:43], 0 offen sc1
W_k1:
    v_add_u32 v10, 159744, v9
    v_bfe_u32 v3, v2, 4, 1
    v_lshrrev_b32 v11, 5, v2
    v_lshl_add_u32 v3, v3, 1, v11
    s_mov_b32 s67, 0xffff0000
    s_mov_b32 s68, 0x00010001
    s_mov_b32 s69, 0x00010001
    ds_read_b128 v[48:51], v10 offset:0
    ds_read_b128 v[52:55], v10 offset:1024
    v_mov_b32 v72, 0
    v_mov_b32 v73, 0
    v_mov_b32 v74, 0
    v_mov_b32 v75, 0
    s_waitcnt lgkmcnt(0)
    v_dot2_f32_bf16 v72, v16, v48, v72
    v_dot2_f32_bf16 v73, v24, v48, v73
    v_dot2_f32_bf16 v74, v32, v48, v74
    v_dot2_f32_bf16 v75, v40, v48, v75
    v_dot2_f32_bf16 v72, v17, v49, v72
    v_dot2_f32_bf16 v73, v25, v49, v73
    v_dot2_f32_bf16 v74, v33, v49, v74
    v_dot2_f32_bf16 v75, v41, v49, v75
    v_dot2_f32_bf16 v72, v18, v50, v72
    v_dot2_f32_bf16 v73, v26, v50, v73
    v_dot2_f32_bf16 v74, v34, v50, v74
    v_dot2_f32_bf16 v75, v42, v50, v75
    v_dot2_f32_bf16 v72, v19, v51, v72
    v_dot2_f32_bf16 v73, v27, v51, v73
    v_dot2_f32_bf16 v74, v35, v51, v74
    v_dot2_f32_bf16 v75, v43, v51, v75
    v_dot2_f32_bf16 v72, v20, v52, v72
    v_dot2_f32_bf16 v73, v28, v52, v73
    v_dot2_f32_bf16 v74, v36, v52, v74
    v_dot2_f32_bf16 v75, v44, v52, v75
    v_dot2_f32_bf16 v72, v21, v53, v72
    v_dot2_f32_bf16 v73, v29, v53, v73
    v_dot2_f32_bf16 v74, v37, v53, v74
    v_dot2_f32_bf16 v75, v45, v53, v75
    v_dot2_f32_bf16 v72, v22, v54, v72
    v_dot2_f32_bf16 v73, v30, v54, v73
    v_dot2_f32_bf16 v74, v38, v54, v74
    v_dot2_f32_bf16 v75, v46, v54, v75
    v_dot2_f32_bf16 v72, v23, v55, v72
    v_dot2_f32_bf16 v73, v31, v55, v73
    v_dot2_f32_bf16 v74, v39, v55, v74
    v_dot2_f32_bf16 v75, v47, v55, v75
    s_nop 2
    ds_read_b128 v[48:51], v10 offset:2048
    ds_read_b128 v[52:55], v10 offset:3072
    s_nop 1
    v_permlane32_swap_b32 v72, v73
    v_permlane32_swap_b32 v74, v75
    v_add_f32 v72, v72, v73
    v_add_f32 v74, v74, v75
    s_nop 1
    v_permlane16_swap_b32 v72, v74
    v_add_f32 v72, v72, v74
    s_nop 1
    v_add_f32_dpp v72, v72, v72 quad_perm:[1,0,3,2] row_mask:0xf bank_mask:0xf
    s_nop 1
    v_add_f32_dpp v72, v72, v72 quad_perm:[2,3,0,1] row_mask:0xf bank_mask:0xf
    s_nop 1
    v_add_f32_dpp v72, v72, v72 row_half_mirror row_mask:0xf bank_mask:0xf
    s_nop 1
    v_add_f32_dpp v72, v72, v72 row_mirror row_mask:0xf bank_mask:0xf
    s_sub_u32 s66, 34815, s50
    v_cvt_pk_bf16_f32 v72, 0, v72
    v_sub_u32 v73, s66, v3
    v_ashrrev_i32 v76, 31, v72
    v_or_b32 v76, 0x80000000, v76
    v_xor_b32 v72, v72, v76
    v_and_or_b32 v72, v72, s67, v73
    v_mov_b32 v10, 155680
    s_mov_b64 exec, s[68:69]
    ds_max_u32 v10, v72
    s_mov_b64 exec, -1
    s_waitcnt vmcnt(0)
    s_waitcnt lgkmcnt(0)
    s_barrier
    s_cmp_lg_u32 s48, 0
    s_cbranch_scc1 W_k2
    v_mov_b32 v10, 155680
    ds_read_b32 v12, v10
    s_waitcnt vmcnt(0)
    s_mov_b32 s67, 0
W_ts:
    v_cmp_eq_u32 vcc, 0, v15
    s_cbranch_vccz W_tok
    s_add_u32 s67, s67, 1
    s_cmp_ge_u32 s67, 200000
    s_cbranch_scc1 W_tok
    s_sleep 4
    buffer_load_dword v15, v14, s[40:43], 0 offen sc1
    s_waitcnt vmcnt(0)
    s_branch W_ts
W_tok:
    s_lshl_b32 s66, s2, 5
    s_add_u32 s66, s66, 6127616
    v_mov_b32 v10, s66
    v_mov_b32 v13, v15
    s_waitcnt lgkmcnt(0)
    s_mov_b64 exec, 1
    buffer_store_dwordx2 v[12:13], v10, s[16:19], 0 offen sc0 sc1
    s_mov_b64 exec, -1
W_k2:
    v_mov_b32 v248, -1
    v_mov_b32 v249, -1
    v_mov_b32 v250, -1
    v_mov_b32 v251, -1
    s_lshl_b32 s67, s4, 3
    s_lshl_b32 s66, s48, 2
    s_add_u32 s67, s67, s66
    s_lshl_b32 s67, s67, 15
    s_lshl_b32 s66, s5, 11
    s_add_u32 s67, s67, s66
    s_add_u32 s66, s67, 0
    buffer_store_dwordx4 v[248:251], v9, s[16:19], s66 offen offset:0 sc0 sc1
    s_add_u32 s66, s67, 0
    buffer_store_dwordx4 v[248:251], v9, s[16:19], s66 offen offset:1024 sc0 sc1
    s_add_u32 s66, s67, 32768
    buffer_store_dwordx4 v[248:251], v9, s[16:19], s66 offen offset:0 sc0 sc1
    s_add_u32 s66, s67, 32768
    buffer_store_dwordx4 v[248:251], v9, s[16:19], s66 offen offset:1024 sc0 sc1
    s_add_u32 s66, s67, 65536
    buffer_store_dwordx4 v[248:251], v9, s[16:19], s66 offen offset:0 sc0 sc1
    s_add_u32 s66, s67, 65536
    buffer_store_dwordx4 v[248:251], v9, s[16:19], s66 offen offset:1024 sc0 sc1
    s_add_u32 s66, s67, 98304
    buffer_store_dwordx4 v[248:251], v9, s[16:19], s66 offen offset:0 sc0 sc1
    s_add_u32 s66, s67, 98304
    buffer_store_dwordx4 v[248:251], v9, s[16:19], s66 offen offset:1024 sc0 sc1
    v_lshlrev_b32 v56, 16, v48
    v_and_b32 v57, 0xffff0000, v48
    v_lshlrev_b32 v58, 16, v49
    v_and_b32 v59, 0xffff0000, v49
    v_lshlrev_b32 v60, 16, v50
    v_and_b32 v61, 0xffff0000, v50
    v_lshlrev_b32 v62, 16, v51
    v_and_b32 v63, 0xffff0000, v51
    v_lshlrev_b32 v64, 16, v52
    v_and_b32 v65, 0xffff0000, v52
    v_lshlrev_b32 v66, 16, v53
    v_and_b32 v67, 0xffff0000, v53
    v_lshlrev_b32 v68, 16, v54
    v_and_b32 v69, 0xffff0000, v54
    v_lshlrev_b32 v70, 16, v55
    v_and_b32 v71, 0xffff0000, v55
    v_mov_b32 v76, 0
    v_lshlrev_b32 v72, 16, v16
    v_and_b32 v73, 0xffff0000, v16
    v_mul_f32 v72, v72, v56
    v_mul_f32 v73, v73, v57
    v_cvt_pk_bf16_f32 v72, 0, v72
    v_cvt_pk_bf16_f32 v73, 0, v73
    v_add_f32 v76, v76, v72
    v_add_f32 v76, v76, v73
    v_lshlrev_b32 v72, 16, v17
    v_and_b32 v73, 0xffff0000, v17
    v_mul_f32 v72, v72, v58
    v_mul_f32 v73, v73, v59
    v_cvt_pk_bf16_f32 v72, 0, v72
    v_cvt_pk_bf16_f32 v73, 0, v73
    v_add_f32 v76, v76, v72
    v_add_f32 v76, v76, v73
    v_lshlrev_b32 v72, 16, v18
    v_and_b32 v73, 0xffff0000, v18
    v_mul_f32 v72, v72, v60
    v_mul_f32 v73, v73, v61
    v_cvt_pk_bf16_f32 v72, 0, v72
    v_cvt_pk_bf16_f32 v73, 0, v73
    v_add_f32 v76, v76, v72
    v_add_f32 v76, v76, v73
    v_lshlrev_b32 v72, 16, v19
    v_and_b32 v73, 0xffff0000, v19
    v_mul_f32 v72, v72, v62
    v_mul_f32 v73, v73, v63
    v_cvt_pk_bf16_f32 v72, 0, v72
    v_cvt_pk_bf16_f32 v73, 0, v73
    v_add_f32 v76, v76, v72
    v_add_f32 v76, v76, v73
    v_lshlrev_b32 v72, 16, v20
    v_and_b32 v73, 0xffff0000, v20
    v_mul_f32 v72, v72, v64
    v_mul_f32 v73, v73, v65
    v_cvt_pk_bf16_f32 v72, 0, v72
    v_cvt_pk_bf16_f32 v73, 0, v73
    v_add_f32 v76, v76, v72
    v_add_f32 v76, v76, v73
    v_lshlrev_b32 v72, 16, v21
    v_and_b32 v73, 0xffff0000, v21
    v_mul_f32 v72, v72, v66
    v_mul_f32 v73, v73, v67
    v_cvt_pk_bf16_f32 v72, 0, v72
    v_cvt_pk_bf16_f32 v73, 0, v73
    v_add_f32 v76, v76, v72
    v_add_f32 v76, v76, v73
    v_lshlrev_b32 v72, 16, v22
    v_and_b32 v73, 0xffff0000, v22
    v_mul_f32 v72, v72, v68
    v_mul_f32 v73, v73, v69
    v_cvt_pk_bf16_f32 v72, 0, v72
    v_cvt_pk_bf16_f32 v73, 0, v73
    v_add_f32 v76, v76, v72
    v_add_f32 v76, v76, v73
    v_lshlrev_b32 v72, 16, v23
    v_and_b32 v73, 0xffff0000, v23
    v_mul_f32 v72, v72, v70
    v_mul_f32 v73, v73, v71
    v_cvt_pk_bf16_f32 v72, 0, v72
    v_cvt_pk_bf16_f32 v73, 0, v73
    v_add_f32 v76, v76, v72
    v_add_f32 v76, v76, v73
    s_barrier
    s_mov_b32 s66, 0
    buffer_load_dwordx4 v[96:99], v6, s[28:31], s66 offen
    s_mov_b32 s66, 7168
    buffer_load_dwordx4 v[100:103], v6, s[28:31], s66 offen
    s_mov_b32 s66, 14336
    buffer_load_dwordx4 v[104:107], v6, s[28:31], s66 offen
    s_mov_b32 s66, 21504
    buffer_load_dwordx4 v[108:111], v6, s[28:31], s66 offen
    s_mov_b32 s66, 28672
    buffer_load_dwordx4 v[112:115], v6, s[28:31], s66 offen
    s_mov_b32 s66, 35840
    buffer_load_dwordx4 v[116:119], v6, s[28:31], s66 offen
    s_mov_b32 s66, 43008
    buffer_load_dwordx4 v[120:123], v6, s[28:31], s66 offen
    s_mov_b32 s66, 50176
    buffer_load_dwordx4 v[124:127], v6, s[28:31], s66 offen
    v_mov_b32 v77, 0
    v_lshlrev_b32 v72, 16, v24
    v_and_b32 v73, 0xffff0000, v24
    v_mul_f32 v72, v72, v56
    v_mul_f32 v73, v73, v57
    v_cvt_pk_bf16_f32 v72, 0, v72
    v_cvt_pk_bf16_f32 v73, 0, v73
    v_add_f32 v77, v77, v72
    v_add_f32 v77, v77, v73
    v_lshlrev_b32 v72, 16, v25
    v_and_b32 v73, 0xffff0000, v25
    v_mul_f32 v72, v72, v58
    v_mul_f32 v73, v73, v59
    v_cvt_pk_bf16_f32 v72, 0, v72
    v_cvt_pk_bf16_f32 v73, 0, v73
    v_add_f32 v77, v77, v72
    v_add_f32 v77, v77, v73
    v_lshlrev_b32 v72, 16, v26
    v_and_b32 v73, 0xffff0000, v26
    v_mul_f32 v72, v72, v60
    v_mul_f32 v73, v73, v61
    v_cvt_pk_bf16_f32 v72, 0, v72
    v_cvt_pk_bf16_f32 v73, 0, v73
    v_add_f32 v77, v77, v72
    v_add_f32 v77, v77, v73
    v_lshlrev_b32 v72, 16, v27
    v_and_b32 v73, 0xffff0000, v27
    v_mul_f32 v72, v72, v62
    v_mul_f32 v73, v73, v63
    v_cvt_pk_bf16_f32 v72, 0, v72
    v_cvt_pk_bf16_f32 v73, 0, v73
    v_add_f32 v77, v77, v72
    v_add_f32 v77, v77, v73
    v_lshlrev_b32 v72, 16, v28
    v_and_b32 v73, 0xffff0000, v28
    v_mul_f32 v72, v72, v64
    v_mul_f32 v73, v73, v65
    v_cvt_pk_bf16_f32 v72, 0, v72
    v_cvt_pk_bf16_f32 v73, 0, v73
    v_add_f32 v77, v77, v72
    v_add_f32 v77, v77, v73
    v_lshlrev_b32 v72, 16, v29
    v_and_b32 v73, 0xffff0000, v29
    v_mul_f32 v72, v72, v66
    v_mul_f32 v73, v73, v67
    v_cvt_pk_bf16_f32 v72, 0, v72
    v_cvt_pk_bf16_f32 v73, 0, v73
    v_add_f32 v77, v77, v72
    v_add_f32 v77, v77, v73
    v_lshlrev_b32 v72, 16, v30
    v_and_b32 v73, 0xffff0000, v30
    v_mul_f32 v72, v72, v68
    v_mul_f32 v73, v73, v69
    v_cvt_pk_bf16_f32 v72, 0, v72
    v_cvt_pk_bf16_f32 v73, 0, v73
    v_add_f32 v77, v77, v72
    v_add_f32 v77, v77, v73
    v_lshlrev_b32 v72, 16, v31
    v_and_b32 v73, 0xffff0000, v31
    v_mul_f32 v72, v72, v70
    v_mul_f32 v73, v73, v71
    v_cvt_pk_bf16_f32 v72, 0, v72
    v_cvt_pk_bf16_f32 v73, 0, v73
    v_add_f32 v77, v77, v72
    v_add_f32 v77, v77, v73
    v_mov_b32 v78, 0
    v_lshlrev_b32 v72, 16, v32
    v_and_b32 v73, 0xffff0000, v32
    v_mul_f32 v72, v72, v56
    v_mul_f32 v73, v73, v57
    v_cvt_pk_bf16_f32 v72, 0, v72
    v_cvt_pk_bf16_f32 v73, 0, v73
    v_add_f32 v78, v78, v72
    v_add_f32 v78, v78, v73
    v_lshlrev_b32 v72, 16, v33
    v_and_b32 v73, 0xffff0000, v33
    v_mul_f32 v72, v72, v58
    v_mul_f32 v73, v73, v59
    v_cvt_pk_bf16_f32 v72, 0, v72
    v_cvt_pk_bf16_f32 v73, 0, v73
    v_add_f32 v78, v78, v72
    v_add_f32 v78, v78, v73
    v_lshlrev_b32 v72, 16, v34
    v_and_b32 v73, 0xffff0000, v34
    v_mul_f32 v72, v72, v60
    v_mul_f32 v73, v73, v61
    v_cvt_pk_bf16_f32 v72, 0, v72
    v_cvt_pk_bf16_f32 v73, 0, v73
    v_add_f32 v78, v78, v72
    v_add_f32 v78, v78, v73
    v_lshlrev_b32 v72, 16, v35
    v_and_b32 v73, 0xffff0000, v35
    v_mul_f32 v72, v72, v62
    v_mul_f32 v73, v73, v63
    v_cvt_pk_bf16_f32 v72, 0, v72
    v_cvt_pk_bf16_f32 v73, 0, v73
    v_add_f32 v78, v78, v72
    v_add_f32 v78, v78, v73
    v_lshlrev_b32 v72, 16, v36
    v_and_b32 v73, 0xffff0000, v36
    v_mul_f32 v72, v72, v64
    v_mul_f32 v73, v73, v65
    v_cvt_pk_bf16_f32 v72, 0, v72
    v_cvt_pk_bf16_f32 v73, 0, v73
    v_add_f32 v78, v78, v72
    v_add_f32 v78, v78, v73
    v_lshlrev_b32 v72, 16, v37
    v_and_b32 v73, 0xffff0000, v37
    v_mul_f32 v72, v72, v66
    v_mul_f32 v73, v73, v67
    v_cvt_pk_bf16_f32 v72, 0, v72
    v_cvt_pk_bf16_f32 v73, 0, v73
    v_add_f32 v78, v78, v72
    v_add_f32 v78, v78, v73
    v_lshlrev_b32 v72, 16, v38
    v_and_b32 v73, 0xffff0000, v38
    v_mul_f32 v72, v72, v68
    v_mul_f32 v73, v73, v69
    v_cvt_pk_bf16_f32 v72, 0, v72
    v_cvt_pk_bf16_f32 v73, 0, v73
    v_add_f32 v78, v78, v72
    v_add_f32 v78, v78, v73
    v_lshlrev_b32 v72, 16, v39
    v_and_b32 v73, 0xffff0000, v39
    v_mul_f32 v72, v72, v70
    v_mul_f32 v73, v73, v71
    v_cvt_pk_bf16_f32 v72, 0, v72
    v_cvt_pk_bf16_f32 v73, 0, v73
    v_add_f32 v78, v78, v72
    v_add_f32 v78, v78, v73
    s_barrier
    s_cmp_lg_u32 s48, 0
    s_cbranch_scc1 W_k4
    s_movk_i32 s66, 0
    buffer_load_dwordx2 v[224:225], v8, s[16:19], s66 offen sc1
    s_movk_i32 s66, 2048
    buffer_load_dwordx2 v[226:227], v8, s[16:19], s66 offen sc1
    s_movk_i32 s66, 4096
    buffer_load_dwordx2 v[228:229], v8, s[16:19], s66 offen sc1
    s_movk_i32 s66, 6144
    buffer_load_dwordx2 v[230:231], v8, s[16:19], s66 offen sc1
W_k4:
    v_mov_b32 v79, 0
    v_lshlrev_b32 v72, 16, v40
    v_and_b32 v73, 0xffff0000, v40
    v_mul_f32 v72, v72, v56
    v_mul_f32 v73, v73, v57
    v_cvt_pk_bf16_f32 v72, 0, v72
    v_cvt_pk_bf16_f32 v73, 0, v73
    v_add_f32 v79, v79, v72
    v_add_f32 v79, v79, v73
    v_lshlrev_b32 v72, 16, v41
    v_and_b32 v73, 0xffff0000, v41
    v_mul_f32 v72, v72, v58
    v_mul_f32 v73, v73, v59
    v_cvt_pk_bf16_f32 v72, 0, v72
    v_cvt_pk_bf16_f32 v73, 0, v73
    v_add_f32 v79, v79, v72
    v_add_f32 v79, v79, v73
    v_lshlrev_b32 v72, 16, v42
    v_and_b32 v73, 0xffff0000, v42
    v_mul_f32 v72, v72, v60
    v_mul_f32 v73, v73, v61
    v_cvt_pk_bf16_f32 v72, 0, v72
    v_cvt_pk_bf16_f32 v73, 0, v73
    v_add_f32 v79, v79, v72
    v_add_f32 v79, v79, v73
    v_lshlrev_b32 v72, 16, v43
    v_and_b32 v73, 0xffff0000, v43
    v_mul_f32 v72, v72, v62
    v_mul_f32 v73, v73, v63
    v_cvt_pk_bf16_f32 v72, 0, v72
    v_cvt_pk_bf16_f32 v73, 0, v73
    v_add_f32 v79, v79, v72
    v_add_f32 v79, v79, v73
    v_lshlrev_b32 v72, 16, v44
    v_and_b32 v73, 0xffff0000, v44
    v_mul_f32 v72, v72, v64
    v_mul_f32 v73, v73, v65
    v_cvt_pk_bf16_f32 v72, 0, v72
    v_cvt_pk_bf16_f32 v73, 0, v73
    v_add_f32 v79, v79, v72
    v_add_f32 v79, v79, v73
    v_lshlrev_b32 v72, 16, v45
    v_and_b32 v73, 0xffff0000, v45
    v_mul_f32 v72, v72, v66
    v_mul_f32 v73, v73, v67
    v_cvt_pk_bf16_f32 v72, 0, v72
    v_cvt_pk_bf16_f32 v73, 0, v73
    v_add_f32 v79, v79, v72
    v_add_f32 v79, v79, v73
    v_lshlrev_b32 v72, 16, v46
    v_and_b32 v73, 0xffff0000, v46
    v_mul_f32 v72, v72, v68
    v_mul_f32 v73, v73, v69
    v_cvt_pk_bf16_f32 v72, 0, v72
    v_cvt_pk_bf16_f32 v73, 0, v73
    v_add_f32 v79, v79, v72
    v_add_f32 v79, v79, v73
    v_lshlrev_b32 v72, 16, v47
    v_and_b32 v73, 0xffff0000, v47
    v_mul_f32 v72, v72, v70
    v_mul_f32 v73, v73, v71
    v_cvt_pk_bf16_f32 v72, 0, v72
    v_cvt_pk_bf16_f32 v73, 0, v73
    v_add_f32 v79, v79, v72
    v_add_f32 v79, v79, v73
    s_nop 1
    v_permlane32_swap_b32 v76, v77
    v_permlane32_swap_b32 v78, v79
    v_add_f32 v76, v76, v77
    v_add_f32 v78, v78, v79
    s_nop 1
    v_permlane16_swap_b32 v76, v78
    v_add_f32 v76, v76, v78
    s_nop 1
    v_add_f32_dpp v76, v76, v76 quad_perm:[1,0,3,2] row_mask:0xf bank_mask:0xf
    s_nop 1
    v_add_f32_dpp v76, v76, v76 quad_perm:[2,3,0,1] row_mask:0xf bank_mask:0xf
    s_nop 1
    v_add_f32_dpp v76, v76, v76 row_half_mirror row_mask:0xf bank_mask:0xf
    s_nop 1
    v_add_f32_dpp v76, v76, v76 row_mirror row_mask:0xf bank_mask:0xf
    v_cvt_pk_bf16_f32 v76, 0, v76
    v_mul_f32 v76, s46, v76
    v_exp_f32 v76, -v76
    s_lshl_b32 s66, s50, 4
    v_add_f32 v76, 1.0, v76
    v_rcp_f32 v76, v76
    s_add_u32 s66, s66, 6094848
    v_cvt_pk_bf16_f32 v76, 0, v76
    v_lshlrev_b32 v10, 2, v3
    s_mov_b32 exec_lo, 0x00010001
    s_mov_b32 exec_hi, 0x00010001
    buffer_store_dword v76, v10, s[16:19], s66 offen sc0 sc1
    s_mov_b64 exec, -1
    s_barrier
    s_mov_b32 s66, 57344
    buffer_load_dwordx4 v[128:131], v6, s[28:31], s66 offen
    s_mov_b32 s66, 64512
    buffer_load_dwordx4 v[132:135], v6, s[28:31], s66 offen
    s_mov_b32 s66, 71680
    buffer_load_dwordx4 v[136:139], v6, s[28:31], s66 offen
    s_mov_b32 s66, 78848
    buffer_load_dwordx4 v[140:143], v6, s[28:31], s66 offen
    s_mov_b32 s66, 86016
    buffer_load_dwordx4 v[144:147], v6, s[28:31], s66 offen
    s_mov_b32 s66, 93184
    buffer_load_dwordx4 v[148:151], v6, s[28:31], s66 offen
    s_mov_b32 s66, 100352
    buffer_load_dwordx4 v[152:155], v6, s[28:31], s66 offen
    s_mov_b32 s66, 107520
    buffer_load_dwordx4 v[156:159], v6, s[28:31], s66 offen
    s_cmp_lg_u32 s48, 0
    s_cbranch_scc1 W_c5
    s_waitcnt vmcnt(9)
    s_mov_b32 s67, 0
W_cs:
    v_xor_b32 v10, v225, v15
    v_xor_b32 v11, v227, v15
    v_or_b32 v10, v10, v11
    v_xor_b32 v11, v229, v15
    v_or_b32 v10, v10, v11
    v_xor_b32 v11, v231, v15
    v_or_b32 v10, v10, v11
    v_cmp_ne_u32 vcc, 0, v10
    s_cbranch_vccz W_cok
    s_add_u32 s67, s67, 1
    s_cmp_ge_u32 s67, 200000
    s_cbranch_scc1 W_cok
    s_sleep 4
    s_movk_i32 s66, 0
    buffer_load_dwordx2 v[224:225], v8, s[16:19], s66 offen sc1
    s_movk_i32 s66, 2048
    buffer_load_dwordx2 v[226:227], v8, s[16:19], s66 offen sc1
    s_movk_i32 s66, 4096
    buffer_load_dwordx2 v[228:229], v8, s[16:19], s66 offen sc1
    s_movk_i32 s66, 6144
    buffer_load_dwordx2 v[230:231], v8, s[16:19], s66 offen sc1
    s_waitcnt vmcnt(0)
    s_branch W_cs
W_cok:
    v_max_u32 v12, v224, v226
    v_max3_u32 v12, v12, v228, v230
    s_nop 1
    s_nop 1
    v_max_u32_dpp v12, v12, v12 quad_perm:[1,0,3,2] row_mask:0xf bank_mask:0xf
    s_nop 1
    v_max_u32_dpp v12, v12, v12 quad_perm:[2,3,0,1] row_mask:0xf bank_mask:0xf
    s_nop 1
    v_max_u32_dpp v12, v12, v12 row_half_mirror row_mask:0xf bank_mask:0xf
    s_nop 1
    v_max_u32_dpp v12, v12, v12 row_mirror row_mask:0xf bank_mask:0xf
    s_nop 1
    v_readlane_b32 s68, v12, 0
    v_readlane_b32 s69, v12, 16
    v_readlane_b32 s70, v12, 32
    v_readlane_b32 s71, v12, 48
    s_nop 1
    v_mov_b32 v12, s68
    v_max_u32 v12, s69, v12
    v_max_u32 v12, s70, v12
    v_max_u32 v12, s71, v12
    v_mov_b32 v10, 155684
    ds_write_b32 v10, v12
W_c5:
    s_waitcnt lgkmcnt(0)
    s_barrier
    v_mov_b32 v10, 155684
    ds_read_b32 v11, v10
    v_lshrrev_b32 v10, 5, v2
    v_lshlrev_b32 v10, 6, v10
    s_waitcnt lgkmcnt(0)
    v_readfirstlane_b32 s66, v11
    s_and_b32 s66, s66, 0x7ff
    s_sub_u32 s66, 2047, s66
    s_lshl_b32 s66, s66, 10
    s_add_u32 s66, s66, s51
    s_lshl_b32 s66, s66, 1
    buffer_load_dwordx4 v[224:227], v10, s[8:11], s66 offen offset:0
    buffer_load_dwordx4 v[228:231], v10, s[8:11], s66 offen offset:16
    buffer_load_dwordx4 v[232:235], v10, s[8:11], s66 offen offset:32
    buffer_load_dwordx4 v[236:239], v10, s[8:11], s66 offen offset:48
    s_barrier
    s_mov_b32 s66, 114688
    buffer_load_dwordx4 v[160:163], v6, s[28:31], s66 offen
    s_mov_b32 s66, 121856
    buffer_load_dwordx4 v[164:167], v6, s[28:31], s66 offen
    s_mov_b32 s66, 129024
    buffer_load_dwordx4 v[168:171], v6, s[28:31], s66 offen
    s_mov_b32 s66, 136192
    buffer_load_dwordx4 v[172:175], v6, s[28:31], s66 offen
    s_mov_b32 s66, 143360
    buffer_load_dwordx4 v[176:179], v6, s[28:31], s66 offen
    s_mov_b32 s66, 150528
    buffer_load_dwordx4 v[180:183], v6, s[28:31], s66 offen
    s_mov_b32 s66, 157696
    buffer_load_dwordx4 v[184:187], v6, s[28:31], s66 offen
    s_mov_b32 s66, 164864
    buffer_load_dwordx4 v[188:191], v6, s[28:31], s66 offen
    s_waitcnt vmcnt(8)
    v_mov_b32 v64, 0
    v_mov_b32 v65, 0
    v_mov_b32 v66, 0
    v_mov_b32 v67, 0
    v_mov_b32 v68, 0
    v_mov_b32 v69, 0
    v_mov_b32 v70, 0
    v_mov_b32 v71, 0
    v_lshlrev_b32 v72, 16, v224
    v_lshlrev_b32 v73, 16, v96
    v_and_b32 v74, 0xffff0000, v96
    v_fmac_f32 v64, v73, v72
    v_fmac_f32 v65, v74, v72
    v_lshlrev_b32 v73, 16, v97
    v_and_b32 v74, 0xffff0000, v97
    v_fmac_f32 v66, v73, v72
    v_fmac_f32 v67, v74, v72
    v_lshlrev_b32 v73, 16, v98
    v_and_b32 v74, 0xffff0000, v98
    v_fmac_f32 v68, v73, v72
    v_fmac_f32 v69, v74, v72
    v_lshlrev_b32 v73, 16, v99
    v_and_b32 v74, 0xffff0000, v99
    v_fmac_f32 v70, v73, v72
    v_fmac_f32 v71, v74, v72
    v_and_b32 v72, 0xffff0000, v224
    v_lshlrev_b32 v73, 16, v100
    v_and_b32 v74, 0xffff0000, v100
    v_fmac_f32 v64, v73, v72
    v_fmac_f32 v65, v74, v72
    v_lshlrev_b32 v73, 16, v101
    v_and_b32 v74, 0xffff0000, v101
    v_fmac_f32 v66, v73, v72
    v_fmac_f32 v67, v74, v72
    v_lshlrev_b32 v73, 16, v102
    v_and_b32 v74, 0xffff0000, v102
    v_fmac_f32 v68, v73, v72
    v_fmac_f32 v69, v74, v72
    v_lshlrev_b32 v73, 16, v103
    v_and_b32 v74, 0xffff0000, v103
    v_fmac_f32 v70, v73, v72
    v_fmac_f32 v71, v74, v72
    v_lshlrev_b32 v72, 16, v225
    v_lshlrev_b32 v73, 16, v104
    v_and_b32 v74, 0xffff0000, v104
    v_fmac_f32 v64, v73, v72
    v_fmac_f32 v65, v74, v72
    v_lshlrev_b32 v73, 16, v105
    v_and_b32 v74, 0xffff0000, v105
    v_fmac_f32 v66, v73, v72
    v_fmac_f32 v67, v74, v72
    v_lshlrev_b32 v73, 16, v106
    v_and_b32 v74, 0xffff0000, v106
    v_fmac_f32 v68, v73, v72
    v_fmac_f32 v69, v74, v72
    v_lshlrev_b32 v73, 16, v107
    v_and_b32 v74, 0xffff0000, v107
    v_fmac_f32 v70, v73, v72
    v_fmac_f32 v71, v74, v72
    v_and_b32 v72, 0xffff0000, v225
    v_lshlrev_b32 v73, 16, v108
    v_and_b32 v74, 0xffff0000, v108
    v_fmac_f32 v64, v73, v72
    v_fmac_f32 v65, v74, v72
    v_lshlrev_b32 v73, 16, v109
    v_and_b32 v74, 0xffff0000, v109
    v_fmac_f32 v66, v73, v72
    v_fmac_f32 v67, v74, v72
    v_lshlrev_b32 v73, 16, v110
    v_and_b32 v74, 0xffff0000, v110
    v_fmac_f32 v68, v73, v72
    v_fmac_f32 v69, v74, v72
    v_lshlrev_b32 v73, 16, v111
    v_and_b32 v74, 0xffff0000, v111
    v_fmac_f32 v70, v73, v72
    v_fmac_f32 v71, v74, v72
    v_lshlrev_b32 v72, 16, v226
    v_lshlrev_b32 v73, 16, v112
    v_and_b32 v74, 0xffff0000, v112
    v_fmac_f32 v64, v73, v72
    v_fmac_f32 v65, v74, v72
    v_lshlrev_b32 v73, 16, v113
    v_and_b32 v74, 0xffff0000, v113
    v_fmac_f32 v66, v73, v72
    v_fmac_f32 v67, v74, v72
    v_lshlrev_b32 v73, 16, v114
    v_and_b32 v74, 0xffff0000, v114
    v_fmac_f32 v68, v73, v72
    v_fmac_f32 v69, v74, v72
    v_lshlrev_b32 v73, 16, v115
    v_and_b32 v74, 0xffff0000, v115
    v_fmac_f32 v70, v73, v72
    v_fmac_f32 v71, v74, v72
    v_and_b32 v72, 0xffff0000, v226
    v_lshlrev_b32 v73, 16, v116
    v_and_b32 v74, 0xffff0000, v116
    v_fmac_f32 v64, v73, v72
    v_fmac_f32 v65, v74, v72
    v_lshlrev_b32 v73, 16, v117
    v_and_b32 v74, 0xffff0000, v117
    v_fmac_f32 v66, v73, v72
    v_fmac_f32 v67, v74, v72
    v_lshlrev_b32 v73, 16, v118
    v_and_b32 v74, 0xffff0000, v118
    v_fmac_f32 v68, v73, v72
    v_fmac_f32 v69, v74, v72
    v_lshlrev_b32 v73, 16, v119
    v_and_b32 v74, 0xffff0000, v119
    v_fmac_f32 v70, v73, v72
    v_fmac_f32 v71, v74, v72
    s_barrier
    v_lshlrev_b32 v72, 16, v227
    v_lshlrev_b32 v73, 16, v120
    v_and_b32 v74, 0xffff0000, v120
    v_fmac_f32 v64, v73, v72
    v_fmac_f32 v65, v74, v72
    v_lshlrev_b32 v73, 16, v121
    v_and_b32 v74, 0xffff0000, v121
    v_fmac_f32 v66, v73, v72
    v_fmac_f32 v67, v74, v72
    v_lshlrev_b32 v73, 16, v122
    v_and_b32 v74, 0xffff0000, v122
    v_fmac_f32 v68, v73, v72
    v_fmac_f32 v69, v74, v72
    v_lshlrev_b32 v73, 16, v123
    v_and_b32 v74, 0xffff0000, v123
    v_fmac_f32 v70, v73, v72
    v_fmac_f32 v71, v74, v72
    v_and_b32 v72, 0xffff0000, v227
    v_lshlrev_b32 v73, 16, v124
    v_and_b32 v74, 0xffff0000, v124
    v_fmac_f32 v64, v73, v72
    v_fmac_f32 v65, v74, v72
    v_lshlrev_b32 v73, 16, v125
    v_and_b32 v74, 0xffff0000, v125
    v_fmac_f32 v66, v73, v72
    v_fmac_f32 v67, v74, v72
    v_lshlrev_b32 v73, 16, v126
    v_and_b32 v74, 0xffff0000, v126
    v_fmac_f32 v68, v73, v72
    v_fmac_f32 v69, v74, v72
    v_lshlrev_b32 v73, 16, v127
    v_and_b32 v74, 0xffff0000, v127
    v_fmac_f32 v70, v73, v72
    v_fmac_f32 v71, v74, v72
    v_lshlrev_b32 v72, 16, v228
    v_lshlrev_b32 v73, 16, v128
    v_and_b32 v74, 0xffff0000, v128
    v_fmac_f32 v64, v73, v72
    v_fmac_f32 v65, v74, v72
    v_lshlrev_b32 v73, 16, v129
    v_and_b32 v74, 0xffff0000, v129
    v_fmac_f32 v66, v73, v72
    v_fmac_f32 v67, v74, v72
    v_lshlrev_b32 v73, 16, v130
    v_and_b32 v74, 0xffff0000, v130
    v_fmac_f32 v68, v73, v72
    v_fmac_f32 v69, v74, v72
    v_lshlrev_b32 v73, 16, v131
    v_and_b32 v74, 0xffff0000, v131
    v_fmac_f32 v70, v73, v72
    v_fmac_f32 v71, v74, v72
    v_and_b32 v72, 0xffff0000, v228
    v_lshlrev_b32 v73, 16, v132
    v_and_b32 v74, 0xffff0000, v132
    v_fmac_f32 v64, v73, v72
    v_fmac_f32 v65, v74, v72
    v_lshlrev_b32 v73, 16, v133
    v_and_b32 v74, 0xffff0000, v133
    v_fmac_f32 v66, v73, v72
    v_fmac_f32 v67, v74, v72
    v_lshlrev_b32 v73, 16, v134
    v_and_b32 v74, 0xffff0000, v134
    v_fmac_f32 v68, v73, v72
    v_fmac_f32 v69, v74, v72
    v_lshlrev_b32 v73, 16, v135
    v_and_b32 v74, 0xffff0000, v135
    v_fmac_f32 v70, v73, v72
    v_fmac_f32 v71, v74, v72
    v_lshlrev_b32 v72, 16, v229
    v_lshlrev_b32 v73, 16, v136
    v_and_b32 v74, 0xffff0000, v136
    v_fmac_f32 v64, v73, v72
    v_fmac_f32 v65, v74, v72
    v_lshlrev_b32 v73, 16, v137
    v_and_b32 v74, 0xffff0000, v137
    v_fmac_f32 v66, v73, v72
    v_fmac_f32 v67, v74, v72
    v_lshlrev_b32 v73, 16, v138
    v_and_b32 v74, 0xffff0000, v138
    v_fmac_f32 v68, v73, v72
    v_fmac_f32 v69, v74, v72
    v_lshlrev_b32 v73, 16, v139
    v_and_b32 v74, 0xffff0000, v139
    v_fmac_f32 v70, v73, v72
    v_fmac_f32 v71, v74, v72
    v_and_b32 v72, 0xffff0000, v229
    v_lshlrev_b32 v73, 16, v140
    v_and_b32 v74, 0xffff0000, v140
    v_fmac_f32 v64, v73, v72
    v_fmac_f32 v65, v74, v72
    v_lshlrev_b32 v73, 16, v141
    v_and_b32 v74, 0xffff0000, v141
    v_fmac_f32 v66, v73, v72
    v_fmac_f32 v67, v74, v72
    v_lshlrev_b32 v73, 16, v142
    v_and_b32 v74, 0xffff0000, v142
    v_fmac_f32 v68, v73, v72
    v_fmac_f32 v69, v74, v72
    v_lshlrev_b32 v73, 16, v143
    v_and_b32 v74, 0xffff0000, v143
    v_fmac_f32 v70, v73, v72
    v_fmac_f32 v71, v74, v72
    s_barrier
    s_mov_b32 s66, 172032
    buffer_load_dwordx4 v[192:195], v6, s[28:31], s66 offen
    s_mov_b32 s66, 179200
    buffer_load_dwordx4 v[196:199], v6, s[28:31], s66 offen
    s_mov_b32 s66, 186368
    buffer_load_dwordx4 v[200:203], v6, s[28:31], s66 offen
    s_mov_b32 s66, 193536
    buffer_load_dwordx4 v[204:207], v6, s[28:31], s66 offen
    s_mov_b32 s66, 200704
    buffer_load_dwordx4 v[208:211], v6, s[28:31], s66 offen
    s_mov_b32 s66, 207872
    buffer_load_dwordx4 v[212:215], v6, s[28:31], s66 offen
    s_mov_b32 s66, 215040
    buffer_load_dwordx4 v[216:219], v6, s[28:31], s66 offen
    s_mov_b32 s66, 222208
    buffer_load_dwordx4 v[220:223], v6, s[28:31], s66 offen
    v_lshlrev_b32 v72, 16, v230
    v_lshlrev_b32 v73, 16, v144
    v_and_b32 v74, 0xffff0000, v144
    v_fmac_f32 v64, v73, v72
    v_fmac_f32 v65, v74, v72
    v_lshlrev_b32 v73, 16, v145
    v_and_b32 v74, 0xffff0000, v145
    v_fmac_f32 v66, v73, v72
    v_fmac_f32 v67, v74, v72
    v_lshlrev_b32 v73, 16, v146
    v_and_b32 v74, 0xffff0000, v146
    v_fmac_f32 v68, v73, v72
    v_fmac_f32 v69, v74, v72
    v_lshlrev_b32 v73, 16, v147
    v_and_b32 v74, 0xffff0000, v147
    v_fmac_f32 v70, v73, v72
    v_fmac_f32 v71, v74, v72
    v_and_b32 v72, 0xffff0000, v230
    v_lshlrev_b32 v73, 16, v148
    v_and_b32 v74, 0xffff0000, v148
    v_fmac_f32 v64, v73, v72
    v_fmac_f32 v65, v74, v72
    v_lshlrev_b32 v73, 16, v149
    v_and_b32 v74, 0xffff0000, v149
    v_fmac_f32 v66, v73, v72
    v_fmac_f32 v67, v74, v72
    v_lshlrev_b32 v73, 16, v150
    v_and_b32 v74, 0xffff0000, v150
    v_fmac_f32 v68, v73, v72
    v_fmac_f32 v69, v74, v72
    v_lshlrev_b32 v73, 16, v151
    v_and_b32 v74, 0xffff0000, v151
    v_fmac_f32 v70, v73, v72
    v_fmac_f32 v71, v74, v72
    v_lshlrev_b32 v72, 16, v231
    v_lshlrev_b32 v73, 16, v152
    v_and_b32 v74, 0xffff0000, v152
    v_fmac_f32 v64, v73, v72
    v_fmac_f32 v65, v74, v72
    v_lshlrev_b32 v73, 16, v153
    v_and_b32 v74, 0xffff0000, v153
    v_fmac_f32 v66, v73, v72
    v_fmac_f32 v67, v74, v72
    v_lshlrev_b32 v73, 16, v154
    v_and_b32 v74, 0xffff0000, v154
    v_fmac_f32 v68, v73, v72
    v_fmac_f32 v69, v74, v72
    v_lshlrev_b32 v73, 16, v155
    v_and_b32 v74, 0xffff0000, v155
    v_fmac_f32 v70, v73, v72
    v_fmac_f32 v71, v74, v72
    v_and_b32 v72, 0xffff0000, v231
    v_lshlrev_b32 v73, 16, v156
    v_and_b32 v74, 0xffff0000, v156
    v_fmac_f32 v64, v73, v72
    v_fmac_f32 v65, v74, v72
    v_lshlrev_b32 v73, 16, v157
    v_and_b32 v74, 0xffff0000, v157
    v_fmac_f32 v66, v73, v72
    v_fmac_f32 v67, v74, v72
    v_lshlrev_b32 v73, 16, v158
    v_and_b32 v74, 0xffff0000, v158
    v_fmac_f32 v68, v73, v72
    v_fmac_f32 v69, v74, v72
    v_lshlrev_b32 v73, 16, v159
    v_and_b32 v74, 0xffff0000, v159
    v_fmac_f32 v70, v73, v72
    v_fmac_f32 v71, v74, v72
    s_waitcnt vmcnt(15)
    v_lshlrev_b32 v72, 16, v232
    v_lshlrev_b32 v73, 16, v160
    v_and_b32 v74, 0xffff0000, v160
    v_fmac_f32 v64, v73, v72
    v_fmac_f32 v65, v74, v72
    v_lshlrev_b32 v73, 16, v161
    v_and_b32 v74, 0xffff0000, v161
    v_fmac_f32 v66, v73, v72
    v_fmac_f32 v67, v74, v72
    v_lshlrev_b32 v73, 16, v162
    v_and_b32 v74, 0xffff0000, v162
    v_fmac_f32 v68, v73, v72
    v_fmac_f32 v69, v74, v72
    v_lshlrev_b32 v73, 16, v163
    v_and_b32 v74, 0xffff0000, v163
    v_fmac_f32 v70, v73, v72
    v_fmac_f32 v71, v74, v72
    s_waitcnt vmcnt(14)
    v_and_b32 v72, 0xffff0000, v232
    v_lshlrev_b32 v73, 16, v164
    v_and_b32 v74, 0xffff0000, v164
    v_fmac_f32 v64, v73, v72
    v_fmac_f32 v65, v74, v72
    v_lshlrev_b32 v73, 16, v165
    v_and_b32 v74, 0xffff0000, v165
    v_fmac_f32 v66, v73, v72
    v_fmac_f32 v67, v74, v72
    v_lshlrev_b32 v73, 16, v166
    v_and_b32 v74, 0xffff0000, v166
    v_fmac_f32 v68, v73, v72
    v_fmac_f32 v69, v74, v72
    v_lshlrev_b32 v73, 16, v167
    v_and_b32 v74, 0xffff0000, v167
    v_fmac_f32 v70, v73, v72
    v_fmac_f32 v71, v74, v72
    s_barrier
    s_waitcnt vmcnt(13)
    v_lshlrev_b32 v72, 16, v233
    v_lshlrev_b32 v73, 16, v168
    v_and_b32 v74, 0xffff0000, v168
    v_fmac_f32 v64, v73, v72
    v_fmac_f32 v65, v74, v72
    v_lshlrev_b32 v73, 16, v169
    v_and_b32 v74, 0xffff0000, v169
    v_fmac_f32 v66, v73, v72
    v_fmac_f32 v67, v74, v72
    v_lshlrev_b32 v73, 16, v170
    v_and_b32 v74, 0xffff0000, v170
    v_fmac_f32 v68, v73, v72
    v_fmac_f32 v69, v74, v72
    v_lshlrev_b32 v73, 16, v171
    v_and_b32 v74, 0xffff0000, v171
    v_fmac_f32 v70, v73, v72
    v_fmac_f32 v71, v74, v72
    s_waitcnt vmcnt(12)
    v_and_b32 v72, 0xffff0000, v233
    v_lshlrev_b32 v73, 16, v172
    v_and_b32 v74, 0xffff0000, v172
    v_fmac_f32 v64, v73, v72
    v_fmac_f32 v65, v74, v72
    v_lshlrev_b32 v73, 16, v173
    v_and_b32 v74, 0xffff0000, v173
    v_fmac_f32 v66, v73, v72
    v_fmac_f32 v67, v74, v72
    v_lshlrev_b32 v73, 16, v174
    v_and_b32 v74, 0xffff0000, v174
    v_fmac_f32 v68, v73, v72
    v_fmac_f32 v69, v74, v72
    v_lshlrev_b32 v73, 16, v175
    v_and_b32 v74, 0xffff0000, v175
    v_fmac_f32 v70, v73, v72
    v_fmac_f32 v71, v74, v72
    s_waitcnt vmcnt(11)
    v_lshlrev_b32 v72, 16, v234
    v_lshlrev_b32 v73, 16, v176
    v_and_b32 v74, 0xffff0000, v176
    v_fmac_f32 v64, v73, v72
    v_fmac_f32 v65, v74, v72
    v_lshlrev_b32 v73, 16, v177
    v_and_b32 v74, 0xffff0000, v177
    v_fmac_f32 v66, v73, v72
    v_fmac_f32 v67, v74, v72
    v_lshlrev_b32 v73, 16, v178
    v_and_b32 v74, 0xffff0000, v178
    v_fmac_f32 v68, v73, v72
    v_fmac_f32 v69, v74, v72
    v_lshlrev_b32 v73, 16, v179
    v_and_b32 v74, 0xffff0000, v179
    v_fmac_f32 v70, v73, v72
    v_fmac_f32 v71, v74, v72
    s_waitcnt vmcnt(10)
    v_and_b32 v72, 0xffff0000, v234
    v_lshlrev_b32 v73, 16, v180
    v_and_b32 v74, 0xffff0000, v180
    v_fmac_f32 v64, v73, v72
    v_fmac_f32 v65, v74, v72
    v_lshlrev_b32 v73, 16, v181
    v_and_b32 v74, 0xffff0000, v181
    v_fmac_f32 v66, v73, v72
    v_fmac_f32 v67, v74, v72
    v_lshlrev_b32 v73, 16, v182
    v_and_b32 v74, 0xffff0000, v182
    v_fmac_f32 v68, v73, v72
    v_fmac_f32 v69, v74, v72
    v_lshlrev_b32 v73, 16, v183
    v_and_b32 v74, 0xffff0000, v183
    v_fmac_f32 v70, v73, v72
    v_fmac_f32 v71, v74, v72
    s_barrier
    s_waitcnt vmcnt(9)
    v_lshlrev_b32 v72, 16, v235
    v_lshlrev_b32 v73, 16, v184
    v_and_b32 v74, 0xffff0000, v184
    v_fmac_f32 v64, v73, v72
    v_fmac_f32 v65, v74, v72
    v_lshlrev_b32 v73, 16, v185
    v_and_b32 v74, 0xffff0000, v185
    v_fmac_f32 v66, v73, v72
    v_fmac_f32 v67, v74, v72
    v_lshlrev_b32 v73, 16, v186
    v_and_b32 v74, 0xffff0000, v186
    v_fmac_f32 v68, v73, v72
    v_fmac_f32 v69, v74, v72
    v_lshlrev_b32 v73, 16, v187
    v_and_b32 v74, 0xffff0000, v187
    v_fmac_f32 v70, v73, v72
    v_fmac_f32 v71, v74, v72
    s_waitcnt vmcnt(8)
    v_and_b32 v72, 0xffff0000, v235
    v_lshlrev_b32 v73, 16, v188
    v_and_b32 v74, 0xffff0000, v188
    v_fmac_f32 v64, v73, v72
    v_fmac_f32 v65, v74, v72
    v_lshlrev_b32 v73, 16, v189
    v_and_b32 v74, 0xffff0000, v189
    v_fmac_f32 v66, v73, v72
    v_fmac_f32 v67, v74, v72
    v_lshlrev_b32 v73, 16, v190
    v_and_b32 v74, 0xffff0000, v190
    v_fmac_f32 v68, v73, v72
    v_fmac_f32 v69, v74, v72
    v_lshlrev_b32 v73, 16, v191
    v_and_b32 v74, 0xffff0000, v191
    v_fmac_f32 v70, v73, v72
    v_fmac_f32 v71, v74, v72
    s_waitcnt vmcnt(7)
    v_lshlrev_b32 v72, 16, v236
    v_lshlrev_b32 v73, 16, v192
    v_and_b32 v74, 0xffff0000, v192
    v_fmac_f32 v64, v73, v72
    v_fmac_f32 v65, v74, v72
    v_lshlrev_b32 v73, 16, v193
    v_and_b32 v74, 0xffff0000, v193
    v_fmac_f32 v66, v73, v72
    v_fmac_f32 v67, v74, v72
    v_lshlrev_b32 v73, 16, v194
    v_and_b32 v74, 0xffff0000, v194
    v_fmac_f32 v68, v73, v72
    v_fmac_f32 v69, v74, v72
    v_lshlrev_b32 v73, 16, v195
    v_and_b32 v74, 0xffff0000, v195
    v_fmac_f32 v70, v73, v72
    v_fmac_f32 v71, v74, v72
    s_waitcnt vmcnt(6)
    v_and_b32 v72, 0xffff0000, v236
    v_lshlrev_b32 v73, 16, v196
    v_and_b32 v74, 0xffff0000, v196
    v_fmac_f32 v64, v73, v72
    v_fmac_f32 v65, v74, v72
    v_lshlrev_b32 v73, 16, v197
    v_and_b32 v74, 0xffff0000, v197
    v_fmac_f32 v66, v73, v72
    v_fmac_f32 v67, v74, v72
    v_lshlrev_b32 v73, 16, v198
    v_and_b32 v74, 0xffff0000, v198
    v_fmac_f32 v68, v73, v72
    v_fmac_f32 v69, v74, v72
    v_lshlrev_b32 v73, 16, v199
    v_and_b32 v74, 0xffff0000, v199
    v_fmac_f32 v70, v73, v72
    v_fmac_f32 v71, v74, v72
    s_waitcnt vmcnt(5)
    v_lshlrev_b32 v72, 16, v237
    v_lshlrev_b32 v73, 16, v200
    v_and_b32 v74, 0xffff0000, v200
    v_fmac_f32 v64, v73, v72
    v_fmac_f32 v65, v74, v72
    v_lshlrev_b32 v73, 16, v201
    v_and_b32 v74, 0xffff0000, v201
    v_fmac_f32 v66, v73, v72
    v_fmac_f32 v67, v74, v72
    v_lshlrev_b32 v73, 16, v202
    v_and_b32 v74, 0xffff0000, v202
    v_fmac_f32 v68, v73, v72
    v_fmac_f32 v69, v74, v72
    v_lshlrev_b32 v73, 16, v203
    v_and_b32 v74, 0xffff0000, v203
    v_fmac_f32 v70, v73, v72
    v_fmac_f32 v71, v74, v72
    s_waitcnt vmcnt(4)
    v_and_b32 v72, 0xffff0000, v237
    v_lshlrev_b32 v73, 16, v204
    v_and_b32 v74, 0xffff0000, v204
    v_fmac_f32 v64, v73, v72
    v_fmac_f32 v65, v74, v72
    v_lshlrev_b32 v73, 16, v205
    v_and_b32 v74, 0xffff0000, v205
    v_fmac_f32 v66, v73, v72
    v_fmac_f32 v67, v74, v72
    v_lshlrev_b32 v73, 16, v206
    v_and_b32 v74, 0xffff0000, v206
    v_fmac_f32 v68, v73, v72
    v_fmac_f32 v69, v74, v72
    v_lshlrev_b32 v73, 16, v207
    v_and_b32 v74, 0xffff0000, v207
    v_fmac_f32 v70, v73, v72
    v_fmac_f32 v71, v74, v72
    s_barrier
    s_waitcnt vmcnt(3)
    v_lshlrev_b32 v72, 16, v238
    v_lshlrev_b32 v73, 16, v208
    v_and_b32 v74, 0xffff0000, v208
    v_fmac_f32 v64, v73, v72
    v_fmac_f32 v65, v74, v72
    v_lshlrev_b32 v73, 16, v209
    v_and_b32 v74, 0xffff0000, v209
    v_fmac_f32 v66, v73, v72
    v_fmac_f32 v67, v74, v72
    v_lshlrev_b32 v73, 16, v210
    v_and_b32 v74, 0xffff0000, v210
    v_fmac_f32 v68, v73, v72
    v_fmac_f32 v69, v74, v72
    v_lshlrev_b32 v73, 16, v211
    v_and_b32 v74, 0xffff0000, v211
    v_fmac_f32 v70, v73, v72
    v_fmac_f32 v71, v74, v72
    s_waitcnt vmcnt(2)
    v_and_b32 v72, 0xffff0000, v238
    v_lshlrev_b32 v73, 16, v212
    v_and_b32 v74, 0xffff0000, v212
    v_fmac_f32 v64, v73, v72
    v_fmac_f32 v65, v74, v72
    v_lshlrev_b32 v73, 16, v213
    v_and_b32 v74, 0xffff0000, v213
    v_fmac_f32 v66, v73, v72
    v_fmac_f32 v67, v74, v72
    v_lshlrev_b32 v73, 16, v214
    v_and_b32 v74, 0xffff0000, v214
    v_fmac_f32 v68, v73, v72
    v_fmac_f32 v69, v74, v72
    v_lshlrev_b32 v73, 16, v215
    v_and_b32 v74, 0xffff0000, v215
    v_fmac_f32 v70, v73, v72
    v_fmac_f32 v71, v74, v72
    s_waitcnt vmcnt(1)
    v_lshlrev_b32 v72, 16, v239
    v_lshlrev_b32 v73, 16, v216
    v_and_b32 v74, 0xffff0000, v216
    v_fmac_f32 v64, v73, v72
    v_fmac_f32 v65, v74, v72
    v_lshlrev_b32 v73, 16, v217
    v_and_b32 v74, 0xffff0000, v217
    v_fmac_f32 v66, v73, v72
    v_fmac_f32 v67, v74, v72
    v_lshlrev_b32 v73, 16, v218
    v_and_b32 v74, 0xffff0000, v218
    v_fmac_f32 v68, v73, v72
    v_fmac_f32 v69, v74, v72
    v_lshlrev_b32 v73, 16, v219
    v_and_b32 v74, 0xffff0000, v219
    v_fmac_f32 v70, v73, v72
    v_fmac_f32 v71, v74, v72
    s_waitcnt vmcnt(0)
    v_and_b32 v72, 0xffff0000, v239
    v_lshlrev_b32 v73, 16, v220
    v_and_b32 v74, 0xffff0000, v220
    v_fmac_f32 v64, v73, v72
    v_fmac_f32 v65, v74, v72
    v_lshlrev_b32 v73, 16, v221
    v_and_b32 v74, 0xffff0000, v221
    v_fmac_f32 v66, v73, v72
    v_fmac_f32 v67, v74, v72
    v_lshlrev_b32 v73, 16, v222
    v_and_b32 v74, 0xffff0000, v222
    v_fmac_f32 v68, v73, v72
    v_fmac_f32 v69, v74, v72
    v_lshlrev_b32 v73, 16, v223
    v_and_b32 v74, 0xffff0000, v223
    v_fmac_f32 v70, v73, v72
    v_fmac_f32 v71, v74, v72
    v_and_b32 v76, 31, v2
    v_lshrrev_b32 v77, 5, v2
    v_lshl_add_u32 v76, v76, 1, v77
    v_permlane32_swap_b32 v64, v68
    v_permlane32_swap_b32 v65, v69
    v_permlane32_swap_b32 v66, v70
    v_permlane32_swap_b32 v67, v71
    v_lshlrev_b32 v76, 4, v76
    v_add_f32 v64, v64, v68
    v_add_f32 v65, v65, v69
    v_add_f32 v66, v66, v70
    v_add_f32 v67, v67, v71
    buffer_store_dwordx4 v[64:67], v76, s[16:19], s54 offen sc0 sc1
    s_barrier
    s_lshl_b32 s66, s2, 2
    s_add_u32 s66, s66, s44
    s_lshl_b32 s66, s66, 11
    buffer_load_dwordx4 v[240:243], v9, s[20:23], s66 offen offset:0
    buffer_load_dwordx4 v[240:243], v9, s[20:23], s66 offen offset:1024
    s_mov_b32 s66, 0
    buffer_load_dwordx4 v[160:163], v7, s[32:35], s66 offen
    s_mov_b32 s66, 2048
    buffer_load_dwordx4 v[164:167], v7, s[32:35], s66 offen
    s_mov_b32 s66, 4096
    buffer_load_dwordx4 v[168:171], v7, s[32:35], s66 offen
    s_mov_b32 s66, 6144
    buffer_load_dwordx4 v[172:175], v7, s[32:35], s66 offen
    s_mov_b32 s66, 8192
    buffer_load_dwordx4 v[176:179], v7, s[32:35], s66 offen
    s_mov_b32 s66, 10240
    buffer_load_dwordx4 v[180:183], v7, s[32:35], s66 offen
    s_mov_b32 s66, 12288
    buffer_load_dwordx4 v[184:187], v7, s[32:35], s66 offen
    s_mov_b32 s66, 14336
    buffer_load_dwordx4 v[188:191], v7, s[32:35], s66 offen
H_b14:
    s_barrier
    s_setprio 3
    s_mov_b32 s70, 0x3fb8aa3b
    s_mov_b32 s71, 0x3fb8aa3b
    s_and_b32 s66, s44, 2
    s_lshl_b32 s67, s66, 2
    s_add_u32 s67, s67, 155648
    v_mov_b32 v10, s67
    s_lshl_b32 s66, s66, 12
    s_and_b32 s67, s44, 1
    s_lshl_b32 s67, s67, 10
    v_add_u32 v11, s66, v9
    v_add_u32 v12, s67, v11
    v_add_u32 v11, 65536, v11
    v_mov_b32 v204, 0x3f803f80
    v_mov_b32 v205, 0x3f803f80
    v_mov_b32 v206, 0x3f803f80
    v_mov_b32 v207, 0x3f803f80
H_fk:
    ds_read_b64 v[14:15], v10
    s_waitcnt lgkmcnt(0)
    v_min_u32 v14, v14, v15
    v_cmp_eq_u32 vcc, 0, v14
    s_cbranch_vccnz H_fk
    ds_read_b128 v[16:19], v12 offset:0
    ds_read_b128 v[20:23], v12 offset:2048
    ds_read_b128 v[24:27], v12 offset:4096
    ds_read_b128 v[28:31], v12 offset:6144
    s_waitcnt lgkmcnt(3)
    v_lshlrev_b32 v72, 16, v16
    v_and_b32 v73, 0xffff0000, v16
    v_pk_mul_f32 v[74:75], v[72:73], s[70:71]
    v_pk_add_f32 v[72:73], v[72:73], 1.0 op_sel_hi:[1,0]
    v_exp_f32 v74, v74 clamp
    v_exp_f32 v75, v75 clamp
    v_lshlrev_b32 v76, 16, v17
    v_and_b32 v77, 0xffff0000, v17
    v_pk_mul_f32 v[78:79], v[76:77], s[70:71]
    v_pk_add_f32 v[76:77], v[76:77], 1.0 op_sel_hi:[1,0]
    v_exp_f32 v78, v78 clamp
    v_exp_f32 v79, v79 clamp
    v_max_f32 v72, v72, v74
    v_max_f32 v73, v73, v75
    v_cvt_pk_bf16_f32 v32, v72, v73
    v_max_f32 v76, v76, v78
    v_max_f32 v77, v77, v79
    v_cvt_pk_bf16_f32 v33, v76, v77
    v_lshlrev_b32 v72, 16, v18
    v_and_b32 v73, 0xffff0000, v18
    v_pk_mul_f32 v[74:75], v[72:73], s[70:71]
    v_pk_add_f32 v[72:73], v[72:73], 1.0 op_sel_hi:[1,0]
    v_exp_f32 v74, v74 clamp
    v_exp_f32 v75, v75 clamp
    v_lshlrev_b32 v76, 16, v19
    v_and_b32 v77, 0xffff0000, v19
    v_pk_mul_f32 v[78:79], v[76:77], s[70:71]
    v_pk_add_f32 v[76:77], v[76:77], 1.0 op_sel_hi:[1,0]
    v_exp_f32 v78, v78 clamp
    v_exp_f32 v79, v79 clamp
    v_max_f32 v72, v72, v74
    v_max_f32 v73, v73, v75
    v_cvt_pk_bf16_f32 v34, v72, v73
    v_max_f32 v76, v76, v78
    v_max_f32 v77, v77, v79
    v_cvt_pk_bf16_f32 v35, v76, v77
    s_waitcnt lgkmcnt(2)
    v_lshlrev_b32 v72, 16, v20
    v_and_b32 v73, 0xffff0000, v20
    v_pk_mul_f32 v[74:75], v[72:73], s[70:71]
    v_pk_add_f32 v[72:73], v[72:73], 1.0 op_sel_hi:[1,0]
    v_exp_f32 v74, v74 clamp
    v_exp_f32 v75, v75 clamp
    v_lshlrev_b32 v76, 16, v21
    v_and_b32 v77, 0xffff0000, v21
    v_pk_mul_f32 v[78:79], v[76:77], s[70:71]
    v_pk_add_f32 v[76:77], v[76:77], 1.0 op_sel_hi:[1,0]
    v_exp_f32 v78, v78 clamp
    v_exp_f32 v79, v79 clamp
    v_max_f32 v72, v72, v74
    v_max_f32 v73, v73, v75
    v_cvt_pk_bf16_f32 v36, v72, v73
    v_max_f32 v76, v76, v78
    v_max_f32 v77, v77, v79
    v_cvt_pk_bf16_f32 v37, v76, v77
    v_lshlrev_b32 v72, 16, v22
    v_and_b32 v73, 0xffff0000, v22
    v_pk_mul_f32 v[74:75], v[72:73], s[70:71]
    v_pk_add_f32 v[72:73], v[72:73], 1.0 op_sel_hi:[1,0]
    v_exp_f32 v74, v74 clamp
    v_exp_f32 v75, v75 clamp
    v_lshlrev_b32 v76, 16, v23
    v_and_b32 v77, 0xffff0000, v23
    v_pk_mul_f32 v[78:79], v[76:77], s[70:71]
    v_pk_add_f32 v[76:77], v[76:77], 1.0 op_sel_hi:[1,0]
    v_exp_f32 v78, v78 clamp
    v_exp_f32 v79, v79 clamp
    v_max_f32 v72, v72, v74
    v_max_f32 v73, v73, v75
    v_cvt_pk_bf16_f32 v38, v72, v73
    v_max_f32 v76, v76, v78
    v_max_f32 v77, v77, v79
    v_cvt_pk_bf16_f32 v39, v76, v77
    s_waitcnt lgkmcnt(1)
    v_lshlrev_b32 v72, 16, v24
    v_and_b32 v73, 0xffff0000, v24
    v_pk_mul_f32 v[74:75], v[72:73], s[70:71]
    v_pk_add_f32 v[72:73], v[72:73], 1.0 op_sel_hi:[1,0]
    v_exp_f32 v74, v74 clamp
    v_exp_f32 v75, v75 clamp
    v_lshlrev_b32 v76, 16, v25
    v_and_b32 v77, 0xffff0000, v25
    v_pk_mul_f32 v[78:79], v[76:77], s[70:71]
    v_pk_add_f32 v[76:77], v[76:77], 1.0 op_sel_hi:[1,0]
    v_exp_f32 v78, v78 clamp
    v_exp_f32 v79, v79 clamp
    v_max_f32 v72, v72, v74
    v_max_f32 v73, v73, v75
    v_cvt_pk_bf16_f32 v40, v72, v73
    v_max_f32 v76, v76, v78
    v_max_f32 v77, v77, v79
    v_cvt_pk_bf16_f32 v41, v76, v77
    v_lshlrev_b32 v72, 16, v26
    v_and_b32 v73, 0xffff0000, v26
    v_pk_mul_f32 v[74:75], v[72:73], s[70:71]
    v_pk_add_f32 v[72:73], v[72:73], 1.0 op_sel_hi:[1,0]
    v_exp_f32 v74, v74 clamp
    v_exp_f32 v75, v75 clamp
    v_lshlrev_b32 v76, 16, v27
    v_and_b32 v77, 0xffff0000, v27
    v_pk_mul_f32 v[78:79], v[76:77], s[70:71]
    v_pk_add_f32 v[76:77], v[76:77], 1.0 op_sel_hi:[1,0]
    v_exp_f32 v78, v78 clamp
    v_exp_f32 v79, v79 clamp
    v_max_f32 v72, v72, v74
    v_max_f32 v73, v73, v75
    v_cvt_pk_bf16_f32 v42, v72, v73
    v_max_f32 v76, v76, v78
    v_max_f32 v77, v77, v79
    v_cvt_pk_bf16_f32 v43, v76, v77
    s_waitcnt lgkmcnt(0)
    v_lshlrev_b32 v72, 16, v28
    v_and_b32 v73, 0xffff0000, v28
    v_pk_mul_f32 v[74:75], v[72:73], s[70:71]
    v_pk_add_f32 v[72:73], v[72:73], 1.0 op_sel_hi:[1,0]
    v_exp_f32 v74, v74 clamp
    v_exp_f32 v75, v75 clamp
    v_lshlrev_b32 v76, 16, v29
    v_and_b32 v77, 0xffff0000, v29
    v_pk_mul_f32 v[78:79], v[76:77], s[70:71]
    v_pk_add_f32 v[76:77], v[76:77], 1.0 op_sel_hi:[1,0]
    v_exp_f32 v78, v78 clamp
    v_exp_f32 v79, v79 clamp
    v_max_f32 v72, v72, v74
    v_max_f32 v73, v73, v75
    v_cvt_pk_bf16_f32 v44, v72, v73
    v_max_f32 v76, v76, v78
    v_max_f32 v77, v77, v79
    v_cvt_pk_bf16_f32 v45, v76, v77
    v_lshlrev_b32 v72, 16, v30
    v_and_b32 v73, 0xffff0000, v30
    v_pk_mul_f32 v[74:75], v[72:73], s[70:71]
    v_pk_add_f32 v[72:73], v[72:73], 1.0 op_sel_hi:[1,0]
    v_exp_f32 v74, v74 clamp
    v_exp_f32 v75, v75 clamp
    v_lshlrev_b32 v76, 16, v31
    v_and_b32 v77, 0xffff0000, v31
    v_pk_mul_f32 v[78:79], v[76:77], s[70:71]
    v_pk_add_f32 v[76:77], v[76:77], 1.0 op_sel_hi:[1,0]
    v_exp_f32 v78, v78 clamp
    v_exp_f32 v79, v79 clamp
    v_max_f32 v72, v72, v74
    v_max_f32 v73, v73, v75
    v_cvt_pk_bf16_f32 v46, v72, v73
    v_max_f32 v76, v76, v78
    v_max_f32 v77, v77, v79
    v_cvt_pk_bf16_f32 v47, v76, v77
H_fv:
    ds_read_b64 v[14:15], v10 offset:16
    s_waitcnt lgkmcnt(0)
    v_min_u32 v13, v14, v15
    v_cmp_eq_u32 vcc, 0, v13
    s_cbranch_vccnz H_fv
    ds_read_b128 v[208:211], v11 offset:0
    ds_read_b128 v[212:215], v11 offset:1024
    ds_read_b128 v[216:219], v11 offset:2048
    ds_read_b128 v[220:223], v11 offset:3072
    ds_read_b128 v[224:227], v11 offset:4096
    ds_read_b128 v[228:231], v11 offset:5120
    ds_read_b128 v[232:235], v11 offset:6144
    ds_read_b128 v[236:239], v11 offset:7168
    v_max_u32 v13, v14, v15
    v_cmp_eq_u32 vcc, 2, v13
    s_cbranch_vccnz H_eps
    v_mfma_f32_16x16x32_bf16 v[200:203], v[32:35], v[204:207], 0
    s_waitcnt lgkmcnt(7)
    v_mfma_f32_16x16x32_bf16 v[192:195], v[32:35], v[208:211], 0
    s_waitcnt lgkmcnt(6)
    v_mfma_f32_16x16x32_bf16 v[196:199], v[32:35], v[212:215], 0
    v_mfma_f32_16x16x32_bf16 v[200:203], v[36:39], v[204:207], v[200:203]
    s_waitcnt lgkmcnt(5)
    v_mfma_f32_16x16x32_bf16 v[192:195], v[36:39], v[216:219], v[192:195]
    s_waitcnt lgkmcnt(4)
    v_mfma_f32_16x16x32_bf16 v[196:199], v[36:39], v[220:223], v[196:199]
    v_mfma_f32_16x16x32_bf16 v[200:203], v[40:43], v[204:207], v[200:203]
    s_waitcnt lgkmcnt(3)
    v_mfma_f32_16x16x32_bf16 v[192:195], v[40:43], v[224:227], v[192:195]
    s_waitcnt lgkmcnt(2)
    v_mfma_f32_16x16x32_bf16 v[196:199], v[40:43], v[228:231], v[196:199]
    v_mfma_f32_16x16x32_bf16 v[200:203], v[44:47], v[204:207], v[200:203]
    s_waitcnt lgkmcnt(1)
    v_mfma_f32_16x16x32_bf16 v[192:195], v[44:47], v[232:235], v[192:195]
    s_waitcnt lgkmcnt(0)
    v_mfma_f32_16x16x32_bf16 v[196:199], v[44:47], v[236:239], v[196:199]
H_ne:
    v_lshrrev_b32 v13, 4, v2
    v_lshlrev_b32 v13, 4, v13
    v_and_b32 v14, 15, v2
    v_cmp_eq_u32 s[68:69], 0, v14
    s_lshl_b32 s66, s44, 11
    s_add_u32 s66, s66, 139264
    v_add_u32 v3, s66, v9
    s_waitcnt vmcnt(10)
    s_nop 1
    v_cvt_pk_bf16_f32 v72, v192, v193
    v_cvt_pk_bf16_f32 v73, v194, v195
    v_cvt_pk_bf16_f32 v74, v196, v197
    v_cvt_pk_bf16_f32 v75, v198, v199
    buffer_store_dwordx4 v[72:75], v9, s[16:19], s56 offen sc0 sc1
    s_mov_b64 exec, s[68:69]
    buffer_store_dwordx4 v[200:203], v13, s[16:19], s53 offen sc0 sc1
    s_mov_b64 exec, -1
    buffer_load_dwordx4 v[144:147], v91, s[8:11], 0 offen offset:0
    buffer_load_dwordx4 v[148:151], v91, s[8:11], 0 offen offset:64
    s_setprio 0
    s_barrier
    ds_read_b128 v[16:19], v3
    ds_read_b128 v[20:23], v3 offset:1024
    s_add_u32 s67, s52, 0
    s_and_b32 s67, s67, 0x1fffff
    s_add_u32 m0, s72, 0
    s_add_u32 s66, s67, 0
    buffer_load_dwordx4 v90, s[20:23], s66 offen lds
    s_add_u32 m0, s72, 4096
    s_add_u32 s66, s67, 65536
    buffer_load_dwordx4 v90, s[20:23], s66 offen lds
    s_add_u32 s67, s52, 0
    s_and_b32 s67, s67, 0x1fffff
    s_add_u32 m0, s72, 65536
    s_add_u32 s66, s67, 131072
    buffer_load_dwordx4 v90, s[20:23], s66 offen lds
    s_add_u32 m0, s72, 69632
    s_add_u32 s66, s67, 196608
    buffer_load_dwordx4 v90, s[20:23], s66 offen lds
    s_add_u32 s67, s52, 262144
    s_and_b32 s67, s67, 0x1fffff
    s_add_u32 m0, s72, 8192
    s_add_u32 s66, s67, 0
    buffer_load_dwordx4 v90, s[20:23], s66 offen lds
    s_add_u32 m0, s72, 12288
    s_add_u32 s66, s67, 65536
    buffer_load_dwordx4 v90, s[20:23], s66 offen lds
    s_add_u32 s67, s52, 262144
    s_and_b32 s67, s67, 0x1fffff
    s_add_u32 m0, s72, 73728
    s_add_u32 s66, s67, 131072
    buffer_load_dwordx4 v90, s[20:23], s66 offen lds
    s_add_u32 m0, s72, 77824
    s_add_u32 s66, s67, 196608
    buffer_load_dwordx4 v90, s[20:23], s66 offen lds
    s_add_u32 s67, s52, 524288
    s_and_b32 s67, s67, 0x1fffff
    s_add_u32 m0, s72, 16384
    s_add_u32 s66, s67, 0
    buffer_load_dwordx4 v90, s[20:23], s66 offen lds
    s_add_u32 m0, s72, 20480
    s_add_u32 s66, s67, 65536
    buffer_load_dwordx4 v90, s[20:23], s66 offen lds
    s_add_u32 s67, s52, 524288
    s_and_b32 s67, s67, 0x1fffff
    s_add_u32 m0, s72, 81920
    s_add_u32 s66, s67, 131072
    buffer_load_dwordx4 v90, s[20:23], s66 offen lds
    s_add_u32 m0, s72, 86016
    s_add_u32 s66, s67, 196608
    buffer_load_dwordx4 v90, s[20:23], s66 offen lds
    s_waitcnt lgkmcnt(0)
    v_lshlrev_b32 v32, 16, v16
    v_and_b32 v33, 0xffff0000, v16
    v_pk_mul_f32 v[34:35], v[32:33], s[70:71]
    v_pk_add_f32 v[32:33], v[32:33], 1.0 op_sel_hi:[1,0]
    v_exp_f32 v34, v34 clamp
    v_exp_f32 v35, v35 clamp
    v_lshlrev_b32 v36, 16, v17
    v_and_b32 v37, 0xffff0000, v17
    v_pk_mul_f32 v[38:39], v[36:37], s[70:71]
    v_pk_add_f32 v[36:37], v[36:37], 1.0 op_sel_hi:[1,0]
    v_exp_f32 v38, v38 clamp
    v_exp_f32 v39, v39 clamp
    v_max_f32 v32, v32, v34
    v_max_f32 v33, v33, v35
    v_min_f32 v40, v32, v33
    v_cvt_pk_bf16_f32 v24, v32, v33
    v_max_f32 v36, v36, v38
    v_max_f32 v37, v37, v39
    v_min3_f32 v40, v36, v37, v40
    v_cvt_pk_bf16_f32 v25, v36, v37
    v_lshlrev_b32 v32, 16, v18
    v_and_b32 v33, 0xffff0000, v18
    v_pk_mul_f32 v[34:35], v[32:33], s[70:71]
    v_pk_add_f32 v[32:33], v[32:33], 1.0 op_sel_hi:[1,0]
    v_exp_f32 v34, v34 clamp
    v_exp_f32 v35, v35 clamp
    v_lshlrev_b32 v36, 16, v19
    v_and_b32 v37, 0xffff0000, v19
    v_pk_mul_f32 v[38:39], v[36:37], s[70:71]
    v_pk_add_f32 v[36:37], v[36:37], 1.0 op_sel_hi:[1,0]
    v_exp_f32 v38, v38 clamp
    v_exp_f32 v39, v39 clamp
    v_max_f32 v32, v32, v34
    v_max_f32 v33, v33, v35
    v_min3_f32 v40, v32, v33, v40
    v_cvt_pk_bf16_f32 v26, v32, v33
    v_max_f32 v36, v36, v38
    v_max_f32 v37, v37, v39
    v_min3_f32 v40, v36, v37, v40
    v_cvt_pk_bf16_f32 v27, v36, v37
    v_lshlrev_b32 v32, 16, v20
    v_and_b32 v33, 0xffff0000, v20
    v_pk_mul_f32 v[34:35], v[32:33], s[70:71]
    v_pk_add_f32 v[32:33], v[32:33], 1.0 op_sel_hi:[1,0]
    v_exp_f32 v34, v34 clamp
    v_exp_f32 v35, v35 clamp
    v_lshlrev_b32 v36, 16, v21
    v_and_b32 v37, 0xffff0000, v21
    v_pk_mul_f32 v[38:39], v[36:37], s[70:71]
    v_pk_add_f32 v[36:37], v[36:37], 1.0 op_sel_hi:[1,0]
    v_exp_f32 v38, v38 clamp
    v_exp_f32 v39, v39 clamp
    v_max_f32 v32, v32, v34
    v_max_f32 v33, v33, v35
    v_min3_f32 v40, v32, v33, v40
    v_cvt_pk_bf16_f32 v28, v32, v33
    v_max_f32 v36, v36, v38
    v_max_f32 v37, v37, v39
    v_min3_f32 v40, v36, v37, v40
    v_cvt_pk_bf16_f32 v29, v36, v37
    v_lshlrev_b32 v32, 16, v22
    v_and_b32 v33, 0xffff0000, v22
    v_pk_mul_f32 v[34:35], v[32:33], s[70:71]
    v_pk_add_f32 v[32:33], v[32:33], 1.0 op_sel_hi:[1,0]
    v_exp_f32 v34, v34 clamp
    v_exp_f32 v35, v35 clamp
    v_lshlrev_b32 v36, 16, v23
    v_and_b32 v37, 0xffff0000, v23
    v_pk_mul_f32 v[38:39], v[36:37], s[70:71]
    v_pk_add_f32 v[36:37], v[36:37], 1.0 op_sel_hi:[1,0]
    v_exp_f32 v38, v38 clamp
    v_exp_f32 v39, v39 clamp
    v_max_f32 v32, v32, v34
    v_max_f32 v33, v33, v35
    v_min3_f32 v40, v32, v33, v40
    v_cvt_pk_bf16_f32 v30, v32, v33
    v_max_f32 v36, v36, v38
    v_max_f32 v37, v37, v39
    v_min3_f32 v40, v36, v37, v40
    v_cvt_pk_bf16_f32 v31, v36, v37
    v_cmp_gt_f32 vcc, 0x3a800000, v40
    s_cbranch_vccz P_qh
    v_lshlrev_b32 v32, 16, v24
    v_and_b32 v33, 0xffff0000, v24
    v_add_f32 v32, s47, v32
    v_add_f32 v33, s47, v33
    v_cvt_pk_bf16_f32 v24, v32, v33
    v_lshlrev_b32 v32, 16, v25
    v_and_b32 v33, 0xffff0000, v25
    v_add_f32 v32, s47, v32
    v_add_f32 v33, s47, v33
    v_cvt_pk_bf16_f32 v25, v32, v33
    v_lshlrev_b32 v32, 16, v26
    v_and_b32 v33, 0xffff0000, v26
    v_add_f32 v32, s47, v32
    v_add_f32 v33, s47, v33
    v_cvt_pk_bf16_f32 v26, v32, v33
    v_lshlrev_b32 v32, 16, v27
    v_and_b32 v33, 0xffff0000, v27
    v_add_f32 v32, s47, v32
    v_add_f32 v33, s47, v33
    v_cvt_pk_bf16_f32 v27, v32, v33
    v_lshlrev_b32 v32, 16, v28
    v_and_b32 v33, 0xffff0000, v28
    v_add_f32 v32, s47, v32
    v_add_f32 v33, s47, v33
    v_cvt_pk_bf16_f32 v28, v32, v33
    v_lshlrev_b32 v32, 16, v29
    v_and_b32 v33, 0xffff0000, v29
    v_add_f32 v32, s47, v32
    v_add_f32 v33, s47, v33
    v_cvt_pk_bf16_f32 v29, v32, v33
    v_lshlrev_b32 v32, 16, v30
    v_and_b32 v33, 0xffff0000, v30
    v_add_f32 v32, s47, v32
    v_add_f32 v33, s47, v33
    v_cvt_pk_bf16_f32 v30, v32, v33
    v_lshlrev_b32 v32, 16, v31
    v_and_b32 v33, 0xffff0000, v31
    v_add_f32 v32, s47, v32
    v_add_f32 v33, s47, v33
    v_cvt_pk_bf16_f32 v31, v32, v33
P_qh:
    s_lshl_b32 s66, s49, 11
    s_add_u32 s66, s66, 159744
    v_add_u32 v10, s66, v9
    s_lshl_b32 s66, s49, 6
    s_add_u32 s66, s66, 159488
    v_lshrrev_b32 v11, 4, v2
    v_lshlrev_b32 v11, 4, v11
    v_add_u32 v11, s66, v11
    buffer_load_dwordx4 v[80:83], v1, s[16:19], s62 offen sc1
    buffer_load_dwordx4 v[84:87], v1, s[16:19], s63 offen sc1
    s_lshl_b32 s66, s6, 6
    s_add_u32 s66, s66, 5242880
    v_lshlrev_b32 v15, 10, v2
    v_add_u32 v15, s66, v15
    s_cmp_lg_u32 s44, 0
    s_cbranch_scc1 H_pd
    s_mov_b32 s59, 0
H_pl:
    buffer_load_dword v14, v15, s[16:19], 0 offen sc1
    s_waitcnt vmcnt(0)
    v_cmp_eq_u32 vcc, -1, v14
    s_cbranch_vccz H_pd
    s_add_u32 s59, s59, 1
    s_cmp_ge_u32 s59, 200000
    s_cbranch_scc1 H_pd
    s_sleep 2
    s_branch H_pl
H_pd:
POST:
    s_waitcnt lgkmcnt(0)
    s_barrier
    s_mov_b32 s66, 6094848
    buffer_load_dword v152, v93, s[16:19], s66 offen sc1
    ds_read_b128 v[40:43], v11
    ds_read_b128 v[32:35], v10
    ds_read_b128 v[36:39], v10 offset:1024
    v_mov_b32 v3, 155684
    ds_read_b32 v4, v3
    s_waitcnt lgkmcnt(3)
    v_mfma_f32_16x16x32_bf16 v[60:63], v[40:43], v[24:27], 0
    v_mfma_f32_16x16x32_bf16 v[64:67], v[40:43], v[28:31], 0
    s_waitcnt lgkmcnt(1)
    v_mfma_f32_16x16x32_bf16 v[44:47], v[32:35], v[24:27], 0
    v_mfma_f32_16x16x32_bf16 v[48:51], v[36:39], v[24:27], 0
    v_mfma_f32_16x16x32_bf16 v[52:55], v[32:35], v[28:31], 0
    v_mfma_f32_16x16x32_bf16 v[56:59], v[36:39], v[28:31], 0
    s_nop 3
    v_cvt_pk_bf16_f32 v60, 0, v60
    v_cvt_pk_bf16_f32 v64, 0, v64
    v_add_f32 v60, s47, v60
    v_add_f32 v64, s47, v64
    v_cvt_pk_bf16_f32 v60, 0, v60
    v_cvt_pk_bf16_f32 v64, 0, v64
    v_rcp_f32 v60, v60
    v_rcp_f32 v64, v64
    v_cvt_pk_bf16_f32 v44, 0, v44
    v_cvt_pk_bf16_f32 v45, 0, v45
    v_cvt_pk_bf16_f32 v46, 0, v46
    v_cvt_pk_bf16_f32 v47, 0, v47
    v_cvt_pk_bf16_f32 v48, 0, v48
    v_cvt_pk_bf16_f32 v49, 0, v49
    v_cvt_pk_bf16_f32 v50, 0, v50
    v_cvt_pk_bf16_f32 v51, 0, v51
    v_pk_mul_f32 v[44:45], v[44:45], v[60:61] op_sel_hi:[1,0]
    v_pk_mul_f32 v[46:47], v[46:47], v[60:61] op_sel_hi:[1,0]
    v_pk_mul_f32 v[48:49], v[48:49], v[60:61] op_sel_hi:[1,0]
    v_pk_mul_f32 v[50:51], v[50:51], v[60:61] op_sel_hi:[1,0]
    v_cvt_pk_bf16_f32 v32, v44, v45
    v_cvt_pk_bf16_f32 v33, v46, v47
    v_cvt_pk_bf16_f32 v34, v48, v49
    v_cvt_pk_bf16_f32 v35, v50, v51
    buffer_store_dwordx4 v[32:35], v9, s[16:19], s60 offen sc0 sc1
    v_cvt_pk_bf16_f32 v52, 0, v52
    v_cvt_pk_bf16_f32 v53, 0, v53
    v_cvt_pk_bf16_f32 v54, 0, v54
    v_cvt_pk_bf16_f32 v55, 0, v55
    v_cvt_pk_bf16_f32 v56, 0, v56
    v_cvt_pk_bf16_f32 v57, 0, v57
    v_cvt_pk_bf16_f32 v58, 0, v58
    v_cvt_pk_bf16_f32 v59, 0, v59
    v_pk_mul_f32 v[52:53], v[52:53], v[64:65] op_sel_hi:[1,0]
    v_pk_mul_f32 v[54:55], v[54:55], v[64:65] op_sel_hi:[1,0]
    v_pk_mul_f32 v[56:57], v[56:57], v[64:65] op_sel_hi:[1,0]
    v_pk_mul_f32 v[58:59], v[58:59], v[64:65] op_sel_hi:[1,0]
    v_cvt_pk_bf16_f32 v36, v52, v53
    v_cvt_pk_bf16_f32 v37, v54, v55
    v_cvt_pk_bf16_f32 v38, v56, v57
    v_cvt_pk_bf16_f32 v39, v58, v59
    buffer_store_dwordx4 v[36:39], v9, s[16:19], s61 offen sc0 sc1
    s_waitcnt lgkmcnt(0)
    v_readfirstlane_b32 s74, v4
    s_waitcnt vmcnt(5)
    s_barrier
    s_cmp_eq_u32 s45, 0
    s_cbranch_scc0 Q_hg
    s_add_u32 s67, s52, 786432
    s_and_b32 s67, s67, 0x1fffff
    s_add_u32 m0, s72, 24576
    s_add_u32 s66, s67, 0
    buffer_load_dwordx4 v90, s[20:23], s66 offen lds
    s_add_u32 m0, s72, 28672
    s_add_u32 s66, s67, 65536
    buffer_load_dwordx4 v90, s[20:23], s66 offen lds
    s_add_u32 s67, s52, 786432
    s_and_b32 s67, s67, 0x1fffff
    s_add_u32 m0, s72, 90112
    s_add_u32 s66, s67, 131072
    buffer_load_dwordx4 v90, s[20:23], s66 offen lds
    s_add_u32 m0, s72, 94208
    s_add_u32 s66, s67, 196608
    buffer_load_dwordx4 v90, s[20:23], s66 offen lds
    s_add_u32 s67, s52, 1048576
    s_and_b32 s67, s67, 0x1fffff
    s_add_u32 m0, s72, 32768
    s_add_u32 s66, s67, 0
    buffer_load_dwordx4 v90, s[20:23], s66 offen lds
    s_add_u32 m0, s72, 36864
    s_add_u32 s66, s67, 65536
    buffer_load_dwordx4 v90, s[20:23], s66 offen lds
    s_add_u32 s67, s52, 1048576
    s_and_b32 s67, s67, 0x1fffff
    s_add_u32 m0, s72, 98304
    s_add_u32 s66, s67, 131072
    buffer_load_dwordx4 v90, s[20:23], s66 offen lds
    s_add_u32 m0, s72, 102400
    s_add_u32 s66, s67, 196608
    buffer_load_dwordx4 v90, s[20:23], s66 offen lds
    s_add_u32 s67, s52, 1310720
    s_and_b32 s67, s67, 0x1fffff
    s_add_u32 m0, s72, 40960
    s_add_u32 s66, s67, 0
    buffer_load_dwordx4 v90, s[20:23], s66 offen lds
    s_add_u32 m0, s72, 45056
    s_add_u32 s66, s67, 65536
    buffer_load_dwordx4 v90, s[20:23], s66 offen lds
    s_add_u32 s67, s52, 1310720
    s_and_b32 s67, s67, 0x1fffff
    s_add_u32 m0, s72, 106496
    s_add_u32 s66, s67, 131072
    buffer_load_dwordx4 v90, s[20:23], s66 offen lds
    s_add_u32 m0, s72, 110592
    s_add_u32 s66, s67, 196608
    buffer_load_dwordx4 v90, s[20:23], s66 offen lds
    s_add_u32 s67, s52, 1572864
    s_and_b32 s67, s67, 0x1fffff
    s_add_u32 m0, s72, 49152
    s_add_u32 s66, s67, 0
    buffer_load_dwordx4 v90, s[20:23], s66 offen lds
    s_add_u32 m0, s72, 53248
    s_add_u32 s66, s67, 65536
    buffer_load_dwordx4 v90, s[20:23], s66 offen lds
    s_add_u32 s67, s52, 1572864
    s_and_b32 s67, s67, 0x1fffff
    s_add_u32 m0, s72, 114688
    s_add_u32 s66, s67, 131072
    buffer_load_dwordx4 v90, s[20:23], s66 offen lds
    s_add_u32 m0, s72, 118784
    s_add_u32 s66, s67, 196608
    buffer_load_dwordx4 v90, s[20:23], s66 offen lds
    s_add_u32 s67, s52, 1835008
    s_and_b32 s67, s67, 0x1fffff
    s_add_u32 m0, s72, 57344
    s_add_u32 s66, s67, 0
    buffer_load_dwordx4 v90, s[20:23], s66 offen lds
    s_add_u32 m0, s72, 61440
    s_add_u32 s66, s67, 65536
    buffer_load_dwordx4 v90, s[20:23], s66 offen lds
    s_add_u32 s67, s52, 1835008
    s_and_b32 s67, s67, 0x1fffff
    s_add_u32 m0, s72, 122880
    s_add_u32 s66, s67, 131072
    buffer_load_dwordx4 v90, s[20:23], s66 offen lds
    s_add_u32 m0, s72, 126976
    s_add_u32 s66, s67, 196608
    buffer_load_dwordx4 v90, s[20:23], s66 offen lds
    s_branch Q_hd
Q_hg:
    s_waitcnt vmcnt(3)
    s_mov_b32 s59, 0
Q_hchk:
    v_max3_u32 v5, v80, v81, v82
    v_max3_u32 v5, v5, v83, v84
    v_max3_u32 v5, v5, v85, v86
    v_max_u32 v5, v5, v87
    v_cmp_eq_u32 vcc, -1, v5
    s_cbranch_vccz Q_hok
    s_add_u32 s59, s59, 1
    s_cmp_ge_u32 s59, 200000
    s_cbranch_scc1 Q_hok
    s_sleep 4
    buffer_load_dwordx4 v[80:83], v1, s[16:19], s62 offen sc1
    buffer_load_dwordx4 v[84:87], v1, s[16:19], s63 offen sc1
    s_waitcnt vmcnt(0)
    s_branch Q_hchk
Q_hok:
    v_permlane16_swap_b32 v80, v82
    v_permlane16_swap_b32 v81, v83
    v_permlane16_swap_b32 v84, v86
    v_permlane16_swap_b32 v85, v87
    v_add_f32 v80, v80, v82
    v_add_f32 v81, v81, v83
    v_add_f32 v84, v84, v86
    v_add_f32 v85, v85, v87
    v_and_b32 v5, 3, v2
    v_lshlrev_b32 v5, 3, v5
    v_permlane32_swap_b32 v80, v81
    v_permlane32_swap_b32 v84, v85
    v_bfe_u32 v6, v2, 4, 1
    v_lshl_add_u32 v5, v6, 2, v5
    v_add_f32 v80, v80, v81
    v_add_f32 v84, v84, v85
    v_lshrrev_b32 v6, 5, v2
    v_lshl_add_u32 v5, v6, 1, v5
    v_add_f32_dpp v80, v80, v80 row_ror:4 row_mask:0xf bank_mask:0xf
    v_add_f32_dpp v84, v84, v84 row_ror:4 row_mask:0xf bank_mask:0xf
    s_nop 0
    v_add_f32_dpp v80, v80, v80 row_ror:8 row_mask:0xf bank_mask:0xf
    v_add_f32_dpp v84, v84, v84 row_ror:8 row_mask:0xf bank_mask:0xf
    s_nop 0
    s_lshl_b32 s66, s44, 5
    s_add_u32 s66, s66, 155712
    v_cvt_pk_bf16_f32 v80, 0, v80
    v_cvt_pk_bf16_f32 v84, 0, v84
    v_mul_f32 v81, s46, v80
    v_exp_f32 v81, -v81
    v_add_u32 v5, s66, v5
    v_add_f32 v81, 1.0, v81
    v_rcp_f32 v81, v81
    v_lshlrev_b32 v6, 4, v6
    v_mul_f32 v81, v81, v80
    v_cvt_pk_bf16_f32 v81, 0, v81
    v_add_u32 v6, s66, v6
    v_mul_f32 v81, v81, v84
    v_cvt_pk_bf16_f32 v81, v81, v81
    ds_write_b16 v5, v81
    ds_read_b128 v[84:87], v6
    v_mov_b32 v64, 0
    v_mov_b32 v65, 0
    v_mov_b32 v66, 0
    v_mov_b32 v67, 0
    v_mov_b32 v68, 0
    v_mov_b32 v69, 0
    v_mov_b32 v70, 0
    v_mov_b32 v71, 0
    s_waitcnt lgkmcnt(0)
    v_and_b32 v72, 0xffff, v84
    v_lshlrev_b32 v73, 16, v84
    v_dot2_f32_bf16 v64, v160, v72, v64
    v_dot2_f32_bf16 v65, v160, v73, v65
    v_dot2_f32_bf16 v66, v161, v72, v66
    v_dot2_f32_bf16 v67, v161, v73, v67
    v_dot2_f32_bf16 v68, v162, v72, v68
    v_dot2_f32_bf16 v69, v162, v73, v69
    v_dot2_f32_bf16 v70, v163, v72, v70
    v_dot2_f32_bf16 v71, v163, v73, v71
    v_lshrrev_b32 v72, 16, v84
    v_and_b32 v73, 0xffff0000, v84
    v_dot2_f32_bf16 v64, v164, v72, v64
    v_dot2_f32_bf16 v65, v164, v73, v65
    v_dot2_f32_bf16 v66, v165, v72, v66
    v_dot2_f32_bf16 v67, v165, v73, v67
    v_dot2_f32_bf16 v68, v166, v72, v68
    v_dot2_f32_bf16 v69, v166, v73, v69
    v_dot2_f32_bf16 v70, v167, v72, v70
    v_dot2_f32_bf16 v71, v167, v73, v71
    v_and_b32 v72, 0xffff, v85
    v_lshlrev_b32 v73, 16, v85
    v_dot2_f32_bf16 v64, v168, v72, v64
    v_dot2_f32_bf16 v65, v168, v73, v65
    v_dot2_f32_bf16 v66, v169, v72, v66
    v_dot2_f32_bf16 v67, v169, v73, v67
    v_dot2_f32_bf16 v68, v170, v72, v68
    v_dot2_f32_bf16 v69, v170, v73, v69
    v_dot2_f32_bf16 v70, v171, v72, v70
    v_dot2_f32_bf16 v71, v171, v73, v71
    v_lshrrev_b32 v72, 16, v85
    v_and_b32 v73, 0xffff0000, v85
    v_dot2_f32_bf16 v64, v172, v72, v64
    v_dot2_f32_bf16 v65, v172, v73, v65
    v_dot2_f32_bf16 v66, v173, v72, v66
    v_dot2_f32_bf16 v67, v173, v73, v67
    v_dot2_f32_bf16 v68, v174, v72, v68
    v_dot2_f32_bf16 v69, v174, v73, v69
    v_dot2_f32_bf16 v70, v175, v72, v70
    v_dot2_f32_bf16 v71, v175, v73, v71
    v_and_b32 v72, 0xffff, v86
    v_lshlrev_b32 v73, 16, v86
    v_dot2_f32_bf16 v64, v176, v72, v64
    v_dot2_f32_bf16 v65, v176, v73, v65
    v_dot2_f32_bf16 v66, v177, v72, v66
    v_dot2_f32_bf16 v67, v177, v73, v67
    v_dot2_f32_bf16 v68, v178, v72, v68
    v_dot2_f32_bf16 v69, v178, v73, v69
    v_dot2_f32_bf16 v70, v179, v72, v70
    v_dot2_f32_bf16 v71, v179, v73, v71
    v_lshrrev_b32 v72, 16, v86
    v_and_b32 v73, 0xffff0000, v86
    v_dot2_f32_bf16 v64, v180, v72, v64
    v_dot2_f32_bf16 v65, v180, v73, v65
    v_dot2_f32_bf16 v66, v181, v72, v66
    v_dot2_f32_bf16 v67, v181, v73, v67
    v_dot2_f32_bf16 v68, v182, v72, v68
    v_dot2_f32_bf16 v69, v182, v73, v69
    v_dot2_f32_bf16 v70, v183, v72, v70
    v_dot2_f32_bf16 v71, v183, v73, v71
    v_and_b32 v72, 0xffff, v87
    v_lshlrev_b32 v73, 16, v87
    v_dot2_f32_bf16 v64, v184, v72, v64
    v_dot2_f32_bf16 v65, v184, v73, v65
    v_dot2_f32_bf16 v66, v185, v72, v66
    v_dot2_f32_bf16 v67, v185, v73, v67
    v_dot2_f32_bf16 v68, v186, v72, v68
    v_dot2_f32_bf16 v69, v186, v73, v69
    v_dot2_f32_bf16 v70, v187, v72, v70
    v_dot2_f32_bf16 v71, v187, v73, v71
    v_lshrrev_b32 v72, 16, v87
    v_and_b32 v73, 0xffff0000, v87
    v_dot2_f32_bf16 v64, v188, v72, v64
    v_dot2_f32_bf16 v65, v188, v73, v65
    v_dot2_f32_bf16 v66, v189, v72, v66
    v_dot2_f32_bf16 v67, v189, v73, v67
    v_dot2_f32_bf16 v68, v190, v72, v68
    v_dot2_f32_bf16 v69, v190, v73, v69
    v_dot2_f32_bf16 v70, v191, v72, v70
    v_dot2_f32_bf16 v71, v191, v73, v71
    v_and_b32 v76, 31, v2
    v_lshrrev_b32 v77, 5, v2
    v_lshl_add_u32 v76, v76, 1, v77
    v_permlane32_swap_b32 v64, v68
    v_permlane32_swap_b32 v65, v69
    v_permlane32_swap_b32 v66, v70
    v_permlane32_swap_b32 v67, v71
    v_lshlrev_b32 v76, 4, v76
    v_add_f32 v64, v64, v68
    v_add_f32 v65, v65, v69
    v_add_f32 v66, v66, v70
    v_add_f32 v67, v67, v71
    s_add_u32 s66, s72, 147456
    v_add_u32 v76, s66, v76
    ds_write_b128 v76, v[64:67]
    s_waitcnt lgkmcnt(0)
Q_hd:
    s_lshl_b32 s53, s45, 12
    s_add_u32 s53, s53, s72
    s_lshl_b32 s54, s45, 16
    s_and_b32 s75, s74, 0x7ff
    s_sub_u32 s75, 2047, s75
    s_lshl_b32 s66, s6, 3
    s_lshl_b32 s67, s44, 1
    s_add_u32 s66, s66, s67
    s_lshl_b32 s66, s66, 15
    s_lshl_b32 s67, s45, 11
    s_add_u32 s66, s66, s67
    v_add_u32 v3, s66, v9
    v_add_u32 v4, 32768, v3
    s_lshr_b32 s63, s52, 6
    v_lshrrev_b32 v5, 4, v2
    v_bfe_u32 v6, v2, 2, 2
    v_lshl_add_u32 v8, v5, 2, v6
    v_bfe_u32 v6, v8, 1, 2
    v_lshlrev_b32 v8, 7, v8
    v_and_b32 v5, 3, v2
    v_lshl_add_u32 v8, v5, 3, v8
    s_lshl_b32 s66, s45, 16
    v_add_u32 v8, s66, v8
    v_xor_b32 v5, 0, v6
    v_lshl_add_u32 v10, v5, 5, v8
    v_xor_b32 v5, 1, v6
    v_lshl_add_u32 v11, v5, 5, v8
    v_xor_b32 v5, 2, v6
    v_lshl_add_u32 v12, v5, 5, v8
    v_xor_b32 v5, 3, v6
    v_lshl_add_u32 v13, v5, 5, v8
    s_lshr_b32 s66, s75, 7
    s_cmp_eq_u32 s66, s6
    s_cselect_b32 s51, 1, 0
    s_barrier
    s_add_u32 s66, s63, 0
    s_and_b32 s66, s66, 0x7fff
    buffer_load_dwordx4 v[96:99], v3, s[16:19], s66 offen offset:0 sc1
    buffer_load_dwordx4 v[100:103], v4, s[16:19], s66 offen offset:0 sc1
    buffer_load_dwordx4 v[104:107], v3, s[16:19], s66 offen offset:1024 sc1
    buffer_load_dwordx4 v[108:111], v4, s[16:19], s66 offen offset:1024 sc1
    s_cmp_eq_u32 s45, 0
    s_cbranch_scc1 Q_ny4
    s_lshl_b32 s66, s44, 8
    s_add_u32 s66, s66, 147456
    v_lshlrev_b32 v5, 2, v2
    v_add_u32 v6, s66, v5
    ds_read_b32 v64, v6 offset:0
    ds_read_b32 v65, v6 offset:1024
    ds_read_b32 v66, v6 offset:2048
    ds_read_b32 v67, v6 offset:3072
    s_waitcnt lgkmcnt(0)
    v_add_f32 v64, v64, v65
    v_add_f32 v66, v66, v67
    v_add_f32 v64, v64, v66
    buffer_store_dword v64, v5, s[16:19], s55 offen sc0 sc1
Q_ny4:
    s_add_u32 s66, s63, 4096
    s_and_b32 s66, s66, 0x7fff
    buffer_load_dwordx4 v[112:115], v3, s[16:19], s66 offen offset:0 sc1
    buffer_load_dwordx4 v[116:119], v4, s[16:19], s66 offen offset:0 sc1
    buffer_load_dwordx4 v[120:123], v3, s[16:19], s66 offen offset:1024 sc1
    buffer_load_dwordx4 v[124:127], v4, s[16:19], s66 offen offset:1024 sc1
    ds_read_b64_tr_b16 v[192:193], v10 offset:0
    ds_read_b64_tr_b16 v[194:195], v10 offset:2048
    ds_read_b64_tr_b16 v[196:197], v11 offset:0
    ds_read_b64_tr_b16 v[198:199], v11 offset:2048
    ds_read_b64_tr_b16 v[200:201], v12 offset:0
    ds_read_b64_tr_b16 v[202:203], v12 offset:2048
    ds_read_b64_tr_b16 v[204:205], v13 offset:0
    ds_read_b64_tr_b16 v[206:207], v13 offset:2048
    s_waitcnt vmcnt(4)
    v_max3_u32 v5, v96, v97, v98
    v_max3_u32 v5, v5, v99, v100
    v_max3_u32 v5, v5, v101, v102
    v_max3_u32 v5, v5, v103, v104
    v_max3_u32 v5, v5, v105, v106
    v_max3_u32 v5, v5, v107, v108
    v_max3_u32 v5, v5, v109, v110
    v_max_u32 v5, v5, v111
    v_cmp_eq_u32 vcc, -1, v5
    s_cbranch_vccnz Q_rt0
Q_go0:
    s_add_u32 s66, s63, 8192
    s_and_b32 s66, s66, 0x7fff
    s_waitcnt lgkmcnt(6)
    v_mfma_f32_16x16x32_bf16 v[224:227], v[192:195], v[96:99], 0
    buffer_load_dwordx4 v[128:131], v3, s[16:19], s66 offen offset:0 sc1
    v_mfma_f32_16x16x32_bf16 v[240:243], v[192:195], v[100:103], 0
    ds_read_b64_tr_b16 v[208:209], v10 offset:4096
    s_waitcnt lgkmcnt(5)
    v_mfma_f32_16x16x32_bf16 v[228:231], v[196:199], v[96:99], 0
    ds_read_b64_tr_b16 v[210:211], v10 offset:6144
    buffer_load_dwordx4 v[132:135], v4, s[16:19], s66 offen offset:0 sc1
    v_mfma_f32_16x16x32_bf16 v[244:247], v[196:199], v[100:103], 0
    ds_read_b64_tr_b16 v[212:213], v11 offset:4096
    s_waitcnt lgkmcnt(5)
    v_mfma_f32_16x16x32_bf16 v[232:235], v[200:203], v[96:99], 0
    ds_read_b64_tr_b16 v[214:215], v11 offset:6144
    buffer_load_dwordx4 v[136:139], v3, s[16:19], s66 offen offset:1024 sc1
    v_mfma_f32_16x16x32_bf16 v[248:251], v[200:203], v[100:103], 0
    ds_read_b64_tr_b16 v[216:217], v12 offset:4096
    s_waitcnt lgkmcnt(5)
    v_mfma_f32_16x16x32_bf16 v[236:239], v[204:207], v[96:99], 0
    ds_read_b64_tr_b16 v[218:219], v12 offset:6144
    buffer_load_dwordx4 v[140:143], v4, s[16:19], s66 offen offset:1024 sc1
    v_mfma_f32_16x16x32_bf16 v[252:255], v[204:207], v[100:103], 0
    ds_read_b64_tr_b16 v[220:221], v13 offset:4096
    ds_read_b64_tr_b16 v[222:223], v13 offset:6144
    s_waitcnt lgkmcnt(6)
    v_mfma_f32_16x16x32_bf16 v[224:227], v[208:211], v[104:107], v[224:227]
    v_mfma_f32_16x16x32_bf16 v[240:243], v[208:211], v[108:111], v[240:243]
    ds_read_b64_tr_b16 v[192:193], v10 offset:8192
    s_waitcnt lgkmcnt(5)
    v_mfma_f32_16x16x32_bf16 v[228:231], v[212:215], v[104:107], v[228:231]
    s_waitcnt vmcnt(4)
    ds_read_b64_tr_b16 v[194:195], v10 offset:10240
    v_max3_u32 v5, v112, v113, v114
    v_mfma_f32_16x16x32_bf16 v[244:247], v[212:215], v[108:111], v[244:247]
    ds_read_b64_tr_b16 v[196:197], v11 offset:8192
    v_max3_u32 v5, v5, v115, v116
    s_waitcnt lgkmcnt(5)
    v_mfma_f32_16x16x32_bf16 v[232:235], v[216:219], v[104:107], v[232:235]
    ds_read_b64_tr_b16 v[198:199], v11 offset:10240
    v_max3_u32 v5, v5, v117, v118
    v_mfma_f32_16x16x32_bf16 v[248:251], v[216:219], v[108:111], v[248:251]
    ds_read_b64_tr_b16 v[200:201], v12 offset:8192
    v_max3_u32 v5, v5, v119, v120
    v_max3_u32 v5, v5, v121, v122
    s_waitcnt lgkmcnt(5)
    v_mfma_f32_16x16x32_bf16 v[236:239], v[220:223], v[104:107], v[236:239]
    ds_read_b64_tr_b16 v[202:203], v12 offset:10240
    v_max3_u32 v5, v5, v123, v124
    v_max3_u32 v5, v5, v125, v126
    v_mfma_f32_16x16x32_bf16 v[252:255], v[220:223], v[108:111], v[252:255]
    ds_read_b64_tr_b16 v[204:205], v13 offset:8192
    ds_read_b64_tr_b16 v[206:207], v13 offset:10240
    v_max_u32 v5, v5, v127
    v_cmp_eq_u32 vcc, -1, v5
    s_cbranch_vccnz Q_rt1
Q_go1:
    s_add_u32 s66, s63, 12288
    s_and_b32 s66, s66, 0x7fff
    s_waitcnt lgkmcnt(6)
    v_mfma_f32_16x16x32_bf16 v[224:227], v[192:195], v[112:115], v[224:227]
    buffer_load_dwordx4 v[96:99], v3, s[16:19], s66 offen offset:0 sc1
    v_mfma_f32_16x16x32_bf16 v[240:243], v[192:195], v[116:119], v[240:243]
    ds_read_b64_tr_b16 v[208:209], v10 offset:12288
    s_waitcnt lgkmcnt(5)
    v_mfma_f32_16x16x32_bf16 v[228:231], v[196:199], v[112:115], v[228:231]
    ds_read_b64_tr_b16 v[210:211], v10 offset:14336
    buffer_load_dwordx4 v[100:103], v4, s[16:19], s66 offen offset:0 sc1
    v_mfma_f32_16x16x32_bf16 v[244:247], v[196:199], v[116:119], v[244:247]
    ds_read_b64_tr_b16 v[212:213], v11 offset:12288
    s_waitcnt lgkmcnt(5)
    v_mfma_f32_16x16x32_bf16 v[232:235], v[200:203], v[112:115], v[232:235]
    ds_read_b64_tr_b16 v[214:215], v11 offset:14336
    buffer_load_dwordx4 v[104:107], v3, s[16:19], s66 offen offset:1024 sc1
    v_mfma_f32_16x16x32_bf16 v[248:251], v[200:203], v[116:119], v[248:251]
    ds_read_b64_tr_b16 v[216:217], v12 offset:12288
    s_waitcnt lgkmcnt(5)
    v_mfma_f32_16x16x32_bf16 v[236:239], v[204:207], v[112:115], v[236:239]
    ds_read_b64_tr_b16 v[218:219], v12 offset:14336
    buffer_load_dwordx4 v[108:111], v4, s[16:19], s66 offen offset:1024 sc1
    v_mfma_f32_16x16x32_bf16 v[252:255], v[204:207], v[116:119], v[252:255]
    ds_read_b64_tr_b16 v[220:221], v13 offset:12288
    ds_read_b64_tr_b16 v[222:223], v13 offset:14336
    s_waitcnt lgkmcnt(6)
    v_mfma_f32_16x16x32_bf16 v[224:227], v[208:211], v[120:123], v[224:227]
    v_mfma_f32_16x16x32_bf16 v[240:243], v[208:211], v[124:127], v[240:243]
    ds_read_b64_tr_b16 v[192:193], v10 offset:16384
    s_waitcnt lgkmcnt(5)
    v_mfma_f32_16x16x32_bf16 v[228:231], v[212:215], v[120:123], v[228:231]
    s_waitcnt vmcnt(4)
    ds_read_b64_tr_b16 v[194:195], v10 offset:18432
    v_max3_u32 v5, v128, v129, v130
    v_mfma_f32_16x16x32_bf16 v[244:247], v[212:215], v[124:127], v[244:247]
    ds_read_b64_tr_b16 v[196:197], v11 offset:16384
    v_max3_u32 v5, v5, v131, v132
    s_waitcnt lgkmcnt(5)
    v_mfma_f32_16x16x32_bf16 v[232:235], v[216:219], v[120:123], v[232:235]
    ds_read_b64_tr_b16 v[198:199], v11 offset:18432
    v_max3_u32 v5, v5, v133, v134
    v_mfma_f32_16x16x32_bf16 v[248:251], v[216:219], v[124:127], v[248:251]
    ds_read_b64_tr_b16 v[200:201], v12 offset:16384
    v_max3_u32 v5, v5, v135, v136
    v_max3_u32 v5, v5, v137, v138
    s_waitcnt lgkmcnt(5)
    v_mfma_f32_16x16x32_bf16 v[236:239], v[220:223], v[120:123], v[236:239]
    ds_read_b64_tr_b16 v[202:203], v12 offset:18432
    v_max3_u32 v5, v5, v139, v140
    v_max3_u32 v5, v5, v141, v142
    v_mfma_f32_16x16x32_bf16 v[252:255], v[220:223], v[124:127], v[252:255]
    ds_read_b64_tr_b16 v[204:205], v13 offset:16384
    ds_read_b64_tr_b16 v[206:207], v13 offset:18432
    v_max_u32 v5, v5, v143
    v_cmp_eq_u32 vcc, -1, v5
    s_cbranch_vccnz Q_rt2
Q_go2:
    s_add_u32 s66, s63, 16384
    s_and_b32 s66, s66, 0x7fff
    s_waitcnt lgkmcnt(6)
    v_mfma_f32_16x16x32_bf16 v[224:227], v[192:195], v[128:131], v[224:227]
    buffer_load_dwordx4 v[112:115], v3, s[16:19], s66 offen offset:0 sc1
    v_mfma_f32_16x16x32_bf16 v[240:243], v[192:195], v[132:135], v[240:243]
    ds_read_b64_tr_b16 v[208:209], v10 offset:20480
    s_waitcnt lgkmcnt(5)
    v_mfma_f32_16x16x32_bf16 v[228:231], v[196:199], v[128:131], v[228:231]
    ds_read_b64_tr_b16 v[210:211], v10 offset:22528
    buffer_load_dwordx4 v[116:119], v4, s[16:19], s66 offen offset:0 sc1
    v_mfma_f32_16x16x32_bf16 v[244:247], v[196:199], v[132:135], v[244:247]
    ds_read_b64_tr_b16 v[212:213], v11 offset:20480
    s_waitcnt lgkmcnt(5)
    v_mfma_f32_16x16x32_bf16 v[232:235], v[200:203], v[128:131], v[232:235]
    ds_read_b64_tr_b16 v[214:215], v11 offset:22528
    buffer_load_dwordx4 v[120:123], v3, s[16:19], s66 offen offset:1024 sc1
    v_mfma_f32_16x16x32_bf16 v[248:251], v[200:203], v[132:135], v[248:251]
    ds_read_b64_tr_b16 v[216:217], v12 offset:20480
    s_waitcnt lgkmcnt(5)
    v_mfma_f32_16x16x32_bf16 v[236:239], v[204:207], v[128:131], v[236:239]
    ds_read_b64_tr_b16 v[218:219], v12 offset:22528
    buffer_load_dwordx4 v[124:127], v4, s[16:19], s66 offen offset:1024 sc1
    v_mfma_f32_16x16x32_bf16 v[252:255], v[204:207], v[132:135], v[252:255]
    ds_read_b64_tr_b16 v[220:221], v13 offset:20480
    ds_read_b64_tr_b16 v[222:223], v13 offset:22528
    s_waitcnt lgkmcnt(0)
    s_barrier
    s_waitcnt lgkmcnt(6)
    v_mfma_f32_16x16x32_bf16 v[224:227], v[208:211], v[136:139], v[224:227]
    v_mfma_f32_16x16x32_bf16 v[240:243], v[208:211], v[140:143], v[240:243]
    ds_read_b64_tr_b16 v[192:193], v10 offset:24576
    s_waitcnt lgkmcnt(5)
    v_mfma_f32_16x16x32_bf16 v[228:231], v[212:215], v[136:139], v[228:231]
    s_waitcnt vmcnt(4)
    ds_read_b64_tr_b16 v[194:195], v10 offset:26624
    v_max3_u32 v5, v96, v97, v98
    v_mfma_f32_16x16x32_bf16 v[244:247], v[212:215], v[140:143], v[244:247]
    ds_read_b64_tr_b16 v[196:197], v11 offset:24576
    v_max3_u32 v5, v5, v99, v100
    s_waitcnt lgkmcnt(5)
    v_mfma_f32_16x16x32_bf16 v[232:235], v[216:219], v[136:139], v[232:235]
    ds_read_b64_tr_b16 v[198:199], v11 offset:26624
    v_max3_u32 v5, v5, v101, v102
    v_mfma_f32_16x16x32_bf16 v[248:251], v[216:219], v[140:143], v[248:251]
    ds_read_b64_tr_b16 v[200:201], v12 offset:24576
    v_max3_u32 v5, v5, v103, v104
    v_max3_u32 v5, v5, v105, v106
    s_waitcnt lgkmcnt(5)
    v_mfma_f32_16x16x32_bf16 v[236:239], v[220:223], v[136:139], v[236:239]
    ds_read_b64_tr_b16 v[202:203], v12 offset:26624
    v_max3_u32 v5, v5, v107, v108
    v_max3_u32 v5, v5, v109, v110
    v_mfma_f32_16x16x32_bf16 v[252:255], v[220:223], v[140:143], v[252:255]
    ds_read_b64_tr_b16 v[204:205], v13 offset:24576
    ds_read_b64_tr_b16 v[206:207], v13 offset:26624
    v_max_u32 v5, v5, v111
    v_cmp_eq_u32 vcc, -1, v5
    s_cbranch_vccnz Q_rt3
Q_go3:
    s_add_u32 s66, s63, 20480
    s_and_b32 s66, s66, 0x7fff
    s_waitcnt lgkmcnt(6)
    v_mfma_f32_16x16x32_bf16 v[224:227], v[192:195], v[96:99], v[224:227]
    buffer_load_dwordx4 v[128:131], v3, s[16:19], s66 offen offset:0 sc1
    v_mfma_f32_16x16x32_bf16 v[240:243], v[192:195], v[100:103], v[240:243]
    ds_read_b64_tr_b16 v[208:209], v10 offset:28672
    s_waitcnt lgkmcnt(5)
    v_mfma_f32_16x16x32_bf16 v[228:231], v[196:199], v[96:99], v[228:231]
    ds_read_b64_tr_b16 v[210:211], v10 offset:30720
    buffer_load_dwordx4 v[132:135], v4, s[16:19], s66 offen offset:0 sc1
    v_mfma_f32_16x16x32_bf16 v[244:247], v[196:199], v[100:103], v[244:247]
    ds_read_b64_tr_b16 v[212:213], v11 offset:28672
    s_waitcnt lgkmcnt(5)
    v_mfma_f32_16x16x32_bf16 v[232:235], v[200:203], v[96:99], v[232:235]
    ds_read_b64_tr_b16 v[214:215], v11 offset:30720
    buffer_load_dwordx4 v[136:139], v3, s[16:19], s66 offen offset:1024 sc1
    v_mfma_f32_16x16x32_bf16 v[248:251], v[200:203], v[100:103], v[248:251]
    ds_read_b64_tr_b16 v[216:217], v12 offset:28672
    s_waitcnt lgkmcnt(5)
    v_mfma_f32_16x16x32_bf16 v[236:239], v[204:207], v[96:99], v[236:239]
    ds_read_b64_tr_b16 v[218:219], v12 offset:30720
    buffer_load_dwordx4 v[140:143], v4, s[16:19], s66 offen offset:1024 sc1
    v_mfma_f32_16x16x32_bf16 v[252:255], v[204:207], v[100:103], v[252:255]
    ds_read_b64_tr_b16 v[220:221], v13 offset:28672
    ds_read_b64_tr_b16 v[222:223], v13 offset:30720
    s_waitcnt lgkmcnt(6)
    v_mfma_f32_16x16x32_bf16 v[224:227], v[208:211], v[104:107], v[224:227]
    v_mfma_f32_16x16x32_bf16 v[240:243], v[208:211], v[108:111], v[240:243]
    ds_read_b64_tr_b16 v[192:193], v10 offset:32768
    s_waitcnt lgkmcnt(5)
    v_mfma_f32_16x16x32_bf16 v[228:231], v[212:215], v[104:107], v[228:231]
    s_waitcnt vmcnt(4)
    ds_read_b64_tr_b16 v[194:195], v10 offset:34816
    v_max3_u32 v5, v112, v113, v114
    v_mfma_f32_16x16x32_bf16 v[244:247], v[212:215], v[108:111], v[244:247]
    ds_read_b64_tr_b16 v[196:197], v11 offset:32768
    v_max3_u32 v5, v5, v115, v116
    s_waitcnt lgkmcnt(5)
    v_mfma_f32_16x16x32_bf16 v[232:235], v[216:219], v[104:107], v[232:235]
    ds_read_b64_tr_b16 v[198:199], v11 offset:34816
    v_max3_u32 v5, v5, v117, v118
    v_mfma_f32_16x16x32_bf16 v[248:251], v[216:219], v[108:111], v[248:251]
    ds_read_b64_tr_b16 v[200:201], v12 offset:32768
    v_max3_u32 v5, v5, v119, v120
    v_max3_u32 v5, v5, v121, v122
    s_waitcnt lgkmcnt(5)
    v_mfma_f32_16x16x32_bf16 v[236:239], v[220:223], v[104:107], v[236:239]
    ds_read_b64_tr_b16 v[202:203], v12 offset:34816
    v_max3_u32 v5, v5, v123, v124
    v_max3_u32 v5, v5, v125, v126
    v_mfma_f32_16x16x32_bf16 v[252:255], v[220:223], v[108:111], v[252:255]
    ds_read_b64_tr_b16 v[204:205], v13 offset:32768
    ds_read_b64_tr_b16 v[206:207], v13 offset:34816
    v_max_u32 v5, v5, v127
    v_cmp_eq_u32 vcc, -1, v5
    s_cbranch_vccnz Q_rt4
Q_go4:
    s_cmp_eq_u32 s51, 0
    s_cbranch_scc1 Q_ny0
    s_lshl_b32 s64, s7, 14
    s_lshl_b32 s66, s3, 11
    s_add_u32 s64, s64, s66
    s_add_u32 s64, s64, 5832704
    buffer_load_dwordx4 v[32:35], v9, s[16:19], s64 offen offset:0 sc1
    buffer_load_dwordx4 v[36:39], v9, s[16:19], s64 offen offset:1024 sc1
Q_ny0:
    s_add_u32 s66, s63, 24576
    s_and_b32 s66, s66, 0x7fff
    s_waitcnt lgkmcnt(6)
    v_mfma_f32_16x16x32_bf16 v[224:227], v[192:195], v[112:115], v[224:227]
    buffer_load_dwordx4 v[96:99], v3, s[16:19], s66 offen offset:0 sc1
    v_mfma_f32_16x16x32_bf16 v[240:243], v[192:195], v[116:119], v[240:243]
    ds_read_b64_tr_b16 v[208:209], v10 offset:36864
    s_waitcnt lgkmcnt(5)
    v_mfma_f32_16x16x32_bf16 v[228:231], v[196:199], v[112:115], v[228:231]
    ds_read_b64_tr_b16 v[210:211], v10 offset:38912
    buffer_load_dwordx4 v[100:103], v4, s[16:19], s66 offen offset:0 sc1
    v_mfma_f32_16x16x32_bf16 v[244:247], v[196:199], v[116:119], v[244:247]
    ds_read_b64_tr_b16 v[212:213], v11 offset:36864
    s_waitcnt lgkmcnt(5)
    v_mfma_f32_16x16x32_bf16 v[232:235], v[200:203], v[112:115], v[232:235]
    ds_read_b64_tr_b16 v[214:215], v11 offset:38912
    buffer_load_dwordx4 v[104:107], v3, s[16:19], s66 offen offset:1024 sc1
    v_mfma_f32_16x16x32_bf16 v[248:251], v[200:203], v[116:119], v[248:251]
    ds_read_b64_tr_b16 v[216:217], v12 offset:36864
    s_waitcnt lgkmcnt(5)
    v_mfma_f32_16x16x32_bf16 v[236:239], v[204:207], v[112:115], v[236:239]
    ds_read_b64_tr_b16 v[218:219], v12 offset:38912
    buffer_load_dwordx4 v[108:111], v4, s[16:19], s66 offen offset:1024 sc1
    v_mfma_f32_16x16x32_bf16 v[252:255], v[204:207], v[116:119], v[252:255]
    ds_read_b64_tr_b16 v[220:221], v13 offset:36864
    ds_read_b64_tr_b16 v[222:223], v13 offset:38912
    s_waitcnt lgkmcnt(6)
    v_mfma_f32_16x16x32_bf16 v[224:227], v[208:211], v[120:123], v[224:227]
    v_mfma_f32_16x16x32_bf16 v[240:243], v[208:211], v[124:127], v[240:243]
    ds_read_b64_tr_b16 v[192:193], v10 offset:40960
    s_waitcnt lgkmcnt(5)
    v_mfma_f32_16x16x32_bf16 v[228:231], v[212:215], v[120:123], v[228:231]
    s_waitcnt vmcnt(4)
    ds_read_b64_tr_b16 v[194:195], v10 offset:43008
    v_max3_u32 v5, v128, v129, v130
    v_mfma_f32_16x16x32_bf16 v[244:247], v[212:215], v[124:127], v[244:247]
    ds_read_b64_tr_b16 v[196:197], v11 offset:40960
    v_max3_u32 v5, v5, v131, v132
    s_waitcnt lgkmcnt(5)
    v_mfma_f32_16x16x32_bf16 v[232:235], v[216:219], v[120:123], v[232:235]
    ds_read_b64_tr_b16 v[198:199], v11 offset:43008
    v_max3_u32 v5, v5, v133, v134
    v_mfma_f32_16x16x32_bf16 v[248:251], v[216:219], v[124:127], v[248:251]
    ds_read_b64_tr_b16 v[200:201], v12 offset:40960
    v_max3_u32 v5, v5, v135, v136
    v_max3_u32 v5, v5, v137, v138
    s_waitcnt lgkmcnt(5)
    v_mfma_f32_16x16x32_bf16 v[236:239], v[220:223], v[120:123], v[236:239]
    ds_read_b64_tr_b16 v[202:203], v12 offset:43008
    v_max3_u32 v5, v5, v139, v140
    v_max3_u32 v5, v5, v141, v142
    v_mfma_f32_16x16x32_bf16 v[252:255], v[220:223], v[124:127], v[252:255]
    ds_read_b64_tr_b16 v[204:205], v13 offset:40960
    ds_read_b64_tr_b16 v[206:207], v13 offset:43008
    v_max_u32 v5, v5, v143
    v_cmp_eq_u32 vcc, -1, v5
    s_cbranch_vccnz Q_rt5
Q_go5:
    s_cmp_eq_u32 s45, 0
    s_cbranch_scc1 Q_np2
    s_setprio 1
Q_np2:
    s_cmp_eq_u32 s51, 0
    s_cbranch_scc1 Q_ny1
    s_mov_b32 s59, 0
Q_ychk:
    s_waitcnt vmcnt(0)
    v_max3_u32 v5, v32, v33, v34
    v_max3_u32 v5, v5, v35, v36
    v_max3_u32 v5, v5, v37, v38
    v_max_u32 v5, v5, v39
    v_cmp_eq_u32 vcc, -1, v5
    s_cbranch_vccz Q_yok
    s_add_u32 s59, s59, 1
    s_cmp_ge_u32 s59, 200000
    s_cbranch_scc1 Q_yok
    s_sleep 4
    buffer_load_dwordx4 v[32:35], v9, s[16:19], s64 offen offset:0 sc1
    buffer_load_dwordx4 v[36:39], v9, s[16:19], s64 offen offset:1024 sc1
    s_branch Q_ychk
Q_yok:
    v_add_f32 v32, v32, v36
    v_add_f32 v33, v33, v37
    v_add_f32 v34, v34, v38
    v_add_f32 v35, v35, v39
    s_nop 1
    v_permlane16_swap_b32 v32, v34
    v_permlane16_swap_b32 v33, v35
    v_add_f32 v32, v32, v34
    v_add_f32 v33, v33, v35
    v_and_b32 v5, 15, v2
    v_lshlrev_b32 v5, 4, v5
    v_permlane32_swap_b32 v32, v33
    v_bfe_u32 v8, v2, 4, 1
    v_lshl_add_u32 v5, v8, 3, v5
    v_lshrrev_b32 v8, 5, v2
    v_lshl_add_u32 v5, v8, 2, v5
    v_add_f32 v32, v32, v33
    s_lshl_b32 s66, s3, 8
    s_add_u32 s66, s66, 156992
    v_add_u32 v5, s66, v5
    ds_write_b32 v5, v32
    v_mov_b32 v5, 155688
    v_mov_b32 v8, 1
    s_mov_b64 exec, 1
    ds_add_u32 v5, v8
    s_mov_b64 exec, -1
    s_waitcnt lgkmcnt(0)
Q_ny1:
    s_add_u32 s66, s63, 28672
    s_and_b32 s66, s66, 0x7fff
    s_waitcnt lgkmcnt(6)
    v_mfma_f32_16x16x32_bf16 v[224:227], v[192:195], v[128:131], v[224:227]
    buffer_load_dwordx4 v[112:115], v3, s[16:19], s66 offen offset:0 sc1
    v_mfma_f32_16x16x32_bf16 v[240:243], v[192:195], v[132:135], v[240:243]
    ds_read_b64_tr_b16 v[208:209], v10 offset:45056
    s_waitcnt lgkmcnt(5)
    v_mfma_f32_16x16x32_bf16 v[228:231], v[196:199], v[128:131], v[228:231]
    ds_read_b64_tr_b16 v[210:211], v10 offset:47104
    buffer_load_dwordx4 v[116:119], v4, s[16:19], s66 offen offset:0 sc1
    v_mfma_f32_16x16x32_bf16 v[244:247], v[196:199], v[132:135], v[244:247]
    ds_read_b64_tr_b16 v[212:213], v11 offset:45056
    s_waitcnt lgkmcnt(5)
    v_mfma_f32_16x16x32_bf16 v[232:235], v[200:203], v[128:131], v[232:235]
    ds_read_b64_tr_b16 v[214:215], v11 offset:47104
    buffer_load_dwordx4 v[120:123], v3, s[16:19], s66 offen offset:1024 sc1
    v_mfma_f32_16x16x32_bf16 v[248:251], v[200:203], v[132:135], v[248:251]
    ds_read_b64_tr_b16 v[216:217], v12 offset:45056
    s_waitcnt lgkmcnt(5)
    v_mfma_f32_16x16x32_bf16 v[236:239], v[204:207], v[128:131], v[236:239]
    ds_read_b64_tr_b16 v[218:219], v12 offset:47104
    buffer_load_dwordx4 v[124:127], v4, s[16:19], s66 offen offset:1024 sc1
    v_mfma_f32_16x16x32_bf16 v[252:255], v[204:207], v[132:135], v[252:255]
    ds_read_b64_tr_b16 v[220:221], v13 offset:45056
    ds_read_b64_tr_b16 v[222:223], v13 offset:47104
    s_waitcnt lgkmcnt(6)
    v_mfma_f32_16x16x32_bf16 v[224:227], v[208:211], v[136:139], v[224:227]
    v_mfma_f32_16x16x32_bf16 v[240:243], v[208:211], v[140:143], v[240:243]
    ds_read_b64_tr_b16 v[192:193], v10 offset:49152
    s_waitcnt lgkmcnt(5)
    v_mfma_f32_16x16x32_bf16 v[228:231], v[212:215], v[136:139], v[228:231]
    s_waitcnt vmcnt(4)
    ds_read_b64_tr_b16 v[194:195], v10 offset:51200
    v_max3_u32 v5, v96, v97, v98
    v_mfma_f32_16x16x32_bf16 v[244:247], v[212:215], v[140:143], v[244:247]
    ds_read_b64_tr_b16 v[196:197], v11 offset:49152
    v_max3_u32 v5, v5, v99, v100
    s_waitcnt lgkmcnt(5)
    v_mfma_f32_16x16x32_bf16 v[232:235], v[216:219], v[136:139], v[232:235]
    ds_read_b64_tr_b16 v[198:199], v11 offset:51200
    v_max3_u32 v5, v5, v101, v102
    v_mfma_f32_16x16x32_bf16 v[248:251], v[216:219], v[140:143], v[248:251]
    ds_read_b64_tr_b16 v[200:201], v12 offset:49152
    v_max3_u32 v5, v5, v103, v104
    v_max3_u32 v5, v5, v105, v106
    s_waitcnt lgkmcnt(5)
    v_mfma_f32_16x16x32_bf16 v[236:239], v[220:223], v[136:139], v[236:239]
    ds_read_b64_tr_b16 v[202:203], v12 offset:51200
    v_max3_u32 v5, v5, v107, v108
    v_max3_u32 v5, v5, v109, v110
    v_mfma_f32_16x16x32_bf16 v[252:255], v[220:223], v[140:143], v[252:255]
    ds_read_b64_tr_b16 v[204:205], v13 offset:49152
    ds_read_b64_tr_b16 v[206:207], v13 offset:51200
    v_max_u32 v5, v5, v111
    v_cmp_eq_u32 vcc, -1, v5
    s_cbranch_vccnz Q_rt6
Q_go6:
    s_waitcnt lgkmcnt(6)
    v_mfma_f32_16x16x32_bf16 v[224:227], v[192:195], v[96:99], v[224:227]
    v_sub_f32 v153, 1.0, v152
    v_cvt_pk_bf16_f32 v153, 0, v153
    v_mfma_f32_16x16x32_bf16 v[240:243], v[192:195], v[100:103], v[240:243]
    ds_read_b64_tr_b16 v[208:209], v10 offset:53248
    v_lshlrev_b32 v16, 16, v144
    v_and_b32 v17, 0xffff0000, v144
    s_waitcnt lgkmcnt(5)
    v_mfma_f32_16x16x32_bf16 v[228:231], v[196:199], v[96:99], v[228:231]
    ds_read_b64_tr_b16 v[210:211], v10 offset:55296
    v_mul_f32 v16, v16, v153
    v_mul_f32 v17, v17, v153
    v_mfma_f32_16x16x32_bf16 v[244:247], v[196:199], v[100:103], v[244:247]
    ds_read_b64_tr_b16 v[212:213], v11 offset:53248
    v_cvt_pk_bf16_f32 v16, 0, v16
    v_cvt_pk_bf16_f32 v17, 0, v17
    s_waitcnt lgkmcnt(5)
    v_mfma_f32_16x16x32_bf16 v[232:235], v[200:203], v[96:99], v[232:235]
    ds_read_b64_tr_b16 v[214:215], v11 offset:55296
    v_lshlrev_b32 v18, 16, v145
    v_and_b32 v19, 0xffff0000, v145
    v_mfma_f32_16x16x32_bf16 v[248:251], v[200:203], v[100:103], v[248:251]
    ds_read_b64_tr_b16 v[216:217], v12 offset:53248
    v_mul_f32 v18, v18, v153
    v_mul_f32 v19, v19, v153
    s_waitcnt lgkmcnt(5)
    v_mfma_f32_16x16x32_bf16 v[236:239], v[204:207], v[96:99], v[236:239]
    ds_read_b64_tr_b16 v[218:219], v12 offset:55296
    v_cvt_pk_bf16_f32 v18, 0, v18
    v_cvt_pk_bf16_f32 v19, 0, v19
    v_mfma_f32_16x16x32_bf16 v[252:255], v[204:207], v[100:103], v[252:255]
    ds_read_b64_tr_b16 v[220:221], v13 offset:53248
    ds_read_b64_tr_b16 v[222:223], v13 offset:55296
    v_lshlrev_b32 v20, 16, v146
    v_and_b32 v21, 0xffff0000, v146
    s_waitcnt lgkmcnt(6)
    v_mfma_f32_16x16x32_bf16 v[224:227], v[208:211], v[104:107], v[224:227]
    v_mfma_f32_16x16x32_bf16 v[240:243], v[208:211], v[108:111], v[240:243]
    ds_read_b64_tr_b16 v[192:193], v10 offset:57344
    s_waitcnt lgkmcnt(5)
    v_mfma_f32_16x16x32_bf16 v[228:231], v[212:215], v[104:107], v[228:231]
    s_waitcnt vmcnt(0)
    ds_read_b64_tr_b16 v[194:195], v10 offset:59392
    v_max3_u32 v5, v112, v113, v114
    v_mfma_f32_16x16x32_bf16 v[244:247], v[212:215], v[108:111], v[244:247]
    ds_read_b64_tr_b16 v[196:197], v11 offset:57344
    v_max3_u32 v5, v5, v115, v116
    s_waitcnt lgkmcnt(5)
    v_mfma_f32_16x16x32_bf16 v[232:235], v[216:219], v[104:107], v[232:235]
    ds_read_b64_tr_b16 v[198:199], v11 offset:59392
    v_max3_u32 v5, v5, v117, v118
    v_mfma_f32_16x16x32_bf16 v[248:251], v[216:219], v[108:111], v[248:251]
    ds_read_b64_tr_b16 v[200:201], v12 offset:57344
    v_max3_u32 v5, v5, v119, v120
    v_max3_u32 v5, v5, v121, v122
    s_waitcnt lgkmcnt(5)
    v_mfma_f32_16x16x32_bf16 v[236:239], v[220:223], v[104:107], v[236:239]
    ds_read_b64_tr_b16 v[202:203], v12 offset:59392
    v_max3_u32 v5, v5, v123, v124
    v_max3_u32 v5, v5, v125, v126
    v_mfma_f32_16x16x32_bf16 v[252:255], v[220:223], v[108:111], v[252:255]
    ds_read_b64_tr_b16 v[204:205], v13 offset:57344
    ds_read_b64_tr_b16 v[206:207], v13 offset:59392
    v_max_u32 v5, v5, v127
    v_cmp_eq_u32 vcc, -1, v5
    s_cbranch_vccnz Q_rt7
Q_go7:
    s_waitcnt lgkmcnt(6)
    v_mfma_f32_16x16x32_bf16 v[224:227], v[192:195], v[112:115], v[224:227]
    v_mul_f32 v20, v20, v153
    v_mul_f32 v21, v21, v153
    v_mfma_f32_16x16x32_bf16 v[240:243], v[192:195], v[116:119], v[240:243]
    ds_read_b64_tr_b16 v[208:209], v10 offset:61440
    v_cvt_pk_bf16_f32 v20, 0, v20
    v_cvt_pk_bf16_f32 v21, 0, v21
    s_waitcnt lgkmcnt(5)
    v_mfma_f32_16x16x32_bf16 v[228:231], v[196:199], v[112:115], v[228:231]
    ds_read_b64_tr_b16 v[210:211], v10 offset:63488
    v_lshlrev_b32 v22, 16, v147
    v_and_b32 v23, 0xffff0000, v147
    v_mfma_f32_16x16x32_bf16 v[244:247], v[196:199], v[116:119], v[244:247]
    ds_read_b64_tr_b16 v[212:213], v11 offset:61440
    v_mul_f32 v22, v22, v153
    v_mul_f32 v23, v23, v153
    s_waitcnt lgkmcnt(5)
    v_mfma_f32_16x16x32_bf16 v[232:235], v[200:203], v[112:115], v[232:235]
    ds_read_b64_tr_b16 v[214:215], v11 offset:63488
    v_cvt_pk_bf16_f32 v22, 0, v22
    v_cvt_pk_bf16_f32 v23, 0, v23
    v_mfma_f32_16x16x32_bf16 v[248:251], v[200:203], v[116:119], v[248:251]
    ds_read_b64_tr_b16 v[216:217], v12 offset:61440
    v_lshlrev_b32 v24, 16, v148
    v_and_b32 v25, 0xffff0000, v148
    s_waitcnt lgkmcnt(5)
    v_mfma_f32_16x16x32_bf16 v[236:239], v[204:207], v[112:115], v[236:239]
    ds_read_b64_tr_b16 v[218:219], v12 offset:63488
    v_mul_f32 v24, v24, v153
    v_mul_f32 v25, v25, v153
    v_mfma_f32_16x16x32_bf16 v[252:255], v[204:207], v[116:119], v[252:255]
    ds_read_b64_tr_b16 v[220:221], v13 offset:61440
    ds_read_b64_tr_b16 v[222:223], v13 offset:63488
    v_cvt_pk_bf16_f32 v24, 0, v24
    v_cvt_pk_bf16_f32 v25, 0, v25
    s_waitcnt lgkmcnt(6)
    v_mfma_f32_16x16x32_bf16 v[224:227], v[208:211], v[120:123], v[224:227]
    v_lshlrev_b32 v26, 16, v149
    v_and_b32 v27, 0xffff0000, v149
    v_mul_f32 v26, v26, v153
    v_mfma_f32_16x16x32_bf16 v[240:243], v[208:211], v[124:127], v[240:243]
    v_mul_f32 v27, v27, v153
    v_cvt_pk_bf16_f32 v26, 0, v26
    v_cvt_pk_bf16_f32 v27, 0, v27
    s_waitcnt lgkmcnt(4)
    v_mfma_f32_16x16x32_bf16 v[228:231], v[212:215], v[120:123], v[228:231]
    v_lshlrev_b32 v28, 16, v150
    v_and_b32 v29, 0xffff0000, v150
    v_mul_f32 v28, v28, v153
    v_mfma_f32_16x16x32_bf16 v[244:247], v[212:215], v[124:127], v[244:247]
    v_mul_f32 v29, v29, v153
    v_cvt_pk_bf16_f32 v28, 0, v28
    v_cvt_pk_bf16_f32 v29, 0, v29
    s_waitcnt lgkmcnt(2)
    v_mfma_f32_16x16x32_bf16 v[232:235], v[216:219], v[120:123], v[232:235]
    v_lshlrev_b32 v30, 16, v151
    v_and_b32 v31, 0xffff0000, v151
    v_mul_f32 v30, v30, v153
    v_mfma_f32_16x16x32_bf16 v[248:251], v[216:219], v[124:127], v[248:251]
    v_mul_f32 v31, v31, v153
    v_cvt_pk_bf16_f32 v30, 0, v30
    v_cvt_pk_bf16_f32 v31, 0, v31
    s_waitcnt lgkmcnt(0)
    v_mfma_f32_16x16x32_bf16 v[236:239], v[220:223], v[120:123], v[236:239]
    v_mov_b32 v154, v152
    v_mov_b32 v155, v152
    s_lshl_b32 s66, s44, 12
    v_mfma_f32_16x16x32_bf16 v[252:255], v[220:223], v[124:127], v[252:255]
    s_add_u32 s66, s66, s54
    v_add_u32 v6, s66, v9
    v_xor_b32 v7, 0x10000, v6
    s_nop 3
    s_cmp_eq_u32 s45, 0
    s_cbranch_scc1 Q_x0
    ds_write_b128 v6, v[224:227] offset:0
    ds_write_b128 v6, v[228:231] offset:1024
    ds_write_b128 v6, v[232:235] offset:2048
    ds_write_b128 v6, v[236:239] offset:3072
    v_mov_b32 v224, v240
    v_mov_b32 v225, v241
    v_mov_b32 v226, v242
    v_mov_b32 v227, v243
    v_mov_b32 v228, v244
    v_mov_b32 v229, v245
    v_mov_b32 v230, v246
    v_mov_b32 v231, v247
    v_mov_b32 v232, v248
    v_mov_b32 v233, v249
    v_mov_b32 v234, v250
    v_mov_b32 v235, v251
    v_mov_b32 v236, v252
    v_mov_b32 v237, v253
    v_mov_b32 v238, v254
    v_mov_b32 v239, v255
    s_branch Q_x1
Q_x0:
    ds_write_b128 v6, v[240:243] offset:0
    ds_write_b128 v6, v[244:247] offset:1024
    ds_write_b128 v6, v[248:251] offset:2048
    ds_write_b128 v6, v[252:255] offset:3072
Q_x1:
    s_cmp_eq_u32 s51, 0
    s_cbranch_scc1 Q_ny2
    s_cmp_lg_u32 s3, 0
    s_cbranch_scc1 Q_ny2
    v_mov_b32 v5, 155688
Q_yw:
    ds_read_b32 v8, v5
    s_waitcnt lgkmcnt(0)
    v_cmp_ne_u32 vcc, 8, v8
    s_cbranch_vccnz Q_yw
    v_lshlrev_b32 v8, 2, v2
    v_add_u32 v8, 156992, v8
    ds_read_b32 v32, v8 offset:0
    ds_read_b32 v33, v8 offset:256
    ds_read_b32 v34, v8 offset:512
    ds_read_b32 v35, v8 offset:768
    ds_read_b32 v36, v8 offset:1024
    ds_read_b32 v37, v8 offset:1280
    ds_read_b32 v38, v8 offset:1536
    ds_read_b32 v39, v8 offset:1792
    s_and_b32 s66, s74, 0xffff0000
    s_xor_b32 s67, s66, 0x80000000
    s_not_b32 s68, s66
    s_and_b32 s68, s68, 0xffff0000
    s_cmp_ge_u32 s66, 0x80000000
    s_cselect_b32 s66, s67, s68
    v_mov_b32 v40, s66
    v_mul_f32 v40, s46, v40
    v_exp_f32 v40, -v40
    s_nop 0
    v_add_f32 v40, 1.0, v40
    v_rcp_f32 v40, v40
    s_nop 0
    v_cvt_pk_bf16_f32 v40, 0, v40
    s_waitcnt lgkmcnt(0)
    v_add_f32 v32, v32, v33
    v_add_f32 v32, v32, v34
    v_add_f32 v32, v32, v35
    v_add_f32 v32, v32, v36
    v_add_f32 v32, v32, v37
    v_add_f32 v32, v32, v38
    v_add_f32 v32, v32, v39
    v_cvt_pk_bf16_f32 v32, 0, v32
    v_mul_f32 v32, v32, v40
    v_cvt_pk_bf16_f32 v32, 0, v32
    ds_write_b32 v8, v32 offset:2048
    s_waitcnt lgkmcnt(0)
Q_ny2:
    s_waitcnt lgkmcnt(0)
    s_barrier
    ds_read_b128 v[240:243], v7 offset:0
    ds_read_b128 v[244:247], v7 offset:1024
    ds_read_b128 v[248:251], v7 offset:2048
    ds_read_b128 v[252:255], v7 offset:3072
    v_cmp_eq_u32 vcc, s75, v92
    s_and_saveexec_b64 s[68:69], vcc
    s_cbranch_execz Q_nr
    v_bfe_u32 v8, v2, 4, 1
    v_lshlrev_b32 v8, 6, v8
    v_lshrrev_b32 v5, 5, v2
    v_lshl_add_u32 v8, v5, 5, v8
    v_add_u32 v8, 159040, v8
    ds_read_b128 v[40:43], v8 offset:0
    ds_read_b128 v[44:47], v8 offset:16
    ds_read_b128 v[48:51], v8 offset:128
    ds_read_b128 v[52:55], v8 offset:144
    s_waitcnt lgkmcnt(0)
    v_lshlrev_b32 v16, 16, v144
    v_and_b32 v17, 0xffff0000, v144
    v_lshlrev_b32 v18, 16, v145
    v_and_b32 v19, 0xffff0000, v145
    v_lshlrev_b32 v20, 16, v146
    v_and_b32 v21, 0xffff0000, v146
    v_lshlrev_b32 v22, 16, v147
    v_and_b32 v23, 0xffff0000, v147
    v_lshlrev_b32 v24, 16, v148
    v_and_b32 v25, 0xffff0000, v148
    v_lshlrev_b32 v26, 16, v149
    v_and_b32 v27, 0xffff0000, v149
    v_lshlrev_b32 v28, 16, v150
    v_and_b32 v29, 0xffff0000, v150
    v_lshlrev_b32 v30, 16, v151
    v_and_b32 v31, 0xffff0000, v151
    v_add_f32 v16, v16, v40
    v_cvt_pk_bf16_f32 v16, 0, v16
    v_mul_f32 v16, v16, v153
    v_cvt_pk_bf16_f32 v16, 0, v16
    v_add_f32 v17, v17, v41
    v_cvt_pk_bf16_f32 v17, 0, v17
    v_mul_f32 v17, v17, v153
    v_cvt_pk_bf16_f32 v17, 0, v17
    v_add_f32 v18, v18, v42
    v_cvt_pk_bf16_f32 v18, 0, v18
    v_mul_f32 v18, v18, v153
    v_cvt_pk_bf16_f32 v18, 0, v18
    v_add_f32 v19, v19, v43
    v_cvt_pk_bf16_f32 v19, 0, v19
    v_mul_f32 v19, v19, v153
    v_cvt_pk_bf16_f32 v19, 0, v19
    v_add_f32 v20, v20, v44
    v_cvt_pk_bf16_f32 v20, 0, v20
    v_mul_f32 v20, v20, v153
    v_cvt_pk_bf16_f32 v20, 0, v20
    v_add_f32 v21, v21, v45
    v_cvt_pk_bf16_f32 v21, 0, v21
    v_mul_f32 v21, v21, v153
    v_cvt_pk_bf16_f32 v21, 0, v21
    v_add_f32 v22, v22, v46
    v_cvt_pk_bf16_f32 v22, 0, v22
    v_mul_f32 v22, v22, v153
    v_cvt_pk_bf16_f32 v22, 0, v22
    v_add_f32 v23, v23, v47
    v_cvt_pk_bf16_f32 v23, 0, v23
    v_mul_f32 v23, v23, v153
    v_cvt_pk_bf16_f32 v23, 0, v23
    v_add_f32 v24, v24, v48
    v_cvt_pk_bf16_f32 v24, 0, v24
    v_mul_f32 v24, v24, v153
    v_cvt_pk_bf16_f32 v24, 0, v24
    v_add_f32 v25, v25, v49
    v_cvt_pk_bf16_f32 v25, 0, v25
    v_mul_f32 v25, v25, v153
    v_cvt_pk_bf16_f32 v25, 0, v25
    v_add_f32 v26, v26, v50
    v_cvt_pk_bf16_f32 v26, 0, v26
    v_mul_f32 v26, v26, v153
    v_cvt_pk_bf16_f32 v26, 0, v26
    v_add_f32 v27, v27, v51
    v_cvt_pk_bf16_f32 v27, 0, v27
    v_mul_f32 v27, v27, v153
    v_cvt_pk_bf16_f32 v27, 0, v27
    v_add_f32 v28, v28, v52
    v_cvt_pk_bf16_f32 v28, 0, v28
    v_mul_f32 v28, v28, v153
    v_cvt_pk_bf16_f32 v28, 0, v28
    v_add_f32 v29, v29, v53
    v_cvt_pk_bf16_f32 v29, 0, v29
    v_mul_f32 v29, v29, v153
    v_cvt_pk_bf16_f32 v29, 0, v29
    v_add_f32 v30, v30, v54
    v_cvt_pk_bf16_f32 v30, 0, v30
    v_mul_f32 v30, v30, v153
    v_cvt_pk_bf16_f32 v30, 0, v30
    v_add_f32 v31, v31, v55
    v_cvt_pk_bf16_f32 v31, 0, v31
    v_mul_f32 v31, v31, v153
    v_cvt_pk_bf16_f32 v31, 0, v31
Q_nr:
    s_mov_b64 exec, s[68:69]
    s_waitcnt lgkmcnt(3)
    v_pk_add_f32 v[224:225], v[224:225], v[240:241]
    v_pk_add_f32 v[226:227], v[226:227], v[242:243]
    v_cvt_pk_bf16_f32 v40, v224, v225
    v_cvt_pk_bf16_f32 v41, v226, v227
    s_waitcnt lgkmcnt(2)
    v_pk_add_f32 v[228:229], v[228:229], v[244:245]
    v_pk_add_f32 v[230:231], v[230:231], v[246:247]
    v_cvt_pk_bf16_f32 v42, v228, v229
    v_cvt_pk_bf16_f32 v43, v230, v231
    s_waitcnt lgkmcnt(1)
    v_pk_add_f32 v[232:233], v[232:233], v[248:249]
    v_pk_add_f32 v[234:235], v[234:235], v[250:251]
    v_cvt_pk_bf16_f32 v44, v232, v233
    v_cvt_pk_bf16_f32 v45, v234, v235
    s_waitcnt lgkmcnt(0)
    v_pk_add_f32 v[236:237], v[236:237], v[252:253]
    v_pk_add_f32 v[238:239], v[238:239], v[254:255]
    v_cvt_pk_bf16_f32 v46, v236, v237
    v_cvt_pk_bf16_f32 v47, v238, v239
    s_nop 0
    v_permlane16_swap_b32 v40, v42
    v_permlane16_swap_b32 v41, v43
    v_permlane16_swap_b32 v44, v46
    v_permlane16_swap_b32 v45, v47
    v_lshlrev_b32 v224, 16, v40
    v_and_b32 v225, 0xffff0000, v40
    v_lshlrev_b32 v226, 16, v41
    v_and_b32 v227, 0xffff0000, v41
    v_lshlrev_b32 v228, 16, v42
    v_and_b32 v229, 0xffff0000, v42
    v_lshlrev_b32 v230, 16, v43
    v_and_b32 v231, 0xffff0000, v43
    v_pk_mul_f32 v[224:225], v[224:225], v[154:155]
    v_pk_mul_f32 v[226:227], v[226:227], v[154:155]
    v_pk_mul_f32 v[228:229], v[228:229], v[154:155]
    v_pk_mul_f32 v[230:231], v[230:231], v[154:155]
    v_cvt_pk_bf16_f32 v224, 0, v224
    v_cvt_pk_bf16_f32 v225, 0, v225
    v_cvt_pk_bf16_f32 v226, 0, v226
    v_cvt_pk_bf16_f32 v227, 0, v227
    v_cvt_pk_bf16_f32 v228, 0, v228
    v_cvt_pk_bf16_f32 v229, 0, v229
    v_cvt_pk_bf16_f32 v230, 0, v230
    v_cvt_pk_bf16_f32 v231, 0, v231
    v_pk_add_f32 v[224:225], v[224:225], v[16:17]
    v_pk_add_f32 v[226:227], v[226:227], v[18:19]
    v_pk_add_f32 v[228:229], v[228:229], v[20:21]
    v_pk_add_f32 v[230:231], v[230:231], v[22:23]
    v_cvt_pk_bf16_f32 v48, v224, v225
    v_cvt_pk_bf16_f32 v49, v226, v227
    v_cvt_pk_bf16_f32 v50, v228, v229
    v_cvt_pk_bf16_f32 v51, v230, v231
    buffer_store_dwordx4 v[48:51], v91, s[36:39], 0 offen offset:0 nt
    v_lshlrev_b32 v232, 16, v44
    v_and_b32 v233, 0xffff0000, v44
    v_lshlrev_b32 v234, 16, v45
    v_and_b32 v235, 0xffff0000, v45
    v_lshlrev_b32 v236, 16, v46
    v_and_b32 v237, 0xffff0000, v46
    v_lshlrev_b32 v238, 16, v47
    v_and_b32 v239, 0xffff0000, v47
    v_pk_mul_f32 v[232:233], v[232:233], v[154:155]
    v_pk_mul_f32 v[234:235], v[234:235], v[154:155]
    v_pk_mul_f32 v[236:237], v[236:237], v[154:155]
    v_pk_mul_f32 v[238:239], v[238:239], v[154:155]
    v_cvt_pk_bf16_f32 v232, 0, v232
    v_cvt_pk_bf16_f32 v233, 0, v233
    v_cvt_pk_bf16_f32 v234, 0, v234
    v_cvt_pk_bf16_f32 v235, 0, v235
    v_cvt_pk_bf16_f32 v236, 0, v236
    v_cvt_pk_bf16_f32 v237, 0, v237
    v_cvt_pk_bf16_f32 v238, 0, v238
    v_cvt_pk_bf16_f32 v239, 0, v239
    v_pk_add_f32 v[232:233], v[232:233], v[24:25]
    v_pk_add_f32 v[234:235], v[234:235], v[26:27]
    v_pk_add_f32 v[236:237], v[236:237], v[28:29]
    v_pk_add_f32 v[238:239], v[238:239], v[30:31]
    v_cvt_pk_bf16_f32 v52, v232, v233
    v_cvt_pk_bf16_f32 v53, v234, v235
    v_cvt_pk_bf16_f32 v54, v236, v237
    v_cvt_pk_bf16_f32 v55, v238, v239
    buffer_store_dwordx4 v[52:55], v91, s[36:39], 0 offen offset:64 nt
END:
    s_endpgm
Q_rt0:
    s_mov_b32 s59, 0
    s_add_u32 s67, s63, 0
    s_and_b32 s67, s67, 0x7fff
Q_rl0:
    s_waitcnt vmcnt(0)
    s_add_u32 s59, s59, 1
    s_cmp_ge_u32 s59, 200000
    s_cbranch_scc1 Q_rd0
    s_sleep 1
    buffer_load_dwordx4 v[96:99], v3, s[16:19], s67 offen offset:0 sc1
    buffer_load_dwordx4 v[100:103], v4, s[16:19], s67 offen offset:0 sc1
    buffer_load_dwordx4 v[104:107], v3, s[16:19], s67 offen offset:1024 sc1
    buffer_load_dwordx4 v[108:111], v4, s[16:19], s67 offen offset:1024 sc1
    s_waitcnt vmcnt(0)
    v_max3_u32 v5, v96, v97, v98
    v_max3_u32 v5, v5, v99, v100
    v_max3_u32 v5, v5, v101, v102
    v_max3_u32 v5, v5, v103, v104
    v_max3_u32 v5, v5, v105, v106
    v_max3_u32 v5, v5, v107, v108
    v_max3_u32 v5, v5, v109, v110
    v_max_u32 v5, v5, v111
    v_cmp_eq_u32 vcc, -1, v5
    s_cbranch_vccnz Q_rl0
Q_rd0:
    s_add_u32 s67, s63, 4096
    s_and_b32 s67, s67, 0x7fff
    buffer_load_dwordx4 v[112:115], v3, s[16:19], s67 offen offset:0 sc1
    buffer_load_dwordx4 v[116:119], v4, s[16:19], s67 offen offset:0 sc1
    buffer_load_dwordx4 v[120:123], v3, s[16:19], s67 offen offset:1024 sc1
    buffer_load_dwordx4 v[124:127], v4, s[16:19], s67 offen offset:1024 sc1
    s_branch Q_go0
Q_rt1:
    s_mov_b32 s59, 0
    s_add_u32 s67, s63, 4096
    s_and_b32 s67, s67, 0x7fff
Q_rl1:
    s_waitcnt vmcnt(0)
    s_add_u32 s59, s59, 1
    s_cmp_ge_u32 s59, 200000
    s_cbranch_scc1 Q_rd1
    s_sleep 1
    buffer_load_dwordx4 v[112:115], v3, s[16:19], s67 offen offset:0 sc1
    buffer_load_dwordx4 v[116:119], v4, s[16:19], s67 offen offset:0 sc1
    buffer_load_dwordx4 v[120:123], v3, s[16:19], s67 offen offset:1024 sc1
    buffer_load_dwordx4 v[124:127], v4, s[16:19], s67 offen offset:1024 sc1
    s_waitcnt vmcnt(0)
    v_max3_u32 v5, v112, v113, v114
    v_max3_u32 v5, v5, v115, v116
    v_max3_u32 v5, v5, v117, v118
    v_max3_u32 v5, v5, v119, v120
    v_max3_u32 v5, v5, v121, v122
    v_max3_u32 v5, v5, v123, v124
    v_max3_u32 v5, v5, v125, v126
    v_max_u32 v5, v5, v127
    v_cmp_eq_u32 vcc, -1, v5
    s_cbranch_vccnz Q_rl1
Q_rd1:
    s_add_u32 s67, s63, 8192
    s_and_b32 s67, s67, 0x7fff
    buffer_load_dwordx4 v[128:131], v3, s[16:19], s67 offen offset:0 sc1
    buffer_load_dwordx4 v[132:135], v4, s[16:19], s67 offen offset:0 sc1
    buffer_load_dwordx4 v[136:139], v3, s[16:19], s67 offen offset:1024 sc1
    buffer_load_dwordx4 v[140:143], v4, s[16:19], s67 offen offset:1024 sc1
    s_branch Q_go1
Q_rt2:
    s_mov_b32 s59, 0
    s_add_u32 s67, s63, 8192
    s_and_b32 s67, s67, 0x7fff
Q_rl2:
    s_waitcnt vmcnt(0)
    s_add_u32 s59, s59, 1
    s_cmp_ge_u32 s59, 200000
    s_cbranch_scc1 Q_rd2
    s_sleep 1
    buffer_load_dwordx4 v[128:131], v3, s[16:19], s67 offen offset:0 sc1
    buffer_load_dwordx4 v[132:135], v4, s[16:19], s67 offen offset:0 sc1
    buffer_load_dwordx4 v[136:139], v3, s[16:19], s67 offen offset:1024 sc1
    buffer_load_dwordx4 v[140:143], v4, s[16:19], s67 offen offset:1024 sc1
    s_waitcnt vmcnt(0)
    v_max3_u32 v5, v128, v129, v130
    v_max3_u32 v5, v5, v131, v132
    v_max3_u32 v5, v5, v133, v134
    v_max3_u32 v5, v5, v135, v136
    v_max3_u32 v5, v5, v137, v138
    v_max3_u32 v5, v5, v139, v140
    v_max3_u32 v5, v5, v141, v142
    v_max_u32 v5, v5, v143
    v_cmp_eq_u32 vcc, -1, v5
    s_cbranch_vccnz Q_rl2
Q_rd2:
    s_add_u32 s67, s63, 12288
    s_and_b32 s67, s67, 0x7fff
    buffer_load_dwordx4 v[96:99], v3, s[16:19], s67 offen offset:0 sc1
    buffer_load_dwordx4 v[100:103], v4, s[16:19], s67 offen offset:0 sc1
    buffer_load_dwordx4 v[104:107], v3, s[16:19], s67 offen offset:1024 sc1
    buffer_load_dwordx4 v[108:111], v4, s[16:19], s67 offen offset:1024 sc1
    s_branch Q_go2
Q_rt3:
    s_mov_b32 s59, 0
    s_add_u32 s67, s63, 12288
    s_and_b32 s67, s67, 0x7fff
Q_rl3:
    s_waitcnt vmcnt(0)
    s_add_u32 s59, s59, 1
    s_cmp_ge_u32 s59, 200000
    s_cbranch_scc1 Q_rd3
    s_sleep 1
    buffer_load_dwordx4 v[96:99], v3, s[16:19], s67 offen offset:0 sc1
    buffer_load_dwordx4 v[100:103], v4, s[16:19], s67 offen offset:0 sc1
    buffer_load_dwordx4 v[104:107], v3, s[16:19], s67 offen offset:1024 sc1
    buffer_load_dwordx4 v[108:111], v4, s[16:19], s67 offen offset:1024 sc1
    s_waitcnt vmcnt(0)
    v_max3_u32 v5, v96, v97, v98
    v_max3_u32 v5, v5, v99, v100
    v_max3_u32 v5, v5, v101, v102
    v_max3_u32 v5, v5, v103, v104
    v_max3_u32 v5, v5, v105, v106
    v_max3_u32 v5, v5, v107, v108
    v_max3_u32 v5, v5, v109, v110
    v_max_u32 v5, v5, v111
    v_cmp_eq_u32 vcc, -1, v5
    s_cbranch_vccnz Q_rl3
Q_rd3:
    s_add_u32 s67, s63, 16384
    s_and_b32 s67, s67, 0x7fff
    buffer_load_dwordx4 v[112:115], v3, s[16:19], s67 offen offset:0 sc1
    buffer_load_dwordx4 v[116:119], v4, s[16:19], s67 offen offset:0 sc1
    buffer_load_dwordx4 v[120:123], v3, s[16:19], s67 offen offset:1024 sc1
    buffer_load_dwordx4 v[124:127], v4, s[16:19], s67 offen offset:1024 sc1
    s_branch Q_go3
Q_rt4:
    s_mov_b32 s59, 0
    s_add_u32 s67, s63, 16384
    s_and_b32 s67, s67, 0x7fff
Q_rl4:
    s_waitcnt vmcnt(0)
    s_add_u32 s59, s59, 1
    s_cmp_ge_u32 s59, 200000
    s_cbranch_scc1 Q_rd4
    s_sleep 1
    buffer_load_dwordx4 v[112:115], v3, s[16:19], s67 offen offset:0 sc1
    buffer_load_dwordx4 v[116:119], v4, s[16:19], s67 offen offset:0 sc1
    buffer_load_dwordx4 v[120:123], v3, s[16:19], s67 offen offset:1024 sc1
    buffer_load_dwordx4 v[124:127], v4, s[16:19], s67 offen offset:1024 sc1
    s_waitcnt vmcnt(0)
    v_max3_u32 v5, v112, v113, v114
    v_max3_u32 v5, v5, v115, v116
    v_max3_u32 v5, v5, v117, v118
    v_max3_u32 v5, v5, v119, v120
    v_max3_u32 v5, v5, v121, v122
    v_max3_u32 v5, v5, v123, v124
    v_max3_u32 v5, v5, v125, v126
    v_max_u32 v5, v5, v127
    v_cmp_eq_u32 vcc, -1, v5
    s_cbranch_vccnz Q_rl4
Q_rd4:
    s_add_u32 s67, s63, 20480
    s_and_b32 s67, s67, 0x7fff
    buffer_load_dwordx4 v[128:131], v3, s[16:19], s67 offen offset:0 sc1
    buffer_load_dwordx4 v[132:135], v4, s[16:19], s67 offen offset:0 sc1
    buffer_load_dwordx4 v[136:139], v3, s[16:19], s67 offen offset:1024 sc1
    buffer_load_dwordx4 v[140:143], v4, s[16:19], s67 offen offset:1024 sc1
    s_branch Q_go4
Q_rt5:
    s_mov_b32 s59, 0
    s_add_u32 s67, s63, 20480
    s_and_b32 s67, s67, 0x7fff
Q_rl5:
    s_waitcnt vmcnt(0)
    s_add_u32 s59, s59, 1
    s_cmp_ge_u32 s59, 200000
    s_cbranch_scc1 Q_rd5
    s_sleep 1
    buffer_load_dwordx4 v[128:131], v3, s[16:19], s67 offen offset:0 sc1
    buffer_load_dwordx4 v[132:135], v4, s[16:19], s67 offen offset:0 sc1
    buffer_load_dwordx4 v[136:139], v3, s[16:19], s67 offen offset:1024 sc1
    buffer_load_dwordx4 v[140:143], v4, s[16:19], s67 offen offset:1024 sc1
    s_waitcnt vmcnt(0)
    v_max3_u32 v5, v128, v129, v130
    v_max3_u32 v5, v5, v131, v132
    v_max3_u32 v5, v5, v133, v134
    v_max3_u32 v5, v5, v135, v136
    v_max3_u32 v5, v5, v137, v138
    v_max3_u32 v5, v5, v139, v140
    v_max3_u32 v5, v5, v141, v142
    v_max_u32 v5, v5, v143
    v_cmp_eq_u32 vcc, -1, v5
    s_cbranch_vccnz Q_rl5
Q_rd5:
    s_add_u32 s67, s63, 24576
    s_and_b32 s67, s67, 0x7fff
    buffer_load_dwordx4 v[96:99], v3, s[16:19], s67 offen offset:0 sc1
    buffer_load_dwordx4 v[100:103], v4, s[16:19], s67 offen offset:0 sc1
    buffer_load_dwordx4 v[104:107], v3, s[16:19], s67 offen offset:1024 sc1
    buffer_load_dwordx4 v[108:111], v4, s[16:19], s67 offen offset:1024 sc1
    s_branch Q_go5
Q_rt6:
    s_mov_b32 s59, 0
    s_add_u32 s67, s63, 24576
    s_and_b32 s67, s67, 0x7fff
Q_rl6:
    s_waitcnt vmcnt(0)
    s_add_u32 s59, s59, 1
    s_cmp_ge_u32 s59, 200000
    s_cbranch_scc1 Q_rd6
    s_sleep 1
    buffer_load_dwordx4 v[96:99], v3, s[16:19], s67 offen offset:0 sc1
    buffer_load_dwordx4 v[100:103], v4, s[16:19], s67 offen offset:0 sc1
    buffer_load_dwordx4 v[104:107], v3, s[16:19], s67 offen offset:1024 sc1
    buffer_load_dwordx4 v[108:111], v4, s[16:19], s67 offen offset:1024 sc1
    s_waitcnt vmcnt(0)
    v_max3_u32 v5, v96, v97, v98
    v_max3_u32 v5, v5, v99, v100
    v_max3_u32 v5, v5, v101, v102
    v_max3_u32 v5, v5, v103, v104
    v_max3_u32 v5, v5, v105, v106
    v_max3_u32 v5, v5, v107, v108
    v_max3_u32 v5, v5, v109, v110
    v_max_u32 v5, v5, v111
    v_cmp_eq_u32 vcc, -1, v5
    s_cbranch_vccnz Q_rl6
Q_rd6:
    s_add_u32 s67, s63, 28672
    s_and_b32 s67, s67, 0x7fff
    buffer_load_dwordx4 v[112:115], v3, s[16:19], s67 offen offset:0 sc1
    buffer_load_dwordx4 v[116:119], v4, s[16:19], s67 offen offset:0 sc1
    buffer_load_dwordx4 v[120:123], v3, s[16:19], s67 offen offset:1024 sc1
    buffer_load_dwordx4 v[124:127], v4, s[16:19], s67 offen offset:1024 sc1
    s_branch Q_go6
Q_rt7:
    s_mov_b32 s59, 0
    s_add_u32 s67, s63, 28672
    s_and_b32 s67, s67, 0x7fff
Q_rl7:
    s_waitcnt vmcnt(0)
    s_add_u32 s59, s59, 1
    s_cmp_ge_u32 s59, 200000
    s_cbranch_scc1 Q_rd7
    s_sleep 1
    buffer_load_dwordx4 v[112:115], v3, s[16:19], s67 offen offset:0 sc1
    buffer_load_dwordx4 v[116:119], v4, s[16:19], s67 offen offset:0 sc1
    buffer_load_dwordx4 v[120:123], v3, s[16:19], s67 offen offset:1024 sc1
    buffer_load_dwordx4 v[124:127], v4, s[16:19], s67 offen offset:1024 sc1
    s_waitcnt vmcnt(0)
    v_max3_u32 v5, v112, v113, v114
    v_max3_u32 v5, v5, v115, v116
    v_max3_u32 v5, v5, v117, v118
    v_max3_u32 v5, v5, v119, v120
    v_max3_u32 v5, v5, v121, v122
    v_max3_u32 v5, v5, v123, v124
    v_max3_u32 v5, v5, v125, v126
    v_max_u32 v5, v5, v127
    v_cmp_eq_u32 vcc, -1, v5
    s_cbranch_vccnz Q_rl7
Q_rd7:
    s_branch Q_go7
H_eps:
    v_lshlrev_b32 v72, 16, v32
    v_and_b32 v73, 0xffff0000, v32
    v_add_f32 v72, s47, v72
    v_add_f32 v73, s47, v73
    v_cvt_pk_bf16_f32 v32, v72, v73
    v_lshlrev_b32 v72, 16, v33
    v_and_b32 v73, 0xffff0000, v33
    v_add_f32 v72, s47, v72
    v_add_f32 v73, s47, v73
    v_cvt_pk_bf16_f32 v33, v72, v73
    v_lshlrev_b32 v72, 16, v34
    v_and_b32 v73, 0xffff0000, v34
    v_add_f32 v72, s47, v72
    v_add_f32 v73, s47, v73
    v_cvt_pk_bf16_f32 v34, v72, v73
    v_lshlrev_b32 v72, 16, v35
    v_and_b32 v73, 0xffff0000, v35
    v_add_f32 v72, s47, v72
    v_add_f32 v73, s47, v73
    v_cvt_pk_bf16_f32 v35, v72, v73
    v_lshlrev_b32 v72, 16, v36
    v_and_b32 v73, 0xffff0000, v36
    v_add_f32 v72, s47, v72
    v_add_f32 v73, s47, v73
    v_cvt_pk_bf16_f32 v36, v72, v73
    v_lshlrev_b32 v72, 16, v37
    v_and_b32 v73, 0xffff0000, v37
    v_add_f32 v72, s47, v72
    v_add_f32 v73, s47, v73
    v_cvt_pk_bf16_f32 v37, v72, v73
    v_lshlrev_b32 v72, 16, v38
    v_and_b32 v73, 0xffff0000, v38
    v_add_f32 v72, s47, v72
    v_add_f32 v73, s47, v73
    v_cvt_pk_bf16_f32 v38, v72, v73
    v_lshlrev_b32 v72, 16, v39
    v_and_b32 v73, 0xffff0000, v39
    v_add_f32 v72, s47, v72
    v_add_f32 v73, s47, v73
    v_cvt_pk_bf16_f32 v39, v72, v73
    v_lshlrev_b32 v72, 16, v40
    v_and_b32 v73, 0xffff0000, v40
    v_add_f32 v72, s47, v72
    v_add_f32 v73, s47, v73
    v_cvt_pk_bf16_f32 v40, v72, v73
    v_lshlrev_b32 v72, 16, v41
    v_and_b32 v73, 0xffff0000, v41
    v_add_f32 v72, s47, v72
    v_add_f32 v73, s47, v73
    v_cvt_pk_bf16_f32 v41, v72, v73
    v_lshlrev_b32 v72, 16, v42
    v_and_b32 v73, 0xffff0000, v42
    v_add_f32 v72, s47, v72
    v_add_f32 v73, s47, v73
    v_cvt_pk_bf16_f32 v42, v72, v73
    v_lshlrev_b32 v72, 16, v43
    v_and_b32 v73, 0xffff0000, v43
    v_add_f32 v72, s47, v72
    v_add_f32 v73, s47, v73
    v_cvt_pk_bf16_f32 v43, v72, v73
    v_lshlrev_b32 v72, 16, v44
    v_and_b32 v73, 0xffff0000, v44
    v_add_f32 v72, s47, v72
    v_add_f32 v73, s47, v73
    v_cvt_pk_bf16_f32 v44, v72, v73
    v_lshlrev_b32 v72, 16, v45
    v_and_b32 v73, 0xffff0000, v45
    v_add_f32 v72, s47, v72
    v_add_f32 v73, s47, v73
    v_cvt_pk_bf16_f32 v45, v72, v73
    v_lshlrev_b32 v72, 16, v46
    v_and_b32 v73, 0xffff0000, v46
    v_add_f32 v72, s47, v72
    v_add_f32 v73, s47, v73
    v_cvt_pk_bf16_f32 v46, v72, v73
    v_lshlrev_b32 v72, 16, v47
    v_and_b32 v73, 0xffff0000, v47
    v_add_f32 v72, s47, v72
    v_add_f32 v73, s47, v73
    v_cvt_pk_bf16_f32 v47, v72, v73
    s_nop 1
    v_mfma_f32_16x16x32_bf16 v[200:203], v[32:35], v[204:207], 0
    s_waitcnt lgkmcnt(7)
    v_mfma_f32_16x16x32_bf16 v[192:195], v[32:35], v[208:211], 0
    s_waitcnt lgkmcnt(6)
    v_mfma_f32_16x16x32_bf16 v[196:199], v[32:35], v[212:215], 0
    v_mfma_f32_16x16x32_bf16 v[200:203], v[36:39], v[204:207], v[200:203]
    s_waitcnt lgkmcnt(5)
    v_mfma_f32_16x16x32_bf16 v[192:195], v[36:39], v[216:219], v[192:195]
    s_waitcnt lgkmcnt(4)
    v_mfma_f32_16x16x32_bf16 v[196:199], v[36:39], v[220:223], v[196:199]
    v_mfma_f32_16x16x32_bf16 v[200:203], v[40:43], v[204:207], v[200:203]
    s_waitcnt lgkmcnt(3)
    v_mfma_f32_16x16x32_bf16 v[192:195], v[40:43], v[224:227], v[192:195]
    s_waitcnt lgkmcnt(2)
    v_mfma_f32_16x16x32_bf16 v[196:199], v[40:43], v[228:231], v[196:199]
    v_mfma_f32_16x16x32_bf16 v[200:203], v[44:47], v[204:207], v[200:203]
    s_waitcnt lgkmcnt(1)
    v_mfma_f32_16x16x32_bf16 v[192:195], v[44:47], v[232:235], v[192:195]
    s_waitcnt lgkmcnt(0)
    v_mfma_f32_16x16x32_bf16 v[196:199], v[44:47], v[236:239], v[196:199]
    s_branch H_ne
CODE_END:
.section .rodata,"a"
.p2align 6
.amdhsa_kernel gated_mix__linear_attn_block__moe_arch_mod__prompt_kernel
  .amdhsa_next_free_vgpr 256
  .amdhsa_next_free_sgpr 102
  .amdhsa_accum_offset 256
  .amdhsa_group_segment_fixed_size 0
  .amdhsa_kernarg_size 96
  .amdhsa_user_sgpr_count 2
  .amdhsa_user_sgpr_kernarg_segment_ptr 1
  .amdhsa_system_sgpr_workgroup_id_x 1
.end_amdhsa_kernel
```

```asm
; @launch grid=(256,1,1) block=(512,1,1) lds=163840
.amdgcn_target "amdgcn-amd-amdhsa--gfx950"
.text
.globl gated_mix__linear_attn_block__moe_arch_mod__prompt_kernel
.p2align 8
.type gated_mix__linear_attn_block__moe_arch_mod__prompt_kernel,@function
gated_mix__linear_attn_block__moe_arch_mod__prompt_kernel:
    s_load_dwordx2 s[12:13], s[0:1], 8
    s_load_dwordx2 s[8:9], s[0:1], 0
    s_getpc_b64 s[64:65]
PC0:
    v_min_u32 v1, 15, v0
    v_lshlrev_b32 v1, 6, v1
    global_load_dword v246, v1, s[64:65]
    s_cmp_ge_u32 s2, 256
    s_cbranch_scc1 END
    v_lshrrev_b32 v1, 6, v0
    v_and_b32 v2, 63, v0
    s_load_dwordx8 s[48:55], s[0:1], 32
    v_readfirstlane_b32 s3, v1
    s_load_dwordx8 s[56:63], s[0:1], 64
    s_load_dwordx2 s[20:21], s[0:1], 16
    s_and_b32 s66, s2, 0xf8
    v_and_b32 v1, 31, v0
    v_lshl_add_u32 v1, s66, 2, v1
    v_lshlrev_b32 v1, 6, v1
    v_min_u32 v1, CODE_END-PC0-4, v1
    global_load_dword v247, v1, s[64:65]
    s_and_b32 s64, s2, 7
    s_lshr_b32 s65, s2, 3
    s_and_b32 s44, s3, 3
    s_lshr_b32 s45, s3, 2
    s_and_b32 s66, s64, 6
    s_lshl_b32 s5, s66, 1
    s_add_u32 s76, s66, s65
    s_lshl_b32 s76, s76, 1
    s_lshr_b32 s66, s65, 3
    s_add_u32 s5, s5, s66
    v_lshrrev_b32 v6, 3, v2
    v_lshl_add_u32 v6, s44, 3, v6
    v_lshrrev_b32 v8, 4, v2
    v_and_b32 v10, 7, v2
    s_and_b32 s67, s44, 1
    v_mul_u32_u24 v7, 6144, v6
    v_and_b32 v9, 1, v8
    v_lshl_add_u32 v9, v9, 1, s67
    v_lshlrev_b32 v9, 1, v9
    v_xor_b32 v9, v9, v10
    v_lshl_add_u32 v7, v9, 4, v7
    v_lshl_add_u32 v5, s5, 7, v7
    s_mov_b32 s14, 0x600000
    s_mov_b32 s15, 0x00020000
    s_lshl_b32 s72, s44, 10
    s_lshl_b32 s66, s45, 12
    s_add_u32 s69, s72, s66
    s_add_u32 s68, s69, s66
    s_sub_u32 s77, s5, s76
    s_and_b32 s77, s77, 15
    s_cmp_le_u32 s77, 0
    s_addc_u32 s70, s76, 0
    s_and_b32 s70, s70, 15
    s_lshl_b32 s71, s70, 1
    s_add_u32 s71, s71, s45
    s_mul_i32 s71, s71, 196608
    s_waitcnt lgkmcnt(0)
    s_add_u32 m0, s69, 24576
    s_add_u32 s66, s71, 2048
    buffer_load_dwordx4 v5, s[12:15], s66 offen lds
    s_add_u32 m0, s69, 32768
    s_add_u32 s66, s71, 4096
    buffer_load_dwordx4 v5, s[12:15], s66 offen lds
    s_add_u32 m0, s69, 16384
    s_add_u32 s66, s71, 0
    buffer_load_dwordx4 v5, s[12:15], s66 offen lds
    s_and_b32 s4, s64, 1
    s_lshl_b32 s4, s4, 3
    s_and_b32 s66, s65, 7
    s_add_u32 s4, s4, s66
    v_lshl_add_u32 v7, s4, 7, v6
    v_lshlrev_b32 v7, 11, v7
    v_lshl_add_u32 v9, s67, 2, v8
    v_xor_b32 v9, v9, v10
    v_lshl_add_u32 v4, v9, 4, v7
    s_mov_b32 s10, 0x400000
    s_mov_b32 s11, 0x00020000
    s_lshl_b32 s70, s70, 7
    s_lshl_b32 s66, s45, 17
    s_add_u32 s70, s70, s66
    s_add_u32 m0, s68, 0
    s_add_u32 s66, s70, 0
    buffer_load_dwordx4 v4, s[8:11], s66 offen lds
    s_add_u32 m0, s68, 4096
    s_add_u32 s66, s70, 65536
    buffer_load_dwordx4 v4, s[8:11], s66 offen lds
    s_barrier
    s_cmp_le_u32 s77, 1
    s_addc_u32 s70, s76, 1
    s_and_b32 s70, s70, 15
    s_lshl_b32 s71, s70, 1
    s_add_u32 s71, s71, s45
    s_mul_i32 s71, s71, 196608
    s_add_u32 m0, s69, 65536
    s_add_u32 s66, s71, 2048
    buffer_load_dwordx4 v5, s[12:15], s66 offen lds
    s_add_u32 m0, s69, 73728
    s_add_u32 s66, s71, 4096
    buffer_load_dwordx4 v5, s[12:15], s66 offen lds
    s_add_u32 m0, s69, 57344
    s_add_u32 s66, s71, 0
    buffer_load_dwordx4 v5, s[12:15], s66 offen lds
    s_lshl_b32 s70, s70, 7
    s_lshl_b32 s66, s45, 17
    s_add_u32 s70, s70, s66
    s_add_u32 m0, s68, 40960
    s_add_u32 s66, s70, 0
    buffer_load_dwordx4 v4, s[8:11], s66 offen lds
    s_add_u32 m0, s68, 45056
    s_add_u32 s66, s70, 65536
    buffer_load_dwordx4 v4, s[8:11], s66 offen lds
    s_mov_b32 s16, s62
    s_mov_b32 s17, s63
    s_mov_b32 s32, s54
    s_mov_b32 s33, s55
    s_mov_b32 s36, s58
    s_mov_b32 s37, s59
    s_mov_b32 s40, s60
    s_mov_b32 s41, s61
    s_mov_b32 s18, 0x10000000
    s_mov_b32 s19, 0x00020000
    s_mov_b32 s34, 0x700000
    s_mov_b32 s35, 0x00020000
    s_mov_b32 s38, 0x400000
    s_mov_b32 s39, 0x00020000
    s_mov_b32 s42, 0x100
    s_mov_b32 s43, 0x00020000
    s_mov_b32 s22, 0x200000
    s_mov_b32 s23, 0x00020000
    s_bitcmp0_b32 s44, 0
    s_cselect_b32 s24, s48, s56
    s_cselect_b32 s25, s49, s57
    s_mov_b32 s26, 0x800
    s_mov_b32 s27, 0x00020000
    s_bitcmp0_b32 s44, 0
    s_cselect_b32 s28, s50, s52
    s_cselect_b32 s29, s51, s53
    s_mov_b32 s30, 0x700000
    s_mov_b32 s31, 0x00020000
    s_lshr_b32 s66, s64, 2
    s_lshl_b32 s66, s66, 1
    s_and_b32 s67, s64, 1
    s_add_u32 s66, s66, s67
    s_lshl_b32 s67, s65, 2
    s_add_u32 s66, s66, s67
    s_add_u32 s66, s66, 96
    s_bitcmp0_b32 s64, 1
    s_cselect_b32 s67, 32, 0
    s_add_u32 s66, s66, s67
    s_cmp_lt_u32 s65, 24
    s_cselect_b32 s67, s2, s66
    s_cmp_ge_u32 s67, 224
    s_cselect_b32 s30, 0, s30
    s_cselect_b32 s34, 0, s34
    s_lshr_b32 s79, s67, 2
    s_and_b32 s73, s67, 3
    s_and_b32 s6, s64, 3
    s_lshl_b32 s6, s6, 2
    s_and_b32 s66, s65, 3
    s_add_u32 s6, s6, s66
    s_lshr_b32 s7, s64, 2
    s_lshl_b32 s7, s7, 3
    s_lshr_b32 s66, s65, 2
    s_add_u32 s7, s7, s66
    s_mov_b32 s6, s4
    s_mov_b32 s7, s5
    s_mov_b32 s46, 0x3fb8aa3b
    s_mov_b32 s47, 0x358637bd
    s_cmp_ge_u32 s3, 4
    s_cbranch_scc1 HELP
    s_and_b32 s48, s3, 1
    s_lshr_b32 s49, s3, 1
    v_and_b32 v3, 15, v2
    s_lshl_b32 s66, s48, 6
    v_add_u32 v3, s66, v3
    v_lshlrev_b32 v3, 7, v3
    v_bfe_u32 v9, v2, 1, 3
    v_lshrrev_b32 v15, 4, v2
    v_xor_b32 v9, v9, v15
    v_xor_b32 v12, 0, v9
    v_lshl_add_u32 v4, v12, 4, v3
    v_xor_b32 v12, 4, v9
    v_lshl_add_u32 v5, v12, 4, v3
    v_bfe_u32 v12, v2, 2, 2
    v_lshl_add_u32 v13, v15, 3, v12
    v_lshlrev_b32 v13, 7, v13
    v_lshrrev_b32 v12, 1, v12
    v_xor_b32 v12, s49, v12
    v_lshl_add_u32 v13, v12, 6, v13
    v_and_b32 v12, 3, v2
    v_lshl_add_u32 v13, v12, 3, v13
    v_add_u32 v13, 16384, v13
    v_and_b32 v12, 1, v15
    v_xor_b32 v14, 0, v12
    v_lshl_add_u32 v6, v14, 5, v13
    v_xor_b32 v14, 1, v12
    v_lshl_add_u32 v7, v14, 5, v13
    v_mov_b32 v8, v4
    v_mov_b32 v9, v5
    v_mov_b32 v10, v6
    v_mov_b32 v11, v7
    v_mov_b32 v96, 0
    v_mov_b32 v97, 0
    v_mov_b32 v98, 0
    v_mov_b32 v99, 0
    v_mov_b32 v100, 0
    v_mov_b32 v101, 0
    v_mov_b32 v102, 0
    v_mov_b32 v103, 0
    v_mov_b32 v104, 0
    v_mov_b32 v105, 0
    v_mov_b32 v106, 0
    v_mov_b32 v107, 0
    v_mov_b32 v108, 0
    v_mov_b32 v109, 0
    v_mov_b32 v110, 0
    v_mov_b32 v111, 0
    v_mov_b32 v112, 0
    v_mov_b32 v113, 0
    v_mov_b32 v114, 0
    v_mov_b32 v115, 0
    v_mov_b32 v116, 0
    v_mov_b32 v117, 0
    v_mov_b32 v118, 0
    v_mov_b32 v119, 0
    v_mov_b32 v120, 0
    v_mov_b32 v121, 0
    v_mov_b32 v122, 0
    v_mov_b32 v123, 0
    v_mov_b32 v124, 0
    v_mov_b32 v125, 0
    v_mov_b32 v126, 0
    v_mov_b32 v127, 0
    v_mov_b32 v128, 0
    v_mov_b32 v129, 0
    v_mov_b32 v130, 0
    v_mov_b32 v131, 0
    v_mov_b32 v132, 0
    v_mov_b32 v133, 0
    v_mov_b32 v134, 0
    v_mov_b32 v135, 0
    v_mov_b32 v136, 0
    v_mov_b32 v137, 0
    v_mov_b32 v138, 0
    v_mov_b32 v139, 0
    v_mov_b32 v140, 0
    v_mov_b32 v141, 0
    v_mov_b32 v142, 0
    v_mov_b32 v143, 0
    v_mov_b32 v144, 0
    v_mov_b32 v145, 0
    v_mov_b32 v146, 0
    v_mov_b32 v147, 0
    v_mov_b32 v148, 0
    v_mov_b32 v149, 0
    v_mov_b32 v150, 0
    v_mov_b32 v151, 0
    v_mov_b32 v152, 0
    v_mov_b32 v153, 0
    v_mov_b32 v154, 0
    v_mov_b32 v155, 0
    v_mov_b32 v156, 0
    v_mov_b32 v157, 0
    v_mov_b32 v158, 0
    v_mov_b32 v159, 0
    v_mov_b32 v160, 0
    v_mov_b32 v161, 0
    v_mov_b32 v162, 0
    v_mov_b32 v163, 0
    v_mov_b32 v164, 0
    v_mov_b32 v165, 0
    v_mov_b32 v166, 0
    v_mov_b32 v167, 0
    v_mov_b32 v168, 0
    v_mov_b32 v169, 0
    v_mov_b32 v170, 0
    v_mov_b32 v171, 0
    v_mov_b32 v172, 0
    v_mov_b32 v173, 0
    v_mov_b32 v174, 0
    v_mov_b32 v175, 0
    v_mov_b32 v176, 0
    v_mov_b32 v177, 0
    v_mov_b32 v178, 0
    v_mov_b32 v179, 0
    v_mov_b32 v180, 0
    v_mov_b32 v181, 0
    v_mov_b32 v182, 0
    v_mov_b32 v183, 0
    v_mov_b32 v184, 0
    v_mov_b32 v185, 0
    v_mov_b32 v186, 0
    v_mov_b32 v187, 0
    v_mov_b32 v188, 0
    v_mov_b32 v189, 0
    v_mov_b32 v190, 0
    v_mov_b32 v191, 0
    v_lshlrev_b32 v12, 2, v2
    v_and_b32 v12, 63, v12
    v_add_u32 v12, 155648, v12
    ds_write_b32 v12, v96
    s_mov_b32 s70, 0x3fb8aa3b
    s_mov_b32 s71, 0x3fb8aa3b
    v_lshrrev_b32 v12, 3, v2
    s_lshl_b32 s67, s44, 3
    v_add_u32 v12, s67, v12
    v_lshlrev_b32 v12, 11, v12
    v_lshrrev_b32 v13, 4, v2
    v_lshlrev_b32 v13, 1, v13
    v_and_b32 v250, 7, v2
    v_xor_b32 v13, v13, v250
    v_lshl_add_u32 v12, v13, 4, v12
    s_lshl_b32 s66, s7, 7
    v_add_u32 v250, s66, v12
    s_lshl_b32 s66, s6, 7
    s_lshl_b32 s67, s44, 5
    s_add_u32 s66, s66, s67
    s_lshl_b32 s67, s45, 4
    s_add_u32 s66, s66, s67
    v_and_b32 v252, 15, v2
    v_add_u32 v252, s66, v252
    v_lshlrev_b32 v251, 11, v252
    v_bfe_u32 v12, v2, 4, 1
    v_lshl_add_u32 v251, v12, 5, v251
    v_lshrrev_b32 v12, 5, v2
    v_lshl_add_u32 v251, v12, 4, v251
    s_lshl_b32 s66, s7, 7
    v_add_u32 v251, s66, v251
    v_lshrrev_b32 v253, 2, v252
    v_lshlrev_b32 v253, 6, v253
    v_and_b32 v12, 3, v2
    v_lshl_add_u32 v253, v12, 2, v253
    s_lshl_b32 s66, s6, 1
    s_and_b32 s66, s66, 6
    s_lshl_b32 s67, s7, 3
    s_add_u32 s66, s66, s67
    s_and_b32 s66, s66, 7
    s_lshl_b32 s52, s66, 18
    s_lshr_b32 s49, s44, 1
    s_and_b32 s66, s44, 1
    s_lshl_b32 s66, s66, 2
    s_lshl_b32 s67, s45, 1
    s_add_u32 s66, s66, s67
    s_lshl_b32 s67, s4, 3
    s_add_u32 s66, s66, s67
    s_lshl_b32 s66, s66, 5
    s_lshl_b32 s67, s5, 1
    s_add_u32 s66, s66, s67
    s_add_u32 s66, s66, s49
    s_lshl_b32 s60, s66, 10
    s_add_u32 s61, s60, 32768
    s_lshl_b32 s58, s5, 2
    s_add_u32 s58, s58, s44
    s_lshl_b32 s66, s58, 14
    s_add_u32 s66, s66, 4194304
    v_lshlrev_b32 v12, 4, v2
    v_add_u32 v248, s66, v12
    s_lshl_b32 s66, s58, 10
    s_add_u32 s66, s66, 5242880
    v_and_b32 v12, 15, v2
    v_lshlrev_b32 v12, 6, v12
    v_lshrrev_b32 v13, 4, v2
    v_lshl_add_u32 v12, v13, 4, v12
    v_add_u32 v249, s66, v12
    s_lshr_b32 s57, s4, 3
    s_xor_b32 s57, s57, s4
    s_and_b32 s57, s57, 1
    s_lshl_b32 s57, s57, 13
    v_bfe_u32 v12, v2, 2, 2
    v_cmp_eq_u32 vcc, v12, v13
    v_mov_b32 v13, 0x3f80
    v_and_b32 v12, 1, v2
    v_lshlrev_b32 v12, 4, v12
    v_lshlrev_b32 v12, v12, v13
    v_cndmask_b32 v12, 0, v12, vcc
    v_and_b32 v13, 2, v2
    v_cmp_eq_u32 vcc, 0, v13
    s_nop 1
    v_cndmask_b32 v254, 0, v12, vcc
    v_cndmask_b32 v255, v12, 0, vcc
    s_mov_b32 s50, 0
    s_mov_b32 s51, 0
    s_waitcnt vmcnt(5) lgkmcnt(0)
    s_barrier
    ds_read_b64_tr_b16 v[32:33], v10 offset:0
    ds_read_b64_tr_b16 v[34:35], v10 offset:512
    ds_read_b128 v[16:19], v8 offset:0
    ds_read_b128 v[20:23], v8 offset:2048
    ds_read_b128 v[24:27], v8 offset:4096
    ds_read_b128 v[28:31], v8 offset:6144
    ds_read_b64_tr_b16 v[36:37], v11 offset:0
    ds_read_b64_tr_b16 v[38:39], v11 offset:512
    ds_read_b64_tr_b16 v[40:41], v10 offset:8192
    ds_read_b64_tr_b16 v[42:43], v10 offset:8704
    ds_read_b64_tr_b16 v[44:45], v11 offset:8192
    ds_read_b64_tr_b16 v[46:47], v11 offset:8704
    ds_read_b64_tr_b16 v[48:49], v10 offset:16384
    ds_read_b64_tr_b16 v[50:51], v10 offset:16896
    ds_read_b64_tr_b16 v[52:53], v11 offset:16384
    ds_read_b64_tr_b16 v[54:55], v11 offset:16896
.p2align 6
LOOP:
    s_waitcnt lgkmcnt(13)
    v_mfma_f32_16x16x32_bf16 v[96:99], v[32:35], v[16:19], v[96:99]
    ds_read_b64_tr_b16 v[72:73], v10 offset:4096
    s_waitcnt lgkmcnt(13)
    v_mfma_f32_16x16x32_bf16 v[104:107], v[32:35], v[20:23], v[104:107]
    ds_read_b64_tr_b16 v[74:75], v10 offset:4608
    s_waitcnt lgkmcnt(13)
    v_mfma_f32_16x16x32_bf16 v[112:115], v[32:35], v[24:27], v[112:115]
    ds_read_b128 v[56:59], v9 offset:0
    s_waitcnt lgkmcnt(13)
    v_mfma_f32_16x16x32_bf16 v[120:123], v[32:35], v[28:31], v[120:123]
    ds_read_b128 v[60:63], v9 offset:2048
    s_waitcnt lgkmcnt(12)
    v_mfma_f32_16x16x32_bf16 v[124:127], v[36:39], v[28:31], v[124:127]
    ds_read_b128 v[64:67], v9 offset:4096
    v_mfma_f32_16x16x32_bf16 v[116:119], v[36:39], v[24:27], v[116:119]
    ds_read_b128 v[68:71], v9 offset:6144
    v_mfma_f32_16x16x32_bf16 v[108:111], v[36:39], v[20:23], v[108:111]
    ds_read_b64_tr_b16 v[76:77], v11 offset:4096
    v_mfma_f32_16x16x32_bf16 v[100:103], v[36:39], v[16:19], v[100:103]
    ds_read_b64_tr_b16 v[78:79], v11 offset:4608
    s_waitcnt lgkmcnt(14)
    v_mfma_f32_16x16x32_bf16 v[128:131], v[16:19], v[40:43], v[128:131]
    ds_read_b64_tr_b16 v[80:81], v10 offset:12288
    v_mfma_f32_16x16x32_bf16 v[136:139], v[20:23], v[40:43], v[136:139]
    ds_read_b64_tr_b16 v[82:83], v10 offset:12800
    v_mfma_f32_16x16x32_bf16 v[144:147], v[24:27], v[40:43], v[144:147]
    ds_read_b64_tr_b16 v[84:85], v11 offset:12288
    v_mfma_f32_16x16x32_bf16 v[152:155], v[28:31], v[40:43], v[152:155]
    ds_read_b64_tr_b16 v[86:87], v11 offset:12800
    s_waitcnt lgkmcnt(15)
    v_mfma_f32_16x16x32_bf16 v[156:159], v[28:31], v[44:47], v[156:159]
    ds_read_b64_tr_b16 v[88:89], v10 offset:20480
    v_mfma_f32_16x16x32_bf16 v[148:151], v[24:27], v[44:47], v[148:151]
    ds_read_b64_tr_b16 v[90:91], v10 offset:20992
    v_mfma_f32_16x16x32_bf16 v[140:143], v[20:23], v[44:47], v[140:143]
    ds_read_b64_tr_b16 v[92:93], v11 offset:20480
    v_mfma_f32_16x16x32_bf16 v[132:135], v[16:19], v[44:47], v[132:135]
    ds_read_b64_tr_b16 v[94:95], v11 offset:20992
    s_waitcnt lgkmcnt(15)
    v_mfma_f32_16x16x32_bf16 v[160:163], v[16:19], v[48:51], v[160:163]
    v_mfma_f32_16x16x32_bf16 v[168:171], v[20:23], v[48:51], v[168:171]
    v_mfma_f32_16x16x32_bf16 v[176:179], v[24:27], v[48:51], v[176:179]
    v_mfma_f32_16x16x32_bf16 v[184:187], v[28:31], v[48:51], v[184:187]
    s_waitcnt lgkmcnt(15)
    v_mfma_f32_16x16x32_bf16 v[188:191], v[28:31], v[52:55], v[188:191]
    v_mfma_f32_16x16x32_bf16 v[180:183], v[24:27], v[52:55], v[180:183]
    v_mfma_f32_16x16x32_bf16 v[172:175], v[20:23], v[52:55], v[172:175]
    v_mfma_f32_16x16x32_bf16 v[164:167], v[16:19], v[52:55], v[164:167]
    s_waitcnt lgkmcnt(13)
    v_mfma_f32_16x16x32_bf16 v[96:99], v[72:75], v[56:59], v[96:99]
    s_add_u32 s50, s50, 40960
    s_cmp_eq_u32 s50, 122880
    s_cselect_b32 s50, 0, s50
    s_waitcnt lgkmcnt(12)
    v_mfma_f32_16x16x32_bf16 v[104:107], v[72:75], v[60:63], v[104:107]
    v_add_u32 v8, s50, v4
    s_waitcnt lgkmcnt(11)
    v_mfma_f32_16x16x32_bf16 v[112:115], v[72:75], v[64:67], v[112:115]
    v_add_u32 v9, s50, v5
    s_waitcnt lgkmcnt(10)
    v_mfma_f32_16x16x32_bf16 v[120:123], v[72:75], v[68:71], v[120:123]
    v_add_u32 v10, s50, v6
    s_waitcnt lgkmcnt(8)
    v_mfma_f32_16x16x32_bf16 v[124:127], v[76:79], v[68:71], v[124:127]
    v_add_u32 v11, s50, v7
    v_mfma_f32_16x16x32_bf16 v[116:119], v[76:79], v[64:67], v[116:119]
    s_waitcnt vmcnt(0) lgkmcnt(0)
    s_barrier
    v_mfma_f32_16x16x32_bf16 v[108:111], v[76:79], v[60:63], v[108:111]
    ds_read_b64_tr_b16 v[32:33], v10 offset:0
    v_mfma_f32_16x16x32_bf16 v[100:103], v[76:79], v[56:59], v[100:103]
    ds_read_b64_tr_b16 v[34:35], v10 offset:512
    v_mfma_f32_16x16x32_bf16 v[128:131], v[56:59], v[80:83], v[128:131]
    ds_read_b128 v[16:19], v8 offset:0
    v_mfma_f32_16x16x32_bf16 v[136:139], v[60:63], v[80:83], v[136:139]
    ds_read_b128 v[20:23], v8 offset:2048
    v_mfma_f32_16x16x32_bf16 v[144:147], v[64:67], v[80:83], v[144:147]
    ds_read_b128 v[24:27], v8 offset:4096
    v_mfma_f32_16x16x32_bf16 v[152:155], v[68:71], v[80:83], v[152:155]
    ds_read_b128 v[28:31], v8 offset:6144
    v_mfma_f32_16x16x32_bf16 v[156:159], v[68:71], v[84:87], v[156:159]
    ds_read_b64_tr_b16 v[36:37], v11 offset:0
    v_mfma_f32_16x16x32_bf16 v[148:151], v[64:67], v[84:87], v[148:151]
    ds_read_b64_tr_b16 v[38:39], v11 offset:512
    v_mfma_f32_16x16x32_bf16 v[140:143], v[60:63], v[84:87], v[140:143]
    ds_read_b64_tr_b16 v[40:41], v10 offset:8192
    v_mfma_f32_16x16x32_bf16 v[132:135], v[56:59], v[84:87], v[132:135]
    ds_read_b64_tr_b16 v[42:43], v10 offset:8704
    v_mfma_f32_16x16x32_bf16 v[160:163], v[56:59], v[88:91], v[160:163]
    ds_read_b64_tr_b16 v[44:45], v11 offset:8192
    v_mfma_f32_16x16x32_bf16 v[168:171], v[60:63], v[88:91], v[168:171]
    ds_read_b64_tr_b16 v[46:47], v11 offset:8704
    v_mfma_f32_16x16x32_bf16 v[176:179], v[64:67], v[88:91], v[176:179]
    ds_read_b64_tr_b16 v[48:49], v10 offset:16384
    v_mfma_f32_16x16x32_bf16 v[184:187], v[68:71], v[88:91], v[184:187]
    ds_read_b64_tr_b16 v[50:51], v10 offset:16896
    v_mfma_f32_16x16x32_bf16 v[188:191], v[68:71], v[92:95], v[188:191]
    ds_read_b64_tr_b16 v[52:53], v11 offset:16384
    v_mfma_f32_16x16x32_bf16 v[180:183], v[64:67], v[92:95], v[180:183]
    ds_read_b64_tr_b16 v[54:55], v11 offset:16896
    v_mfma_f32_16x16x32_bf16 v[172:175], v[60:63], v[92:95], v[172:175]
    v_mfma_f32_16x16x32_bf16 v[164:167], v[56:59], v[92:95], v[164:167]
    s_add_u32 s51, s51, 1
    s_cmp_lt_u32 s51, 13
    s_cbranch_scc1 LOOP
    s_waitcnt lgkmcnt(13)
    v_mfma_f32_16x16x32_bf16 v[96:99], v[32:35], v[16:19], v[96:99]
    ds_read_b64_tr_b16 v[72:73], v10 offset:12288
    v_add_u32 v12, 122880, v4
    s_waitcnt lgkmcnt(13)
    v_mfma_f32_16x16x32_bf16 v[104:107], v[32:35], v[20:23], v[104:107]
    ds_read_b64_tr_b16 v[74:75], v10 offset:12800
    v_add_u32 v13, 122880, v5
    s_waitcnt lgkmcnt(13)
    v_mfma_f32_16x16x32_bf16 v[112:115], v[32:35], v[24:27], v[112:115]
    ds_read_b128 v[56:59], v9 offset:0
    v_add_u32 v14, 114688, v6
    s_waitcnt lgkmcnt(13)
    v_mfma_f32_16x16x32_bf16 v[120:123], v[32:35], v[28:31], v[120:123]
    ds_read_b128 v[60:63], v9 offset:2048
    v_add_u32 v15, 114688, v7
    s_waitcnt lgkmcnt(12)
    v_mfma_f32_16x16x32_bf16 v[124:127], v[36:39], v[28:31], v[124:127]
    ds_read_b128 v[64:67], v9 offset:4096
    s_lshl_b32 s66, s3, 12
    v_mfma_f32_16x16x32_bf16 v[116:119], v[36:39], v[24:27], v[116:119]
    ds_read_b128 v[68:71], v9 offset:6144
    v_lshlrev_b32 v3, 4, v2
    v_mfma_f32_16x16x32_bf16 v[108:111], v[36:39], v[20:23], v[108:111]
    ds_read_b64_tr_b16 v[76:77], v11 offset:12288
    v_add_u32 v3, s66, v3
    v_mfma_f32_16x16x32_bf16 v[100:103], v[36:39], v[16:19], v[100:103]
    ds_read_b64_tr_b16 v[78:79], v11 offset:12800
    s_lshl_b32 s66, s3, 2
    s_waitcnt lgkmcnt(14)
    v_mfma_f32_16x16x32_bf16 v[128:131], v[16:19], v[40:43], v[128:131]
    ds_read_b64_tr_b16 v[80:81], v10 offset:20480
    s_add_u32 s66, s66, 155648
    v_mfma_f32_16x16x32_bf16 v[136:139], v[20:23], v[40:43], v[136:139]
    ds_read_b64_tr_b16 v[82:83], v10 offset:20992
    v_mov_b32 v1, s66
    v_mfma_f32_16x16x32_bf16 v[144:147], v[24:27], v[40:43], v[144:147]
    ds_read_b64_tr_b16 v[84:85], v11 offset:20480
    v_mov_b32 v0, 1
    v_mfma_f32_16x16x32_bf16 v[152:155], v[28:31], v[40:43], v[152:155]
    ds_read_b64_tr_b16 v[86:87], v11 offset:20992
    v_mov_b32 v88, v248
    s_waitcnt lgkmcnt(15)
    v_mfma_f32_16x16x32_bf16 v[156:159], v[28:31], v[44:47], v[156:159]
    v_mov_b32 v89, v249
    v_mfma_f32_16x16x32_bf16 v[148:151], v[24:27], v[44:47], v[148:151]
    v_mov_b32 v90, v250
    v_mfma_f32_16x16x32_bf16 v[140:143], v[20:23], v[44:47], v[140:143]
    v_mov_b32 v91, v251
    v_mfma_f32_16x16x32_bf16 v[132:135], v[16:19], v[44:47], v[132:135]
    v_mov_b32 v92, v252
    s_waitcnt lgkmcnt(14)
    v_mfma_f32_16x16x32_bf16 v[160:163], v[16:19], v[48:51], v[160:163]
    v_mov_b32 v93, v253
    v_mfma_f32_16x16x32_bf16 v[168:171], v[20:23], v[48:51], v[168:171]
    v_mov_b32 v94, v254
    v_mfma_f32_16x16x32_bf16 v[176:179], v[24:27], v[48:51], v[176:179]
    v_mov_b32 v95, v255
    v_mfma_f32_16x16x32_bf16 v[184:187], v[28:31], v[48:51], v[184:187]
    s_waitcnt lgkmcnt(12)
    v_mfma_f32_16x16x32_bf16 v[188:191], v[28:31], v[52:55], v[188:191]
    v_mfma_f32_16x16x32_bf16 v[180:183], v[24:27], v[52:55], v[180:183]
    v_mfma_f32_16x16x32_bf16 v[172:175], v[20:23], v[52:55], v[172:175]
    v_mfma_f32_16x16x32_bf16 v[164:167], v[16:19], v[52:55], v[164:167]
    s_waitcnt lgkmcnt(9)
    v_mfma_f32_16x16x32_bf16 v[128:131], v[56:59], v[72:75], v[128:131]
    s_waitcnt lgkmcnt(8)
    v_mfma_f32_16x16x32_bf16 v[136:139], v[60:63], v[72:75], v[136:139]
    s_waitcnt lgkmcnt(7)
    v_mfma_f32_16x16x32_bf16 v[144:147], v[64:67], v[72:75], v[144:147]
    s_waitcnt lgkmcnt(6)
    v_mfma_f32_16x16x32_bf16 v[152:155], v[68:71], v[72:75], v[152:155]
    s_waitcnt lgkmcnt(4)
    v_mfma_f32_16x16x32_bf16 v[156:159], v[68:71], v[76:79], v[156:159]
    v_mfma_f32_16x16x32_bf16 v[148:151], v[64:67], v[76:79], v[148:151]
    s_barrier
    v_mfma_f32_16x16x32_bf16 v[140:143], v[60:63], v[76:79], v[140:143]
    ds_read_b64_tr_b16 v[16:17], v10 offset:49152
    v_mfma_f32_16x16x32_bf16 v[132:135], v[56:59], v[76:79], v[132:135]
    ds_read_b64_tr_b16 v[18:19], v10 offset:49664
    s_waitcnt lgkmcnt(4)
    v_mfma_f32_16x16x32_bf16 v[160:163], v[56:59], v[80:83], v[160:163]
    ds_read_b128 v[192:195], v8 offset:40960
    v_mfma_f32_16x16x32_bf16 v[168:171], v[60:63], v[80:83], v[168:171]
    ds_read_b128 v[196:199], v8 offset:43008
    v_mfma_f32_16x16x32_bf16 v[176:179], v[64:67], v[80:83], v[176:179]
    ds_read_b128 v[200:203], v8 offset:45056
    v_mfma_f32_16x16x32_bf16 v[184:187], v[68:71], v[80:83], v[184:187]
    ds_read_b128 v[204:207], v8 offset:47104
    s_waitcnt lgkmcnt(6)
    v_mfma_f32_16x16x32_bf16 v[188:191], v[68:71], v[84:87], v[188:191]
    ds_read_b64_tr_b16 v[20:21], v11 offset:49152
    v_mfma_f32_16x16x32_bf16 v[180:183], v[64:67], v[84:87], v[180:183]
    ds_read_b64_tr_b16 v[22:23], v11 offset:49664
    v_mfma_f32_16x16x32_bf16 v[172:175], v[60:63], v[84:87], v[172:175]
    v_mfma_f32_16x16x32_bf16 v[164:167], v[56:59], v[84:87], v[164:167]
    s_waitcnt lgkmcnt(5)
    v_mfma_f32_16x16x32_bf16 v[128:131], v[192:195], v[16:19], v[128:131]
    ds_read_b64_tr_b16 v[24:25], v10 offset:53248
    ds_read_b64_tr_b16 v[26:27], v10 offset:53760
    s_waitcnt lgkmcnt(6)
    v_mfma_f32_16x16x32_bf16 v[136:139], v[196:199], v[16:19], v[136:139]
    ds_read_b128 v[208:211], v9 offset:40960
    ds_read_b128 v[212:215], v9 offset:43008
    s_waitcnt lgkmcnt(7)
    v_mfma_f32_16x16x32_bf16 v[144:147], v[200:203], v[16:19], v[144:147]
    ds_read_b128 v[216:219], v9 offset:45056
    s_waitcnt lgkmcnt(7)
    v_mfma_f32_16x16x32_bf16 v[152:155], v[204:207], v[16:19], v[152:155]
    ds_read_b128 v[220:223], v9 offset:47104
    s_waitcnt lgkmcnt(6)
    v_mfma_f32_16x16x32_bf16 v[156:159], v[204:207], v[20:23], v[156:159]
    ds_read_b64_tr_b16 v[28:29], v11 offset:53248
    v_mfma_f32_16x16x32_bf16 v[148:151], v[200:203], v[20:23], v[148:151]
    ds_read_b64_tr_b16 v[30:31], v11 offset:53760
    v_mfma_f32_16x16x32_bf16 v[140:143], v[196:199], v[20:23], v[140:143]
    v_mfma_f32_16x16x32_bf16 v[132:135], v[192:195], v[20:23], v[132:135]
    s_waitcnt lgkmcnt(5)
    v_mfma_f32_16x16x32_bf16 v[128:131], v[208:211], v[24:27], v[128:131]
    ds_read_b64_tr_b16 v[32:33], v10 offset:4096
    s_waitcnt lgkmcnt(5)
    v_mfma_f32_16x16x32_bf16 v[136:139], v[212:215], v[24:27], v[136:139]
    ds_read_b64_tr_b16 v[34:35], v10 offset:4608
    s_waitcnt lgkmcnt(5)
    v_mfma_f32_16x16x32_bf16 v[144:147], v[216:219], v[24:27], v[144:147]
    ds_read_b64_tr_b16 v[36:37], v11 offset:4096
    s_waitcnt lgkmcnt(5)
    v_mfma_f32_16x16x32_bf16 v[152:155], v[220:223], v[24:27], v[152:155]
    ds_read_b64_tr_b16 v[38:39], v11 offset:4608
    s_waitcnt lgkmcnt(4)
    v_mfma_f32_16x16x32_bf16 v[156:159], v[220:223], v[28:31], v[156:159]
    v_mfma_f32_16x16x32_bf16 v[148:151], v[216:219], v[28:31], v[148:151]
    v_mfma_f32_16x16x32_bf16 v[140:143], v[212:215], v[28:31], v[140:143]
    v_mfma_f32_16x16x32_bf16 v[132:135], v[208:211], v[28:31], v[132:135]
    s_waitcnt lgkmcnt(2)
    v_mfma_f32_16x16x32_bf16 v[96:99], v[32:35], v[56:59], v[96:99]
    v_mfma_f32_16x16x32_bf16 v[104:107], v[32:35], v[60:63], v[104:107]
    s_barrier
    v_mfma_f32_16x16x32_bf16 v[112:115], v[32:35], v[64:67], v[112:115]
    ds_read_b64_tr_b16 v[16:17], v14 offset:8192
    ds_read_b64_tr_b16 v[18:19], v14 offset:8704
    v_mfma_f32_16x16x32_bf16 v[120:123], v[32:35], v[68:71], v[120:123]
    ds_read_b128 v[224:227], v12 offset:0
    ds_read_b128 v[228:231], v12 offset:2048
    s_waitcnt lgkmcnt(4)
    v_mfma_f32_16x16x32_bf16 v[124:127], v[36:39], v[68:71], v[124:127]
    ds_read_b128 v[232:235], v12 offset:4096
    ds_read_b128 v[236:239], v12 offset:6144
    v_mfma_f32_16x16x32_bf16 v[116:119], v[36:39], v[64:67], v[116:119]
    ds_read_b64_tr_b16 v[20:21], v15 offset:8192
    ds_read_b64_tr_b16 v[22:23], v15 offset:8704
    v_mfma_f32_16x16x32_bf16 v[108:111], v[36:39], v[60:63], v[108:111]
    v_mfma_f32_16x16x32_bf16 v[100:103], v[36:39], v[56:59], v[100:103]
    s_waitcnt lgkmcnt(5)
    v_mfma_f32_16x16x32_bf16 v[128:131], v[224:227], v[16:19], v[128:131]
    ds_read_b64_tr_b16 v[24:25], v14 offset:12288
    ds_read_b64_tr_b16 v[26:27], v14 offset:12800
    s_waitcnt lgkmcnt(6)
    v_mfma_f32_16x16x32_bf16 v[136:139], v[228:231], v[16:19], v[136:139]
    ds_read_b128 v[240:243], v13 offset:0
    ds_read_b128 v[244:247], v13 offset:2048
    s_waitcnt lgkmcnt(7)
    v_mfma_f32_16x16x32_bf16 v[144:147], v[232:235], v[16:19], v[144:147]
    ds_read_b128 v[248:251], v13 offset:4096
    s_waitcnt lgkmcnt(7)
    v_mfma_f32_16x16x32_bf16 v[152:155], v[236:239], v[16:19], v[152:155]
    ds_read_b128 v[252:255], v13 offset:6144
    s_waitcnt lgkmcnt(6)
    v_mfma_f32_16x16x32_bf16 v[156:159], v[236:239], v[20:23], v[156:159]
    ds_read_b64_tr_b16 v[28:29], v15 offset:12288
    v_mfma_f32_16x16x32_bf16 v[148:151], v[232:235], v[20:23], v[148:151]
    ds_read_b64_tr_b16 v[30:31], v15 offset:12800
    v_mfma_f32_16x16x32_bf16 v[140:143], v[228:231], v[20:23], v[140:143]
    v_mfma_f32_16x16x32_bf16 v[132:135], v[224:227], v[20:23], v[132:135]
    s_waitcnt lgkmcnt(5)
    v_mfma_f32_16x16x32_bf16 v[128:131], v[240:243], v[24:27], v[128:131]
    ds_read_b64_tr_b16 v[32:33], v10 offset:57344
    s_waitcnt lgkmcnt(5)
    v_mfma_f32_16x16x32_bf16 v[136:139], v[244:247], v[24:27], v[136:139]
    ds_read_b64_tr_b16 v[34:35], v10 offset:57856
    s_waitcnt lgkmcnt(5)
    v_mfma_f32_16x16x32_bf16 v[144:147], v[248:251], v[24:27], v[144:147]
    ds_read_b64_tr_b16 v[36:37], v11 offset:57344
    s_waitcnt lgkmcnt(5)
    v_mfma_f32_16x16x32_bf16 v[152:155], v[252:255], v[24:27], v[152:155]
    ds_read_b64_tr_b16 v[38:39], v11 offset:57856
    s_waitcnt lgkmcnt(4)
    v_mfma_f32_16x16x32_bf16 v[156:159], v[252:255], v[28:31], v[156:159]
    v_mfma_f32_16x16x32_bf16 v[148:151], v[248:251], v[28:31], v[148:151]
    v_mfma_f32_16x16x32_bf16 v[140:143], v[244:247], v[28:31], v[140:143]
    v_mfma_f32_16x16x32_bf16 v[132:135], v[240:243], v[28:31], v[132:135]
    s_waitcnt lgkmcnt(2)
    v_mfma_f32_16x16x32_bf16 v[160:163], v[192:195], v[32:35], v[160:163]
    ds_read_b64_tr_b16 v[16:17], v10 offset:61440
    s_nop 5
    v_cvt_pk_bf16_f32 v40, v128, v129
    v_cvt_pk_bf16_f32 v41, v130, v131
    v_mfma_f32_16x16x32_bf16 v[168:171], v[196:199], v[32:35], v[168:171]
    ds_read_b64_tr_b16 v[18:19], v10 offset:61952
    v_cvt_pk_bf16_f32 v42, v136, v137
    v_cvt_pk_bf16_f32 v43, v138, v139
    ds_write_b128 v3, v[40:43] offset:0
    v_mfma_f32_16x16x32_bf16 v[176:179], v[200:203], v[32:35], v[176:179]
    ds_read_b64_tr_b16 v[20:21], v11 offset:61440
    v_cvt_pk_bf16_f32 v44, v132, v133
    v_cvt_pk_bf16_f32 v45, v134, v135
    v_cvt_pk_bf16_f32 v46, v140, v141
    v_mfma_f32_16x16x32_bf16 v[184:187], v[204:207], v[32:35], v[184:187]
    ds_read_b64_tr_b16 v[22:23], v11 offset:61952
    v_cvt_pk_bf16_f32 v47, v142, v143
    ds_write_b128 v3, v[44:47] offset:1024
    v_cvt_pk_bf16_f32 v48, v144, v145
    s_waitcnt lgkmcnt(6)
    v_mfma_f32_16x16x32_bf16 v[188:191], v[204:207], v[36:39], v[188:191]
    v_cvt_pk_bf16_f32 v49, v146, v147
    v_cvt_pk_bf16_f32 v50, v152, v153
    v_cvt_pk_bf16_f32 v51, v154, v155
    v_mfma_f32_16x16x32_bf16 v[180:183], v[200:203], v[36:39], v[180:183]
    ds_write_b128 v3, v[48:51] offset:2048
    v_cvt_pk_bf16_f32 v52, v148, v149
    v_cvt_pk_bf16_f32 v53, v150, v151
    v_mfma_f32_16x16x32_bf16 v[172:175], v[196:199], v[36:39], v[172:175]
    v_cvt_pk_bf16_f32 v54, v156, v157
    v_cvt_pk_bf16_f32 v55, v158, v159
    v_mfma_f32_16x16x32_bf16 v[164:167], v[192:195], v[36:39], v[164:167]
    ds_write_b128 v3, v[52:55] offset:3072
    ds_write_b32 v1, v0
    s_waitcnt lgkmcnt(7)
    v_mfma_f32_16x16x32_bf16 v[160:163], v[208:211], v[16:19], v[160:163]
    ds_read_b64_tr_b16 v[24:25], v14 offset:16384
    v_pk_max_u16 v72, v40, v41
    v_mfma_f32_16x16x32_bf16 v[168:171], v[212:215], v[16:19], v[168:171]
    ds_read_b64_tr_b16 v[26:27], v14 offset:16896
    v_pk_max_u16 v72, v72, v42
    v_mfma_f32_16x16x32_bf16 v[176:179], v[216:219], v[16:19], v[176:179]
    ds_read_b64_tr_b16 v[28:29], v15 offset:16384
    v_pk_max_u16 v72, v72, v43
    v_mfma_f32_16x16x32_bf16 v[184:187], v[220:223], v[16:19], v[184:187]
    ds_read_b64_tr_b16 v[30:31], v15 offset:16896
    v_pk_max_u16 v72, v72, v44
    s_waitcnt lgkmcnt(8)
    v_mfma_f32_16x16x32_bf16 v[188:191], v[220:223], v[20:23], v[188:191]
    v_pk_max_u16 v72, v72, v45
    v_mfma_f32_16x16x32_bf16 v[180:183], v[216:219], v[20:23], v[180:183]
    v_pk_max_u16 v72, v72, v46
    v_mfma_f32_16x16x32_bf16 v[172:175], v[212:215], v[20:23], v[172:175]
    v_pk_max_u16 v72, v72, v47
    v_mfma_f32_16x16x32_bf16 v[164:167], v[208:211], v[20:23], v[164:167]
    s_waitcnt lgkmcnt(2)
    v_mfma_f32_16x16x32_bf16 v[160:163], v[224:227], v[24:27], v[160:163]
    ds_read_b64_tr_b16 v[32:33], v14 offset:20480
    v_pk_max_u16 v72, v72, v48
    v_mfma_f32_16x16x32_bf16 v[168:171], v[228:231], v[24:27], v[168:171]
    ds_read_b64_tr_b16 v[34:35], v14 offset:20992
    v_pk_max_u16 v72, v72, v49
    v_mfma_f32_16x16x32_bf16 v[176:179], v[232:235], v[24:27], v[176:179]
    ds_read_b64_tr_b16 v[36:37], v15 offset:20480
    v_pk_max_u16 v72, v72, v50
    v_mfma_f32_16x16x32_bf16 v[184:187], v[236:239], v[24:27], v[184:187]
    ds_read_b64_tr_b16 v[38:39], v15 offset:20992
    v_pk_max_u16 v72, v72, v51
    s_waitcnt lgkmcnt(4)
    v_mfma_f32_16x16x32_bf16 v[188:191], v[236:239], v[28:31], v[188:191]
    v_pk_max_u16 v72, v72, v52
    v_mfma_f32_16x16x32_bf16 v[180:183], v[232:235], v[28:31], v[180:183]
    v_pk_max_u16 v72, v72, v53
    v_mfma_f32_16x16x32_bf16 v[172:175], v[228:231], v[28:31], v[172:175]
    v_pk_max_u16 v72, v72, v54
    v_mfma_f32_16x16x32_bf16 v[164:167], v[224:227], v[28:31], v[164:167]
    v_pk_max_u16 v72, v72, v55
    s_waitcnt lgkmcnt(2)
    v_mfma_f32_16x16x32_bf16 v[160:163], v[240:243], v[32:35], v[160:163]
    ds_read_b64_tr_b16 v[16:17], v10 offset:40960
    v_add_u32 v3, 65536, v3
    v_mfma_f32_16x16x32_bf16 v[168:171], v[244:247], v[32:35], v[168:171]
    ds_read_b64_tr_b16 v[18:19], v10 offset:41472
    v_lshrrev_b32 v73, 16, v72
    v_mfma_f32_16x16x32_bf16 v[176:179], v[248:251], v[32:35], v[176:179]
    ds_read_b64_tr_b16 v[20:21], v11 offset:40960
    v_and_b32 v72, 0xffff, v72
    v_mfma_f32_16x16x32_bf16 v[184:187], v[252:255], v[32:35], v[184:187]
    ds_read_b64_tr_b16 v[22:23], v11 offset:41472
    v_max_u32 v72, v72, v73
    s_waitcnt lgkmcnt(4)
    v_mfma_f32_16x16x32_bf16 v[188:191], v[252:255], v[36:39], v[188:191]
    v_cmp_lt_u32 vcc, 0xc0db, v72
    v_mfma_f32_16x16x32_bf16 v[180:183], v[248:251], v[36:39], v[180:183]
    s_cmp_lg_u64 vcc, 0
    v_mfma_f32_16x16x32_bf16 v[172:175], v[244:247], v[36:39], v[172:175]
    s_cselect_b32 s66, 2, 1
    v_mfma_f32_16x16x32_bf16 v[164:167], v[240:243], v[36:39], v[164:167]
    v_mov_b32 v0, s66
    s_waitcnt lgkmcnt(2)
    v_mfma_f32_16x16x32_bf16 v[96:99], v[16:19], v[192:195], v[96:99]
    ds_read_b64_tr_b16 v[24:25], v10 offset:45056
    s_nop 5
    v_cvt_pk_bf16_f32 v40, v160, v161
    v_cvt_pk_bf16_f32 v41, v162, v163
    v_mfma_f32_16x16x32_bf16 v[104:107], v[16:19], v[196:199], v[104:107]
    ds_read_b64_tr_b16 v[26:27], v10 offset:45568
    v_cvt_pk_bf16_f32 v42, v168, v169
    v_cvt_pk_bf16_f32 v43, v170, v171
    ds_write_b128 v3, v[40:43] offset:0
    v_mfma_f32_16x16x32_bf16 v[112:115], v[16:19], v[200:203], v[112:115]
    ds_read_b64_tr_b16 v[28:29], v11 offset:45056
    v_cvt_pk_bf16_f32 v44, v164, v165
    v_cvt_pk_bf16_f32 v45, v166, v167
    v_cvt_pk_bf16_f32 v46, v172, v173
    v_mfma_f32_16x16x32_bf16 v[120:123], v[16:19], v[204:207], v[120:123]
    ds_read_b64_tr_b16 v[30:31], v11 offset:45568
    v_cvt_pk_bf16_f32 v47, v174, v175
    ds_write_b128 v3, v[44:47] offset:1024
    v_cvt_pk_bf16_f32 v48, v176, v177
    s_waitcnt lgkmcnt(6)
    v_mfma_f32_16x16x32_bf16 v[124:127], v[20:23], v[204:207], v[124:127]
    v_cvt_pk_bf16_f32 v49, v178, v179
    v_cvt_pk_bf16_f32 v50, v184, v185
    v_cvt_pk_bf16_f32 v51, v186, v187
    v_mfma_f32_16x16x32_bf16 v[116:119], v[20:23], v[200:203], v[116:119]
    ds_write_b128 v3, v[48:51] offset:2048
    v_cvt_pk_bf16_f32 v52, v180, v181
    v_cvt_pk_bf16_f32 v53, v182, v183
    v_mfma_f32_16x16x32_bf16 v[108:111], v[20:23], v[196:199], v[108:111]
    v_cvt_pk_bf16_f32 v54, v188, v189
    v_cvt_pk_bf16_f32 v55, v190, v191
    v_mfma_f32_16x16x32_bf16 v[100:103], v[20:23], v[192:195], v[100:103]
    ds_write_b128 v3, v[52:55] offset:3072
    ds_write_b32 v1, v0 offset:16
    s_waitcnt lgkmcnt(7)
    v_mfma_f32_16x16x32_bf16 v[96:99], v[24:27], v[208:211], v[96:99]
    ds_read_b64_tr_b16 v[32:33], v6 offset:0
    v_lshlrev_b32 v9, 4, v2
    v_mfma_f32_16x16x32_bf16 v[104:107], v[24:27], v[212:215], v[104:107]
    ds_read_b64_tr_b16 v[34:35], v6 offset:512
    v_mov_b32 v136, 0
    v_mfma_f32_16x16x32_bf16 v[112:115], v[24:27], v[216:219], v[112:115]
    ds_read_b64_tr_b16 v[36:37], v7 offset:0
    v_mov_b32 v137, 0
    v_mfma_f32_16x16x32_bf16 v[120:123], v[24:27], v[220:223], v[120:123]
    ds_read_b64_tr_b16 v[38:39], v7 offset:512
    v_mov_b32 v140, 0
    s_waitcnt lgkmcnt(8)
    v_mfma_f32_16x16x32_bf16 v[124:127], v[28:31], v[220:223], v[124:127]
    v_mov_b32 v141, 0
    v_mfma_f32_16x16x32_bf16 v[116:119], v[28:31], v[216:219], v[116:119]
    v_mov_b32 v138, v94
    v_mfma_f32_16x16x32_bf16 v[108:111], v[28:31], v[212:215], v[108:111]
    v_mov_b32 v139, v95
    v_mfma_f32_16x16x32_bf16 v[100:103], v[28:31], v[208:211], v[100:103]
    s_waitcnt lgkmcnt(2)
    v_mfma_f32_16x16x32_bf16 v[96:99], v[32:35], v[224:227], v[96:99]
    ds_read_b64_tr_b16 v[16:17], v6 offset:4096
    v_bfe_u32 v77, v2, 4, 1
    v_lshrrev_b32 v78, 5, v2
    v_mfma_f32_16x16x32_bf16 v[104:107], v[32:35], v[228:231], v[104:107]
    ds_read_b64_tr_b16 v[18:19], v6 offset:4608
    v_lshl_add_u32 v77, v77, 1, v78
    v_bfe_u32 v78, v2, 1, 3
    v_mfma_f32_16x16x32_bf16 v[112:115], v[32:35], v[232:235], v[112:115]
    ds_read_b64_tr_b16 v[20:21], v7 offset:4096
    v_xor_b32 v77, v77, v78
    v_and_b32 v78, 127, v92
    v_mfma_f32_16x16x32_bf16 v[120:123], v[32:35], v[236:239], v[120:123]
    ds_read_b64_tr_b16 v[22:23], v7 offset:4608
    v_lshlrev_b32 v78, 7, v78
    v_lshl_add_u32 v77, v77, 4, v78
    s_waitcnt lgkmcnt(4)
    v_mfma_f32_16x16x32_bf16 v[124:127], v[36:39], v[236:239], v[124:127]
    v_add_u32 v77, 122880, v77
    v_xor_b32 v78, 64, v77
    v_mfma_f32_16x16x32_bf16 v[116:119], v[36:39], v[232:235], v[116:119]
    ds_read_b128 v[144:147], v77
    v_mfma_f32_16x16x32_bf16 v[108:111], v[36:39], v[228:231], v[108:111]
    ds_read_b128 v[148:151], v78
    v_mfma_f32_16x16x32_bf16 v[100:103], v[36:39], v[224:227], v[100:103]
    v_mov_b32 v76, 155664
    s_waitcnt lgkmcnt(4)
    v_mfma_f32_16x16x32_bf16 v[96:99], v[16:19], v[240:243], v[96:99]
    ds_read_b128 v[72:75], v76
    v_mfma_f32_16x16x32_bf16 v[104:107], v[16:19], v[244:247], v[104:107]
    v_mfma_f32_16x16x32_bf16 v[112:115], v[16:19], v[248:251], v[112:115]
    v_mfma_f32_16x16x32_bf16 v[120:123], v[16:19], v[252:255], v[120:123]
    s_waitcnt lgkmcnt(3)
    v_mfma_f32_16x16x32_bf16 v[124:127], v[20:23], v[252:255], v[124:127]
    v_mfma_f32_16x16x32_bf16 v[116:119], v[20:23], v[248:251], v[116:119]
    v_mfma_f32_16x16x32_bf16 v[108:111], v[20:23], v[244:247], v[108:111]
    v_mfma_f32_16x16x32_bf16 v[100:103], v[20:23], v[240:243], v[100:103]
    s_nop 7
    v_cvt_pk_bf16_f32 v16, v96, v97
    v_cvt_pk_bf16_f32 v17, v98, v99
    v_cvt_pk_bf16_f32 v18, v100, v101
    v_cvt_pk_bf16_f32 v19, v102, v103
    v_cvt_pk_bf16_f32 v20, v104, v105
    v_cvt_pk_bf16_f32 v21, v106, v107
    v_cvt_pk_bf16_f32 v22, v108, v109
    v_cvt_pk_bf16_f32 v23, v110, v111
    v_cvt_pk_bf16_f32 v40, v112, v113
    v_cvt_pk_bf16_f32 v41, v114, v115
    v_cvt_pk_bf16_f32 v42, v116, v117
    v_cvt_pk_bf16_f32 v43, v118, v119
    v_cvt_pk_bf16_f32 v44, v120, v121
    v_cvt_pk_bf16_f32 v45, v122, v123
    v_cvt_pk_bf16_f32 v46, v124, v125
    v_cvt_pk_bf16_f32 v47, v126, v127
    s_lshl_b32 s66, s3, 11
    s_add_u32 s66, s66, 139264
    v_lshlrev_b32 v3, 4, v2
    v_add_u32 v3, s66, v3
C_qw:
    s_waitcnt lgkmcnt(0)
    v_min_u32 v72, v72, v73
    v_min3_u32 v72, v72, v74, v75
    v_cmp_eq_u32 vcc, 0, v72
    s_cbranch_vccz C_qg
    ds_read_b128 v[72:75], v76
    s_branch C_qw
C_qg:
    ds_write_b128 v3, v[40:43]
    ds_write_b128 v3, v[44:47] offset:1024
    s_waitcnt lgkmcnt(0)
    s_barrier
    v_lshlrev_b32 v32, 16, v16
    v_and_b32 v33, 0xffff0000, v16
    v_pk_mul_f32 v[34:35], v[32:33], s[70:71]
    v_pk_add_f32 v[32:33], v[32:33], 1.0 op_sel_hi:[1,0]
    v_exp_f32 v34, v34 clamp
    v_exp_f32 v35, v35 clamp
    v_lshlrev_b32 v36, 16, v17
    v_and_b32 v37, 0xffff0000, v17
    v_pk_mul_f32 v[38:39], v[36:37], s[70:71]
    v_pk_add_f32 v[36:37], v[36:37], 1.0 op_sel_hi:[1,0]
    v_exp_f32 v38, v38 clamp
    v_exp_f32 v39, v39 clamp
    v_max_f32 v32, v32, v34
    v_max_f32 v33, v33, v35
    v_min_f32 v40, v32, v33
    v_cvt_pk_bf16_f32 v24, v32, v33
    v_max_f32 v36, v36, v38
    v_max_f32 v37, v37, v39
    v_min3_f32 v40, v36, v37, v40
    v_cvt_pk_bf16_f32 v25, v36, v37
    v_lshlrev_b32 v32, 16, v18
    v_and_b32 v33, 0xffff0000, v18
    v_pk_mul_f32 v[34:35], v[32:33], s[70:71]
    v_pk_add_f32 v[32:33], v[32:33], 1.0 op_sel_hi:[1,0]
    v_exp_f32 v34, v34 clamp
    v_exp_f32 v35, v35 clamp
    v_lshlrev_b32 v36, 16, v19
    v_and_b32 v37, 0xffff0000, v19
    v_pk_mul_f32 v[38:39], v[36:37], s[70:71]
    v_pk_add_f32 v[36:37], v[36:37], 1.0 op_sel_hi:[1,0]
    v_exp_f32 v38, v38 clamp
    v_exp_f32 v39, v39 clamp
    v_max_f32 v32, v32, v34
    v_max_f32 v33, v33, v35
    v_min3_f32 v40, v32, v33, v40
    v_cvt_pk_bf16_f32 v26, v32, v33
    v_max_f32 v36, v36, v38
    v_max_f32 v37, v37, v39
    v_min3_f32 v40, v36, v37, v40
    v_cvt_pk_bf16_f32 v27, v36, v37
    v_lshlrev_b32 v32, 16, v20
    v_and_b32 v33, 0xffff0000, v20
    v_pk_mul_f32 v[34:35], v[32:33], s[70:71]
    v_pk_add_f32 v[32:33], v[32:33], 1.0 op_sel_hi:[1,0]
    v_exp_f32 v34, v34 clamp
    v_exp_f32 v35, v35 clamp
    v_lshlrev_b32 v36, 16, v21
    v_and_b32 v37, 0xffff0000, v21
    v_pk_mul_f32 v[38:39], v[36:37], s[70:71]
    v_pk_add_f32 v[36:37], v[36:37], 1.0 op_sel_hi:[1,0]
    v_exp_f32 v38, v38 clamp
    v_exp_f32 v39, v39 clamp
    v_max_f32 v32, v32, v34
    v_max_f32 v33, v33, v35
    v_min3_f32 v40, v32, v33, v40
    v_cvt_pk_bf16_f32 v28, v32, v33
    v_max_f32 v36, v36, v38
    v_max_f32 v37, v37, v39
    v_min3_f32 v40, v36, v37, v40
    v_cvt_pk_bf16_f32 v29, v36, v37
    v_lshlrev_b32 v32, 16, v22
    v_and_b32 v33, 0xffff0000, v22
    v_pk_mul_f32 v[34:35], v[32:33], s[70:71]
    v_pk_add_f32 v[32:33], v[32:33], 1.0 op_sel_hi:[1,0]
    v_exp_f32 v34, v34 clamp
    v_exp_f32 v35, v35 clamp
    v_lshlrev_b32 v36, 16, v23
    v_and_b32 v37, 0xffff0000, v23
    v_pk_mul_f32 v[38:39], v[36:37], s[70:71]
    v_pk_add_f32 v[36:37], v[36:37], 1.0 op_sel_hi:[1,0]
    v_exp_f32 v38, v38 clamp
    v_exp_f32 v39, v39 clamp
    v_max_f32 v32, v32, v34
    v_max_f32 v33, v33, v35
    v_min3_f32 v40, v32, v33, v40
    v_cvt_pk_bf16_f32 v30, v32, v33
    v_max_f32 v36, v36, v38
    v_max_f32 v37, v37, v39
    v_min3_f32 v40, v36, v37, v40
    v_cvt_pk_bf16_f32 v31, v36, v37
    v_cmp_gt_f32 vcc, 0x3a800000, v40
    s_cbranch_vccz P_qd
    v_lshlrev_b32 v32, 16, v24
    v_and_b32 v33, 0xffff0000, v24
    v_add_f32 v32, s47, v32
    v_add_f32 v33, s47, v33
    v_cvt_pk_bf16_f32 v24, v32, v33
    v_lshlrev_b32 v32, 16, v25
    v_and_b32 v33, 0xffff0000, v25
    v_add_f32 v32, s47, v32
    v_add_f32 v33, s47, v33
    v_cvt_pk_bf16_f32 v25, v32, v33
    v_lshlrev_b32 v32, 16, v26
    v_and_b32 v33, 0xffff0000, v26
    v_add_f32 v32, s47, v32
    v_add_f32 v33, s47, v33
    v_cvt_pk_bf16_f32 v26, v32, v33
    v_lshlrev_b32 v32, 16, v27
    v_and_b32 v33, 0xffff0000, v27
    v_add_f32 v32, s47, v32
    v_add_f32 v33, s47, v33
    v_cvt_pk_bf16_f32 v27, v32, v33
    v_lshlrev_b32 v32, 16, v28
    v_and_b32 v33, 0xffff0000, v28
    v_add_f32 v32, s47, v32
    v_add_f32 v33, s47, v33
    v_cvt_pk_bf16_f32 v28, v32, v33
    v_lshlrev_b32 v32, 16, v29
    v_and_b32 v33, 0xffff0000, v29
    v_add_f32 v32, s47, v32
    v_add_f32 v33, s47, v33
    v_cvt_pk_bf16_f32 v29, v32, v33
    v_lshlrev_b32 v32, 16, v30
    v_and_b32 v33, 0xffff0000, v30
    v_add_f32 v32, s47, v32
    v_add_f32 v33, s47, v33
    v_cvt_pk_bf16_f32 v30, v32, v33
    v_lshlrev_b32 v32, 16, v31
    v_and_b32 v33, 0xffff0000, v31
    v_add_f32 v32, s47, v32
    v_add_f32 v33, s47, v33
    v_cvt_pk_bf16_f32 v31, v32, v33
P_qd:
    buffer_load_dwordx4 v[232:235], v89, s[16:19], 0 offen sc1
    s_lshl_b32 s66, s49, 11
    s_add_u32 s66, s66, 159744
    v_add_u32 v10, s66, v9
    s_lshl_b32 s66, s49, 6
    s_add_u32 s66, s66, 159488
    v_lshrrev_b32 v11, 4, v2
    v_lshlrev_b32 v11, 4, v11
    v_add_u32 v11, s66, v11
    s_lshr_b32 s66, s44, 1
    s_lshl_b32 s67, s66, 11
    s_lshl_b32 s66, s66, 6
    s_and_b32 s59, s44, 1
    s_lshl_b32 s59, s59, 3
    s_add_u32 s66, s66, s59
    s_add_u32 s67, s67, s59
    s_add_u32 s66, s66, 159488
    s_add_u32 s67, s67, 159744
    v_add_u32 v12, s67, v9
    v_lshrrev_b32 v13, 4, v2
    v_lshlrev_b32 v13, 4, v13
    v_add_u32 v13, s66, v13
    s_mov_b32 s59, 0
P_z:
    s_add_u32 s59, s59, 1
    s_cmp_ge_u32 s59, 200000
    s_waitcnt vmcnt(0)
    s_cbranch_scc1 P_zk
    v_max_u32 v14, v232, v233
    v_max3_u32 v14, v14, v234, v235
    v_cmp_eq_u32 vcc, -1, v14
    s_cbranch_vccz P_zk
    buffer_load_dwordx4 v[232:235], v89, s[16:19], 0 offen sc1
    s_branch P_z
P_zk:
    s_xor_b32 s66, s57, 0
    buffer_load_dwordx4 v[160:163], v88, s[16:19], s66 offen offset:0 sc1
    s_xor_b32 s66, s57, 0
    buffer_load_dwordx4 v[164:167], v88, s[16:19], s66 offen offset:1024 sc1
    s_xor_b32 s66, s57, 0
    buffer_load_dwordx4 v[168:171], v88, s[16:19], s66 offen offset:2048 sc1
    s_xor_b32 s66, s57, 0
    buffer_load_dwordx4 v[172:175], v88, s[16:19], s66 offen offset:3072 sc1
    s_xor_b32 s66, s57, 4096
    buffer_load_dwordx4 v[176:179], v88, s[16:19], s66 offen offset:0 sc1
    s_xor_b32 s66, s57, 4096
    buffer_load_dwordx4 v[180:183], v88, s[16:19], s66 offen offset:1024 sc1
    s_xor_b32 s66, s57, 4096
    buffer_load_dwordx4 v[184:187], v88, s[16:19], s66 offen offset:2048 sc1
    s_xor_b32 s66, s57, 4096
    buffer_load_dwordx4 v[188:191], v88, s[16:19], s66 offen offset:3072 sc1
    s_xor_b32 s66, s57, 8192
    buffer_load_dwordx4 v[192:195], v88, s[16:19], s66 offen offset:0 sc1
    s_xor_b32 s66, s57, 8192
    buffer_load_dwordx4 v[196:199], v88, s[16:19], s66 offen offset:1024 sc1
    s_xor_b32 s66, s57, 8192
    buffer_load_dwordx4 v[200:203], v88, s[16:19], s66 offen offset:2048 sc1
    s_xor_b32 s66, s57, 8192
    buffer_load_dwordx4 v[204:207], v88, s[16:19], s66 offen offset:3072 sc1
    s_xor_b32 s66, s57, 12288
    buffer_load_dwordx4 v[208:211], v88, s[16:19], s66 offen offset:0 sc1
    s_xor_b32 s66, s57, 12288
    buffer_load_dwordx4 v[212:215], v88, s[16:19], s66 offen offset:1024 sc1
    s_xor_b32 s66, s57, 12288
    buffer_load_dwordx4 v[216:219], v88, s[16:19], s66 offen offset:2048 sc1
    s_xor_b32 s66, s57, 12288
    buffer_load_dwordx4 v[220:223], v88, s[16:19], s66 offen offset:3072 sc1
    v_add_f32_dpp v232, v232, v232 quad_perm:[1,0,3,2] row_mask:0xf bank_mask:0xf
    v_add_f32_dpp v233, v233, v233 quad_perm:[1,0,3,2] row_mask:0xf bank_mask:0xf
    v_add_f32_dpp v234, v234, v234 quad_perm:[1,0,3,2] row_mask:0xf bank_mask:0xf
    v_add_f32_dpp v235, v235, v235 quad_perm:[1,0,3,2] row_mask:0xf bank_mask:0xf
    v_add_f32_dpp v232, v232, v232 quad_perm:[2,3,0,1] row_mask:0xf bank_mask:0xf
    v_add_f32_dpp v233, v233, v233 quad_perm:[2,3,0,1] row_mask:0xf bank_mask:0xf
    v_add_f32_dpp v234, v234, v234 quad_perm:[2,3,0,1] row_mask:0xf bank_mask:0xf
    v_add_f32_dpp v235, v235, v235 quad_perm:[2,3,0,1] row_mask:0xf bank_mask:0xf
    v_add_f32_dpp v232, v232, v232 row_half_mirror row_mask:0xf bank_mask:0xf
    v_add_f32_dpp v233, v233, v233 row_half_mirror row_mask:0xf bank_mask:0xf
    v_add_f32_dpp v234, v234, v234 row_half_mirror row_mask:0xf bank_mask:0xf
    v_add_f32_dpp v235, v235, v235 row_half_mirror row_mask:0xf bank_mask:0xf
    v_add_f32_dpp v232, v232, v232 row_mirror row_mask:0xf bank_mask:0xf
    v_add_f32_dpp v233, v233, v233 row_mirror row_mask:0xf bank_mask:0xf
    v_add_f32_dpp v234, v234, v234 row_mirror row_mask:0xf bank_mask:0xf
    v_add_f32_dpp v235, v235, v235 row_mirror row_mask:0xf bank_mask:0xf
    v_cvt_pk_bf16_f32 v232, v232, v233
    v_cvt_pk_bf16_f32 v233, v234, v235
    ds_write_b64 v13, v[232:233]
    s_waitcnt vmcnt(15)
    v_max_u32 v14, v160, v161
    v_max3_u32 v14, v14, v162, v163
    v_mfma_f32_16x16x32_bf16 v[224:227], v[138:141], v[160:163], 0
    v_mfma_f32_16x16x32_bf16 v[228:231], v[136:139], v[160:163], 0
    s_waitcnt vmcnt(14)
    v_max3_u32 v14, v14, v164, v165
    v_max3_u32 v14, v14, v166, v167
    v_mfma_f32_16x16x32_bf16 v[224:227], v[138:141], v[164:167], v[224:227]
    v_mfma_f32_16x16x32_bf16 v[228:231], v[136:139], v[164:167], v[228:231]
    s_waitcnt vmcnt(13)
    v_max3_u32 v14, v14, v168, v169
    v_max3_u32 v14, v14, v170, v171
    v_mfma_f32_16x16x32_bf16 v[224:227], v[138:141], v[168:171], v[224:227]
    v_mfma_f32_16x16x32_bf16 v[228:231], v[136:139], v[168:171], v[228:231]
    s_waitcnt vmcnt(12)
    v_max3_u32 v14, v14, v172, v173
    v_max3_u32 v14, v14, v174, v175
    v_mfma_f32_16x16x32_bf16 v[224:227], v[138:141], v[172:175], v[224:227]
    v_mfma_f32_16x16x32_bf16 v[228:231], v[136:139], v[172:175], v[228:231]
    s_waitcnt vmcnt(11)
    v_max3_u32 v14, v14, v176, v177
    v_max3_u32 v14, v14, v178, v179
    v_mfma_f32_16x16x32_bf16 v[224:227], v[138:141], v[176:179], v[224:227]
    v_mfma_f32_16x16x32_bf16 v[228:231], v[136:139], v[176:179], v[228:231]
    s_waitcnt vmcnt(10)
    v_max3_u32 v14, v14, v180, v181
    v_max3_u32 v14, v14, v182, v183
    v_mfma_f32_16x16x32_bf16 v[224:227], v[138:141], v[180:183], v[224:227]
    v_mfma_f32_16x16x32_bf16 v[228:231], v[136:139], v[180:183], v[228:231]
    s_waitcnt vmcnt(9)
    v_max3_u32 v14, v14, v184, v185
    v_max3_u32 v14, v14, v186, v187
    v_mfma_f32_16x16x32_bf16 v[224:227], v[138:141], v[184:187], v[224:227]
    v_mfma_f32_16x16x32_bf16 v[228:231], v[136:139], v[184:187], v[228:231]
    s_waitcnt vmcnt(8)
    v_max3_u32 v14, v14, v188, v189
    v_max3_u32 v14, v14, v190, v191
    v_mfma_f32_16x16x32_bf16 v[224:227], v[138:141], v[188:191], v[224:227]
    v_mfma_f32_16x16x32_bf16 v[228:231], v[136:139], v[188:191], v[228:231]
    s_waitcnt vmcnt(7)
    v_max3_u32 v14, v14, v192, v193
    v_max3_u32 v14, v14, v194, v195
    v_mfma_f32_16x16x32_bf16 v[224:227], v[138:141], v[192:195], v[224:227]
    v_mfma_f32_16x16x32_bf16 v[228:231], v[136:139], v[192:195], v[228:231]
    s_waitcnt vmcnt(6)
    v_max3_u32 v14, v14, v196, v197
    v_max3_u32 v14, v14, v198, v199
    v_mfma_f32_16x16x32_bf16 v[224:227], v[138:141], v[196:199], v[224:227]
    v_mfma_f32_16x16x32_bf16 v[228:231], v[136:139], v[196:199], v[228:231]
    s_waitcnt vmcnt(5)
    v_max3_u32 v14, v14, v200, v201
    v_max3_u32 v14, v14, v202, v203
    v_mfma_f32_16x16x32_bf16 v[224:227], v[138:141], v[200:203], v[224:227]
    v_mfma_f32_16x16x32_bf16 v[228:231], v[136:139], v[200:203], v[228:231]
    s_waitcnt vmcnt(4)
    v_max3_u32 v14, v14, v204, v205
    v_max3_u32 v14, v14, v206, v207
    v_mfma_f32_16x16x32_bf16 v[224:227], v[138:141], v[204:207], v[224:227]
    v_mfma_f32_16x16x32_bf16 v[228:231], v[136:139], v[204:207], v[228:231]
    s_waitcnt vmcnt(3)
    v_max3_u32 v14, v14, v208, v209
    v_max3_u32 v14, v14, v210, v211
    v_mfma_f32_16x16x32_bf16 v[224:227], v[138:141], v[208:211], v[224:227]
    v_mfma_f32_16x16x32_bf16 v[228:231], v[136:139], v[208:211], v[228:231]
    s_waitcnt vmcnt(2)
    v_max3_u32 v14, v14, v212, v213
    v_max3_u32 v14, v14, v214, v215
    v_mfma_f32_16x16x32_bf16 v[224:227], v[138:141], v[212:215], v[224:227]
    v_mfma_f32_16x16x32_bf16 v[228:231], v[136:139], v[212:215], v[228:231]
    s_waitcnt vmcnt(1)
    v_max3_u32 v14, v14, v216, v217
    v_max3_u32 v14, v14, v218, v219
    v_mfma_f32_16x16x32_bf16 v[224:227], v[138:141], v[216:219], v[224:227]
    v_mfma_f32_16x16x32_bf16 v[228:231], v[136:139], v[216:219], v[228:231]
    s_waitcnt vmcnt(0)
    v_max3_u32 v14, v14, v220, v221
    v_max3_u32 v14, v14, v222, v223
    v_mfma_f32_16x16x32_bf16 v[224:227], v[138:141], v[220:223], v[224:227]
    v_mfma_f32_16x16x32_bf16 v[228:231], v[136:139], v[220:223], v[228:231]
    v_cmp_eq_u32 vcc, -1, v14
    s_cbranch_vccnz P_slow
P_h1ok:
    s_nop 5
    v_cvt_pk_bf16_f32 v224, v224, v225
    v_cvt_pk_bf16_f32 v225, v226, v227
    v_cvt_pk_bf16_f32 v226, v228, v229
    v_cvt_pk_bf16_f32 v227, v230, v231
    ds_write_b64 v12, v[224:225]
    ds_write_b64 v12, v[226:227] offset:1024
    s_branch POST
P_slow:
    s_mov_b32 s59, 0
P_retry:
    s_mov_b32 s76, 0
    v_max_u32 v14, v160, v161
    v_max3_u32 v14, v14, v162, v163
    v_cmp_eq_u32 vcc, -1, v14
    s_cbranch_vccz P_rc0
    s_xor_b32 s66, s57, 0
    buffer_load_dwordx4 v[160:163], v88, s[16:19], s66 offen offset:0 sc1
    s_mov_b32 s76, 1
P_rc0:
    v_max_u32 v14, v164, v165
    v_max3_u32 v14, v14, v166, v167
    v_cmp_eq_u32 vcc, -1, v14
    s_cbranch_vccz P_rc1
    s_xor_b32 s66, s57, 0
    buffer_load_dwordx4 v[164:167], v88, s[16:19], s66 offen offset:1024 sc1
    s_mov_b32 s76, 1
P_rc1:
    v_max_u32 v14, v168, v169
    v_max3_u32 v14, v14, v170, v171
    v_cmp_eq_u32 vcc, -1, v14
    s_cbranch_vccz P_rc2
    s_xor_b32 s66, s57, 0
    buffer_load_dwordx4 v[168:171], v88, s[16:19], s66 offen offset:2048 sc1
    s_mov_b32 s76, 1
P_rc2:
    v_max_u32 v14, v172, v173
    v_max3_u32 v14, v14, v174, v175
    v_cmp_eq_u32 vcc, -1, v14
    s_cbranch_vccz P_rc3
    s_xor_b32 s66, s57, 0
    buffer_load_dwordx4 v[172:175], v88, s[16:19], s66 offen offset:3072 sc1
    s_mov_b32 s76, 1
P_rc3:
    v_max_u32 v14, v176, v177
    v_max3_u32 v14, v14, v178, v179
    v_cmp_eq_u32 vcc, -1, v14
    s_cbranch_vccz P_rc4
    s_xor_b32 s66, s57, 4096
    buffer_load_dwordx4 v[176:179], v88, s[16:19], s66 offen offset:0 sc1
    s_mov_b32 s76, 1
P_rc4:
    v_max_u32 v14, v180, v181
    v_max3_u32 v14, v14, v182, v183
    v_cmp_eq_u32 vcc, -1, v14
    s_cbranch_vccz P_rc5
    s_xor_b32 s66, s57, 4096
    buffer_load_dwordx4 v[180:183], v88, s[16:19], s66 offen offset:1024 sc1
    s_mov_b32 s76, 1
P_rc5:
    v_max_u32 v14, v184, v185
    v_max3_u32 v14, v14, v186, v187
    v_cmp_eq_u32 vcc, -1, v14
    s_cbranch_vccz P_rc6
    s_xor_b32 s66, s57, 4096
    buffer_load_dwordx4 v[184:187], v88, s[16:19], s66 offen offset:2048 sc1
    s_mov_b32 s76, 1
P_rc6:
    v_max_u32 v14, v188, v189
    v_max3_u32 v14, v14, v190, v191
    v_cmp_eq_u32 vcc, -1, v14
    s_cbranch_vccz P_rc7
    s_xor_b32 s66, s57, 4096
    buffer_load_dwordx4 v[188:191], v88, s[16:19], s66 offen offset:3072 sc1
    s_mov_b32 s76, 1
P_rc7:
    v_max_u32 v14, v192, v193
    v_max3_u32 v14, v14, v194, v195
    v_cmp_eq_u32 vcc, -1, v14
    s_cbranch_vccz P_rc8
    s_xor_b32 s66, s57, 8192
    buffer_load_dwordx4 v[192:195], v88, s[16:19], s66 offen offset:0 sc1
    s_mov_b32 s76, 1
P_rc8:
    v_max_u32 v14, v196, v197
    v_max3_u32 v14, v14, v198, v199
    v_cmp_eq_u32 vcc, -1, v14
    s_cbranch_vccz P_rc9
    s_xor_b32 s66, s57, 8192
    buffer_load_dwordx4 v[196:199], v88, s[16:19], s66 offen offset:1024 sc1
    s_mov_b32 s76, 1
P_rc9:
    v_max_u32 v14, v200, v201
    v_max3_u32 v14, v14, v202, v203
    v_cmp_eq_u32 vcc, -1, v14
    s_cbranch_vccz P_rc10
    s_xor_b32 s66, s57, 8192
    buffer_load_dwordx4 v[200:203], v88, s[16:19], s66 offen offset:2048 sc1
    s_mov_b32 s76, 1
P_rc10:
    v_max_u32 v14, v204, v205
    v_max3_u32 v14, v14, v206, v207
    v_cmp_eq_u32 vcc, -1, v14
    s_cbranch_vccz P_rc11
    s_xor_b32 s66, s57, 8192
    buffer_load_dwordx4 v[204:207], v88, s[16:19], s66 offen offset:3072 sc1
    s_mov_b32 s76, 1
P_rc11:
    v_max_u32 v14, v208, v209
    v_max3_u32 v14, v14, v210, v211
    v_cmp_eq_u32 vcc, -1, v14
    s_cbranch_vccz P_rc12
    s_xor_b32 s66, s57, 12288
    buffer_load_dwordx4 v[208:211], v88, s[16:19], s66 offen offset:0 sc1
    s_mov_b32 s76, 1
P_rc12:
    v_max_u32 v14, v212, v213
    v_max3_u32 v14, v14, v214, v215
    v_cmp_eq_u32 vcc, -1, v14
    s_cbranch_vccz P_rc13
    s_xor_b32 s66, s57, 12288
    buffer_load_dwordx4 v[212:215], v88, s[16:19], s66 offen offset:1024 sc1
    s_mov_b32 s76, 1
P_rc13:
    v_max_u32 v14, v216, v217
    v_max3_u32 v14, v14, v218, v219
    v_cmp_eq_u32 vcc, -1, v14
    s_cbranch_vccz P_rc14
    s_xor_b32 s66, s57, 12288
    buffer_load_dwordx4 v[216:219], v88, s[16:19], s66 offen offset:2048 sc1
    s_mov_b32 s76, 1
P_rc14:
    v_max_u32 v14, v220, v221
    v_max3_u32 v14, v14, v222, v223
    v_cmp_eq_u32 vcc, -1, v14
    s_cbranch_vccz P_rc15
    s_xor_b32 s66, s57, 12288
    buffer_load_dwordx4 v[220:223], v88, s[16:19], s66 offen offset:3072 sc1
    s_mov_b32 s76, 1
P_rc15:
    s_add_u32 s59, s59, 1
    s_cmp_ge_u32 s59, 200000
    s_cselect_b32 s76, 0, s76
    s_waitcnt vmcnt(0)
    s_cmp_lg_u32 s76, 0
    s_cbranch_scc1 P_retry
    v_mfma_f32_16x16x32_bf16 v[224:227], v[138:141], v[160:163], 0
    v_mfma_f32_16x16x32_bf16 v[228:231], v[136:139], v[160:163], 0
    v_mfma_f32_16x16x32_bf16 v[224:227], v[138:141], v[164:167], v[224:227]
    v_mfma_f32_16x16x32_bf16 v[228:231], v[136:139], v[164:167], v[228:231]
    v_mfma_f32_16x16x32_bf16 v[224:227], v[138:141], v[168:171], v[224:227]
    v_mfma_f32_16x16x32_bf16 v[228:231], v[136:139], v[168:171], v[228:231]
    v_mfma_f32_16x16x32_bf16 v[224:227], v[138:141], v[172:175], v[224:227]
    v_mfma_f32_16x16x32_bf16 v[228:231], v[136:139], v[172:175], v[228:231]
    v_mfma_f32_16x16x32_bf16 v[224:227], v[138:141], v[176:179], v[224:227]
    v_mfma_f32_16x16x32_bf16 v[228:231], v[136:139], v[176:179], v[228:231]
    v_mfma_f32_16x16x32_bf16 v[224:227], v[138:141], v[180:183], v[224:227]
    v_mfma_f32_16x16x32_bf16 v[228:231], v[136:139], v[180:183], v[228:231]
    v_mfma_f32_16x16x32_bf16 v[224:227], v[138:141], v[184:187], v[224:227]
    v_mfma_f32_16x16x32_bf16 v[228:231], v[136:139], v[184:187], v[228:231]
    v_mfma_f32_16x16x32_bf16 v[224:227], v[138:141], v[188:191], v[224:227]
    v_mfma_f32_16x16x32_bf16 v[228:231], v[136:139], v[188:191], v[228:231]
    v_mfma_f32_16x16x32_bf16 v[224:227], v[138:141], v[192:195], v[224:227]
    v_mfma_f32_16x16x32_bf16 v[228:231], v[136:139], v[192:195], v[228:231]
    v_mfma_f32_16x16x32_bf16 v[224:227], v[138:141], v[196:199], v[224:227]
    v_mfma_f32_16x16x32_bf16 v[228:231], v[136:139], v[196:199], v[228:231]
    v_mfma_f32_16x16x32_bf16 v[224:227], v[138:141], v[200:203], v[224:227]
    v_mfma_f32_16x16x32_bf16 v[228:231], v[136:139], v[200:203], v[228:231]
    v_mfma_f32_16x16x32_bf16 v[224:227], v[138:141], v[204:207], v[224:227]
    v_mfma_f32_16x16x32_bf16 v[228:231], v[136:139], v[204:207], v[228:231]
    v_mfma_f32_16x16x32_bf16 v[224:227], v[138:141], v[208:211], v[224:227]
    v_mfma_f32_16x16x32_bf16 v[228:231], v[136:139], v[208:211], v[228:231]
    v_mfma_f32_16x16x32_bf16 v[224:227], v[138:141], v[212:215], v[224:227]
    v_mfma_f32_16x16x32_bf16 v[228:231], v[136:139], v[212:215], v[228:231]
    v_mfma_f32_16x16x32_bf16 v[224:227], v[138:141], v[216:219], v[224:227]
    v_mfma_f32_16x16x32_bf16 v[228:231], v[136:139], v[216:219], v[228:231]
    v_mfma_f32_16x16x32_bf16 v[224:227], v[138:141], v[220:223], v[224:227]
    v_mfma_f32_16x16x32_bf16 v[228:231], v[136:139], v[220:223], v[228:231]
    s_nop 1
    s_branch P_h1ok
HELP:
    v_lshlrev_b32 v9, 4, v2
    s_lshl_b32 s56, s5, 2
    s_add_u32 s56, s56, s44
    s_lshl_b32 s53, s56, 10
    s_lshl_b32 s66, s4, 6
    s_add_u32 s53, s53, s66
    s_add_u32 s53, s53, 5242880
    s_lshl_b32 s56, s56, 4
    s_add_u32 s56, s56, s4
    s_lshl_b32 s56, s56, 10
    s_add_u32 s56, s56, 4194304
    s_lshl_b32 s55, s73, 2
    s_add_u32 s55, s55, s44
    s_lshl_b32 s55, s55, 6
    s_add_u32 s55, s55, s79
    s_lshl_b32 s55, s55, 8
    s_add_u32 s55, s55, 5832704
    v_lshrrev_b32 v12, 3, v2
    s_lshl_b32 s67, s44, 3
    v_add_u32 v12, s67, v12
    v_lshlrev_b32 v12, 11, v12
    v_lshrrev_b32 v13, 4, v2
    v_lshlrev_b32 v13, 1, v13
    v_and_b32 v90, 7, v2
    v_xor_b32 v13, v13, v90
    v_lshl_add_u32 v12, v13, 4, v12
    s_lshl_b32 s66, s7, 7
    v_add_u32 v90, s66, v12
    s_lshl_b32 s66, s6, 7
    s_lshl_b32 s67, s44, 5
    s_add_u32 s66, s66, s67
    s_lshl_b32 s67, s45, 4
    s_add_u32 s66, s66, s67
    v_and_b32 v92, 15, v2
    v_add_u32 v92, s66, v92
    v_lshlrev_b32 v91, 11, v92
    v_bfe_u32 v12, v2, 4, 1
    v_lshl_add_u32 v91, v12, 5, v91
    v_lshrrev_b32 v12, 5, v2
    v_lshl_add_u32 v91, v12, 4, v91
    s_lshl_b32 s66, s7, 7
    v_add_u32 v91, s66, v91
    v_lshrrev_b32 v93, 2, v92
    v_lshlrev_b32 v93, 6, v93
    v_and_b32 v12, 3, v2
    v_lshl_add_u32 v93, v12, 2, v93
    s_lshl_b32 s66, s6, 1
    s_and_b32 s66, s66, 6
    s_lshl_b32 s67, s7, 3
    s_add_u32 s66, s66, s67
    s_and_b32 s66, s66, 7
    s_lshl_b32 s52, s66, 18
    s_lshr_b32 s49, s44, 1
    s_and_b32 s66, s44, 1
    s_lshl_b32 s66, s66, 2
    s_lshl_b32 s67, s45, 1
    s_add_u32 s66, s66, s67
    s_lshl_b32 s67, s4, 3
    s_add_u32 s66, s66, s67
    s_lshl_b32 s66, s66, 5
    s_lshl_b32 s67, s5, 1
    s_add_u32 s66, s66, s67
    s_add_u32 s66, s66, s49
    s_lshl_b32 s60, s66, 10
    s_add_u32 s61, s60, 32768
    v_lshrrev_b32 v10, 5, v2
    v_and_b32 v11, 31, v2
    v_lshlrev_b32 v12, 3, v10
    s_lshl_b32 s66, s79, 6
    s_lshl_b32 s67, s44, 4
    s_add_u32 s66, s66, s67
    v_add_u32 v12, s66, v12
    v_lshlrev_b32 v12, 11, v12
    v_lshl_add_u32 v12, v11, 4, v12
    s_lshl_b32 s66, s73, 9
    v_add_u32 v7, s66, v12
    s_lshr_b32 s62, s79, 2
    s_lshl_b32 s62, s62, 15
    s_and_b32 s66, s79, 3
    s_lshl_b32 s66, s66, 8
    s_add_u32 s62, s62, s66
    s_lshl_b32 s66, s44, 6
    s_add_u32 s62, s62, s66
    s_add_u32 s62, s62, 5308416
    s_add_u32 s63, s62, 16384
    v_lshrrev_b32 v1, 2, v2
    v_lshlrev_b32 v1, 10, v1
    v_and_b32 v13, 3, v2
    v_lshl_add_u32 v1, v13, 4, v1
    s_cmp_ge_u32 s44, 2
    s_cbranch_scc1 WORK
    s_waitcnt vmcnt(5)
    s_barrier
    s_cmp_le_u32 s77, 2
    s_addc_u32 s71, s76, 2
    s_and_b32 s71, s71, 15
    s_lshl_b32 s70, s71, 7
    s_mul_i32 s71, s71, 393216
    s_add_u32 m0, s72, 106496
    s_add_u32 s66, s71, 2048
    buffer_load_dwordx4 v5, s[12:15], s66 offen lds
    s_add_u32 m0, s72, 108544
    s_add_u32 s66, s71, 100352
    buffer_load_dwordx4 v5, s[12:15], s66 offen lds
    s_add_u32 m0, s72, 110592
    s_add_u32 s66, s71, 198656
    buffer_load_dwordx4 v5, s[12:15], s66 offen lds
    s_add_u32 m0, s72, 112640
    s_add_u32 s66, s71, 296960
    buffer_load_dwordx4 v5, s[12:15], s66 offen lds
    s_add_u32 m0, s72, 81920
    s_add_u32 s66, s70, 0
    buffer_load_dwordx4 v4, s[8:11], s66 offen lds
    s_add_u32 m0, s72, 83968
    s_add_u32 s66, s70, 32768
    buffer_load_dwordx4 v4, s[8:11], s66 offen lds
    s_add_u32 m0, s72, 86016
    s_add_u32 s66, s70, 65536
    buffer_load_dwordx4 v4, s[8:11], s66 offen lds
    s_add_u32 m0, s72, 88064
    s_add_u32 s66, s70, 98304
    buffer_load_dwordx4 v4, s[8:11], s66 offen lds
    s_add_u32 m0, s72, 90112
    s_add_u32 s66, s70, 131072
    buffer_load_dwordx4 v4, s[8:11], s66 offen lds
    s_add_u32 m0, s72, 92160
    s_add_u32 s66, s70, 163840
    buffer_load_dwordx4 v4, s[8:11], s66 offen lds
    s_add_u32 m0, s72, 94208
    s_add_u32 s66, s70, 196608
    buffer_load_dwordx4 v4, s[8:11], s66 offen lds
    s_add_u32 m0, s72, 96256
    s_add_u32 s66, s70, 229376
    buffer_load_dwordx4 v4, s[8:11], s66 offen lds
    s_add_u32 m0, s72, 114688
    s_add_u32 s66, s71, 4096
    buffer_load_dwordx4 v5, s[12:15], s66 offen lds
    s_add_u32 m0, s72, 116736
    s_add_u32 s66, s71, 102400
    buffer_load_dwordx4 v5, s[12:15], s66 offen lds
    s_add_u32 m0, s72, 118784
    s_add_u32 s66, s71, 200704
    buffer_load_dwordx4 v5, s[12:15], s66 offen lds
    s_add_u32 m0, s72, 120832
    s_add_u32 s66, s71, 299008
    buffer_load_dwordx4 v5, s[12:15], s66 offen lds
    s_add_u32 m0, s72, 98304
    s_add_u32 s66, s71, 0
    buffer_load_dwordx4 v5, s[12:15], s66 offen lds
    s_add_u32 m0, s72, 100352
    s_add_u32 s66, s71, 98304
    buffer_load_dwordx4 v5, s[12:15], s66 offen lds
    s_add_u32 m0, s72, 102400
    s_add_u32 s66, s71, 196608
    buffer_load_dwordx4 v5, s[12:15], s66 offen lds
    s_add_u32 m0, s72, 104448
    s_add_u32 s66, s71, 294912
    buffer_load_dwordx4 v5, s[12:15], s66 offen lds
    s_waitcnt vmcnt(20)
    s_barrier
    s_cmp_le_u32 s77, 3
    s_addc_u32 s71, s76, 3
    s_and_b32 s71, s71, 15
    s_lshl_b32 s70, s71, 7
    s_mul_i32 s71, s71, 393216
    s_add_u32 m0, s72, 24576
    s_add_u32 s66, s71, 2048
    buffer_load_dwordx4 v5, s[12:15], s66 offen lds
    s_add_u32 m0, s72, 26624
    s_add_u32 s66, s71, 100352
    buffer_load_dwordx4 v5, s[12:15], s66 offen lds
    s_add_u32 m0, s72, 28672
    s_add_u32 s66, s71, 198656
    buffer_load_dwordx4 v5, s[12:15], s66 offen lds
    s_add_u32 m0, s72, 30720
    s_add_u32 s66, s71, 296960
    buffer_load_dwordx4 v5, s[12:15], s66 offen lds
    s_add_u32 m0, s72, 0
    s_add_u32 s66, s70, 0
    buffer_load_dwordx4 v4, s[8:11], s66 offen lds
    s_add_u32 m0, s72, 2048
    s_add_u32 s66, s70, 32768
    buffer_load_dwordx4 v4, s[8:11], s66 offen lds
    s_add_u32 m0, s72, 4096
    s_add_u32 s66, s70, 65536
    buffer_load_dwordx4 v4, s[8:11], s66 offen lds
    s_add_u32 m0, s72, 6144
    s_add_u32 s66, s70, 98304
    buffer_load_dwordx4 v4, s[8:11], s66 offen lds
    s_add_u32 m0, s72, 8192
    s_add_u32 s66, s70, 131072
    buffer_load_dwordx4 v4, s[8:11], s66 offen lds
    s_add_u32 m0, s72, 10240
    s_add_u32 s66, s70, 163840
    buffer_load_dwordx4 v4, s[8:11], s66 offen lds
    s_add_u32 m0, s72, 12288
    s_add_u32 s66, s70, 196608
    buffer_load_dwordx4 v4, s[8:11], s66 offen lds
    s_add_u32 m0, s72, 14336
    s_add_u32 s66, s70, 229376
    buffer_load_dwordx4 v4, s[8:11], s66 offen lds
    s_add_u32 m0, s72, 32768
    s_add_u32 s66, s71, 4096
    buffer_load_dwordx4 v5, s[12:15], s66 offen lds
    s_add_u32 m0, s72, 34816
    s_add_u32 s66, s71, 102400
    buffer_load_dwordx4 v5, s[12:15], s66 offen lds
    s_add_u32 m0, s72, 36864
    s_add_u32 s66, s71, 200704
    buffer_load_dwordx4 v5, s[12:15], s66 offen lds
    s_add_u32 m0, s72, 38912
    s_add_u32 s66, s71, 299008
    buffer_load_dwordx4 v5, s[12:15], s66 offen lds
    s_add_u32 m0, s72, 16384
    s_add_u32 s66, s71, 0
    buffer_load_dwordx4 v5, s[12:15], s66 offen lds
    s_add_u32 m0, s72, 18432
    s_add_u32 s66, s71, 98304
    buffer_load_dwordx4 v5, s[12:15], s66 offen lds
    s_add_u32 m0, s72, 20480
    s_add_u32 s66, s71, 196608
    buffer_load_dwordx4 v5, s[12:15], s66 offen lds
    s_add_u32 m0, s72, 22528
    s_add_u32 s66, s71, 294912
    buffer_load_dwordx4 v5, s[12:15], s66 offen lds
    s_waitcnt vmcnt(20)
    s_barrier
    s_cmp_le_u32 s77, 4
    s_addc_u32 s71, s76, 4
    s_and_b32 s71, s71, 15
    s_lshl_b32 s70, s71, 7
    s_mul_i32 s71, s71, 393216
    s_add_u32 m0, s72, 65536
    s_add_u32 s66, s71, 2048
    buffer_load_dwordx4 v5, s[12:15], s66 offen lds
    s_add_u32 m0, s72, 67584
    s_add_u32 s66, s71, 100352
    buffer_load_dwordx4 v5, s[12:15], s66 offen lds
    s_add_u32 m0, s72, 69632
    s_add_u32 s66, s71, 198656
    buffer_load_dwordx4 v5, s[12:15], s66 offen lds
    s_add_u32 m0, s72, 71680
    s_add_u32 s66, s71, 296960
    buffer_load_dwordx4 v5, s[12:15], s66 offen lds
    s_add_u32 m0, s72, 40960
    s_add_u32 s66, s70, 0
    buffer_load_dwordx4 v4, s[8:11], s66 offen lds
    s_add_u32 m0, s72, 43008
    s_add_u32 s66, s70, 32768
    buffer_load_dwordx4 v4, s[8:11], s66 offen lds
    s_add_u32 m0, s72, 45056
    s_add_u32 s66, s70, 65536
    buffer_load_dwordx4 v4, s[8:11], s66 offen lds
    s_add_u32 m0, s72, 47104
    s_add_u32 s66, s70, 98304
    buffer_load_dwordx4 v4, s[8:11], s66 offen lds
    s_add_u32 m0, s72, 49152
    s_add_u32 s66, s70, 131072
    buffer_load_dwordx4 v4, s[8:11], s66 offen lds
    s_add_u32 m0, s72, 51200
    s_add_u32 s66, s70, 163840
    buffer_load_dwordx4 v4, s[8:11], s66 offen lds
    s_add_u32 m0, s72, 53248
    s_add_u32 s66, s70, 196608
    buffer_load_dwordx4 v4, s[8:11], s66 offen lds
    s_add_u32 m0, s72, 55296
    s_add_u32 s66, s70, 229376
    buffer_load_dwordx4 v4, s[8:11], s66 offen lds
    s_add_u32 m0, s72, 73728
    s_add_u32 s66, s71, 4096
    buffer_load_dwordx4 v5, s[12:15], s66 offen lds
    s_add_u32 m0, s72, 75776
    s_add_u32 s66, s71, 102400
    buffer_load_dwordx4 v5, s[12:15], s66 offen lds
    s_add_u32 m0, s72, 77824
    s_add_u32 s66, s71, 200704
    buffer_load_dwordx4 v5, s[12:15], s66 offen lds
    s_add_u32 m0, s72, 79872
    s_add_u32 s66, s71, 299008
    buffer_load_dwordx4 v5, s[12:15], s66 offen lds
    s_add_u32 m0, s72, 57344
    s_add_u32 s66, s71, 0
    buffer_load_dwordx4 v5, s[12:15], s66 offen lds
    s_add_u32 m0, s72, 59392
    s_add_u32 s66, s71, 98304
    buffer_load_dwordx4 v5, s[12:15], s66 offen lds
    s_add_u32 m0, s72, 61440
    s_add_u32 s66, s71, 196608
    buffer_load_dwordx4 v5, s[12:15], s66 offen lds
    s_add_u32 m0, s72, 63488
    s_add_u32 s66, s71, 294912
    buffer_load_dwordx4 v5, s[12:15], s66 offen lds
    s_waitcnt vmcnt(20)
    s_barrier
    s_cmp_le_u32 s77, 5
    s_addc_u32 s71, s76, 5
    s_and_b32 s71, s71, 15
    s_lshl_b32 s70, s71, 7
    s_mul_i32 s71, s71, 393216
    s_add_u32 m0, s72, 106496
    s_add_u32 s66, s71, 2048
    buffer_load_dwordx4 v5, s[12:15], s66 offen lds
    s_add_u32 m0, s72, 108544
    s_add_u32 s66, s71, 100352
    buffer_load_dwordx4 v5, s[12:15], s66 offen lds
    s_add_u32 m0, s72, 110592
    s_add_u32 s66, s71, 198656
    buffer_load_dwordx4 v5, s[12:15], s66 offen lds
    s_add_u32 m0, s72, 112640
    s_add_u32 s66, s71, 296960
    buffer_load_dwordx4 v5, s[12:15], s66 offen lds
    s_add_u32 m0, s72, 81920
    s_add_u32 s66, s70, 0
    buffer_load_dwordx4 v4, s[8:11], s66 offen lds
    s_add_u32 m0, s72, 83968
    s_add_u32 s66, s70, 32768
    buffer_load_dwordx4 v4, s[8:11], s66 offen lds
    s_add_u32 m0, s72, 86016
    s_add_u32 s66, s70, 65536
    buffer_load_dwordx4 v4, s[8:11], s66 offen lds
    s_add_u32 m0, s72, 88064
    s_add_u32 s66, s70, 98304
    buffer_load_dwordx4 v4, s[8:11], s66 offen lds
    s_add_u32 m0, s72, 90112
    s_add_u32 s66, s70, 131072
    buffer_load_dwordx4 v4, s[8:11], s66 offen lds
    s_add_u32 m0, s72, 92160
    s_add_u32 s66, s70, 163840
    buffer_load_dwordx4 v4, s[8:11], s66 offen lds
    s_add_u32 m0, s72, 94208
    s_add_u32 s66, s70, 196608
    buffer_load_dwordx4 v4, s[8:11], s66 offen lds
    s_add_u32 m0, s72, 96256
    s_add_u32 s66, s70, 229376
    buffer_load_dwordx4 v4, s[8:11], s66 offen lds
    s_add_u32 m0, s72, 114688
    s_add_u32 s66, s71, 4096
    buffer_load_dwordx4 v5, s[12:15], s66 offen lds
    s_add_u32 m0, s72, 116736
    s_add_u32 s66, s71, 102400
    buffer_load_dwordx4 v5, s[12:15], s66 offen lds
    s_add_u32 m0, s72, 118784
    s_add_u32 s66, s71, 200704
    buffer_load_dwordx4 v5, s[12:15], s66 offen lds
    s_add_u32 m0, s72, 120832
    s_add_u32 s66, s71, 299008
    buffer_load_dwordx4 v5, s[12:15], s66 offen lds
    s_add_u32 m0, s72, 98304
    s_add_u32 s66, s71, 0
    buffer_load_dwordx4 v5, s[12:15], s66 offen lds
    s_add_u32 m0, s72, 100352
    s_add_u32 s66, s71, 98304
    buffer_load_dwordx4 v5, s[12:15], s66 offen lds
    s_add_u32 m0, s72, 102400
    s_add_u32 s66, s71, 196608
    buffer_load_dwordx4 v5, s[12:15], s66 offen lds
    s_add_u32 m0, s72, 104448
    s_add_u32 s66, s71, 294912
    buffer_load_dwordx4 v5, s[12:15], s66 offen lds
    s_waitcnt vmcnt(20)
    s_barrier
    s_cmp_le_u32 s77, 6
    s_addc_u32 s71, s76, 6
    s_and_b32 s71, s71, 15
    s_lshl_b32 s70, s71, 7
    s_mul_i32 s71, s71, 393216
    s_add_u32 m0, s72, 24576
    s_add_u32 s66, s71, 2048
    buffer_load_dwordx4 v5, s[12:15], s66 offen lds
    s_add_u32 m0, s72, 26624
    s_add_u32 s66, s71, 100352
    buffer_load_dwordx4 v5, s[12:15], s66 offen lds
    s_add_u32 m0, s72, 28672
    s_add_u32 s66, s71, 198656
    buffer_load_dwordx4 v5, s[12:15], s66 offen lds
    s_add_u32 m0, s72, 30720
    s_add_u32 s66, s71, 296960
    buffer_load_dwordx4 v5, s[12:15], s66 offen lds
    s_add_u32 m0, s72, 0
    s_add_u32 s66, s70, 0
    buffer_load_dwordx4 v4, s[8:11], s66 offen lds
    s_add_u32 m0, s72, 2048
    s_add_u32 s66, s70, 32768
    buffer_load_dwordx4 v4, s[8:11], s66 offen lds
    s_add_u32 m0, s72, 4096
    s_add_u32 s66, s70, 65536
    buffer_load_dwordx4 v4, s[8:11], s66 offen lds
    s_add_u32 m0, s72, 6144
    s_add_u32 s66, s70, 98304
    buffer_load_dwordx4 v4, s[8:11], s66 offen lds
    s_add_u32 m0, s72, 8192
    s_add_u32 s66, s70, 131072
    buffer_load_dwordx4 v4, s[8:11], s66 offen lds
    s_add_u32 m0, s72, 10240
    s_add_u32 s66, s70, 163840
    buffer_load_dwordx4 v4, s[8:11], s66 offen lds
    s_add_u32 m0, s72, 12288
    s_add_u32 s66, s70, 196608
    buffer_load_dwordx4 v4, s[8:11], s66 offen lds
    s_add_u32 m0, s72, 14336
    s_add_u32 s66, s70, 229376
    buffer_load_dwordx4 v4, s[8:11], s66 offen lds
    s_add_u32 m0, s72, 32768
    s_add_u32 s66, s71, 4096
    buffer_load_dwordx4 v5, s[12:15], s66 offen lds
    s_add_u32 m0, s72, 34816
    s_add_u32 s66, s71, 102400
    buffer_load_dwordx4 v5, s[12:15], s66 offen lds
    s_add_u32 m0, s72, 36864
    s_add_u32 s66, s71, 200704
    buffer_load_dwordx4 v5, s[12:15], s66 offen lds
    s_add_u32 m0, s72, 38912
    s_add_u32 s66, s71, 299008
    buffer_load_dwordx4 v5, s[12:15], s66 offen lds
    s_add_u32 m0, s72, 16384
    s_add_u32 s66, s71, 0
    buffer_load_dwordx4 v5, s[12:15], s66 offen lds
    s_add_u32 m0, s72, 18432
    s_add_u32 s66, s71, 98304
    buffer_load_dwordx4 v5, s[12:15], s66 offen lds
    s_add_u32 m0, s72, 20480
    s_add_u32 s66, s71, 196608
    buffer_load_dwordx4 v5, s[12:15], s66 offen lds
    s_add_u32 m0, s72, 22528
    s_add_u32 s66, s71, 294912
    buffer_load_dwordx4 v5, s[12:15], s66 offen lds
    s_waitcnt vmcnt(20)
    s_barrier
    s_cmp_le_u32 s77, 7
    s_addc_u32 s71, s76, 7
    s_and_b32 s71, s71, 15
    s_lshl_b32 s70, s71, 7
    s_mul_i32 s71, s71, 393216
    s_add_u32 m0, s72, 65536
    s_add_u32 s66, s71, 2048
    buffer_load_dwordx4 v5, s[12:15], s66 offen lds
    s_add_u32 m0, s72, 67584
    s_add_u32 s66, s71, 100352
    buffer_load_dwordx4 v5, s[12:15], s66 offen lds
    s_add_u32 m0, s72, 69632
    s_add_u32 s66, s71, 198656
    buffer_load_dwordx4 v5, s[12:15], s66 offen lds
    s_add_u32 m0, s72, 71680
    s_add_u32 s66, s71, 296960
    buffer_load_dwordx4 v5, s[12:15], s66 offen lds
    s_add_u32 m0, s72, 40960
    s_add_u32 s66, s70, 0
    buffer_load_dwordx4 v4, s[8:11], s66 offen lds
    s_add_u32 m0, s72, 43008
    s_add_u32 s66, s70, 32768
    buffer_load_dwordx4 v4, s[8:11], s66 offen lds
    s_add_u32 m0, s72, 45056
    s_add_u32 s66, s70, 65536
    buffer_load_dwordx4 v4, s[8:11], s66 offen lds
    s_add_u32 m0, s72, 47104
    s_add_u32 s66, s70, 98304
    buffer_load_dwordx4 v4, s[8:11], s66 offen lds
    s_add_u32 m0, s72, 49152
    s_add_u32 s66, s70, 131072
    buffer_load_dwordx4 v4, s[8:11], s66 offen lds
    s_add_u32 m0, s72, 51200
    s_add_u32 s66, s70, 163840
    buffer_load_dwordx4 v4, s[8:11], s66 offen lds
    s_add_u32 m0, s72, 53248
    s_add_u32 s66, s70, 196608
    buffer_load_dwordx4 v4, s[8:11], s66 offen lds
    s_add_u32 m0, s72, 55296
    s_add_u32 s66, s70, 229376
    buffer_load_dwordx4 v4, s[8:11], s66 offen lds
    s_add_u32 m0, s72, 73728
    s_add_u32 s66, s71, 4096
    buffer_load_dwordx4 v5, s[12:15], s66 offen lds
    s_add_u32 m0, s72, 75776
    s_add_u32 s66, s71, 102400
    buffer_load_dwordx4 v5, s[12:15], s66 offen lds
    s_add_u32 m0, s72, 77824
    s_add_u32 s66, s71, 200704
    buffer_load_dwordx4 v5, s[12:15], s66 offen lds
    s_add_u32 m0, s72, 79872
    s_add_u32 s66, s71, 299008
    buffer_load_dwordx4 v5, s[12:15], s66 offen lds
    s_add_u32 m0, s72, 57344
    s_add_u32 s66, s71, 0
    buffer_load_dwordx4 v5, s[12:15], s66 offen lds
    s_add_u32 m0, s72, 59392
    s_add_u32 s66, s71, 98304
    buffer_load_dwordx4 v5, s[12:15], s66 offen lds
    s_add_u32 m0, s72, 61440
    s_add_u32 s66, s71, 196608
    buffer_load_dwordx4 v5, s[12:15], s66 offen lds
    s_add_u32 m0, s72, 63488
    s_add_u32 s66, s71, 294912
    buffer_load_dwordx4 v5, s[12:15], s66 offen lds
    s_waitcnt vmcnt(20)
    s_barrier
    s_cmp_le_u32 s77, 8
    s_addc_u32 s71, s76, 8
    s_and_b32 s71, s71, 15
    s_lshl_b32 s70, s71, 7
    s_mul_i32 s71, s71, 393216
    s_add_u32 m0, s72, 106496
    s_add_u32 s66, s71, 2048
    buffer_load_dwordx4 v5, s[12:15], s66 offen lds
    s_add_u32 m0, s72, 108544
    s_add_u32 s66, s71, 100352
    buffer_load_dwordx4 v5, s[12:15], s66 offen lds
    s_add_u32 m0, s72, 110592
    s_add_u32 s66, s71, 198656
    buffer_load_dwordx4 v5, s[12:15], s66 offen lds
    s_add_u32 m0, s72, 112640
    s_add_u32 s66, s71, 296960
    buffer_load_dwordx4 v5, s[12:15], s66 offen lds
    s_add_u32 m0, s72, 81920
    s_add_u32 s66, s70, 0
    buffer_load_dwordx4 v4, s[8:11], s66 offen lds
    s_add_u32 m0, s72, 83968
    s_add_u32 s66, s70, 32768
    buffer_load_dwordx4 v4, s[8:11], s66 offen lds
    s_add_u32 m0, s72, 86016
    s_add_u32 s66, s70, 65536
    buffer_load_dwordx4 v4, s[8:11], s66 offen lds
    s_add_u32 m0, s72, 88064
    s_add_u32 s66, s70, 98304
    buffer_load_dwordx4 v4, s[8:11], s66 offen lds
    s_add_u32 m0, s72, 90112
    s_add_u32 s66, s70, 131072
    buffer_load_dwordx4 v4, s[8:11], s66 offen lds
    s_add_u32 m0, s72, 92160
    s_add_u32 s66, s70, 163840
    buffer_load_dwordx4 v4, s[8:11], s66 offen lds
    s_add_u32 m0, s72, 94208
    s_add_u32 s66, s70, 196608
    buffer_load_dwordx4 v4, s[8:11], s66 offen lds
    s_add_u32 m0, s72, 96256
    s_add_u32 s66, s70, 229376
    buffer_load_dwordx4 v4, s[8:11], s66 offen lds
    s_add_u32 m0, s72, 114688
    s_add_u32 s66, s71, 4096
    buffer_load_dwordx4 v5, s[12:15], s66 offen lds
    s_add_u32 m0, s72, 116736
    s_add_u32 s66, s71, 102400
    buffer_load_dwordx4 v5, s[12:15], s66 offen lds
    s_add_u32 m0, s72, 118784
    s_add_u32 s66, s71, 200704
    buffer_load_dwordx4 v5, s[12:15], s66 offen lds
    s_add_u32 m0, s72, 120832
    s_add_u32 s66, s71, 299008
    buffer_load_dwordx4 v5, s[12:15], s66 offen lds
    s_add_u32 m0, s72, 98304
    s_add_u32 s66, s71, 0
    buffer_load_dwordx4 v5, s[12:15], s66 offen lds
    s_add_u32 m0, s72, 100352
    s_add_u32 s66, s71, 98304
    buffer_load_dwordx4 v5, s[12:15], s66 offen lds
    s_add_u32 m0, s72, 102400
    s_add_u32 s66, s71, 196608
    buffer_load_dwordx4 v5, s[12:15], s66 offen lds
    s_add_u32 m0, s72, 104448
    s_add_u32 s66, s71, 294912
    buffer_load_dwordx4 v5, s[12:15], s66 offen lds
    s_waitcnt vmcnt(20)
    s_barrier
    s_cmp_le_u32 s77, 9
    s_addc_u32 s71, s76, 9
    s_and_b32 s71, s71, 15
    s_lshl_b32 s70, s71, 7
    s_mul_i32 s71, s71, 393216
    s_add_u32 m0, s72, 24576
    s_add_u32 s66, s71, 2048
    buffer_load_dwordx4 v5, s[12:15], s66 offen lds
    s_add_u32 m0, s72, 26624
    s_add_u32 s66, s71, 100352
    buffer_load_dwordx4 v5, s[12:15], s66 offen lds
    s_add_u32 m0, s72, 28672
    s_add_u32 s66, s71, 198656
    buffer_load_dwordx4 v5, s[12:15], s66 offen lds
    s_add_u32 m0, s72, 30720
    s_add_u32 s66, s71, 296960
    buffer_load_dwordx4 v5, s[12:15], s66 offen lds
    s_add_u32 m0, s72, 0
    s_add_u32 s66, s70, 0
    buffer_load_dwordx4 v4, s[8:11], s66 offen lds
    s_add_u32 m0, s72, 2048
    s_add_u32 s66, s70, 32768
    buffer_load_dwordx4 v4, s[8:11], s66 offen lds
    s_add_u32 m0, s72, 4096
    s_add_u32 s66, s70, 65536
    buffer_load_dwordx4 v4, s[8:11], s66 offen lds
    s_add_u32 m0, s72, 6144
    s_add_u32 s66, s70, 98304
    buffer_load_dwordx4 v4, s[8:11], s66 offen lds
    s_add_u32 m0, s72, 8192
    s_add_u32 s66, s70, 131072
    buffer_load_dwordx4 v4, s[8:11], s66 offen lds
    s_add_u32 m0, s72, 10240
    s_add_u32 s66, s70, 163840
    buffer_load_dwordx4 v4, s[8:11], s66 offen lds
    s_add_u32 m0, s72, 12288
    s_add_u32 s66, s70, 196608
    buffer_load_dwordx4 v4, s[8:11], s66 offen lds
    s_add_u32 m0, s72, 14336
    s_add_u32 s66, s70, 229376
    buffer_load_dwordx4 v4, s[8:11], s66 offen lds
    s_add_u32 m0, s72, 32768
    s_add_u32 s66, s71, 4096
    buffer_load_dwordx4 v5, s[12:15], s66 offen lds
    s_add_u32 m0, s72, 34816
    s_add_u32 s66, s71, 102400
    buffer_load_dwordx4 v5, s[12:15], s66 offen lds
    s_add_u32 m0, s72, 36864
    s_add_u32 s66, s71, 200704
    buffer_load_dwordx4 v5, s[12:15], s66 offen lds
    s_add_u32 m0, s72, 38912
    s_add_u32 s66, s71, 299008
    buffer_load_dwordx4 v5, s[12:15], s66 offen lds
    s_add_u32 m0, s72, 16384
    s_add_u32 s66, s71, 0
    buffer_load_dwordx4 v5, s[12:15], s66 offen lds
    s_add_u32 m0, s72, 18432
    s_add_u32 s66, s71, 98304
    buffer_load_dwordx4 v5, s[12:15], s66 offen lds
    s_add_u32 m0, s72, 20480
    s_add_u32 s66, s71, 196608
    buffer_load_dwordx4 v5, s[12:15], s66 offen lds
    s_add_u32 m0, s72, 22528
    s_add_u32 s66, s71, 294912
    buffer_load_dwordx4 v5, s[12:15], s66 offen lds
    s_waitcnt vmcnt(20)
    s_barrier
    s_cmp_le_u32 s77, 10
    s_addc_u32 s71, s76, 10
    s_and_b32 s71, s71, 15
    s_lshl_b32 s70, s71, 7
    s_mul_i32 s71, s71, 393216
    s_add_u32 m0, s72, 65536
    s_add_u32 s66, s71, 2048
    buffer_load_dwordx4 v5, s[12:15], s66 offen lds
    s_add_u32 m0, s72, 67584
    s_add_u32 s66, s71, 100352
    buffer_load_dwordx4 v5, s[12:15], s66 offen lds
    s_add_u32 m0, s72, 69632
    s_add_u32 s66, s71, 198656
    buffer_load_dwordx4 v5, s[12:15], s66 offen lds
    s_add_u32 m0, s72, 71680
    s_add_u32 s66, s71, 296960
    buffer_load_dwordx4 v5, s[12:15], s66 offen lds
    s_add_u32 m0, s72, 40960
    s_add_u32 s66, s70, 0
    buffer_load_dwordx4 v4, s[8:11], s66 offen lds
    s_add_u32 m0, s72, 43008
    s_add_u32 s66, s70, 32768
    buffer_load_dwordx4 v4, s[8:11], s66 offen lds
    s_add_u32 m0, s72, 45056
    s_add_u32 s66, s70, 65536
    buffer_load_dwordx4 v4, s[8:11], s66 offen lds
    s_add_u32 m0, s72, 47104
    s_add_u32 s66, s70, 98304
    buffer_load_dwordx4 v4, s[8:11], s66 offen lds
    s_add_u32 m0, s72, 49152
    s_add_u32 s66, s70, 131072
    buffer_load_dwordx4 v4, s[8:11], s66 offen lds
    s_add_u32 m0, s72, 51200
    s_add_u32 s66, s70, 163840
    buffer_load_dwordx4 v4, s[8:11], s66 offen lds
    s_add_u32 m0, s72, 53248
    s_add_u32 s66, s70, 196608
    buffer_load_dwordx4 v4, s[8:11], s66 offen lds
    s_add_u32 m0, s72, 55296
    s_add_u32 s66, s70, 229376
    buffer_load_dwordx4 v4, s[8:11], s66 offen lds
    s_add_u32 m0, s72, 73728
    s_add_u32 s66, s71, 4096
    buffer_load_dwordx4 v5, s[12:15], s66 offen lds
    s_add_u32 m0, s72, 75776
    s_add_u32 s66, s71, 102400
    buffer_load_dwordx4 v5, s[12:15], s66 offen lds
    s_add_u32 m0, s72, 77824
    s_add_u32 s66, s71, 200704
    buffer_load_dwordx4 v5, s[12:15], s66 offen lds
    s_add_u32 m0, s72, 79872
    s_add_u32 s66, s71, 299008
    buffer_load_dwordx4 v5, s[12:15], s66 offen lds
    s_add_u32 m0, s72, 57344
    s_add_u32 s66, s71, 0
    buffer_load_dwordx4 v5, s[12:15], s66 offen lds
    s_add_u32 m0, s72, 59392
    s_add_u32 s66, s71, 98304
    buffer_load_dwordx4 v5, s[12:15], s66 offen lds
    s_add_u32 m0, s72, 61440
    s_add_u32 s66, s71, 196608
    buffer_load_dwordx4 v5, s[12:15], s66 offen lds
    s_add_u32 m0, s72, 63488
    s_add_u32 s66, s71, 294912
    buffer_load_dwordx4 v5, s[12:15], s66 offen lds
    s_waitcnt vmcnt(20)
    s_barrier
    s_cmp_le_u32 s77, 11
    s_addc_u32 s71, s76, 11
    s_and_b32 s71, s71, 15
    s_lshl_b32 s70, s71, 7
    s_mul_i32 s71, s71, 393216
    s_add_u32 m0, s72, 106496
    s_add_u32 s66, s71, 2048
    buffer_load_dwordx4 v5, s[12:15], s66 offen lds
    s_add_u32 m0, s72, 108544
    s_add_u32 s66, s71, 100352
    buffer_load_dwordx4 v5, s[12:15], s66 offen lds
    s_add_u32 m0, s72, 110592
    s_add_u32 s66, s71, 198656
    buffer_load_dwordx4 v5, s[12:15], s66 offen lds
    s_add_u32 m0, s72, 112640
    s_add_u32 s66, s71, 296960
    buffer_load_dwordx4 v5, s[12:15], s66 offen lds
    s_add_u32 m0, s72, 81920
    s_add_u32 s66, s70, 0
    buffer_load_dwordx4 v4, s[8:11], s66 offen lds
    s_add_u32 m0, s72, 83968
    s_add_u32 s66, s70, 32768
    buffer_load_dwordx4 v4, s[8:11], s66 offen lds
    s_add_u32 m0, s72, 86016
    s_add_u32 s66, s70, 65536
    buffer_load_dwordx4 v4, s[8:11], s66 offen lds
    s_add_u32 m0, s72, 88064
    s_add_u32 s66, s70, 98304
    buffer_load_dwordx4 v4, s[8:11], s66 offen lds
    s_add_u32 m0, s72, 90112
    s_add_u32 s66, s70, 131072
    buffer_load_dwordx4 v4, s[8:11], s66 offen lds
    s_add_u32 m0, s72, 92160
    s_add_u32 s66, s70, 163840
    buffer_load_dwordx4 v4, s[8:11], s66 offen lds
    s_add_u32 m0, s72, 94208
    s_add_u32 s66, s70, 196608
    buffer_load_dwordx4 v4, s[8:11], s66 offen lds
    s_add_u32 m0, s72, 96256
    s_add_u32 s66, s70, 229376
    buffer_load_dwordx4 v4, s[8:11], s66 offen lds
    s_add_u32 m0, s72, 114688
    s_add_u32 s66, s71, 4096
    buffer_load_dwordx4 v5, s[12:15], s66 offen lds
    s_add_u32 m0, s72, 116736
    s_add_u32 s66, s71, 102400
    buffer_load_dwordx4 v5, s[12:15], s66 offen lds
    s_add_u32 m0, s72, 118784
    s_add_u32 s66, s71, 200704
    buffer_load_dwordx4 v5, s[12:15], s66 offen lds
    s_add_u32 m0, s72, 120832
    s_add_u32 s66, s71, 299008
    buffer_load_dwordx4 v5, s[12:15], s66 offen lds
    s_add_u32 m0, s72, 98304
    s_add_u32 s66, s71, 0
    buffer_load_dwordx4 v5, s[12:15], s66 offen lds
    s_add_u32 m0, s72, 100352
    s_add_u32 s66, s71, 98304
    buffer_load_dwordx4 v5, s[12:15], s66 offen lds
    s_add_u32 m0, s72, 102400
    s_add_u32 s66, s71, 196608
    buffer_load_dwordx4 v5, s[12:15], s66 offen lds
    s_add_u32 m0, s72, 104448
    s_add_u32 s66, s71, 294912
    buffer_load_dwordx4 v5, s[12:15], s66 offen lds
    s_waitcnt vmcnt(20)
    s_barrier
    s_cmp_le_u32 s77, 12
    s_addc_u32 s71, s76, 12
    s_and_b32 s71, s71, 15
    s_lshl_b32 s70, s71, 7
    s_mul_i32 s71, s71, 393216
    s_add_u32 m0, s72, 24576
    s_add_u32 s66, s71, 2048
    buffer_load_dwordx4 v5, s[12:15], s66 offen lds
    s_add_u32 m0, s72, 26624
    s_add_u32 s66, s71, 100352
    buffer_load_dwordx4 v5, s[12:15], s66 offen lds
    s_add_u32 m0, s72, 28672
    s_add_u32 s66, s71, 198656
    buffer_load_dwordx4 v5, s[12:15], s66 offen lds
    s_add_u32 m0, s72, 30720
    s_add_u32 s66, s71, 296960
    buffer_load_dwordx4 v5, s[12:15], s66 offen lds
    s_add_u32 m0, s72, 0
    s_add_u32 s66, s70, 0
    buffer_load_dwordx4 v4, s[8:11], s66 offen lds
    s_add_u32 m0, s72, 2048
    s_add_u32 s66, s70, 32768
    buffer_load_dwordx4 v4, s[8:11], s66 offen lds
    s_add_u32 m0, s72, 4096
    s_add_u32 s66, s70, 65536
    buffer_load_dwordx4 v4, s[8:11], s66 offen lds
    s_add_u32 m0, s72, 6144
    s_add_u32 s66, s70, 98304
    buffer_load_dwordx4 v4, s[8:11], s66 offen lds
    s_add_u32 m0, s72, 8192
    s_add_u32 s66, s70, 131072
    buffer_load_dwordx4 v4, s[8:11], s66 offen lds
    s_add_u32 m0, s72, 10240
    s_add_u32 s66, s70, 163840
    buffer_load_dwordx4 v4, s[8:11], s66 offen lds
    s_add_u32 m0, s72, 12288
    s_add_u32 s66, s70, 196608
    buffer_load_dwordx4 v4, s[8:11], s66 offen lds
    s_add_u32 m0, s72, 14336
    s_add_u32 s66, s70, 229376
    buffer_load_dwordx4 v4, s[8:11], s66 offen lds
    s_add_u32 m0, s72, 32768
    s_add_u32 s66, s71, 4096
    buffer_load_dwordx4 v5, s[12:15], s66 offen lds
    s_add_u32 m0, s72, 34816
    s_add_u32 s66, s71, 102400
    buffer_load_dwordx4 v5, s[12:15], s66 offen lds
    s_add_u32 m0, s72, 36864
    s_add_u32 s66, s71, 200704
    buffer_load_dwordx4 v5, s[12:15], s66 offen lds
    s_add_u32 m0, s72, 38912
    s_add_u32 s66, s71, 299008
    buffer_load_dwordx4 v5, s[12:15], s66 offen lds
    s_add_u32 m0, s72, 16384
    s_add_u32 s66, s71, 0
    buffer_load_dwordx4 v5, s[12:15], s66 offen lds
    s_add_u32 m0, s72, 18432
    s_add_u32 s66, s71, 98304
    buffer_load_dwordx4 v5, s[12:15], s66 offen lds
    s_add_u32 m0, s72, 20480
    s_add_u32 s66, s71, 196608
    buffer_load_dwordx4 v5, s[12:15], s66 offen lds
    s_add_u32 m0, s72, 22528
    s_add_u32 s66, s71, 294912
    buffer_load_dwordx4 v5, s[12:15], s66 offen lds
    s_waitcnt vmcnt(20)
    s_barrier
    s_cmp_le_u32 s77, 13
    s_addc_u32 s71, s76, 13
    s_and_b32 s71, s71, 15
    s_lshl_b32 s70, s71, 7
    s_mul_i32 s71, s71, 393216
    s_add_u32 m0, s72, 65536
    s_add_u32 s66, s71, 2048
    buffer_load_dwordx4 v5, s[12:15], s66 offen lds
    s_add_u32 m0, s72, 67584
    s_add_u32 s66, s71, 100352
    buffer_load_dwordx4 v5, s[12:15], s66 offen lds
    s_add_u32 m0, s72, 69632
    s_add_u32 s66, s71, 198656
    buffer_load_dwordx4 v5, s[12:15], s66 offen lds
    s_add_u32 m0, s72, 71680
    s_add_u32 s66, s71, 296960
    buffer_load_dwordx4 v5, s[12:15], s66 offen lds
    s_add_u32 m0, s72, 40960
    s_add_u32 s66, s70, 0
    buffer_load_dwordx4 v4, s[8:11], s66 offen lds
    s_add_u32 m0, s72, 43008
    s_add_u32 s66, s70, 32768
    buffer_load_dwordx4 v4, s[8:11], s66 offen lds
    s_add_u32 m0, s72, 45056
    s_add_u32 s66, s70, 65536
    buffer_load_dwordx4 v4, s[8:11], s66 offen lds
    s_add_u32 m0, s72, 47104
    s_add_u32 s66, s70, 98304
    buffer_load_dwordx4 v4, s[8:11], s66 offen lds
    s_add_u32 m0, s72, 49152
    s_add_u32 s66, s70, 131072
    buffer_load_dwordx4 v4, s[8:11], s66 offen lds
    s_add_u32 m0, s72, 51200
    s_add_u32 s66, s70, 163840
    buffer_load_dwordx4 v4, s[8:11], s66 offen lds
    s_add_u32 m0, s72, 53248
    s_add_u32 s66, s70, 196608
    buffer_load_dwordx4 v4, s[8:11], s66 offen lds
    s_add_u32 m0, s72, 55296
    s_add_u32 s66, s70, 229376
    buffer_load_dwordx4 v4, s[8:11], s66 offen lds
    s_add_u32 m0, s72, 73728
    s_add_u32 s66, s71, 4096
    buffer_load_dwordx4 v5, s[12:15], s66 offen lds
    s_add_u32 m0, s72, 75776
    s_add_u32 s66, s71, 102400
    buffer_load_dwordx4 v5, s[12:15], s66 offen lds
    s_add_u32 m0, s72, 77824
    s_add_u32 s66, s71, 200704
    buffer_load_dwordx4 v5, s[12:15], s66 offen lds
    s_add_u32 m0, s72, 79872
    s_add_u32 s66, s71, 299008
    buffer_load_dwordx4 v5, s[12:15], s66 offen lds
    s_add_u32 m0, s72, 57344
    s_add_u32 s66, s71, 0
    buffer_load_dwordx4 v5, s[12:15], s66 offen lds
    s_add_u32 m0, s72, 59392
    s_add_u32 s66, s71, 98304
    buffer_load_dwordx4 v5, s[12:15], s66 offen lds
    s_add_u32 m0, s72, 61440
    s_add_u32 s66, s71, 196608
    buffer_load_dwordx4 v5, s[12:15], s66 offen lds
    s_add_u32 m0, s72, 63488
    s_add_u32 s66, s71, 294912
    buffer_load_dwordx4 v5, s[12:15], s66 offen lds
    s_waitcnt vmcnt(20)
    s_barrier
    s_cmp_le_u32 s77, 14
    s_addc_u32 s71, s76, 14
    s_and_b32 s71, s71, 15
    s_lshl_b32 s70, s71, 7
    s_mul_i32 s71, s71, 393216
    s_add_u32 m0, s72, 106496
    s_add_u32 s66, s71, 2048
    buffer_load_dwordx4 v5, s[12:15], s66 offen lds
    s_add_u32 m0, s72, 108544
    s_add_u32 s66, s71, 100352
    buffer_load_dwordx4 v5, s[12:15], s66 offen lds
    s_add_u32 m0, s72, 110592
    s_add_u32 s66, s71, 198656
    buffer_load_dwordx4 v5, s[12:15], s66 offen lds
    s_add_u32 m0, s72, 112640
    s_add_u32 s66, s71, 296960
    buffer_load_dwordx4 v5, s[12:15], s66 offen lds
    s_add_u32 m0, s72, 81920
    s_add_u32 s66, s70, 0
    buffer_load_dwordx4 v4, s[8:11], s66 offen lds
    s_add_u32 m0, s72, 83968
    s_add_u32 s66, s70, 32768
    buffer_load_dwordx4 v4, s[8:11], s66 offen lds
    s_add_u32 m0, s72, 86016
    s_add_u32 s66, s70, 65536
    buffer_load_dwordx4 v4, s[8:11], s66 offen lds
    s_add_u32 m0, s72, 88064
    s_add_u32 s66, s70, 98304
    buffer_load_dwordx4 v4, s[8:11], s66 offen lds
    s_add_u32 m0, s72, 90112
    s_add_u32 s66, s70, 131072
    buffer_load_dwordx4 v4, s[8:11], s66 offen lds
    s_add_u32 m0, s72, 92160
    s_add_u32 s66, s70, 163840
    buffer_load_dwordx4 v4, s[8:11], s66 offen lds
    s_add_u32 m0, s72, 94208
    s_add_u32 s66, s70, 196608
    buffer_load_dwordx4 v4, s[8:11], s66 offen lds
    s_add_u32 m0, s72, 96256
    s_add_u32 s66, s70, 229376
    buffer_load_dwordx4 v4, s[8:11], s66 offen lds
    s_add_u32 m0, s72, 114688
    s_add_u32 s66, s71, 4096
    buffer_load_dwordx4 v5, s[12:15], s66 offen lds
    s_add_u32 m0, s72, 116736
    s_add_u32 s66, s71, 102400
    buffer_load_dwordx4 v5, s[12:15], s66 offen lds
    s_add_u32 m0, s72, 118784
    s_add_u32 s66, s71, 200704
    buffer_load_dwordx4 v5, s[12:15], s66 offen lds
    s_add_u32 m0, s72, 120832
    s_add_u32 s66, s71, 299008
    buffer_load_dwordx4 v5, s[12:15], s66 offen lds
    s_add_u32 m0, s72, 98304
    s_add_u32 s66, s71, 0
    buffer_load_dwordx4 v5, s[12:15], s66 offen lds
    s_add_u32 m0, s72, 100352
    s_add_u32 s66, s71, 98304
    buffer_load_dwordx4 v5, s[12:15], s66 offen lds
    s_add_u32 m0, s72, 102400
    s_add_u32 s66, s71, 196608
    buffer_load_dwordx4 v5, s[12:15], s66 offen lds
    s_add_u32 m0, s72, 104448
    s_add_u32 s66, s71, 294912
    buffer_load_dwordx4 v5, s[12:15], s66 offen lds
    s_mov_b32 s71, s5
    s_lshl_b32 s70, s71, 7
    s_mul_i32 s71, s71, 393216
    s_add_u32 m0, s72, 139264
    s_add_u32 s66, s71, 2048
    buffer_load_dwordx4 v5, s[12:15], s66 offen lds
    s_add_u32 m0, s72, 141312
    s_add_u32 s66, s71, 100352
    buffer_load_dwordx4 v5, s[12:15], s66 offen lds
    s_add_u32 m0, s72, 143360
    s_add_u32 s66, s71, 198656
    buffer_load_dwordx4 v5, s[12:15], s66 offen lds
    s_add_u32 m0, s72, 145408
    s_add_u32 s66, s71, 296960
    buffer_load_dwordx4 v5, s[12:15], s66 offen lds
    s_waitcnt vmcnt(24)
    s_barrier
    s_mov_b32 s71, s5
    s_lshl_b32 s70, s71, 7
    s_mul_i32 s71, s71, 393216
    s_add_u32 m0, s72, 122880
    s_add_u32 s66, s70, 0
    buffer_load_dwordx4 v4, s[8:11], s66 offen lds
    s_add_u32 m0, s72, 124928
    s_add_u32 s66, s70, 32768
    buffer_load_dwordx4 v4, s[8:11], s66 offen lds
    s_add_u32 m0, s72, 126976
    s_add_u32 s66, s70, 65536
    buffer_load_dwordx4 v4, s[8:11], s66 offen lds
    s_add_u32 m0, s72, 129024
    s_add_u32 s66, s70, 98304
    buffer_load_dwordx4 v4, s[8:11], s66 offen lds
    s_add_u32 m0, s72, 131072
    s_add_u32 s66, s70, 131072
    buffer_load_dwordx4 v4, s[8:11], s66 offen lds
    s_add_u32 m0, s72, 133120
    s_add_u32 s66, s70, 163840
    buffer_load_dwordx4 v4, s[8:11], s66 offen lds
    s_add_u32 m0, s72, 135168
    s_add_u32 s66, s70, 196608
    buffer_load_dwordx4 v4, s[8:11], s66 offen lds
    s_add_u32 m0, s72, 137216
    s_add_u32 s66, s70, 229376
    buffer_load_dwordx4 v4, s[8:11], s66 offen lds
    s_mov_b32 s71, s5
    s_lshl_b32 s70, s71, 7
    s_mul_i32 s71, s71, 393216
    s_add_u32 m0, s72, 147456
    s_add_u32 s66, s71, 4096
    buffer_load_dwordx4 v5, s[12:15], s66 offen lds
    s_add_u32 m0, s72, 149504
    s_add_u32 s66, s71, 102400
    buffer_load_dwordx4 v5, s[12:15], s66 offen lds
    s_add_u32 m0, s72, 151552
    s_add_u32 s66, s71, 200704
    buffer_load_dwordx4 v5, s[12:15], s66 offen lds
    s_add_u32 m0, s72, 153600
    s_add_u32 s66, s71, 299008
    buffer_load_dwordx4 v5, s[12:15], s66 offen lds
    s_add_u32 m0, s72, 16384
    s_add_u32 s66, s71, 0
    buffer_load_dwordx4 v5, s[12:15], s66 offen lds
    s_add_u32 m0, s72, 18432
    s_add_u32 s66, s71, 98304
    buffer_load_dwordx4 v5, s[12:15], s66 offen lds
    s_add_u32 m0, s72, 20480
    s_add_u32 s66, s71, 196608
    buffer_load_dwordx4 v5, s[12:15], s66 offen lds
    s_add_u32 m0, s72, 22528
    s_add_u32 s66, s71, 294912
    buffer_load_dwordx4 v5, s[12:15], s66 offen lds
    s_waitcnt vmcnt(20)
    s_barrier
    s_mov_b32 s66, 0
    buffer_load_dwordx4 v[96:99], v7, s[32:35], s66 offen
    s_mov_b32 s66, 2048
    buffer_load_dwordx4 v[100:103], v7, s[32:35], s66 offen
    s_mov_b32 s66, 4096
    buffer_load_dwordx4 v[104:107], v7, s[32:35], s66 offen
    s_mov_b32 s66, 6144
    buffer_load_dwordx4 v[108:111], v7, s[32:35], s66 offen
    s_mov_b32 s66, 8192
    buffer_load_dwordx4 v[112:115], v7, s[32:35], s66 offen
    s_mov_b32 s66, 10240
    buffer_load_dwordx4 v[116:119], v7, s[32:35], s66 offen
    s_mov_b32 s66, 12288
    buffer_load_dwordx4 v[120:123], v7, s[32:35], s66 offen
    s_mov_b32 s66, 14336
    buffer_load_dwordx4 v[124:127], v7, s[32:35], s66 offen
    s_waitcnt vmcnt(8)
    s_branch H_b14
WORK:
    v_mov_b32 v14, 0
    v_lshlrev_b32 v8, 5, v2
    v_add_u32 v8, 6127616, v8
    s_lshl_b32 s66, s2, 2
    s_add_u32 s66, s66, s44
    s_cmp_lg_u32 s66, 2
    s_cbranch_scc1 W_nn
    s_movk_i32 s66, 0
    buffer_load_dword v72, v8, s[16:19], s66 offen offset:4 sc1
    s_movk_i32 s66, 2048
    buffer_load_dword v73, v8, s[16:19], s66 offen offset:4 sc1
    s_movk_i32 s66, 4096
    buffer_load_dword v74, v8, s[16:19], s66 offen offset:4 sc1
    s_movk_i32 s66, 6144
    buffer_load_dword v75, v8, s[16:19], s66 offen offset:4 sc1
    s_memrealtime s[66:67]
    s_waitcnt vmcnt(0) lgkmcnt(0)
    s_or_b32 s66, s66, 1
W_nl:
    s_add_u32 s66, s66, 2
    v_cmp_eq_u32 vcc, s66, v72
    v_cmp_eq_u32 s[68:69], s66, v73
    s_or_b64 vcc, vcc, s[68:69]
    v_cmp_eq_u32 s[68:69], s66, v74
    s_or_b64 vcc, vcc, s[68:69]
    v_cmp_eq_u32 s[68:69], s66, v75
    s_or_b64 vcc, vcc, s[68:69]
    s_cbranch_vccnz W_nl
    v_mov_b32 v10, 0
    v_mov_b32 v11, s66
    s_mov_b64 exec, 1
    buffer_store_dword v11, v10, s[40:43], 0 offen sc0 sc1
    s_mov_b64 exec, -1
W_nn:
    s_and_b32 s48, s44, 1
    s_waitcnt vmcnt(5)
    s_barrier
    s_waitcnt vmcnt(0)
    s_barrier
    s_lshl_b32 s50, s4, 7
    s_lshl_b32 s66, s5, 3
    s_add_u32 s50, s50, s66
    s_lshl_b32 s66, s48, 2
    s_add_u32 s50, s50, s66
    s_lshl_b32 s66, s50, 11
    s_add_u32 s67, s66, 4096
    buffer_load_dwordx4 v[16:19], v9, s[8:11], s66 offen offset:0
    buffer_load_dwordx4 v[20:23], v9, s[8:11], s66 offen offset:1024
    buffer_load_dwordx4 v[24:27], v9, s[8:11], s66 offen offset:2048
    buffer_load_dwordx4 v[28:31], v9, s[8:11], s66 offen offset:3072
    buffer_load_dwordx4 v[32:35], v9, s[8:11], s67 offen offset:0
    buffer_load_dwordx4 v[36:39], v9, s[8:11], s67 offen offset:1024
    buffer_load_dwordx4 v[40:43], v9, s[8:11], s67 offen offset:2048
    buffer_load_dwordx4 v[44:47], v9, s[8:11], s67 offen offset:3072
    s_lshl_b32 s66, s48, 11
    s_add_u32 m0, s66, 159744
    s_nop 0
    buffer_load_dwordx4 v9, s[24:27], 0 offen offset:0 lds
    buffer_load_dwordx4 v9, s[24:27], 0 offen offset:1024 lds
    s_lshl_b32 s66, s79, 2
    s_add_u32 s66, s66, s73
    s_and_b32 s51, s66, 15
    s_lshr_b32 s67, s66, 4
    s_lshl_b32 s54, s67, 5
    s_lshl_b32 s66, s48, 4
    s_add_u32 s54, s54, s66
    s_add_u32 s54, s54, s51
    s_lshl_b32 s54, s54, 10
    s_add_u32 s54, s54, 5308416
    s_lshl_b32 s51, s51, 6
    v_lshrrev_b32 v10, 5, v2
    v_and_b32 v11, 31, v2
    v_lshlrev_b32 v12, 5, v10
    v_add_u32 v12, s51, v12
    v_mul_u32_u24 v12, 7168, v12
    v_lshl_add_u32 v12, v11, 4, v12
    s_lshl_b32 s67, s67, 9
    v_add_u32 v6, s67, v12
    v_mov_b32 v72, -1
    v_mov_b32 v73, -1
    v_mov_b32 v74, -1
    v_mov_b32 v75, -1
    v_and_b32 v12, 3, v2
    v_lshlrev_b32 v12, 4, v12
    v_add_u32 v12, s53, v12
    s_add_u32 s66, s53, 4294965248
    v_subrev_u32 v13, 4, v2
    v_cmp_gt_u32 vcc, 4, v13
    v_lshlrev_b32 v13, 4, v13
    v_add_u32 v13, s66, v13
    v_cndmask_b32 v12, v12, v13, vcc
    s_add_u32 s66, s55, 0
    v_subrev_u32 v13, 24, v2
    v_cmp_gt_u32 vcc, 16, v13
    v_lshlrev_b32 v13, 4, v13
    v_add_u32 v13, s66, v13
    v_cndmask_b32 v12, v12, v13, vcc
    s_add_u32 s66, s55, 4294934528
    v_subrev_u32 v13, 40, v2
    v_cmp_gt_u32 vcc, 16, v13
    v_lshlrev_b32 v13, 4, v13
    v_add_u32 v13, s66, v13
    v_cndmask_b32 v12, v12, v13, vcc
    s_sub_u32 s66, s56, 32768
    buffer_store_dwordx4 v[72:75], v9, s[16:19], s56 offen sc0 sc1
    buffer_store_dwordx4 v[72:75], v9, s[16:19], s66 offen sc0 sc1
    buffer_store_dwordx4 v[72:75], v9, s[16:19], s54 offen sc0 sc1
    buffer_store_dwordx4 v[72:75], v12, s[16:19], 0 offen sc0 sc1
    s_waitcnt vmcnt(4)
    s_barrier
    s_cmp_lg_u32 s48, 0
    s_cbranch_scc1 W_k1
    buffer_load_dword v15, v14, s[40:43], 0 offen sc1
W_k1:
    v_add_u32 v10, 159744, v9
    v_bfe_u32 v3, v2, 4, 1
    v_lshrrev_b32 v11, 5, v2
    v_lshl_add_u32 v3, v3, 1, v11
    s_mov_b32 s67, 0xffff0000
    s_mov_b32 s68, 0x00010001
    s_mov_b32 s69, 0x00010001
    ds_read_b128 v[48:51], v10 offset:0
    ds_read_b128 v[52:55], v10 offset:1024
    v_mov_b32 v72, 0
    v_mov_b32 v73, 0
    v_mov_b32 v74, 0
    v_mov_b32 v75, 0
    s_waitcnt lgkmcnt(0)
    v_dot2_f32_bf16 v72, v16, v48, v72
    v_dot2_f32_bf16 v73, v24, v48, v73
    v_dot2_f32_bf16 v74, v32, v48, v74
    v_dot2_f32_bf16 v75, v40, v48, v75
    v_dot2_f32_bf16 v72, v17, v49, v72
    v_dot2_f32_bf16 v73, v25, v49, v73
    v_dot2_f32_bf16 v74, v33, v49, v74
    v_dot2_f32_bf16 v75, v41, v49, v75
    v_dot2_f32_bf16 v72, v18, v50, v72
    v_dot2_f32_bf16 v73, v26, v50, v73
    v_dot2_f32_bf16 v74, v34, v50, v74
    v_dot2_f32_bf16 v75, v42, v50, v75
    v_dot2_f32_bf16 v72, v19, v51, v72
    v_dot2_f32_bf16 v73, v27, v51, v73
    v_dot2_f32_bf16 v74, v35, v51, v74
    v_dot2_f32_bf16 v75, v43, v51, v75
    v_dot2_f32_bf16 v72, v20, v52, v72
    v_dot2_f32_bf16 v73, v28, v52, v73
    v_dot2_f32_bf16 v74, v36, v52, v74
    v_dot2_f32_bf16 v75, v44, v52, v75
    v_dot2_f32_bf16 v72, v21, v53, v72
    v_dot2_f32_bf16 v73, v29, v53, v73
    v_dot2_f32_bf16 v74, v37, v53, v74
    v_dot2_f32_bf16 v75, v45, v53, v75
    v_dot2_f32_bf16 v72, v22, v54, v72
    v_dot2_f32_bf16 v73, v30, v54, v73
    v_dot2_f32_bf16 v74, v38, v54, v74
    v_dot2_f32_bf16 v75, v46, v54, v75
    v_dot2_f32_bf16 v72, v23, v55, v72
    v_dot2_f32_bf16 v73, v31, v55, v73
    v_dot2_f32_bf16 v74, v39, v55, v74
    v_dot2_f32_bf16 v75, v47, v55, v75
    s_nop 2
    ds_read_b128 v[48:51], v10 offset:2048
    ds_read_b128 v[52:55], v10 offset:3072
    s_nop 1
    v_permlane32_swap_b32 v72, v73
    v_permlane32_swap_b32 v74, v75
    v_add_f32 v72, v72, v73
    v_add_f32 v74, v74, v75
    s_nop 1
    v_permlane16_swap_b32 v72, v74
    v_add_f32 v72, v72, v74
    s_nop 1
    v_add_f32_dpp v72, v72, v72 quad_perm:[1,0,3,2] row_mask:0xf bank_mask:0xf
    s_nop 1
    v_add_f32_dpp v72, v72, v72 quad_perm:[2,3,0,1] row_mask:0xf bank_mask:0xf
    s_nop 1
    v_add_f32_dpp v72, v72, v72 row_half_mirror row_mask:0xf bank_mask:0xf
    s_nop 1
    v_add_f32_dpp v72, v72, v72 row_mirror row_mask:0xf bank_mask:0xf
    s_sub_u32 s66, 34815, s50
    v_cvt_pk_bf16_f32 v72, 0, v72
    v_sub_u32 v73, s66, v3
    v_ashrrev_i32 v76, 31, v72
    v_or_b32 v76, 0x80000000, v76
    v_xor_b32 v72, v72, v76
    v_and_or_b32 v72, v72, s67, v73
    v_mov_b32 v10, 155680
    s_mov_b64 exec, s[68:69]
    ds_max_u32 v10, v72
    s_mov_b64 exec, -1
    s_waitcnt vmcnt(0)
    s_waitcnt lgkmcnt(0)
    s_barrier
    s_cmp_lg_u32 s48, 0
    s_cbranch_scc1 W_k2
    v_mov_b32 v10, 155680
    ds_read_b32 v12, v10
    s_waitcnt vmcnt(0)
    s_mov_b32 s67, 0
W_ts:
    v_cmp_eq_u32 vcc, 0, v15
    s_cbranch_vccz W_tok
    s_add_u32 s67, s67, 1
    s_cmp_ge_u32 s67, 200000
    s_cbranch_scc1 W_tok
    s_sleep 4
    buffer_load_dword v15, v14, s[40:43], 0 offen sc1
    s_waitcnt vmcnt(0)
    s_branch W_ts
W_tok:
    s_lshl_b32 s66, s2, 5
    s_add_u32 s66, s66, 6127616
    v_mov_b32 v10, s66
    v_mov_b32 v13, v15
    s_waitcnt lgkmcnt(0)
    s_mov_b64 exec, 1
    buffer_store_dwordx2 v[12:13], v10, s[16:19], 0 offen sc0 sc1
    s_mov_b64 exec, -1
W_k2:
    v_mov_b32 v248, -1
    v_mov_b32 v249, -1
    v_mov_b32 v250, -1
    v_mov_b32 v251, -1
    s_lshl_b32 s67, s4, 3
    s_lshl_b32 s66, s48, 2
    s_add_u32 s67, s67, s66
    s_lshl_b32 s67, s67, 15
    s_lshl_b32 s66, s5, 11
    s_add_u32 s67, s67, s66
    s_add_u32 s66, s67, 0
    buffer_store_dwordx4 v[248:251], v9, s[16:19], s66 offen offset:0 sc0 sc1
    s_add_u32 s66, s67, 0
    buffer_store_dwordx4 v[248:251], v9, s[16:19], s66 offen offset:1024 sc0 sc1
    s_add_u32 s66, s67, 32768
    buffer_store_dwordx4 v[248:251], v9, s[16:19], s66 offen offset:0 sc0 sc1
    s_add_u32 s66, s67, 32768
    buffer_store_dwordx4 v[248:251], v9, s[16:19], s66 offen offset:1024 sc0 sc1
    s_add_u32 s66, s67, 65536
    buffer_store_dwordx4 v[248:251], v9, s[16:19], s66 offen offset:0 sc0 sc1
    s_add_u32 s66, s67, 65536
    buffer_store_dwordx4 v[248:251], v9, s[16:19], s66 offen offset:1024 sc0 sc1
    s_add_u32 s66, s67, 98304
    buffer_store_dwordx4 v[248:251], v9, s[16:19], s66 offen offset:0 sc0 sc1
    s_add_u32 s66, s67, 98304
    buffer_store_dwordx4 v[248:251], v9, s[16:19], s66 offen offset:1024 sc0 sc1
    v_lshlrev_b32 v56, 16, v48
    v_and_b32 v57, 0xffff0000, v48
    v_lshlrev_b32 v58, 16, v49
    v_and_b32 v59, 0xffff0000, v49
    v_lshlrev_b32 v60, 16, v50
    v_and_b32 v61, 0xffff0000, v50
    v_lshlrev_b32 v62, 16, v51
    v_and_b32 v63, 0xffff0000, v51
    v_lshlrev_b32 v64, 16, v52
    v_and_b32 v65, 0xffff0000, v52
    v_lshlrev_b32 v66, 16, v53
    v_and_b32 v67, 0xffff0000, v53
    v_lshlrev_b32 v68, 16, v54
    v_and_b32 v69, 0xffff0000, v54
    v_lshlrev_b32 v70, 16, v55
    v_and_b32 v71, 0xffff0000, v55
    v_mov_b32 v76, 0
    v_lshlrev_b32 v72, 16, v16
    v_and_b32 v73, 0xffff0000, v16
    v_mul_f32 v72, v72, v56
    v_mul_f32 v73, v73, v57
    v_cvt_pk_bf16_f32 v72, 0, v72
    v_cvt_pk_bf16_f32 v73, 0, v73
    v_add_f32 v76, v76, v72
    v_add_f32 v76, v76, v73
    v_lshlrev_b32 v72, 16, v17
    v_and_b32 v73, 0xffff0000, v17
    v_mul_f32 v72, v72, v58
    v_mul_f32 v73, v73, v59
    v_cvt_pk_bf16_f32 v72, 0, v72
    v_cvt_pk_bf16_f32 v73, 0, v73
    v_add_f32 v76, v76, v72
    v_add_f32 v76, v76, v73
    v_lshlrev_b32 v72, 16, v18
    v_and_b32 v73, 0xffff0000, v18
    v_mul_f32 v72, v72, v60
    v_mul_f32 v73, v73, v61
    v_cvt_pk_bf16_f32 v72, 0, v72
    v_cvt_pk_bf16_f32 v73, 0, v73
    v_add_f32 v76, v76, v72
    v_add_f32 v76, v76, v73
    v_lshlrev_b32 v72, 16, v19
    v_and_b32 v73, 0xffff0000, v19
    v_mul_f32 v72, v72, v62
    v_mul_f32 v73, v73, v63
    v_cvt_pk_bf16_f32 v72, 0, v72
    v_cvt_pk_bf16_f32 v73, 0, v73
    v_add_f32 v76, v76, v72
    v_add_f32 v76, v76, v73
    v_lshlrev_b32 v72, 16, v20
    v_and_b32 v73, 0xffff0000, v20
    v_mul_f32 v72, v72, v64
    v_mul_f32 v73, v73, v65
    v_cvt_pk_bf16_f32 v72, 0, v72
    v_cvt_pk_bf16_f32 v73, 0, v73
    v_add_f32 v76, v76, v72
    v_add_f32 v76, v76, v73
    v_lshlrev_b32 v72, 16, v21
    v_and_b32 v73, 0xffff0000, v21
    v_mul_f32 v72, v72, v66
    v_mul_f32 v73, v73, v67
    v_cvt_pk_bf16_f32 v72, 0, v72
    v_cvt_pk_bf16_f32 v73, 0, v73
    v_add_f32 v76, v76, v72
    v_add_f32 v76, v76, v73
    v_lshlrev_b32 v72, 16, v22
    v_and_b32 v73, 0xffff0000, v22
    v_mul_f32 v72, v72, v68
    v_mul_f32 v73, v73, v69
    v_cvt_pk_bf16_f32 v72, 0, v72
    v_cvt_pk_bf16_f32 v73, 0, v73
    v_add_f32 v76, v76, v72
    v_add_f32 v76, v76, v73
    v_lshlrev_b32 v72, 16, v23
    v_and_b32 v73, 0xffff0000, v23
    v_mul_f32 v72, v72, v70
    v_mul_f32 v73, v73, v71
    v_cvt_pk_bf16_f32 v72, 0, v72
    v_cvt_pk_bf16_f32 v73, 0, v73
    v_add_f32 v76, v76, v72
    v_add_f32 v76, v76, v73
    s_barrier
    s_mov_b32 s66, 0
    buffer_load_dwordx4 v[96:99], v6, s[28:31], s66 offen
    s_mov_b32 s66, 7168
    buffer_load_dwordx4 v[100:103], v6, s[28:31], s66 offen
    s_mov_b32 s66, 14336
    buffer_load_dwordx4 v[104:107], v6, s[28:31], s66 offen
    s_mov_b32 s66, 21504
    buffer_load_dwordx4 v[108:111], v6, s[28:31], s66 offen
    s_mov_b32 s66, 28672
    buffer_load_dwordx4 v[112:115], v6, s[28:31], s66 offen
    s_mov_b32 s66, 35840
    buffer_load_dwordx4 v[116:119], v6, s[28:31], s66 offen
    s_mov_b32 s66, 43008
    buffer_load_dwordx4 v[120:123], v6, s[28:31], s66 offen
    s_mov_b32 s66, 50176
    buffer_load_dwordx4 v[124:127], v6, s[28:31], s66 offen
    v_mov_b32 v77, 0
    v_lshlrev_b32 v72, 16, v24
    v_and_b32 v73, 0xffff0000, v24
    v_mul_f32 v72, v72, v56
    v_mul_f32 v73, v73, v57
    v_cvt_pk_bf16_f32 v72, 0, v72
    v_cvt_pk_bf16_f32 v73, 0, v73
    v_add_f32 v77, v77, v72
    v_add_f32 v77, v77, v73
    v_lshlrev_b32 v72, 16, v25
    v_and_b32 v73, 0xffff0000, v25
    v_mul_f32 v72, v72, v58
    v_mul_f32 v73, v73, v59
    v_cvt_pk_bf16_f32 v72, 0, v72
    v_cvt_pk_bf16_f32 v73, 0, v73
    v_add_f32 v77, v77, v72
    v_add_f32 v77, v77, v73
    v_lshlrev_b32 v72, 16, v26
    v_and_b32 v73, 0xffff0000, v26
    v_mul_f32 v72, v72, v60
    v_mul_f32 v73, v73, v61
    v_cvt_pk_bf16_f32 v72, 0, v72
    v_cvt_pk_bf16_f32 v73, 0, v73
    v_add_f32 v77, v77, v72
    v_add_f32 v77, v77, v73
    v_lshlrev_b32 v72, 16, v27
    v_and_b32 v73, 0xffff0000, v27
    v_mul_f32 v72, v72, v62
    v_mul_f32 v73, v73, v63
    v_cvt_pk_bf16_f32 v72, 0, v72
    v_cvt_pk_bf16_f32 v73, 0, v73
    v_add_f32 v77, v77, v72
    v_add_f32 v77, v77, v73
    v_lshlrev_b32 v72, 16, v28
    v_and_b32 v73, 0xffff0000, v28
    v_mul_f32 v72, v72, v64
    v_mul_f32 v73, v73, v65
    v_cvt_pk_bf16_f32 v72, 0, v72
    v_cvt_pk_bf16_f32 v73, 0, v73
    v_add_f32 v77, v77, v72
    v_add_f32 v77, v77, v73
    v_lshlrev_b32 v72, 16, v29
    v_and_b32 v73, 0xffff0000, v29
    v_mul_f32 v72, v72, v66
    v_mul_f32 v73, v73, v67
    v_cvt_pk_bf16_f32 v72, 0, v72
    v_cvt_pk_bf16_f32 v73, 0, v73
    v_add_f32 v77, v77, v72
    v_add_f32 v77, v77, v73
    v_lshlrev_b32 v72, 16, v30
    v_and_b32 v73, 0xffff0000, v30
    v_mul_f32 v72, v72, v68
    v_mul_f32 v73, v73, v69
    v_cvt_pk_bf16_f32 v72, 0, v72
    v_cvt_pk_bf16_f32 v73, 0, v73
    v_add_f32 v77, v77, v72
    v_add_f32 v77, v77, v73
    v_lshlrev_b32 v72, 16, v31
    v_and_b32 v73, 0xffff0000, v31
    v_mul_f32 v72, v72, v70
    v_mul_f32 v73, v73, v71
    v_cvt_pk_bf16_f32 v72, 0, v72
    v_cvt_pk_bf16_f32 v73, 0, v73
    v_add_f32 v77, v77, v72
    v_add_f32 v77, v77, v73
    v_mov_b32 v78, 0
    v_lshlrev_b32 v72, 16, v32
    v_and_b32 v73, 0xffff0000, v32
    v_mul_f32 v72, v72, v56
    v_mul_f32 v73, v73, v57
    v_cvt_pk_bf16_f32 v72, 0, v72
    v_cvt_pk_bf16_f32 v73, 0, v73
    v_add_f32 v78, v78, v72
    v_add_f32 v78, v78, v73
    v_lshlrev_b32 v72, 16, v33
    v_and_b32 v73, 0xffff0000, v33
    v_mul_f32 v72, v72, v58
    v_mul_f32 v73, v73, v59
    v_cvt_pk_bf16_f32 v72, 0, v72
    v_cvt_pk_bf16_f32 v73, 0, v73
    v_add_f32 v78, v78, v72
    v_add_f32 v78, v78, v73
    v_lshlrev_b32 v72, 16, v34
    v_and_b32 v73, 0xffff0000, v34
    v_mul_f32 v72, v72, v60
    v_mul_f32 v73, v73, v61
    v_cvt_pk_bf16_f32 v72, 0, v72
    v_cvt_pk_bf16_f32 v73, 0, v73
    v_add_f32 v78, v78, v72
    v_add_f32 v78, v78, v73
    v_lshlrev_b32 v72, 16, v35
    v_and_b32 v73, 0xffff0000, v35
    v_mul_f32 v72, v72, v62
    v_mul_f32 v73, v73, v63
    v_cvt_pk_bf16_f32 v72, 0, v72
    v_cvt_pk_bf16_f32 v73, 0, v73
    v_add_f32 v78, v78, v72
    v_add_f32 v78, v78, v73
    v_lshlrev_b32 v72, 16, v36
    v_and_b32 v73, 0xffff0000, v36
    v_mul_f32 v72, v72, v64
    v_mul_f32 v73, v73, v65
    v_cvt_pk_bf16_f32 v72, 0, v72
    v_cvt_pk_bf16_f32 v73, 0, v73
    v_add_f32 v78, v78, v72
    v_add_f32 v78, v78, v73
    v_lshlrev_b32 v72, 16, v37
    v_and_b32 v73, 0xffff0000, v37
    v_mul_f32 v72, v72, v66
    v_mul_f32 v73, v73, v67
    v_cvt_pk_bf16_f32 v72, 0, v72
    v_cvt_pk_bf16_f32 v73, 0, v73
    v_add_f32 v78, v78, v72
    v_add_f32 v78, v78, v73
    v_lshlrev_b32 v72, 16, v38
    v_and_b32 v73, 0xffff0000, v38
    v_mul_f32 v72, v72, v68
    v_mul_f32 v73, v73, v69
    v_cvt_pk_bf16_f32 v72, 0, v72
    v_cvt_pk_bf16_f32 v73, 0, v73
    v_add_f32 v78, v78, v72
    v_add_f32 v78, v78, v73
    v_lshlrev_b32 v72, 16, v39
    v_and_b32 v73, 0xffff0000, v39
    v_mul_f32 v72, v72, v70
    v_mul_f32 v73, v73, v71
    v_cvt_pk_bf16_f32 v72, 0, v72
    v_cvt_pk_bf16_f32 v73, 0, v73
    v_add_f32 v78, v78, v72
    v_add_f32 v78, v78, v73
    s_barrier
    s_cmp_lg_u32 s48, 0
    s_cbranch_scc1 W_k4
    s_movk_i32 s66, 0
    buffer_load_dwordx2 v[224:225], v8, s[16:19], s66 offen sc1
    s_movk_i32 s66, 2048
    buffer_load_dwordx2 v[226:227], v8, s[16:19], s66 offen sc1
    s_movk_i32 s66, 4096
    buffer_load_dwordx2 v[228:229], v8, s[16:19], s66 offen sc1
    s_movk_i32 s66, 6144
    buffer_load_dwordx2 v[230:231], v8, s[16:19], s66 offen sc1
W_k4:
    v_mov_b32 v79, 0
    v_lshlrev_b32 v72, 16, v40
    v_and_b32 v73, 0xffff0000, v40
    v_mul_f32 v72, v72, v56
    v_mul_f32 v73, v73, v57
    v_cvt_pk_bf16_f32 v72, 0, v72
    v_cvt_pk_bf16_f32 v73, 0, v73
    v_add_f32 v79, v79, v72
    v_add_f32 v79, v79, v73
    v_lshlrev_b32 v72, 16, v41
    v_and_b32 v73, 0xffff0000, v41
    v_mul_f32 v72, v72, v58
    v_mul_f32 v73, v73, v59
    v_cvt_pk_bf16_f32 v72, 0, v72
    v_cvt_pk_bf16_f32 v73, 0, v73
    v_add_f32 v79, v79, v72
    v_add_f32 v79, v79, v73
    v_lshlrev_b32 v72, 16, v42
    v_and_b32 v73, 0xffff0000, v42
    v_mul_f32 v72, v72, v60
    v_mul_f32 v73, v73, v61
    v_cvt_pk_bf16_f32 v72, 0, v72
    v_cvt_pk_bf16_f32 v73, 0, v73
    v_add_f32 v79, v79, v72
    v_add_f32 v79, v79, v73
    v_lshlrev_b32 v72, 16, v43
    v_and_b32 v73, 0xffff0000, v43
    v_mul_f32 v72, v72, v62
    v_mul_f32 v73, v73, v63
    v_cvt_pk_bf16_f32 v72, 0, v72
    v_cvt_pk_bf16_f32 v73, 0, v73
    v_add_f32 v79, v79, v72
    v_add_f32 v79, v79, v73
    v_lshlrev_b32 v72, 16, v44
    v_and_b32 v73, 0xffff0000, v44
    v_mul_f32 v72, v72, v64
    v_mul_f32 v73, v73, v65
    v_cvt_pk_bf16_f32 v72, 0, v72
    v_cvt_pk_bf16_f32 v73, 0, v73
    v_add_f32 v79, v79, v72
    v_add_f32 v79, v79, v73
    v_lshlrev_b32 v72, 16, v45
    v_and_b32 v73, 0xffff0000, v45
    v_mul_f32 v72, v72, v66
    v_mul_f32 v73, v73, v67
    v_cvt_pk_bf16_f32 v72, 0, v72
    v_cvt_pk_bf16_f32 v73, 0, v73
    v_add_f32 v79, v79, v72
    v_add_f32 v79, v79, v73
    v_lshlrev_b32 v72, 16, v46
    v_and_b32 v73, 0xffff0000, v46
    v_mul_f32 v72, v72, v68
    v_mul_f32 v73, v73, v69
    v_cvt_pk_bf16_f32 v72, 0, v72
    v_cvt_pk_bf16_f32 v73, 0, v73
    v_add_f32 v79, v79, v72
    v_add_f32 v79, v79, v73
    v_lshlrev_b32 v72, 16, v47
    v_and_b32 v73, 0xffff0000, v47
    v_mul_f32 v72, v72, v70
    v_mul_f32 v73, v73, v71
    v_cvt_pk_bf16_f32 v72, 0, v72
    v_cvt_pk_bf16_f32 v73, 0, v73
    v_add_f32 v79, v79, v72
    v_add_f32 v79, v79, v73
    s_nop 1
    v_permlane32_swap_b32 v76, v77
    v_permlane32_swap_b32 v78, v79
    v_add_f32 v76, v76, v77
    v_add_f32 v78, v78, v79
    s_nop 1
    v_permlane16_swap_b32 v76, v78
    v_add_f32 v76, v76, v78
    s_nop 1
    v_add_f32_dpp v76, v76, v76 quad_perm:[1,0,3,2] row_mask:0xf bank_mask:0xf
    s_nop 1
    v_add_f32_dpp v76, v76, v76 quad_perm:[2,3,0,1] row_mask:0xf bank_mask:0xf
    s_nop 1
    v_add_f32_dpp v76, v76, v76 row_half_mirror row_mask:0xf bank_mask:0xf
    s_nop 1
    v_add_f32_dpp v76, v76, v76 row_mirror row_mask:0xf bank_mask:0xf
    v_cvt_pk_bf16_f32 v76, 0, v76
    v_mul_f32 v76, s46, v76
    v_exp_f32 v76, -v76
    s_lshl_b32 s66, s50, 4
    v_add_f32 v76, 1.0, v76
    v_rcp_f32 v76, v76
    s_add_u32 s66, s66, 6094848
    v_cvt_pk_bf16_f32 v76, 0, v76
    v_lshlrev_b32 v10, 2, v3
    s_mov_b32 exec_lo, 0x00010001
    s_mov_b32 exec_hi, 0x00010001
    buffer_store_dword v76, v10, s[16:19], s66 offen sc0 sc1
    s_mov_b64 exec, -1
    s_barrier
    s_mov_b32 s66, 57344
    buffer_load_dwordx4 v[128:131], v6, s[28:31], s66 offen
    s_mov_b32 s66, 64512
    buffer_load_dwordx4 v[132:135], v6, s[28:31], s66 offen
    s_mov_b32 s66, 71680
    buffer_load_dwordx4 v[136:139], v6, s[28:31], s66 offen
    s_mov_b32 s66, 78848
    buffer_load_dwordx4 v[140:143], v6, s[28:31], s66 offen
    s_mov_b32 s66, 86016
    buffer_load_dwordx4 v[144:147], v6, s[28:31], s66 offen
    s_mov_b32 s66, 93184
    buffer_load_dwordx4 v[148:151], v6, s[28:31], s66 offen
    s_mov_b32 s66, 100352
    buffer_load_dwordx4 v[152:155], v6, s[28:31], s66 offen
    s_mov_b32 s66, 107520
    buffer_load_dwordx4 v[156:159], v6, s[28:31], s66 offen
    s_cmp_lg_u32 s48, 0
    s_cbranch_scc1 W_c5
    s_waitcnt vmcnt(9)
    s_mov_b32 s67, 0
W_cs:
    v_xor_b32 v10, v225, v15
    v_xor_b32 v11, v227, v15
    v_or_b32 v10, v10, v11
    v_xor_b32 v11, v229, v15
    v_or_b32 v10, v10, v11
    v_xor_b32 v11, v231, v15
    v_or_b32 v10, v10, v11
    v_cmp_ne_u32 vcc, 0, v10
    s_cbranch_vccz W_cok
    s_add_u32 s67, s67, 1
    s_cmp_ge_u32 s67, 200000
    s_cbranch_scc1 W_cok
    s_sleep 4
    s_movk_i32 s66, 0
    buffer_load_dwordx2 v[224:225], v8, s[16:19], s66 offen sc1
    s_movk_i32 s66, 2048
    buffer_load_dwordx2 v[226:227], v8, s[16:19], s66 offen sc1
    s_movk_i32 s66, 4096
    buffer_load_dwordx2 v[228:229], v8, s[16:19], s66 offen sc1
    s_movk_i32 s66, 6144
    buffer_load_dwordx2 v[230:231], v8, s[16:19], s66 offen sc1
    s_waitcnt vmcnt(0)
    s_branch W_cs
W_cok:
    v_max_u32 v12, v224, v226
    v_max3_u32 v12, v12, v228, v230
    s_nop 1
    s_nop 1
    v_max_u32_dpp v12, v12, v12 quad_perm:[1,0,3,2] row_mask:0xf bank_mask:0xf
    s_nop 1
    v_max_u32_dpp v12, v12, v12 quad_perm:[2,3,0,1] row_mask:0xf bank_mask:0xf
    s_nop 1
    v_max_u32_dpp v12, v12, v12 row_half_mirror row_mask:0xf bank_mask:0xf
    s_nop 1
    v_max_u32_dpp v12, v12, v12 row_mirror row_mask:0xf bank_mask:0xf
    s_nop 1
    v_readlane_b32 s68, v12, 0
    v_readlane_b32 s69, v12, 16
    v_readlane_b32 s70, v12, 32
    v_readlane_b32 s71, v12, 48
    s_nop 1
    v_mov_b32 v12, s68
    v_max_u32 v12, s69, v12
    v_max_u32 v12, s70, v12
    v_max_u32 v12, s71, v12
    v_mov_b32 v10, 155684
    ds_write_b32 v10, v12
W_c5:
    s_waitcnt lgkmcnt(0)
    s_barrier
    v_mov_b32 v10, 155684
    ds_read_b32 v11, v10
    v_lshrrev_b32 v10, 5, v2
    v_lshlrev_b32 v10, 6, v10
    s_waitcnt lgkmcnt(0)
    v_readfirstlane_b32 s66, v11
    s_and_b32 s66, s66, 0x7ff
    s_sub_u32 s66, 2047, s66
    s_lshl_b32 s66, s66, 10
    s_add_u32 s66, s66, s51
    s_lshl_b32 s66, s66, 1
    buffer_load_dwordx4 v[224:227], v10, s[8:11], s66 offen offset:0
    buffer_load_dwordx4 v[228:231], v10, s[8:11], s66 offen offset:16
    buffer_load_dwordx4 v[232:235], v10, s[8:11], s66 offen offset:32
    buffer_load_dwordx4 v[236:239], v10, s[8:11], s66 offen offset:48
    s_barrier
    s_mov_b32 s66, 114688
    buffer_load_dwordx4 v[160:163], v6, s[28:31], s66 offen
    s_mov_b32 s66, 121856
    buffer_load_dwordx4 v[164:167], v6, s[28:31], s66 offen
    s_mov_b32 s66, 129024
    buffer_load_dwordx4 v[168:171], v6, s[28:31], s66 offen
    s_mov_b32 s66, 136192
    buffer_load_dwordx4 v[172:175], v6, s[28:31], s66 offen
    s_mov_b32 s66, 143360
    buffer_load_dwordx4 v[176:179], v6, s[28:31], s66 offen
    s_mov_b32 s66, 150528
    buffer_load_dwordx4 v[180:183], v6, s[28:31], s66 offen
    s_mov_b32 s66, 157696
    buffer_load_dwordx4 v[184:187], v6, s[28:31], s66 offen
    s_mov_b32 s66, 164864
    buffer_load_dwordx4 v[188:191], v6, s[28:31], s66 offen
    s_waitcnt vmcnt(8)
    v_mov_b32 v64, 0
    v_mov_b32 v65, 0
    v_mov_b32 v66, 0
    v_mov_b32 v67, 0
    v_mov_b32 v68, 0
    v_mov_b32 v69, 0
    v_mov_b32 v70, 0
    v_mov_b32 v71, 0
    v_lshlrev_b32 v72, 16, v224
    v_lshlrev_b32 v73, 16, v96
    v_and_b32 v74, 0xffff0000, v96
    v_fmac_f32 v64, v73, v72
    v_fmac_f32 v65, v74, v72
    v_lshlrev_b32 v73, 16, v97
    v_and_b32 v74, 0xffff0000, v97
    v_fmac_f32 v66, v73, v72
    v_fmac_f32 v67, v74, v72
    v_lshlrev_b32 v73, 16, v98
    v_and_b32 v74, 0xffff0000, v98
    v_fmac_f32 v68, v73, v72
    v_fmac_f32 v69, v74, v72
    v_lshlrev_b32 v73, 16, v99
    v_and_b32 v74, 0xffff0000, v99
    v_fmac_f32 v70, v73, v72
    v_fmac_f32 v71, v74, v72
    v_and_b32 v72, 0xffff0000, v224
    v_lshlrev_b32 v73, 16, v100
    v_and_b32 v74, 0xffff0000, v100
    v_fmac_f32 v64, v73, v72
    v_fmac_f32 v65, v74, v72
    v_lshlrev_b32 v73, 16, v101
    v_and_b32 v74, 0xffff0000, v101
    v_fmac_f32 v66, v73, v72
    v_fmac_f32 v67, v74, v72
    v_lshlrev_b32 v73, 16, v102
    v_and_b32 v74, 0xffff0000, v102
    v_fmac_f32 v68, v73, v72
    v_fmac_f32 v69, v74, v72
    v_lshlrev_b32 v73, 16, v103
    v_and_b32 v74, 0xffff0000, v103
    v_fmac_f32 v70, v73, v72
    v_fmac_f32 v71, v74, v72
    v_lshlrev_b32 v72, 16, v225
    v_lshlrev_b32 v73, 16, v104
    v_and_b32 v74, 0xffff0000, v104
    v_fmac_f32 v64, v73, v72
    v_fmac_f32 v65, v74, v72
    v_lshlrev_b32 v73, 16, v105
    v_and_b32 v74, 0xffff0000, v105
    v_fmac_f32 v66, v73, v72
    v_fmac_f32 v67, v74, v72
    v_lshlrev_b32 v73, 16, v106
    v_and_b32 v74, 0xffff0000, v106
    v_fmac_f32 v68, v73, v72
    v_fmac_f32 v69, v74, v72
    v_lshlrev_b32 v73, 16, v107
    v_and_b32 v74, 0xffff0000, v107
    v_fmac_f32 v70, v73, v72
    v_fmac_f32 v71, v74, v72
    v_and_b32 v72, 0xffff0000, v225
    v_lshlrev_b32 v73, 16, v108
    v_and_b32 v74, 0xffff0000, v108
    v_fmac_f32 v64, v73, v72
    v_fmac_f32 v65, v74, v72
    v_lshlrev_b32 v73, 16, v109
    v_and_b32 v74, 0xffff0000, v109
    v_fmac_f32 v66, v73, v72
    v_fmac_f32 v67, v74, v72
    v_lshlrev_b32 v73, 16, v110
    v_and_b32 v74, 0xffff0000, v110
    v_fmac_f32 v68, v73, v72
    v_fmac_f32 v69, v74, v72
    v_lshlrev_b32 v73, 16, v111
    v_and_b32 v74, 0xffff0000, v111
    v_fmac_f32 v70, v73, v72
    v_fmac_f32 v71, v74, v72
    v_lshlrev_b32 v72, 16, v226
    v_lshlrev_b32 v73, 16, v112
    v_and_b32 v74, 0xffff0000, v112
    v_fmac_f32 v64, v73, v72
    v_fmac_f32 v65, v74, v72
    v_lshlrev_b32 v73, 16, v113
    v_and_b32 v74, 0xffff0000, v113
    v_fmac_f32 v66, v73, v72
    v_fmac_f32 v67, v74, v72
    v_lshlrev_b32 v73, 16, v114
    v_and_b32 v74, 0xffff0000, v114
    v_fmac_f32 v68, v73, v72
    v_fmac_f32 v69, v74, v72
    v_lshlrev_b32 v73, 16, v115
    v_and_b32 v74, 0xffff0000, v115
    v_fmac_f32 v70, v73, v72
    v_fmac_f32 v71, v74, v72
    v_and_b32 v72, 0xffff0000, v226
    v_lshlrev_b32 v73, 16, v116
    v_and_b32 v74, 0xffff0000, v116
    v_fmac_f32 v64, v73, v72
    v_fmac_f32 v65, v74, v72
    v_lshlrev_b32 v73, 16, v117
    v_and_b32 v74, 0xffff0000, v117
    v_fmac_f32 v66, v73, v72
    v_fmac_f32 v67, v74, v72
    v_lshlrev_b32 v73, 16, v118
    v_and_b32 v74, 0xffff0000, v118
    v_fmac_f32 v68, v73, v72
    v_fmac_f32 v69, v74, v72
    v_lshlrev_b32 v73, 16, v119
    v_and_b32 v74, 0xffff0000, v119
    v_fmac_f32 v70, v73, v72
    v_fmac_f32 v71, v74, v72
    s_barrier
    v_lshlrev_b32 v72, 16, v227
    v_lshlrev_b32 v73, 16, v120
    v_and_b32 v74, 0xffff0000, v120
    v_fmac_f32 v64, v73, v72
    v_fmac_f32 v65, v74, v72
    v_lshlrev_b32 v73, 16, v121
    v_and_b32 v74, 0xffff0000, v121
    v_fmac_f32 v66, v73, v72
    v_fmac_f32 v67, v74, v72
    v_lshlrev_b32 v73, 16, v122
    v_and_b32 v74, 0xffff0000, v122
    v_fmac_f32 v68, v73, v72
    v_fmac_f32 v69, v74, v72
    v_lshlrev_b32 v73, 16, v123
    v_and_b32 v74, 0xffff0000, v123
    v_fmac_f32 v70, v73, v72
    v_fmac_f32 v71, v74, v72
    v_and_b32 v72, 0xffff0000, v227
    v_lshlrev_b32 v73, 16, v124
    v_and_b32 v74, 0xffff0000, v124
    v_fmac_f32 v64, v73, v72
    v_fmac_f32 v65, v74, v72
    v_lshlrev_b32 v73, 16, v125
    v_and_b32 v74, 0xffff0000, v125
    v_fmac_f32 v66, v73, v72
    v_fmac_f32 v67, v74, v72
    v_lshlrev_b32 v73, 16, v126
    v_and_b32 v74, 0xffff0000, v126
    v_fmac_f32 v68, v73, v72
    v_fmac_f32 v69, v74, v72
    v_lshlrev_b32 v73, 16, v127
    v_and_b32 v74, 0xffff0000, v127
    v_fmac_f32 v70, v73, v72
    v_fmac_f32 v71, v74, v72
    v_lshlrev_b32 v72, 16, v228
    v_lshlrev_b32 v73, 16, v128
    v_and_b32 v74, 0xffff0000, v128
    v_fmac_f32 v64, v73, v72
    v_fmac_f32 v65, v74, v72
    v_lshlrev_b32 v73, 16, v129
    v_and_b32 v74, 0xffff0000, v129
    v_fmac_f32 v66, v73, v72
    v_fmac_f32 v67, v74, v72
    v_lshlrev_b32 v73, 16, v130
    v_and_b32 v74, 0xffff0000, v130
    v_fmac_f32 v68, v73, v72
    v_fmac_f32 v69, v74, v72
    v_lshlrev_b32 v73, 16, v131
    v_and_b32 v74, 0xffff0000, v131
    v_fmac_f32 v70, v73, v72
    v_fmac_f32 v71, v74, v72
    v_and_b32 v72, 0xffff0000, v228
    v_lshlrev_b32 v73, 16, v132
    v_and_b32 v74, 0xffff0000, v132
    v_fmac_f32 v64, v73, v72
    v_fmac_f32 v65, v74, v72
    v_lshlrev_b32 v73, 16, v133
    v_and_b32 v74, 0xffff0000, v133
    v_fmac_f32 v66, v73, v72
    v_fmac_f32 v67, v74, v72
    v_lshlrev_b32 v73, 16, v134
    v_and_b32 v74, 0xffff0000, v134
    v_fmac_f32 v68, v73, v72
    v_fmac_f32 v69, v74, v72
    v_lshlrev_b32 v73, 16, v135
    v_and_b32 v74, 0xffff0000, v135
    v_fmac_f32 v70, v73, v72
    v_fmac_f32 v71, v74, v72
    v_lshlrev_b32 v72, 16, v229
    v_lshlrev_b32 v73, 16, v136
    v_and_b32 v74, 0xffff0000, v136
    v_fmac_f32 v64, v73, v72
    v_fmac_f32 v65, v74, v72
    v_lshlrev_b32 v73, 16, v137
    v_and_b32 v74, 0xffff0000, v137
    v_fmac_f32 v66, v73, v72
    v_fmac_f32 v67, v74, v72
    v_lshlrev_b32 v73, 16, v138
    v_and_b32 v74, 0xffff0000, v138
    v_fmac_f32 v68, v73, v72
    v_fmac_f32 v69, v74, v72
    v_lshlrev_b32 v73, 16, v139
    v_and_b32 v74, 0xffff0000, v139
    v_fmac_f32 v70, v73, v72
    v_fmac_f32 v71, v74, v72
    v_and_b32 v72, 0xffff0000, v229
    v_lshlrev_b32 v73, 16, v140
    v_and_b32 v74, 0xffff0000, v140
    v_fmac_f32 v64, v73, v72
    v_fmac_f32 v65, v74, v72
    v_lshlrev_b32 v73, 16, v141
    v_and_b32 v74, 0xffff0000, v141
    v_fmac_f32 v66, v73, v72
    v_fmac_f32 v67, v74, v72
    v_lshlrev_b32 v73, 16, v142
    v_and_b32 v74, 0xffff0000, v142
    v_fmac_f32 v68, v73, v72
    v_fmac_f32 v69, v74, v72
    v_lshlrev_b32 v73, 16, v143
    v_and_b32 v74, 0xffff0000, v143
    v_fmac_f32 v70, v73, v72
    v_fmac_f32 v71, v74, v72
    s_barrier
    s_mov_b32 s66, 172032
    buffer_load_dwordx4 v[192:195], v6, s[28:31], s66 offen
    s_mov_b32 s66, 179200
    buffer_load_dwordx4 v[196:199], v6, s[28:31], s66 offen
    s_mov_b32 s66, 186368
    buffer_load_dwordx4 v[200:203], v6, s[28:31], s66 offen
    s_mov_b32 s66, 193536
    buffer_load_dwordx4 v[204:207], v6, s[28:31], s66 offen
    s_mov_b32 s66, 200704
    buffer_load_dwordx4 v[208:211], v6, s[28:31], s66 offen
    s_mov_b32 s66, 207872
    buffer_load_dwordx4 v[212:215], v6, s[28:31], s66 offen
    s_mov_b32 s66, 215040
    buffer_load_dwordx4 v[216:219], v6, s[28:31], s66 offen
    s_mov_b32 s66, 222208
    buffer_load_dwordx4 v[220:223], v6, s[28:31], s66 offen
    v_lshlrev_b32 v72, 16, v230
    v_lshlrev_b32 v73, 16, v144
    v_and_b32 v74, 0xffff0000, v144
    v_fmac_f32 v64, v73, v72
    v_fmac_f32 v65, v74, v72
    v_lshlrev_b32 v73, 16, v145
    v_and_b32 v74, 0xffff0000, v145
    v_fmac_f32 v66, v73, v72
    v_fmac_f32 v67, v74, v72
    v_lshlrev_b32 v73, 16, v146
    v_and_b32 v74, 0xffff0000, v146
    v_fmac_f32 v68, v73, v72
    v_fmac_f32 v69, v74, v72
    v_lshlrev_b32 v73, 16, v147
    v_and_b32 v74, 0xffff0000, v147
    v_fmac_f32 v70, v73, v72
    v_fmac_f32 v71, v74, v72
    v_and_b32 v72, 0xffff0000, v230
    v_lshlrev_b32 v73, 16, v148
    v_and_b32 v74, 0xffff0000, v148
    v_fmac_f32 v64, v73, v72
    v_fmac_f32 v65, v74, v72
    v_lshlrev_b32 v73, 16, v149
    v_and_b32 v74, 0xffff0000, v149
    v_fmac_f32 v66, v73, v72
    v_fmac_f32 v67, v74, v72
    v_lshlrev_b32 v73, 16, v150
    v_and_b32 v74, 0xffff0000, v150
    v_fmac_f32 v68, v73, v72
    v_fmac_f32 v69, v74, v72
    v_lshlrev_b32 v73, 16, v151
    v_and_b32 v74, 0xffff0000, v151
    v_fmac_f32 v70, v73, v72
    v_fmac_f32 v71, v74, v72
    v_lshlrev_b32 v72, 16, v231
    v_lshlrev_b32 v73, 16, v152
    v_and_b32 v74, 0xffff0000, v152
    v_fmac_f32 v64, v73, v72
    v_fmac_f32 v65, v74, v72
    v_lshlrev_b32 v73, 16, v153
    v_and_b32 v74, 0xffff0000, v153
    v_fmac_f32 v66, v73, v72
    v_fmac_f32 v67, v74, v72
    v_lshlrev_b32 v73, 16, v154
    v_and_b32 v74, 0xffff0000, v154
    v_fmac_f32 v68, v73, v72
    v_fmac_f32 v69, v74, v72
    v_lshlrev_b32 v73, 16, v155
    v_and_b32 v74, 0xffff0000, v155
    v_fmac_f32 v70, v73, v72
    v_fmac_f32 v71, v74, v72
    v_and_b32 v72, 0xffff0000, v231
    v_lshlrev_b32 v73, 16, v156
    v_and_b32 v74, 0xffff0000, v156
    v_fmac_f32 v64, v73, v72
    v_fmac_f32 v65, v74, v72
    v_lshlrev_b32 v73, 16, v157
    v_and_b32 v74, 0xffff0000, v157
    v_fmac_f32 v66, v73, v72
    v_fmac_f32 v67, v74, v72
    v_lshlrev_b32 v73, 16, v158
    v_and_b32 v74, 0xffff0000, v158
    v_fmac_f32 v68, v73, v72
    v_fmac_f32 v69, v74, v72
    v_lshlrev_b32 v73, 16, v159
    v_and_b32 v74, 0xffff0000, v159
    v_fmac_f32 v70, v73, v72
    v_fmac_f32 v71, v74, v72
    s_waitcnt vmcnt(15)
    v_lshlrev_b32 v72, 16, v232
    v_lshlrev_b32 v73, 16, v160
    v_and_b32 v74, 0xffff0000, v160
    v_fmac_f32 v64, v73, v72
    v_fmac_f32 v65, v74, v72
    v_lshlrev_b32 v73, 16, v161
    v_and_b32 v74, 0xffff0000, v161
    v_fmac_f32 v66, v73, v72
    v_fmac_f32 v67, v74, v72
    v_lshlrev_b32 v73, 16, v162
    v_and_b32 v74, 0xffff0000, v162
    v_fmac_f32 v68, v73, v72
    v_fmac_f32 v69, v74, v72
    v_lshlrev_b32 v73, 16, v163
    v_and_b32 v74, 0xffff0000, v163
    v_fmac_f32 v70, v73, v72
    v_fmac_f32 v71, v74, v72
    s_waitcnt vmcnt(14)
    v_and_b32 v72, 0xffff0000, v232
    v_lshlrev_b32 v73, 16, v164
    v_and_b32 v74, 0xffff0000, v164
    v_fmac_f32 v64, v73, v72
    v_fmac_f32 v65, v74, v72
    v_lshlrev_b32 v73, 16, v165
    v_and_b32 v74, 0xffff0000, v165
    v_fmac_f32 v66, v73, v72
    v_fmac_f32 v67, v74, v72
    v_lshlrev_b32 v73, 16, v166
    v_and_b32 v74, 0xffff0000, v166
    v_fmac_f32 v68, v73, v72
    v_fmac_f32 v69, v74, v72
    v_lshlrev_b32 v73, 16, v167
    v_and_b32 v74, 0xffff0000, v167
    v_fmac_f32 v70, v73, v72
    v_fmac_f32 v71, v74, v72
    s_barrier
    s_waitcnt vmcnt(13)
    v_lshlrev_b32 v72, 16, v233
    v_lshlrev_b32 v73, 16, v168
    v_and_b32 v74, 0xffff0000, v168
    v_fmac_f32 v64, v73, v72
    v_fmac_f32 v65, v74, v72
    v_lshlrev_b32 v73, 16, v169
    v_and_b32 v74, 0xffff0000, v169
    v_fmac_f32 v66, v73, v72
    v_fmac_f32 v67, v74, v72
    v_lshlrev_b32 v73, 16, v170
    v_and_b32 v74, 0xffff0000, v170
    v_fmac_f32 v68, v73, v72
    v_fmac_f32 v69, v74, v72
    v_lshlrev_b32 v73, 16, v171
    v_and_b32 v74, 0xffff0000, v171
    v_fmac_f32 v70, v73, v72
    v_fmac_f32 v71, v74, v72
    s_waitcnt vmcnt(12)
    v_and_b32 v72, 0xffff0000, v233
    v_lshlrev_b32 v73, 16, v172
    v_and_b32 v74, 0xffff0000, v172
    v_fmac_f32 v64, v73, v72
    v_fmac_f32 v65, v74, v72
    v_lshlrev_b32 v73, 16, v173
    v_and_b32 v74, 0xffff0000, v173
    v_fmac_f32 v66, v73, v72
    v_fmac_f32 v67, v74, v72
    v_lshlrev_b32 v73, 16, v174
    v_and_b32 v74, 0xffff0000, v174
    v_fmac_f32 v68, v73, v72
    v_fmac_f32 v69, v74, v72
    v_lshlrev_b32 v73, 16, v175
    v_and_b32 v74, 0xffff0000, v175
    v_fmac_f32 v70, v73, v72
    v_fmac_f32 v71, v74, v72
    s_waitcnt vmcnt(11)
    v_lshlrev_b32 v72, 16, v234
    v_lshlrev_b32 v73, 16, v176
    v_and_b32 v74, 0xffff0000, v176
    v_fmac_f32 v64, v73, v72
    v_fmac_f32 v65, v74, v72
    v_lshlrev_b32 v73, 16, v177
    v_and_b32 v74, 0xffff0000, v177
    v_fmac_f32 v66, v73, v72
    v_fmac_f32 v67, v74, v72
    v_lshlrev_b32 v73, 16, v178
    v_and_b32 v74, 0xffff0000, v178
    v_fmac_f32 v68, v73, v72
    v_fmac_f32 v69, v74, v72
    v_lshlrev_b32 v73, 16, v179
    v_and_b32 v74, 0xffff0000, v179
    v_fmac_f32 v70, v73, v72
    v_fmac_f32 v71, v74, v72
    s_waitcnt vmcnt(10)
    v_and_b32 v72, 0xffff0000, v234
    v_lshlrev_b32 v73, 16, v180
    v_and_b32 v74, 0xffff0000, v180
    v_fmac_f32 v64, v73, v72
    v_fmac_f32 v65, v74, v72
    v_lshlrev_b32 v73, 16, v181
    v_and_b32 v74, 0xffff0000, v181
    v_fmac_f32 v66, v73, v72
    v_fmac_f32 v67, v74, v72
    v_lshlrev_b32 v73, 16, v182
    v_and_b32 v74, 0xffff0000, v182
    v_fmac_f32 v68, v73, v72
    v_fmac_f32 v69, v74, v72
    v_lshlrev_b32 v73, 16, v183
    v_and_b32 v74, 0xffff0000, v183
    v_fmac_f32 v70, v73, v72
    v_fmac_f32 v71, v74, v72
    s_barrier
    s_waitcnt vmcnt(9)
    v_lshlrev_b32 v72, 16, v235
    v_lshlrev_b32 v73, 16, v184
    v_and_b32 v74, 0xffff0000, v184
    v_fmac_f32 v64, v73, v72
    v_fmac_f32 v65, v74, v72
    v_lshlrev_b32 v73, 16, v185
    v_and_b32 v74, 0xffff0000, v185
    v_fmac_f32 v66, v73, v72
    v_fmac_f32 v67, v74, v72
    v_lshlrev_b32 v73, 16, v186
    v_and_b32 v74, 0xffff0000, v186
    v_fmac_f32 v68, v73, v72
    v_fmac_f32 v69, v74, v72
    v_lshlrev_b32 v73, 16, v187
    v_and_b32 v74, 0xffff0000, v187
    v_fmac_f32 v70, v73, v72
    v_fmac_f32 v71, v74, v72
    s_waitcnt vmcnt(8)
    v_and_b32 v72, 0xffff0000, v235
    v_lshlrev_b32 v73, 16, v188
    v_and_b32 v74, 0xffff0000, v188
    v_fmac_f32 v64, v73, v72
    v_fmac_f32 v65, v74, v72
    v_lshlrev_b32 v73, 16, v189
    v_and_b32 v74, 0xffff0000, v189
    v_fmac_f32 v66, v73, v72
    v_fmac_f32 v67, v74, v72
    v_lshlrev_b32 v73, 16, v190
    v_and_b32 v74, 0xffff0000, v190
    v_fmac_f32 v68, v73, v72
    v_fmac_f32 v69, v74, v72
    v_lshlrev_b32 v73, 16, v191
    v_and_b32 v74, 0xffff0000, v191
    v_fmac_f32 v70, v73, v72
    v_fmac_f32 v71, v74, v72
    s_waitcnt vmcnt(7)
    v_lshlrev_b32 v72, 16, v236
    v_lshlrev_b32 v73, 16, v192
    v_and_b32 v74, 0xffff0000, v192
    v_fmac_f32 v64, v73, v72
    v_fmac_f32 v65, v74, v72
    v_lshlrev_b32 v73, 16, v193
    v_and_b32 v74, 0xffff0000, v193
    v_fmac_f32 v66, v73, v72
    v_fmac_f32 v67, v74, v72
    v_lshlrev_b32 v73, 16, v194
    v_and_b32 v74, 0xffff0000, v194
    v_fmac_f32 v68, v73, v72
    v_fmac_f32 v69, v74, v72
    v_lshlrev_b32 v73, 16, v195
    v_and_b32 v74, 0xffff0000, v195
    v_fmac_f32 v70, v73, v72
    v_fmac_f32 v71, v74, v72
    s_waitcnt vmcnt(6)
    v_and_b32 v72, 0xffff0000, v236
    v_lshlrev_b32 v73, 16, v196
    v_and_b32 v74, 0xffff0000, v196
    v_fmac_f32 v64, v73, v72
    v_fmac_f32 v65, v74, v72
    v_lshlrev_b32 v73, 16, v197
    v_and_b32 v74, 0xffff0000, v197
    v_fmac_f32 v66, v73, v72
    v_fmac_f32 v67, v74, v72
    v_lshlrev_b32 v73, 16, v198
    v_and_b32 v74, 0xffff0000, v198
    v_fmac_f32 v68, v73, v72
    v_fmac_f32 v69, v74, v72
    v_lshlrev_b32 v73, 16, v199
    v_and_b32 v74, 0xffff0000, v199
    v_fmac_f32 v70, v73, v72
    v_fmac_f32 v71, v74, v72
    s_waitcnt vmcnt(5)
    v_lshlrev_b32 v72, 16, v237
    v_lshlrev_b32 v73, 16, v200
    v_and_b32 v74, 0xffff0000, v200
    v_fmac_f32 v64, v73, v72
    v_fmac_f32 v65, v74, v72
    v_lshlrev_b32 v73, 16, v201
    v_and_b32 v74, 0xffff0000, v201
    v_fmac_f32 v66, v73, v72
    v_fmac_f32 v67, v74, v72
    v_lshlrev_b32 v73, 16, v202
    v_and_b32 v74, 0xffff0000, v202
    v_fmac_f32 v68, v73, v72
    v_fmac_f32 v69, v74, v72
    v_lshlrev_b32 v73, 16, v203
    v_and_b32 v74, 0xffff0000, v203
    v_fmac_f32 v70, v73, v72
    v_fmac_f32 v71, v74, v72
    s_waitcnt vmcnt(4)
    v_and_b32 v72, 0xffff0000, v237
    v_lshlrev_b32 v73, 16, v204
    v_and_b32 v74, 0xffff0000, v204
    v_fmac_f32 v64, v73, v72
    v_fmac_f32 v65, v74, v72
    v_lshlrev_b32 v73, 16, v205
    v_and_b32 v74, 0xffff0000, v205
    v_fmac_f32 v66, v73, v72
    v_fmac_f32 v67, v74, v72
    v_lshlrev_b32 v73, 16, v206
    v_and_b32 v74, 0xffff0000, v206
    v_fmac_f32 v68, v73, v72
    v_fmac_f32 v69, v74, v72
    v_lshlrev_b32 v73, 16, v207
    v_and_b32 v74, 0xffff0000, v207
    v_fmac_f32 v70, v73, v72
    v_fmac_f32 v71, v74, v72
    s_barrier
    s_waitcnt vmcnt(3)
    v_lshlrev_b32 v72, 16, v238
    v_lshlrev_b32 v73, 16, v208
    v_and_b32 v74, 0xffff0000, v208
    v_fmac_f32 v64, v73, v72
    v_fmac_f32 v65, v74, v72
    v_lshlrev_b32 v73, 16, v209
    v_and_b32 v74, 0xffff0000, v209
    v_fmac_f32 v66, v73, v72
    v_fmac_f32 v67, v74, v72
    v_lshlrev_b32 v73, 16, v210
    v_and_b32 v74, 0xffff0000, v210
    v_fmac_f32 v68, v73, v72
    v_fmac_f32 v69, v74, v72
    v_lshlrev_b32 v73, 16, v211
    v_and_b32 v74, 0xffff0000, v211
    v_fmac_f32 v70, v73, v72
    v_fmac_f32 v71, v74, v72
    s_waitcnt vmcnt(2)
    v_and_b32 v72, 0xffff0000, v238
    v_lshlrev_b32 v73, 16, v212
    v_and_b32 v74, 0xffff0000, v212
    v_fmac_f32 v64, v73, v72
    v_fmac_f32 v65, v74, v72
    v_lshlrev_b32 v73, 16, v213
    v_and_b32 v74, 0xffff0000, v213
    v_fmac_f32 v66, v73, v72
    v_fmac_f32 v67, v74, v72
    v_lshlrev_b32 v73, 16, v214
    v_and_b32 v74, 0xffff0000, v214
    v_fmac_f32 v68, v73, v72
    v_fmac_f32 v69, v74, v72
    v_lshlrev_b32 v73, 16, v215
    v_and_b32 v74, 0xffff0000, v215
    v_fmac_f32 v70, v73, v72
    v_fmac_f32 v71, v74, v72
    s_waitcnt vmcnt(1)
    v_lshlrev_b32 v72, 16, v239
    v_lshlrev_b32 v73, 16, v216
    v_and_b32 v74, 0xffff0000, v216
    v_fmac_f32 v64, v73, v72
    v_fmac_f32 v65, v74, v72
    v_lshlrev_b32 v73, 16, v217
    v_and_b32 v74, 0xffff0000, v217
    v_fmac_f32 v66, v73, v72
    v_fmac_f32 v67, v74, v72
    v_lshlrev_b32 v73, 16, v218
    v_and_b32 v74, 0xffff0000, v218
    v_fmac_f32 v68, v73, v72
    v_fmac_f32 v69, v74, v72
    v_lshlrev_b32 v73, 16, v219
    v_and_b32 v74, 0xffff0000, v219
    v_fmac_f32 v70, v73, v72
    v_fmac_f32 v71, v74, v72
    s_waitcnt vmcnt(0)
    v_and_b32 v72, 0xffff0000, v239
    v_lshlrev_b32 v73, 16, v220
    v_and_b32 v74, 0xffff0000, v220
    v_fmac_f32 v64, v73, v72
    v_fmac_f32 v65, v74, v72
    v_lshlrev_b32 v73, 16, v221
    v_and_b32 v74, 0xffff0000, v221
    v_fmac_f32 v66, v73, v72
    v_fmac_f32 v67, v74, v72
    v_lshlrev_b32 v73, 16, v222
    v_and_b32 v74, 0xffff0000, v222
    v_fmac_f32 v68, v73, v72
    v_fmac_f32 v69, v74, v72
    v_lshlrev_b32 v73, 16, v223
    v_and_b32 v74, 0xffff0000, v223
    v_fmac_f32 v70, v73, v72
    v_fmac_f32 v71, v74, v72
    v_and_b32 v76, 31, v2
    v_lshrrev_b32 v77, 5, v2
    v_lshl_add_u32 v76, v76, 1, v77
    v_permlane32_swap_b32 v64, v68
    v_permlane32_swap_b32 v65, v69
    v_permlane32_swap_b32 v66, v70
    v_permlane32_swap_b32 v67, v71
    v_lshlrev_b32 v76, 4, v76
    v_add_f32 v64, v64, v68
    v_add_f32 v65, v65, v69
    v_add_f32 v66, v66, v70
    v_add_f32 v67, v67, v71
    buffer_store_dwordx4 v[64:67], v76, s[16:19], s54 offen sc0 sc1
    s_barrier
    s_mov_b32 s66, 0
    buffer_load_dwordx4 v[96:99], v7, s[32:35], s66 offen
    s_mov_b32 s66, 2048
    buffer_load_dwordx4 v[100:103], v7, s[32:35], s66 offen
    s_mov_b32 s66, 4096
    buffer_load_dwordx4 v[104:107], v7, s[32:35], s66 offen
    s_mov_b32 s66, 6144
    buffer_load_dwordx4 v[108:111], v7, s[32:35], s66 offen
    s_mov_b32 s66, 8192
    buffer_load_dwordx4 v[112:115], v7, s[32:35], s66 offen
    s_mov_b32 s66, 10240
    buffer_load_dwordx4 v[116:119], v7, s[32:35], s66 offen
    s_mov_b32 s66, 12288
    buffer_load_dwordx4 v[120:123], v7, s[32:35], s66 offen
    s_mov_b32 s66, 14336
    buffer_load_dwordx4 v[124:127], v7, s[32:35], s66 offen
H_b14:
    s_barrier
    s_setprio 3
    s_add_u32 s67, s52, 0
    s_and_b32 s67, s67, 0x1fffff
    s_add_u32 m0, s72, 24576
    s_add_u32 s66, s67, 0
    buffer_load_dwordx4 v90, s[20:23], s66 offen lds
    s_add_u32 m0, s72, 28672
    s_add_u32 s66, s67, 65536
    buffer_load_dwordx4 v90, s[20:23], s66 offen lds
    s_add_u32 s67, s52, 0
    s_and_b32 s67, s67, 0x1fffff
    s_add_u32 m0, s72, 40960
    s_add_u32 s66, s67, 131072
    buffer_load_dwordx4 v90, s[20:23], s66 offen lds
    s_add_u32 m0, s72, 45056
    s_add_u32 s66, s67, 196608
    buffer_load_dwordx4 v90, s[20:23], s66 offen lds
    s_mov_b32 s70, 0x3fb8aa3b
    s_mov_b32 s71, 0x3fb8aa3b
    s_and_b32 s66, s44, 2
    s_lshl_b32 s67, s66, 2
    s_add_u32 s67, s67, 155648
    v_mov_b32 v10, s67
    s_lshl_b32 s66, s66, 12
    s_and_b32 s67, s44, 1
    s_lshl_b32 s67, s67, 10
    v_add_u32 v11, s66, v9
    v_add_u32 v12, s67, v11
    v_add_u32 v11, 65536, v11
    v_mov_b32 v204, 0x3f803f80
    v_mov_b32 v205, 0x3f803f80
    v_mov_b32 v206, 0x3f803f80
    v_mov_b32 v207, 0x3f803f80
H_fk:
    ds_read_b64 v[14:15], v10
    s_waitcnt lgkmcnt(0)
    v_min_u32 v14, v14, v15
    v_cmp_eq_u32 vcc, 0, v14
    s_cbranch_vccnz H_fk
    ds_read_b128 v[16:19], v12 offset:0
    ds_read_b128 v[20:23], v12 offset:2048
    ds_read_b128 v[24:27], v12 offset:4096
    ds_read_b128 v[28:31], v12 offset:6144
    s_waitcnt lgkmcnt(3)
    v_lshlrev_b32 v72, 16, v16
    v_and_b32 v73, 0xffff0000, v16
    v_pk_mul_f32 v[74:75], v[72:73], s[70:71]
    v_pk_add_f32 v[72:73], v[72:73], 1.0 op_sel_hi:[1,0]
    v_exp_f32 v74, v74 clamp
    v_exp_f32 v75, v75 clamp
    v_lshlrev_b32 v76, 16, v17
    v_and_b32 v77, 0xffff0000, v17
    v_pk_mul_f32 v[78:79], v[76:77], s[70:71]
    v_pk_add_f32 v[76:77], v[76:77], 1.0 op_sel_hi:[1,0]
    v_exp_f32 v78, v78 clamp
    v_exp_f32 v79, v79 clamp
    v_max_f32 v72, v72, v74
    v_max_f32 v73, v73, v75
    v_cvt_pk_bf16_f32 v32, v72, v73
    v_max_f32 v76, v76, v78
    v_max_f32 v77, v77, v79
    v_cvt_pk_bf16_f32 v33, v76, v77
    v_lshlrev_b32 v72, 16, v18
    v_and_b32 v73, 0xffff0000, v18
    v_pk_mul_f32 v[74:75], v[72:73], s[70:71]
    v_pk_add_f32 v[72:73], v[72:73], 1.0 op_sel_hi:[1,0]
    v_exp_f32 v74, v74 clamp
    v_exp_f32 v75, v75 clamp
    v_lshlrev_b32 v76, 16, v19
    v_and_b32 v77, 0xffff0000, v19
    v_pk_mul_f32 v[78:79], v[76:77], s[70:71]
    v_pk_add_f32 v[76:77], v[76:77], 1.0 op_sel_hi:[1,0]
    v_exp_f32 v78, v78 clamp
    v_exp_f32 v79, v79 clamp
    v_max_f32 v72, v72, v74
    v_max_f32 v73, v73, v75
    v_cvt_pk_bf16_f32 v34, v72, v73
    v_max_f32 v76, v76, v78
    v_max_f32 v77, v77, v79
    v_cvt_pk_bf16_f32 v35, v76, v77
    s_waitcnt lgkmcnt(2)
    v_lshlrev_b32 v72, 16, v20
    v_and_b32 v73, 0xffff0000, v20
    v_pk_mul_f32 v[74:75], v[72:73], s[70:71]
    v_pk_add_f32 v[72:73], v[72:73], 1.0 op_sel_hi:[1,0]
    v_exp_f32 v74, v74 clamp
    v_exp_f32 v75, v75 clamp
    v_lshlrev_b32 v76, 16, v21
    v_and_b32 v77, 0xffff0000, v21
    v_pk_mul_f32 v[78:79], v[76:77], s[70:71]
    v_pk_add_f32 v[76:77], v[76:77], 1.0 op_sel_hi:[1,0]
    v_exp_f32 v78, v78 clamp
    v_exp_f32 v79, v79 clamp
    v_max_f32 v72, v72, v74
    v_max_f32 v73, v73, v75
    v_cvt_pk_bf16_f32 v36, v72, v73
    v_max_f32 v76, v76, v78
    v_max_f32 v77, v77, v79
    v_cvt_pk_bf16_f32 v37, v76, v77
    v_lshlrev_b32 v72, 16, v22
    v_and_b32 v73, 0xffff0000, v22
    v_pk_mul_f32 v[74:75], v[72:73], s[70:71]
    v_pk_add_f32 v[72:73], v[72:73], 1.0 op_sel_hi:[1,0]
    v_exp_f32 v74, v74 clamp
    v_exp_f32 v75, v75 clamp
    v_lshlrev_b32 v76, 16, v23
    v_and_b32 v77, 0xffff0000, v23
    v_pk_mul_f32 v[78:79], v[76:77], s[70:71]
    v_pk_add_f32 v[76:77], v[76:77], 1.0 op_sel_hi:[1,0]
    v_exp_f32 v78, v78 clamp
    v_exp_f32 v79, v79 clamp
    v_max_f32 v72, v72, v74
    v_max_f32 v73, v73, v75
    v_cvt_pk_bf16_f32 v38, v72, v73
    v_max_f32 v76, v76, v78
    v_max_f32 v77, v77, v79
    v_cvt_pk_bf16_f32 v39, v76, v77
    s_waitcnt lgkmcnt(1)
    v_lshlrev_b32 v72, 16, v24
    v_and_b32 v73, 0xffff0000, v24
    v_pk_mul_f32 v[74:75], v[72:73], s[70:71]
    v_pk_add_f32 v[72:73], v[72:73], 1.0 op_sel_hi:[1,0]
    v_exp_f32 v74, v74 clamp
    v_exp_f32 v75, v75 clamp
    v_lshlrev_b32 v76, 16, v25
    v_and_b32 v77, 0xffff0000, v25
    v_pk_mul_f32 v[78:79], v[76:77], s[70:71]
    v_pk_add_f32 v[76:77], v[76:77], 1.0 op_sel_hi:[1,0]
    v_exp_f32 v78, v78 clamp
    v_exp_f32 v79, v79 clamp
    v_max_f32 v72, v72, v74
    v_max_f32 v73, v73, v75
    v_cvt_pk_bf16_f32 v40, v72, v73
    v_max_f32 v76, v76, v78
    v_max_f32 v77, v77, v79
    v_cvt_pk_bf16_f32 v41, v76, v77
    v_lshlrev_b32 v72, 16, v26
    v_and_b32 v73, 0xffff0000, v26
    v_pk_mul_f32 v[74:75], v[72:73], s[70:71]
    v_pk_add_f32 v[72:73], v[72:73], 1.0 op_sel_hi:[1,0]
    v_exp_f32 v74, v74 clamp
    v_exp_f32 v75, v75 clamp
    v_lshlrev_b32 v76, 16, v27
    v_and_b32 v77, 0xffff0000, v27
    v_pk_mul_f32 v[78:79], v[76:77], s[70:71]
    v_pk_add_f32 v[76:77], v[76:77], 1.0 op_sel_hi:[1,0]
    v_exp_f32 v78, v78 clamp
    v_exp_f32 v79, v79 clamp
    v_max_f32 v72, v72, v74
    v_max_f32 v73, v73, v75
    v_cvt_pk_bf16_f32 v42, v72, v73
    v_max_f32 v76, v76, v78
    v_max_f32 v77, v77, v79
    v_cvt_pk_bf16_f32 v43, v76, v77
    s_waitcnt lgkmcnt(0)
    v_lshlrev_b32 v72, 16, v28
    v_and_b32 v73, 0xffff0000, v28
    v_pk_mul_f32 v[74:75], v[72:73], s[70:71]
    v_pk_add_f32 v[72:73], v[72:73], 1.0 op_sel_hi:[1,0]
    v_exp_f32 v74, v74 clamp
    v_exp_f32 v75, v75 clamp
    v_lshlrev_b32 v76, 16, v29
    v_and_b32 v77, 0xffff0000, v29
    v_pk_mul_f32 v[78:79], v[76:77], s[70:71]
    v_pk_add_f32 v[76:77], v[76:77], 1.0 op_sel_hi:[1,0]
    v_exp_f32 v78, v78 clamp
    v_exp_f32 v79, v79 clamp
    v_max_f32 v72, v72, v74
    v_max_f32 v73, v73, v75
    v_cvt_pk_bf16_f32 v44, v72, v73
    v_max_f32 v76, v76, v78
    v_max_f32 v77, v77, v79
    v_cvt_pk_bf16_f32 v45, v76, v77
    v_lshlrev_b32 v72, 16, v30
    v_and_b32 v73, 0xffff0000, v30
    v_pk_mul_f32 v[74:75], v[72:73], s[70:71]
    v_pk_add_f32 v[72:73], v[72:73], 1.0 op_sel_hi:[1,0]
    v_exp_f32 v74, v74 clamp
    v_exp_f32 v75, v75 clamp
    v_lshlrev_b32 v76, 16, v31
    v_and_b32 v77, 0xffff0000, v31
    v_pk_mul_f32 v[78:79], v[76:77], s[70:71]
    v_pk_add_f32 v[76:77], v[76:77], 1.0 op_sel_hi:[1,0]
    v_exp_f32 v78, v78 clamp
    v_exp_f32 v79, v79 clamp
    v_max_f32 v72, v72, v74
    v_max_f32 v73, v73, v75
    v_cvt_pk_bf16_f32 v46, v72, v73
    v_max_f32 v76, v76, v78
    v_max_f32 v77, v77, v79
    v_cvt_pk_bf16_f32 v47, v76, v77
H_fv:
    ds_read_b64 v[14:15], v10 offset:16
    s_waitcnt lgkmcnt(0)
    v_min_u32 v13, v14, v15
    v_cmp_eq_u32 vcc, 0, v13
    s_cbranch_vccnz H_fv
    ds_read_b128 v[208:211], v11 offset:0
    ds_read_b128 v[212:215], v11 offset:1024
    ds_read_b128 v[216:219], v11 offset:2048
    ds_read_b128 v[220:223], v11 offset:3072
    ds_read_b128 v[224:227], v11 offset:4096
    ds_read_b128 v[228:231], v11 offset:5120
    ds_read_b128 v[232:235], v11 offset:6144
    ds_read_b128 v[236:239], v11 offset:7168
    v_max_u32 v13, v14, v15
    v_cmp_eq_u32 vcc, 2, v13
    s_cbranch_vccnz H_eps
    v_mfma_f32_16x16x32_bf16 v[200:203], v[32:35], v[204:207], 0
    s_waitcnt lgkmcnt(7)
    v_mfma_f32_16x16x32_bf16 v[192:195], v[32:35], v[208:211], 0
    s_waitcnt lgkmcnt(6)
    v_mfma_f32_16x16x32_bf16 v[196:199], v[32:35], v[212:215], 0
    v_mfma_f32_16x16x32_bf16 v[200:203], v[36:39], v[204:207], v[200:203]
    s_waitcnt lgkmcnt(5)
    v_mfma_f32_16x16x32_bf16 v[192:195], v[36:39], v[216:219], v[192:195]
    s_waitcnt lgkmcnt(4)
    v_mfma_f32_16x16x32_bf16 v[196:199], v[36:39], v[220:223], v[196:199]
    v_mfma_f32_16x16x32_bf16 v[200:203], v[40:43], v[204:207], v[200:203]
    s_waitcnt lgkmcnt(3)
    v_mfma_f32_16x16x32_bf16 v[192:195], v[40:43], v[224:227], v[192:195]
    s_waitcnt lgkmcnt(2)
    v_mfma_f32_16x16x32_bf16 v[196:199], v[40:43], v[228:231], v[196:199]
    v_mfma_f32_16x16x32_bf16 v[200:203], v[44:47], v[204:207], v[200:203]
    s_waitcnt lgkmcnt(1)
    v_mfma_f32_16x16x32_bf16 v[192:195], v[44:47], v[232:235], v[192:195]
    s_waitcnt lgkmcnt(0)
    v_mfma_f32_16x16x32_bf16 v[196:199], v[44:47], v[236:239], v[196:199]
H_ne:
    v_lshrrev_b32 v13, 4, v2
    v_lshlrev_b32 v13, 4, v13
    v_and_b32 v14, 15, v2
    v_cmp_eq_u32 s[68:69], 0, v14
    s_lshl_b32 s66, s44, 11
    s_add_u32 s66, s66, 139264
    v_add_u32 v3, s66, v9
    s_waitcnt vmcnt(12)
    s_nop 1
    v_cvt_pk_bf16_f32 v72, v192, v193
    v_cvt_pk_bf16_f32 v73, v194, v195
    v_cvt_pk_bf16_f32 v74, v196, v197
    v_cvt_pk_bf16_f32 v75, v198, v199
    buffer_store_dwordx4 v[72:75], v9, s[16:19], s56 offen sc0 sc1
    s_mov_b64 exec, s[68:69]
    buffer_store_dwordx4 v[200:203], v13, s[16:19], s53 offen sc0 sc1
    s_mov_b64 exec, -1
    s_add_u32 s67, s52, 262144
    s_and_b32 s67, s67, 0x1fffff
    s_add_u32 m0, s72, 32768
    s_add_u32 s66, s67, 0
    buffer_load_dwordx4 v90, s[20:23], s66 offen lds
    s_add_u32 m0, s72, 36864
    s_add_u32 s66, s67, 65536
    buffer_load_dwordx4 v90, s[20:23], s66 offen lds
    s_add_u32 s67, s52, 262144
    s_and_b32 s67, s67, 0x1fffff
    s_add_u32 m0, s72, 49152
    s_add_u32 s66, s67, 131072
    buffer_load_dwordx4 v90, s[20:23], s66 offen lds
    s_add_u32 m0, s72, 53248
    s_add_u32 s66, s67, 196608
    buffer_load_dwordx4 v90, s[20:23], s66 offen lds
    v_bfe_u32 v12, v2, 4, 1
    v_lshrrev_b32 v13, 5, v2
    v_lshl_add_u32 v12, v12, 1, v13
    v_bfe_u32 v13, v2, 1, 3
    v_xor_b32 v12, v12, v13
    v_and_b32 v13, 127, v92
    v_lshlrev_b32 v13, 7, v13
    v_lshl_add_u32 v12, v12, 4, v13
    v_add_u32 v12, 122880, v12
    v_xor_b32 v13, 64, v12
    ds_read_b128 v[144:147], v12
    ds_read_b128 v[148:151], v13
    s_waitcnt lgkmcnt(0)
    s_setprio 0
    s_barrier
    ds_read_b128 v[16:19], v3
    ds_read_b128 v[20:23], v3 offset:1024
    buffer_load_dwordx4 v[80:83], v1, s[16:19], s62 offen sc1
    buffer_load_dwordx4 v[84:87], v1, s[16:19], s63 offen sc1
    s_add_u32 s67, s52, 524288
    s_and_b32 s67, s67, 0x1fffff
    s_add_u32 m0, s72, 81920
    s_add_u32 s66, s67, 0
    buffer_load_dwordx4 v90, s[20:23], s66 offen lds
    s_add_u32 m0, s72, 86016
    s_add_u32 s66, s67, 65536
    buffer_load_dwordx4 v90, s[20:23], s66 offen lds
    s_add_u32 s67, s52, 524288
    s_and_b32 s67, s67, 0x1fffff
    s_add_u32 m0, s72, 90112
    s_add_u32 s66, s67, 131072
    buffer_load_dwordx4 v90, s[20:23], s66 offen lds
    s_add_u32 m0, s72, 94208
    s_add_u32 s66, s67, 196608
    buffer_load_dwordx4 v90, s[20:23], s66 offen lds
    s_add_u32 s67, s52, 786432
    s_and_b32 s67, s67, 0x1fffff
    s_add_u32 m0, s72, 0
    s_add_u32 s66, s67, 0
    buffer_load_dwordx4 v90, s[20:23], s66 offen lds
    s_add_u32 m0, s72, 4096
    s_add_u32 s66, s67, 65536
    buffer_load_dwordx4 v90, s[20:23], s66 offen lds
    s_add_u32 s67, s52, 786432
    s_and_b32 s67, s67, 0x1fffff
    s_add_u32 m0, s72, 57344
    s_add_u32 s66, s67, 131072
    buffer_load_dwordx4 v90, s[20:23], s66 offen lds
    s_add_u32 m0, s72, 61440
    s_add_u32 s66, s67, 196608
    buffer_load_dwordx4 v90, s[20:23], s66 offen lds
    s_waitcnt lgkmcnt(0)
    v_lshlrev_b32 v32, 16, v16
    v_and_b32 v33, 0xffff0000, v16
    v_pk_mul_f32 v[34:35], v[32:33], s[70:71]
    v_pk_add_f32 v[32:33], v[32:33], 1.0 op_sel_hi:[1,0]
    v_exp_f32 v34, v34 clamp
    v_exp_f32 v35, v35 clamp
    v_lshlrev_b32 v36, 16, v17
    v_and_b32 v37, 0xffff0000, v17
    v_pk_mul_f32 v[38:39], v[36:37], s[70:71]
    v_pk_add_f32 v[36:37], v[36:37], 1.0 op_sel_hi:[1,0]
    v_exp_f32 v38, v38 clamp
    v_exp_f32 v39, v39 clamp
    v_max_f32 v32, v32, v34
    v_max_f32 v33, v33, v35
    v_min_f32 v40, v32, v33
    v_cvt_pk_bf16_f32 v24, v32, v33
    v_max_f32 v36, v36, v38
    v_max_f32 v37, v37, v39
    v_min3_f32 v40, v36, v37, v40
    v_cvt_pk_bf16_f32 v25, v36, v37
    v_lshlrev_b32 v32, 16, v18
    v_and_b32 v33, 0xffff0000, v18
    v_pk_mul_f32 v[34:35], v[32:33], s[70:71]
    v_pk_add_f32 v[32:33], v[32:33], 1.0 op_sel_hi:[1,0]
    v_exp_f32 v34, v34 clamp
    v_exp_f32 v35, v35 clamp
    v_lshlrev_b32 v36, 16, v19
    v_and_b32 v37, 0xffff0000, v19
    v_pk_mul_f32 v[38:39], v[36:37], s[70:71]
    v_pk_add_f32 v[36:37], v[36:37], 1.0 op_sel_hi:[1,0]
    v_exp_f32 v38, v38 clamp
    v_exp_f32 v39, v39 clamp
    v_max_f32 v32, v32, v34
    v_max_f32 v33, v33, v35
    v_min3_f32 v40, v32, v33, v40
    v_cvt_pk_bf16_f32 v26, v32, v33
    v_max_f32 v36, v36, v38
    v_max_f32 v37, v37, v39
    v_min3_f32 v40, v36, v37, v40
    v_cvt_pk_bf16_f32 v27, v36, v37
    v_lshlrev_b32 v32, 16, v20
    v_and_b32 v33, 0xffff0000, v20
    v_pk_mul_f32 v[34:35], v[32:33], s[70:71]
    v_pk_add_f32 v[32:33], v[32:33], 1.0 op_sel_hi:[1,0]
    v_exp_f32 v34, v34 clamp
    v_exp_f32 v35, v35 clamp
    v_lshlrev_b32 v36, 16, v21
    v_and_b32 v37, 0xffff0000, v21
    v_pk_mul_f32 v[38:39], v[36:37], s[70:71]
    v_pk_add_f32 v[36:37], v[36:37], 1.0 op_sel_hi:[1,0]
    v_exp_f32 v38, v38 clamp
    v_exp_f32 v39, v39 clamp
    v_max_f32 v32, v32, v34
    v_max_f32 v33, v33, v35
    v_min3_f32 v40, v32, v33, v40
    v_cvt_pk_bf16_f32 v28, v32, v33
    v_max_f32 v36, v36, v38
    v_max_f32 v37, v37, v39
    v_min3_f32 v40, v36, v37, v40
    v_cvt_pk_bf16_f32 v29, v36, v37
    v_lshlrev_b32 v32, 16, v22
    v_and_b32 v33, 0xffff0000, v22
    v_pk_mul_f32 v[34:35], v[32:33], s[70:71]
    v_pk_add_f32 v[32:33], v[32:33], 1.0 op_sel_hi:[1,0]
    v_exp_f32 v34, v34 clamp
    v_exp_f32 v35, v35 clamp
    v_lshlrev_b32 v36, 16, v23
    v_and_b32 v37, 0xffff0000, v23
    v_pk_mul_f32 v[38:39], v[36:37], s[70:71]
    v_pk_add_f32 v[36:37], v[36:37], 1.0 op_sel_hi:[1,0]
    v_exp_f32 v38, v38 clamp
    v_exp_f32 v39, v39 clamp
    v_max_f32 v32, v32, v34
    v_max_f32 v33, v33, v35
    v_min3_f32 v40, v32, v33, v40
    v_cvt_pk_bf16_f32 v30, v32, v33
    v_max_f32 v36, v36, v38
    v_max_f32 v37, v37, v39
    v_min3_f32 v40, v36, v37, v40
    v_cvt_pk_bf16_f32 v31, v36, v37
    v_cmp_gt_f32 vcc, 0x3a800000, v40
    s_cbranch_vccz P_qh
    v_lshlrev_b32 v32, 16, v24
    v_and_b32 v33, 0xffff0000, v24
    v_add_f32 v32, s47, v32
    v_add_f32 v33, s47, v33
    v_cvt_pk_bf16_f32 v24, v32, v33
    v_lshlrev_b32 v32, 16, v25
    v_and_b32 v33, 0xffff0000, v25
    v_add_f32 v32, s47, v32
    v_add_f32 v33, s47, v33
    v_cvt_pk_bf16_f32 v25, v32, v33
    v_lshlrev_b32 v32, 16, v26
    v_and_b32 v33, 0xffff0000, v26
    v_add_f32 v32, s47, v32
    v_add_f32 v33, s47, v33
    v_cvt_pk_bf16_f32 v26, v32, v33
    v_lshlrev_b32 v32, 16, v27
    v_and_b32 v33, 0xffff0000, v27
    v_add_f32 v32, s47, v32
    v_add_f32 v33, s47, v33
    v_cvt_pk_bf16_f32 v27, v32, v33
    v_lshlrev_b32 v32, 16, v28
    v_and_b32 v33, 0xffff0000, v28
    v_add_f32 v32, s47, v32
    v_add_f32 v33, s47, v33
    v_cvt_pk_bf16_f32 v28, v32, v33
    v_lshlrev_b32 v32, 16, v29
    v_and_b32 v33, 0xffff0000, v29
    v_add_f32 v32, s47, v32
    v_add_f32 v33, s47, v33
    v_cvt_pk_bf16_f32 v29, v32, v33
    v_lshlrev_b32 v32, 16, v30
    v_and_b32 v33, 0xffff0000, v30
    v_add_f32 v32, s47, v32
    v_add_f32 v33, s47, v33
    v_cvt_pk_bf16_f32 v30, v32, v33
    v_lshlrev_b32 v32, 16, v31
    v_and_b32 v33, 0xffff0000, v31
    v_add_f32 v32, s47, v32
    v_add_f32 v33, s47, v33
    v_cvt_pk_bf16_f32 v31, v32, v33
P_qh:
    s_lshl_b32 s66, s49, 11
    s_add_u32 s66, s66, 159744
    v_add_u32 v10, s66, v9
    s_lshl_b32 s66, s49, 6
    s_add_u32 s66, s66, 159488
    v_lshrrev_b32 v11, 4, v2
    v_lshlrev_b32 v11, 4, v11
    v_add_u32 v11, s66, v11
    s_waitcnt vmcnt(8)
    s_mov_b32 s59, 0
Q_hchk:
    v_max3_u32 v5, v80, v81, v82
    v_max3_u32 v5, v5, v83, v84
    v_max3_u32 v5, v5, v85, v86
    v_max_u32 v5, v5, v87
    v_cmp_eq_u32 vcc, -1, v5
    s_cbranch_vccz Q_hok
    s_add_u32 s59, s59, 1
    s_cmp_ge_u32 s59, 200000
    s_cbranch_scc1 Q_hok
    s_sleep 4
    buffer_load_dwordx4 v[80:83], v1, s[16:19], s62 offen sc1
    buffer_load_dwordx4 v[84:87], v1, s[16:19], s63 offen sc1
    s_waitcnt vmcnt(0)
    s_branch Q_hchk
Q_hok:
    v_permlane16_swap_b32 v80, v82
    v_permlane16_swap_b32 v81, v83
    v_permlane16_swap_b32 v84, v86
    v_permlane16_swap_b32 v85, v87
    v_add_f32 v80, v80, v82
    v_add_f32 v81, v81, v83
    v_add_f32 v84, v84, v86
    v_add_f32 v85, v85, v87
    v_and_b32 v5, 3, v2
    v_lshlrev_b32 v5, 3, v5
    v_permlane32_swap_b32 v80, v81
    v_permlane32_swap_b32 v84, v85
    v_bfe_u32 v6, v2, 4, 1
    v_lshl_add_u32 v5, v6, 2, v5
    v_add_f32 v80, v80, v81
    v_add_f32 v84, v84, v85
    v_lshrrev_b32 v6, 5, v2
    v_lshl_add_u32 v5, v6, 1, v5
    v_add_f32_dpp v80, v80, v80 row_ror:4 row_mask:0xf bank_mask:0xf
    v_add_f32_dpp v84, v84, v84 row_ror:4 row_mask:0xf bank_mask:0xf
    s_nop 0
    v_add_f32_dpp v80, v80, v80 row_ror:8 row_mask:0xf bank_mask:0xf
    v_add_f32_dpp v84, v84, v84 row_ror:8 row_mask:0xf bank_mask:0xf
    s_nop 0
    s_lshl_b32 s66, s44, 5
    s_add_u32 s66, s66, 155712
    v_cvt_pk_bf16_f32 v80, 0, v80
    v_cvt_pk_bf16_f32 v84, 0, v84
    v_mul_f32 v81, s46, v80
    v_exp_f32 v81, -v81
    v_add_u32 v5, s66, v5
    v_add_f32 v81, 1.0, v81
    v_rcp_f32 v81, v81
    v_lshlrev_b32 v6, 4, v6
    v_mul_f32 v81, v81, v80
    v_cvt_pk_bf16_f32 v81, 0, v81
    v_add_u32 v6, s66, v6
    v_mul_f32 v81, v81, v84
    v_cvt_pk_bf16_f32 v81, v81, v81
    ds_write_b16 v5, v81
    ds_read_b128 v[84:87], v6
    v_mov_b32 v64, 0
    v_mov_b32 v65, 0
    v_mov_b32 v66, 0
    v_mov_b32 v67, 0
    v_mov_b32 v68, 0
    v_mov_b32 v69, 0
    v_mov_b32 v70, 0
    v_mov_b32 v71, 0
    s_waitcnt lgkmcnt(0)
    v_and_b32 v72, 0xffff, v84
    v_lshlrev_b32 v73, 16, v84
    v_dot2_f32_bf16 v64, v96, v72, v64
    v_dot2_f32_bf16 v65, v96, v73, v65
    v_dot2_f32_bf16 v66, v97, v72, v66
    v_dot2_f32_bf16 v67, v97, v73, v67
    v_dot2_f32_bf16 v68, v98, v72, v68
    v_dot2_f32_bf16 v69, v98, v73, v69
    v_dot2_f32_bf16 v70, v99, v72, v70
    v_dot2_f32_bf16 v71, v99, v73, v71
    v_lshrrev_b32 v72, 16, v84
    v_and_b32 v73, 0xffff0000, v84
    v_dot2_f32_bf16 v64, v100, v72, v64
    v_dot2_f32_bf16 v65, v100, v73, v65
    v_dot2_f32_bf16 v66, v101, v72, v66
    v_dot2_f32_bf16 v67, v101, v73, v67
    v_dot2_f32_bf16 v68, v102, v72, v68
    v_dot2_f32_bf16 v69, v102, v73, v69
    v_dot2_f32_bf16 v70, v103, v72, v70
    v_dot2_f32_bf16 v71, v103, v73, v71
    v_and_b32 v72, 0xffff, v85
    v_lshlrev_b32 v73, 16, v85
    v_dot2_f32_bf16 v64, v104, v72, v64
    v_dot2_f32_bf16 v65, v104, v73, v65
    v_dot2_f32_bf16 v66, v105, v72, v66
    v_dot2_f32_bf16 v67, v105, v73, v67
    v_dot2_f32_bf16 v68, v106, v72, v68
    v_dot2_f32_bf16 v69, v106, v73, v69
    v_dot2_f32_bf16 v70, v107, v72, v70
    v_dot2_f32_bf16 v71, v107, v73, v71
    v_lshrrev_b32 v72, 16, v85
    v_and_b32 v73, 0xffff0000, v85
    v_dot2_f32_bf16 v64, v108, v72, v64
    v_dot2_f32_bf16 v65, v108, v73, v65
    v_dot2_f32_bf16 v66, v109, v72, v66
    v_dot2_f32_bf16 v67, v109, v73, v67
    v_dot2_f32_bf16 v68, v110, v72, v68
    v_dot2_f32_bf16 v69, v110, v73, v69
    v_dot2_f32_bf16 v70, v111, v72, v70
    v_dot2_f32_bf16 v71, v111, v73, v71
    v_and_b32 v72, 0xffff, v86
    v_lshlrev_b32 v73, 16, v86
    v_dot2_f32_bf16 v64, v112, v72, v64
    v_dot2_f32_bf16 v65, v112, v73, v65
    v_dot2_f32_bf16 v66, v113, v72, v66
    v_dot2_f32_bf16 v67, v113, v73, v67
    v_dot2_f32_bf16 v68, v114, v72, v68
    v_dot2_f32_bf16 v69, v114, v73, v69
    v_dot2_f32_bf16 v70, v115, v72, v70
    v_dot2_f32_bf16 v71, v115, v73, v71
    v_lshrrev_b32 v72, 16, v86
    v_and_b32 v73, 0xffff0000, v86
    v_dot2_f32_bf16 v64, v116, v72, v64
    v_dot2_f32_bf16 v65, v116, v73, v65
    v_dot2_f32_bf16 v66, v117, v72, v66
    v_dot2_f32_bf16 v67, v117, v73, v67
    v_dot2_f32_bf16 v68, v118, v72, v68
    v_dot2_f32_bf16 v69, v118, v73, v69
    v_dot2_f32_bf16 v70, v119, v72, v70
    v_dot2_f32_bf16 v71, v119, v73, v71
    v_and_b32 v72, 0xffff, v87
    v_lshlrev_b32 v73, 16, v87
    v_dot2_f32_bf16 v64, v120, v72, v64
    v_dot2_f32_bf16 v65, v120, v73, v65
    v_dot2_f32_bf16 v66, v121, v72, v66
    v_dot2_f32_bf16 v67, v121, v73, v67
    v_dot2_f32_bf16 v68, v122, v72, v68
    v_dot2_f32_bf16 v69, v122, v73, v69
    v_dot2_f32_bf16 v70, v123, v72, v70
    v_dot2_f32_bf16 v71, v123, v73, v71
    v_lshrrev_b32 v72, 16, v87
    v_and_b32 v73, 0xffff0000, v87
    v_dot2_f32_bf16 v64, v124, v72, v64
    v_dot2_f32_bf16 v65, v124, v73, v65
    v_dot2_f32_bf16 v66, v125, v72, v66
    v_dot2_f32_bf16 v67, v125, v73, v67
    v_dot2_f32_bf16 v68, v126, v72, v68
    v_dot2_f32_bf16 v69, v126, v73, v69
    v_dot2_f32_bf16 v70, v127, v72, v70
    v_dot2_f32_bf16 v71, v127, v73, v71
    v_and_b32 v76, 31, v2
    v_lshrrev_b32 v77, 5, v2
    v_lshl_add_u32 v76, v76, 1, v77
    v_permlane32_swap_b32 v64, v68
    v_permlane32_swap_b32 v65, v69
    v_permlane32_swap_b32 v66, v70
    v_permlane32_swap_b32 v67, v71
    v_lshlrev_b32 v76, 4, v76
    v_add_f32 v64, v64, v68
    v_add_f32 v65, v65, v69
    v_add_f32 v66, v66, v70
    v_add_f32 v67, v67, v71
    s_add_u32 s66, s72, 147456
    v_add_u32 v76, s66, v76
    ds_write_b128 v76, v[64:67]
    s_lshl_b32 s66, s6, 6
    s_add_u32 s66, s66, 5242880
    v_lshlrev_b32 v15, 10, v2
    v_add_u32 v15, s66, v15
    s_cmp_lg_u32 s44, 0
    s_cbranch_scc1 H_pd
    s_mov_b32 s59, 0
H_pl:
    buffer_load_dword v14, v15, s[16:19], 0 offen sc1
    s_waitcnt vmcnt(0)
    v_cmp_eq_u32 vcc, -1, v14
    s_cbranch_vccz H_pd
    s_add_u32 s59, s59, 1
    s_cmp_ge_u32 s59, 200000
    s_cbranch_scc1 H_pd
    s_sleep 2
    s_branch H_pl
H_pd:
POST:
    s_waitcnt lgkmcnt(0)
    s_barrier
    s_mov_b32 s66, 6094848
    buffer_load_dword v152, v93, s[16:19], s66 offen sc1
    ds_read_b128 v[40:43], v11
    ds_read_b128 v[32:35], v10
    ds_read_b128 v[36:39], v10 offset:1024
    v_mov_b32 v3, 155684
    ds_read_b32 v4, v3
    s_waitcnt lgkmcnt(3)
    v_mfma_f32_16x16x32_bf16 v[60:63], v[40:43], v[24:27], 0
    v_mfma_f32_16x16x32_bf16 v[64:67], v[40:43], v[28:31], 0
    s_waitcnt lgkmcnt(1)
    v_mfma_f32_16x16x32_bf16 v[44:47], v[32:35], v[24:27], 0
    v_mfma_f32_16x16x32_bf16 v[48:51], v[36:39], v[24:27], 0
    v_mfma_f32_16x16x32_bf16 v[52:55], v[32:35], v[28:31], 0
    v_mfma_f32_16x16x32_bf16 v[56:59], v[36:39], v[28:31], 0
    s_nop 3
    v_cvt_pk_bf16_f32 v60, 0, v60
    v_cvt_pk_bf16_f32 v64, 0, v64
    v_add_f32 v60, s47, v60
    v_add_f32 v64, s47, v64
    v_cvt_pk_bf16_f32 v60, 0, v60
    v_cvt_pk_bf16_f32 v64, 0, v64
    v_rcp_f32 v60, v60
    v_rcp_f32 v64, v64
    v_cvt_pk_bf16_f32 v44, 0, v44
    v_cvt_pk_bf16_f32 v45, 0, v45
    v_cvt_pk_bf16_f32 v46, 0, v46
    v_cvt_pk_bf16_f32 v47, 0, v47
    v_cvt_pk_bf16_f32 v48, 0, v48
    v_cvt_pk_bf16_f32 v49, 0, v49
    v_cvt_pk_bf16_f32 v50, 0, v50
    v_cvt_pk_bf16_f32 v51, 0, v51
    v_pk_mul_f32 v[44:45], v[44:45], v[60:61] op_sel_hi:[1,0]
    v_pk_mul_f32 v[46:47], v[46:47], v[60:61] op_sel_hi:[1,0]
    v_pk_mul_f32 v[48:49], v[48:49], v[60:61] op_sel_hi:[1,0]
    v_pk_mul_f32 v[50:51], v[50:51], v[60:61] op_sel_hi:[1,0]
    v_cvt_pk_bf16_f32 v32, v44, v45
    v_cvt_pk_bf16_f32 v33, v46, v47
    v_cvt_pk_bf16_f32 v34, v48, v49
    v_cvt_pk_bf16_f32 v35, v50, v51
    buffer_store_dwordx4 v[32:35], v9, s[16:19], s60 offen sc0 sc1
    v_cvt_pk_bf16_f32 v52, 0, v52
    v_cvt_pk_bf16_f32 v53, 0, v53
    v_cvt_pk_bf16_f32 v54, 0, v54
    v_cvt_pk_bf16_f32 v55, 0, v55
    v_cvt_pk_bf16_f32 v56, 0, v56
    v_cvt_pk_bf16_f32 v57, 0, v57
    v_cvt_pk_bf16_f32 v58, 0, v58
    v_cvt_pk_bf16_f32 v59, 0, v59
    v_pk_mul_f32 v[52:53], v[52:53], v[64:65] op_sel_hi:[1,0]
    v_pk_mul_f32 v[54:55], v[54:55], v[64:65] op_sel_hi:[1,0]
    v_pk_mul_f32 v[56:57], v[56:57], v[64:65] op_sel_hi:[1,0]
    v_pk_mul_f32 v[58:59], v[58:59], v[64:65] op_sel_hi:[1,0]
    v_cvt_pk_bf16_f32 v36, v52, v53
    v_cvt_pk_bf16_f32 v37, v54, v55
    v_cvt_pk_bf16_f32 v38, v56, v57
    v_cvt_pk_bf16_f32 v39, v58, v59
    buffer_store_dwordx4 v[36:39], v9, s[16:19], s61 offen sc0 sc1
    s_waitcnt lgkmcnt(0)
    v_readfirstlane_b32 s74, v4
    s_waitcnt vmcnt(3)
    s_barrier
    s_lshl_b32 s53, s45, 12
    s_add_u32 s53, s53, s72
    s_lshl_b32 s54, s45, 16
    s_add_u32 s67, s52, 1048576
    s_and_b32 s67, s67, 0x1fffff
    s_add_u32 m0, s53, 8192
    s_add_u32 s67, s67, s54
    s_add_u32 s67, s67, 0
    buffer_load_dwordx4 v90, s[20:23], s67 offen lds
    s_add_u32 s67, s52, 1048576
    s_and_b32 s67, s67, 0x1fffff
    s_add_u32 m0, s53, 65536
    s_add_u32 s67, s67, s54
    s_add_u32 s67, s67, 131072
    buffer_load_dwordx4 v90, s[20:23], s67 offen lds
    s_add_u32 s67, s52, 1310720
    s_and_b32 s67, s67, 0x1fffff
    s_add_u32 m0, s53, 16384
    s_add_u32 s67, s67, s54
    s_add_u32 s67, s67, 0
    buffer_load_dwordx4 v90, s[20:23], s67 offen lds
    s_add_u32 s67, s52, 1310720
    s_and_b32 s67, s67, 0x1fffff
    s_add_u32 m0, s53, 73728
    s_add_u32 s67, s67, s54
    s_add_u32 s67, s67, 131072
    buffer_load_dwordx4 v90, s[20:23], s67 offen lds
    s_add_u32 s67, s52, 1572864
    s_and_b32 s67, s67, 0x1fffff
    s_add_u32 m0, s53, 98304
    s_add_u32 s67, s67, s54
    s_add_u32 s67, s67, 0
    buffer_load_dwordx4 v90, s[20:23], s67 offen lds
    s_add_u32 s67, s52, 1572864
    s_and_b32 s67, s67, 0x1fffff
    s_add_u32 m0, s53, 114688
    s_add_u32 s67, s67, s54
    s_add_u32 s67, s67, 131072
    buffer_load_dwordx4 v90, s[20:23], s67 offen lds
    s_add_u32 s67, s52, 1835008
    s_and_b32 s67, s67, 0x1fffff
    s_add_u32 m0, s53, 106496
    s_add_u32 s67, s67, s54
    s_add_u32 s67, s67, 0
    buffer_load_dwordx4 v90, s[20:23], s67 offen lds
    s_add_u32 s67, s52, 1835008
    s_and_b32 s67, s67, 0x1fffff
    s_add_u32 m0, s53, 122880
    s_add_u32 s67, s67, s54
    s_add_u32 s67, s67, 131072
    buffer_load_dwordx4 v90, s[20:23], s67 offen lds
    s_cmp_eq_u32 s45, 0
    s_cbranch_scc0 Q_hg
    s_branch Q_hd
Q_hg:
    s_waitcnt lgkmcnt(0)
Q_hd:
    s_and_b32 s75, s74, 0x7ff
    s_sub_u32 s75, 2047, s75
    s_lshl_b32 s66, s6, 3
    s_lshl_b32 s67, s44, 1
    s_add_u32 s66, s66, s67
    s_lshl_b32 s66, s66, 15
    s_lshl_b32 s67, s45, 11
    s_add_u32 s66, s66, s67
    s_lshl_b32 s67, s45, 15
    s_add_u32 s66, s66, s67
    v_add_u32 v4, s66, v9
    v_xor_b32 v3, 0x8000, v4
    s_lshr_b32 s63, s52, 6
    v_lshrrev_b32 v5, 4, v2
    v_bfe_u32 v6, v2, 2, 2
    v_lshl_add_u32 v8, v5, 2, v6
    v_bfe_u32 v6, v8, 1, 2
    v_lshlrev_b32 v8, 7, v8
    v_and_b32 v5, 3, v2
    v_lshl_add_u32 v8, v5, 3, v8
    s_mul_i32 s66, s45, 16384
    s_add_u32 s66, s66, 24576
    s_mul_i32 s67, s45, 8192
    s_add_u32 s67, s67, 81920
    s_mul_i32 s68, s45, 57344
    s_add_u32 s68, s68, 0
    s_mul_i32 s69, s45, 16384
    s_add_u32 s69, s69, 98304
    v_xor_b32 v5, 0, v6
    v_lshl_add_u32 v5, v5, 5, v8
    v_add_u32 v160, s66, v5
    v_add_u32 v164, s67, v5
    v_add_u32 v168, s68, v5
    v_add_u32 v172, s69, v5
    v_xor_b32 v5, 1, v6
    v_lshl_add_u32 v5, v5, 5, v8
    v_add_u32 v161, s66, v5
    v_add_u32 v165, s67, v5
    v_add_u32 v169, s68, v5
    v_add_u32 v173, s69, v5
    v_xor_b32 v5, 2, v6
    v_lshl_add_u32 v5, v5, 5, v8
    v_add_u32 v162, s66, v5
    v_add_u32 v166, s67, v5
    v_add_u32 v170, s68, v5
    v_add_u32 v174, s69, v5
    v_xor_b32 v5, 3, v6
    v_lshl_add_u32 v5, v5, 5, v8
    v_add_u32 v163, s66, v5
    v_add_u32 v167, s67, v5
    v_add_u32 v171, s68, v5
    v_add_u32 v175, s69, v5
    s_lshr_b32 s66, s75, 7
    s_cmp_eq_u32 s66, s6
    s_cselect_b32 s51, 1, 0
    s_barrier
    s_add_u32 s66, s63, 0
    s_and_b32 s66, s66, 0x7fff
    buffer_load_dwordx4 v[96:99], v3, s[16:19], s66 offen offset:0 sc1
    buffer_load_dwordx4 v[100:103], v4, s[16:19], s66 offen offset:0 sc1
    buffer_load_dwordx4 v[104:107], v3, s[16:19], s66 offen offset:1024 sc1
    buffer_load_dwordx4 v[108:111], v4, s[16:19], s66 offen offset:1024 sc1
    s_cmp_eq_u32 s45, 0
    s_cbranch_scc1 Q_ny4
    s_lshl_b32 s66, s44, 8
    s_add_u32 s66, s66, 147456
    v_lshlrev_b32 v5, 2, v2
    v_add_u32 v6, s66, v5
    ds_read_b32 v64, v6 offset:0
    ds_read_b32 v65, v6 offset:1024
    ds_read_b32 v66, v6 offset:2048
    ds_read_b32 v67, v6 offset:3072
    s_waitcnt lgkmcnt(0)
    v_add_f32 v64, v64, v65
    v_add_f32 v66, v66, v67
    v_add_f32 v64, v64, v66
    buffer_store_dword v64, v5, s[16:19], s55 offen sc0 sc1
Q_ny4:
    s_add_u32 s66, s63, 4096
    s_and_b32 s66, s66, 0x7fff
    buffer_load_dwordx4 v[112:115], v3, s[16:19], s66 offen offset:0 sc1
    buffer_load_dwordx4 v[116:119], v4, s[16:19], s66 offen offset:0 sc1
    buffer_load_dwordx4 v[120:123], v3, s[16:19], s66 offen offset:1024 sc1
    buffer_load_dwordx4 v[124:127], v4, s[16:19], s66 offen offset:1024 sc1
    ds_read_b64_tr_b16 v[192:193], v160 offset:0
    ds_read_b64_tr_b16 v[194:195], v160 offset:2048
    ds_read_b64_tr_b16 v[196:197], v161 offset:0
    ds_read_b64_tr_b16 v[198:199], v161 offset:2048
    ds_read_b64_tr_b16 v[200:201], v162 offset:0
    ds_read_b64_tr_b16 v[202:203], v162 offset:2048
    ds_read_b64_tr_b16 v[204:205], v163 offset:0
    ds_read_b64_tr_b16 v[206:207], v163 offset:2048
    s_waitcnt vmcnt(4)
    v_max3_u32 v5, v96, v97, v98
    v_max3_u32 v5, v5, v99, v100
    v_max3_u32 v5, v5, v101, v102
    v_max3_u32 v5, v5, v103, v104
    v_max3_u32 v5, v5, v105, v106
    v_max3_u32 v5, v5, v107, v108
    v_max3_u32 v5, v5, v109, v110
    v_max_u32 v5, v5, v111
    v_cmp_eq_u32 vcc, -1, v5
    s_cbranch_vccnz Q_rt0
Q_go0:
    s_add_u32 s66, s63, 8192
    s_and_b32 s66, s66, 0x7fff
    s_waitcnt lgkmcnt(6)
    v_mfma_f32_16x16x32_bf16 v[224:227], v[192:195], v[96:99], 0
    buffer_load_dwordx4 v[128:131], v3, s[16:19], s66 offen offset:0 sc1
    v_mfma_f32_16x16x32_bf16 v[240:243], v[192:195], v[100:103], 0
    ds_read_b64_tr_b16 v[208:209], v160 offset:4096
    s_waitcnt lgkmcnt(5)
    v_mfma_f32_16x16x32_bf16 v[228:231], v[196:199], v[96:99], 0
    ds_read_b64_tr_b16 v[210:211], v160 offset:6144
    buffer_load_dwordx4 v[132:135], v4, s[16:19], s66 offen offset:0 sc1
    v_mfma_f32_16x16x32_bf16 v[244:247], v[196:199], v[100:103], 0
    ds_read_b64_tr_b16 v[212:213], v161 offset:4096
    s_waitcnt lgkmcnt(5)
    v_mfma_f32_16x16x32_bf16 v[232:235], v[200:203], v[96:99], 0
    ds_read_b64_tr_b16 v[214:215], v161 offset:6144
    buffer_load_dwordx4 v[136:139], v3, s[16:19], s66 offen offset:1024 sc1
    v_mfma_f32_16x16x32_bf16 v[248:251], v[200:203], v[100:103], 0
    ds_read_b64_tr_b16 v[216:217], v162 offset:4096
    s_waitcnt lgkmcnt(5)
    v_mfma_f32_16x16x32_bf16 v[236:239], v[204:207], v[96:99], 0
    ds_read_b64_tr_b16 v[218:219], v162 offset:6144
    buffer_load_dwordx4 v[140:143], v4, s[16:19], s66 offen offset:1024 sc1
    v_mfma_f32_16x16x32_bf16 v[252:255], v[204:207], v[100:103], 0
    ds_read_b64_tr_b16 v[220:221], v163 offset:4096
    ds_read_b64_tr_b16 v[222:223], v163 offset:6144
    s_waitcnt lgkmcnt(6)
    v_mfma_f32_16x16x32_bf16 v[224:227], v[208:211], v[104:107], v[224:227]
    v_mfma_f32_16x16x32_bf16 v[240:243], v[208:211], v[108:111], v[240:243]
    ds_read_b64_tr_b16 v[192:193], v160 offset:8192
    s_waitcnt lgkmcnt(5)
    v_mfma_f32_16x16x32_bf16 v[228:231], v[212:215], v[104:107], v[228:231]
    s_waitcnt vmcnt(4)
    ds_read_b64_tr_b16 v[194:195], v160 offset:10240
    v_max3_u32 v5, v112, v113, v114
    v_mfma_f32_16x16x32_bf16 v[244:247], v[212:215], v[108:111], v[244:247]
    ds_read_b64_tr_b16 v[196:197], v161 offset:8192
    v_max3_u32 v5, v5, v115, v116
    s_waitcnt lgkmcnt(5)
    v_mfma_f32_16x16x32_bf16 v[232:235], v[216:219], v[104:107], v[232:235]
    ds_read_b64_tr_b16 v[198:199], v161 offset:10240
    v_max3_u32 v5, v5, v117, v118
    v_mfma_f32_16x16x32_bf16 v[248:251], v[216:219], v[108:111], v[248:251]
    ds_read_b64_tr_b16 v[200:201], v162 offset:8192
    v_max3_u32 v5, v5, v119, v120
    v_max3_u32 v5, v5, v121, v122
    s_waitcnt lgkmcnt(5)
    v_mfma_f32_16x16x32_bf16 v[236:239], v[220:223], v[104:107], v[236:239]
    ds_read_b64_tr_b16 v[202:203], v162 offset:10240
    v_max3_u32 v5, v5, v123, v124
    v_max3_u32 v5, v5, v125, v126
    v_mfma_f32_16x16x32_bf16 v[252:255], v[220:223], v[108:111], v[252:255]
    ds_read_b64_tr_b16 v[204:205], v163 offset:8192
    ds_read_b64_tr_b16 v[206:207], v163 offset:10240
    v_max_u32 v5, v5, v127
    v_cmp_eq_u32 vcc, -1, v5
    s_cbranch_vccnz Q_rt1
Q_go1:
    s_add_u32 s66, s63, 12288
    s_and_b32 s66, s66, 0x7fff
    s_waitcnt lgkmcnt(6)
    v_mfma_f32_16x16x32_bf16 v[224:227], v[192:195], v[112:115], v[224:227]
    buffer_load_dwordx4 v[96:99], v3, s[16:19], s66 offen offset:0 sc1
    v_mfma_f32_16x16x32_bf16 v[240:243], v[192:195], v[116:119], v[240:243]
    ds_read_b64_tr_b16 v[208:209], v160 offset:12288
    s_waitcnt lgkmcnt(5)
    v_mfma_f32_16x16x32_bf16 v[228:231], v[196:199], v[112:115], v[228:231]
    ds_read_b64_tr_b16 v[210:211], v160 offset:14336
    buffer_load_dwordx4 v[100:103], v4, s[16:19], s66 offen offset:0 sc1
    v_mfma_f32_16x16x32_bf16 v[244:247], v[196:199], v[116:119], v[244:247]
    ds_read_b64_tr_b16 v[212:213], v161 offset:12288
    s_waitcnt lgkmcnt(5)
    v_mfma_f32_16x16x32_bf16 v[232:235], v[200:203], v[112:115], v[232:235]
    ds_read_b64_tr_b16 v[214:215], v161 offset:14336
    buffer_load_dwordx4 v[104:107], v3, s[16:19], s66 offen offset:1024 sc1
    v_mfma_f32_16x16x32_bf16 v[248:251], v[200:203], v[116:119], v[248:251]
    ds_read_b64_tr_b16 v[216:217], v162 offset:12288
    s_waitcnt lgkmcnt(5)
    v_mfma_f32_16x16x32_bf16 v[236:239], v[204:207], v[112:115], v[236:239]
    ds_read_b64_tr_b16 v[218:219], v162 offset:14336
    buffer_load_dwordx4 v[108:111], v4, s[16:19], s66 offen offset:1024 sc1
    v_mfma_f32_16x16x32_bf16 v[252:255], v[204:207], v[116:119], v[252:255]
    ds_read_b64_tr_b16 v[220:221], v163 offset:12288
    ds_read_b64_tr_b16 v[222:223], v163 offset:14336
    s_waitcnt lgkmcnt(0)
    s_barrier
    s_waitcnt lgkmcnt(6)
    v_mfma_f32_16x16x32_bf16 v[224:227], v[208:211], v[120:123], v[224:227]
    v_mfma_f32_16x16x32_bf16 v[240:243], v[208:211], v[124:127], v[240:243]
    ds_read_b64_tr_b16 v[192:193], v164 offset:0
    s_waitcnt lgkmcnt(5)
    v_mfma_f32_16x16x32_bf16 v[228:231], v[212:215], v[120:123], v[228:231]
    s_waitcnt vmcnt(4)
    ds_read_b64_tr_b16 v[194:195], v164 offset:2048
    v_max3_u32 v5, v128, v129, v130
    v_mfma_f32_16x16x32_bf16 v[244:247], v[212:215], v[124:127], v[244:247]
    ds_read_b64_tr_b16 v[196:197], v165 offset:0
    v_max3_u32 v5, v5, v131, v132
    s_waitcnt lgkmcnt(5)
    v_mfma_f32_16x16x32_bf16 v[232:235], v[216:219], v[120:123], v[232:235]
    ds_read_b64_tr_b16 v[198:199], v165 offset:2048
    v_max3_u32 v5, v5, v133, v134
    v_mfma_f32_16x16x32_bf16 v[248:251], v[216:219], v[124:127], v[248:251]
    ds_read_b64_tr_b16 v[200:201], v166 offset:0
    v_max3_u32 v5, v5, v135, v136
    v_max3_u32 v5, v5, v137, v138
    s_waitcnt lgkmcnt(5)
    v_mfma_f32_16x16x32_bf16 v[236:239], v[220:223], v[120:123], v[236:239]
    ds_read_b64_tr_b16 v[202:203], v166 offset:2048
    v_max3_u32 v5, v5, v139, v140
    v_max3_u32 v5, v5, v141, v142
    v_mfma_f32_16x16x32_bf16 v[252:255], v[220:223], v[124:127], v[252:255]
    ds_read_b64_tr_b16 v[204:205], v167 offset:0
    ds_read_b64_tr_b16 v[206:207], v167 offset:2048
    v_max_u32 v5, v5, v143
    v_cmp_eq_u32 vcc, -1, v5
    s_cbranch_vccnz Q_rt2
Q_go2:
    s_add_u32 s66, s63, 16384
    s_and_b32 s66, s66, 0x7fff
    s_waitcnt lgkmcnt(6)
    v_mfma_f32_16x16x32_bf16 v[224:227], v[192:195], v[128:131], v[224:227]
    buffer_load_dwordx4 v[112:115], v3, s[16:19], s66 offen offset:0 sc1
    v_mfma_f32_16x16x32_bf16 v[240:243], v[192:195], v[132:135], v[240:243]
    ds_read_b64_tr_b16 v[208:209], v164 offset:4096
    s_waitcnt lgkmcnt(5)
    v_mfma_f32_16x16x32_bf16 v[228:231], v[196:199], v[128:131], v[228:231]
    ds_read_b64_tr_b16 v[210:211], v164 offset:6144
    buffer_load_dwordx4 v[116:119], v4, s[16:19], s66 offen offset:0 sc1
    v_mfma_f32_16x16x32_bf16 v[244:247], v[196:199], v[132:135], v[244:247]
    ds_read_b64_tr_b16 v[212:213], v165 offset:4096
    s_waitcnt lgkmcnt(5)
    v_mfma_f32_16x16x32_bf16 v[232:235], v[200:203], v[128:131], v[232:235]
    ds_read_b64_tr_b16 v[214:215], v165 offset:6144
    buffer_load_dwordx4 v[120:123], v3, s[16:19], s66 offen offset:1024 sc1
    v_mfma_f32_16x16x32_bf16 v[248:251], v[200:203], v[132:135], v[248:251]
    ds_read_b64_tr_b16 v[216:217], v166 offset:4096
    s_waitcnt lgkmcnt(5)
    v_mfma_f32_16x16x32_bf16 v[236:239], v[204:207], v[128:131], v[236:239]
    ds_read_b64_tr_b16 v[218:219], v166 offset:6144
    buffer_load_dwordx4 v[124:127], v4, s[16:19], s66 offen offset:1024 sc1
    v_mfma_f32_16x16x32_bf16 v[252:255], v[204:207], v[132:135], v[252:255]
    ds_read_b64_tr_b16 v[220:221], v167 offset:4096
    ds_read_b64_tr_b16 v[222:223], v167 offset:6144
    s_waitcnt lgkmcnt(6)
    v_mfma_f32_16x16x32_bf16 v[224:227], v[208:211], v[136:139], v[224:227]
    v_mfma_f32_16x16x32_bf16 v[240:243], v[208:211], v[140:143], v[240:243]
    ds_read_b64_tr_b16 v[192:193], v168 offset:0
    s_waitcnt lgkmcnt(5)
    v_mfma_f32_16x16x32_bf16 v[228:231], v[212:215], v[136:139], v[228:231]
    s_waitcnt vmcnt(4)
    ds_read_b64_tr_b16 v[194:195], v168 offset:2048
    v_max3_u32 v5, v96, v97, v98
    v_mfma_f32_16x16x32_bf16 v[244:247], v[212:215], v[140:143], v[244:247]
    ds_read_b64_tr_b16 v[196:197], v169 offset:0
    v_max3_u32 v5, v5, v99, v100
    s_waitcnt lgkmcnt(5)
    v_mfma_f32_16x16x32_bf16 v[232:235], v[216:219], v[136:139], v[232:235]
    ds_read_b64_tr_b16 v[198:199], v169 offset:2048
    v_max3_u32 v5, v5, v101, v102
    v_mfma_f32_16x16x32_bf16 v[248:251], v[216:219], v[140:143], v[248:251]
    ds_read_b64_tr_b16 v[200:201], v170 offset:0
    v_max3_u32 v5, v5, v103, v104
    v_max3_u32 v5, v5, v105, v106
    s_waitcnt lgkmcnt(5)
    v_mfma_f32_16x16x32_bf16 v[236:239], v[220:223], v[136:139], v[236:239]
    ds_read_b64_tr_b16 v[202:203], v170 offset:2048
    v_max3_u32 v5, v5, v107, v108
    v_max3_u32 v5, v5, v109, v110
    v_mfma_f32_16x16x32_bf16 v[252:255], v[220:223], v[140:143], v[252:255]
    ds_read_b64_tr_b16 v[204:205], v171 offset:0
    ds_read_b64_tr_b16 v[206:207], v171 offset:2048
    v_max_u32 v5, v5, v111
    v_cmp_eq_u32 vcc, -1, v5
    s_cbranch_vccnz Q_rt3
Q_go3:
    s_add_u32 s66, s63, 20480
    s_and_b32 s66, s66, 0x7fff
    s_waitcnt lgkmcnt(6)
    v_mfma_f32_16x16x32_bf16 v[224:227], v[192:195], v[96:99], v[224:227]
    buffer_load_dwordx4 v[128:131], v3, s[16:19], s66 offen offset:0 sc1
    v_mfma_f32_16x16x32_bf16 v[240:243], v[192:195], v[100:103], v[240:243]
    ds_read_b64_tr_b16 v[208:209], v168 offset:4096
    s_waitcnt lgkmcnt(5)
    v_mfma_f32_16x16x32_bf16 v[228:231], v[196:199], v[96:99], v[228:231]
    ds_read_b64_tr_b16 v[210:211], v168 offset:6144
    buffer_load_dwordx4 v[132:135], v4, s[16:19], s66 offen offset:0 sc1
    v_mfma_f32_16x16x32_bf16 v[244:247], v[196:199], v[100:103], v[244:247]
    ds_read_b64_tr_b16 v[212:213], v169 offset:4096
    s_waitcnt lgkmcnt(5)
    v_mfma_f32_16x16x32_bf16 v[232:235], v[200:203], v[96:99], v[232:235]
    ds_read_b64_tr_b16 v[214:215], v169 offset:6144
    buffer_load_dwordx4 v[136:139], v3, s[16:19], s66 offen offset:1024 sc1
    v_mfma_f32_16x16x32_bf16 v[248:251], v[200:203], v[100:103], v[248:251]
    ds_read_b64_tr_b16 v[216:217], v170 offset:4096
    s_waitcnt lgkmcnt(5)
    v_mfma_f32_16x16x32_bf16 v[236:239], v[204:207], v[96:99], v[236:239]
    ds_read_b64_tr_b16 v[218:219], v170 offset:6144
    buffer_load_dwordx4 v[140:143], v4, s[16:19], s66 offen offset:1024 sc1
    v_mfma_f32_16x16x32_bf16 v[252:255], v[204:207], v[100:103], v[252:255]
    ds_read_b64_tr_b16 v[220:221], v171 offset:4096
    ds_read_b64_tr_b16 v[222:223], v171 offset:6144
    s_waitcnt lgkmcnt(6)
    v_mfma_f32_16x16x32_bf16 v[224:227], v[208:211], v[104:107], v[224:227]
    v_mfma_f32_16x16x32_bf16 v[240:243], v[208:211], v[108:111], v[240:243]
    ds_read_b64_tr_b16 v[192:193], v168 offset:8192
    s_waitcnt lgkmcnt(5)
    v_mfma_f32_16x16x32_bf16 v[228:231], v[212:215], v[104:107], v[228:231]
    s_waitcnt vmcnt(4)
    ds_read_b64_tr_b16 v[194:195], v168 offset:10240
    v_max3_u32 v5, v112, v113, v114
    v_mfma_f32_16x16x32_bf16 v[244:247], v[212:215], v[108:111], v[244:247]
    ds_read_b64_tr_b16 v[196:197], v169 offset:8192
    v_max3_u32 v5, v5, v115, v116
    s_waitcnt lgkmcnt(5)
    v_mfma_f32_16x16x32_bf16 v[232:235], v[216:219], v[104:107], v[232:235]
    ds_read_b64_tr_b16 v[198:199], v169 offset:10240
    v_max3_u32 v5, v5, v117, v118
    v_mfma_f32_16x16x32_bf16 v[248:251], v[216:219], v[108:111], v[248:251]
    ds_read_b64_tr_b16 v[200:201], v170 offset:8192
    v_max3_u32 v5, v5, v119, v120
    v_max3_u32 v5, v5, v121, v122
    s_waitcnt lgkmcnt(5)
    v_mfma_f32_16x16x32_bf16 v[236:239], v[220:223], v[104:107], v[236:239]
    ds_read_b64_tr_b16 v[202:203], v170 offset:10240
    v_max3_u32 v5, v5, v123, v124
    v_max3_u32 v5, v5, v125, v126
    v_mfma_f32_16x16x32_bf16 v[252:255], v[220:223], v[108:111], v[252:255]
    ds_read_b64_tr_b16 v[204:205], v171 offset:8192
    ds_read_b64_tr_b16 v[206:207], v171 offset:10240
    v_max_u32 v5, v5, v127
    v_cmp_eq_u32 vcc, -1, v5
    s_cbranch_vccnz Q_rt4
Q_go4:
    s_cmp_eq_u32 s51, 0
    s_cbranch_scc1 Q_ny0
    s_lshl_b32 s64, s7, 14
    s_lshl_b32 s66, s3, 11
    s_add_u32 s64, s64, s66
    s_add_u32 s64, s64, 5832704
    buffer_load_dwordx4 v[32:35], v9, s[16:19], s64 offen offset:0 sc1
    buffer_load_dwordx4 v[36:39], v9, s[16:19], s64 offen offset:1024 sc1
Q_ny0:
    s_add_u32 s66, s63, 24576
    s_and_b32 s66, s66, 0x7fff
    s_waitcnt lgkmcnt(6)
    v_mfma_f32_16x16x32_bf16 v[224:227], v[192:195], v[112:115], v[224:227]
    buffer_load_dwordx4 v[96:99], v3, s[16:19], s66 offen offset:0 sc1
    v_mfma_f32_16x16x32_bf16 v[240:243], v[192:195], v[116:119], v[240:243]
    ds_read_b64_tr_b16 v[208:209], v168 offset:12288
    s_waitcnt lgkmcnt(5)
    v_mfma_f32_16x16x32_bf16 v[228:231], v[196:199], v[112:115], v[228:231]
    ds_read_b64_tr_b16 v[210:211], v168 offset:14336
    buffer_load_dwordx4 v[100:103], v4, s[16:19], s66 offen offset:0 sc1
    v_mfma_f32_16x16x32_bf16 v[244:247], v[196:199], v[116:119], v[244:247]
    ds_read_b64_tr_b16 v[212:213], v169 offset:12288
    s_waitcnt lgkmcnt(5)
    v_mfma_f32_16x16x32_bf16 v[232:235], v[200:203], v[112:115], v[232:235]
    ds_read_b64_tr_b16 v[214:215], v169 offset:14336
    buffer_load_dwordx4 v[104:107], v3, s[16:19], s66 offen offset:1024 sc1
    v_mfma_f32_16x16x32_bf16 v[248:251], v[200:203], v[116:119], v[248:251]
    ds_read_b64_tr_b16 v[216:217], v170 offset:12288
    s_waitcnt lgkmcnt(5)
    v_mfma_f32_16x16x32_bf16 v[236:239], v[204:207], v[112:115], v[236:239]
    ds_read_b64_tr_b16 v[218:219], v170 offset:14336
    buffer_load_dwordx4 v[108:111], v4, s[16:19], s66 offen offset:1024 sc1
    v_mfma_f32_16x16x32_bf16 v[252:255], v[204:207], v[116:119], v[252:255]
    ds_read_b64_tr_b16 v[220:221], v171 offset:12288
    ds_read_b64_tr_b16 v[222:223], v171 offset:14336
    s_waitcnt lgkmcnt(6)
    v_mfma_f32_16x16x32_bf16 v[224:227], v[208:211], v[120:123], v[224:227]
    v_mfma_f32_16x16x32_bf16 v[240:243], v[208:211], v[124:127], v[240:243]
    ds_read_b64_tr_b16 v[192:193], v168 offset:16384
    s_waitcnt lgkmcnt(5)
    v_mfma_f32_16x16x32_bf16 v[228:231], v[212:215], v[120:123], v[228:231]
    s_waitcnt vmcnt(4)
    ds_read_b64_tr_b16 v[194:195], v168 offset:18432
    v_max3_u32 v5, v128, v129, v130
    v_mfma_f32_16x16x32_bf16 v[244:247], v[212:215], v[124:127], v[244:247]
    ds_read_b64_tr_b16 v[196:197], v169 offset:16384
    v_max3_u32 v5, v5, v131, v132
    s_waitcnt lgkmcnt(5)
    v_mfma_f32_16x16x32_bf16 v[232:235], v[216:219], v[120:123], v[232:235]
    ds_read_b64_tr_b16 v[198:199], v169 offset:18432
    v_max3_u32 v5, v5, v133, v134
    v_mfma_f32_16x16x32_bf16 v[248:251], v[216:219], v[124:127], v[248:251]
    ds_read_b64_tr_b16 v[200:201], v170 offset:16384
    v_max3_u32 v5, v5, v135, v136
    v_max3_u32 v5, v5, v137, v138
    s_waitcnt lgkmcnt(5)
    v_mfma_f32_16x16x32_bf16 v[236:239], v[220:223], v[120:123], v[236:239]
    ds_read_b64_tr_b16 v[202:203], v170 offset:18432
    v_max3_u32 v5, v5, v139, v140
    v_max3_u32 v5, v5, v141, v142
    v_mfma_f32_16x16x32_bf16 v[252:255], v[220:223], v[124:127], v[252:255]
    ds_read_b64_tr_b16 v[204:205], v171 offset:16384
    ds_read_b64_tr_b16 v[206:207], v171 offset:18432
    v_max_u32 v5, v5, v143
    v_cmp_eq_u32 vcc, -1, v5
    s_cbranch_vccnz Q_rt5
Q_go5:
    s_cmp_eq_u32 s45, 0
    s_cbranch_scc1 Q_np2
    s_setprio 1
Q_np2:
    s_cmp_eq_u32 s51, 0
    s_cbranch_scc1 Q_ny1
    s_mov_b32 s59, 0
Q_ychk:
    s_waitcnt vmcnt(0)
    v_max3_u32 v5, v32, v33, v34
    v_max3_u32 v5, v5, v35, v36
    v_max3_u32 v5, v5, v37, v38
    v_max_u32 v5, v5, v39
    v_cmp_eq_u32 vcc, -1, v5
    s_cbranch_vccz Q_yok
    s_add_u32 s59, s59, 1
    s_cmp_ge_u32 s59, 200000
    s_cbranch_scc1 Q_yok
    s_sleep 4
    buffer_load_dwordx4 v[32:35], v9, s[16:19], s64 offen offset:0 sc1
    buffer_load_dwordx4 v[36:39], v9, s[16:19], s64 offen offset:1024 sc1
    s_branch Q_ychk
Q_yok:
    v_add_f32 v32, v32, v36
    v_add_f32 v33, v33, v37
    v_add_f32 v34, v34, v38
    v_add_f32 v35, v35, v39
    s_nop 1
    v_permlane16_swap_b32 v32, v34
    v_permlane16_swap_b32 v33, v35
    v_add_f32 v32, v32, v34
    v_add_f32 v33, v33, v35
    v_and_b32 v5, 15, v2
    v_lshlrev_b32 v5, 4, v5
    v_permlane32_swap_b32 v32, v33
    v_bfe_u32 v8, v2, 4, 1
    v_lshl_add_u32 v5, v8, 3, v5
    v_lshrrev_b32 v8, 5, v2
    v_lshl_add_u32 v5, v8, 2, v5
    v_add_f32 v32, v32, v33
    s_lshl_b32 s66, s3, 8
    s_add_u32 s66, s66, 156992
    v_add_u32 v5, s66, v5
    ds_write_b32 v5, v32
    v_mov_b32 v5, 155688
    v_mov_b32 v8, 1
    s_mov_b64 exec, 1
    ds_add_u32 v5, v8
    s_mov_b64 exec, -1
    s_waitcnt lgkmcnt(0)
Q_ny1:
    s_add_u32 s66, s63, 28672
    s_and_b32 s66, s66, 0x7fff
    s_waitcnt lgkmcnt(6)
    v_mfma_f32_16x16x32_bf16 v[224:227], v[192:195], v[128:131], v[224:227]
    buffer_load_dwordx4 v[112:115], v3, s[16:19], s66 offen offset:0 sc1
    v_mfma_f32_16x16x32_bf16 v[240:243], v[192:195], v[132:135], v[240:243]
    ds_read_b64_tr_b16 v[208:209], v168 offset:20480
    s_waitcnt lgkmcnt(5)
    v_mfma_f32_16x16x32_bf16 v[228:231], v[196:199], v[128:131], v[228:231]
    ds_read_b64_tr_b16 v[210:211], v168 offset:22528
    buffer_load_dwordx4 v[116:119], v4, s[16:19], s66 offen offset:0 sc1
    v_mfma_f32_16x16x32_bf16 v[244:247], v[196:199], v[132:135], v[244:247]
    ds_read_b64_tr_b16 v[212:213], v169 offset:20480
    s_waitcnt lgkmcnt(5)
    v_mfma_f32_16x16x32_bf16 v[232:235], v[200:203], v[128:131], v[232:235]
    ds_read_b64_tr_b16 v[214:215], v169 offset:22528
    buffer_load_dwordx4 v[120:123], v3, s[16:19], s66 offen offset:1024 sc1
    v_mfma_f32_16x16x32_bf16 v[248:251], v[200:203], v[132:135], v[248:251]
    ds_read_b64_tr_b16 v[216:217], v170 offset:20480
    s_waitcnt lgkmcnt(5)
    v_mfma_f32_16x16x32_bf16 v[236:239], v[204:207], v[128:131], v[236:239]
    ds_read_b64_tr_b16 v[218:219], v170 offset:22528
    buffer_load_dwordx4 v[124:127], v4, s[16:19], s66 offen offset:1024 sc1
    v_mfma_f32_16x16x32_bf16 v[252:255], v[204:207], v[132:135], v[252:255]
    ds_read_b64_tr_b16 v[220:221], v171 offset:20480
    ds_read_b64_tr_b16 v[222:223], v171 offset:22528
    s_waitcnt lgkmcnt(6)
    v_mfma_f32_16x16x32_bf16 v[224:227], v[208:211], v[136:139], v[224:227]
    v_mfma_f32_16x16x32_bf16 v[240:243], v[208:211], v[140:143], v[240:243]
    ds_read_b64_tr_b16 v[192:193], v172 offset:0
    s_waitcnt lgkmcnt(5)
    v_mfma_f32_16x16x32_bf16 v[228:231], v[212:215], v[136:139], v[228:231]
    s_waitcnt vmcnt(4)
    ds_read_b64_tr_b16 v[194:195], v172 offset:2048
    v_max3_u32 v5, v96, v97, v98
    v_mfma_f32_16x16x32_bf16 v[244:247], v[212:215], v[140:143], v[244:247]
    ds_read_b64_tr_b16 v[196:197], v173 offset:0
    v_max3_u32 v5, v5, v99, v100
    s_waitcnt lgkmcnt(5)
    v_mfma_f32_16x16x32_bf16 v[232:235], v[216:219], v[136:139], v[232:235]
    ds_read_b64_tr_b16 v[198:199], v173 offset:2048
    v_max3_u32 v5, v5, v101, v102
    v_mfma_f32_16x16x32_bf16 v[248:251], v[216:219], v[140:143], v[248:251]
    ds_read_b64_tr_b16 v[200:201], v174 offset:0
    v_max3_u32 v5, v5, v103, v104
    v_max3_u32 v5, v5, v105, v106
    s_waitcnt lgkmcnt(5)
    v_mfma_f32_16x16x32_bf16 v[236:239], v[220:223], v[136:139], v[236:239]
    ds_read_b64_tr_b16 v[202:203], v174 offset:2048
    v_max3_u32 v5, v5, v107, v108
    v_max3_u32 v5, v5, v109, v110
    v_mfma_f32_16x16x32_bf16 v[252:255], v[220:223], v[140:143], v[252:255]
    ds_read_b64_tr_b16 v[204:205], v175 offset:0
    ds_read_b64_tr_b16 v[206:207], v175 offset:2048
    v_max_u32 v5, v5, v111
    v_cmp_eq_u32 vcc, -1, v5
    s_cbranch_vccnz Q_rt6
Q_go6:
    s_waitcnt lgkmcnt(6)
    v_mfma_f32_16x16x32_bf16 v[224:227], v[192:195], v[96:99], v[224:227]
    v_sub_f32 v153, 1.0, v152
    v_cvt_pk_bf16_f32 v153, 0, v153
    v_lshlrev_b32 v16, 16, v144
    v_mfma_f32_16x16x32_bf16 v[240:243], v[192:195], v[100:103], v[240:243]
    ds_read_b64_tr_b16 v[208:209], v172 offset:4096
    v_and_b32 v17, 0xffff0000, v144
    v_mul_f32 v16, v16, v153
    v_mul_f32 v17, v17, v153
    s_waitcnt lgkmcnt(5)
    v_mfma_f32_16x16x32_bf16 v[228:231], v[196:199], v[96:99], v[228:231]
    ds_read_b64_tr_b16 v[210:211], v172 offset:6144
    v_cvt_pk_bf16_f32 v16, 0, v16
    v_cvt_pk_bf16_f32 v17, 0, v17
    v_lshlrev_b32 v18, 16, v145
    v_mfma_f32_16x16x32_bf16 v[244:247], v[196:199], v[100:103], v[244:247]
    ds_read_b64_tr_b16 v[212:213], v173 offset:4096
    v_and_b32 v19, 0xffff0000, v145
    v_mul_f32 v18, v18, v153
    v_mul_f32 v19, v19, v153
    s_waitcnt lgkmcnt(5)
    v_mfma_f32_16x16x32_bf16 v[232:235], v[200:203], v[96:99], v[232:235]
    ds_read_b64_tr_b16 v[214:215], v173 offset:6144
    v_cvt_pk_bf16_f32 v18, 0, v18
    v_cvt_pk_bf16_f32 v19, 0, v19
    v_lshlrev_b32 v20, 16, v146
    v_mfma_f32_16x16x32_bf16 v[248:251], v[200:203], v[100:103], v[248:251]
    ds_read_b64_tr_b16 v[216:217], v174 offset:4096
    v_and_b32 v21, 0xffff0000, v146
    v_mul_f32 v20, v20, v153
    v_mul_f32 v21, v21, v153
    s_waitcnt lgkmcnt(5)
    v_mfma_f32_16x16x32_bf16 v[236:239], v[204:207], v[96:99], v[236:239]
    ds_read_b64_tr_b16 v[218:219], v174 offset:6144
    v_cvt_pk_bf16_f32 v20, 0, v20
    v_cvt_pk_bf16_f32 v21, 0, v21
    v_lshlrev_b32 v22, 16, v147
    v_mfma_f32_16x16x32_bf16 v[252:255], v[204:207], v[100:103], v[252:255]
    ds_read_b64_tr_b16 v[220:221], v175 offset:4096
    ds_read_b64_tr_b16 v[222:223], v175 offset:6144
    v_and_b32 v23, 0xffff0000, v147
    v_mul_f32 v22, v22, v153
    v_mul_f32 v23, v23, v153
    s_waitcnt lgkmcnt(6)
    v_mfma_f32_16x16x32_bf16 v[224:227], v[208:211], v[104:107], v[224:227]
    v_mfma_f32_16x16x32_bf16 v[240:243], v[208:211], v[108:111], v[240:243]
    ds_read_b64_tr_b16 v[192:193], v172 offset:8192
    s_waitcnt lgkmcnt(5)
    v_mfma_f32_16x16x32_bf16 v[228:231], v[212:215], v[104:107], v[228:231]
    s_waitcnt vmcnt(0)
    ds_read_b64_tr_b16 v[194:195], v172 offset:10240
    v_max3_u32 v5, v112, v113, v114
    v_mfma_f32_16x16x32_bf16 v[244:247], v[212:215], v[108:111], v[244:247]
    ds_read_b64_tr_b16 v[196:197], v173 offset:8192
    v_max3_u32 v5, v5, v115, v116
    s_waitcnt lgkmcnt(5)
    v_mfma_f32_16x16x32_bf16 v[232:235], v[216:219], v[104:107], v[232:235]
    ds_read_b64_tr_b16 v[198:199], v173 offset:10240
    v_max3_u32 v5, v5, v117, v118
    v_mfma_f32_16x16x32_bf16 v[248:251], v[216:219], v[108:111], v[248:251]
    ds_read_b64_tr_b16 v[200:201], v174 offset:8192
    v_max3_u32 v5, v5, v119, v120
    v_max3_u32 v5, v5, v121, v122
    s_waitcnt lgkmcnt(5)
    v_mfma_f32_16x16x32_bf16 v[236:239], v[220:223], v[104:107], v[236:239]
    ds_read_b64_tr_b16 v[202:203], v174 offset:10240
    v_max3_u32 v5, v5, v123, v124
    v_max3_u32 v5, v5, v125, v126
    v_mfma_f32_16x16x32_bf16 v[252:255], v[220:223], v[108:111], v[252:255]
    ds_read_b64_tr_b16 v[204:205], v175 offset:8192
    ds_read_b64_tr_b16 v[206:207], v175 offset:10240
    v_max_u32 v5, v5, v127
    v_cmp_eq_u32 vcc, -1, v5
    s_cbranch_vccnz Q_rt7
Q_go7:
    s_waitcnt lgkmcnt(6)
    v_mfma_f32_16x16x32_bf16 v[224:227], v[192:195], v[112:115], v[224:227]
    v_cvt_pk_bf16_f32 v22, 0, v22
    v_cvt_pk_bf16_f32 v23, 0, v23
    v_lshlrev_b32 v24, 16, v148
    v_and_b32 v25, 0xffff0000, v148
    v_mul_f32 v24, v24, v153
    v_mfma_f32_16x16x32_bf16 v[240:243], v[192:195], v[116:119], v[240:243]
    ds_read_b64_tr_b16 v[208:209], v172 offset:12288
    v_mul_f32 v25, v25, v153
    v_cvt_pk_bf16_f32 v24, 0, v24
    v_cvt_pk_bf16_f32 v25, 0, v25
    v_lshlrev_b32 v26, 16, v149
    v_and_b32 v27, 0xffff0000, v149
    s_waitcnt lgkmcnt(5)
    v_mfma_f32_16x16x32_bf16 v[228:231], v[196:199], v[112:115], v[228:231]
    ds_read_b64_tr_b16 v[210:211], v172 offset:14336
    v_mul_f32 v26, v26, v153
    v_mul_f32 v27, v27, v153
    v_cvt_pk_bf16_f32 v26, 0, v26
    v_cvt_pk_bf16_f32 v27, 0, v27
    v_mfma_f32_16x16x32_bf16 v[244:247], v[196:199], v[116:119], v[244:247]
    ds_read_b64_tr_b16 v[212:213], v173 offset:12288
    v_lshlrev_b32 v28, 16, v150
    v_and_b32 v29, 0xffff0000, v150
    v_mul_f32 v28, v28, v153
    v_mul_f32 v29, v29, v153
    s_waitcnt lgkmcnt(5)
    v_mfma_f32_16x16x32_bf16 v[232:235], v[200:203], v[112:115], v[232:235]
    ds_read_b64_tr_b16 v[214:215], v173 offset:14336
    v_cvt_pk_bf16_f32 v28, 0, v28
    v_cvt_pk_bf16_f32 v29, 0, v29
    v_lshlrev_b32 v30, 16, v151
    v_and_b32 v31, 0xffff0000, v151
    v_mfma_f32_16x16x32_bf16 v[248:251], v[200:203], v[116:119], v[248:251]
    ds_read_b64_tr_b16 v[216:217], v174 offset:12288
    v_mul_f32 v30, v30, v153
    v_mul_f32 v31, v31, v153
    v_cvt_pk_bf16_f32 v30, 0, v30
    v_cvt_pk_bf16_f32 v31, 0, v31
    s_waitcnt lgkmcnt(5)
    v_mfma_f32_16x16x32_bf16 v[236:239], v[204:207], v[112:115], v[236:239]
    ds_read_b64_tr_b16 v[218:219], v174 offset:14336
    v_mov_b32 v154, v152
    v_mov_b32 v155, v152
    s_lshl_b32 s66, s3, 12
    s_add_u32 s67, s66, 24576
    v_mfma_f32_16x16x32_bf16 v[252:255], v[204:207], v[116:119], v[252:255]
    ds_read_b64_tr_b16 v[220:221], v175 offset:12288
    ds_read_b64_tr_b16 v[222:223], v175 offset:14336
    v_add_u32 v6, s67, v9
    s_xor_b32 s66, s66, 16384
    s_add_u32 s66, s66, 24576
    v_add_u32 v7, s66, v9
    s_waitcnt lgkmcnt(6)
    v_mfma_f32_16x16x32_bf16 v[224:227], v[208:211], v[120:123], v[224:227]
    s_waitcnt lgkmcnt(4)
    v_mfma_f32_16x16x32_bf16 v[228:231], v[212:215], v[120:123], v[228:231]
    s_waitcnt lgkmcnt(2)
    v_mfma_f32_16x16x32_bf16 v[232:235], v[216:219], v[120:123], v[232:235]
    s_waitcnt lgkmcnt(0)
    v_mfma_f32_16x16x32_bf16 v[236:239], v[220:223], v[120:123], v[236:239]
    v_mfma_f32_16x16x32_bf16 v[240:243], v[208:211], v[124:127], v[240:243]
    s_nop 0
    v_mfma_f32_16x16x32_bf16 v[244:247], v[212:215], v[124:127], v[244:247]
    s_nop 0
    v_mfma_f32_16x16x32_bf16 v[248:251], v[216:219], v[124:127], v[248:251]
    s_nop 0
    v_mfma_f32_16x16x32_bf16 v[252:255], v[220:223], v[124:127], v[252:255]
    s_nop 0
    ds_write_b128 v6, v[224:227] offset:0
    ds_write_b128 v6, v[228:231] offset:1024
    ds_write_b128 v6, v[232:235] offset:2048
    ds_write_b128 v6, v[236:239] offset:3072
    s_cmp_eq_u32 s51, 0
    s_cbranch_scc1 Q_ny2
    s_cmp_lg_u32 s3, 0
    s_cbranch_scc1 Q_ny2
    v_mov_b32 v5, 155688
Q_yw:
    ds_read_b32 v8, v5
    s_waitcnt lgkmcnt(0)
    v_cmp_ne_u32 vcc, 8, v8
    s_cbranch_vccnz Q_yw
    v_lshlrev_b32 v8, 2, v2
    v_add_u32 v8, 156992, v8
    ds_read_b32 v32, v8 offset:0
    ds_read_b32 v33, v8 offset:256
    ds_read_b32 v34, v8 offset:512
    ds_read_b32 v35, v8 offset:768
    ds_read_b32 v36, v8 offset:1024
    ds_read_b32 v37, v8 offset:1280
    ds_read_b32 v38, v8 offset:1536
    ds_read_b32 v39, v8 offset:1792
    s_and_b32 s66, s74, 0xffff0000
    s_xor_b32 s67, s66, 0x80000000
    s_not_b32 s68, s66
    s_and_b32 s68, s68, 0xffff0000
    s_cmp_ge_u32 s66, 0x80000000
    s_cselect_b32 s66, s67, s68
    v_mov_b32 v40, s66
    v_mul_f32 v40, s46, v40
    v_exp_f32 v40, -v40
    s_nop 0
    v_add_f32 v40, 1.0, v40
    v_rcp_f32 v40, v40
    s_nop 0
    v_cvt_pk_bf16_f32 v40, 0, v40
    s_waitcnt lgkmcnt(0)
    v_add_f32 v32, v32, v33
    v_add_f32 v32, v32, v34
    v_add_f32 v32, v32, v35
    v_add_f32 v32, v32, v36
    v_add_f32 v32, v32, v37
    v_add_f32 v32, v32, v38
    v_add_f32 v32, v32, v39
    v_cvt_pk_bf16_f32 v32, 0, v32
    v_mul_f32 v32, v32, v40
    v_cvt_pk_bf16_f32 v32, 0, v32
    ds_write_b32 v8, v32 offset:2048
    s_waitcnt lgkmcnt(0)
Q_ny2:
    s_waitcnt lgkmcnt(0)
    s_barrier
    ds_read_b128 v[224:227], v7 offset:0
    ds_read_b128 v[228:231], v7 offset:1024
    ds_read_b128 v[232:235], v7 offset:2048
    ds_read_b128 v[236:239], v7 offset:3072
    v_cmp_eq_u32 vcc, s75, v92
    s_and_saveexec_b64 s[68:69], vcc
    s_cbranch_execz Q_nr
    v_bfe_u32 v8, v2, 4, 1
    v_lshlrev_b32 v8, 6, v8
    v_lshrrev_b32 v5, 5, v2
    v_lshl_add_u32 v8, v5, 5, v8
    v_add_u32 v8, 159040, v8
    ds_read_b128 v[40:43], v8 offset:0
    ds_read_b128 v[44:47], v8 offset:16
    ds_read_b128 v[48:51], v8 offset:128
    ds_read_b128 v[52:55], v8 offset:144
    s_waitcnt lgkmcnt(0)
    v_lshlrev_b32 v16, 16, v144
    v_and_b32 v17, 0xffff0000, v144
    v_lshlrev_b32 v18, 16, v145
    v_and_b32 v19, 0xffff0000, v145
    v_lshlrev_b32 v20, 16, v146
    v_and_b32 v21, 0xffff0000, v146
    v_lshlrev_b32 v22, 16, v147
    v_and_b32 v23, 0xffff0000, v147
    v_lshlrev_b32 v24, 16, v148
    v_and_b32 v25, 0xffff0000, v148
    v_lshlrev_b32 v26, 16, v149
    v_and_b32 v27, 0xffff0000, v149
    v_lshlrev_b32 v28, 16, v150
    v_and_b32 v29, 0xffff0000, v150
    v_lshlrev_b32 v30, 16, v151
    v_and_b32 v31, 0xffff0000, v151
    v_add_f32 v16, v16, v40
    v_cvt_pk_bf16_f32 v16, 0, v16
    v_mul_f32 v16, v16, v153
    v_cvt_pk_bf16_f32 v16, 0, v16
    v_add_f32 v17, v17, v41
    v_cvt_pk_bf16_f32 v17, 0, v17
    v_mul_f32 v17, v17, v153
    v_cvt_pk_bf16_f32 v17, 0, v17
    v_add_f32 v18, v18, v42
    v_cvt_pk_bf16_f32 v18, 0, v18
    v_mul_f32 v18, v18, v153
    v_cvt_pk_bf16_f32 v18, 0, v18
    v_add_f32 v19, v19, v43
    v_cvt_pk_bf16_f32 v19, 0, v19
    v_mul_f32 v19, v19, v153
    v_cvt_pk_bf16_f32 v19, 0, v19
    v_add_f32 v20, v20, v44
    v_cvt_pk_bf16_f32 v20, 0, v20
    v_mul_f32 v20, v20, v153
    v_cvt_pk_bf16_f32 v20, 0, v20
    v_add_f32 v21, v21, v45
    v_cvt_pk_bf16_f32 v21, 0, v21
    v_mul_f32 v21, v21, v153
    v_cvt_pk_bf16_f32 v21, 0, v21
    v_add_f32 v22, v22, v46
    v_cvt_pk_bf16_f32 v22, 0, v22
    v_mul_f32 v22, v22, v153
    v_cvt_pk_bf16_f32 v22, 0, v22
    v_add_f32 v23, v23, v47
    v_cvt_pk_bf16_f32 v23, 0, v23
    v_mul_f32 v23, v23, v153
    v_cvt_pk_bf16_f32 v23, 0, v23
    v_add_f32 v24, v24, v48
    v_cvt_pk_bf16_f32 v24, 0, v24
    v_mul_f32 v24, v24, v153
    v_cvt_pk_bf16_f32 v24, 0, v24
    v_add_f32 v25, v25, v49
    v_cvt_pk_bf16_f32 v25, 0, v25
    v_mul_f32 v25, v25, v153
    v_cvt_pk_bf16_f32 v25, 0, v25
    v_add_f32 v26, v26, v50
    v_cvt_pk_bf16_f32 v26, 0, v26
    v_mul_f32 v26, v26, v153
    v_cvt_pk_bf16_f32 v26, 0, v26
    v_add_f32 v27, v27, v51
    v_cvt_pk_bf16_f32 v27, 0, v27
    v_mul_f32 v27, v27, v153
    v_cvt_pk_bf16_f32 v27, 0, v27
    v_add_f32 v28, v28, v52
    v_cvt_pk_bf16_f32 v28, 0, v28
    v_mul_f32 v28, v28, v153
    v_cvt_pk_bf16_f32 v28, 0, v28
    v_add_f32 v29, v29, v53
    v_cvt_pk_bf16_f32 v29, 0, v29
    v_mul_f32 v29, v29, v153
    v_cvt_pk_bf16_f32 v29, 0, v29
    v_add_f32 v30, v30, v54
    v_cvt_pk_bf16_f32 v30, 0, v30
    v_mul_f32 v30, v30, v153
    v_cvt_pk_bf16_f32 v30, 0, v30
    v_add_f32 v31, v31, v55
    v_cvt_pk_bf16_f32 v31, 0, v31
    v_mul_f32 v31, v31, v153
    v_cvt_pk_bf16_f32 v31, 0, v31
Q_nr:
    s_mov_b64 exec, s[68:69]
    s_waitcnt lgkmcnt(3)
    v_pk_add_f32 v[224:225], v[224:225], v[240:241]
    v_pk_add_f32 v[226:227], v[226:227], v[242:243]
    v_cvt_pk_bf16_f32 v40, v224, v225
    v_cvt_pk_bf16_f32 v41, v226, v227
    s_waitcnt lgkmcnt(2)
    v_pk_add_f32 v[228:229], v[228:229], v[244:245]
    v_pk_add_f32 v[230:231], v[230:231], v[246:247]
    v_cvt_pk_bf16_f32 v42, v228, v229
    v_cvt_pk_bf16_f32 v43, v230, v231
    s_waitcnt lgkmcnt(1)
    v_pk_add_f32 v[232:233], v[232:233], v[248:249]
    v_pk_add_f32 v[234:235], v[234:235], v[250:251]
    v_cvt_pk_bf16_f32 v44, v232, v233
    v_cvt_pk_bf16_f32 v45, v234, v235
    s_waitcnt lgkmcnt(0)
    v_pk_add_f32 v[236:237], v[236:237], v[252:253]
    v_pk_add_f32 v[238:239], v[238:239], v[254:255]
    v_cvt_pk_bf16_f32 v46, v236, v237
    v_cvt_pk_bf16_f32 v47, v238, v239
    s_nop 0
    v_permlane16_swap_b32 v40, v42
    v_permlane16_swap_b32 v41, v43
    v_permlane16_swap_b32 v44, v46
    v_permlane16_swap_b32 v45, v47
    v_lshlrev_b32 v224, 16, v40
    v_and_b32 v225, 0xffff0000, v40
    v_lshlrev_b32 v226, 16, v41
    v_and_b32 v227, 0xffff0000, v41
    v_lshlrev_b32 v228, 16, v42
    v_and_b32 v229, 0xffff0000, v42
    v_lshlrev_b32 v230, 16, v43
    v_and_b32 v231, 0xffff0000, v43
    v_pk_mul_f32 v[224:225], v[224:225], v[154:155]
    v_pk_mul_f32 v[226:227], v[226:227], v[154:155]
    v_pk_mul_f32 v[228:229], v[228:229], v[154:155]
    v_pk_mul_f32 v[230:231], v[230:231], v[154:155]
    v_cvt_pk_bf16_f32 v224, 0, v224
    v_cvt_pk_bf16_f32 v225, 0, v225
    v_cvt_pk_bf16_f32 v226, 0, v226
    v_cvt_pk_bf16_f32 v227, 0, v227
    v_cvt_pk_bf16_f32 v228, 0, v228
    v_cvt_pk_bf16_f32 v229, 0, v229
    v_cvt_pk_bf16_f32 v230, 0, v230
    v_cvt_pk_bf16_f32 v231, 0, v231
    v_pk_add_f32 v[224:225], v[224:225], v[16:17]
    v_pk_add_f32 v[226:227], v[226:227], v[18:19]
    v_pk_add_f32 v[228:229], v[228:229], v[20:21]
    v_pk_add_f32 v[230:231], v[230:231], v[22:23]
    v_cvt_pk_bf16_f32 v48, v224, v225
    v_cvt_pk_bf16_f32 v49, v226, v227
    v_cvt_pk_bf16_f32 v50, v228, v229
    v_cvt_pk_bf16_f32 v51, v230, v231
    buffer_store_dwordx4 v[48:51], v91, s[36:39], 0 offen offset:0 nt
    v_lshlrev_b32 v232, 16, v44
    v_and_b32 v233, 0xffff0000, v44
    v_lshlrev_b32 v234, 16, v45
    v_and_b32 v235, 0xffff0000, v45
    v_lshlrev_b32 v236, 16, v46
    v_and_b32 v237, 0xffff0000, v46
    v_lshlrev_b32 v238, 16, v47
    v_and_b32 v239, 0xffff0000, v47
    v_pk_mul_f32 v[232:233], v[232:233], v[154:155]
    v_pk_mul_f32 v[234:235], v[234:235], v[154:155]
    v_pk_mul_f32 v[236:237], v[236:237], v[154:155]
    v_pk_mul_f32 v[238:239], v[238:239], v[154:155]
    v_cvt_pk_bf16_f32 v232, 0, v232
    v_cvt_pk_bf16_f32 v233, 0, v233
    v_cvt_pk_bf16_f32 v234, 0, v234
    v_cvt_pk_bf16_f32 v235, 0, v235
    v_cvt_pk_bf16_f32 v236, 0, v236
    v_cvt_pk_bf16_f32 v237, 0, v237
    v_cvt_pk_bf16_f32 v238, 0, v238
    v_cvt_pk_bf16_f32 v239, 0, v239
    v_pk_add_f32 v[232:233], v[232:233], v[24:25]
    v_pk_add_f32 v[234:235], v[234:235], v[26:27]
    v_pk_add_f32 v[236:237], v[236:237], v[28:29]
    v_pk_add_f32 v[238:239], v[238:239], v[30:31]
    v_cvt_pk_bf16_f32 v52, v232, v233
    v_cvt_pk_bf16_f32 v53, v234, v235
    v_cvt_pk_bf16_f32 v54, v236, v237
    v_cvt_pk_bf16_f32 v55, v238, v239
    buffer_store_dwordx4 v[52:55], v91, s[36:39], 0 offen offset:64 nt
END:
    s_endpgm
Q_rt0:
    s_mov_b32 s59, 0
    s_add_u32 s67, s63, 0
    s_and_b32 s67, s67, 0x7fff
Q_rl0:
    s_waitcnt vmcnt(0)
    s_add_u32 s59, s59, 1
    s_cmp_ge_u32 s59, 200000
    s_cbranch_scc1 Q_rd0
    s_sleep 1
    buffer_load_dwordx4 v[96:99], v3, s[16:19], s67 offen offset:0 sc1
    buffer_load_dwordx4 v[100:103], v4, s[16:19], s67 offen offset:0 sc1
    buffer_load_dwordx4 v[104:107], v3, s[16:19], s67 offen offset:1024 sc1
    buffer_load_dwordx4 v[108:111], v4, s[16:19], s67 offen offset:1024 sc1
    s_waitcnt vmcnt(0)
    v_max3_u32 v5, v96, v97, v98
    v_max3_u32 v5, v5, v99, v100
    v_max3_u32 v5, v5, v101, v102
    v_max3_u32 v5, v5, v103, v104
    v_max3_u32 v5, v5, v105, v106
    v_max3_u32 v5, v5, v107, v108
    v_max3_u32 v5, v5, v109, v110
    v_max_u32 v5, v5, v111
    v_cmp_eq_u32 vcc, -1, v5
    s_cbranch_vccnz Q_rl0
Q_rd0:
    s_add_u32 s67, s63, 4096
    s_and_b32 s67, s67, 0x7fff
    buffer_load_dwordx4 v[112:115], v3, s[16:19], s67 offen offset:0 sc1
    buffer_load_dwordx4 v[116:119], v4, s[16:19], s67 offen offset:0 sc1
    buffer_load_dwordx4 v[120:123], v3, s[16:19], s67 offen offset:1024 sc1
    buffer_load_dwordx4 v[124:127], v4, s[16:19], s67 offen offset:1024 sc1
    s_branch Q_go0
Q_rt1:
    s_mov_b32 s59, 0
    s_add_u32 s67, s63, 4096
    s_and_b32 s67, s67, 0x7fff
Q_rl1:
    s_waitcnt vmcnt(0)
    s_add_u32 s59, s59, 1
    s_cmp_ge_u32 s59, 200000
    s_cbranch_scc1 Q_rd1
    s_sleep 1
    buffer_load_dwordx4 v[112:115], v3, s[16:19], s67 offen offset:0 sc1
    buffer_load_dwordx4 v[116:119], v4, s[16:19], s67 offen offset:0 sc1
    buffer_load_dwordx4 v[120:123], v3, s[16:19], s67 offen offset:1024 sc1
    buffer_load_dwordx4 v[124:127], v4, s[16:19], s67 offen offset:1024 sc1
    s_waitcnt vmcnt(0)
    v_max3_u32 v5, v112, v113, v114
    v_max3_u32 v5, v5, v115, v116
    v_max3_u32 v5, v5, v117, v118
    v_max3_u32 v5, v5, v119, v120
    v_max3_u32 v5, v5, v121, v122
    v_max3_u32 v5, v5, v123, v124
    v_max3_u32 v5, v5, v125, v126
    v_max_u32 v5, v5, v127
    v_cmp_eq_u32 vcc, -1, v5
    s_cbranch_vccnz Q_rl1
Q_rd1:
    s_add_u32 s67, s63, 8192
    s_and_b32 s67, s67, 0x7fff
    buffer_load_dwordx4 v[128:131], v3, s[16:19], s67 offen offset:0 sc1
    buffer_load_dwordx4 v[132:135], v4, s[16:19], s67 offen offset:0 sc1
    buffer_load_dwordx4 v[136:139], v3, s[16:19], s67 offen offset:1024 sc1
    buffer_load_dwordx4 v[140:143], v4, s[16:19], s67 offen offset:1024 sc1
    s_branch Q_go1
Q_rt2:
    s_mov_b32 s59, 0
    s_add_u32 s67, s63, 8192
    s_and_b32 s67, s67, 0x7fff
Q_rl2:
    s_waitcnt vmcnt(0)
    s_add_u32 s59, s59, 1
    s_cmp_ge_u32 s59, 200000
    s_cbranch_scc1 Q_rd2
    s_sleep 1
    buffer_load_dwordx4 v[128:131], v3, s[16:19], s67 offen offset:0 sc1
    buffer_load_dwordx4 v[132:135], v4, s[16:19], s67 offen offset:0 sc1
    buffer_load_dwordx4 v[136:139], v3, s[16:19], s67 offen offset:1024 sc1
    buffer_load_dwordx4 v[140:143], v4, s[16:19], s67 offen offset:1024 sc1
    s_waitcnt vmcnt(0)
    v_max3_u32 v5, v128, v129, v130
    v_max3_u32 v5, v5, v131, v132
    v_max3_u32 v5, v5, v133, v134
    v_max3_u32 v5, v5, v135, v136
    v_max3_u32 v5, v5, v137, v138
    v_max3_u32 v5, v5, v139, v140
    v_max3_u32 v5, v5, v141, v142
    v_max_u32 v5, v5, v143
    v_cmp_eq_u32 vcc, -1, v5
    s_cbranch_vccnz Q_rl2
Q_rd2:
    s_add_u32 s67, s63, 12288
    s_and_b32 s67, s67, 0x7fff
    buffer_load_dwordx4 v[96:99], v3, s[16:19], s67 offen offset:0 sc1
    buffer_load_dwordx4 v[100:103], v4, s[16:19], s67 offen offset:0 sc1
    buffer_load_dwordx4 v[104:107], v3, s[16:19], s67 offen offset:1024 sc1
    buffer_load_dwordx4 v[108:111], v4, s[16:19], s67 offen offset:1024 sc1
    s_branch Q_go2
Q_rt3:
    s_mov_b32 s59, 0
    s_add_u32 s67, s63, 12288
    s_and_b32 s67, s67, 0x7fff
Q_rl3:
    s_waitcnt vmcnt(0)
    s_add_u32 s59, s59, 1
    s_cmp_ge_u32 s59, 200000
    s_cbranch_scc1 Q_rd3
    s_sleep 1
    buffer_load_dwordx4 v[96:99], v3, s[16:19], s67 offen offset:0 sc1
    buffer_load_dwordx4 v[100:103], v4, s[16:19], s67 offen offset:0 sc1
    buffer_load_dwordx4 v[104:107], v3, s[16:19], s67 offen offset:1024 sc1
    buffer_load_dwordx4 v[108:111], v4, s[16:19], s67 offen offset:1024 sc1
    s_waitcnt vmcnt(0)
    v_max3_u32 v5, v96, v97, v98
    v_max3_u32 v5, v5, v99, v100
    v_max3_u32 v5, v5, v101, v102
    v_max3_u32 v5, v5, v103, v104
    v_max3_u32 v5, v5, v105, v106
    v_max3_u32 v5, v5, v107, v108
    v_max3_u32 v5, v5, v109, v110
    v_max_u32 v5, v5, v111
    v_cmp_eq_u32 vcc, -1, v5
    s_cbranch_vccnz Q_rl3
Q_rd3:
    s_add_u32 s67, s63, 16384
    s_and_b32 s67, s67, 0x7fff
    buffer_load_dwordx4 v[112:115], v3, s[16:19], s67 offen offset:0 sc1
    buffer_load_dwordx4 v[116:119], v4, s[16:19], s67 offen offset:0 sc1
    buffer_load_dwordx4 v[120:123], v3, s[16:19], s67 offen offset:1024 sc1
    buffer_load_dwordx4 v[124:127], v4, s[16:19], s67 offen offset:1024 sc1
    s_branch Q_go3
Q_rt4:
    s_mov_b32 s59, 0
    s_add_u32 s67, s63, 16384
    s_and_b32 s67, s67, 0x7fff
Q_rl4:
    s_waitcnt vmcnt(0)
    s_add_u32 s59, s59, 1
    s_cmp_ge_u32 s59, 200000
    s_cbranch_scc1 Q_rd4
    s_sleep 1
    buffer_load_dwordx4 v[112:115], v3, s[16:19], s67 offen offset:0 sc1
    buffer_load_dwordx4 v[116:119], v4, s[16:19], s67 offen offset:0 sc1
    buffer_load_dwordx4 v[120:123], v3, s[16:19], s67 offen offset:1024 sc1
    buffer_load_dwordx4 v[124:127], v4, s[16:19], s67 offen offset:1024 sc1
    s_waitcnt vmcnt(0)
    v_max3_u32 v5, v112, v113, v114
    v_max3_u32 v5, v5, v115, v116
    v_max3_u32 v5, v5, v117, v118
    v_max3_u32 v5, v5, v119, v120
    v_max3_u32 v5, v5, v121, v122
    v_max3_u32 v5, v5, v123, v124
    v_max3_u32 v5, v5, v125, v126
    v_max_u32 v5, v5, v127
    v_cmp_eq_u32 vcc, -1, v5
    s_cbranch_vccnz Q_rl4
Q_rd4:
    s_add_u32 s67, s63, 20480
    s_and_b32 s67, s67, 0x7fff
    buffer_load_dwordx4 v[128:131], v3, s[16:19], s67 offen offset:0 sc1
    buffer_load_dwordx4 v[132:135], v4, s[16:19], s67 offen offset:0 sc1
    buffer_load_dwordx4 v[136:139], v3, s[16:19], s67 offen offset:1024 sc1
    buffer_load_dwordx4 v[140:143], v4, s[16:19], s67 offen offset:1024 sc1
    s_branch Q_go4
Q_rt5:
    s_mov_b32 s59, 0
    s_add_u32 s67, s63, 20480
    s_and_b32 s67, s67, 0x7fff
Q_rl5:
    s_waitcnt vmcnt(0)
    s_add_u32 s59, s59, 1
    s_cmp_ge_u32 s59, 200000
    s_cbranch_scc1 Q_rd5
    s_sleep 1
    buffer_load_dwordx4 v[128:131], v3, s[16:19], s67 offen offset:0 sc1
    buffer_load_dwordx4 v[132:135], v4, s[16:19], s67 offen offset:0 sc1
    buffer_load_dwordx4 v[136:139], v3, s[16:19], s67 offen offset:1024 sc1
    buffer_load_dwordx4 v[140:143], v4, s[16:19], s67 offen offset:1024 sc1
    s_waitcnt vmcnt(0)
    v_max3_u32 v5, v128, v129, v130
    v_max3_u32 v5, v5, v131, v132
    v_max3_u32 v5, v5, v133, v134
    v_max3_u32 v5, v5, v135, v136
    v_max3_u32 v5, v5, v137, v138
    v_max3_u32 v5, v5, v139, v140
    v_max3_u32 v5, v5, v141, v142
    v_max_u32 v5, v5, v143
    v_cmp_eq_u32 vcc, -1, v5
    s_cbranch_vccnz Q_rl5
Q_rd5:
    s_add_u32 s67, s63, 24576
    s_and_b32 s67, s67, 0x7fff
    buffer_load_dwordx4 v[96:99], v3, s[16:19], s67 offen offset:0 sc1
    buffer_load_dwordx4 v[100:103], v4, s[16:19], s67 offen offset:0 sc1
    buffer_load_dwordx4 v[104:107], v3, s[16:19], s67 offen offset:1024 sc1
    buffer_load_dwordx4 v[108:111], v4, s[16:19], s67 offen offset:1024 sc1
    s_branch Q_go5
Q_rt6:
    s_mov_b32 s59, 0
    s_add_u32 s67, s63, 24576
    s_and_b32 s67, s67, 0x7fff
Q_rl6:
    s_waitcnt vmcnt(0)
    s_add_u32 s59, s59, 1
    s_cmp_ge_u32 s59, 200000
    s_cbranch_scc1 Q_rd6
    s_sleep 1
    buffer_load_dwordx4 v[96:99], v3, s[16:19], s67 offen offset:0 sc1
    buffer_load_dwordx4 v[100:103], v4, s[16:19], s67 offen offset:0 sc1
    buffer_load_dwordx4 v[104:107], v3, s[16:19], s67 offen offset:1024 sc1
    buffer_load_dwordx4 v[108:111], v4, s[16:19], s67 offen offset:1024 sc1
    s_waitcnt vmcnt(0)
    v_max3_u32 v5, v96, v97, v98
    v_max3_u32 v5, v5, v99, v100
    v_max3_u32 v5, v5, v101, v102
    v_max3_u32 v5, v5, v103, v104
    v_max3_u32 v5, v5, v105, v106
    v_max3_u32 v5, v5, v107, v108
    v_max3_u32 v5, v5, v109, v110
    v_max_u32 v5, v5, v111
    v_cmp_eq_u32 vcc, -1, v5
    s_cbranch_vccnz Q_rl6
Q_rd6:
    s_add_u32 s67, s63, 28672
    s_and_b32 s67, s67, 0x7fff
    buffer_load_dwordx4 v[112:115], v3, s[16:19], s67 offen offset:0 sc1
    buffer_load_dwordx4 v[116:119], v4, s[16:19], s67 offen offset:0 sc1
    buffer_load_dwordx4 v[120:123], v3, s[16:19], s67 offen offset:1024 sc1
    buffer_load_dwordx4 v[124:127], v4, s[16:19], s67 offen offset:1024 sc1
    s_branch Q_go6
Q_rt7:
    s_mov_b32 s59, 0
    s_add_u32 s67, s63, 28672
    s_and_b32 s67, s67, 0x7fff
Q_rl7:
    s_waitcnt vmcnt(0)
    s_add_u32 s59, s59, 1
    s_cmp_ge_u32 s59, 200000
    s_cbranch_scc1 Q_rd7
    s_sleep 1
    buffer_load_dwordx4 v[112:115], v3, s[16:19], s67 offen offset:0 sc1
    buffer_load_dwordx4 v[116:119], v4, s[16:19], s67 offen offset:0 sc1
    buffer_load_dwordx4 v[120:123], v3, s[16:19], s67 offen offset:1024 sc1
    buffer_load_dwordx4 v[124:127], v4, s[16:19], s67 offen offset:1024 sc1
    s_waitcnt vmcnt(0)
    v_max3_u32 v5, v112, v113, v114
    v_max3_u32 v5, v5, v115, v116
    v_max3_u32 v5, v5, v117, v118
    v_max3_u32 v5, v5, v119, v120
    v_max3_u32 v5, v5, v121, v122
    v_max3_u32 v5, v5, v123, v124
    v_max3_u32 v5, v5, v125, v126
    v_max_u32 v5, v5, v127
    v_cmp_eq_u32 vcc, -1, v5
    s_cbranch_vccnz Q_rl7
Q_rd7:
    s_branch Q_go7
H_eps:
    v_lshlrev_b32 v72, 16, v32
    v_and_b32 v73, 0xffff0000, v32
    v_add_f32 v72, s47, v72
    v_add_f32 v73, s47, v73
    v_cvt_pk_bf16_f32 v32, v72, v73
    v_lshlrev_b32 v72, 16, v33
    v_and_b32 v73, 0xffff0000, v33
    v_add_f32 v72, s47, v72
    v_add_f32 v73, s47, v73
    v_cvt_pk_bf16_f32 v33, v72, v73
    v_lshlrev_b32 v72, 16, v34
    v_and_b32 v73, 0xffff0000, v34
    v_add_f32 v72, s47, v72
    v_add_f32 v73, s47, v73
    v_cvt_pk_bf16_f32 v34, v72, v73
    v_lshlrev_b32 v72, 16, v35
    v_and_b32 v73, 0xffff0000, v35
    v_add_f32 v72, s47, v72
    v_add_f32 v73, s47, v73
    v_cvt_pk_bf16_f32 v35, v72, v73
    v_lshlrev_b32 v72, 16, v36
    v_and_b32 v73, 0xffff0000, v36
    v_add_f32 v72, s47, v72
    v_add_f32 v73, s47, v73
    v_cvt_pk_bf16_f32 v36, v72, v73
    v_lshlrev_b32 v72, 16, v37
    v_and_b32 v73, 0xffff0000, v37
    v_add_f32 v72, s47, v72
    v_add_f32 v73, s47, v73
    v_cvt_pk_bf16_f32 v37, v72, v73
    v_lshlrev_b32 v72, 16, v38
    v_and_b32 v73, 0xffff0000, v38
    v_add_f32 v72, s47, v72
    v_add_f32 v73, s47, v73
    v_cvt_pk_bf16_f32 v38, v72, v73
    v_lshlrev_b32 v72, 16, v39
    v_and_b32 v73, 0xffff0000, v39
    v_add_f32 v72, s47, v72
    v_add_f32 v73, s47, v73
    v_cvt_pk_bf16_f32 v39, v72, v73
    v_lshlrev_b32 v72, 16, v40
    v_and_b32 v73, 0xffff0000, v40
    v_add_f32 v72, s47, v72
    v_add_f32 v73, s47, v73
    v_cvt_pk_bf16_f32 v40, v72, v73
    v_lshlrev_b32 v72, 16, v41
    v_and_b32 v73, 0xffff0000, v41
    v_add_f32 v72, s47, v72
    v_add_f32 v73, s47, v73
    v_cvt_pk_bf16_f32 v41, v72, v73
    v_lshlrev_b32 v72, 16, v42
    v_and_b32 v73, 0xffff0000, v42
    v_add_f32 v72, s47, v72
    v_add_f32 v73, s47, v73
    v_cvt_pk_bf16_f32 v42, v72, v73
    v_lshlrev_b32 v72, 16, v43
    v_and_b32 v73, 0xffff0000, v43
    v_add_f32 v72, s47, v72
    v_add_f32 v73, s47, v73
    v_cvt_pk_bf16_f32 v43, v72, v73
    v_lshlrev_b32 v72, 16, v44
    v_and_b32 v73, 0xffff0000, v44
    v_add_f32 v72, s47, v72
    v_add_f32 v73, s47, v73
    v_cvt_pk_bf16_f32 v44, v72, v73
    v_lshlrev_b32 v72, 16, v45
    v_and_b32 v73, 0xffff0000, v45
    v_add_f32 v72, s47, v72
    v_add_f32 v73, s47, v73
    v_cvt_pk_bf16_f32 v45, v72, v73
    v_lshlrev_b32 v72, 16, v46
    v_and_b32 v73, 0xffff0000, v46
    v_add_f32 v72, s47, v72
    v_add_f32 v73, s47, v73
    v_cvt_pk_bf16_f32 v46, v72, v73
    v_lshlrev_b32 v72, 16, v47
    v_and_b32 v73, 0xffff0000, v47
    v_add_f32 v72, s47, v72
    v_add_f32 v73, s47, v73
    v_cvt_pk_bf16_f32 v47, v72, v73
    s_nop 1
    v_mfma_f32_16x16x32_bf16 v[200:203], v[32:35], v[204:207], 0
    s_waitcnt lgkmcnt(7)
    v_mfma_f32_16x16x32_bf16 v[192:195], v[32:35], v[208:211], 0
    s_waitcnt lgkmcnt(6)
    v_mfma_f32_16x16x32_bf16 v[196:199], v[32:35], v[212:215], 0
    v_mfma_f32_16x16x32_bf16 v[200:203], v[36:39], v[204:207], v[200:203]
    s_waitcnt lgkmcnt(5)
    v_mfma_f32_16x16x32_bf16 v[192:195], v[36:39], v[216:219], v[192:195]
    s_waitcnt lgkmcnt(4)
    v_mfma_f32_16x16x32_bf16 v[196:199], v[36:39], v[220:223], v[196:199]
    v_mfma_f32_16x16x32_bf16 v[200:203], v[40:43], v[204:207], v[200:203]
    s_waitcnt lgkmcnt(3)
    v_mfma_f32_16x16x32_bf16 v[192:195], v[40:43], v[224:227], v[192:195]
    s_waitcnt lgkmcnt(2)
    v_mfma_f32_16x16x32_bf16 v[196:199], v[40:43], v[228:231], v[196:199]
    v_mfma_f32_16x16x32_bf16 v[200:203], v[44:47], v[204:207], v[200:203]
    s_waitcnt lgkmcnt(1)
    v_mfma_f32_16x16x32_bf16 v[192:195], v[44:47], v[232:235], v[192:195]
    s_waitcnt lgkmcnt(0)
    v_mfma_f32_16x16x32_bf16 v[196:199], v[44:47], v[236:239], v[196:199]
    s_branch H_ne
CODE_END:
.section .rodata,"a"
.p2align 6
.amdhsa_kernel gated_mix__linear_attn_block__moe_arch_mod__prompt_kernel
  .amdhsa_next_free_vgpr 256
  .amdhsa_next_free_sgpr 102
  .amdhsa_accum_offset 256
  .amdhsa_group_segment_fixed_size 0
  .amdhsa_kernarg_size 96
  .amdhsa_user_sgpr_count 2
  .amdhsa_user_sgpr_kernarg_segment_ptr 1
  .amdhsa_system_sgpr_workgroup_id_x 1
.end_amdhsa_kernel
```

```asm
; @launch grid=(256,1,1) block=(512,1,1) lds=163840
.amdgcn_target "amdgcn-amd-amdhsa--gfx950"
.text
.globl gated_mix__linear_attn_block__moe_arch_mod__prompt_kernel
.p2align 8
.type gated_mix__linear_attn_block__moe_arch_mod__prompt_kernel,@function
gated_mix__linear_attn_block__moe_arch_mod__prompt_kernel:
    s_load_dwordx2 s[12:13], s[0:1], 8
    s_load_dwordx2 s[8:9], s[0:1], 0
    s_getpc_b64 s[64:65]
PC0:
    v_min_u32 v1, 15, v0
    v_lshlrev_b32 v1, 6, v1
    global_load_dword v246, v1, s[64:65]
    s_cmp_ge_u32 s2, 256
    s_cbranch_scc1 END
    v_lshrrev_b32 v1, 6, v0
    v_and_b32 v2, 63, v0
    s_load_dwordx8 s[48:55], s[0:1], 32
    v_readfirstlane_b32 s3, v1
    s_load_dwordx8 s[56:63], s[0:1], 64
    s_load_dwordx2 s[20:21], s[0:1], 16
    s_and_b32 s66, s2, 0xf8
    v_and_b32 v1, 31, v0
    v_lshl_add_u32 v1, s66, 2, v1
    v_lshlrev_b32 v1, 6, v1
    v_min_u32 v1, CODE_END-PC0-4, v1
    global_load_dword v247, v1, s[64:65]
    s_and_b32 s64, s2, 7
    s_lshr_b32 s65, s2, 3
    s_and_b32 s44, s3, 3
    s_lshr_b32 s45, s3, 2
    s_and_b32 s66, s64, 6
    s_lshl_b32 s5, s66, 1
    s_add_u32 s76, s66, s65
    s_lshl_b32 s76, s76, 1
    s_lshr_b32 s66, s65, 3
    s_add_u32 s5, s5, s66
    v_lshrrev_b32 v6, 3, v2
    v_lshl_add_u32 v6, s44, 3, v6
    v_lshrrev_b32 v8, 4, v2
    v_and_b32 v10, 7, v2
    s_and_b32 s67, s44, 1
    v_mul_u32_u24 v7, 6144, v6
    v_and_b32 v9, 1, v8
    v_lshl_add_u32 v9, v9, 1, s67
    v_lshlrev_b32 v9, 1, v9
    v_xor_b32 v9, v9, v10
    v_lshl_add_u32 v7, v9, 4, v7
    v_lshl_add_u32 v5, s5, 7, v7
    s_mov_b32 s14, 0x600000
    s_mov_b32 s15, 0x00020000
    s_lshl_b32 s72, s44, 10
    s_lshl_b32 s66, s45, 12
    s_add_u32 s69, s72, s66
    s_add_u32 s68, s69, s66
    s_sub_u32 s77, s5, s76
    s_and_b32 s77, s77, 15
    s_cmp_le_u32 s77, 0
    s_addc_u32 s70, s76, 0
    s_and_b32 s70, s70, 15
    s_lshl_b32 s71, s70, 1
    s_add_u32 s71, s71, s45
    s_mul_i32 s71, s71, 196608
    s_waitcnt lgkmcnt(0)
    s_add_u32 m0, s69, 24576
    s_add_u32 s66, s71, 2048
    buffer_load_dwordx4 v5, s[12:15], s66 offen lds
    s_add_u32 m0, s69, 32768
    s_add_u32 s66, s71, 4096
    buffer_load_dwordx4 v5, s[12:15], s66 offen lds
    s_add_u32 m0, s69, 16384
    s_add_u32 s66, s71, 0
    buffer_load_dwordx4 v5, s[12:15], s66 offen lds
    s_and_b32 s4, s64, 1
    s_lshl_b32 s4, s4, 3
    s_and_b32 s66, s65, 7
    s_add_u32 s4, s4, s66
    v_lshl_add_u32 v7, s4, 7, v6
    v_lshlrev_b32 v7, 11, v7
    v_lshl_add_u32 v9, s67, 2, v8
    v_xor_b32 v9, v9, v10
    v_lshl_add_u32 v4, v9, 4, v7
    s_mov_b32 s10, 0x400000
    s_mov_b32 s11, 0x00020000
    s_lshl_b32 s70, s70, 7
    s_lshl_b32 s66, s45, 17
    s_add_u32 s70, s70, s66
    s_add_u32 m0, s68, 0
    s_add_u32 s66, s70, 0
    buffer_load_dwordx4 v4, s[8:11], s66 offen lds
    s_add_u32 m0, s68, 4096
    s_add_u32 s66, s70, 65536
    buffer_load_dwordx4 v4, s[8:11], s66 offen lds
    s_barrier
    s_cmp_le_u32 s77, 1
    s_addc_u32 s70, s76, 1
    s_and_b32 s70, s70, 15
    s_lshl_b32 s71, s70, 1
    s_add_u32 s71, s71, s45
    s_mul_i32 s71, s71, 196608
    s_add_u32 m0, s69, 65536
    s_add_u32 s66, s71, 2048
    buffer_load_dwordx4 v5, s[12:15], s66 offen lds
    s_add_u32 m0, s69, 73728
    s_add_u32 s66, s71, 4096
    buffer_load_dwordx4 v5, s[12:15], s66 offen lds
    s_add_u32 m0, s69, 57344
    s_add_u32 s66, s71, 0
    buffer_load_dwordx4 v5, s[12:15], s66 offen lds
    s_lshl_b32 s70, s70, 7
    s_lshl_b32 s66, s45, 17
    s_add_u32 s70, s70, s66
    s_add_u32 m0, s68, 40960
    s_add_u32 s66, s70, 0
    buffer_load_dwordx4 v4, s[8:11], s66 offen lds
    s_add_u32 m0, s68, 45056
    s_add_u32 s66, s70, 65536
    buffer_load_dwordx4 v4, s[8:11], s66 offen lds
    s_mov_b32 s16, s62
    s_mov_b32 s17, s63
    s_mov_b32 s32, s54
    s_mov_b32 s33, s55
    s_mov_b32 s36, s58
    s_mov_b32 s37, s59
    s_mov_b32 s40, s60
    s_mov_b32 s41, s61
    s_mov_b32 s18, 0x10000000
    s_mov_b32 s19, 0x00020000
    s_mov_b32 s34, 0x700000
    s_mov_b32 s35, 0x00020000
    s_mov_b32 s38, 0x400000
    s_mov_b32 s39, 0x00020000
    s_mov_b32 s42, 0x100
    s_mov_b32 s43, 0x00020000
    s_mov_b32 s22, 0x200000
    s_mov_b32 s23, 0x00020000
    s_bitcmp0_b32 s44, 0
    s_cselect_b32 s24, s48, s56
    s_cselect_b32 s25, s49, s57
    s_mov_b32 s26, 0x800
    s_mov_b32 s27, 0x00020000
    s_bitcmp0_b32 s44, 0
    s_cselect_b32 s28, s50, s52
    s_cselect_b32 s29, s51, s53
    s_mov_b32 s30, 0x700000
    s_mov_b32 s31, 0x00020000
    s_lshr_b32 s66, s64, 2
    s_lshl_b32 s66, s66, 1
    s_and_b32 s67, s64, 1
    s_add_u32 s66, s66, s67
    s_lshl_b32 s67, s65, 2
    s_add_u32 s66, s66, s67
    s_add_u32 s66, s66, 96
    s_bitcmp0_b32 s64, 1
    s_cselect_b32 s67, 32, 0
    s_add_u32 s66, s66, s67
    s_cmp_lt_u32 s65, 24
    s_cselect_b32 s67, s2, s66
    s_cmp_ge_u32 s67, 224
    s_cselect_b32 s30, 0, s30
    s_cselect_b32 s34, 0, s34
    s_lshr_b32 s79, s67, 2
    s_and_b32 s73, s67, 3
    s_and_b32 s6, s64, 3
    s_lshl_b32 s6, s6, 2
    s_and_b32 s66, s65, 3
    s_add_u32 s6, s6, s66
    s_lshr_b32 s7, s64, 2
    s_lshl_b32 s7, s7, 3
    s_lshr_b32 s66, s65, 2
    s_add_u32 s7, s7, s66
    s_mov_b32 s6, s4
    s_mov_b32 s7, s5
    s_mov_b32 s46, 0x3fb8aa3b
    s_mov_b32 s47, 0x358637bd
    s_cmp_ge_u32 s3, 4
    s_cbranch_scc1 HELP
    s_and_b32 s48, s3, 1
    s_lshr_b32 s49, s3, 1
    v_and_b32 v3, 15, v2
    s_lshl_b32 s66, s48, 6
    v_add_u32 v3, s66, v3
    v_lshlrev_b32 v3, 7, v3
    v_bfe_u32 v9, v2, 1, 3
    v_lshrrev_b32 v15, 4, v2
    v_xor_b32 v9, v9, v15
    v_xor_b32 v12, 0, v9
    v_lshl_add_u32 v4, v12, 4, v3
    v_xor_b32 v12, 4, v9
    v_lshl_add_u32 v5, v12, 4, v3
    v_bfe_u32 v12, v2, 2, 2
    v_lshl_add_u32 v13, v15, 3, v12
    v_lshlrev_b32 v13, 7, v13
    v_lshrrev_b32 v12, 1, v12
    v_xor_b32 v12, s49, v12
    v_lshl_add_u32 v13, v12, 6, v13
    v_and_b32 v12, 3, v2
    v_lshl_add_u32 v13, v12, 3, v13
    v_add_u32 v13, 16384, v13
    v_and_b32 v12, 1, v15
    v_xor_b32 v14, 0, v12
    v_lshl_add_u32 v6, v14, 5, v13
    v_xor_b32 v14, 1, v12
    v_lshl_add_u32 v7, v14, 5, v13
    v_mov_b32 v8, v4
    v_mov_b32 v9, v5
    v_mov_b32 v10, v6
    v_mov_b32 v11, v7
    v_mov_b32 v96, 0
    v_mov_b32 v97, 0
    v_mov_b32 v98, 0
    v_mov_b32 v99, 0
    v_mov_b32 v100, 0
    v_mov_b32 v101, 0
    v_mov_b32 v102, 0
    v_mov_b32 v103, 0
    v_mov_b32 v104, 0
    v_mov_b32 v105, 0
    v_mov_b32 v106, 0
    v_mov_b32 v107, 0
    v_mov_b32 v108, 0
    v_mov_b32 v109, 0
    v_mov_b32 v110, 0
    v_mov_b32 v111, 0
    v_mov_b32 v112, 0
    v_mov_b32 v113, 0
    v_mov_b32 v114, 0
    v_mov_b32 v115, 0
    v_mov_b32 v116, 0
    v_mov_b32 v117, 0
    v_mov_b32 v118, 0
    v_mov_b32 v119, 0
    v_mov_b32 v120, 0
    v_mov_b32 v121, 0
    v_mov_b32 v122, 0
    v_mov_b32 v123, 0
    v_mov_b32 v124, 0
    v_mov_b32 v125, 0
    v_mov_b32 v126, 0
    v_mov_b32 v127, 0
    v_mov_b32 v128, 0
    v_mov_b32 v129, 0
    v_mov_b32 v130, 0
    v_mov_b32 v131, 0
    v_mov_b32 v132, 0
    v_mov_b32 v133, 0
    v_mov_b32 v134, 0
    v_mov_b32 v135, 0
    v_mov_b32 v136, 0
    v_mov_b32 v137, 0
    v_mov_b32 v138, 0
    v_mov_b32 v139, 0
    v_mov_b32 v140, 0
    v_mov_b32 v141, 0
    v_mov_b32 v142, 0
    v_mov_b32 v143, 0
    v_mov_b32 v144, 0
    v_mov_b32 v145, 0
    v_mov_b32 v146, 0
    v_mov_b32 v147, 0
    v_mov_b32 v148, 0
    v_mov_b32 v149, 0
    v_mov_b32 v150, 0
    v_mov_b32 v151, 0
    v_mov_b32 v152, 0
    v_mov_b32 v153, 0
    v_mov_b32 v154, 0
    v_mov_b32 v155, 0
    v_mov_b32 v156, 0
    v_mov_b32 v157, 0
    v_mov_b32 v158, 0
    v_mov_b32 v159, 0
    v_mov_b32 v160, 0
    v_mov_b32 v161, 0
    v_mov_b32 v162, 0
    v_mov_b32 v163, 0
    v_mov_b32 v164, 0
    v_mov_b32 v165, 0
    v_mov_b32 v166, 0
    v_mov_b32 v167, 0
    v_mov_b32 v168, 0
    v_mov_b32 v169, 0
    v_mov_b32 v170, 0
    v_mov_b32 v171, 0
    v_mov_b32 v172, 0
    v_mov_b32 v173, 0
    v_mov_b32 v174, 0
    v_mov_b32 v175, 0
    v_mov_b32 v176, 0
    v_mov_b32 v177, 0
    v_mov_b32 v178, 0
    v_mov_b32 v179, 0
    v_mov_b32 v180, 0
    v_mov_b32 v181, 0
    v_mov_b32 v182, 0
    v_mov_b32 v183, 0
    v_mov_b32 v184, 0
    v_mov_b32 v185, 0
    v_mov_b32 v186, 0
    v_mov_b32 v187, 0
    v_mov_b32 v188, 0
    v_mov_b32 v189, 0
    v_mov_b32 v190, 0
    v_mov_b32 v191, 0
    v_lshlrev_b32 v12, 2, v2
    v_and_b32 v12, 63, v12
    v_add_u32 v12, 155648, v12
    ds_write_b32 v12, v96
    s_mov_b32 s70, 0x3fb8aa3b
    s_mov_b32 s71, 0x3fb8aa3b
    v_lshrrev_b32 v12, 3, v2
    s_lshl_b32 s67, s44, 3
    v_add_u32 v12, s67, v12
    v_lshlrev_b32 v12, 11, v12
    v_lshrrev_b32 v13, 4, v2
    v_lshlrev_b32 v13, 1, v13
    v_and_b32 v250, 7, v2
    v_xor_b32 v13, v13, v250
    v_lshl_add_u32 v12, v13, 4, v12
    s_lshl_b32 s66, s7, 7
    v_add_u32 v250, s66, v12
    s_lshl_b32 s66, s6, 7
    s_lshl_b32 s67, s44, 5
    s_add_u32 s66, s66, s67
    s_lshl_b32 s67, s45, 4
    s_add_u32 s66, s66, s67
    v_and_b32 v252, 15, v2
    v_add_u32 v252, s66, v252
    v_lshlrev_b32 v251, 11, v252
    v_bfe_u32 v12, v2, 4, 1
    v_lshl_add_u32 v251, v12, 5, v251
    v_lshrrev_b32 v12, 5, v2
    v_lshl_add_u32 v251, v12, 4, v251
    s_lshl_b32 s66, s7, 7
    v_add_u32 v251, s66, v251
    v_lshrrev_b32 v253, 2, v252
    v_lshlrev_b32 v253, 6, v253
    v_and_b32 v12, 3, v2
    v_lshl_add_u32 v253, v12, 2, v253
    s_lshl_b32 s66, s6, 1
    s_and_b32 s66, s66, 6
    s_lshl_b32 s67, s7, 3
    s_add_u32 s66, s66, s67
    s_and_b32 s66, s66, 7
    s_lshl_b32 s52, s66, 18
    s_lshr_b32 s49, s44, 1
    s_and_b32 s66, s44, 1
    s_lshl_b32 s66, s66, 2
    s_lshl_b32 s67, s45, 1
    s_add_u32 s66, s66, s67
    s_lshl_b32 s67, s4, 3
    s_add_u32 s66, s66, s67
    s_lshl_b32 s66, s66, 15
    s_lshl_b32 s67, s5, 11
    s_add_u32 s66, s66, s67
    s_lshl_b32 s67, s49, 10
    s_add_u32 s60, s66, s67
    s_add_u32 s61, s60, 32768
    s_lshl_b32 s58, s5, 2
    s_add_u32 s58, s58, s44
    s_lshl_b32 s66, s58, 14
    s_add_u32 s66, s66, 4194304
    v_lshlrev_b32 v12, 4, v2
    v_add_u32 v248, s66, v12
    s_lshl_b32 s66, s58, 10
    s_add_u32 s66, s66, 5242880
    v_and_b32 v12, 15, v2
    v_lshlrev_b32 v12, 6, v12
    v_lshrrev_b32 v13, 4, v2
    v_lshl_add_u32 v12, v13, 4, v12
    v_add_u32 v249, s66, v12
    s_lshr_b32 s57, s4, 3
    s_xor_b32 s57, s57, s4
    s_and_b32 s57, s57, 1
    s_lshl_b32 s57, s57, 13
    v_bfe_u32 v12, v2, 2, 2
    v_cmp_eq_u32 vcc, v12, v13
    v_mov_b32 v13, 0x3f80
    v_and_b32 v12, 1, v2
    v_lshlrev_b32 v12, 4, v12
    v_lshlrev_b32 v12, v12, v13
    v_cndmask_b32 v12, 0, v12, vcc
    v_and_b32 v13, 2, v2
    v_cmp_eq_u32 vcc, 0, v13
    s_nop 1
    v_cndmask_b32 v254, 0, v12, vcc
    v_cndmask_b32 v255, v12, 0, vcc
    s_mov_b32 s50, 0
    s_mov_b32 s51, 0
    s_waitcnt vmcnt(5) lgkmcnt(0)
    s_barrier
    ds_read_b64_tr_b16 v[32:33], v10 offset:0
    ds_read_b64_tr_b16 v[34:35], v10 offset:512
    ds_read_b128 v[16:19], v8 offset:0
    ds_read_b128 v[20:23], v8 offset:2048
    ds_read_b128 v[24:27], v8 offset:4096
    ds_read_b128 v[28:31], v8 offset:6144
    ds_read_b64_tr_b16 v[36:37], v11 offset:0
    ds_read_b64_tr_b16 v[38:39], v11 offset:512
    ds_read_b64_tr_b16 v[40:41], v10 offset:8192
    ds_read_b64_tr_b16 v[42:43], v10 offset:8704
    ds_read_b64_tr_b16 v[44:45], v11 offset:8192
    ds_read_b64_tr_b16 v[46:47], v11 offset:8704
    ds_read_b64_tr_b16 v[48:49], v10 offset:16384
    ds_read_b64_tr_b16 v[50:51], v10 offset:16896
    ds_read_b64_tr_b16 v[52:53], v11 offset:16384
    ds_read_b64_tr_b16 v[54:55], v11 offset:16896
.p2align 6
LOOP:
    s_waitcnt lgkmcnt(13)
    v_mfma_f32_16x16x32_bf16 v[96:99], v[32:35], v[16:19], v[96:99]
    ds_read_b64_tr_b16 v[72:73], v10 offset:4096
    s_waitcnt lgkmcnt(13)
    v_mfma_f32_16x16x32_bf16 v[104:107], v[32:35], v[20:23], v[104:107]
    ds_read_b64_tr_b16 v[74:75], v10 offset:4608
    s_waitcnt lgkmcnt(13)
    v_mfma_f32_16x16x32_bf16 v[112:115], v[32:35], v[24:27], v[112:115]
    ds_read_b128 v[56:59], v9 offset:0
    s_waitcnt lgkmcnt(13)
    v_mfma_f32_16x16x32_bf16 v[120:123], v[32:35], v[28:31], v[120:123]
    ds_read_b128 v[60:63], v9 offset:2048
    s_waitcnt lgkmcnt(12)
    v_mfma_f32_16x16x32_bf16 v[124:127], v[36:39], v[28:31], v[124:127]
    ds_read_b128 v[64:67], v9 offset:4096
    v_mfma_f32_16x16x32_bf16 v[116:119], v[36:39], v[24:27], v[116:119]
    ds_read_b128 v[68:71], v9 offset:6144
    v_mfma_f32_16x16x32_bf16 v[108:111], v[36:39], v[20:23], v[108:111]
    ds_read_b64_tr_b16 v[76:77], v11 offset:4096
    v_mfma_f32_16x16x32_bf16 v[100:103], v[36:39], v[16:19], v[100:103]
    ds_read_b64_tr_b16 v[78:79], v11 offset:4608
    s_waitcnt lgkmcnt(14)
    v_mfma_f32_16x16x32_bf16 v[128:131], v[16:19], v[40:43], v[128:131]
    ds_read_b64_tr_b16 v[80:81], v10 offset:12288
    v_mfma_f32_16x16x32_bf16 v[136:139], v[20:23], v[40:43], v[136:139]
    ds_read_b64_tr_b16 v[82:83], v10 offset:12800
    v_mfma_f32_16x16x32_bf16 v[144:147], v[24:27], v[40:43], v[144:147]
    ds_read_b64_tr_b16 v[84:85], v11 offset:12288
    v_mfma_f32_16x16x32_bf16 v[152:155], v[28:31], v[40:43], v[152:155]
    ds_read_b64_tr_b16 v[86:87], v11 offset:12800
    s_waitcnt lgkmcnt(15)
    v_mfma_f32_16x16x32_bf16 v[156:159], v[28:31], v[44:47], v[156:159]
    ds_read_b64_tr_b16 v[88:89], v10 offset:20480
    v_mfma_f32_16x16x32_bf16 v[148:151], v[24:27], v[44:47], v[148:151]
    ds_read_b64_tr_b16 v[90:91], v10 offset:20992
    v_mfma_f32_16x16x32_bf16 v[140:143], v[20:23], v[44:47], v[140:143]
    ds_read_b64_tr_b16 v[92:93], v11 offset:20480
    v_mfma_f32_16x16x32_bf16 v[132:135], v[16:19], v[44:47], v[132:135]
    ds_read_b64_tr_b16 v[94:95], v11 offset:20992
    s_waitcnt lgkmcnt(15)
    v_mfma_f32_16x16x32_bf16 v[160:163], v[16:19], v[48:51], v[160:163]
    v_mfma_f32_16x16x32_bf16 v[168:171], v[20:23], v[48:51], v[168:171]
    v_mfma_f32_16x16x32_bf16 v[176:179], v[24:27], v[48:51], v[176:179]
    v_mfma_f32_16x16x32_bf16 v[184:187], v[28:31], v[48:51], v[184:187]
    s_waitcnt lgkmcnt(15)
    v_mfma_f32_16x16x32_bf16 v[188:191], v[28:31], v[52:55], v[188:191]
    v_mfma_f32_16x16x32_bf16 v[180:183], v[24:27], v[52:55], v[180:183]
    v_mfma_f32_16x16x32_bf16 v[172:175], v[20:23], v[52:55], v[172:175]
    v_mfma_f32_16x16x32_bf16 v[164:167], v[16:19], v[52:55], v[164:167]
    s_waitcnt lgkmcnt(13)
    v_mfma_f32_16x16x32_bf16 v[96:99], v[72:75], v[56:59], v[96:99]
    s_add_u32 s50, s50, 40960
    s_cmp_eq_u32 s50, 122880
    s_cselect_b32 s50, 0, s50
    s_waitcnt lgkmcnt(12)
    v_mfma_f32_16x16x32_bf16 v[104:107], v[72:75], v[60:63], v[104:107]
    v_add_u32 v8, s50, v4
    s_waitcnt lgkmcnt(11)
    v_mfma_f32_16x16x32_bf16 v[112:115], v[72:75], v[64:67], v[112:115]
    v_add_u32 v9, s50, v5
    s_waitcnt lgkmcnt(10)
    v_mfma_f32_16x16x32_bf16 v[120:123], v[72:75], v[68:71], v[120:123]
    v_add_u32 v10, s50, v6
    s_waitcnt lgkmcnt(8)
    v_mfma_f32_16x16x32_bf16 v[124:127], v[76:79], v[68:71], v[124:127]
    v_add_u32 v11, s50, v7
    v_mfma_f32_16x16x32_bf16 v[116:119], v[76:79], v[64:67], v[116:119]
    s_waitcnt vmcnt(0) lgkmcnt(0)
    s_barrier
    v_mfma_f32_16x16x32_bf16 v[108:111], v[76:79], v[60:63], v[108:111]
    ds_read_b64_tr_b16 v[32:33], v10 offset:0
    v_mfma_f32_16x16x32_bf16 v[100:103], v[76:79], v[56:59], v[100:103]
    ds_read_b64_tr_b16 v[34:35], v10 offset:512
    v_mfma_f32_16x16x32_bf16 v[128:131], v[56:59], v[80:83], v[128:131]
    ds_read_b128 v[16:19], v8 offset:0
    v_mfma_f32_16x16x32_bf16 v[136:139], v[60:63], v[80:83], v[136:139]
    ds_read_b128 v[20:23], v8 offset:2048
    v_mfma_f32_16x16x32_bf16 v[144:147], v[64:67], v[80:83], v[144:147]
    ds_read_b128 v[24:27], v8 offset:4096
    v_mfma_f32_16x16x32_bf16 v[152:155], v[68:71], v[80:83], v[152:155]
    ds_read_b128 v[28:31], v8 offset:6144
    v_mfma_f32_16x16x32_bf16 v[156:159], v[68:71], v[84:87], v[156:159]
    ds_read_b64_tr_b16 v[36:37], v11 offset:0
    v_mfma_f32_16x16x32_bf16 v[148:151], v[64:67], v[84:87], v[148:151]
    ds_read_b64_tr_b16 v[38:39], v11 offset:512
    v_mfma_f32_16x16x32_bf16 v[140:143], v[60:63], v[84:87], v[140:143]
    ds_read_b64_tr_b16 v[40:41], v10 offset:8192
    v_mfma_f32_16x16x32_bf16 v[132:135], v[56:59], v[84:87], v[132:135]
    ds_read_b64_tr_b16 v[42:43], v10 offset:8704
    v_mfma_f32_16x16x32_bf16 v[160:163], v[56:59], v[88:91], v[160:163]
    ds_read_b64_tr_b16 v[44:45], v11 offset:8192
    v_mfma_f32_16x16x32_bf16 v[168:171], v[60:63], v[88:91], v[168:171]
    ds_read_b64_tr_b16 v[46:47], v11 offset:8704
    v_mfma_f32_16x16x32_bf16 v[176:179], v[64:67], v[88:91], v[176:179]
    ds_read_b64_tr_b16 v[48:49], v10 offset:16384
    v_mfma_f32_16x16x32_bf16 v[184:187], v[68:71], v[88:91], v[184:187]
    ds_read_b64_tr_b16 v[50:51], v10 offset:16896
    v_mfma_f32_16x16x32_bf16 v[188:191], v[68:71], v[92:95], v[188:191]
    ds_read_b64_tr_b16 v[52:53], v11 offset:16384
    v_mfma_f32_16x16x32_bf16 v[180:183], v[64:67], v[92:95], v[180:183]
    ds_read_b64_tr_b16 v[54:55], v11 offset:16896
    v_mfma_f32_16x16x32_bf16 v[172:175], v[60:63], v[92:95], v[172:175]
    v_mfma_f32_16x16x32_bf16 v[164:167], v[56:59], v[92:95], v[164:167]
    s_add_u32 s51, s51, 1
    s_cmp_lt_u32 s51, 13
    s_cbranch_scc1 LOOP
    s_waitcnt lgkmcnt(13)
    v_mfma_f32_16x16x32_bf16 v[96:99], v[32:35], v[16:19], v[96:99]
    ds_read_b64_tr_b16 v[72:73], v10 offset:12288
    v_add_u32 v12, 122880, v4
    s_waitcnt lgkmcnt(13)
    v_mfma_f32_16x16x32_bf16 v[104:107], v[32:35], v[20:23], v[104:107]
    ds_read_b64_tr_b16 v[74:75], v10 offset:12800
    v_add_u32 v13, 122880, v5
    s_waitcnt lgkmcnt(13)
    v_mfma_f32_16x16x32_bf16 v[112:115], v[32:35], v[24:27], v[112:115]
    ds_read_b128 v[56:59], v9 offset:0
    v_add_u32 v14, 114688, v6
    s_waitcnt lgkmcnt(13)
    v_mfma_f32_16x16x32_bf16 v[120:123], v[32:35], v[28:31], v[120:123]
    ds_read_b128 v[60:63], v9 offset:2048
    v_add_u32 v15, 114688, v7
    s_waitcnt lgkmcnt(12)
    v_mfma_f32_16x16x32_bf16 v[124:127], v[36:39], v[28:31], v[124:127]
    ds_read_b128 v[64:67], v9 offset:4096
    s_lshl_b32 s66, s3, 12
    v_mfma_f32_16x16x32_bf16 v[116:119], v[36:39], v[24:27], v[116:119]
    ds_read_b128 v[68:71], v9 offset:6144
    v_lshlrev_b32 v3, 4, v2
    v_mfma_f32_16x16x32_bf16 v[108:111], v[36:39], v[20:23], v[108:111]
    ds_read_b64_tr_b16 v[76:77], v11 offset:12288
    v_add_u32 v3, s66, v3
    v_mfma_f32_16x16x32_bf16 v[100:103], v[36:39], v[16:19], v[100:103]
    ds_read_b64_tr_b16 v[78:79], v11 offset:12800
    s_lshl_b32 s66, s3, 2
    s_waitcnt lgkmcnt(14)
    v_mfma_f32_16x16x32_bf16 v[128:131], v[16:19], v[40:43], v[128:131]
    ds_read_b64_tr_b16 v[80:81], v10 offset:20480
    s_add_u32 s66, s66, 155648
    v_mfma_f32_16x16x32_bf16 v[136:139], v[20:23], v[40:43], v[136:139]
    ds_read_b64_tr_b16 v[82:83], v10 offset:20992
    v_mov_b32 v1, s66
    v_mfma_f32_16x16x32_bf16 v[144:147], v[24:27], v[40:43], v[144:147]
    ds_read_b64_tr_b16 v[84:85], v11 offset:20480
    v_mov_b32 v0, 1
    v_mfma_f32_16x16x32_bf16 v[152:155], v[28:31], v[40:43], v[152:155]
    ds_read_b64_tr_b16 v[86:87], v11 offset:20992
    v_mov_b32 v88, v248
    s_waitcnt lgkmcnt(15)
    v_mfma_f32_16x16x32_bf16 v[156:159], v[28:31], v[44:47], v[156:159]
    v_mov_b32 v89, v249
    v_mfma_f32_16x16x32_bf16 v[148:151], v[24:27], v[44:47], v[148:151]
    v_mov_b32 v90, v250
    v_mfma_f32_16x16x32_bf16 v[140:143], v[20:23], v[44:47], v[140:143]
    v_mov_b32 v91, v251
    v_mfma_f32_16x16x32_bf16 v[132:135], v[16:19], v[44:47], v[132:135]
    v_mov_b32 v92, v252
    s_waitcnt lgkmcnt(14)
    v_mfma_f32_16x16x32_bf16 v[160:163], v[16:19], v[48:51], v[160:163]
    v_mov_b32 v93, v253
    v_mfma_f32_16x16x32_bf16 v[168:171], v[20:23], v[48:51], v[168:171]
    v_mov_b32 v94, v254
    v_mfma_f32_16x16x32_bf16 v[176:179], v[24:27], v[48:51], v[176:179]
    v_mov_b32 v95, v255
    v_mfma_f32_16x16x32_bf16 v[184:187], v[28:31], v[48:51], v[184:187]
    s_waitcnt lgkmcnt(12)
    v_mfma_f32_16x16x32_bf16 v[188:191], v[28:31], v[52:55], v[188:191]
    v_mfma_f32_16x16x32_bf16 v[180:183], v[24:27], v[52:55], v[180:183]
    v_mfma_f32_16x16x32_bf16 v[172:175], v[20:23], v[52:55], v[172:175]
    v_mfma_f32_16x16x32_bf16 v[164:167], v[16:19], v[52:55], v[164:167]
    s_waitcnt lgkmcnt(9)
    v_mfma_f32_16x16x32_bf16 v[128:131], v[56:59], v[72:75], v[128:131]
    s_waitcnt lgkmcnt(8)
    v_mfma_f32_16x16x32_bf16 v[136:139], v[60:63], v[72:75], v[136:139]
    s_waitcnt lgkmcnt(7)
    v_mfma_f32_16x16x32_bf16 v[144:147], v[64:67], v[72:75], v[144:147]
    s_waitcnt lgkmcnt(6)
    v_mfma_f32_16x16x32_bf16 v[152:155], v[68:71], v[72:75], v[152:155]
    s_waitcnt lgkmcnt(4)
    v_mfma_f32_16x16x32_bf16 v[156:159], v[68:71], v[76:79], v[156:159]
    v_mfma_f32_16x16x32_bf16 v[148:151], v[64:67], v[76:79], v[148:151]
    s_barrier
    v_mfma_f32_16x16x32_bf16 v[140:143], v[60:63], v[76:79], v[140:143]
    ds_read_b64_tr_b16 v[16:17], v10 offset:49152
    v_mfma_f32_16x16x32_bf16 v[132:135], v[56:59], v[76:79], v[132:135]
    ds_read_b64_tr_b16 v[18:19], v10 offset:49664
    s_waitcnt lgkmcnt(4)
    v_mfma_f32_16x16x32_bf16 v[160:163], v[56:59], v[80:83], v[160:163]
    ds_read_b128 v[192:195], v8 offset:40960
    v_mfma_f32_16x16x32_bf16 v[168:171], v[60:63], v[80:83], v[168:171]
    ds_read_b128 v[196:199], v8 offset:43008
    v_mfma_f32_16x16x32_bf16 v[176:179], v[64:67], v[80:83], v[176:179]
    ds_read_b128 v[200:203], v8 offset:45056
    v_mfma_f32_16x16x32_bf16 v[184:187], v[68:71], v[80:83], v[184:187]
    ds_read_b128 v[204:207], v8 offset:47104
    s_waitcnt lgkmcnt(6)
    v_mfma_f32_16x16x32_bf16 v[188:191], v[68:71], v[84:87], v[188:191]
    ds_read_b64_tr_b16 v[20:21], v11 offset:49152
    v_mfma_f32_16x16x32_bf16 v[180:183], v[64:67], v[84:87], v[180:183]
    ds_read_b64_tr_b16 v[22:23], v11 offset:49664
    v_mfma_f32_16x16x32_bf16 v[172:175], v[60:63], v[84:87], v[172:175]
    v_mfma_f32_16x16x32_bf16 v[164:167], v[56:59], v[84:87], v[164:167]
    s_waitcnt lgkmcnt(5)
    v_mfma_f32_16x16x32_bf16 v[128:131], v[192:195], v[16:19], v[128:131]
    ds_read_b64_tr_b16 v[24:25], v10 offset:53248
    ds_read_b64_tr_b16 v[26:27], v10 offset:53760
    s_waitcnt lgkmcnt(6)
    v_mfma_f32_16x16x32_bf16 v[136:139], v[196:199], v[16:19], v[136:139]
    ds_read_b128 v[208:211], v9 offset:40960
    ds_read_b128 v[212:215], v9 offset:43008
    s_waitcnt lgkmcnt(7)
    v_mfma_f32_16x16x32_bf16 v[144:147], v[200:203], v[16:19], v[144:147]
    ds_read_b128 v[216:219], v9 offset:45056
    s_waitcnt lgkmcnt(7)
    v_mfma_f32_16x16x32_bf16 v[152:155], v[204:207], v[16:19], v[152:155]
    ds_read_b128 v[220:223], v9 offset:47104
    s_waitcnt lgkmcnt(6)
    v_mfma_f32_16x16x32_bf16 v[156:159], v[204:207], v[20:23], v[156:159]
    ds_read_b64_tr_b16 v[28:29], v11 offset:53248
    v_mfma_f32_16x16x32_bf16 v[148:151], v[200:203], v[20:23], v[148:151]
    ds_read_b64_tr_b16 v[30:31], v11 offset:53760
    v_mfma_f32_16x16x32_bf16 v[140:143], v[196:199], v[20:23], v[140:143]
    v_mfma_f32_16x16x32_bf16 v[132:135], v[192:195], v[20:23], v[132:135]
    s_waitcnt lgkmcnt(5)
    v_mfma_f32_16x16x32_bf16 v[128:131], v[208:211], v[24:27], v[128:131]
    ds_read_b64_tr_b16 v[32:33], v10 offset:4096
    s_waitcnt lgkmcnt(5)
    v_mfma_f32_16x16x32_bf16 v[136:139], v[212:215], v[24:27], v[136:139]
    ds_read_b64_tr_b16 v[34:35], v10 offset:4608
    s_waitcnt lgkmcnt(5)
    v_mfma_f32_16x16x32_bf16 v[144:147], v[216:219], v[24:27], v[144:147]
    ds_read_b64_tr_b16 v[36:37], v11 offset:4096
    s_waitcnt lgkmcnt(5)
    v_mfma_f32_16x16x32_bf16 v[152:155], v[220:223], v[24:27], v[152:155]
    ds_read_b64_tr_b16 v[38:39], v11 offset:4608
    s_waitcnt lgkmcnt(4)
    v_mfma_f32_16x16x32_bf16 v[156:159], v[220:223], v[28:31], v[156:159]
    v_mfma_f32_16x16x32_bf16 v[148:151], v[216:219], v[28:31], v[148:151]
    v_mfma_f32_16x16x32_bf16 v[140:143], v[212:215], v[28:31], v[140:143]
    v_mfma_f32_16x16x32_bf16 v[132:135], v[208:211], v[28:31], v[132:135]
    s_waitcnt lgkmcnt(2)
    v_mfma_f32_16x16x32_bf16 v[96:99], v[32:35], v[56:59], v[96:99]
    v_mfma_f32_16x16x32_bf16 v[104:107], v[32:35], v[60:63], v[104:107]
    s_barrier
    v_mfma_f32_16x16x32_bf16 v[112:115], v[32:35], v[64:67], v[112:115]
    ds_read_b64_tr_b16 v[16:17], v14 offset:8192
    ds_read_b64_tr_b16 v[18:19], v14 offset:8704
    v_mfma_f32_16x16x32_bf16 v[120:123], v[32:35], v[68:71], v[120:123]
    ds_read_b128 v[224:227], v12 offset:0
    ds_read_b128 v[228:231], v12 offset:2048
    s_waitcnt lgkmcnt(4)
    v_mfma_f32_16x16x32_bf16 v[124:127], v[36:39], v[68:71], v[124:127]
    ds_read_b128 v[232:235], v12 offset:4096
    ds_read_b128 v[236:239], v12 offset:6144
    v_mfma_f32_16x16x32_bf16 v[116:119], v[36:39], v[64:67], v[116:119]
    ds_read_b64_tr_b16 v[20:21], v15 offset:8192
    ds_read_b64_tr_b16 v[22:23], v15 offset:8704
    v_mfma_f32_16x16x32_bf16 v[108:111], v[36:39], v[60:63], v[108:111]
    v_mfma_f32_16x16x32_bf16 v[100:103], v[36:39], v[56:59], v[100:103]
    s_waitcnt lgkmcnt(5)
    v_mfma_f32_16x16x32_bf16 v[128:131], v[224:227], v[16:19], v[128:131]
    ds_read_b64_tr_b16 v[24:25], v14 offset:12288
    ds_read_b64_tr_b16 v[26:27], v14 offset:12800
    s_waitcnt lgkmcnt(6)
    v_mfma_f32_16x16x32_bf16 v[136:139], v[228:231], v[16:19], v[136:139]
    ds_read_b128 v[240:243], v13 offset:0
    ds_read_b128 v[244:247], v13 offset:2048
    s_waitcnt lgkmcnt(7)
    v_mfma_f32_16x16x32_bf16 v[144:147], v[232:235], v[16:19], v[144:147]
    ds_read_b128 v[248:251], v13 offset:4096
    s_waitcnt lgkmcnt(7)
    v_mfma_f32_16x16x32_bf16 v[152:155], v[236:239], v[16:19], v[152:155]
    ds_read_b128 v[252:255], v13 offset:6144
    s_waitcnt lgkmcnt(6)
    v_mfma_f32_16x16x32_bf16 v[156:159], v[236:239], v[20:23], v[156:159]
    ds_read_b64_tr_b16 v[28:29], v15 offset:12288
    v_mfma_f32_16x16x32_bf16 v[148:151], v[232:235], v[20:23], v[148:151]
    ds_read_b64_tr_b16 v[30:31], v15 offset:12800
    v_mfma_f32_16x16x32_bf16 v[140:143], v[228:231], v[20:23], v[140:143]
    v_mfma_f32_16x16x32_bf16 v[132:135], v[224:227], v[20:23], v[132:135]
    s_waitcnt lgkmcnt(5)
    v_mfma_f32_16x16x32_bf16 v[128:131], v[240:243], v[24:27], v[128:131]
    ds_read_b64_tr_b16 v[32:33], v10 offset:57344
    s_waitcnt lgkmcnt(5)
    v_mfma_f32_16x16x32_bf16 v[136:139], v[244:247], v[24:27], v[136:139]
    ds_read_b64_tr_b16 v[34:35], v10 offset:57856
    s_waitcnt lgkmcnt(5)
    v_mfma_f32_16x16x32_bf16 v[144:147], v[248:251], v[24:27], v[144:147]
    ds_read_b64_tr_b16 v[36:37], v11 offset:57344
    s_waitcnt lgkmcnt(5)
    v_mfma_f32_16x16x32_bf16 v[152:155], v[252:255], v[24:27], v[152:155]
    ds_read_b64_tr_b16 v[38:39], v11 offset:57856
    s_waitcnt lgkmcnt(4)
    v_mfma_f32_16x16x32_bf16 v[156:159], v[252:255], v[28:31], v[156:159]
    v_mfma_f32_16x16x32_bf16 v[148:151], v[248:251], v[28:31], v[148:151]
    v_mfma_f32_16x16x32_bf16 v[140:143], v[244:247], v[28:31], v[140:143]
    v_mfma_f32_16x16x32_bf16 v[132:135], v[240:243], v[28:31], v[132:135]
    s_waitcnt lgkmcnt(2)
    v_mfma_f32_16x16x32_bf16 v[160:163], v[192:195], v[32:35], v[160:163]
    ds_read_b64_tr_b16 v[16:17], v10 offset:61440
    s_nop 5
    v_cvt_pk_bf16_f32 v40, v128, v129
    v_cvt_pk_bf16_f32 v41, v130, v131
    v_mfma_f32_16x16x32_bf16 v[168:171], v[196:199], v[32:35], v[168:171]
    ds_read_b64_tr_b16 v[18:19], v10 offset:61952
    v_cvt_pk_bf16_f32 v42, v136, v137
    v_cvt_pk_bf16_f32 v43, v138, v139
    ds_write_b128 v3, v[40:43] offset:0
    v_mfma_f32_16x16x32_bf16 v[176:179], v[200:203], v[32:35], v[176:179]
    ds_read_b64_tr_b16 v[20:21], v11 offset:61440
    v_cvt_pk_bf16_f32 v44, v132, v133
    v_cvt_pk_bf16_f32 v45, v134, v135
    v_cvt_pk_bf16_f32 v46, v140, v141
    v_mfma_f32_16x16x32_bf16 v[184:187], v[204:207], v[32:35], v[184:187]
    ds_read_b64_tr_b16 v[22:23], v11 offset:61952
    v_cvt_pk_bf16_f32 v47, v142, v143
    ds_write_b128 v3, v[44:47] offset:1024
    v_cvt_pk_bf16_f32 v48, v144, v145
    s_waitcnt lgkmcnt(6)
    v_mfma_f32_16x16x32_bf16 v[188:191], v[204:207], v[36:39], v[188:191]
    v_cvt_pk_bf16_f32 v49, v146, v147
    v_cvt_pk_bf16_f32 v50, v152, v153
    v_cvt_pk_bf16_f32 v51, v154, v155
    v_mfma_f32_16x16x32_bf16 v[180:183], v[200:203], v[36:39], v[180:183]
    ds_write_b128 v3, v[48:51] offset:2048
    v_cvt_pk_bf16_f32 v52, v148, v149
    v_cvt_pk_bf16_f32 v53, v150, v151
    v_mfma_f32_16x16x32_bf16 v[172:175], v[196:199], v[36:39], v[172:175]
    v_cvt_pk_bf16_f32 v54, v156, v157
    v_cvt_pk_bf16_f32 v55, v158, v159
    v_mfma_f32_16x16x32_bf16 v[164:167], v[192:195], v[36:39], v[164:167]
    ds_write_b128 v3, v[52:55] offset:3072
    ds_write_b32 v1, v0
    s_waitcnt lgkmcnt(7)
    v_mfma_f32_16x16x32_bf16 v[160:163], v[208:211], v[16:19], v[160:163]
    ds_read_b64_tr_b16 v[24:25], v14 offset:16384
    v_pk_max_u16 v72, v40, v41
    v_mfma_f32_16x16x32_bf16 v[168:171], v[212:215], v[16:19], v[168:171]
    ds_read_b64_tr_b16 v[26:27], v14 offset:16896
    v_pk_max_u16 v72, v72, v42
    v_mfma_f32_16x16x32_bf16 v[176:179], v[216:219], v[16:19], v[176:179]
    ds_read_b64_tr_b16 v[28:29], v15 offset:16384
    v_pk_max_u16 v72, v72, v43
    v_mfma_f32_16x16x32_bf16 v[184:187], v[220:223], v[16:19], v[184:187]
    ds_read_b64_tr_b16 v[30:31], v15 offset:16896
    v_pk_max_u16 v72, v72, v44
    s_waitcnt lgkmcnt(8)
    v_mfma_f32_16x16x32_bf16 v[188:191], v[220:223], v[20:23], v[188:191]
    v_pk_max_u16 v72, v72, v45
    v_mfma_f32_16x16x32_bf16 v[180:183], v[216:219], v[20:23], v[180:183]
    v_pk_max_u16 v72, v72, v46
    v_mfma_f32_16x16x32_bf16 v[172:175], v[212:215], v[20:23], v[172:175]
    v_pk_max_u16 v72, v72, v47
    v_mfma_f32_16x16x32_bf16 v[164:167], v[208:211], v[20:23], v[164:167]
    s_waitcnt lgkmcnt(2)
    v_mfma_f32_16x16x32_bf16 v[160:163], v[224:227], v[24:27], v[160:163]
    ds_read_b64_tr_b16 v[32:33], v14 offset:20480
    v_pk_max_u16 v72, v72, v48
    v_mfma_f32_16x16x32_bf16 v[168:171], v[228:231], v[24:27], v[168:171]
    ds_read_b64_tr_b16 v[34:35], v14 offset:20992
    v_pk_max_u16 v72, v72, v49
    v_mfma_f32_16x16x32_bf16 v[176:179], v[232:235], v[24:27], v[176:179]
    ds_read_b64_tr_b16 v[36:37], v15 offset:20480
    v_pk_max_u16 v72, v72, v50
    v_mfma_f32_16x16x32_bf16 v[184:187], v[236:239], v[24:27], v[184:187]
    ds_read_b64_tr_b16 v[38:39], v15 offset:20992
    v_pk_max_u16 v72, v72, v51
    s_waitcnt lgkmcnt(4)
    v_mfma_f32_16x16x32_bf16 v[188:191], v[236:239], v[28:31], v[188:191]
    v_pk_max_u16 v72, v72, v52
    v_mfma_f32_16x16x32_bf16 v[180:183], v[232:235], v[28:31], v[180:183]
    v_pk_max_u16 v72, v72, v53
    v_mfma_f32_16x16x32_bf16 v[172:175], v[228:231], v[28:31], v[172:175]
    v_pk_max_u16 v72, v72, v54
    v_mfma_f32_16x16x32_bf16 v[164:167], v[224:227], v[28:31], v[164:167]
    v_pk_max_u16 v72, v72, v55
    s_waitcnt lgkmcnt(2)
    v_mfma_f32_16x16x32_bf16 v[160:163], v[240:243], v[32:35], v[160:163]
    ds_read_b64_tr_b16 v[16:17], v10 offset:40960
    v_add_u32 v3, 65536, v3
    v_mfma_f32_16x16x32_bf16 v[168:171], v[244:247], v[32:35], v[168:171]
    ds_read_b64_tr_b16 v[18:19], v10 offset:41472
    v_lshrrev_b32 v73, 16, v72
    v_mfma_f32_16x16x32_bf16 v[176:179], v[248:251], v[32:35], v[176:179]
    ds_read_b64_tr_b16 v[20:21], v11 offset:40960
    v_and_b32 v72, 0xffff, v72
    v_mfma_f32_16x16x32_bf16 v[184:187], v[252:255], v[32:35], v[184:187]
    ds_read_b64_tr_b16 v[22:23], v11 offset:41472
    v_max_u32 v72, v72, v73
    s_waitcnt lgkmcnt(4)
    v_mfma_f32_16x16x32_bf16 v[188:191], v[252:255], v[36:39], v[188:191]
    v_cmp_lt_u32 vcc, 0xc0db, v72
    v_mfma_f32_16x16x32_bf16 v[180:183], v[248:251], v[36:39], v[180:183]
    s_cmp_lg_u64 vcc, 0
    v_mfma_f32_16x16x32_bf16 v[172:175], v[244:247], v[36:39], v[172:175]
    s_cselect_b32 s66, 2, 1
    v_mfma_f32_16x16x32_bf16 v[164:167], v[240:243], v[36:39], v[164:167]
    v_mov_b32 v0, s66
    s_waitcnt lgkmcnt(2)
    v_mfma_f32_16x16x32_bf16 v[96:99], v[16:19], v[192:195], v[96:99]
    ds_read_b64_tr_b16 v[24:25], v10 offset:45056
    s_nop 5
    v_cvt_pk_bf16_f32 v40, v160, v161
    v_cvt_pk_bf16_f32 v41, v162, v163
    v_mfma_f32_16x16x32_bf16 v[104:107], v[16:19], v[196:199], v[104:107]
    ds_read_b64_tr_b16 v[26:27], v10 offset:45568
    v_cvt_pk_bf16_f32 v42, v168, v169
    v_cvt_pk_bf16_f32 v43, v170, v171
    ds_write_b128 v3, v[40:43] offset:0
    v_mfma_f32_16x16x32_bf16 v[112:115], v[16:19], v[200:203], v[112:115]
    ds_read_b64_tr_b16 v[28:29], v11 offset:45056
    v_cvt_pk_bf16_f32 v44, v164, v165
    v_cvt_pk_bf16_f32 v45, v166, v167
    v_cvt_pk_bf16_f32 v46, v172, v173
    v_mfma_f32_16x16x32_bf16 v[120:123], v[16:19], v[204:207], v[120:123]
    ds_read_b64_tr_b16 v[30:31], v11 offset:45568
    v_cvt_pk_bf16_f32 v47, v174, v175
    ds_write_b128 v3, v[44:47] offset:1024
    v_cvt_pk_bf16_f32 v48, v176, v177
    s_waitcnt lgkmcnt(6)
    v_mfma_f32_16x16x32_bf16 v[124:127], v[20:23], v[204:207], v[124:127]
    v_cvt_pk_bf16_f32 v49, v178, v179
    v_cvt_pk_bf16_f32 v50, v184, v185
    v_cvt_pk_bf16_f32 v51, v186, v187
    v_mfma_f32_16x16x32_bf16 v[116:119], v[20:23], v[200:203], v[116:119]
    ds_write_b128 v3, v[48:51] offset:2048
    v_cvt_pk_bf16_f32 v52, v180, v181
    v_cvt_pk_bf16_f32 v53, v182, v183
    v_mfma_f32_16x16x32_bf16 v[108:111], v[20:23], v[196:199], v[108:111]
    v_cvt_pk_bf16_f32 v54, v188, v189
    v_cvt_pk_bf16_f32 v55, v190, v191
    v_mfma_f32_16x16x32_bf16 v[100:103], v[20:23], v[192:195], v[100:103]
    ds_write_b128 v3, v[52:55] offset:3072
    ds_write_b32 v1, v0 offset:16
    s_waitcnt lgkmcnt(7)
    v_mfma_f32_16x16x32_bf16 v[96:99], v[24:27], v[208:211], v[96:99]
    ds_read_b64_tr_b16 v[32:33], v6 offset:0
    v_lshlrev_b32 v9, 4, v2
    v_mfma_f32_16x16x32_bf16 v[104:107], v[24:27], v[212:215], v[104:107]
    ds_read_b64_tr_b16 v[34:35], v6 offset:512
    v_mov_b32 v136, 0
    v_mfma_f32_16x16x32_bf16 v[112:115], v[24:27], v[216:219], v[112:115]
    ds_read_b64_tr_b16 v[36:37], v7 offset:0
    v_mov_b32 v137, 0
    v_mfma_f32_16x16x32_bf16 v[120:123], v[24:27], v[220:223], v[120:123]
    ds_read_b64_tr_b16 v[38:39], v7 offset:512
    v_mov_b32 v140, 0
    s_waitcnt lgkmcnt(8)
    v_mfma_f32_16x16x32_bf16 v[124:127], v[28:31], v[220:223], v[124:127]
    v_mov_b32 v141, 0
    v_mfma_f32_16x16x32_bf16 v[116:119], v[28:31], v[216:219], v[116:119]
    v_mov_b32 v138, v94
    v_mfma_f32_16x16x32_bf16 v[108:111], v[28:31], v[212:215], v[108:111]
    v_mov_b32 v139, v95
    v_mfma_f32_16x16x32_bf16 v[100:103], v[28:31], v[208:211], v[100:103]
    s_waitcnt lgkmcnt(2)
    v_mfma_f32_16x16x32_bf16 v[96:99], v[32:35], v[224:227], v[96:99]
    ds_read_b64_tr_b16 v[16:17], v6 offset:4096
    v_bfe_u32 v77, v2, 4, 1
    v_lshrrev_b32 v78, 5, v2
    v_mfma_f32_16x16x32_bf16 v[104:107], v[32:35], v[228:231], v[104:107]
    ds_read_b64_tr_b16 v[18:19], v6 offset:4608
    v_lshl_add_u32 v77, v77, 1, v78
    v_bfe_u32 v78, v2, 1, 3
    v_mfma_f32_16x16x32_bf16 v[112:115], v[32:35], v[232:235], v[112:115]
    ds_read_b64_tr_b16 v[20:21], v7 offset:4096
    v_xor_b32 v77, v77, v78
    v_and_b32 v78, 127, v92
    v_mfma_f32_16x16x32_bf16 v[120:123], v[32:35], v[236:239], v[120:123]
    ds_read_b64_tr_b16 v[22:23], v7 offset:4608
    v_lshlrev_b32 v78, 7, v78
    v_lshl_add_u32 v77, v77, 4, v78
    s_waitcnt lgkmcnt(4)
    v_mfma_f32_16x16x32_bf16 v[124:127], v[36:39], v[236:239], v[124:127]
    v_add_u32 v77, 122880, v77
    v_xor_b32 v78, 64, v77
    v_mfma_f32_16x16x32_bf16 v[116:119], v[36:39], v[232:235], v[116:119]
    ds_read_b128 v[144:147], v77
    v_mfma_f32_16x16x32_bf16 v[108:111], v[36:39], v[228:231], v[108:111]
    ds_read_b128 v[148:151], v78
    v_mfma_f32_16x16x32_bf16 v[100:103], v[36:39], v[224:227], v[100:103]
    v_mov_b32 v76, 155664
    s_waitcnt lgkmcnt(4)
    v_mfma_f32_16x16x32_bf16 v[96:99], v[16:19], v[240:243], v[96:99]
    ds_read_b128 v[72:75], v76
    v_mfma_f32_16x16x32_bf16 v[104:107], v[16:19], v[244:247], v[104:107]
    v_mfma_f32_16x16x32_bf16 v[112:115], v[16:19], v[248:251], v[112:115]
    v_mfma_f32_16x16x32_bf16 v[120:123], v[16:19], v[252:255], v[120:123]
    s_waitcnt lgkmcnt(3)
    v_mfma_f32_16x16x32_bf16 v[124:127], v[20:23], v[252:255], v[124:127]
    v_mfma_f32_16x16x32_bf16 v[116:119], v[20:23], v[248:251], v[116:119]
    v_mfma_f32_16x16x32_bf16 v[108:111], v[20:23], v[244:247], v[108:111]
    v_mfma_f32_16x16x32_bf16 v[100:103], v[20:23], v[240:243], v[100:103]
    s_nop 7
    v_cvt_pk_bf16_f32 v16, v96, v97
    v_cvt_pk_bf16_f32 v17, v98, v99
    v_cvt_pk_bf16_f32 v18, v100, v101
    v_cvt_pk_bf16_f32 v19, v102, v103
    v_cvt_pk_bf16_f32 v20, v104, v105
    v_cvt_pk_bf16_f32 v21, v106, v107
    v_cvt_pk_bf16_f32 v22, v108, v109
    v_cvt_pk_bf16_f32 v23, v110, v111
    v_cvt_pk_bf16_f32 v40, v112, v113
    v_cvt_pk_bf16_f32 v41, v114, v115
    v_cvt_pk_bf16_f32 v42, v116, v117
    v_cvt_pk_bf16_f32 v43, v118, v119
    v_cvt_pk_bf16_f32 v44, v120, v121
    v_cvt_pk_bf16_f32 v45, v122, v123
    v_cvt_pk_bf16_f32 v46, v124, v125
    v_cvt_pk_bf16_f32 v47, v126, v127
    s_lshl_b32 s66, s3, 11
    s_add_u32 s66, s66, 139264
    v_lshlrev_b32 v3, 4, v2
    v_add_u32 v3, s66, v3
C_qw:
    s_waitcnt lgkmcnt(0)
    v_min_u32 v72, v72, v73
    v_min3_u32 v72, v72, v74, v75
    v_cmp_eq_u32 vcc, 0, v72
    s_cbranch_vccz C_qg
    ds_read_b128 v[72:75], v76
    s_branch C_qw
C_qg:
    ds_write_b128 v3, v[40:43]
    ds_write_b128 v3, v[44:47] offset:1024
    s_waitcnt lgkmcnt(0)
    s_barrier
    v_lshlrev_b32 v32, 16, v16
    v_and_b32 v33, 0xffff0000, v16
    v_pk_mul_f32 v[34:35], v[32:33], s[70:71]
    v_pk_add_f32 v[32:33], v[32:33], 1.0 op_sel_hi:[1,0]
    v_exp_f32 v34, v34 clamp
    v_exp_f32 v35, v35 clamp
    v_lshlrev_b32 v36, 16, v17
    v_and_b32 v37, 0xffff0000, v17
    v_pk_mul_f32 v[38:39], v[36:37], s[70:71]
    v_pk_add_f32 v[36:37], v[36:37], 1.0 op_sel_hi:[1,0]
    v_exp_f32 v38, v38 clamp
    v_exp_f32 v39, v39 clamp
    v_max_f32 v32, v32, v34
    v_max_f32 v33, v33, v35
    v_min_f32 v40, v32, v33
    v_cvt_pk_bf16_f32 v24, v32, v33
    v_max_f32 v36, v36, v38
    v_max_f32 v37, v37, v39
    v_min3_f32 v40, v36, v37, v40
    v_cvt_pk_bf16_f32 v25, v36, v37
    v_lshlrev_b32 v32, 16, v18
    v_and_b32 v33, 0xffff0000, v18
    v_pk_mul_f32 v[34:35], v[32:33], s[70:71]
    v_pk_add_f32 v[32:33], v[32:33], 1.0 op_sel_hi:[1,0]
    v_exp_f32 v34, v34 clamp
    v_exp_f32 v35, v35 clamp
    v_lshlrev_b32 v36, 16, v19
    v_and_b32 v37, 0xffff0000, v19
    v_pk_mul_f32 v[38:39], v[36:37], s[70:71]
    v_pk_add_f32 v[36:37], v[36:37], 1.0 op_sel_hi:[1,0]
    v_exp_f32 v38, v38 clamp
    v_exp_f32 v39, v39 clamp
    v_max_f32 v32, v32, v34
    v_max_f32 v33, v33, v35
    v_min3_f32 v40, v32, v33, v40
    v_cvt_pk_bf16_f32 v26, v32, v33
    v_max_f32 v36, v36, v38
    v_max_f32 v37, v37, v39
    v_min3_f32 v40, v36, v37, v40
    v_cvt_pk_bf16_f32 v27, v36, v37
    v_lshlrev_b32 v32, 16, v20
    v_and_b32 v33, 0xffff0000, v20
    v_pk_mul_f32 v[34:35], v[32:33], s[70:71]
    v_pk_add_f32 v[32:33], v[32:33], 1.0 op_sel_hi:[1,0]
    v_exp_f32 v34, v34 clamp
    v_exp_f32 v35, v35 clamp
    v_lshlrev_b32 v36, 16, v21
    v_and_b32 v37, 0xffff0000, v21
    v_pk_mul_f32 v[38:39], v[36:37], s[70:71]
    v_pk_add_f32 v[36:37], v[36:37], 1.0 op_sel_hi:[1,0]
    v_exp_f32 v38, v38 clamp
    v_exp_f32 v39, v39 clamp
    v_max_f32 v32, v32, v34
    v_max_f32 v33, v33, v35
    v_min3_f32 v40, v32, v33, v40
    v_cvt_pk_bf16_f32 v28, v32, v33
    v_max_f32 v36, v36, v38
    v_max_f32 v37, v37, v39
    v_min3_f32 v40, v36, v37, v40
    v_cvt_pk_bf16_f32 v29, v36, v37
    v_lshlrev_b32 v32, 16, v22
    v_and_b32 v33, 0xffff0000, v22
    v_pk_mul_f32 v[34:35], v[32:33], s[70:71]
    v_pk_add_f32 v[32:33], v[32:33], 1.0 op_sel_hi:[1,0]
    v_exp_f32 v34, v34 clamp
    v_exp_f32 v35, v35 clamp
    v_lshlrev_b32 v36, 16, v23
    v_and_b32 v37, 0xffff0000, v23
    v_pk_mul_f32 v[38:39], v[36:37], s[70:71]
    v_pk_add_f32 v[36:37], v[36:37], 1.0 op_sel_hi:[1,0]
    v_exp_f32 v38, v38 clamp
    v_exp_f32 v39, v39 clamp
    v_max_f32 v32, v32, v34
    v_max_f32 v33, v33, v35
    v_min3_f32 v40, v32, v33, v40
    v_cvt_pk_bf16_f32 v30, v32, v33
    v_max_f32 v36, v36, v38
    v_max_f32 v37, v37, v39
    v_min3_f32 v40, v36, v37, v40
    v_cvt_pk_bf16_f32 v31, v36, v37
    v_cmp_gt_f32 vcc, 0x3a800000, v40
    s_cbranch_vccz P_qd
    v_lshlrev_b32 v32, 16, v24
    v_and_b32 v33, 0xffff0000, v24
    v_add_f32 v32, s47, v32
    v_add_f32 v33, s47, v33
    v_cvt_pk_bf16_f32 v24, v32, v33
    v_lshlrev_b32 v32, 16, v25
    v_and_b32 v33, 0xffff0000, v25
    v_add_f32 v32, s47, v32
    v_add_f32 v33, s47, v33
    v_cvt_pk_bf16_f32 v25, v32, v33
    v_lshlrev_b32 v32, 16, v26
    v_and_b32 v33, 0xffff0000, v26
    v_add_f32 v32, s47, v32
    v_add_f32 v33, s47, v33
    v_cvt_pk_bf16_f32 v26, v32, v33
    v_lshlrev_b32 v32, 16, v27
    v_and_b32 v33, 0xffff0000, v27
    v_add_f32 v32, s47, v32
    v_add_f32 v33, s47, v33
    v_cvt_pk_bf16_f32 v27, v32, v33
    v_lshlrev_b32 v32, 16, v28
    v_and_b32 v33, 0xffff0000, v28
    v_add_f32 v32, s47, v32
    v_add_f32 v33, s47, v33
    v_cvt_pk_bf16_f32 v28, v32, v33
    v_lshlrev_b32 v32, 16, v29
    v_and_b32 v33, 0xffff0000, v29
    v_add_f32 v32, s47, v32
    v_add_f32 v33, s47, v33
    v_cvt_pk_bf16_f32 v29, v32, v33
    v_lshlrev_b32 v32, 16, v30
    v_and_b32 v33, 0xffff0000, v30
    v_add_f32 v32, s47, v32
    v_add_f32 v33, s47, v33
    v_cvt_pk_bf16_f32 v30, v32, v33
    v_lshlrev_b32 v32, 16, v31
    v_and_b32 v33, 0xffff0000, v31
    v_add_f32 v32, s47, v32
    v_add_f32 v33, s47, v33
    v_cvt_pk_bf16_f32 v31, v32, v33
P_qd:
    buffer_load_dwordx4 v[232:235], v89, s[16:19], 0 offen sc1
    s_lshl_b32 s66, s49, 11
    s_add_u32 s66, s66, 159744
    v_add_u32 v10, s66, v9
    s_lshl_b32 s66, s49, 6
    s_add_u32 s66, s66, 159488
    v_lshrrev_b32 v11, 4, v2
    v_lshlrev_b32 v11, 4, v11
    v_add_u32 v11, s66, v11
    s_lshr_b32 s66, s44, 1
    s_lshl_b32 s67, s66, 11
    s_lshl_b32 s66, s66, 6
    s_and_b32 s59, s44, 1
    s_lshl_b32 s59, s59, 3
    s_add_u32 s66, s66, s59
    s_add_u32 s67, s67, s59
    s_add_u32 s66, s66, 159488
    s_add_u32 s67, s67, 159744
    v_add_u32 v12, s67, v9
    v_lshrrev_b32 v13, 4, v2
    v_lshlrev_b32 v13, 4, v13
    v_add_u32 v13, s66, v13
    s_mov_b32 s59, 0
P_z:
    s_add_u32 s59, s59, 1
    s_cmp_ge_u32 s59, 200000
    s_waitcnt vmcnt(0)
    s_cbranch_scc1 P_zk
    v_max_u32 v14, v232, v233
    v_max3_u32 v14, v14, v234, v235
    v_cmp_eq_u32 vcc, -1, v14
    s_cbranch_vccz P_zk
    buffer_load_dwordx4 v[232:235], v89, s[16:19], 0 offen sc1
    s_branch P_z
P_zk:
    s_xor_b32 s66, s57, 0
    buffer_load_dwordx4 v[160:163], v88, s[16:19], s66 offen offset:0 sc1
    s_xor_b32 s66, s57, 0
    buffer_load_dwordx4 v[164:167], v88, s[16:19], s66 offen offset:1024 sc1
    s_xor_b32 s66, s57, 0
    buffer_load_dwordx4 v[168:171], v88, s[16:19], s66 offen offset:2048 sc1
    s_xor_b32 s66, s57, 0
    buffer_load_dwordx4 v[172:175], v88, s[16:19], s66 offen offset:3072 sc1
    s_xor_b32 s66, s57, 4096
    buffer_load_dwordx4 v[176:179], v88, s[16:19], s66 offen offset:0 sc1
    s_xor_b32 s66, s57, 4096
    buffer_load_dwordx4 v[180:183], v88, s[16:19], s66 offen offset:1024 sc1
    s_xor_b32 s66, s57, 4096
    buffer_load_dwordx4 v[184:187], v88, s[16:19], s66 offen offset:2048 sc1
    s_xor_b32 s66, s57, 4096
    buffer_load_dwordx4 v[188:191], v88, s[16:19], s66 offen offset:3072 sc1
    s_xor_b32 s66, s57, 8192
    buffer_load_dwordx4 v[192:195], v88, s[16:19], s66 offen offset:0 sc1
    s_xor_b32 s66, s57, 8192
    buffer_load_dwordx4 v[196:199], v88, s[16:19], s66 offen offset:1024 sc1
    s_xor_b32 s66, s57, 8192
    buffer_load_dwordx4 v[200:203], v88, s[16:19], s66 offen offset:2048 sc1
    s_xor_b32 s66, s57, 8192
    buffer_load_dwordx4 v[204:207], v88, s[16:19], s66 offen offset:3072 sc1
    s_xor_b32 s66, s57, 12288
    buffer_load_dwordx4 v[208:211], v88, s[16:19], s66 offen offset:0 sc1
    s_xor_b32 s66, s57, 12288
    buffer_load_dwordx4 v[212:215], v88, s[16:19], s66 offen offset:1024 sc1
    s_xor_b32 s66, s57, 12288
    buffer_load_dwordx4 v[216:219], v88, s[16:19], s66 offen offset:2048 sc1
    s_xor_b32 s66, s57, 12288
    buffer_load_dwordx4 v[220:223], v88, s[16:19], s66 offen offset:3072 sc1
    v_add_f32_dpp v232, v232, v232 quad_perm:[1,0,3,2] row_mask:0xf bank_mask:0xf
    v_add_f32_dpp v233, v233, v233 quad_perm:[1,0,3,2] row_mask:0xf bank_mask:0xf
    v_add_f32_dpp v234, v234, v234 quad_perm:[1,0,3,2] row_mask:0xf bank_mask:0xf
    v_add_f32_dpp v235, v235, v235 quad_perm:[1,0,3,2] row_mask:0xf bank_mask:0xf
    v_add_f32_dpp v232, v232, v232 quad_perm:[2,3,0,1] row_mask:0xf bank_mask:0xf
    v_add_f32_dpp v233, v233, v233 quad_perm:[2,3,0,1] row_mask:0xf bank_mask:0xf
    v_add_f32_dpp v234, v234, v234 quad_perm:[2,3,0,1] row_mask:0xf bank_mask:0xf
    v_add_f32_dpp v235, v235, v235 quad_perm:[2,3,0,1] row_mask:0xf bank_mask:0xf
    v_add_f32_dpp v232, v232, v232 row_half_mirror row_mask:0xf bank_mask:0xf
    v_add_f32_dpp v233, v233, v233 row_half_mirror row_mask:0xf bank_mask:0xf
    v_add_f32_dpp v234, v234, v234 row_half_mirror row_mask:0xf bank_mask:0xf
    v_add_f32_dpp v235, v235, v235 row_half_mirror row_mask:0xf bank_mask:0xf
    v_add_f32_dpp v232, v232, v232 row_mirror row_mask:0xf bank_mask:0xf
    v_add_f32_dpp v233, v233, v233 row_mirror row_mask:0xf bank_mask:0xf
    v_add_f32_dpp v234, v234, v234 row_mirror row_mask:0xf bank_mask:0xf
    v_add_f32_dpp v235, v235, v235 row_mirror row_mask:0xf bank_mask:0xf
    v_cvt_pk_bf16_f32 v232, v232, v233
    v_cvt_pk_bf16_f32 v233, v234, v235
    ds_write_b64 v13, v[232:233]
    s_waitcnt vmcnt(15)
    v_max_u32 v14, v160, v161
    v_max3_u32 v14, v14, v162, v163
    v_mfma_f32_16x16x32_bf16 v[224:227], v[138:141], v[160:163], 0
    v_mfma_f32_16x16x32_bf16 v[228:231], v[136:139], v[160:163], 0
    s_waitcnt vmcnt(14)
    v_max3_u32 v14, v14, v164, v165
    v_max3_u32 v14, v14, v166, v167
    v_mfma_f32_16x16x32_bf16 v[224:227], v[138:141], v[164:167], v[224:227]
    v_mfma_f32_16x16x32_bf16 v[228:231], v[136:139], v[164:167], v[228:231]
    s_waitcnt vmcnt(13)
    v_max3_u32 v14, v14, v168, v169
    v_max3_u32 v14, v14, v170, v171
    v_mfma_f32_16x16x32_bf16 v[224:227], v[138:141], v[168:171], v[224:227]
    v_mfma_f32_16x16x32_bf16 v[228:231], v[136:139], v[168:171], v[228:231]
    s_waitcnt vmcnt(12)
    v_max3_u32 v14, v14, v172, v173
    v_max3_u32 v14, v14, v174, v175
    v_mfma_f32_16x16x32_bf16 v[224:227], v[138:141], v[172:175], v[224:227]
    v_mfma_f32_16x16x32_bf16 v[228:231], v[136:139], v[172:175], v[228:231]
    s_waitcnt vmcnt(11)
    v_max3_u32 v14, v14, v176, v177
    v_max3_u32 v14, v14, v178, v179
    v_mfma_f32_16x16x32_bf16 v[224:227], v[138:141], v[176:179], v[224:227]
    v_mfma_f32_16x16x32_bf16 v[228:231], v[136:139], v[176:179], v[228:231]
    s_waitcnt vmcnt(10)
    v_max3_u32 v14, v14, v180, v181
    v_max3_u32 v14, v14, v182, v183
    v_mfma_f32_16x16x32_bf16 v[224:227], v[138:141], v[180:183], v[224:227]
    v_mfma_f32_16x16x32_bf16 v[228:231], v[136:139], v[180:183], v[228:231]
    s_waitcnt vmcnt(9)
    v_max3_u32 v14, v14, v184, v185
    v_max3_u32 v14, v14, v186, v187
    v_mfma_f32_16x16x32_bf16 v[224:227], v[138:141], v[184:187], v[224:227]
    v_mfma_f32_16x16x32_bf16 v[228:231], v[136:139], v[184:187], v[228:231]
    s_waitcnt vmcnt(8)
    v_max3_u32 v14, v14, v188, v189
    v_max3_u32 v14, v14, v190, v191
    v_mfma_f32_16x16x32_bf16 v[224:227], v[138:141], v[188:191], v[224:227]
    v_mfma_f32_16x16x32_bf16 v[228:231], v[136:139], v[188:191], v[228:231]
    s_waitcnt vmcnt(7)
    v_max3_u32 v14, v14, v192, v193
    v_max3_u32 v14, v14, v194, v195
    v_mfma_f32_16x16x32_bf16 v[224:227], v[138:141], v[192:195], v[224:227]
    v_mfma_f32_16x16x32_bf16 v[228:231], v[136:139], v[192:195], v[228:231]
    s_waitcnt vmcnt(6)
    v_max3_u32 v14, v14, v196, v197
    v_max3_u32 v14, v14, v198, v199
    v_mfma_f32_16x16x32_bf16 v[224:227], v[138:141], v[196:199], v[224:227]
    v_mfma_f32_16x16x32_bf16 v[228:231], v[136:139], v[196:199], v[228:231]
    s_waitcnt vmcnt(5)
    v_max3_u32 v14, v14, v200, v201
    v_max3_u32 v14, v14, v202, v203
    v_mfma_f32_16x16x32_bf16 v[224:227], v[138:141], v[200:203], v[224:227]
    v_mfma_f32_16x16x32_bf16 v[228:231], v[136:139], v[200:203], v[228:231]
    s_waitcnt vmcnt(4)
    v_max3_u32 v14, v14, v204, v205
    v_max3_u32 v14, v14, v206, v207
    v_mfma_f32_16x16x32_bf16 v[224:227], v[138:141], v[204:207], v[224:227]
    v_mfma_f32_16x16x32_bf16 v[228:231], v[136:139], v[204:207], v[228:231]
    s_waitcnt vmcnt(3)
    v_max3_u32 v14, v14, v208, v209
    v_max3_u32 v14, v14, v210, v211
    v_mfma_f32_16x16x32_bf16 v[224:227], v[138:141], v[208:211], v[224:227]
    v_mfma_f32_16x16x32_bf16 v[228:231], v[136:139], v[208:211], v[228:231]
    s_waitcnt vmcnt(2)
    v_max3_u32 v14, v14, v212, v213
    v_max3_u32 v14, v14, v214, v215
    v_mfma_f32_16x16x32_bf16 v[224:227], v[138:141], v[212:215], v[224:227]
    v_mfma_f32_16x16x32_bf16 v[228:231], v[136:139], v[212:215], v[228:231]
    s_waitcnt vmcnt(1)
    v_max3_u32 v14, v14, v216, v217
    v_max3_u32 v14, v14, v218, v219
    v_mfma_f32_16x16x32_bf16 v[224:227], v[138:141], v[216:219], v[224:227]
    v_mfma_f32_16x16x32_bf16 v[228:231], v[136:139], v[216:219], v[228:231]
    s_waitcnt vmcnt(0)
    v_max3_u32 v14, v14, v220, v221
    v_max3_u32 v14, v14, v222, v223
    v_mfma_f32_16x16x32_bf16 v[224:227], v[138:141], v[220:223], v[224:227]
    v_mfma_f32_16x16x32_bf16 v[228:231], v[136:139], v[220:223], v[228:231]
    v_cmp_eq_u32 vcc, -1, v14
    s_cbranch_vccnz P_slow
P_h1ok:
    s_nop 5
    v_cvt_pk_bf16_f32 v224, v224, v225
    v_cvt_pk_bf16_f32 v225, v226, v227
    v_cvt_pk_bf16_f32 v226, v228, v229
    v_cvt_pk_bf16_f32 v227, v230, v231
    ds_write_b64 v12, v[224:225]
    ds_write_b64 v12, v[226:227] offset:1024
    s_branch POST
P_slow:
    s_mov_b32 s59, 0
P_retry:
    s_mov_b32 s76, 0
    v_max_u32 v14, v160, v161
    v_max3_u32 v14, v14, v162, v163
    v_cmp_eq_u32 vcc, -1, v14
    s_cbranch_vccz P_rc0
    s_xor_b32 s66, s57, 0
    buffer_load_dwordx4 v[160:163], v88, s[16:19], s66 offen offset:0 sc1
    s_mov_b32 s76, 1
P_rc0:
    v_max_u32 v14, v164, v165
    v_max3_u32 v14, v14, v166, v167
    v_cmp_eq_u32 vcc, -1, v14
    s_cbranch_vccz P_rc1
    s_xor_b32 s66, s57, 0
    buffer_load_dwordx4 v[164:167], v88, s[16:19], s66 offen offset:1024 sc1
    s_mov_b32 s76, 1
P_rc1:
    v_max_u32 v14, v168, v169
    v_max3_u32 v14, v14, v170, v171
    v_cmp_eq_u32 vcc, -1, v14
    s_cbranch_vccz P_rc2
    s_xor_b32 s66, s57, 0
    buffer_load_dwordx4 v[168:171], v88, s[16:19], s66 offen offset:2048 sc1
    s_mov_b32 s76, 1
P_rc2:
    v_max_u32 v14, v172, v173
    v_max3_u32 v14, v14, v174, v175
    v_cmp_eq_u32 vcc, -1, v14
    s_cbranch_vccz P_rc3
    s_xor_b32 s66, s57, 0
    buffer_load_dwordx4 v[172:175], v88, s[16:19], s66 offen offset:3072 sc1
    s_mov_b32 s76, 1
P_rc3:
    v_max_u32 v14, v176, v177
    v_max3_u32 v14, v14, v178, v179
    v_cmp_eq_u32 vcc, -1, v14
    s_cbranch_vccz P_rc4
    s_xor_b32 s66, s57, 4096
    buffer_load_dwordx4 v[176:179], v88, s[16:19], s66 offen offset:0 sc1
    s_mov_b32 s76, 1
P_rc4:
    v_max_u32 v14, v180, v181
    v_max3_u32 v14, v14, v182, v183
    v_cmp_eq_u32 vcc, -1, v14
    s_cbranch_vccz P_rc5
    s_xor_b32 s66, s57, 4096
    buffer_load_dwordx4 v[180:183], v88, s[16:19], s66 offen offset:1024 sc1
    s_mov_b32 s76, 1
P_rc5:
    v_max_u32 v14, v184, v185
    v_max3_u32 v14, v14, v186, v187
    v_cmp_eq_u32 vcc, -1, v14
    s_cbranch_vccz P_rc6
    s_xor_b32 s66, s57, 4096
    buffer_load_dwordx4 v[184:187], v88, s[16:19], s66 offen offset:2048 sc1
    s_mov_b32 s76, 1
P_rc6:
    v_max_u32 v14, v188, v189
    v_max3_u32 v14, v14, v190, v191
    v_cmp_eq_u32 vcc, -1, v14
    s_cbranch_vccz P_rc7
    s_xor_b32 s66, s57, 4096
    buffer_load_dwordx4 v[188:191], v88, s[16:19], s66 offen offset:3072 sc1
    s_mov_b32 s76, 1
P_rc7:
    v_max_u32 v14, v192, v193
    v_max3_u32 v14, v14, v194, v195
    v_cmp_eq_u32 vcc, -1, v14
    s_cbranch_vccz P_rc8
    s_xor_b32 s66, s57, 8192
    buffer_load_dwordx4 v[192:195], v88, s[16:19], s66 offen offset:0 sc1
    s_mov_b32 s76, 1
P_rc8:
    v_max_u32 v14, v196, v197
    v_max3_u32 v14, v14, v198, v199
    v_cmp_eq_u32 vcc, -1, v14
    s_cbranch_vccz P_rc9
    s_xor_b32 s66, s57, 8192
    buffer_load_dwordx4 v[196:199], v88, s[16:19], s66 offen offset:1024 sc1
    s_mov_b32 s76, 1
P_rc9:
    v_max_u32 v14, v200, v201
    v_max3_u32 v14, v14, v202, v203
    v_cmp_eq_u32 vcc, -1, v14
    s_cbranch_vccz P_rc10
    s_xor_b32 s66, s57, 8192
    buffer_load_dwordx4 v[200:203], v88, s[16:19], s66 offen offset:2048 sc1
    s_mov_b32 s76, 1
P_rc10:
    v_max_u32 v14, v204, v205
    v_max3_u32 v14, v14, v206, v207
    v_cmp_eq_u32 vcc, -1, v14
    s_cbranch_vccz P_rc11
    s_xor_b32 s66, s57, 8192
    buffer_load_dwordx4 v[204:207], v88, s[16:19], s66 offen offset:3072 sc1
    s_mov_b32 s76, 1
P_rc11:
    v_max_u32 v14, v208, v209
    v_max3_u32 v14, v14, v210, v211
    v_cmp_eq_u32 vcc, -1, v14
    s_cbranch_vccz P_rc12
    s_xor_b32 s66, s57, 12288
    buffer_load_dwordx4 v[208:211], v88, s[16:19], s66 offen offset:0 sc1
    s_mov_b32 s76, 1
P_rc12:
    v_max_u32 v14, v212, v213
    v_max3_u32 v14, v14, v214, v215
    v_cmp_eq_u32 vcc, -1, v14
    s_cbranch_vccz P_rc13
    s_xor_b32 s66, s57, 12288
    buffer_load_dwordx4 v[212:215], v88, s[16:19], s66 offen offset:1024 sc1
    s_mov_b32 s76, 1
P_rc13:
    v_max_u32 v14, v216, v217
    v_max3_u32 v14, v14, v218, v219
    v_cmp_eq_u32 vcc, -1, v14
    s_cbranch_vccz P_rc14
    s_xor_b32 s66, s57, 12288
    buffer_load_dwordx4 v[216:219], v88, s[16:19], s66 offen offset:2048 sc1
    s_mov_b32 s76, 1
P_rc14:
    v_max_u32 v14, v220, v221
    v_max3_u32 v14, v14, v222, v223
    v_cmp_eq_u32 vcc, -1, v14
    s_cbranch_vccz P_rc15
    s_xor_b32 s66, s57, 12288
    buffer_load_dwordx4 v[220:223], v88, s[16:19], s66 offen offset:3072 sc1
    s_mov_b32 s76, 1
P_rc15:
    s_add_u32 s59, s59, 1
    s_cmp_ge_u32 s59, 200000
    s_cselect_b32 s76, 0, s76
    s_waitcnt vmcnt(0)
    s_cmp_lg_u32 s76, 0
    s_cbranch_scc1 P_retry
    v_mfma_f32_16x16x32_bf16 v[224:227], v[138:141], v[160:163], 0
    v_mfma_f32_16x16x32_bf16 v[228:231], v[136:139], v[160:163], 0
    v_mfma_f32_16x16x32_bf16 v[224:227], v[138:141], v[164:167], v[224:227]
    v_mfma_f32_16x16x32_bf16 v[228:231], v[136:139], v[164:167], v[228:231]
    v_mfma_f32_16x16x32_bf16 v[224:227], v[138:141], v[168:171], v[224:227]
    v_mfma_f32_16x16x32_bf16 v[228:231], v[136:139], v[168:171], v[228:231]
    v_mfma_f32_16x16x32_bf16 v[224:227], v[138:141], v[172:175], v[224:227]
    v_mfma_f32_16x16x32_bf16 v[228:231], v[136:139], v[172:175], v[228:231]
    v_mfma_f32_16x16x32_bf16 v[224:227], v[138:141], v[176:179], v[224:227]
    v_mfma_f32_16x16x32_bf16 v[228:231], v[136:139], v[176:179], v[228:231]
    v_mfma_f32_16x16x32_bf16 v[224:227], v[138:141], v[180:183], v[224:227]
    v_mfma_f32_16x16x32_bf16 v[228:231], v[136:139], v[180:183], v[228:231]
    v_mfma_f32_16x16x32_bf16 v[224:227], v[138:141], v[184:187], v[224:227]
    v_mfma_f32_16x16x32_bf16 v[228:231], v[136:139], v[184:187], v[228:231]
    v_mfma_f32_16x16x32_bf16 v[224:227], v[138:141], v[188:191], v[224:227]
    v_mfma_f32_16x16x32_bf16 v[228:231], v[136:139], v[188:191], v[228:231]
    v_mfma_f32_16x16x32_bf16 v[224:227], v[138:141], v[192:195], v[224:227]
    v_mfma_f32_16x16x32_bf16 v[228:231], v[136:139], v[192:195], v[228:231]
    v_mfma_f32_16x16x32_bf16 v[224:227], v[138:141], v[196:199], v[224:227]
    v_mfma_f32_16x16x32_bf16 v[228:231], v[136:139], v[196:199], v[228:231]
    v_mfma_f32_16x16x32_bf16 v[224:227], v[138:141], v[200:203], v[224:227]
    v_mfma_f32_16x16x32_bf16 v[228:231], v[136:139], v[200:203], v[228:231]
    v_mfma_f32_16x16x32_bf16 v[224:227], v[138:141], v[204:207], v[224:227]
    v_mfma_f32_16x16x32_bf16 v[228:231], v[136:139], v[204:207], v[228:231]
    v_mfma_f32_16x16x32_bf16 v[224:227], v[138:141], v[208:211], v[224:227]
    v_mfma_f32_16x16x32_bf16 v[228:231], v[136:139], v[208:211], v[228:231]
    v_mfma_f32_16x16x32_bf16 v[224:227], v[138:141], v[212:215], v[224:227]
    v_mfma_f32_16x16x32_bf16 v[228:231], v[136:139], v[212:215], v[228:231]
    v_mfma_f32_16x16x32_bf16 v[224:227], v[138:141], v[216:219], v[224:227]
    v_mfma_f32_16x16x32_bf16 v[228:231], v[136:139], v[216:219], v[228:231]
    v_mfma_f32_16x16x32_bf16 v[224:227], v[138:141], v[220:223], v[224:227]
    v_mfma_f32_16x16x32_bf16 v[228:231], v[136:139], v[220:223], v[228:231]
    s_nop 1
    s_branch P_h1ok
HELP:
    v_lshlrev_b32 v9, 4, v2
    s_lshl_b32 s56, s5, 2
    s_add_u32 s56, s56, s44
    s_lshl_b32 s53, s56, 10
    s_lshl_b32 s66, s4, 6
    s_add_u32 s53, s53, s66
    s_add_u32 s53, s53, 5242880
    s_lshl_b32 s56, s56, 4
    s_add_u32 s56, s56, s4
    s_lshl_b32 s56, s56, 10
    s_add_u32 s56, s56, 4194304
    s_lshl_b32 s55, s73, 2
    s_add_u32 s55, s55, s44
    s_lshl_b32 s55, s55, 6
    s_add_u32 s55, s55, s79
    s_lshl_b32 s55, s55, 8
    s_add_u32 s55, s55, 5832704
    v_lshrrev_b32 v12, 3, v2
    s_lshl_b32 s67, s44, 3
    v_add_u32 v12, s67, v12
    v_lshlrev_b32 v12, 11, v12
    v_lshrrev_b32 v13, 4, v2
    v_lshlrev_b32 v13, 1, v13
    v_and_b32 v90, 7, v2
    v_xor_b32 v13, v13, v90
    v_lshl_add_u32 v12, v13, 4, v12
    s_lshl_b32 s66, s7, 7
    v_add_u32 v90, s66, v12
    s_lshl_b32 s66, s6, 7
    s_lshl_b32 s67, s44, 5
    s_add_u32 s66, s66, s67
    s_lshl_b32 s67, s45, 4
    s_add_u32 s66, s66, s67
    v_and_b32 v92, 15, v2
    v_add_u32 v92, s66, v92
    v_lshlrev_b32 v91, 11, v92
    v_bfe_u32 v12, v2, 4, 1
    v_lshl_add_u32 v91, v12, 5, v91
    v_lshrrev_b32 v12, 5, v2
    v_lshl_add_u32 v91, v12, 4, v91
    s_lshl_b32 s66, s7, 7
    v_add_u32 v91, s66, v91
    v_lshrrev_b32 v93, 2, v92
    v_lshlrev_b32 v93, 6, v93
    v_and_b32 v12, 3, v2
    v_lshl_add_u32 v93, v12, 2, v93
    s_lshl_b32 s66, s6, 1
    s_and_b32 s66, s66, 6
    s_lshl_b32 s67, s7, 3
    s_add_u32 s66, s66, s67
    s_and_b32 s66, s66, 7
    s_lshl_b32 s52, s66, 18
    s_lshr_b32 s49, s44, 1
    s_and_b32 s66, s44, 1
    s_lshl_b32 s66, s66, 2
    s_lshl_b32 s67, s45, 1
    s_add_u32 s66, s66, s67
    s_lshl_b32 s67, s4, 3
    s_add_u32 s66, s66, s67
    s_lshl_b32 s66, s66, 15
    s_lshl_b32 s67, s5, 11
    s_add_u32 s66, s66, s67
    s_lshl_b32 s67, s49, 10
    s_add_u32 s60, s66, s67
    s_add_u32 s61, s60, 32768
    v_lshrrev_b32 v10, 5, v2
    v_and_b32 v11, 31, v2
    v_lshlrev_b32 v12, 3, v10
    s_lshl_b32 s66, s79, 6
    s_lshl_b32 s67, s44, 4
    s_add_u32 s66, s66, s67
    v_add_u32 v12, s66, v12
    v_lshlrev_b32 v12, 11, v12
    v_lshl_add_u32 v12, v11, 4, v12
    s_lshl_b32 s66, s73, 9
    v_add_u32 v7, s66, v12
    s_lshr_b32 s62, s79, 2
    s_lshl_b32 s62, s62, 15
    s_and_b32 s66, s79, 3
    s_lshl_b32 s66, s66, 8
    s_add_u32 s62, s62, s66
    s_lshl_b32 s66, s44, 6
    s_add_u32 s62, s62, s66
    s_add_u32 s62, s62, 5308416
    s_add_u32 s63, s62, 16384
    v_lshrrev_b32 v1, 2, v2
    v_lshlrev_b32 v1, 10, v1
    v_and_b32 v13, 3, v2
    v_lshl_add_u32 v1, v13, 4, v1
    s_cmp_ge_u32 s44, 2
    s_cbranch_scc1 WORK
    s_waitcnt vmcnt(5)
    s_barrier
    s_cmp_le_u32 s77, 2
    s_addc_u32 s71, s76, 2
    s_and_b32 s71, s71, 15
    s_lshl_b32 s70, s71, 7
    s_mul_i32 s71, s71, 393216
    s_add_u32 m0, s72, 106496
    s_add_u32 s66, s71, 2048
    buffer_load_dwordx4 v5, s[12:15], s66 offen lds
    s_add_u32 m0, s72, 108544
    s_add_u32 s66, s71, 100352
    buffer_load_dwordx4 v5, s[12:15], s66 offen lds
    s_add_u32 m0, s72, 110592
    s_add_u32 s66, s71, 198656
    buffer_load_dwordx4 v5, s[12:15], s66 offen lds
    s_add_u32 m0, s72, 112640
    s_add_u32 s66, s71, 296960
    buffer_load_dwordx4 v5, s[12:15], s66 offen lds
    s_add_u32 m0, s72, 81920
    s_add_u32 s66, s70, 0
    buffer_load_dwordx4 v4, s[8:11], s66 offen lds
    s_add_u32 m0, s72, 83968
    s_add_u32 s66, s70, 32768
    buffer_load_dwordx4 v4, s[8:11], s66 offen lds
    s_add_u32 m0, s72, 86016
    s_add_u32 s66, s70, 65536
    buffer_load_dwordx4 v4, s[8:11], s66 offen lds
    s_add_u32 m0, s72, 88064
    s_add_u32 s66, s70, 98304
    buffer_load_dwordx4 v4, s[8:11], s66 offen lds
    s_add_u32 m0, s72, 90112
    s_add_u32 s66, s70, 131072
    buffer_load_dwordx4 v4, s[8:11], s66 offen lds
    s_add_u32 m0, s72, 92160
    s_add_u32 s66, s70, 163840
    buffer_load_dwordx4 v4, s[8:11], s66 offen lds
    s_add_u32 m0, s72, 94208
    s_add_u32 s66, s70, 196608
    buffer_load_dwordx4 v4, s[8:11], s66 offen lds
    s_add_u32 m0, s72, 96256
    s_add_u32 s66, s70, 229376
    buffer_load_dwordx4 v4, s[8:11], s66 offen lds
    s_add_u32 m0, s72, 114688
    s_add_u32 s66, s71, 4096
    buffer_load_dwordx4 v5, s[12:15], s66 offen lds
    s_add_u32 m0, s72, 116736
    s_add_u32 s66, s71, 102400
    buffer_load_dwordx4 v5, s[12:15], s66 offen lds
    s_add_u32 m0, s72, 118784
    s_add_u32 s66, s71, 200704
    buffer_load_dwordx4 v5, s[12:15], s66 offen lds
    s_add_u32 m0, s72, 120832
    s_add_u32 s66, s71, 299008
    buffer_load_dwordx4 v5, s[12:15], s66 offen lds
    s_add_u32 m0, s72, 98304
    s_add_u32 s66, s71, 0
    buffer_load_dwordx4 v5, s[12:15], s66 offen lds
    s_add_u32 m0, s72, 100352
    s_add_u32 s66, s71, 98304
    buffer_load_dwordx4 v5, s[12:15], s66 offen lds
    s_add_u32 m0, s72, 102400
    s_add_u32 s66, s71, 196608
    buffer_load_dwordx4 v5, s[12:15], s66 offen lds
    s_add_u32 m0, s72, 104448
    s_add_u32 s66, s71, 294912
    buffer_load_dwordx4 v5, s[12:15], s66 offen lds
    s_waitcnt vmcnt(20)
    s_barrier
    s_cmp_le_u32 s77, 3
    s_addc_u32 s71, s76, 3
    s_and_b32 s71, s71, 15
    s_lshl_b32 s70, s71, 7
    s_mul_i32 s71, s71, 393216
    s_add_u32 m0, s72, 24576
    s_add_u32 s66, s71, 2048
    buffer_load_dwordx4 v5, s[12:15], s66 offen lds
    s_add_u32 m0, s72, 26624
    s_add_u32 s66, s71, 100352
    buffer_load_dwordx4 v5, s[12:15], s66 offen lds
    s_add_u32 m0, s72, 28672
    s_add_u32 s66, s71, 198656
    buffer_load_dwordx4 v5, s[12:15], s66 offen lds
    s_add_u32 m0, s72, 30720
    s_add_u32 s66, s71, 296960
    buffer_load_dwordx4 v5, s[12:15], s66 offen lds
    s_add_u32 m0, s72, 0
    s_add_u32 s66, s70, 0
    buffer_load_dwordx4 v4, s[8:11], s66 offen lds
    s_add_u32 m0, s72, 2048
    s_add_u32 s66, s70, 32768
    buffer_load_dwordx4 v4, s[8:11], s66 offen lds
    s_add_u32 m0, s72, 4096
    s_add_u32 s66, s70, 65536
    buffer_load_dwordx4 v4, s[8:11], s66 offen lds
    s_add_u32 m0, s72, 6144
    s_add_u32 s66, s70, 98304
    buffer_load_dwordx4 v4, s[8:11], s66 offen lds
    s_add_u32 m0, s72, 8192
    s_add_u32 s66, s70, 131072
    buffer_load_dwordx4 v4, s[8:11], s66 offen lds
    s_add_u32 m0, s72, 10240
    s_add_u32 s66, s70, 163840
    buffer_load_dwordx4 v4, s[8:11], s66 offen lds
    s_add_u32 m0, s72, 12288
    s_add_u32 s66, s70, 196608
    buffer_load_dwordx4 v4, s[8:11], s66 offen lds
    s_add_u32 m0, s72, 14336
    s_add_u32 s66, s70, 229376
    buffer_load_dwordx4 v4, s[8:11], s66 offen lds
    s_add_u32 m0, s72, 32768
    s_add_u32 s66, s71, 4096
    buffer_load_dwordx4 v5, s[12:15], s66 offen lds
    s_add_u32 m0, s72, 34816
    s_add_u32 s66, s71, 102400
    buffer_load_dwordx4 v5, s[12:15], s66 offen lds
    s_add_u32 m0, s72, 36864
    s_add_u32 s66, s71, 200704
    buffer_load_dwordx4 v5, s[12:15], s66 offen lds
    s_add_u32 m0, s72, 38912
    s_add_u32 s66, s71, 299008
    buffer_load_dwordx4 v5, s[12:15], s66 offen lds
    s_add_u32 m0, s72, 16384
    s_add_u32 s66, s71, 0
    buffer_load_dwordx4 v5, s[12:15], s66 offen lds
    s_add_u32 m0, s72, 18432
    s_add_u32 s66, s71, 98304
    buffer_load_dwordx4 v5, s[12:15], s66 offen lds
    s_add_u32 m0, s72, 20480
    s_add_u32 s66, s71, 196608
    buffer_load_dwordx4 v5, s[12:15], s66 offen lds
    s_add_u32 m0, s72, 22528
    s_add_u32 s66, s71, 294912
    buffer_load_dwordx4 v5, s[12:15], s66 offen lds
    s_waitcnt vmcnt(20)
    s_barrier
    s_cmp_le_u32 s77, 4
    s_addc_u32 s71, s76, 4
    s_and_b32 s71, s71, 15
    s_lshl_b32 s70, s71, 7
    s_mul_i32 s71, s71, 393216
    s_add_u32 m0, s72, 65536
    s_add_u32 s66, s71, 2048
    buffer_load_dwordx4 v5, s[12:15], s66 offen lds
    s_add_u32 m0, s72, 67584
    s_add_u32 s66, s71, 100352
    buffer_load_dwordx4 v5, s[12:15], s66 offen lds
    s_add_u32 m0, s72, 69632
    s_add_u32 s66, s71, 198656
    buffer_load_dwordx4 v5, s[12:15], s66 offen lds
    s_add_u32 m0, s72, 71680
    s_add_u32 s66, s71, 296960
    buffer_load_dwordx4 v5, s[12:15], s66 offen lds
    s_add_u32 m0, s72, 40960
    s_add_u32 s66, s70, 0
    buffer_load_dwordx4 v4, s[8:11], s66 offen lds
    s_add_u32 m0, s72, 43008
    s_add_u32 s66, s70, 32768
    buffer_load_dwordx4 v4, s[8:11], s66 offen lds
    s_add_u32 m0, s72, 45056
    s_add_u32 s66, s70, 65536
    buffer_load_dwordx4 v4, s[8:11], s66 offen lds
    s_add_u32 m0, s72, 47104
    s_add_u32 s66, s70, 98304
    buffer_load_dwordx4 v4, s[8:11], s66 offen lds
    s_add_u32 m0, s72, 49152
    s_add_u32 s66, s70, 131072
    buffer_load_dwordx4 v4, s[8:11], s66 offen lds
    s_add_u32 m0, s72, 51200
    s_add_u32 s66, s70, 163840
    buffer_load_dwordx4 v4, s[8:11], s66 offen lds
    s_add_u32 m0, s72, 53248
    s_add_u32 s66, s70, 196608
    buffer_load_dwordx4 v4, s[8:11], s66 offen lds
    s_add_u32 m0, s72, 55296
    s_add_u32 s66, s70, 229376
    buffer_load_dwordx4 v4, s[8:11], s66 offen lds
    s_add_u32 m0, s72, 73728
    s_add_u32 s66, s71, 4096
    buffer_load_dwordx4 v5, s[12:15], s66 offen lds
    s_add_u32 m0, s72, 75776
    s_add_u32 s66, s71, 102400
    buffer_load_dwordx4 v5, s[12:15], s66 offen lds
    s_add_u32 m0, s72, 77824
    s_add_u32 s66, s71, 200704
    buffer_load_dwordx4 v5, s[12:15], s66 offen lds
    s_add_u32 m0, s72, 79872
    s_add_u32 s66, s71, 299008
    buffer_load_dwordx4 v5, s[12:15], s66 offen lds
    s_add_u32 m0, s72, 57344
    s_add_u32 s66, s71, 0
    buffer_load_dwordx4 v5, s[12:15], s66 offen lds
    s_add_u32 m0, s72, 59392
    s_add_u32 s66, s71, 98304
    buffer_load_dwordx4 v5, s[12:15], s66 offen lds
    s_add_u32 m0, s72, 61440
    s_add_u32 s66, s71, 196608
    buffer_load_dwordx4 v5, s[12:15], s66 offen lds
    s_add_u32 m0, s72, 63488
    s_add_u32 s66, s71, 294912
    buffer_load_dwordx4 v5, s[12:15], s66 offen lds
    s_waitcnt vmcnt(20)
    s_barrier
    s_cmp_le_u32 s77, 5
    s_addc_u32 s71, s76, 5
    s_and_b32 s71, s71, 15
    s_lshl_b32 s70, s71, 7
    s_mul_i32 s71, s71, 393216
    s_add_u32 m0, s72, 106496
    s_add_u32 s66, s71, 2048
    buffer_load_dwordx4 v5, s[12:15], s66 offen lds
    s_add_u32 m0, s72, 108544
    s_add_u32 s66, s71, 100352
    buffer_load_dwordx4 v5, s[12:15], s66 offen lds
    s_add_u32 m0, s72, 110592
    s_add_u32 s66, s71, 198656
    buffer_load_dwordx4 v5, s[12:15], s66 offen lds
    s_add_u32 m0, s72, 112640
    s_add_u32 s66, s71, 296960
    buffer_load_dwordx4 v5, s[12:15], s66 offen lds
    s_add_u32 m0, s72, 81920
    s_add_u32 s66, s70, 0
    buffer_load_dwordx4 v4, s[8:11], s66 offen lds
    s_add_u32 m0, s72, 83968
    s_add_u32 s66, s70, 32768
    buffer_load_dwordx4 v4, s[8:11], s66 offen lds
    s_add_u32 m0, s72, 86016
    s_add_u32 s66, s70, 65536
    buffer_load_dwordx4 v4, s[8:11], s66 offen lds
    s_add_u32 m0, s72, 88064
    s_add_u32 s66, s70, 98304
    buffer_load_dwordx4 v4, s[8:11], s66 offen lds
    s_add_u32 m0, s72, 90112
    s_add_u32 s66, s70, 131072
    buffer_load_dwordx4 v4, s[8:11], s66 offen lds
    s_add_u32 m0, s72, 92160
    s_add_u32 s66, s70, 163840
    buffer_load_dwordx4 v4, s[8:11], s66 offen lds
    s_add_u32 m0, s72, 94208
    s_add_u32 s66, s70, 196608
    buffer_load_dwordx4 v4, s[8:11], s66 offen lds
    s_add_u32 m0, s72, 96256
    s_add_u32 s66, s70, 229376
    buffer_load_dwordx4 v4, s[8:11], s66 offen lds
    s_add_u32 m0, s72, 114688
    s_add_u32 s66, s71, 4096
    buffer_load_dwordx4 v5, s[12:15], s66 offen lds
    s_add_u32 m0, s72, 116736
    s_add_u32 s66, s71, 102400
    buffer_load_dwordx4 v5, s[12:15], s66 offen lds
    s_add_u32 m0, s72, 118784
    s_add_u32 s66, s71, 200704
    buffer_load_dwordx4 v5, s[12:15], s66 offen lds
    s_add_u32 m0, s72, 120832
    s_add_u32 s66, s71, 299008
    buffer_load_dwordx4 v5, s[12:15], s66 offen lds
    s_add_u32 m0, s72, 98304
    s_add_u32 s66, s71, 0
    buffer_load_dwordx4 v5, s[12:15], s66 offen lds
    s_add_u32 m0, s72, 100352
    s_add_u32 s66, s71, 98304
    buffer_load_dwordx4 v5, s[12:15], s66 offen lds
    s_add_u32 m0, s72, 102400
    s_add_u32 s66, s71, 196608
    buffer_load_dwordx4 v5, s[12:15], s66 offen lds
    s_add_u32 m0, s72, 104448
    s_add_u32 s66, s71, 294912
    buffer_load_dwordx4 v5, s[12:15], s66 offen lds
    s_waitcnt vmcnt(20)
    s_barrier
    s_cmp_le_u32 s77, 6
    s_addc_u32 s71, s76, 6
    s_and_b32 s71, s71, 15
    s_lshl_b32 s70, s71, 7
    s_mul_i32 s71, s71, 393216
    s_add_u32 m0, s72, 24576
    s_add_u32 s66, s71, 2048
    buffer_load_dwordx4 v5, s[12:15], s66 offen lds
    s_add_u32 m0, s72, 26624
    s_add_u32 s66, s71, 100352
    buffer_load_dwordx4 v5, s[12:15], s66 offen lds
    s_add_u32 m0, s72, 28672
    s_add_u32 s66, s71, 198656
    buffer_load_dwordx4 v5, s[12:15], s66 offen lds
    s_add_u32 m0, s72, 30720
    s_add_u32 s66, s71, 296960
    buffer_load_dwordx4 v5, s[12:15], s66 offen lds
    s_add_u32 m0, s72, 0
    s_add_u32 s66, s70, 0
    buffer_load_dwordx4 v4, s[8:11], s66 offen lds
    s_add_u32 m0, s72, 2048
    s_add_u32 s66, s70, 32768
    buffer_load_dwordx4 v4, s[8:11], s66 offen lds
    s_add_u32 m0, s72, 4096
    s_add_u32 s66, s70, 65536
    buffer_load_dwordx4 v4, s[8:11], s66 offen lds
    s_add_u32 m0, s72, 6144
    s_add_u32 s66, s70, 98304
    buffer_load_dwordx4 v4, s[8:11], s66 offen lds
    s_add_u32 m0, s72, 8192
    s_add_u32 s66, s70, 131072
    buffer_load_dwordx4 v4, s[8:11], s66 offen lds
    s_add_u32 m0, s72, 10240
    s_add_u32 s66, s70, 163840
    buffer_load_dwordx4 v4, s[8:11], s66 offen lds
    s_add_u32 m0, s72, 12288
    s_add_u32 s66, s70, 196608
    buffer_load_dwordx4 v4, s[8:11], s66 offen lds
    s_add_u32 m0, s72, 14336
    s_add_u32 s66, s70, 229376
    buffer_load_dwordx4 v4, s[8:11], s66 offen lds
    s_add_u32 m0, s72, 32768
    s_add_u32 s66, s71, 4096
    buffer_load_dwordx4 v5, s[12:15], s66 offen lds
    s_add_u32 m0, s72, 34816
    s_add_u32 s66, s71, 102400
    buffer_load_dwordx4 v5, s[12:15], s66 offen lds
    s_add_u32 m0, s72, 36864
    s_add_u32 s66, s71, 200704
    buffer_load_dwordx4 v5, s[12:15], s66 offen lds
    s_add_u32 m0, s72, 38912
    s_add_u32 s66, s71, 299008
    buffer_load_dwordx4 v5, s[12:15], s66 offen lds
    s_add_u32 m0, s72, 16384
    s_add_u32 s66, s71, 0
    buffer_load_dwordx4 v5, s[12:15], s66 offen lds
    s_add_u32 m0, s72, 18432
    s_add_u32 s66, s71, 98304
    buffer_load_dwordx4 v5, s[12:15], s66 offen lds
    s_add_u32 m0, s72, 20480
    s_add_u32 s66, s71, 196608
    buffer_load_dwordx4 v5, s[12:15], s66 offen lds
    s_add_u32 m0, s72, 22528
    s_add_u32 s66, s71, 294912
    buffer_load_dwordx4 v5, s[12:15], s66 offen lds
    s_waitcnt vmcnt(20)
    s_barrier
    s_cmp_le_u32 s77, 7
    s_addc_u32 s71, s76, 7
    s_and_b32 s71, s71, 15
    s_lshl_b32 s70, s71, 7
    s_mul_i32 s71, s71, 393216
    s_add_u32 m0, s72, 65536
    s_add_u32 s66, s71, 2048
    buffer_load_dwordx4 v5, s[12:15], s66 offen lds
    s_add_u32 m0, s72, 67584
    s_add_u32 s66, s71, 100352
    buffer_load_dwordx4 v5, s[12:15], s66 offen lds
    s_add_u32 m0, s72, 69632
    s_add_u32 s66, s71, 198656
    buffer_load_dwordx4 v5, s[12:15], s66 offen lds
    s_add_u32 m0, s72, 71680
    s_add_u32 s66, s71, 296960
    buffer_load_dwordx4 v5, s[12:15], s66 offen lds
    s_add_u32 m0, s72, 40960
    s_add_u32 s66, s70, 0
    buffer_load_dwordx4 v4, s[8:11], s66 offen lds
    s_add_u32 m0, s72, 43008
    s_add_u32 s66, s70, 32768
    buffer_load_dwordx4 v4, s[8:11], s66 offen lds
    s_add_u32 m0, s72, 45056
    s_add_u32 s66, s70, 65536
    buffer_load_dwordx4 v4, s[8:11], s66 offen lds
    s_add_u32 m0, s72, 47104
    s_add_u32 s66, s70, 98304
    buffer_load_dwordx4 v4, s[8:11], s66 offen lds
    s_add_u32 m0, s72, 49152
    s_add_u32 s66, s70, 131072
    buffer_load_dwordx4 v4, s[8:11], s66 offen lds
    s_add_u32 m0, s72, 51200
    s_add_u32 s66, s70, 163840
    buffer_load_dwordx4 v4, s[8:11], s66 offen lds
    s_add_u32 m0, s72, 53248
    s_add_u32 s66, s70, 196608
    buffer_load_dwordx4 v4, s[8:11], s66 offen lds
    s_add_u32 m0, s72, 55296
    s_add_u32 s66, s70, 229376
    buffer_load_dwordx4 v4, s[8:11], s66 offen lds
    s_add_u32 m0, s72, 73728
    s_add_u32 s66, s71, 4096
    buffer_load_dwordx4 v5, s[12:15], s66 offen lds
    s_add_u32 m0, s72, 75776
    s_add_u32 s66, s71, 102400
    buffer_load_dwordx4 v5, s[12:15], s66 offen lds
    s_add_u32 m0, s72, 77824
    s_add_u32 s66, s71, 200704
    buffer_load_dwordx4 v5, s[12:15], s66 offen lds
    s_add_u32 m0, s72, 79872
    s_add_u32 s66, s71, 299008
    buffer_load_dwordx4 v5, s[12:15], s66 offen lds
    s_add_u32 m0, s72, 57344
    s_add_u32 s66, s71, 0
    buffer_load_dwordx4 v5, s[12:15], s66 offen lds
    s_add_u32 m0, s72, 59392
    s_add_u32 s66, s71, 98304
    buffer_load_dwordx4 v5, s[12:15], s66 offen lds
    s_add_u32 m0, s72, 61440
    s_add_u32 s66, s71, 196608
    buffer_load_dwordx4 v5, s[12:15], s66 offen lds
    s_add_u32 m0, s72, 63488
    s_add_u32 s66, s71, 294912
    buffer_load_dwordx4 v5, s[12:15], s66 offen lds
    s_waitcnt vmcnt(20)
    s_barrier
    s_cmp_le_u32 s77, 8
    s_addc_u32 s71, s76, 8
    s_and_b32 s71, s71, 15
    s_lshl_b32 s70, s71, 7
    s_mul_i32 s71, s71, 393216
    s_add_u32 m0, s72, 106496
    s_add_u32 s66, s71, 2048
    buffer_load_dwordx4 v5, s[12:15], s66 offen lds
    s_add_u32 m0, s72, 108544
    s_add_u32 s66, s71, 100352
    buffer_load_dwordx4 v5, s[12:15], s66 offen lds
    s_add_u32 m0, s72, 110592
    s_add_u32 s66, s71, 198656
    buffer_load_dwordx4 v5, s[12:15], s66 offen lds
    s_add_u32 m0, s72, 112640
    s_add_u32 s66, s71, 296960
    buffer_load_dwordx4 v5, s[12:15], s66 offen lds
    s_add_u32 m0, s72, 81920
    s_add_u32 s66, s70, 0
    buffer_load_dwordx4 v4, s[8:11], s66 offen lds
    s_add_u32 m0, s72, 83968
    s_add_u32 s66, s70, 32768
    buffer_load_dwordx4 v4, s[8:11], s66 offen lds
    s_add_u32 m0, s72, 86016
    s_add_u32 s66, s70, 65536
    buffer_load_dwordx4 v4, s[8:11], s66 offen lds
    s_add_u32 m0, s72, 88064
    s_add_u32 s66, s70, 98304
    buffer_load_dwordx4 v4, s[8:11], s66 offen lds
    s_add_u32 m0, s72, 90112
    s_add_u32 s66, s70, 131072
    buffer_load_dwordx4 v4, s[8:11], s66 offen lds
    s_add_u32 m0, s72, 92160
    s_add_u32 s66, s70, 163840
    buffer_load_dwordx4 v4, s[8:11], s66 offen lds
    s_add_u32 m0, s72, 94208
    s_add_u32 s66, s70, 196608
    buffer_load_dwordx4 v4, s[8:11], s66 offen lds
    s_add_u32 m0, s72, 96256
    s_add_u32 s66, s70, 229376
    buffer_load_dwordx4 v4, s[8:11], s66 offen lds
    s_add_u32 m0, s72, 114688
    s_add_u32 s66, s71, 4096
    buffer_load_dwordx4 v5, s[12:15], s66 offen lds
    s_add_u32 m0, s72, 116736
    s_add_u32 s66, s71, 102400
    buffer_load_dwordx4 v5, s[12:15], s66 offen lds
    s_add_u32 m0, s72, 118784
    s_add_u32 s66, s71, 200704
    buffer_load_dwordx4 v5, s[12:15], s66 offen lds
    s_add_u32 m0, s72, 120832
    s_add_u32 s66, s71, 299008
    buffer_load_dwordx4 v5, s[12:15], s66 offen lds
    s_add_u32 m0, s72, 98304
    s_add_u32 s66, s71, 0
    buffer_load_dwordx4 v5, s[12:15], s66 offen lds
    s_add_u32 m0, s72, 100352
    s_add_u32 s66, s71, 98304
    buffer_load_dwordx4 v5, s[12:15], s66 offen lds
    s_add_u32 m0, s72, 102400
    s_add_u32 s66, s71, 196608
    buffer_load_dwordx4 v5, s[12:15], s66 offen lds
    s_add_u32 m0, s72, 104448
    s_add_u32 s66, s71, 294912
    buffer_load_dwordx4 v5, s[12:15], s66 offen lds
    s_waitcnt vmcnt(20)
    s_barrier
    s_cmp_le_u32 s77, 9
    s_addc_u32 s71, s76, 9
    s_and_b32 s71, s71, 15
    s_lshl_b32 s70, s71, 7
    s_mul_i32 s71, s71, 393216
    s_add_u32 m0, s72, 24576
    s_add_u32 s66, s71, 2048
    buffer_load_dwordx4 v5, s[12:15], s66 offen lds
    s_add_u32 m0, s72, 26624
    s_add_u32 s66, s71, 100352
    buffer_load_dwordx4 v5, s[12:15], s66 offen lds
    s_add_u32 m0, s72, 28672
    s_add_u32 s66, s71, 198656
    buffer_load_dwordx4 v5, s[12:15], s66 offen lds
    s_add_u32 m0, s72, 30720
    s_add_u32 s66, s71, 296960
    buffer_load_dwordx4 v5, s[12:15], s66 offen lds
    s_add_u32 m0, s72, 0
    s_add_u32 s66, s70, 0
    buffer_load_dwordx4 v4, s[8:11], s66 offen lds
    s_add_u32 m0, s72, 2048
    s_add_u32 s66, s70, 32768
    buffer_load_dwordx4 v4, s[8:11], s66 offen lds
    s_add_u32 m0, s72, 4096
    s_add_u32 s66, s70, 65536
    buffer_load_dwordx4 v4, s[8:11], s66 offen lds
    s_add_u32 m0, s72, 6144
    s_add_u32 s66, s70, 98304
    buffer_load_dwordx4 v4, s[8:11], s66 offen lds
    s_add_u32 m0, s72, 8192
    s_add_u32 s66, s70, 131072
    buffer_load_dwordx4 v4, s[8:11], s66 offen lds
    s_add_u32 m0, s72, 10240
    s_add_u32 s66, s70, 163840
    buffer_load_dwordx4 v4, s[8:11], s66 offen lds
    s_add_u32 m0, s72, 12288
    s_add_u32 s66, s70, 196608
    buffer_load_dwordx4 v4, s[8:11], s66 offen lds
    s_add_u32 m0, s72, 14336
    s_add_u32 s66, s70, 229376
    buffer_load_dwordx4 v4, s[8:11], s66 offen lds
    s_add_u32 m0, s72, 32768
    s_add_u32 s66, s71, 4096
    buffer_load_dwordx4 v5, s[12:15], s66 offen lds
    s_add_u32 m0, s72, 34816
    s_add_u32 s66, s71, 102400
    buffer_load_dwordx4 v5, s[12:15], s66 offen lds
    s_add_u32 m0, s72, 36864
    s_add_u32 s66, s71, 200704
    buffer_load_dwordx4 v5, s[12:15], s66 offen lds
    s_add_u32 m0, s72, 38912
    s_add_u32 s66, s71, 299008
    buffer_load_dwordx4 v5, s[12:15], s66 offen lds
    s_add_u32 m0, s72, 16384
    s_add_u32 s66, s71, 0
    buffer_load_dwordx4 v5, s[12:15], s66 offen lds
    s_add_u32 m0, s72, 18432
    s_add_u32 s66, s71, 98304
    buffer_load_dwordx4 v5, s[12:15], s66 offen lds
    s_add_u32 m0, s72, 20480
    s_add_u32 s66, s71, 196608
    buffer_load_dwordx4 v5, s[12:15], s66 offen lds
    s_add_u32 m0, s72, 22528
    s_add_u32 s66, s71, 294912
    buffer_load_dwordx4 v5, s[12:15], s66 offen lds
    s_waitcnt vmcnt(20)
    s_barrier
    s_cmp_le_u32 s77, 10
    s_addc_u32 s71, s76, 10
    s_and_b32 s71, s71, 15
    s_lshl_b32 s70, s71, 7
    s_mul_i32 s71, s71, 393216
    s_add_u32 m0, s72, 65536
    s_add_u32 s66, s71, 2048
    buffer_load_dwordx4 v5, s[12:15], s66 offen lds
    s_add_u32 m0, s72, 67584
    s_add_u32 s66, s71, 100352
    buffer_load_dwordx4 v5, s[12:15], s66 offen lds
    s_add_u32 m0, s72, 69632
    s_add_u32 s66, s71, 198656
    buffer_load_dwordx4 v5, s[12:15], s66 offen lds
    s_add_u32 m0, s72, 71680
    s_add_u32 s66, s71, 296960
    buffer_load_dwordx4 v5, s[12:15], s66 offen lds
    s_add_u32 m0, s72, 40960
    s_add_u32 s66, s70, 0
    buffer_load_dwordx4 v4, s[8:11], s66 offen lds
    s_add_u32 m0, s72, 43008
    s_add_u32 s66, s70, 32768
    buffer_load_dwordx4 v4, s[8:11], s66 offen lds
    s_add_u32 m0, s72, 45056
    s_add_u32 s66, s70, 65536
    buffer_load_dwordx4 v4, s[8:11], s66 offen lds
    s_add_u32 m0, s72, 47104
    s_add_u32 s66, s70, 98304
    buffer_load_dwordx4 v4, s[8:11], s66 offen lds
    s_add_u32 m0, s72, 49152
    s_add_u32 s66, s70, 131072
    buffer_load_dwordx4 v4, s[8:11], s66 offen lds
    s_add_u32 m0, s72, 51200
    s_add_u32 s66, s70, 163840
    buffer_load_dwordx4 v4, s[8:11], s66 offen lds
    s_add_u32 m0, s72, 53248
    s_add_u32 s66, s70, 196608
    buffer_load_dwordx4 v4, s[8:11], s66 offen lds
    s_add_u32 m0, s72, 55296
    s_add_u32 s66, s70, 229376
    buffer_load_dwordx4 v4, s[8:11], s66 offen lds
    s_add_u32 m0, s72, 73728
    s_add_u32 s66, s71, 4096
    buffer_load_dwordx4 v5, s[12:15], s66 offen lds
    s_add_u32 m0, s72, 75776
    s_add_u32 s66, s71, 102400
    buffer_load_dwordx4 v5, s[12:15], s66 offen lds
    s_add_u32 m0, s72, 77824
    s_add_u32 s66, s71, 200704
    buffer_load_dwordx4 v5, s[12:15], s66 offen lds
    s_add_u32 m0, s72, 79872
    s_add_u32 s66, s71, 299008
    buffer_load_dwordx4 v5, s[12:15], s66 offen lds
    s_add_u32 m0, s72, 57344
    s_add_u32 s66, s71, 0
    buffer_load_dwordx4 v5, s[12:15], s66 offen lds
    s_add_u32 m0, s72, 59392
    s_add_u32 s66, s71, 98304
    buffer_load_dwordx4 v5, s[12:15], s66 offen lds
    s_add_u32 m0, s72, 61440
    s_add_u32 s66, s71, 196608
    buffer_load_dwordx4 v5, s[12:15], s66 offen lds
    s_add_u32 m0, s72, 63488
    s_add_u32 s66, s71, 294912
    buffer_load_dwordx4 v5, s[12:15], s66 offen lds
    s_waitcnt vmcnt(20)
    s_barrier
    s_cmp_le_u32 s77, 11
    s_addc_u32 s71, s76, 11
    s_and_b32 s71, s71, 15
    s_lshl_b32 s70, s71, 7
    s_mul_i32 s71, s71, 393216
    s_add_u32 m0, s72, 106496
    s_add_u32 s66, s71, 2048
    buffer_load_dwordx4 v5, s[12:15], s66 offen lds
    s_add_u32 m0, s72, 108544
    s_add_u32 s66, s71, 100352
    buffer_load_dwordx4 v5, s[12:15], s66 offen lds
    s_add_u32 m0, s72, 110592
    s_add_u32 s66, s71, 198656
    buffer_load_dwordx4 v5, s[12:15], s66 offen lds
    s_add_u32 m0, s72, 112640
    s_add_u32 s66, s71, 296960
    buffer_load_dwordx4 v5, s[12:15], s66 offen lds
    s_add_u32 m0, s72, 81920
    s_add_u32 s66, s70, 0
    buffer_load_dwordx4 v4, s[8:11], s66 offen lds
    s_add_u32 m0, s72, 83968
    s_add_u32 s66, s70, 32768
    buffer_load_dwordx4 v4, s[8:11], s66 offen lds
    s_add_u32 m0, s72, 86016
    s_add_u32 s66, s70, 65536
    buffer_load_dwordx4 v4, s[8:11], s66 offen lds
    s_add_u32 m0, s72, 88064
    s_add_u32 s66, s70, 98304
    buffer_load_dwordx4 v4, s[8:11], s66 offen lds
    s_add_u32 m0, s72, 90112
    s_add_u32 s66, s70, 131072
    buffer_load_dwordx4 v4, s[8:11], s66 offen lds
    s_add_u32 m0, s72, 92160
    s_add_u32 s66, s70, 163840
    buffer_load_dwordx4 v4, s[8:11], s66 offen lds
    s_add_u32 m0, s72, 94208
    s_add_u32 s66, s70, 196608
    buffer_load_dwordx4 v4, s[8:11], s66 offen lds
    s_add_u32 m0, s72, 96256
    s_add_u32 s66, s70, 229376
    buffer_load_dwordx4 v4, s[8:11], s66 offen lds
    s_add_u32 m0, s72, 114688
    s_add_u32 s66, s71, 4096
    buffer_load_dwordx4 v5, s[12:15], s66 offen lds
    s_add_u32 m0, s72, 116736
    s_add_u32 s66, s71, 102400
    buffer_load_dwordx4 v5, s[12:15], s66 offen lds
    s_add_u32 m0, s72, 118784
    s_add_u32 s66, s71, 200704
    buffer_load_dwordx4 v5, s[12:15], s66 offen lds
    s_add_u32 m0, s72, 120832
    s_add_u32 s66, s71, 299008
    buffer_load_dwordx4 v5, s[12:15], s66 offen lds
    s_add_u32 m0, s72, 98304
    s_add_u32 s66, s71, 0
    buffer_load_dwordx4 v5, s[12:15], s66 offen lds
    s_add_u32 m0, s72, 100352
    s_add_u32 s66, s71, 98304
    buffer_load_dwordx4 v5, s[12:15], s66 offen lds
    s_add_u32 m0, s72, 102400
    s_add_u32 s66, s71, 196608
    buffer_load_dwordx4 v5, s[12:15], s66 offen lds
    s_add_u32 m0, s72, 104448
    s_add_u32 s66, s71, 294912
    buffer_load_dwordx4 v5, s[12:15], s66 offen lds
    s_waitcnt vmcnt(20)
    s_barrier
    s_cmp_le_u32 s77, 12
    s_addc_u32 s71, s76, 12
    s_and_b32 s71, s71, 15
    s_lshl_b32 s70, s71, 7
    s_mul_i32 s71, s71, 393216
    s_add_u32 m0, s72, 24576
    s_add_u32 s66, s71, 2048
    buffer_load_dwordx4 v5, s[12:15], s66 offen lds
    s_add_u32 m0, s72, 26624
    s_add_u32 s66, s71, 100352
    buffer_load_dwordx4 v5, s[12:15], s66 offen lds
    s_add_u32 m0, s72, 28672
    s_add_u32 s66, s71, 198656
    buffer_load_dwordx4 v5, s[12:15], s66 offen lds
    s_add_u32 m0, s72, 30720
    s_add_u32 s66, s71, 296960
    buffer_load_dwordx4 v5, s[12:15], s66 offen lds
    s_add_u32 m0, s72, 0
    s_add_u32 s66, s70, 0
    buffer_load_dwordx4 v4, s[8:11], s66 offen lds
    s_add_u32 m0, s72, 2048
    s_add_u32 s66, s70, 32768
    buffer_load_dwordx4 v4, s[8:11], s66 offen lds
    s_add_u32 m0, s72, 4096
    s_add_u32 s66, s70, 65536
    buffer_load_dwordx4 v4, s[8:11], s66 offen lds
    s_add_u32 m0, s72, 6144
    s_add_u32 s66, s70, 98304
    buffer_load_dwordx4 v4, s[8:11], s66 offen lds
    s_add_u32 m0, s72, 8192
    s_add_u32 s66, s70, 131072
    buffer_load_dwordx4 v4, s[8:11], s66 offen lds
    s_add_u32 m0, s72, 10240
    s_add_u32 s66, s70, 163840
    buffer_load_dwordx4 v4, s[8:11], s66 offen lds
    s_add_u32 m0, s72, 12288
    s_add_u32 s66, s70, 196608
    buffer_load_dwordx4 v4, s[8:11], s66 offen lds
    s_add_u32 m0, s72, 14336
    s_add_u32 s66, s70, 229376
    buffer_load_dwordx4 v4, s[8:11], s66 offen lds
    s_add_u32 m0, s72, 32768
    s_add_u32 s66, s71, 4096
    buffer_load_dwordx4 v5, s[12:15], s66 offen lds
    s_add_u32 m0, s72, 34816
    s_add_u32 s66, s71, 102400
    buffer_load_dwordx4 v5, s[12:15], s66 offen lds
    s_add_u32 m0, s72, 36864
    s_add_u32 s66, s71, 200704
    buffer_load_dwordx4 v5, s[12:15], s66 offen lds
    s_add_u32 m0, s72, 38912
    s_add_u32 s66, s71, 299008
    buffer_load_dwordx4 v5, s[12:15], s66 offen lds
    s_add_u32 m0, s72, 16384
    s_add_u32 s66, s71, 0
    buffer_load_dwordx4 v5, s[12:15], s66 offen lds
    s_add_u32 m0, s72, 18432
    s_add_u32 s66, s71, 98304
    buffer_load_dwordx4 v5, s[12:15], s66 offen lds
    s_add_u32 m0, s72, 20480
    s_add_u32 s66, s71, 196608
    buffer_load_dwordx4 v5, s[12:15], s66 offen lds
    s_add_u32 m0, s72, 22528
    s_add_u32 s66, s71, 294912
    buffer_load_dwordx4 v5, s[12:15], s66 offen lds
    s_waitcnt vmcnt(20)
    s_barrier
    s_cmp_le_u32 s77, 13
    s_addc_u32 s71, s76, 13
    s_and_b32 s71, s71, 15
    s_lshl_b32 s70, s71, 7
    s_mul_i32 s71, s71, 393216
    s_add_u32 m0, s72, 65536
    s_add_u32 s66, s71, 2048
    buffer_load_dwordx4 v5, s[12:15], s66 offen lds
    s_add_u32 m0, s72, 67584
    s_add_u32 s66, s71, 100352
    buffer_load_dwordx4 v5, s[12:15], s66 offen lds
    s_add_u32 m0, s72, 69632
    s_add_u32 s66, s71, 198656
    buffer_load_dwordx4 v5, s[12:15], s66 offen lds
    s_add_u32 m0, s72, 71680
    s_add_u32 s66, s71, 296960
    buffer_load_dwordx4 v5, s[12:15], s66 offen lds
    s_add_u32 m0, s72, 40960
    s_add_u32 s66, s70, 0
    buffer_load_dwordx4 v4, s[8:11], s66 offen lds
    s_add_u32 m0, s72, 43008
    s_add_u32 s66, s70, 32768
    buffer_load_dwordx4 v4, s[8:11], s66 offen lds
    s_add_u32 m0, s72, 45056
    s_add_u32 s66, s70, 65536
    buffer_load_dwordx4 v4, s[8:11], s66 offen lds
    s_add_u32 m0, s72, 47104
    s_add_u32 s66, s70, 98304
    buffer_load_dwordx4 v4, s[8:11], s66 offen lds
    s_add_u32 m0, s72, 49152
    s_add_u32 s66, s70, 131072
    buffer_load_dwordx4 v4, s[8:11], s66 offen lds
    s_add_u32 m0, s72, 51200
    s_add_u32 s66, s70, 163840
    buffer_load_dwordx4 v4, s[8:11], s66 offen lds
    s_add_u32 m0, s72, 53248
    s_add_u32 s66, s70, 196608
    buffer_load_dwordx4 v4, s[8:11], s66 offen lds
    s_add_u32 m0, s72, 55296
    s_add_u32 s66, s70, 229376
    buffer_load_dwordx4 v4, s[8:11], s66 offen lds
    s_add_u32 m0, s72, 73728
    s_add_u32 s66, s71, 4096
    buffer_load_dwordx4 v5, s[12:15], s66 offen lds
    s_add_u32 m0, s72, 75776
    s_add_u32 s66, s71, 102400
    buffer_load_dwordx4 v5, s[12:15], s66 offen lds
    s_add_u32 m0, s72, 77824
    s_add_u32 s66, s71, 200704
    buffer_load_dwordx4 v5, s[12:15], s66 offen lds
    s_add_u32 m0, s72, 79872
    s_add_u32 s66, s71, 299008
    buffer_load_dwordx4 v5, s[12:15], s66 offen lds
    s_add_u32 m0, s72, 57344
    s_add_u32 s66, s71, 0
    buffer_load_dwordx4 v5, s[12:15], s66 offen lds
    s_add_u32 m0, s72, 59392
    s_add_u32 s66, s71, 98304
    buffer_load_dwordx4 v5, s[12:15], s66 offen lds
    s_add_u32 m0, s72, 61440
    s_add_u32 s66, s71, 196608
    buffer_load_dwordx4 v5, s[12:15], s66 offen lds
    s_add_u32 m0, s72, 63488
    s_add_u32 s66, s71, 294912
    buffer_load_dwordx4 v5, s[12:15], s66 offen lds
    s_waitcnt vmcnt(20)
    s_barrier
    s_cmp_le_u32 s77, 14
    s_addc_u32 s71, s76, 14
    s_and_b32 s71, s71, 15
    s_lshl_b32 s70, s71, 7
    s_mul_i32 s71, s71, 393216
    s_add_u32 m0, s72, 106496
    s_add_u32 s66, s71, 2048
    buffer_load_dwordx4 v5, s[12:15], s66 offen lds
    s_add_u32 m0, s72, 108544
    s_add_u32 s66, s71, 100352
    buffer_load_dwordx4 v5, s[12:15], s66 offen lds
    s_add_u32 m0, s72, 110592
    s_add_u32 s66, s71, 198656
    buffer_load_dwordx4 v5, s[12:15], s66 offen lds
    s_add_u32 m0, s72, 112640
    s_add_u32 s66, s71, 296960
    buffer_load_dwordx4 v5, s[12:15], s66 offen lds
    s_add_u32 m0, s72, 81920
    s_add_u32 s66, s70, 0
    buffer_load_dwordx4 v4, s[8:11], s66 offen lds
    s_add_u32 m0, s72, 83968
    s_add_u32 s66, s70, 32768
    buffer_load_dwordx4 v4, s[8:11], s66 offen lds
    s_add_u32 m0, s72, 86016
    s_add_u32 s66, s70, 65536
    buffer_load_dwordx4 v4, s[8:11], s66 offen lds
    s_add_u32 m0, s72, 88064
    s_add_u32 s66, s70, 98304
    buffer_load_dwordx4 v4, s[8:11], s66 offen lds
    s_add_u32 m0, s72, 90112
    s_add_u32 s66, s70, 131072
    buffer_load_dwordx4 v4, s[8:11], s66 offen lds
    s_add_u32 m0, s72, 92160
    s_add_u32 s66, s70, 163840
    buffer_load_dwordx4 v4, s[8:11], s66 offen lds
    s_add_u32 m0, s72, 94208
    s_add_u32 s66, s70, 196608
    buffer_load_dwordx4 v4, s[8:11], s66 offen lds
    s_add_u32 m0, s72, 96256
    s_add_u32 s66, s70, 229376
    buffer_load_dwordx4 v4, s[8:11], s66 offen lds
    s_add_u32 m0, s72, 114688
    s_add_u32 s66, s71, 4096
    buffer_load_dwordx4 v5, s[12:15], s66 offen lds
    s_add_u32 m0, s72, 116736
    s_add_u32 s66, s71, 102400
    buffer_load_dwordx4 v5, s[12:15], s66 offen lds
    s_add_u32 m0, s72, 118784
    s_add_u32 s66, s71, 200704
    buffer_load_dwordx4 v5, s[12:15], s66 offen lds
    s_add_u32 m0, s72, 120832
    s_add_u32 s66, s71, 299008
    buffer_load_dwordx4 v5, s[12:15], s66 offen lds
    s_add_u32 m0, s72, 98304
    s_add_u32 s66, s71, 0
    buffer_load_dwordx4 v5, s[12:15], s66 offen lds
    s_add_u32 m0, s72, 100352
    s_add_u32 s66, s71, 98304
    buffer_load_dwordx4 v5, s[12:15], s66 offen lds
    s_add_u32 m0, s72, 102400
    s_add_u32 s66, s71, 196608
    buffer_load_dwordx4 v5, s[12:15], s66 offen lds
    s_add_u32 m0, s72, 104448
    s_add_u32 s66, s71, 294912
    buffer_load_dwordx4 v5, s[12:15], s66 offen lds
    s_mov_b32 s71, s5
    s_lshl_b32 s70, s71, 7
    s_mul_i32 s71, s71, 393216
    s_add_u32 m0, s72, 139264
    s_add_u32 s66, s71, 2048
    buffer_load_dwordx4 v5, s[12:15], s66 offen lds
    s_add_u32 m0, s72, 141312
    s_add_u32 s66, s71, 100352
    buffer_load_dwordx4 v5, s[12:15], s66 offen lds
    s_add_u32 m0, s72, 143360
    s_add_u32 s66, s71, 198656
    buffer_load_dwordx4 v5, s[12:15], s66 offen lds
    s_add_u32 m0, s72, 145408
    s_add_u32 s66, s71, 296960
    buffer_load_dwordx4 v5, s[12:15], s66 offen lds
    s_waitcnt vmcnt(24)
    s_barrier
    s_mov_b32 s71, s5
    s_lshl_b32 s70, s71, 7
    s_mul_i32 s71, s71, 393216
    s_add_u32 m0, s72, 122880
    s_add_u32 s66, s70, 0
    buffer_load_dwordx4 v4, s[8:11], s66 offen lds
    s_add_u32 m0, s72, 124928
    s_add_u32 s66, s70, 32768
    buffer_load_dwordx4 v4, s[8:11], s66 offen lds
    s_add_u32 m0, s72, 126976
    s_add_u32 s66, s70, 65536
    buffer_load_dwordx4 v4, s[8:11], s66 offen lds
    s_add_u32 m0, s72, 129024
    s_add_u32 s66, s70, 98304
    buffer_load_dwordx4 v4, s[8:11], s66 offen lds
    s_add_u32 m0, s72, 131072
    s_add_u32 s66, s70, 131072
    buffer_load_dwordx4 v4, s[8:11], s66 offen lds
    s_add_u32 m0, s72, 133120
    s_add_u32 s66, s70, 163840
    buffer_load_dwordx4 v4, s[8:11], s66 offen lds
    s_add_u32 m0, s72, 135168
    s_add_u32 s66, s70, 196608
    buffer_load_dwordx4 v4, s[8:11], s66 offen lds
    s_add_u32 m0, s72, 137216
    s_add_u32 s66, s70, 229376
    buffer_load_dwordx4 v4, s[8:11], s66 offen lds
    s_mov_b32 s71, s5
    s_lshl_b32 s70, s71, 7
    s_mul_i32 s71, s71, 393216
    s_add_u32 m0, s72, 147456
    s_add_u32 s66, s71, 4096
    buffer_load_dwordx4 v5, s[12:15], s66 offen lds
    s_add_u32 m0, s72, 149504
    s_add_u32 s66, s71, 102400
    buffer_load_dwordx4 v5, s[12:15], s66 offen lds
    s_add_u32 m0, s72, 151552
    s_add_u32 s66, s71, 200704
    buffer_load_dwordx4 v5, s[12:15], s66 offen lds
    s_add_u32 m0, s72, 153600
    s_add_u32 s66, s71, 299008
    buffer_load_dwordx4 v5, s[12:15], s66 offen lds
    s_add_u32 m0, s72, 16384
    s_add_u32 s66, s71, 0
    buffer_load_dwordx4 v5, s[12:15], s66 offen lds
    s_add_u32 m0, s72, 18432
    s_add_u32 s66, s71, 98304
    buffer_load_dwordx4 v5, s[12:15], s66 offen lds
    s_add_u32 m0, s72, 20480
    s_add_u32 s66, s71, 196608
    buffer_load_dwordx4 v5, s[12:15], s66 offen lds
    s_add_u32 m0, s72, 22528
    s_add_u32 s66, s71, 294912
    buffer_load_dwordx4 v5, s[12:15], s66 offen lds
    s_waitcnt vmcnt(20)
    s_barrier
    s_mov_b32 s66, 0
    buffer_load_dwordx4 v[96:99], v7, s[32:35], s66 offen
    s_mov_b32 s66, 2048
    buffer_load_dwordx4 v[100:103], v7, s[32:35], s66 offen
    s_mov_b32 s66, 4096
    buffer_load_dwordx4 v[104:107], v7, s[32:35], s66 offen
    s_mov_b32 s66, 6144
    buffer_load_dwordx4 v[108:111], v7, s[32:35], s66 offen
    s_mov_b32 s66, 8192
    buffer_load_dwordx4 v[112:115], v7, s[32:35], s66 offen
    s_mov_b32 s66, 10240
    buffer_load_dwordx4 v[116:119], v7, s[32:35], s66 offen
    s_mov_b32 s66, 12288
    buffer_load_dwordx4 v[120:123], v7, s[32:35], s66 offen
    s_mov_b32 s66, 14336
    buffer_load_dwordx4 v[124:127], v7, s[32:35], s66 offen
    s_waitcnt vmcnt(8)
    s_branch H_b14
WORK:
    v_mov_b32 v14, 0
    v_lshlrev_b32 v8, 5, v2
    v_add_u32 v8, 6127616, v8
    s_lshl_b32 s66, s2, 2
    s_add_u32 s66, s66, s44
    s_cmp_lg_u32 s66, 2
    s_cbranch_scc1 W_nn
    s_movk_i32 s66, 0
    buffer_load_dword v72, v8, s[16:19], s66 offen offset:4 sc1
    s_movk_i32 s66, 2048
    buffer_load_dword v73, v8, s[16:19], s66 offen offset:4 sc1
    s_movk_i32 s66, 4096
    buffer_load_dword v74, v8, s[16:19], s66 offen offset:4 sc1
    s_movk_i32 s66, 6144
    buffer_load_dword v75, v8, s[16:19], s66 offen offset:4 sc1
    s_waitcnt vmcnt(0)
    v_readfirstlane_b32 s66, v72
    s_or_b32 s66, s66, 1
W_nl:
    s_add_u32 s66, s66, 2
    v_cmp_eq_u32 vcc, s66, v72
    v_cmp_eq_u32 s[68:69], s66, v73
    s_or_b64 vcc, vcc, s[68:69]
    v_cmp_eq_u32 s[68:69], s66, v74
    s_or_b64 vcc, vcc, s[68:69]
    v_cmp_eq_u32 s[68:69], s66, v75
    s_or_b64 vcc, vcc, s[68:69]
    s_cmp_lg_u64 vcc, 0
    s_cbranch_scc1 W_nl
    v_mov_b32 v10, 0
    v_mov_b32 v11, s66
    s_mov_b64 exec, 1
    buffer_store_dword v11, v10, s[40:43], 0 offen sc0 sc1
    s_mov_b64 exec, -1
W_nn:
    s_and_b32 s48, s44, 1
    s_waitcnt vmcnt(5)
    s_barrier
    s_waitcnt vmcnt(0)
    s_barrier
    s_lshl_b32 s50, s4, 7
    s_lshl_b32 s66, s5, 3
    s_add_u32 s50, s50, s66
    s_lshl_b32 s66, s48, 2
    s_add_u32 s50, s50, s66
    s_lshl_b32 s66, s50, 11
    s_add_u32 s67, s66, 4096
    buffer_load_dwordx4 v[16:19], v9, s[8:11], s66 offen offset:0
    buffer_load_dwordx4 v[20:23], v9, s[8:11], s66 offen offset:1024
    buffer_load_dwordx4 v[24:27], v9, s[8:11], s66 offen offset:2048
    buffer_load_dwordx4 v[28:31], v9, s[8:11], s66 offen offset:3072
    buffer_load_dwordx4 v[32:35], v9, s[8:11], s67 offen offset:0
    buffer_load_dwordx4 v[36:39], v9, s[8:11], s67 offen offset:1024
    buffer_load_dwordx4 v[40:43], v9, s[8:11], s67 offen offset:2048
    buffer_load_dwordx4 v[44:47], v9, s[8:11], s67 offen offset:3072
    s_lshl_b32 s66, s48, 11
    s_add_u32 m0, s66, 159744
    s_nop 0
    buffer_load_dwordx4 v9, s[24:27], 0 offen offset:0 lds
    buffer_load_dwordx4 v9, s[24:27], 0 offen offset:1024 lds
    s_lshl_b32 s66, s79, 2
    s_add_u32 s66, s66, s73
    s_and_b32 s51, s66, 15
    s_lshr_b32 s67, s66, 4
    s_lshl_b32 s54, s67, 5
    s_lshl_b32 s66, s48, 4
    s_add_u32 s54, s54, s66
    s_add_u32 s54, s54, s51
    s_lshl_b32 s54, s54, 10
    s_add_u32 s54, s54, 5308416
    s_lshl_b32 s51, s51, 6
    v_lshrrev_b32 v10, 5, v2
    v_and_b32 v11, 31, v2
    v_lshlrev_b32 v12, 5, v10
    v_add_u32 v12, s51, v12
    v_mul_u32_u24 v12, 7168, v12
    v_lshl_add_u32 v12, v11, 4, v12
    s_lshl_b32 s67, s67, 9
    v_add_u32 v6, s67, v12
    v_mov_b32 v72, -1
    v_mov_b32 v73, -1
    v_mov_b32 v74, -1
    v_mov_b32 v75, -1
    v_and_b32 v12, 3, v2
    v_lshlrev_b32 v12, 4, v12
    v_add_u32 v12, s53, v12
    s_add_u32 s66, s53, 4294965248
    v_subrev_u32 v13, 4, v2
    v_cmp_gt_u32 vcc, 4, v13
    v_lshlrev_b32 v13, 4, v13
    v_add_u32 v13, s66, v13
    v_cndmask_b32 v12, v12, v13, vcc
    s_add_u32 s66, s55, 0
    v_subrev_u32 v13, 24, v2
    v_cmp_gt_u32 vcc, 16, v13
    v_lshlrev_b32 v13, 4, v13
    v_add_u32 v13, s66, v13
    v_cndmask_b32 v12, v12, v13, vcc
    s_add_u32 s66, s55, 4294934528
    v_subrev_u32 v13, 40, v2
    v_cmp_gt_u32 vcc, 16, v13
    v_lshlrev_b32 v13, 4, v13
    v_add_u32 v13, s66, v13
    v_cndmask_b32 v12, v12, v13, vcc
    s_sub_u32 s66, s56, 32768
    buffer_store_dwordx4 v[72:75], v9, s[16:19], s56 offen sc0 sc1
    buffer_store_dwordx4 v[72:75], v9, s[16:19], s66 offen sc0 sc1
    buffer_store_dwordx4 v[72:75], v9, s[16:19], s54 offen sc0 sc1
    buffer_store_dwordx4 v[72:75], v12, s[16:19], 0 offen sc0 sc1
    s_waitcnt vmcnt(4)
    s_barrier
    s_cmp_lg_u32 s48, 0
    s_cbranch_scc1 W_k1
    buffer_load_dword v15, v14, s[40:43], 0 offen sc1
W_k1:
    v_add_u32 v10, 159744, v9
    v_bfe_u32 v3, v2, 4, 1
    v_lshrrev_b32 v11, 5, v2
    v_lshl_add_u32 v3, v3, 1, v11
    s_mov_b32 s67, 0xffff0000
    s_mov_b32 s68, 0x00010001
    s_mov_b32 s69, 0x00010001
    ds_read_b128 v[48:51], v10 offset:0
    ds_read_b128 v[52:55], v10 offset:1024
    v_mov_b32 v72, 0
    v_mov_b32 v73, 0
    v_mov_b32 v74, 0
    v_mov_b32 v75, 0
    s_waitcnt lgkmcnt(0)
    v_dot2_f32_bf16 v72, v16, v48, v72
    v_dot2_f32_bf16 v73, v24, v48, v73
    v_dot2_f32_bf16 v74, v32, v48, v74
    v_dot2_f32_bf16 v75, v40, v48, v75
    v_dot2_f32_bf16 v72, v17, v49, v72
    v_dot2_f32_bf16 v73, v25, v49, v73
    v_dot2_f32_bf16 v74, v33, v49, v74
    v_dot2_f32_bf16 v75, v41, v49, v75
    v_dot2_f32_bf16 v72, v18, v50, v72
    v_dot2_f32_bf16 v73, v26, v50, v73
    v_dot2_f32_bf16 v74, v34, v50, v74
    v_dot2_f32_bf16 v75, v42, v50, v75
    v_dot2_f32_bf16 v72, v19, v51, v72
    v_dot2_f32_bf16 v73, v27, v51, v73
    v_dot2_f32_bf16 v74, v35, v51, v74
    v_dot2_f32_bf16 v75, v43, v51, v75
    v_dot2_f32_bf16 v72, v20, v52, v72
    v_dot2_f32_bf16 v73, v28, v52, v73
    v_dot2_f32_bf16 v74, v36, v52, v74
    v_dot2_f32_bf16 v75, v44, v52, v75
    v_dot2_f32_bf16 v72, v21, v53, v72
    v_dot2_f32_bf16 v73, v29, v53, v73
    v_dot2_f32_bf16 v74, v37, v53, v74
    v_dot2_f32_bf16 v75, v45, v53, v75
    v_dot2_f32_bf16 v72, v22, v54, v72
    v_dot2_f32_bf16 v73, v30, v54, v73
    v_dot2_f32_bf16 v74, v38, v54, v74
    v_dot2_f32_bf16 v75, v46, v54, v75
    v_dot2_f32_bf16 v72, v23, v55, v72
    v_dot2_f32_bf16 v73, v31, v55, v73
    v_dot2_f32_bf16 v74, v39, v55, v74
    v_dot2_f32_bf16 v75, v47, v55, v75
    s_nop 2
    ds_read_b128 v[48:51], v10 offset:2048
    ds_read_b128 v[52:55], v10 offset:3072
    s_nop 1
    v_permlane32_swap_b32 v72, v73
    v_permlane32_swap_b32 v74, v75
    v_add_f32 v72, v72, v73
    v_add_f32 v74, v74, v75
    s_nop 1
    v_permlane16_swap_b32 v72, v74
    v_add_f32 v72, v72, v74
    s_nop 1
    v_add_f32_dpp v72, v72, v72 quad_perm:[1,0,3,2] row_mask:0xf bank_mask:0xf
    s_nop 1
    v_add_f32_dpp v72, v72, v72 quad_perm:[2,3,0,1] row_mask:0xf bank_mask:0xf
    s_nop 1
    v_add_f32_dpp v72, v72, v72 row_half_mirror row_mask:0xf bank_mask:0xf
    s_nop 1
    v_add_f32_dpp v72, v72, v72 row_mirror row_mask:0xf bank_mask:0xf
    s_sub_u32 s66, 34815, s50
    v_cvt_pk_bf16_f32 v72, 0, v72
    v_sub_u32 v73, s66, v3
    v_ashrrev_i32 v76, 31, v72
    v_or_b32 v76, 0x80000000, v76
    v_xor_b32 v72, v72, v76
    v_and_or_b32 v72, v72, s67, v73
    v_mov_b32 v10, 155680
    s_mov_b64 exec, s[68:69]
    ds_max_u32 v10, v72
    s_mov_b64 exec, -1
    s_waitcnt vmcnt(0)
    s_waitcnt lgkmcnt(0)
    s_barrier
    s_cmp_lg_u32 s48, 0
    s_cbranch_scc1 W_k2
    v_mov_b32 v10, 155680
    ds_read_b32 v12, v10
    s_waitcnt vmcnt(0)
    s_mov_b32 s67, 0
W_ts:
    v_cmp_eq_u32 vcc, 0, v15
    s_cbranch_vccz W_tok
    s_add_u32 s67, s67, 1
    s_cmp_ge_u32 s67, 200000
    s_cbranch_scc1 W_tok
    s_sleep 4
    buffer_load_dword v15, v14, s[40:43], 0 offen sc1
    s_waitcnt vmcnt(0)
    s_branch W_ts
W_tok:
    s_lshl_b32 s66, s2, 5
    s_add_u32 s66, s66, 6127616
    v_mov_b32 v10, s66
    v_mov_b32 v13, v15
    s_waitcnt lgkmcnt(0)
    s_mov_b64 exec, 1
    buffer_store_dwordx2 v[12:13], v10, s[16:19], 0 offen sc0 sc1
    s_mov_b64 exec, -1
W_k2:
    v_mov_b32 v248, -1
    v_mov_b32 v249, -1
    v_mov_b32 v250, -1
    v_mov_b32 v251, -1
    s_lshl_b32 s67, s4, 3
    s_lshl_b32 s66, s48, 2
    s_add_u32 s67, s67, s66
    s_lshl_b32 s67, s67, 15
    s_lshl_b32 s66, s5, 11
    s_add_u32 s67, s67, s66
    s_add_u32 s66, s67, 0
    buffer_store_dwordx4 v[248:251], v9, s[16:19], s66 offen offset:0 sc0 sc1
    s_add_u32 s66, s67, 0
    buffer_store_dwordx4 v[248:251], v9, s[16:19], s66 offen offset:1024 sc0 sc1
    s_add_u32 s66, s67, 32768
    buffer_store_dwordx4 v[248:251], v9, s[16:19], s66 offen offset:0 sc0 sc1
    s_add_u32 s66, s67, 32768
    buffer_store_dwordx4 v[248:251], v9, s[16:19], s66 offen offset:1024 sc0 sc1
    s_add_u32 s66, s67, 65536
    buffer_store_dwordx4 v[248:251], v9, s[16:19], s66 offen offset:0 sc0 sc1
    s_add_u32 s66, s67, 65536
    buffer_store_dwordx4 v[248:251], v9, s[16:19], s66 offen offset:1024 sc0 sc1
    s_add_u32 s66, s67, 98304
    buffer_store_dwordx4 v[248:251], v9, s[16:19], s66 offen offset:0 sc0 sc1
    s_add_u32 s66, s67, 98304
    buffer_store_dwordx4 v[248:251], v9, s[16:19], s66 offen offset:1024 sc0 sc1
    v_lshlrev_b32 v56, 16, v48
    v_and_b32 v57, 0xffff0000, v48
    v_lshlrev_b32 v58, 16, v49
    v_and_b32 v59, 0xffff0000, v49
    v_lshlrev_b32 v60, 16, v50
    v_and_b32 v61, 0xffff0000, v50
    v_lshlrev_b32 v62, 16, v51
    v_and_b32 v63, 0xffff0000, v51
    v_lshlrev_b32 v64, 16, v52
    v_and_b32 v65, 0xffff0000, v52
    v_lshlrev_b32 v66, 16, v53
    v_and_b32 v67, 0xffff0000, v53
    v_lshlrev_b32 v68, 16, v54
    v_and_b32 v69, 0xffff0000, v54
    v_lshlrev_b32 v70, 16, v55
    v_and_b32 v71, 0xffff0000, v55
    v_mov_b32 v76, 0
    v_lshlrev_b32 v72, 16, v16
    v_and_b32 v73, 0xffff0000, v16
    v_mul_f32 v72, v72, v56
    v_mul_f32 v73, v73, v57
    v_cvt_pk_bf16_f32 v72, 0, v72
    v_cvt_pk_bf16_f32 v73, 0, v73
    v_add_f32 v76, v76, v72
    v_add_f32 v76, v76, v73
    v_lshlrev_b32 v72, 16, v17
    v_and_b32 v73, 0xffff0000, v17
    v_mul_f32 v72, v72, v58
    v_mul_f32 v73, v73, v59
    v_cvt_pk_bf16_f32 v72, 0, v72
    v_cvt_pk_bf16_f32 v73, 0, v73
    v_add_f32 v76, v76, v72
    v_add_f32 v76, v76, v73
    v_lshlrev_b32 v72, 16, v18
    v_and_b32 v73, 0xffff0000, v18
    v_mul_f32 v72, v72, v60
    v_mul_f32 v73, v73, v61
    v_cvt_pk_bf16_f32 v72, 0, v72
    v_cvt_pk_bf16_f32 v73, 0, v73
    v_add_f32 v76, v76, v72
    v_add_f32 v76, v76, v73
    v_lshlrev_b32 v72, 16, v19
    v_and_b32 v73, 0xffff0000, v19
    v_mul_f32 v72, v72, v62
    v_mul_f32 v73, v73, v63
    v_cvt_pk_bf16_f32 v72, 0, v72
    v_cvt_pk_bf16_f32 v73, 0, v73
    v_add_f32 v76, v76, v72
    v_add_f32 v76, v76, v73
    v_lshlrev_b32 v72, 16, v20
    v_and_b32 v73, 0xffff0000, v20
    v_mul_f32 v72, v72, v64
    v_mul_f32 v73, v73, v65
    v_cvt_pk_bf16_f32 v72, 0, v72
    v_cvt_pk_bf16_f32 v73, 0, v73
    v_add_f32 v76, v76, v72
    v_add_f32 v76, v76, v73
    v_lshlrev_b32 v72, 16, v21
    v_and_b32 v73, 0xffff0000, v21
    v_mul_f32 v72, v72, v66
    v_mul_f32 v73, v73, v67
    v_cvt_pk_bf16_f32 v72, 0, v72
    v_cvt_pk_bf16_f32 v73, 0, v73
    v_add_f32 v76, v76, v72
    v_add_f32 v76, v76, v73
    v_lshlrev_b32 v72, 16, v22
    v_and_b32 v73, 0xffff0000, v22
    v_mul_f32 v72, v72, v68
    v_mul_f32 v73, v73, v69
    v_cvt_pk_bf16_f32 v72, 0, v72
    v_cvt_pk_bf16_f32 v73, 0, v73
    v_add_f32 v76, v76, v72
    v_add_f32 v76, v76, v73
    v_lshlrev_b32 v72, 16, v23
    v_and_b32 v73, 0xffff0000, v23
    v_mul_f32 v72, v72, v70
    v_mul_f32 v73, v73, v71
    v_cvt_pk_bf16_f32 v72, 0, v72
    v_cvt_pk_bf16_f32 v73, 0, v73
    v_add_f32 v76, v76, v72
    v_add_f32 v76, v76, v73
    s_barrier
    s_mov_b32 s66, 0
    buffer_load_dwordx4 v[96:99], v6, s[28:31], s66 offen nt
    s_mov_b32 s66, 7168
    buffer_load_dwordx4 v[100:103], v6, s[28:31], s66 offen nt
    s_mov_b32 s66, 14336
    buffer_load_dwordx4 v[104:107], v6, s[28:31], s66 offen nt
    s_mov_b32 s66, 21504
    buffer_load_dwordx4 v[108:111], v6, s[28:31], s66 offen nt
    s_mov_b32 s66, 28672
    buffer_load_dwordx4 v[112:115], v6, s[28:31], s66 offen nt
    s_mov_b32 s66, 35840
    buffer_load_dwordx4 v[116:119], v6, s[28:31], s66 offen nt
    s_mov_b32 s66, 43008
    buffer_load_dwordx4 v[120:123], v6, s[28:31], s66 offen nt
    s_mov_b32 s66, 50176
    buffer_load_dwordx4 v[124:127], v6, s[28:31], s66 offen nt
    v_mov_b32 v77, 0
    v_lshlrev_b32 v72, 16, v24
    v_and_b32 v73, 0xffff0000, v24
    v_mul_f32 v72, v72, v56
    v_mul_f32 v73, v73, v57
    v_cvt_pk_bf16_f32 v72, 0, v72
    v_cvt_pk_bf16_f32 v73, 0, v73
    v_add_f32 v77, v77, v72
    v_add_f32 v77, v77, v73
    v_lshlrev_b32 v72, 16, v25
    v_and_b32 v73, 0xffff0000, v25
    v_mul_f32 v72, v72, v58
    v_mul_f32 v73, v73, v59
    v_cvt_pk_bf16_f32 v72, 0, v72
    v_cvt_pk_bf16_f32 v73, 0, v73
    v_add_f32 v77, v77, v72
    v_add_f32 v77, v77, v73
    v_lshlrev_b32 v72, 16, v26
    v_and_b32 v73, 0xffff0000, v26
    v_mul_f32 v72, v72, v60
    v_mul_f32 v73, v73, v61
    v_cvt_pk_bf16_f32 v72, 0, v72
    v_cvt_pk_bf16_f32 v73, 0, v73
    v_add_f32 v77, v77, v72
    v_add_f32 v77, v77, v73
    v_lshlrev_b32 v72, 16, v27
    v_and_b32 v73, 0xffff0000, v27
    v_mul_f32 v72, v72, v62
    v_mul_f32 v73, v73, v63
    v_cvt_pk_bf16_f32 v72, 0, v72
    v_cvt_pk_bf16_f32 v73, 0, v73
    v_add_f32 v77, v77, v72
    v_add_f32 v77, v77, v73
    v_lshlrev_b32 v72, 16, v28
    v_and_b32 v73, 0xffff0000, v28
    v_mul_f32 v72, v72, v64
    v_mul_f32 v73, v73, v65
    v_cvt_pk_bf16_f32 v72, 0, v72
    v_cvt_pk_bf16_f32 v73, 0, v73
    v_add_f32 v77, v77, v72
    v_add_f32 v77, v77, v73
    v_lshlrev_b32 v72, 16, v29
    v_and_b32 v73, 0xffff0000, v29
    v_mul_f32 v72, v72, v66
    v_mul_f32 v73, v73, v67
    v_cvt_pk_bf16_f32 v72, 0, v72
    v_cvt_pk_bf16_f32 v73, 0, v73
    v_add_f32 v77, v77, v72
    v_add_f32 v77, v77, v73
    v_lshlrev_b32 v72, 16, v30
    v_and_b32 v73, 0xffff0000, v30
    v_mul_f32 v72, v72, v68
    v_mul_f32 v73, v73, v69
    v_cvt_pk_bf16_f32 v72, 0, v72
    v_cvt_pk_bf16_f32 v73, 0, v73
    v_add_f32 v77, v77, v72
    v_add_f32 v77, v77, v73
    v_lshlrev_b32 v72, 16, v31
    v_and_b32 v73, 0xffff0000, v31
    v_mul_f32 v72, v72, v70
    v_mul_f32 v73, v73, v71
    v_cvt_pk_bf16_f32 v72, 0, v72
    v_cvt_pk_bf16_f32 v73, 0, v73
    v_add_f32 v77, v77, v72
    v_add_f32 v77, v77, v73
    v_mov_b32 v78, 0
    v_lshlrev_b32 v72, 16, v32
    v_and_b32 v73, 0xffff0000, v32
    v_mul_f32 v72, v72, v56
    v_mul_f32 v73, v73, v57
    v_cvt_pk_bf16_f32 v72, 0, v72
    v_cvt_pk_bf16_f32 v73, 0, v73
    v_add_f32 v78, v78, v72
    v_add_f32 v78, v78, v73
    v_lshlrev_b32 v72, 16, v33
    v_and_b32 v73, 0xffff0000, v33
    v_mul_f32 v72, v72, v58
    v_mul_f32 v73, v73, v59
    v_cvt_pk_bf16_f32 v72, 0, v72
    v_cvt_pk_bf16_f32 v73, 0, v73
    v_add_f32 v78, v78, v72
    v_add_f32 v78, v78, v73
    v_lshlrev_b32 v72, 16, v34
    v_and_b32 v73, 0xffff0000, v34
    v_mul_f32 v72, v72, v60
    v_mul_f32 v73, v73, v61
    v_cvt_pk_bf16_f32 v72, 0, v72
    v_cvt_pk_bf16_f32 v73, 0, v73
    v_add_f32 v78, v78, v72
    v_add_f32 v78, v78, v73
    v_lshlrev_b32 v72, 16, v35
    v_and_b32 v73, 0xffff0000, v35
    v_mul_f32 v72, v72, v62
    v_mul_f32 v73, v73, v63
    v_cvt_pk_bf16_f32 v72, 0, v72
    v_cvt_pk_bf16_f32 v73, 0, v73
    v_add_f32 v78, v78, v72
    v_add_f32 v78, v78, v73
    v_lshlrev_b32 v72, 16, v36
    v_and_b32 v73, 0xffff0000, v36
    v_mul_f32 v72, v72, v64
    v_mul_f32 v73, v73, v65
    v_cvt_pk_bf16_f32 v72, 0, v72
    v_cvt_pk_bf16_f32 v73, 0, v73
    v_add_f32 v78, v78, v72
    v_add_f32 v78, v78, v73
    v_lshlrev_b32 v72, 16, v37
    v_and_b32 v73, 0xffff0000, v37
    v_mul_f32 v72, v72, v66
    v_mul_f32 v73, v73, v67
    v_cvt_pk_bf16_f32 v72, 0, v72
    v_cvt_pk_bf16_f32 v73, 0, v73
    v_add_f32 v78, v78, v72
    v_add_f32 v78, v78, v73
    v_lshlrev_b32 v72, 16, v38
    v_and_b32 v73, 0xffff0000, v38
    v_mul_f32 v72, v72, v68
    v_mul_f32 v73, v73, v69
    v_cvt_pk_bf16_f32 v72, 0, v72
    v_cvt_pk_bf16_f32 v73, 0, v73
    v_add_f32 v78, v78, v72
    v_add_f32 v78, v78, v73
    v_lshlrev_b32 v72, 16, v39
    v_and_b32 v73, 0xffff0000, v39
    v_mul_f32 v72, v72, v70
    v_mul_f32 v73, v73, v71
    v_cvt_pk_bf16_f32 v72, 0, v72
    v_cvt_pk_bf16_f32 v73, 0, v73
    v_add_f32 v78, v78, v72
    v_add_f32 v78, v78, v73
    s_barrier
    s_cmp_lg_u32 s48, 0
    s_cbranch_scc1 W_k4
    s_movk_i32 s66, 0
    buffer_load_dwordx2 v[224:225], v8, s[16:19], s66 offen sc1
    s_movk_i32 s66, 2048
    buffer_load_dwordx2 v[226:227], v8, s[16:19], s66 offen sc1
    s_movk_i32 s66, 4096
    buffer_load_dwordx2 v[228:229], v8, s[16:19], s66 offen sc1
    s_movk_i32 s66, 6144
    buffer_load_dwordx2 v[230:231], v8, s[16:19], s66 offen sc1
W_k4:
    v_mov_b32 v79, 0
    v_lshlrev_b32 v72, 16, v40
    v_and_b32 v73, 0xffff0000, v40
    v_mul_f32 v72, v72, v56
    v_mul_f32 v73, v73, v57
    v_cvt_pk_bf16_f32 v72, 0, v72
    v_cvt_pk_bf16_f32 v73, 0, v73
    v_add_f32 v79, v79, v72
    v_add_f32 v79, v79, v73
    v_lshlrev_b32 v72, 16, v41
    v_and_b32 v73, 0xffff0000, v41
    v_mul_f32 v72, v72, v58
    v_mul_f32 v73, v73, v59
    v_cvt_pk_bf16_f32 v72, 0, v72
    v_cvt_pk_bf16_f32 v73, 0, v73
    v_add_f32 v79, v79, v72
    v_add_f32 v79, v79, v73
    v_lshlrev_b32 v72, 16, v42
    v_and_b32 v73, 0xffff0000, v42
    v_mul_f32 v72, v72, v60
    v_mul_f32 v73, v73, v61
    v_cvt_pk_bf16_f32 v72, 0, v72
    v_cvt_pk_bf16_f32 v73, 0, v73
    v_add_f32 v79, v79, v72
    v_add_f32 v79, v79, v73
    v_lshlrev_b32 v72, 16, v43
    v_and_b32 v73, 0xffff0000, v43
    v_mul_f32 v72, v72, v62
    v_mul_f32 v73, v73, v63
    v_cvt_pk_bf16_f32 v72, 0, v72
    v_cvt_pk_bf16_f32 v73, 0, v73
    v_add_f32 v79, v79, v72
    v_add_f32 v79, v79, v73
    v_lshlrev_b32 v72, 16, v44
    v_and_b32 v73, 0xffff0000, v44
    v_mul_f32 v72, v72, v64
    v_mul_f32 v73, v73, v65
    v_cvt_pk_bf16_f32 v72, 0, v72
    v_cvt_pk_bf16_f32 v73, 0, v73
    v_add_f32 v79, v79, v72
    v_add_f32 v79, v79, v73
    v_lshlrev_b32 v72, 16, v45
    v_and_b32 v73, 0xffff0000, v45
    v_mul_f32 v72, v72, v66
    v_mul_f32 v73, v73, v67
    v_cvt_pk_bf16_f32 v72, 0, v72
    v_cvt_pk_bf16_f32 v73, 0, v73
    v_add_f32 v79, v79, v72
    v_add_f32 v79, v79, v73
    v_lshlrev_b32 v72, 16, v46
    v_and_b32 v73, 0xffff0000, v46
    v_mul_f32 v72, v72, v68
    v_mul_f32 v73, v73, v69
    v_cvt_pk_bf16_f32 v72, 0, v72
    v_cvt_pk_bf16_f32 v73, 0, v73
    v_add_f32 v79, v79, v72
    v_add_f32 v79, v79, v73
    v_lshlrev_b32 v72, 16, v47
    v_and_b32 v73, 0xffff0000, v47
    v_mul_f32 v72, v72, v70
    v_mul_f32 v73, v73, v71
    v_cvt_pk_bf16_f32 v72, 0, v72
    v_cvt_pk_bf16_f32 v73, 0, v73
    v_add_f32 v79, v79, v72
    v_add_f32 v79, v79, v73
    s_nop 1
    v_permlane32_swap_b32 v76, v77
    v_permlane32_swap_b32 v78, v79
    v_add_f32 v76, v76, v77
    v_add_f32 v78, v78, v79
    s_nop 1
    v_permlane16_swap_b32 v76, v78
    v_add_f32 v76, v76, v78
    s_nop 1
    v_add_f32_dpp v76, v76, v76 quad_perm:[1,0,3,2] row_mask:0xf bank_mask:0xf
    s_nop 1
    v_add_f32_dpp v76, v76, v76 quad_perm:[2,3,0,1] row_mask:0xf bank_mask:0xf
    s_nop 1
    v_add_f32_dpp v76, v76, v76 row_half_mirror row_mask:0xf bank_mask:0xf
    s_nop 1
    v_add_f32_dpp v76, v76, v76 row_mirror row_mask:0xf bank_mask:0xf
    v_cvt_pk_bf16_f32 v76, 0, v76
    v_mul_f32 v76, s46, v76
    v_exp_f32 v76, -v76
    s_lshl_b32 s66, s50, 4
    v_add_f32 v76, 1.0, v76
    v_rcp_f32 v76, v76
    s_add_u32 s66, s66, 6094848
    v_cvt_pk_bf16_f32 v76, 0, v76
    v_lshlrev_b32 v10, 2, v3
    s_mov_b32 exec_lo, 0x00010001
    s_mov_b32 exec_hi, 0x00010001
    buffer_store_dword v76, v10, s[16:19], s66 offen sc0 sc1
    s_mov_b64 exec, -1
    s_barrier
    s_mov_b32 s66, 57344
    buffer_load_dwordx4 v[128:131], v6, s[28:31], s66 offen nt
    s_mov_b32 s66, 64512
    buffer_load_dwordx4 v[132:135], v6, s[28:31], s66 offen nt
    s_mov_b32 s66, 71680
    buffer_load_dwordx4 v[136:139], v6, s[28:31], s66 offen nt
    s_mov_b32 s66, 78848
    buffer_load_dwordx4 v[140:143], v6, s[28:31], s66 offen nt
    s_mov_b32 s66, 86016
    buffer_load_dwordx4 v[144:147], v6, s[28:31], s66 offen nt
    s_mov_b32 s66, 93184
    buffer_load_dwordx4 v[148:151], v6, s[28:31], s66 offen nt
    s_mov_b32 s66, 100352
    buffer_load_dwordx4 v[152:155], v6, s[28:31], s66 offen nt
    s_mov_b32 s66, 107520
    buffer_load_dwordx4 v[156:159], v6, s[28:31], s66 offen nt
    s_cmp_lg_u32 s48, 0
    s_cbranch_scc1 W_c5
    s_waitcnt vmcnt(9)
    s_mov_b32 s67, 0
W_cs:
    v_xor_b32 v10, v225, v15
    v_xor_b32 v11, v227, v15
    v_or_b32 v10, v10, v11
    v_xor_b32 v11, v229, v15
    v_or_b32 v10, v10, v11
    v_xor_b32 v11, v231, v15
    v_or_b32 v10, v10, v11
    v_cmp_ne_u32 vcc, 0, v10
    s_cbranch_vccz W_cok
    s_add_u32 s67, s67, 1
    s_cmp_ge_u32 s67, 200000
    s_cbranch_scc1 W_cok
    s_sleep 4
    s_movk_i32 s66, 0
    buffer_load_dwordx2 v[224:225], v8, s[16:19], s66 offen sc1
    s_movk_i32 s66, 2048
    buffer_load_dwordx2 v[226:227], v8, s[16:19], s66 offen sc1
    s_movk_i32 s66, 4096
    buffer_load_dwordx2 v[228:229], v8, s[16:19], s66 offen sc1
    s_movk_i32 s66, 6144
    buffer_load_dwordx2 v[230:231], v8, s[16:19], s66 offen sc1
    s_waitcnt vmcnt(0)
    s_branch W_cs
W_cok:
    v_max_u32 v12, v224, v226
    v_max3_u32 v12, v12, v228, v230
    s_nop 1
    s_nop 1
    v_max_u32_dpp v12, v12, v12 quad_perm:[1,0,3,2] row_mask:0xf bank_mask:0xf
    s_nop 1
    v_max_u32_dpp v12, v12, v12 quad_perm:[2,3,0,1] row_mask:0xf bank_mask:0xf
    s_nop 1
    v_max_u32_dpp v12, v12, v12 row_half_mirror row_mask:0xf bank_mask:0xf
    s_nop 1
    v_max_u32_dpp v12, v12, v12 row_mirror row_mask:0xf bank_mask:0xf
    s_nop 1
    v_readlane_b32 s68, v12, 0
    v_readlane_b32 s69, v12, 16
    v_readlane_b32 s70, v12, 32
    v_readlane_b32 s71, v12, 48
    s_nop 1
    v_mov_b32 v12, s68
    v_max_u32 v12, s69, v12
    v_max_u32 v12, s70, v12
    v_max_u32 v12, s71, v12
    v_mov_b32 v10, 155684
    ds_write_b32 v10, v12
W_c5:
    s_waitcnt lgkmcnt(0)
    s_barrier
    v_mov_b32 v10, 155684
    ds_read_b32 v11, v10
    v_lshrrev_b32 v10, 5, v2
    v_lshlrev_b32 v10, 6, v10
    s_waitcnt lgkmcnt(0)
    v_readfirstlane_b32 s66, v11
    s_and_b32 s66, s66, 0x7ff
    s_sub_u32 s66, 2047, s66
    s_lshl_b32 s66, s66, 10
    s_add_u32 s66, s66, s51
    s_lshl_b32 s66, s66, 1
    buffer_load_dwordx4 v[224:227], v10, s[8:11], s66 offen offset:0
    buffer_load_dwordx4 v[228:231], v10, s[8:11], s66 offen offset:16
    buffer_load_dwordx4 v[232:235], v10, s[8:11], s66 offen offset:32
    buffer_load_dwordx4 v[236:239], v10, s[8:11], s66 offen offset:48
    s_barrier
    s_mov_b32 s66, 114688
    buffer_load_dwordx4 v[160:163], v6, s[28:31], s66 offen nt
    s_mov_b32 s66, 121856
    buffer_load_dwordx4 v[164:167], v6, s[28:31], s66 offen nt
    s_mov_b32 s66, 129024
    buffer_load_dwordx4 v[168:171], v6, s[28:31], s66 offen nt
    s_mov_b32 s66, 136192
    buffer_load_dwordx4 v[172:175], v6, s[28:31], s66 offen nt
    s_mov_b32 s66, 143360
    buffer_load_dwordx4 v[176:179], v6, s[28:31], s66 offen nt
    s_mov_b32 s66, 150528
    buffer_load_dwordx4 v[180:183], v6, s[28:31], s66 offen nt
    s_mov_b32 s66, 157696
    buffer_load_dwordx4 v[184:187], v6, s[28:31], s66 offen nt
    s_mov_b32 s66, 164864
    buffer_load_dwordx4 v[188:191], v6, s[28:31], s66 offen nt
    s_waitcnt vmcnt(8)
    v_mov_b32 v64, 0
    v_mov_b32 v65, 0
    v_mov_b32 v66, 0
    v_mov_b32 v67, 0
    v_mov_b32 v68, 0
    v_mov_b32 v69, 0
    v_mov_b32 v70, 0
    v_mov_b32 v71, 0
    v_lshlrev_b32 v72, 16, v224
    v_lshlrev_b32 v73, 16, v96
    v_and_b32 v74, 0xffff0000, v96
    v_fmac_f32 v64, v73, v72
    v_fmac_f32 v65, v74, v72
    v_lshlrev_b32 v73, 16, v97
    v_and_b32 v74, 0xffff0000, v97
    v_fmac_f32 v66, v73, v72
    v_fmac_f32 v67, v74, v72
    v_lshlrev_b32 v73, 16, v98
    v_and_b32 v74, 0xffff0000, v98
    v_fmac_f32 v68, v73, v72
    v_fmac_f32 v69, v74, v72
    v_lshlrev_b32 v73, 16, v99
    v_and_b32 v74, 0xffff0000, v99
    v_fmac_f32 v70, v73, v72
    v_fmac_f32 v71, v74, v72
    v_and_b32 v72, 0xffff0000, v224
    v_lshlrev_b32 v73, 16, v100
    v_and_b32 v74, 0xffff0000, v100
    v_fmac_f32 v64, v73, v72
    v_fmac_f32 v65, v74, v72
    v_lshlrev_b32 v73, 16, v101
    v_and_b32 v74, 0xffff0000, v101
    v_fmac_f32 v66, v73, v72
    v_fmac_f32 v67, v74, v72
    v_lshlrev_b32 v73, 16, v102
    v_and_b32 v74, 0xffff0000, v102
    v_fmac_f32 v68, v73, v72
    v_fmac_f32 v69, v74, v72
    v_lshlrev_b32 v73, 16, v103
    v_and_b32 v74, 0xffff0000, v103
    v_fmac_f32 v70, v73, v72
    v_fmac_f32 v71, v74, v72
    v_lshlrev_b32 v72, 16, v225
    v_lshlrev_b32 v73, 16, v104
    v_and_b32 v74, 0xffff0000, v104
    v_fmac_f32 v64, v73, v72
    v_fmac_f32 v65, v74, v72
    v_lshlrev_b32 v73, 16, v105
    v_and_b32 v74, 0xffff0000, v105
    v_fmac_f32 v66, v73, v72
    v_fmac_f32 v67, v74, v72
    v_lshlrev_b32 v73, 16, v106
    v_and_b32 v74, 0xffff0000, v106
    v_fmac_f32 v68, v73, v72
    v_fmac_f32 v69, v74, v72
    v_lshlrev_b32 v73, 16, v107
    v_and_b32 v74, 0xffff0000, v107
    v_fmac_f32 v70, v73, v72
    v_fmac_f32 v71, v74, v72
    v_and_b32 v72, 0xffff0000, v225
    v_lshlrev_b32 v73, 16, v108
    v_and_b32 v74, 0xffff0000, v108
    v_fmac_f32 v64, v73, v72
    v_fmac_f32 v65, v74, v72
    v_lshlrev_b32 v73, 16, v109
    v_and_b32 v74, 0xffff0000, v109
    v_fmac_f32 v66, v73, v72
    v_fmac_f32 v67, v74, v72
    v_lshlrev_b32 v73, 16, v110
    v_and_b32 v74, 0xffff0000, v110
    v_fmac_f32 v68, v73, v72
    v_fmac_f32 v69, v74, v72
    v_lshlrev_b32 v73, 16, v111
    v_and_b32 v74, 0xffff0000, v111
    v_fmac_f32 v70, v73, v72
    v_fmac_f32 v71, v74, v72
    v_lshlrev_b32 v72, 16, v226
    v_lshlrev_b32 v73, 16, v112
    v_and_b32 v74, 0xffff0000, v112
    v_fmac_f32 v64, v73, v72
    v_fmac_f32 v65, v74, v72
    v_lshlrev_b32 v73, 16, v113
    v_and_b32 v74, 0xffff0000, v113
    v_fmac_f32 v66, v73, v72
    v_fmac_f32 v67, v74, v72
    v_lshlrev_b32 v73, 16, v114
    v_and_b32 v74, 0xffff0000, v114
    v_fmac_f32 v68, v73, v72
    v_fmac_f32 v69, v74, v72
    v_lshlrev_b32 v73, 16, v115
    v_and_b32 v74, 0xffff0000, v115
    v_fmac_f32 v70, v73, v72
    v_fmac_f32 v71, v74, v72
    v_and_b32 v72, 0xffff0000, v226
    v_lshlrev_b32 v73, 16, v116
    v_and_b32 v74, 0xffff0000, v116
    v_fmac_f32 v64, v73, v72
    v_fmac_f32 v65, v74, v72
    v_lshlrev_b32 v73, 16, v117
    v_and_b32 v74, 0xffff0000, v117
    v_fmac_f32 v66, v73, v72
    v_fmac_f32 v67, v74, v72
    v_lshlrev_b32 v73, 16, v118
    v_and_b32 v74, 0xffff0000, v118
    v_fmac_f32 v68, v73, v72
    v_fmac_f32 v69, v74, v72
    v_lshlrev_b32 v73, 16, v119
    v_and_b32 v74, 0xffff0000, v119
    v_fmac_f32 v70, v73, v72
    v_fmac_f32 v71, v74, v72
    s_barrier
    v_lshlrev_b32 v72, 16, v227
    v_lshlrev_b32 v73, 16, v120
    v_and_b32 v74, 0xffff0000, v120
    v_fmac_f32 v64, v73, v72
    v_fmac_f32 v65, v74, v72
    v_lshlrev_b32 v73, 16, v121
    v_and_b32 v74, 0xffff0000, v121
    v_fmac_f32 v66, v73, v72
    v_fmac_f32 v67, v74, v72
    v_lshlrev_b32 v73, 16, v122
    v_and_b32 v74, 0xffff0000, v122
    v_fmac_f32 v68, v73, v72
    v_fmac_f32 v69, v74, v72
    v_lshlrev_b32 v73, 16, v123
    v_and_b32 v74, 0xffff0000, v123
    v_fmac_f32 v70, v73, v72
    v_fmac_f32 v71, v74, v72
    v_and_b32 v72, 0xffff0000, v227
    v_lshlrev_b32 v73, 16, v124
    v_and_b32 v74, 0xffff0000, v124
    v_fmac_f32 v64, v73, v72
    v_fmac_f32 v65, v74, v72
    v_lshlrev_b32 v73, 16, v125
    v_and_b32 v74, 0xffff0000, v125
    v_fmac_f32 v66, v73, v72
    v_fmac_f32 v67, v74, v72
    v_lshlrev_b32 v73, 16, v126
    v_and_b32 v74, 0xffff0000, v126
    v_fmac_f32 v68, v73, v72
    v_fmac_f32 v69, v74, v72
    v_lshlrev_b32 v73, 16, v127
    v_and_b32 v74, 0xffff0000, v127
    v_fmac_f32 v70, v73, v72
    v_fmac_f32 v71, v74, v72
    v_lshlrev_b32 v72, 16, v228
    v_lshlrev_b32 v73, 16, v128
    v_and_b32 v74, 0xffff0000, v128
    v_fmac_f32 v64, v73, v72
    v_fmac_f32 v65, v74, v72
    v_lshlrev_b32 v73, 16, v129
    v_and_b32 v74, 0xffff0000, v129
    v_fmac_f32 v66, v73, v72
    v_fmac_f32 v67, v74, v72
    v_lshlrev_b32 v73, 16, v130
    v_and_b32 v74, 0xffff0000, v130
    v_fmac_f32 v68, v73, v72
    v_fmac_f32 v69, v74, v72
    v_lshlrev_b32 v73, 16, v131
    v_and_b32 v74, 0xffff0000, v131
    v_fmac_f32 v70, v73, v72
    v_fmac_f32 v71, v74, v72
    v_and_b32 v72, 0xffff0000, v228
    v_lshlrev_b32 v73, 16, v132
    v_and_b32 v74, 0xffff0000, v132
    v_fmac_f32 v64, v73, v72
    v_fmac_f32 v65, v74, v72
    v_lshlrev_b32 v73, 16, v133
    v_and_b32 v74, 0xffff0000, v133
    v_fmac_f32 v66, v73, v72
    v_fmac_f32 v67, v74, v72
    v_lshlrev_b32 v73, 16, v134
    v_and_b32 v74, 0xffff0000, v134
    v_fmac_f32 v68, v73, v72
    v_fmac_f32 v69, v74, v72
    v_lshlrev_b32 v73, 16, v135
    v_and_b32 v74, 0xffff0000, v135
    v_fmac_f32 v70, v73, v72
    v_fmac_f32 v71, v74, v72
    v_lshlrev_b32 v72, 16, v229
    v_lshlrev_b32 v73, 16, v136
    v_and_b32 v74, 0xffff0000, v136
    v_fmac_f32 v64, v73, v72
    v_fmac_f32 v65, v74, v72
    v_lshlrev_b32 v73, 16, v137
    v_and_b32 v74, 0xffff0000, v137
    v_fmac_f32 v66, v73, v72
    v_fmac_f32 v67, v74, v72
    v_lshlrev_b32 v73, 16, v138
    v_and_b32 v74, 0xffff0000, v138
    v_fmac_f32 v68, v73, v72
    v_fmac_f32 v69, v74, v72
    v_lshlrev_b32 v73, 16, v139
    v_and_b32 v74, 0xffff0000, v139
    v_fmac_f32 v70, v73, v72
    v_fmac_f32 v71, v74, v72
    v_and_b32 v72, 0xffff0000, v229
    v_lshlrev_b32 v73, 16, v140
    v_and_b32 v74, 0xffff0000, v140
    v_fmac_f32 v64, v73, v72
    v_fmac_f32 v65, v74, v72
    v_lshlrev_b32 v73, 16, v141
    v_and_b32 v74, 0xffff0000, v141
    v_fmac_f32 v66, v73, v72
    v_fmac_f32 v67, v74, v72
    v_lshlrev_b32 v73, 16, v142
    v_and_b32 v74, 0xffff0000, v142
    v_fmac_f32 v68, v73, v72
    v_fmac_f32 v69, v74, v72
    v_lshlrev_b32 v73, 16, v143
    v_and_b32 v74, 0xffff0000, v143
    v_fmac_f32 v70, v73, v72
    v_fmac_f32 v71, v74, v72
    s_barrier
    s_mov_b32 s66, 172032
    buffer_load_dwordx4 v[192:195], v6, s[28:31], s66 offen nt
    s_mov_b32 s66, 179200
    buffer_load_dwordx4 v[196:199], v6, s[28:31], s66 offen nt
    s_mov_b32 s66, 186368
    buffer_load_dwordx4 v[200:203], v6, s[28:31], s66 offen nt
    s_mov_b32 s66, 193536
    buffer_load_dwordx4 v[204:207], v6, s[28:31], s66 offen nt
    s_mov_b32 s66, 200704
    buffer_load_dwordx4 v[208:211], v6, s[28:31], s66 offen nt
    s_mov_b32 s66, 207872
    buffer_load_dwordx4 v[212:215], v6, s[28:31], s66 offen nt
    s_mov_b32 s66, 215040
    buffer_load_dwordx4 v[216:219], v6, s[28:31], s66 offen nt
    s_mov_b32 s66, 222208
    buffer_load_dwordx4 v[220:223], v6, s[28:31], s66 offen nt
    v_lshlrev_b32 v72, 16, v230
    v_lshlrev_b32 v73, 16, v144
    v_and_b32 v74, 0xffff0000, v144
    v_fmac_f32 v64, v73, v72
    v_fmac_f32 v65, v74, v72
    v_lshlrev_b32 v73, 16, v145
    v_and_b32 v74, 0xffff0000, v145
    v_fmac_f32 v66, v73, v72
    v_fmac_f32 v67, v74, v72
    v_lshlrev_b32 v73, 16, v146
    v_and_b32 v74, 0xffff0000, v146
    v_fmac_f32 v68, v73, v72
    v_fmac_f32 v69, v74, v72
    v_lshlrev_b32 v73, 16, v147
    v_and_b32 v74, 0xffff0000, v147
    v_fmac_f32 v70, v73, v72
    v_fmac_f32 v71, v74, v72
    v_and_b32 v72, 0xffff0000, v230
    v_lshlrev_b32 v73, 16, v148
    v_and_b32 v74, 0xffff0000, v148
    v_fmac_f32 v64, v73, v72
    v_fmac_f32 v65, v74, v72
    v_lshlrev_b32 v73, 16, v149
    v_and_b32 v74, 0xffff0000, v149
    v_fmac_f32 v66, v73, v72
    v_fmac_f32 v67, v74, v72
    v_lshlrev_b32 v73, 16, v150
    v_and_b32 v74, 0xffff0000, v150
    v_fmac_f32 v68, v73, v72
    v_fmac_f32 v69, v74, v72
    v_lshlrev_b32 v73, 16, v151
    v_and_b32 v74, 0xffff0000, v151
    v_fmac_f32 v70, v73, v72
    v_fmac_f32 v71, v74, v72
    v_lshlrev_b32 v72, 16, v231
    v_lshlrev_b32 v73, 16, v152
    v_and_b32 v74, 0xffff0000, v152
    v_fmac_f32 v64, v73, v72
    v_fmac_f32 v65, v74, v72
    v_lshlrev_b32 v73, 16, v153
    v_and_b32 v74, 0xffff0000, v153
    v_fmac_f32 v66, v73, v72
    v_fmac_f32 v67, v74, v72
    v_lshlrev_b32 v73, 16, v154
    v_and_b32 v74, 0xffff0000, v154
    v_fmac_f32 v68, v73, v72
    v_fmac_f32 v69, v74, v72
    v_lshlrev_b32 v73, 16, v155
    v_and_b32 v74, 0xffff0000, v155
    v_fmac_f32 v70, v73, v72
    v_fmac_f32 v71, v74, v72
    v_and_b32 v72, 0xffff0000, v231
    v_lshlrev_b32 v73, 16, v156
    v_and_b32 v74, 0xffff0000, v156
    v_fmac_f32 v64, v73, v72
    v_fmac_f32 v65, v74, v72
    v_lshlrev_b32 v73, 16, v157
    v_and_b32 v74, 0xffff0000, v157
    v_fmac_f32 v66, v73, v72
    v_fmac_f32 v67, v74, v72
    v_lshlrev_b32 v73, 16, v158
    v_and_b32 v74, 0xffff0000, v158
    v_fmac_f32 v68, v73, v72
    v_fmac_f32 v69, v74, v72
    v_lshlrev_b32 v73, 16, v159
    v_and_b32 v74, 0xffff0000, v159
    v_fmac_f32 v70, v73, v72
    v_fmac_f32 v71, v74, v72
    s_waitcnt vmcnt(15)
    v_lshlrev_b32 v72, 16, v232
    v_lshlrev_b32 v73, 16, v160
    v_and_b32 v74, 0xffff0000, v160
    v_fmac_f32 v64, v73, v72
    v_fmac_f32 v65, v74, v72
    v_lshlrev_b32 v73, 16, v161
    v_and_b32 v74, 0xffff0000, v161
    v_fmac_f32 v66, v73, v72
    v_fmac_f32 v67, v74, v72
    v_lshlrev_b32 v73, 16, v162
    v_and_b32 v74, 0xffff0000, v162
    v_fmac_f32 v68, v73, v72
    v_fmac_f32 v69, v74, v72
    v_lshlrev_b32 v73, 16, v163
    v_and_b32 v74, 0xffff0000, v163
    v_fmac_f32 v70, v73, v72
    v_fmac_f32 v71, v74, v72
    s_waitcnt vmcnt(14)
    v_and_b32 v72, 0xffff0000, v232
    v_lshlrev_b32 v73, 16, v164
    v_and_b32 v74, 0xffff0000, v164
    v_fmac_f32 v64, v73, v72
    v_fmac_f32 v65, v74, v72
    v_lshlrev_b32 v73, 16, v165
    v_and_b32 v74, 0xffff0000, v165
    v_fmac_f32 v66, v73, v72
    v_fmac_f32 v67, v74, v72
    v_lshlrev_b32 v73, 16, v166
    v_and_b32 v74, 0xffff0000, v166
    v_fmac_f32 v68, v73, v72
    v_fmac_f32 v69, v74, v72
    v_lshlrev_b32 v73, 16, v167
    v_and_b32 v74, 0xffff0000, v167
    v_fmac_f32 v70, v73, v72
    v_fmac_f32 v71, v74, v72
    s_barrier
    s_waitcnt vmcnt(13)
    v_lshlrev_b32 v72, 16, v233
    v_lshlrev_b32 v73, 16, v168
    v_and_b32 v74, 0xffff0000, v168
    v_fmac_f32 v64, v73, v72
    v_fmac_f32 v65, v74, v72
    v_lshlrev_b32 v73, 16, v169
    v_and_b32 v74, 0xffff0000, v169
    v_fmac_f32 v66, v73, v72
    v_fmac_f32 v67, v74, v72
    v_lshlrev_b32 v73, 16, v170
    v_and_b32 v74, 0xffff0000, v170
    v_fmac_f32 v68, v73, v72
    v_fmac_f32 v69, v74, v72
    v_lshlrev_b32 v73, 16, v171
    v_and_b32 v74, 0xffff0000, v171
    v_fmac_f32 v70, v73, v72
    v_fmac_f32 v71, v74, v72
    s_waitcnt vmcnt(12)
    v_and_b32 v72, 0xffff0000, v233
    v_lshlrev_b32 v73, 16, v172
    v_and_b32 v74, 0xffff0000, v172
    v_fmac_f32 v64, v73, v72
    v_fmac_f32 v65, v74, v72
    v_lshlrev_b32 v73, 16, v173
    v_and_b32 v74, 0xffff0000, v173
    v_fmac_f32 v66, v73, v72
    v_fmac_f32 v67, v74, v72
    v_lshlrev_b32 v73, 16, v174
    v_and_b32 v74, 0xffff0000, v174
    v_fmac_f32 v68, v73, v72
    v_fmac_f32 v69, v74, v72
    v_lshlrev_b32 v73, 16, v175
    v_and_b32 v74, 0xffff0000, v175
    v_fmac_f32 v70, v73, v72
    v_fmac_f32 v71, v74, v72
    s_waitcnt vmcnt(11)
    v_lshlrev_b32 v72, 16, v234
    v_lshlrev_b32 v73, 16, v176
    v_and_b32 v74, 0xffff0000, v176
    v_fmac_f32 v64, v73, v72
    v_fmac_f32 v65, v74, v72
    v_lshlrev_b32 v73, 16, v177
    v_and_b32 v74, 0xffff0000, v177
    v_fmac_f32 v66, v73, v72
    v_fmac_f32 v67, v74, v72
    v_lshlrev_b32 v73, 16, v178
    v_and_b32 v74, 0xffff0000, v178
    v_fmac_f32 v68, v73, v72
    v_fmac_f32 v69, v74, v72
    v_lshlrev_b32 v73, 16, v179
    v_and_b32 v74, 0xffff0000, v179
    v_fmac_f32 v70, v73, v72
    v_fmac_f32 v71, v74, v72
    s_waitcnt vmcnt(10)
    v_and_b32 v72, 0xffff0000, v234
    v_lshlrev_b32 v73, 16, v180
    v_and_b32 v74, 0xffff0000, v180
    v_fmac_f32 v64, v73, v72
    v_fmac_f32 v65, v74, v72
    v_lshlrev_b32 v73, 16, v181
    v_and_b32 v74, 0xffff0000, v181
    v_fmac_f32 v66, v73, v72
    v_fmac_f32 v67, v74, v72
    v_lshlrev_b32 v73, 16, v182
    v_and_b32 v74, 0xffff0000, v182
    v_fmac_f32 v68, v73, v72
    v_fmac_f32 v69, v74, v72
    v_lshlrev_b32 v73, 16, v183
    v_and_b32 v74, 0xffff0000, v183
    v_fmac_f32 v70, v73, v72
    v_fmac_f32 v71, v74, v72
    s_barrier
    s_waitcnt vmcnt(9)
    v_lshlrev_b32 v72, 16, v235
    v_lshlrev_b32 v73, 16, v184
    v_and_b32 v74, 0xffff0000, v184
    v_fmac_f32 v64, v73, v72
    v_fmac_f32 v65, v74, v72
    v_lshlrev_b32 v73, 16, v185
    v_and_b32 v74, 0xffff0000, v185
    v_fmac_f32 v66, v73, v72
    v_fmac_f32 v67, v74, v72
    v_lshlrev_b32 v73, 16, v186
    v_and_b32 v74, 0xffff0000, v186
    v_fmac_f32 v68, v73, v72
    v_fmac_f32 v69, v74, v72
    v_lshlrev_b32 v73, 16, v187
    v_and_b32 v74, 0xffff0000, v187
    v_fmac_f32 v70, v73, v72
    v_fmac_f32 v71, v74, v72
    s_waitcnt vmcnt(8)
    v_and_b32 v72, 0xffff0000, v235
    v_lshlrev_b32 v73, 16, v188
    v_and_b32 v74, 0xffff0000, v188
    v_fmac_f32 v64, v73, v72
    v_fmac_f32 v65, v74, v72
    v_lshlrev_b32 v73, 16, v189
    v_and_b32 v74, 0xffff0000, v189
    v_fmac_f32 v66, v73, v72
    v_fmac_f32 v67, v74, v72
    v_lshlrev_b32 v73, 16, v190
    v_and_b32 v74, 0xffff0000, v190
    v_fmac_f32 v68, v73, v72
    v_fmac_f32 v69, v74, v72
    v_lshlrev_b32 v73, 16, v191
    v_and_b32 v74, 0xffff0000, v191
    v_fmac_f32 v70, v73, v72
    v_fmac_f32 v71, v74, v72
    s_waitcnt vmcnt(7)
    v_lshlrev_b32 v72, 16, v236
    v_lshlrev_b32 v73, 16, v192
    v_and_b32 v74, 0xffff0000, v192
    v_fmac_f32 v64, v73, v72
    v_fmac_f32 v65, v74, v72
    v_lshlrev_b32 v73, 16, v193
    v_and_b32 v74, 0xffff0000, v193
    v_fmac_f32 v66, v73, v72
    v_fmac_f32 v67, v74, v72
    v_lshlrev_b32 v73, 16, v194
    v_and_b32 v74, 0xffff0000, v194
    v_fmac_f32 v68, v73, v72
    v_fmac_f32 v69, v74, v72
    v_lshlrev_b32 v73, 16, v195
    v_and_b32 v74, 0xffff0000, v195
    v_fmac_f32 v70, v73, v72
    v_fmac_f32 v71, v74, v72
    s_waitcnt vmcnt(6)
    v_and_b32 v72, 0xffff0000, v236
    v_lshlrev_b32 v73, 16, v196
    v_and_b32 v74, 0xffff0000, v196
    v_fmac_f32 v64, v73, v72
    v_fmac_f32 v65, v74, v72
    v_lshlrev_b32 v73, 16, v197
    v_and_b32 v74, 0xffff0000, v197
    v_fmac_f32 v66, v73, v72
    v_fmac_f32 v67, v74, v72
    v_lshlrev_b32 v73, 16, v198
    v_and_b32 v74, 0xffff0000, v198
    v_fmac_f32 v68, v73, v72
    v_fmac_f32 v69, v74, v72
    v_lshlrev_b32 v73, 16, v199
    v_and_b32 v74, 0xffff0000, v199
    v_fmac_f32 v70, v73, v72
    v_fmac_f32 v71, v74, v72
    s_waitcnt vmcnt(5)
    v_lshlrev_b32 v72, 16, v237
    v_lshlrev_b32 v73, 16, v200
    v_and_b32 v74, 0xffff0000, v200
    v_fmac_f32 v64, v73, v72
    v_fmac_f32 v65, v74, v72
    v_lshlrev_b32 v73, 16, v201
    v_and_b32 v74, 0xffff0000, v201
    v_fmac_f32 v66, v73, v72
    v_fmac_f32 v67, v74, v72
    v_lshlrev_b32 v73, 16, v202
    v_and_b32 v74, 0xffff0000, v202
    v_fmac_f32 v68, v73, v72
    v_fmac_f32 v69, v74, v72
    v_lshlrev_b32 v73, 16, v203
    v_and_b32 v74, 0xffff0000, v203
    v_fmac_f32 v70, v73, v72
    v_fmac_f32 v71, v74, v72
    s_waitcnt vmcnt(4)
    v_and_b32 v72, 0xffff0000, v237
    v_lshlrev_b32 v73, 16, v204
    v_and_b32 v74, 0xffff0000, v204
    v_fmac_f32 v64, v73, v72
    v_fmac_f32 v65, v74, v72
    v_lshlrev_b32 v73, 16, v205
    v_and_b32 v74, 0xffff0000, v205
    v_fmac_f32 v66, v73, v72
    v_fmac_f32 v67, v74, v72
    v_lshlrev_b32 v73, 16, v206
    v_and_b32 v74, 0xffff0000, v206
    v_fmac_f32 v68, v73, v72
    v_fmac_f32 v69, v74, v72
    v_lshlrev_b32 v73, 16, v207
    v_and_b32 v74, 0xffff0000, v207
    v_fmac_f32 v70, v73, v72
    v_fmac_f32 v71, v74, v72
    s_barrier
    s_waitcnt vmcnt(3)
    v_lshlrev_b32 v72, 16, v238
    v_lshlrev_b32 v73, 16, v208
    v_and_b32 v74, 0xffff0000, v208
    v_fmac_f32 v64, v73, v72
    v_fmac_f32 v65, v74, v72
    v_lshlrev_b32 v73, 16, v209
    v_and_b32 v74, 0xffff0000, v209
    v_fmac_f32 v66, v73, v72
    v_fmac_f32 v67, v74, v72
    v_lshlrev_b32 v73, 16, v210
    v_and_b32 v74, 0xffff0000, v210
    v_fmac_f32 v68, v73, v72
    v_fmac_f32 v69, v74, v72
    v_lshlrev_b32 v73, 16, v211
    v_and_b32 v74, 0xffff0000, v211
    v_fmac_f32 v70, v73, v72
    v_fmac_f32 v71, v74, v72
    s_waitcnt vmcnt(2)
    v_and_b32 v72, 0xffff0000, v238
    v_lshlrev_b32 v73, 16, v212
    v_and_b32 v74, 0xffff0000, v212
    v_fmac_f32 v64, v73, v72
    v_fmac_f32 v65, v74, v72
    v_lshlrev_b32 v73, 16, v213
    v_and_b32 v74, 0xffff0000, v213
    v_fmac_f32 v66, v73, v72
    v_fmac_f32 v67, v74, v72
    v_lshlrev_b32 v73, 16, v214
    v_and_b32 v74, 0xffff0000, v214
    v_fmac_f32 v68, v73, v72
    v_fmac_f32 v69, v74, v72
    v_lshlrev_b32 v73, 16, v215
    v_and_b32 v74, 0xffff0000, v215
    v_fmac_f32 v70, v73, v72
    v_fmac_f32 v71, v74, v72
    s_waitcnt vmcnt(1)
    v_lshlrev_b32 v72, 16, v239
    v_lshlrev_b32 v73, 16, v216
    v_and_b32 v74, 0xffff0000, v216
    v_fmac_f32 v64, v73, v72
    v_fmac_f32 v65, v74, v72
    v_lshlrev_b32 v73, 16, v217
    v_and_b32 v74, 0xffff0000, v217
    v_fmac_f32 v66, v73, v72
    v_fmac_f32 v67, v74, v72
    v_lshlrev_b32 v73, 16, v218
    v_and_b32 v74, 0xffff0000, v218
    v_fmac_f32 v68, v73, v72
    v_fmac_f32 v69, v74, v72
    v_lshlrev_b32 v73, 16, v219
    v_and_b32 v74, 0xffff0000, v219
    v_fmac_f32 v70, v73, v72
    v_fmac_f32 v71, v74, v72
    s_waitcnt vmcnt(0)
    v_and_b32 v72, 0xffff0000, v239
    v_lshlrev_b32 v73, 16, v220
    v_and_b32 v74, 0xffff0000, v220
    v_fmac_f32 v64, v73, v72
    v_fmac_f32 v65, v74, v72
    v_lshlrev_b32 v73, 16, v221
    v_and_b32 v74, 0xffff0000, v221
    v_fmac_f32 v66, v73, v72
    v_fmac_f32 v67, v74, v72
    v_lshlrev_b32 v73, 16, v222
    v_and_b32 v74, 0xffff0000, v222
    v_fmac_f32 v68, v73, v72
    v_fmac_f32 v69, v74, v72
    v_lshlrev_b32 v73, 16, v223
    v_and_b32 v74, 0xffff0000, v223
    v_fmac_f32 v70, v73, v72
    v_fmac_f32 v71, v74, v72
    v_and_b32 v76, 31, v2
    v_lshrrev_b32 v77, 5, v2
    v_lshl_add_u32 v76, v76, 1, v77
    v_permlane32_swap_b32 v64, v68
    v_permlane32_swap_b32 v65, v69
    v_permlane32_swap_b32 v66, v70
    v_permlane32_swap_b32 v67, v71
    v_lshlrev_b32 v76, 4, v76
    v_add_f32 v64, v64, v68
    v_add_f32 v65, v65, v69
    v_add_f32 v66, v66, v70
    v_add_f32 v67, v67, v71
    buffer_store_dwordx4 v[64:67], v76, s[16:19], s54 offen sc0 sc1
    s_barrier
    s_mov_b32 s66, 0
    buffer_load_dwordx4 v[96:99], v7, s[32:35], s66 offen
    s_mov_b32 s66, 2048
    buffer_load_dwordx4 v[100:103], v7, s[32:35], s66 offen
    s_mov_b32 s66, 4096
    buffer_load_dwordx4 v[104:107], v7, s[32:35], s66 offen
    s_mov_b32 s66, 6144
    buffer_load_dwordx4 v[108:111], v7, s[32:35], s66 offen
    s_mov_b32 s66, 8192
    buffer_load_dwordx4 v[112:115], v7, s[32:35], s66 offen
    s_mov_b32 s66, 10240
    buffer_load_dwordx4 v[116:119], v7, s[32:35], s66 offen
    s_mov_b32 s66, 12288
    buffer_load_dwordx4 v[120:123], v7, s[32:35], s66 offen
    s_mov_b32 s66, 14336
    buffer_load_dwordx4 v[124:127], v7, s[32:35], s66 offen
H_b14:
    s_barrier
    s_setprio 3
    s_add_u32 s67, s52, 0
    s_and_b32 s67, s67, 0x1fffff
    s_add_u32 m0, s72, 24576
    s_add_u32 s66, s67, 0
    buffer_load_dwordx4 v90, s[20:23], s66 offen lds
    s_add_u32 m0, s72, 28672
    s_add_u32 s66, s67, 65536
    buffer_load_dwordx4 v90, s[20:23], s66 offen lds
    s_add_u32 s67, s52, 0
    s_and_b32 s67, s67, 0x1fffff
    s_add_u32 m0, s72, 40960
    s_add_u32 s66, s67, 131072
    buffer_load_dwordx4 v90, s[20:23], s66 offen lds
    s_add_u32 m0, s72, 45056
    s_add_u32 s66, s67, 196608
    buffer_load_dwordx4 v90, s[20:23], s66 offen lds
    s_mov_b32 s70, 0x3fb8aa3b
    s_mov_b32 s71, 0x3fb8aa3b
    s_and_b32 s66, s44, 2
    s_lshl_b32 s67, s66, 2
    s_add_u32 s67, s67, 155648
    v_mov_b32 v10, s67
    s_lshl_b32 s66, s66, 12
    s_and_b32 s67, s44, 1
    s_lshl_b32 s67, s67, 10
    v_add_u32 v11, s66, v9
    v_add_u32 v12, s67, v11
    v_add_u32 v11, 65536, v11
    v_mov_b32 v204, 0x3f803f80
    v_mov_b32 v205, 0x3f803f80
    v_mov_b32 v206, 0x3f803f80
    v_mov_b32 v207, 0x3f803f80
H_fk:
    ds_read_b64 v[14:15], v10
    s_waitcnt lgkmcnt(0)
    v_min_u32 v14, v14, v15
    v_cmp_eq_u32 vcc, 0, v14
    s_cbranch_vccnz H_fk
    ds_read_b128 v[16:19], v12 offset:0
    ds_read_b128 v[20:23], v12 offset:2048
    ds_read_b128 v[24:27], v12 offset:4096
    ds_read_b128 v[28:31], v12 offset:6144
    s_waitcnt lgkmcnt(3)
    v_lshlrev_b32 v72, 16, v16
    v_and_b32 v73, 0xffff0000, v16
    v_pk_mul_f32 v[74:75], v[72:73], s[70:71]
    v_pk_add_f32 v[72:73], v[72:73], 1.0 op_sel_hi:[1,0]
    v_exp_f32 v74, v74 clamp
    v_exp_f32 v75, v75 clamp
    v_lshlrev_b32 v76, 16, v17
    v_and_b32 v77, 0xffff0000, v17
    v_pk_mul_f32 v[78:79], v[76:77], s[70:71]
    v_pk_add_f32 v[76:77], v[76:77], 1.0 op_sel_hi:[1,0]
    v_exp_f32 v78, v78 clamp
    v_exp_f32 v79, v79 clamp
    v_max_f32 v72, v72, v74
    v_max_f32 v73, v73, v75
    v_cvt_pk_bf16_f32 v32, v72, v73
    v_max_f32 v76, v76, v78
    v_max_f32 v77, v77, v79
    v_cvt_pk_bf16_f32 v33, v76, v77
    v_lshlrev_b32 v72, 16, v18
    v_and_b32 v73, 0xffff0000, v18
    v_pk_mul_f32 v[74:75], v[72:73], s[70:71]
    v_pk_add_f32 v[72:73], v[72:73], 1.0 op_sel_hi:[1,0]
    v_exp_f32 v74, v74 clamp
    v_exp_f32 v75, v75 clamp
    v_lshlrev_b32 v76, 16, v19
    v_and_b32 v77, 0xffff0000, v19
    v_pk_mul_f32 v[78:79], v[76:77], s[70:71]
    v_pk_add_f32 v[76:77], v[76:77], 1.0 op_sel_hi:[1,0]
    v_exp_f32 v78, v78 clamp
    v_exp_f32 v79, v79 clamp
    v_max_f32 v72, v72, v74
    v_max_f32 v73, v73, v75
    v_cvt_pk_bf16_f32 v34, v72, v73
    v_max_f32 v76, v76, v78
    v_max_f32 v77, v77, v79
    v_cvt_pk_bf16_f32 v35, v76, v77
    s_waitcnt lgkmcnt(2)
    v_lshlrev_b32 v72, 16, v20
    v_and_b32 v73, 0xffff0000, v20
    v_pk_mul_f32 v[74:75], v[72:73], s[70:71]
    v_pk_add_f32 v[72:73], v[72:73], 1.0 op_sel_hi:[1,0]
    v_exp_f32 v74, v74 clamp
    v_exp_f32 v75, v75 clamp
    v_lshlrev_b32 v76, 16, v21
    v_and_b32 v77, 0xffff0000, v21
    v_pk_mul_f32 v[78:79], v[76:77], s[70:71]
    v_pk_add_f32 v[76:77], v[76:77], 1.0 op_sel_hi:[1,0]
    v_exp_f32 v78, v78 clamp
    v_exp_f32 v79, v79 clamp
    v_max_f32 v72, v72, v74
    v_max_f32 v73, v73, v75
    v_cvt_pk_bf16_f32 v36, v72, v73
    v_max_f32 v76, v76, v78
    v_max_f32 v77, v77, v79
    v_cvt_pk_bf16_f32 v37, v76, v77
    v_lshlrev_b32 v72, 16, v22
    v_and_b32 v73, 0xffff0000, v22
    v_pk_mul_f32 v[74:75], v[72:73], s[70:71]
    v_pk_add_f32 v[72:73], v[72:73], 1.0 op_sel_hi:[1,0]
    v_exp_f32 v74, v74 clamp
    v_exp_f32 v75, v75 clamp
    v_lshlrev_b32 v76, 16, v23
    v_and_b32 v77, 0xffff0000, v23
    v_pk_mul_f32 v[78:79], v[76:77], s[70:71]
    v_pk_add_f32 v[76:77], v[76:77], 1.0 op_sel_hi:[1,0]
    v_exp_f32 v78, v78 clamp
    v_exp_f32 v79, v79 clamp
    v_max_f32 v72, v72, v74
    v_max_f32 v73, v73, v75
    v_cvt_pk_bf16_f32 v38, v72, v73
    v_max_f32 v76, v76, v78
    v_max_f32 v77, v77, v79
    v_cvt_pk_bf16_f32 v39, v76, v77
    s_waitcnt lgkmcnt(1)
    v_lshlrev_b32 v72, 16, v24
    v_and_b32 v73, 0xffff0000, v24
    v_pk_mul_f32 v[74:75], v[72:73], s[70:71]
    v_pk_add_f32 v[72:73], v[72:73], 1.0 op_sel_hi:[1,0]
    v_exp_f32 v74, v74 clamp
    v_exp_f32 v75, v75 clamp
    v_lshlrev_b32 v76, 16, v25
    v_and_b32 v77, 0xffff0000, v25
    v_pk_mul_f32 v[78:79], v[76:77], s[70:71]
    v_pk_add_f32 v[76:77], v[76:77], 1.0 op_sel_hi:[1,0]
    v_exp_f32 v78, v78 clamp
    v_exp_f32 v79, v79 clamp
    v_max_f32 v72, v72, v74
    v_max_f32 v73, v73, v75
    v_cvt_pk_bf16_f32 v40, v72, v73
    v_max_f32 v76, v76, v78
    v_max_f32 v77, v77, v79
    v_cvt_pk_bf16_f32 v41, v76, v77
    v_lshlrev_b32 v72, 16, v26
    v_and_b32 v73, 0xffff0000, v26
    v_pk_mul_f32 v[74:75], v[72:73], s[70:71]
    v_pk_add_f32 v[72:73], v[72:73], 1.0 op_sel_hi:[1,0]
    v_exp_f32 v74, v74 clamp
    v_exp_f32 v75, v75 clamp
    v_lshlrev_b32 v76, 16, v27
    v_and_b32 v77, 0xffff0000, v27
    v_pk_mul_f32 v[78:79], v[76:77], s[70:71]
    v_pk_add_f32 v[76:77], v[76:77], 1.0 op_sel_hi:[1,0]
    v_exp_f32 v78, v78 clamp
    v_exp_f32 v79, v79 clamp
    v_max_f32 v72, v72, v74
    v_max_f32 v73, v73, v75
    v_cvt_pk_bf16_f32 v42, v72, v73
    v_max_f32 v76, v76, v78
    v_max_f32 v77, v77, v79
    v_cvt_pk_bf16_f32 v43, v76, v77
    s_waitcnt lgkmcnt(0)
    v_lshlrev_b32 v72, 16, v28
    v_and_b32 v73, 0xffff0000, v28
    v_pk_mul_f32 v[74:75], v[72:73], s[70:71]
    v_pk_add_f32 v[72:73], v[72:73], 1.0 op_sel_hi:[1,0]
    v_exp_f32 v74, v74 clamp
    v_exp_f32 v75, v75 clamp
    v_lshlrev_b32 v76, 16, v29
    v_and_b32 v77, 0xffff0000, v29
    v_pk_mul_f32 v[78:79], v[76:77], s[70:71]
    v_pk_add_f32 v[76:77], v[76:77], 1.0 op_sel_hi:[1,0]
    v_exp_f32 v78, v78 clamp
    v_exp_f32 v79, v79 clamp
    v_max_f32 v72, v72, v74
    v_max_f32 v73, v73, v75
    v_cvt_pk_bf16_f32 v44, v72, v73
    v_max_f32 v76, v76, v78
    v_max_f32 v77, v77, v79
    v_cvt_pk_bf16_f32 v45, v76, v77
    v_lshlrev_b32 v72, 16, v30
    v_and_b32 v73, 0xffff0000, v30
    v_pk_mul_f32 v[74:75], v[72:73], s[70:71]
    v_pk_add_f32 v[72:73], v[72:73], 1.0 op_sel_hi:[1,0]
    v_exp_f32 v74, v74 clamp
    v_exp_f32 v75, v75 clamp
    v_lshlrev_b32 v76, 16, v31
    v_and_b32 v77, 0xffff0000, v31
    v_pk_mul_f32 v[78:79], v[76:77], s[70:71]
    v_pk_add_f32 v[76:77], v[76:77], 1.0 op_sel_hi:[1,0]
    v_exp_f32 v78, v78 clamp
    v_exp_f32 v79, v79 clamp
    v_max_f32 v72, v72, v74
    v_max_f32 v73, v73, v75
    v_cvt_pk_bf16_f32 v46, v72, v73
    v_max_f32 v76, v76, v78
    v_max_f32 v77, v77, v79
    v_cvt_pk_bf16_f32 v47, v76, v77
H_fv:
    ds_read_b64 v[14:15], v10 offset:16
    s_waitcnt lgkmcnt(0)
    v_min_u32 v13, v14, v15
    v_cmp_eq_u32 vcc, 0, v13
    s_cbranch_vccnz H_fv
    ds_read_b128 v[208:211], v11 offset:0
    ds_read_b128 v[212:215], v11 offset:1024
    ds_read_b128 v[216:219], v11 offset:2048
    ds_read_b128 v[220:223], v11 offset:3072
    ds_read_b128 v[224:227], v11 offset:4096
    ds_read_b128 v[228:231], v11 offset:5120
    ds_read_b128 v[232:235], v11 offset:6144
    ds_read_b128 v[236:239], v11 offset:7168
    v_max_u32 v13, v14, v15
    v_cmp_eq_u32 vcc, 2, v13
    s_cbranch_vccnz H_eps
    v_mfma_f32_16x16x32_bf16 v[200:203], v[32:35], v[204:207], 0
    s_waitcnt lgkmcnt(7)
    v_mfma_f32_16x16x32_bf16 v[192:195], v[32:35], v[208:211], 0
    s_waitcnt lgkmcnt(6)
    v_mfma_f32_16x16x32_bf16 v[196:199], v[32:35], v[212:215], 0
    v_mfma_f32_16x16x32_bf16 v[200:203], v[36:39], v[204:207], v[200:203]
    s_waitcnt lgkmcnt(5)
    v_mfma_f32_16x16x32_bf16 v[192:195], v[36:39], v[216:219], v[192:195]
    s_waitcnt lgkmcnt(4)
    v_mfma_f32_16x16x32_bf16 v[196:199], v[36:39], v[220:223], v[196:199]
    v_mfma_f32_16x16x32_bf16 v[200:203], v[40:43], v[204:207], v[200:203]
    s_waitcnt lgkmcnt(3)
    v_mfma_f32_16x16x32_bf16 v[192:195], v[40:43], v[224:227], v[192:195]
    s_waitcnt lgkmcnt(2)
    v_mfma_f32_16x16x32_bf16 v[196:199], v[40:43], v[228:231], v[196:199]
    v_mfma_f32_16x16x32_bf16 v[200:203], v[44:47], v[204:207], v[200:203]
    s_waitcnt lgkmcnt(1)
    v_mfma_f32_16x16x32_bf16 v[192:195], v[44:47], v[232:235], v[192:195]
    s_waitcnt lgkmcnt(0)
    v_mfma_f32_16x16x32_bf16 v[196:199], v[44:47], v[236:239], v[196:199]
H_ne:
    v_lshrrev_b32 v13, 4, v2
    v_lshlrev_b32 v13, 4, v13
    v_and_b32 v14, 15, v2
    v_cmp_eq_u32 s[68:69], 0, v14
    s_lshl_b32 s66, s44, 11
    s_add_u32 s66, s66, 139264
    v_add_u32 v3, s66, v9
    s_waitcnt vmcnt(12)
    s_nop 1
    v_cvt_pk_bf16_f32 v72, v192, v193
    v_cvt_pk_bf16_f32 v73, v194, v195
    v_cvt_pk_bf16_f32 v74, v196, v197
    v_cvt_pk_bf16_f32 v75, v198, v199
    buffer_store_dwordx4 v[72:75], v9, s[16:19], s56 offen sc0 sc1
    s_mov_b64 exec, s[68:69]
    buffer_store_dwordx4 v[200:203], v13, s[16:19], s53 offen sc0 sc1
    s_mov_b64 exec, -1
    s_add_u32 s67, s52, 262144
    s_and_b32 s67, s67, 0x1fffff
    s_add_u32 m0, s72, 32768
    s_add_u32 s66, s67, 0
    buffer_load_dwordx4 v90, s[20:23], s66 offen lds
    s_add_u32 m0, s72, 36864
    s_add_u32 s66, s67, 65536
    buffer_load_dwordx4 v90, s[20:23], s66 offen lds
    s_add_u32 s67, s52, 262144
    s_and_b32 s67, s67, 0x1fffff
    s_add_u32 m0, s72, 49152
    s_add_u32 s66, s67, 131072
    buffer_load_dwordx4 v90, s[20:23], s66 offen lds
    s_add_u32 m0, s72, 53248
    s_add_u32 s66, s67, 196608
    buffer_load_dwordx4 v90, s[20:23], s66 offen lds
    v_bfe_u32 v12, v2, 4, 1
    v_lshrrev_b32 v13, 5, v2
    v_lshl_add_u32 v12, v12, 1, v13
    v_bfe_u32 v13, v2, 1, 3
    v_xor_b32 v12, v12, v13
    v_and_b32 v13, 127, v92
    v_lshlrev_b32 v13, 7, v13
    v_lshl_add_u32 v12, v12, 4, v13
    v_add_u32 v12, 122880, v12
    v_xor_b32 v13, 64, v12
    ds_read_b128 v[144:147], v12
    ds_read_b128 v[148:151], v13
    s_waitcnt lgkmcnt(0)
    s_setprio 0
    s_barrier
    ds_read_b128 v[16:19], v3
    ds_read_b128 v[20:23], v3 offset:1024
    buffer_load_dwordx4 v[80:83], v1, s[16:19], s62 offen sc1
    buffer_load_dwordx4 v[84:87], v1, s[16:19], s63 offen sc1
    s_add_u32 s67, s52, 524288
    s_and_b32 s67, s67, 0x1fffff
    s_add_u32 m0, s72, 81920
    s_add_u32 s66, s67, 0
    buffer_load_dwordx4 v90, s[20:23], s66 offen lds
    s_add_u32 m0, s72, 86016
    s_add_u32 s66, s67, 65536
    buffer_load_dwordx4 v90, s[20:23], s66 offen lds
    s_add_u32 s67, s52, 524288
    s_and_b32 s67, s67, 0x1fffff
    s_add_u32 m0, s72, 90112
    s_add_u32 s66, s67, 131072
    buffer_load_dwordx4 v90, s[20:23], s66 offen lds
    s_add_u32 m0, s72, 94208
    s_add_u32 s66, s67, 196608
    buffer_load_dwordx4 v90, s[20:23], s66 offen lds
    s_add_u32 s67, s52, 786432
    s_and_b32 s67, s67, 0x1fffff
    s_add_u32 m0, s72, 0
    s_add_u32 s66, s67, 0
    buffer_load_dwordx4 v90, s[20:23], s66 offen lds
    s_add_u32 m0, s72, 4096
    s_add_u32 s66, s67, 65536
    buffer_load_dwordx4 v90, s[20:23], s66 offen lds
    s_add_u32 s67, s52, 786432
    s_and_b32 s67, s67, 0x1fffff
    s_add_u32 m0, s72, 57344
    s_add_u32 s66, s67, 131072
    buffer_load_dwordx4 v90, s[20:23], s66 offen lds
    s_add_u32 m0, s72, 61440
    s_add_u32 s66, s67, 196608
    buffer_load_dwordx4 v90, s[20:23], s66 offen lds
    s_waitcnt lgkmcnt(0)
    v_lshlrev_b32 v32, 16, v16
    v_and_b32 v33, 0xffff0000, v16
    v_pk_mul_f32 v[34:35], v[32:33], s[70:71]
    v_pk_add_f32 v[32:33], v[32:33], 1.0 op_sel_hi:[1,0]
    v_exp_f32 v34, v34 clamp
    v_exp_f32 v35, v35 clamp
    v_lshlrev_b32 v36, 16, v17
    v_and_b32 v37, 0xffff0000, v17
    v_pk_mul_f32 v[38:39], v[36:37], s[70:71]
    v_pk_add_f32 v[36:37], v[36:37], 1.0 op_sel_hi:[1,0]
    v_exp_f32 v38, v38 clamp
    v_exp_f32 v39, v39 clamp
    v_max_f32 v32, v32, v34
    v_max_f32 v33, v33, v35
    v_min_f32 v40, v32, v33
    v_cvt_pk_bf16_f32 v24, v32, v33
    v_max_f32 v36, v36, v38
    v_max_f32 v37, v37, v39
    v_min3_f32 v40, v36, v37, v40
    v_cvt_pk_bf16_f32 v25, v36, v37
    v_lshlrev_b32 v32, 16, v18
    v_and_b32 v33, 0xffff0000, v18
    v_pk_mul_f32 v[34:35], v[32:33], s[70:71]
    v_pk_add_f32 v[32:33], v[32:33], 1.0 op_sel_hi:[1,0]
    v_exp_f32 v34, v34 clamp
    v_exp_f32 v35, v35 clamp
    v_lshlrev_b32 v36, 16, v19
    v_and_b32 v37, 0xffff0000, v19
    v_pk_mul_f32 v[38:39], v[36:37], s[70:71]
    v_pk_add_f32 v[36:37], v[36:37], 1.0 op_sel_hi:[1,0]
    v_exp_f32 v38, v38 clamp
    v_exp_f32 v39, v39 clamp
    v_max_f32 v32, v32, v34
    v_max_f32 v33, v33, v35
    v_min3_f32 v40, v32, v33, v40
    v_cvt_pk_bf16_f32 v26, v32, v33
    v_max_f32 v36, v36, v38
    v_max_f32 v37, v37, v39
    v_min3_f32 v40, v36, v37, v40
    v_cvt_pk_bf16_f32 v27, v36, v37
    v_lshlrev_b32 v32, 16, v20
    v_and_b32 v33, 0xffff0000, v20
    v_pk_mul_f32 v[34:35], v[32:33], s[70:71]
    v_pk_add_f32 v[32:33], v[32:33], 1.0 op_sel_hi:[1,0]
    v_exp_f32 v34, v34 clamp
    v_exp_f32 v35, v35 clamp
    v_lshlrev_b32 v36, 16, v21
    v_and_b32 v37, 0xffff0000, v21
    v_pk_mul_f32 v[38:39], v[36:37], s[70:71]
    v_pk_add_f32 v[36:37], v[36:37], 1.0 op_sel_hi:[1,0]
    v_exp_f32 v38, v38 clamp
    v_exp_f32 v39, v39 clamp
    v_max_f32 v32, v32, v34
    v_max_f32 v33, v33, v35
    v_min3_f32 v40, v32, v33, v40
    v_cvt_pk_bf16_f32 v28, v32, v33
    v_max_f32 v36, v36, v38
    v_max_f32 v37, v37, v39
    v_min3_f32 v40, v36, v37, v40
    v_cvt_pk_bf16_f32 v29, v36, v37
    v_lshlrev_b32 v32, 16, v22
    v_and_b32 v33, 0xffff0000, v22
    v_pk_mul_f32 v[34:35], v[32:33], s[70:71]
    v_pk_add_f32 v[32:33], v[32:33], 1.0 op_sel_hi:[1,0]
    v_exp_f32 v34, v34 clamp
    v_exp_f32 v35, v35 clamp
    v_lshlrev_b32 v36, 16, v23
    v_and_b32 v37, 0xffff0000, v23
    v_pk_mul_f32 v[38:39], v[36:37], s[70:71]
    v_pk_add_f32 v[36:37], v[36:37], 1.0 op_sel_hi:[1,0]
    v_exp_f32 v38, v38 clamp
    v_exp_f32 v39, v39 clamp
    v_max_f32 v32, v32, v34
    v_max_f32 v33, v33, v35
    v_min3_f32 v40, v32, v33, v40
    v_cvt_pk_bf16_f32 v30, v32, v33
    v_max_f32 v36, v36, v38
    v_max_f32 v37, v37, v39
    v_min3_f32 v40, v36, v37, v40
    v_cvt_pk_bf16_f32 v31, v36, v37
    v_cmp_gt_f32 vcc, 0x3a800000, v40
    s_cbranch_vccz P_qh
    v_lshlrev_b32 v32, 16, v24
    v_and_b32 v33, 0xffff0000, v24
    v_add_f32 v32, s47, v32
    v_add_f32 v33, s47, v33
    v_cvt_pk_bf16_f32 v24, v32, v33
    v_lshlrev_b32 v32, 16, v25
    v_and_b32 v33, 0xffff0000, v25
    v_add_f32 v32, s47, v32
    v_add_f32 v33, s47, v33
    v_cvt_pk_bf16_f32 v25, v32, v33
    v_lshlrev_b32 v32, 16, v26
    v_and_b32 v33, 0xffff0000, v26
    v_add_f32 v32, s47, v32
    v_add_f32 v33, s47, v33
    v_cvt_pk_bf16_f32 v26, v32, v33
    v_lshlrev_b32 v32, 16, v27
    v_and_b32 v33, 0xffff0000, v27
    v_add_f32 v32, s47, v32
    v_add_f32 v33, s47, v33
    v_cvt_pk_bf16_f32 v27, v32, v33
    v_lshlrev_b32 v32, 16, v28
    v_and_b32 v33, 0xffff0000, v28
    v_add_f32 v32, s47, v32
    v_add_f32 v33, s47, v33
    v_cvt_pk_bf16_f32 v28, v32, v33
    v_lshlrev_b32 v32, 16, v29
    v_and_b32 v33, 0xffff0000, v29
    v_add_f32 v32, s47, v32
    v_add_f32 v33, s47, v33
    v_cvt_pk_bf16_f32 v29, v32, v33
    v_lshlrev_b32 v32, 16, v30
    v_and_b32 v33, 0xffff0000, v30
    v_add_f32 v32, s47, v32
    v_add_f32 v33, s47, v33
    v_cvt_pk_bf16_f32 v30, v32, v33
    v_lshlrev_b32 v32, 16, v31
    v_and_b32 v33, 0xffff0000, v31
    v_add_f32 v32, s47, v32
    v_add_f32 v33, s47, v33
    v_cvt_pk_bf16_f32 v31, v32, v33
P_qh:
    s_lshl_b32 s66, s49, 11
    s_add_u32 s66, s66, 159744
    v_add_u32 v10, s66, v9
    s_lshl_b32 s66, s49, 6
    s_add_u32 s66, s66, 159488
    v_lshrrev_b32 v11, 4, v2
    v_lshlrev_b32 v11, 4, v11
    v_add_u32 v11, s66, v11
    s_waitcnt vmcnt(8)
    s_mov_b32 s59, 0
Q_hchk:
    v_max3_u32 v5, v80, v81, v82
    v_max3_u32 v5, v5, v83, v84
    v_max3_u32 v5, v5, v85, v86
    v_max_u32 v5, v5, v87
    v_cmp_eq_u32 vcc, -1, v5
    s_cbranch_vccz Q_hok
    s_add_u32 s59, s59, 1
    s_cmp_ge_u32 s59, 200000
    s_cbranch_scc1 Q_hok
    s_sleep 4
    buffer_load_dwordx4 v[80:83], v1, s[16:19], s62 offen sc1
    buffer_load_dwordx4 v[84:87], v1, s[16:19], s63 offen sc1
    s_waitcnt vmcnt(0)
    s_branch Q_hchk
Q_hok:
    v_permlane16_swap_b32 v80, v82
    v_permlane16_swap_b32 v81, v83
    v_permlane16_swap_b32 v84, v86
    v_permlane16_swap_b32 v85, v87
    v_add_f32 v80, v80, v82
    v_add_f32 v81, v81, v83
    v_add_f32 v84, v84, v86
    v_add_f32 v85, v85, v87
    v_and_b32 v5, 3, v2
    v_lshlrev_b32 v5, 3, v5
    v_permlane32_swap_b32 v80, v81
    v_permlane32_swap_b32 v84, v85
    v_bfe_u32 v6, v2, 4, 1
    v_lshl_add_u32 v5, v6, 2, v5
    v_add_f32 v80, v80, v81
    v_add_f32 v84, v84, v85
    v_lshrrev_b32 v6, 5, v2
    v_lshl_add_u32 v5, v6, 1, v5
    v_add_f32_dpp v80, v80, v80 row_ror:4 row_mask:0xf bank_mask:0xf
    v_add_f32_dpp v84, v84, v84 row_ror:4 row_mask:0xf bank_mask:0xf
    s_nop 0
    v_add_f32_dpp v80, v80, v80 row_ror:8 row_mask:0xf bank_mask:0xf
    v_add_f32_dpp v84, v84, v84 row_ror:8 row_mask:0xf bank_mask:0xf
    s_nop 0
    s_lshl_b32 s66, s44, 5
    s_add_u32 s66, s66, 155712
    v_cvt_pk_bf16_f32 v80, 0, v80
    v_cvt_pk_bf16_f32 v84, 0, v84
    v_mul_f32 v81, s46, v80
    v_exp_f32 v81, -v81
    v_add_u32 v5, s66, v5
    v_add_f32 v81, 1.0, v81
    v_rcp_f32 v81, v81
    v_lshlrev_b32 v6, 4, v6
    v_mul_f32 v81, v81, v80
    v_cvt_pk_bf16_f32 v81, 0, v81
    v_add_u32 v6, s66, v6
    v_mul_f32 v81, v81, v84
    v_cvt_pk_bf16_f32 v81, v81, v81
    ds_write_b16 v5, v81
    ds_read_b128 v[84:87], v6
    v_mov_b32 v64, 0
    v_mov_b32 v65, 0
    v_mov_b32 v66, 0
    v_mov_b32 v67, 0
    v_mov_b32 v68, 0
    v_mov_b32 v69, 0
    v_mov_b32 v70, 0
    v_mov_b32 v71, 0
    s_waitcnt lgkmcnt(0)
    v_and_b32 v72, 0xffff, v84
    v_lshlrev_b32 v73, 16, v84
    v_dot2_f32_bf16 v64, v96, v72, v64
    v_dot2_f32_bf16 v65, v96, v73, v65
    v_dot2_f32_bf16 v66, v97, v72, v66
    v_dot2_f32_bf16 v67, v97, v73, v67
    v_dot2_f32_bf16 v68, v98, v72, v68
    v_dot2_f32_bf16 v69, v98, v73, v69
    v_dot2_f32_bf16 v70, v99, v72, v70
    v_dot2_f32_bf16 v71, v99, v73, v71
    v_lshrrev_b32 v72, 16, v84
    v_and_b32 v73, 0xffff0000, v84
    v_dot2_f32_bf16 v64, v100, v72, v64
    v_dot2_f32_bf16 v65, v100, v73, v65
    v_dot2_f32_bf16 v66, v101, v72, v66
    v_dot2_f32_bf16 v67, v101, v73, v67
    v_dot2_f32_bf16 v68, v102, v72, v68
    v_dot2_f32_bf16 v69, v102, v73, v69
    v_dot2_f32_bf16 v70, v103, v72, v70
    v_dot2_f32_bf16 v71, v103, v73, v71
    v_and_b32 v72, 0xffff, v85
    v_lshlrev_b32 v73, 16, v85
    v_dot2_f32_bf16 v64, v104, v72, v64
    v_dot2_f32_bf16 v65, v104, v73, v65
    v_dot2_f32_bf16 v66, v105, v72, v66
    v_dot2_f32_bf16 v67, v105, v73, v67
    v_dot2_f32_bf16 v68, v106, v72, v68
    v_dot2_f32_bf16 v69, v106, v73, v69
    v_dot2_f32_bf16 v70, v107, v72, v70
    v_dot2_f32_bf16 v71, v107, v73, v71
    v_lshrrev_b32 v72, 16, v85
    v_and_b32 v73, 0xffff0000, v85
    v_dot2_f32_bf16 v64, v108, v72, v64
    v_dot2_f32_bf16 v65, v108, v73, v65
    v_dot2_f32_bf16 v66, v109, v72, v66
    v_dot2_f32_bf16 v67, v109, v73, v67
    v_dot2_f32_bf16 v68, v110, v72, v68
    v_dot2_f32_bf16 v69, v110, v73, v69
    v_dot2_f32_bf16 v70, v111, v72, v70
    v_dot2_f32_bf16 v71, v111, v73, v71
    v_and_b32 v72, 0xffff, v86
    v_lshlrev_b32 v73, 16, v86
    v_dot2_f32_bf16 v64, v112, v72, v64
    v_dot2_f32_bf16 v65, v112, v73, v65
    v_dot2_f32_bf16 v66, v113, v72, v66
    v_dot2_f32_bf16 v67, v113, v73, v67
    v_dot2_f32_bf16 v68, v114, v72, v68
    v_dot2_f32_bf16 v69, v114, v73, v69
    v_dot2_f32_bf16 v70, v115, v72, v70
    v_dot2_f32_bf16 v71, v115, v73, v71
    v_lshrrev_b32 v72, 16, v86
    v_and_b32 v73, 0xffff0000, v86
    v_dot2_f32_bf16 v64, v116, v72, v64
    v_dot2_f32_bf16 v65, v116, v73, v65
    v_dot2_f32_bf16 v66, v117, v72, v66
    v_dot2_f32_bf16 v67, v117, v73, v67
    v_dot2_f32_bf16 v68, v118, v72, v68
    v_dot2_f32_bf16 v69, v118, v73, v69
    v_dot2_f32_bf16 v70, v119, v72, v70
    v_dot2_f32_bf16 v71, v119, v73, v71
    v_and_b32 v72, 0xffff, v87
    v_lshlrev_b32 v73, 16, v87
    v_dot2_f32_bf16 v64, v120, v72, v64
    v_dot2_f32_bf16 v65, v120, v73, v65
    v_dot2_f32_bf16 v66, v121, v72, v66
    v_dot2_f32_bf16 v67, v121, v73, v67
    v_dot2_f32_bf16 v68, v122, v72, v68
    v_dot2_f32_bf16 v69, v122, v73, v69
    v_dot2_f32_bf16 v70, v123, v72, v70
    v_dot2_f32_bf16 v71, v123, v73, v71
    v_lshrrev_b32 v72, 16, v87
    v_and_b32 v73, 0xffff0000, v87
    v_dot2_f32_bf16 v64, v124, v72, v64
    v_dot2_f32_bf16 v65, v124, v73, v65
    v_dot2_f32_bf16 v66, v125, v72, v66
    v_dot2_f32_bf16 v67, v125, v73, v67
    v_dot2_f32_bf16 v68, v126, v72, v68
    v_dot2_f32_bf16 v69, v126, v73, v69
    v_dot2_f32_bf16 v70, v127, v72, v70
    v_dot2_f32_bf16 v71, v127, v73, v71
    v_and_b32 v76, 31, v2
    v_lshrrev_b32 v77, 5, v2
    v_lshl_add_u32 v76, v76, 1, v77
    v_permlane32_swap_b32 v64, v68
    v_permlane32_swap_b32 v65, v69
    v_permlane32_swap_b32 v66, v70
    v_permlane32_swap_b32 v67, v71
    v_lshlrev_b32 v76, 4, v76
    v_add_f32 v64, v64, v68
    v_add_f32 v65, v65, v69
    v_add_f32 v66, v66, v70
    v_add_f32 v67, v67, v71
    s_add_u32 s66, s72, 147456
    v_add_u32 v76, s66, v76
    ds_write_b128 v76, v[64:67]
    s_lshl_b32 s66, s6, 6
    s_add_u32 s66, s66, 5242880
    v_lshlrev_b32 v15, 10, v2
    v_add_u32 v15, s66, v15
    s_cmp_lg_u32 s44, 0
    s_cbranch_scc1 H_pd
    s_mov_b32 s59, 0
H_pl:
    buffer_load_dword v14, v15, s[16:19], 0 offen sc1
    s_waitcnt vmcnt(0)
    v_cmp_eq_u32 vcc, -1, v14
    s_cbranch_vccz H_pd
    s_add_u32 s59, s59, 1
    s_cmp_ge_u32 s59, 200000
    s_cbranch_scc1 H_pd
    s_sleep 2
    s_branch H_pl
H_pd:
POST:
    s_waitcnt lgkmcnt(0)
    s_barrier
    s_mov_b32 s66, 6094848
    buffer_load_dword v152, v93, s[16:19], s66 offen sc1
    ds_read_b128 v[40:43], v11
    ds_read_b128 v[32:35], v10
    ds_read_b128 v[36:39], v10 offset:1024
    v_mov_b32 v3, 155684
    ds_read_b32 v4, v3
    s_waitcnt lgkmcnt(3)
    v_mfma_f32_16x16x32_bf16 v[60:63], v[40:43], v[24:27], 0
    v_mfma_f32_16x16x32_bf16 v[64:67], v[40:43], v[28:31], 0
    s_waitcnt lgkmcnt(1)
    v_mfma_f32_16x16x32_bf16 v[44:47], v[32:35], v[24:27], 0
    v_mfma_f32_16x16x32_bf16 v[48:51], v[36:39], v[24:27], 0
    v_mfma_f32_16x16x32_bf16 v[52:55], v[32:35], v[28:31], 0
    v_mfma_f32_16x16x32_bf16 v[56:59], v[36:39], v[28:31], 0
    s_nop 3
    v_cvt_pk_bf16_f32 v60, 0, v60
    v_cvt_pk_bf16_f32 v64, 0, v64
    v_add_f32 v60, s47, v60
    v_add_f32 v64, s47, v64
    v_cvt_pk_bf16_f32 v60, 0, v60
    v_cvt_pk_bf16_f32 v64, 0, v64
    v_rcp_f32 v60, v60
    v_rcp_f32 v64, v64
    v_cvt_pk_bf16_f32 v44, 0, v44
    v_cvt_pk_bf16_f32 v45, 0, v45
    v_cvt_pk_bf16_f32 v46, 0, v46
    v_cvt_pk_bf16_f32 v47, 0, v47
    v_cvt_pk_bf16_f32 v48, 0, v48
    v_cvt_pk_bf16_f32 v49, 0, v49
    v_cvt_pk_bf16_f32 v50, 0, v50
    v_cvt_pk_bf16_f32 v51, 0, v51
    v_pk_mul_f32 v[44:45], v[44:45], v[60:61] op_sel_hi:[1,0]
    v_pk_mul_f32 v[46:47], v[46:47], v[60:61] op_sel_hi:[1,0]
    v_pk_mul_f32 v[48:49], v[48:49], v[60:61] op_sel_hi:[1,0]
    v_pk_mul_f32 v[50:51], v[50:51], v[60:61] op_sel_hi:[1,0]
    v_cvt_pk_bf16_f32 v32, v44, v45
    v_cvt_pk_bf16_f32 v33, v46, v47
    v_cvt_pk_bf16_f32 v34, v48, v49
    v_cvt_pk_bf16_f32 v35, v50, v51
    buffer_store_dwordx4 v[32:35], v9, s[16:19], s60 offen sc0 sc1
    v_cvt_pk_bf16_f32 v52, 0, v52
    v_cvt_pk_bf16_f32 v53, 0, v53
    v_cvt_pk_bf16_f32 v54, 0, v54
    v_cvt_pk_bf16_f32 v55, 0, v55
    v_cvt_pk_bf16_f32 v56, 0, v56
    v_cvt_pk_bf16_f32 v57, 0, v57
    v_cvt_pk_bf16_f32 v58, 0, v58
    v_cvt_pk_bf16_f32 v59, 0, v59
    v_pk_mul_f32 v[52:53], v[52:53], v[64:65] op_sel_hi:[1,0]
    v_pk_mul_f32 v[54:55], v[54:55], v[64:65] op_sel_hi:[1,0]
    v_pk_mul_f32 v[56:57], v[56:57], v[64:65] op_sel_hi:[1,0]
    v_pk_mul_f32 v[58:59], v[58:59], v[64:65] op_sel_hi:[1,0]
    v_cvt_pk_bf16_f32 v36, v52, v53
    v_cvt_pk_bf16_f32 v37, v54, v55
    v_cvt_pk_bf16_f32 v38, v56, v57
    v_cvt_pk_bf16_f32 v39, v58, v59
    buffer_store_dwordx4 v[36:39], v9, s[16:19], s61 offen sc0 sc1
    s_waitcnt lgkmcnt(0)
    v_readfirstlane_b32 s74, v4
    s_waitcnt vmcnt(3)
    s_barrier
    s_lshl_b32 s53, s45, 12
    s_add_u32 s53, s53, s72
    s_lshl_b32 s54, s45, 16
    s_add_u32 s67, s52, 1048576
    s_and_b32 s67, s67, 0x1fffff
    s_add_u32 m0, s53, 8192
    s_add_u32 s67, s67, s54
    s_add_u32 s67, s67, 0
    buffer_load_dwordx4 v90, s[20:23], s67 offen lds
    s_add_u32 s67, s52, 1048576
    s_and_b32 s67, s67, 0x1fffff
    s_add_u32 m0, s53, 65536
    s_add_u32 s67, s67, s54
    s_add_u32 s67, s67, 131072
    buffer_load_dwordx4 v90, s[20:23], s67 offen lds
    s_add_u32 s67, s52, 1310720
    s_and_b32 s67, s67, 0x1fffff
    s_add_u32 m0, s53, 16384
    s_add_u32 s67, s67, s54
    s_add_u32 s67, s67, 0
    buffer_load_dwordx4 v90, s[20:23], s67 offen lds
    s_add_u32 s67, s52, 1310720
    s_and_b32 s67, s67, 0x1fffff
    s_add_u32 m0, s53, 73728
    s_add_u32 s67, s67, s54
    s_add_u32 s67, s67, 131072
    buffer_load_dwordx4 v90, s[20:23], s67 offen lds
    s_add_u32 s67, s52, 1572864
    s_and_b32 s67, s67, 0x1fffff
    s_add_u32 m0, s53, 98304
    s_add_u32 s67, s67, s54
    s_add_u32 s67, s67, 0
    buffer_load_dwordx4 v90, s[20:23], s67 offen lds
    s_add_u32 s67, s52, 1572864
    s_and_b32 s67, s67, 0x1fffff
    s_add_u32 m0, s53, 114688
    s_add_u32 s67, s67, s54
    s_add_u32 s67, s67, 131072
    buffer_load_dwordx4 v90, s[20:23], s67 offen lds
    s_add_u32 s67, s52, 1835008
    s_and_b32 s67, s67, 0x1fffff
    s_add_u32 m0, s53, 106496
    s_add_u32 s67, s67, s54
    s_add_u32 s67, s67, 0
    buffer_load_dwordx4 v90, s[20:23], s67 offen lds
    s_add_u32 s67, s52, 1835008
    s_and_b32 s67, s67, 0x1fffff
    s_add_u32 m0, s53, 122880
    s_add_u32 s67, s67, s54
    s_add_u32 s67, s67, 131072
    buffer_load_dwordx4 v90, s[20:23], s67 offen lds
    s_cmp_eq_u32 s45, 0
    s_cbranch_scc0 Q_hg
    s_branch Q_hd
Q_hg:
    s_waitcnt lgkmcnt(0)
Q_hd:
    s_and_b32 s75, s74, 0x7ff
    s_sub_u32 s75, 2047, s75
    s_lshl_b32 s66, s6, 3
    s_lshl_b32 s67, s44, 1
    s_add_u32 s66, s66, s67
    s_lshl_b32 s66, s66, 15
    s_lshl_b32 s67, s45, 11
    s_add_u32 s66, s66, s67
    s_lshl_b32 s67, s45, 15
    s_add_u32 s66, s66, s67
    v_add_u32 v4, s66, v9
    v_xor_b32 v3, 32768, v4
    s_lshr_b32 s63, s52, 6
    v_lshrrev_b32 v5, 4, v2
    v_bfe_u32 v6, v2, 2, 2
    v_lshl_add_u32 v8, v5, 2, v6
    v_bfe_u32 v6, v8, 1, 2
    v_lshlrev_b32 v8, 7, v8
    v_and_b32 v5, 3, v2
    v_lshl_add_u32 v8, v5, 3, v8
    s_mul_i32 s66, s45, 16384
    s_add_u32 s66, s66, 24576
    s_mul_i32 s67, s45, 8192
    s_add_u32 s67, s67, 81920
    s_mul_i32 s68, s45, 57344
    s_add_u32 s68, s68, 0
    s_mul_i32 s69, s45, 16384
    s_add_u32 s69, s69, 98304
    v_xor_b32 v5, 0, v6
    v_lshl_add_u32 v5, v5, 5, v8
    v_add_u32 v160, s66, v5
    v_add_u32 v164, s67, v5
    v_add_u32 v168, s68, v5
    v_add_u32 v172, s69, v5
    v_xor_b32 v5, 1, v6
    v_lshl_add_u32 v5, v5, 5, v8
    v_add_u32 v161, s66, v5
    v_add_u32 v165, s67, v5
    v_add_u32 v169, s68, v5
    v_add_u32 v173, s69, v5
    v_xor_b32 v5, 2, v6
    v_lshl_add_u32 v5, v5, 5, v8
    v_add_u32 v162, s66, v5
    v_add_u32 v166, s67, v5
    v_add_u32 v170, s68, v5
    v_add_u32 v174, s69, v5
    v_xor_b32 v5, 3, v6
    v_lshl_add_u32 v5, v5, 5, v8
    v_add_u32 v163, s66, v5
    v_add_u32 v167, s67, v5
    v_add_u32 v171, s68, v5
    v_add_u32 v175, s69, v5
    s_lshr_b32 s66, s75, 7
    s_cmp_eq_u32 s66, s6
    s_cselect_b32 s51, 1, 0
    s_barrier
    s_add_u32 s66, s63, 0
    s_and_b32 s66, s66, 32767
    buffer_load_dwordx4 v[96:99], v3, s[16:19], s66 offen offset:0 sc1
    buffer_load_dwordx4 v[100:103], v4, s[16:19], s66 offen offset:0 sc1
    buffer_load_dwordx4 v[104:107], v3, s[16:19], s66 offen offset:1024 sc1
    buffer_load_dwordx4 v[108:111], v4, s[16:19], s66 offen offset:1024 sc1
    s_cmp_eq_u32 s45, 0
    s_cbranch_scc1 Q_ny4
    s_lshl_b32 s66, s44, 8
    s_add_u32 s66, s66, 147456
    v_lshlrev_b32 v5, 2, v2
    v_add_u32 v6, s66, v5
    ds_read_b32 v64, v6 offset:0
    ds_read_b32 v65, v6 offset:1024
    ds_read_b32 v66, v6 offset:2048
    ds_read_b32 v67, v6 offset:3072
    s_waitcnt lgkmcnt(0)
    v_add_f32 v64, v64, v65
    v_add_f32 v66, v66, v67
    v_add_f32 v64, v64, v66
    buffer_store_dword v64, v5, s[16:19], s55 offen sc0 sc1
Q_ny4:
    s_add_u32 s66, s63, 4096
    s_and_b32 s66, s66, 32767
    buffer_load_dwordx4 v[112:115], v3, s[16:19], s66 offen offset:0 sc1
    buffer_load_dwordx4 v[116:119], v4, s[16:19], s66 offen offset:0 sc1
    buffer_load_dwordx4 v[120:123], v3, s[16:19], s66 offen offset:1024 sc1
    buffer_load_dwordx4 v[124:127], v4, s[16:19], s66 offen offset:1024 sc1
    ds_read_b64_tr_b16 v[192:193], v160 offset:0
    ds_read_b64_tr_b16 v[194:195], v160 offset:2048
    ds_read_b64_tr_b16 v[196:197], v161 offset:0
    ds_read_b64_tr_b16 v[198:199], v161 offset:2048
    ds_read_b64_tr_b16 v[200:201], v162 offset:0
    ds_read_b64_tr_b16 v[202:203], v162 offset:2048
    ds_read_b64_tr_b16 v[204:205], v163 offset:0
    ds_read_b64_tr_b16 v[206:207], v163 offset:2048
    s_waitcnt vmcnt(4)
    v_max3_u32 v5, v96, v97, v98
    v_max3_u32 v5, v5, v99, v100
    v_max3_u32 v5, v5, v101, v102
    v_max3_u32 v5, v5, v103, v104
    v_max3_u32 v5, v5, v105, v106
    v_max3_u32 v5, v5, v107, v108
    v_max3_u32 v5, v5, v109, v110
    v_max_u32 v5, v5, v111
    v_cmp_eq_u32 vcc, -1, v5
    s_cbranch_vccnz Q_rt0
Q_go0:
    s_add_u32 s66, s63, 8192
    s_and_b32 s66, s66, 32767
    s_waitcnt lgkmcnt(6)
    v_mfma_f32_16x16x32_bf16 v[224:227], v[192:195], v[96:99], 0
    buffer_load_dwordx4 v[128:131], v3, s[16:19], s66 offen offset:0 sc1
    v_mfma_f32_16x16x32_bf16 v[240:243], v[192:195], v[100:103], 0
    ds_read_b64_tr_b16 v[208:209], v160 offset:4096
    s_waitcnt lgkmcnt(5)
    v_mfma_f32_16x16x32_bf16 v[228:231], v[196:199], v[96:99], 0
    ds_read_b64_tr_b16 v[210:211], v160 offset:6144
    buffer_load_dwordx4 v[132:135], v4, s[16:19], s66 offen offset:0 sc1
    v_mfma_f32_16x16x32_bf16 v[244:247], v[196:199], v[100:103], 0
    ds_read_b64_tr_b16 v[212:213], v161 offset:4096
    s_waitcnt lgkmcnt(5)
    v_mfma_f32_16x16x32_bf16 v[232:235], v[200:203], v[96:99], 0
    ds_read_b64_tr_b16 v[214:215], v161 offset:6144
    buffer_load_dwordx4 v[136:139], v3, s[16:19], s66 offen offset:1024 sc1
    v_mfma_f32_16x16x32_bf16 v[248:251], v[200:203], v[100:103], 0
    ds_read_b64_tr_b16 v[216:217], v162 offset:4096
    s_waitcnt lgkmcnt(5)
    v_mfma_f32_16x16x32_bf16 v[236:239], v[204:207], v[96:99], 0
    ds_read_b64_tr_b16 v[218:219], v162 offset:6144
    buffer_load_dwordx4 v[140:143], v4, s[16:19], s66 offen offset:1024 sc1
    v_mfma_f32_16x16x32_bf16 v[252:255], v[204:207], v[100:103], 0
    ds_read_b64_tr_b16 v[220:221], v163 offset:4096
    ds_read_b64_tr_b16 v[222:223], v163 offset:6144
    s_waitcnt lgkmcnt(6)
    v_mfma_f32_16x16x32_bf16 v[224:227], v[208:211], v[104:107], v[224:227]
    v_mfma_f32_16x16x32_bf16 v[240:243], v[208:211], v[108:111], v[240:243]
    ds_read_b64_tr_b16 v[192:193], v160 offset:8192
    s_waitcnt lgkmcnt(5)
    v_mfma_f32_16x16x32_bf16 v[228:231], v[212:215], v[104:107], v[228:231]
    s_waitcnt vmcnt(4)
    ds_read_b64_tr_b16 v[194:195], v160 offset:10240
    v_max3_u32 v5, v112, v113, v114
    v_mfma_f32_16x16x32_bf16 v[244:247], v[212:215], v[108:111], v[244:247]
    ds_read_b64_tr_b16 v[196:197], v161 offset:8192
    v_max3_u32 v5, v5, v115, v116
    s_waitcnt lgkmcnt(5)
    v_mfma_f32_16x16x32_bf16 v[232:235], v[216:219], v[104:107], v[232:235]
    ds_read_b64_tr_b16 v[198:199], v161 offset:10240
    v_max3_u32 v5, v5, v117, v118
    v_mfma_f32_16x16x32_bf16 v[248:251], v[216:219], v[108:111], v[248:251]
    ds_read_b64_tr_b16 v[200:201], v162 offset:8192
    v_max3_u32 v5, v5, v119, v120
    v_max3_u32 v5, v5, v121, v122
    s_waitcnt lgkmcnt(5)
    v_mfma_f32_16x16x32_bf16 v[236:239], v[220:223], v[104:107], v[236:239]
    ds_read_b64_tr_b16 v[202:203], v162 offset:10240
    v_max3_u32 v5, v5, v123, v124
    v_max3_u32 v5, v5, v125, v126
    v_mfma_f32_16x16x32_bf16 v[252:255], v[220:223], v[108:111], v[252:255]
    ds_read_b64_tr_b16 v[204:205], v163 offset:8192
    ds_read_b64_tr_b16 v[206:207], v163 offset:10240
    v_max_u32 v5, v5, v127
    v_cmp_eq_u32 vcc, -1, v5
    s_cbranch_vccnz Q_rt1
Q_go1:
    s_add_u32 s66, s63, 12288
    s_and_b32 s66, s66, 32767
    s_waitcnt lgkmcnt(6)
    v_mfma_f32_16x16x32_bf16 v[224:227], v[192:195], v[112:115], v[224:227]
    buffer_load_dwordx4 v[96:99], v3, s[16:19], s66 offen offset:0 sc1
    v_mfma_f32_16x16x32_bf16 v[240:243], v[192:195], v[116:119], v[240:243]
    ds_read_b64_tr_b16 v[208:209], v160 offset:12288
    s_waitcnt lgkmcnt(5)
    v_mfma_f32_16x16x32_bf16 v[228:231], v[196:199], v[112:115], v[228:231]
    ds_read_b64_tr_b16 v[210:211], v160 offset:14336
    buffer_load_dwordx4 v[100:103], v4, s[16:19], s66 offen offset:0 sc1
    v_mfma_f32_16x16x32_bf16 v[244:247], v[196:199], v[116:119], v[244:247]
    ds_read_b64_tr_b16 v[212:213], v161 offset:12288
    s_waitcnt lgkmcnt(5)
    v_mfma_f32_16x16x32_bf16 v[232:235], v[200:203], v[112:115], v[232:235]
    ds_read_b64_tr_b16 v[214:215], v161 offset:14336
    buffer_load_dwordx4 v[104:107], v3, s[16:19], s66 offen offset:1024 sc1
    v_mfma_f32_16x16x32_bf16 v[248:251], v[200:203], v[116:119], v[248:251]
    ds_read_b64_tr_b16 v[216:217], v162 offset:12288
    s_waitcnt lgkmcnt(5)
    v_mfma_f32_16x16x32_bf16 v[236:239], v[204:207], v[112:115], v[236:239]
    ds_read_b64_tr_b16 v[218:219], v162 offset:14336
    buffer_load_dwordx4 v[108:111], v4, s[16:19], s66 offen offset:1024 sc1
    v_mfma_f32_16x16x32_bf16 v[252:255], v[204:207], v[116:119], v[252:255]
    ds_read_b64_tr_b16 v[220:221], v163 offset:12288
    ds_read_b64_tr_b16 v[222:223], v163 offset:14336
    s_waitcnt lgkmcnt(0)
    s_barrier
    s_waitcnt lgkmcnt(6)
    v_mfma_f32_16x16x32_bf16 v[224:227], v[208:211], v[120:123], v[224:227]
    v_mfma_f32_16x16x32_bf16 v[240:243], v[208:211], v[124:127], v[240:243]
    ds_read_b64_tr_b16 v[192:193], v164 offset:0
    s_waitcnt lgkmcnt(5)
    v_mfma_f32_16x16x32_bf16 v[228:231], v[212:215], v[120:123], v[228:231]
    s_waitcnt vmcnt(4)
    ds_read_b64_tr_b16 v[194:195], v164 offset:2048
    v_max3_u32 v5, v128, v129, v130
    v_mfma_f32_16x16x32_bf16 v[244:247], v[212:215], v[124:127], v[244:247]
    ds_read_b64_tr_b16 v[196:197], v165 offset:0
    v_max3_u32 v5, v5, v131, v132
    s_waitcnt lgkmcnt(5)
    v_mfma_f32_16x16x32_bf16 v[232:235], v[216:219], v[120:123], v[232:235]
    ds_read_b64_tr_b16 v[198:199], v165 offset:2048
    v_max3_u32 v5, v5, v133, v134
    v_mfma_f32_16x16x32_bf16 v[248:251], v[216:219], v[124:127], v[248:251]
    ds_read_b64_tr_b16 v[200:201], v166 offset:0
    v_max3_u32 v5, v5, v135, v136
    v_max3_u32 v5, v5, v137, v138
    s_waitcnt lgkmcnt(5)
    v_mfma_f32_16x16x32_bf16 v[236:239], v[220:223], v[120:123], v[236:239]
    ds_read_b64_tr_b16 v[202:203], v166 offset:2048
    v_max3_u32 v5, v5, v139, v140
    v_max3_u32 v5, v5, v141, v142
    v_mfma_f32_16x16x32_bf16 v[252:255], v[220:223], v[124:127], v[252:255]
    ds_read_b64_tr_b16 v[204:205], v167 offset:0
    ds_read_b64_tr_b16 v[206:207], v167 offset:2048
    v_max_u32 v5, v5, v143
    v_cmp_eq_u32 vcc, -1, v5
    s_cbranch_vccnz Q_rt2
Q_go2:
    s_add_u32 s66, s63, 16384
    s_and_b32 s66, s66, 32767
    s_waitcnt lgkmcnt(6)
    v_mfma_f32_16x16x32_bf16 v[224:227], v[192:195], v[128:131], v[224:227]
    buffer_load_dwordx4 v[112:115], v3, s[16:19], s66 offen offset:0 sc1
    v_mfma_f32_16x16x32_bf16 v[240:243], v[192:195], v[132:135], v[240:243]
    ds_read_b64_tr_b16 v[208:209], v164 offset:4096
    s_waitcnt lgkmcnt(5)
    v_mfma_f32_16x16x32_bf16 v[228:231], v[196:199], v[128:131], v[228:231]
    ds_read_b64_tr_b16 v[210:211], v164 offset:6144
    buffer_load_dwordx4 v[116:119], v4, s[16:19], s66 offen offset:0 sc1
    v_mfma_f32_16x16x32_bf16 v[244:247], v[196:199], v[132:135], v[244:247]
    ds_read_b64_tr_b16 v[212:213], v165 offset:4096
    s_waitcnt lgkmcnt(5)
    v_mfma_f32_16x16x32_bf16 v[232:235], v[200:203], v[128:131], v[232:235]
    ds_read_b64_tr_b16 v[214:215], v165 offset:6144
    buffer_load_dwordx4 v[120:123], v3, s[16:19], s66 offen offset:1024 sc1
    v_mfma_f32_16x16x32_bf16 v[248:251], v[200:203], v[132:135], v[248:251]
    ds_read_b64_tr_b16 v[216:217], v166 offset:4096
    s_waitcnt lgkmcnt(5)
    v_mfma_f32_16x16x32_bf16 v[236:239], v[204:207], v[128:131], v[236:239]
    ds_read_b64_tr_b16 v[218:219], v166 offset:6144
    buffer_load_dwordx4 v[124:127], v4, s[16:19], s66 offen offset:1024 sc1
    v_mfma_f32_16x16x32_bf16 v[252:255], v[204:207], v[132:135], v[252:255]
    ds_read_b64_tr_b16 v[220:221], v167 offset:4096
    ds_read_b64_tr_b16 v[222:223], v167 offset:6144
    s_waitcnt lgkmcnt(6)
    v_mfma_f32_16x16x32_bf16 v[224:227], v[208:211], v[136:139], v[224:227]
    v_mfma_f32_16x16x32_bf16 v[240:243], v[208:211], v[140:143], v[240:243]
    ds_read_b64_tr_b16 v[192:193], v168 offset:0
    s_waitcnt lgkmcnt(5)
    v_mfma_f32_16x16x32_bf16 v[228:231], v[212:215], v[136:139], v[228:231]
    s_waitcnt vmcnt(4)
    ds_read_b64_tr_b16 v[194:195], v168 offset:2048
    v_max3_u32 v5, v96, v97, v98
    v_mfma_f32_16x16x32_bf16 v[244:247], v[212:215], v[140:143], v[244:247]
    ds_read_b64_tr_b16 v[196:197], v169 offset:0
    v_max3_u32 v5, v5, v99, v100
    s_waitcnt lgkmcnt(5)
    v_mfma_f32_16x16x32_bf16 v[232:235], v[216:219], v[136:139], v[232:235]
    ds_read_b64_tr_b16 v[198:199], v169 offset:2048
    v_max3_u32 v5, v5, v101, v102
    v_mfma_f32_16x16x32_bf16 v[248:251], v[216:219], v[140:143], v[248:251]
    ds_read_b64_tr_b16 v[200:201], v170 offset:0
    v_max3_u32 v5, v5, v103, v104
    v_max3_u32 v5, v5, v105, v106
    s_waitcnt lgkmcnt(5)
    v_mfma_f32_16x16x32_bf16 v[236:239], v[220:223], v[136:139], v[236:239]
    ds_read_b64_tr_b16 v[202:203], v170 offset:2048
    v_max3_u32 v5, v5, v107, v108
    v_max3_u32 v5, v5, v109, v110
    v_mfma_f32_16x16x32_bf16 v[252:255], v[220:223], v[140:143], v[252:255]
    ds_read_b64_tr_b16 v[204:205], v171 offset:0
    ds_read_b64_tr_b16 v[206:207], v171 offset:2048
    v_max_u32 v5, v5, v111
    v_cmp_eq_u32 vcc, -1, v5
    s_cbranch_vccnz Q_rt3
Q_go3:
    s_add_u32 s66, s63, 20480
    s_and_b32 s66, s66, 32767
    s_waitcnt lgkmcnt(6)
    v_mfma_f32_16x16x32_bf16 v[224:227], v[192:195], v[96:99], v[224:227]
    buffer_load_dwordx4 v[128:131], v3, s[16:19], s66 offen offset:0 sc1
    v_mfma_f32_16x16x32_bf16 v[240:243], v[192:195], v[100:103], v[240:243]
    ds_read_b64_tr_b16 v[208:209], v168 offset:4096
    s_waitcnt lgkmcnt(5)
    v_mfma_f32_16x16x32_bf16 v[228:231], v[196:199], v[96:99], v[228:231]
    ds_read_b64_tr_b16 v[210:211], v168 offset:6144
    buffer_load_dwordx4 v[132:135], v4, s[16:19], s66 offen offset:0 sc1
    v_mfma_f32_16x16x32_bf16 v[244:247], v[196:199], v[100:103], v[244:247]
    ds_read_b64_tr_b16 v[212:213], v169 offset:4096
    s_waitcnt lgkmcnt(5)
    v_mfma_f32_16x16x32_bf16 v[232:235], v[200:203], v[96:99], v[232:235]
    ds_read_b64_tr_b16 v[214:215], v169 offset:6144
    buffer_load_dwordx4 v[136:139], v3, s[16:19], s66 offen offset:1024 sc1
    v_mfma_f32_16x16x32_bf16 v[248:251], v[200:203], v[100:103], v[248:251]
    ds_read_b64_tr_b16 v[216:217], v170 offset:4096
    s_waitcnt lgkmcnt(5)
    v_mfma_f32_16x16x32_bf16 v[236:239], v[204:207], v[96:99], v[236:239]
    ds_read_b64_tr_b16 v[218:219], v170 offset:6144
    buffer_load_dwordx4 v[140:143], v4, s[16:19], s66 offen offset:1024 sc1
    v_mfma_f32_16x16x32_bf16 v[252:255], v[204:207], v[100:103], v[252:255]
    ds_read_b64_tr_b16 v[220:221], v171 offset:4096
    ds_read_b64_tr_b16 v[222:223], v171 offset:6144
    s_waitcnt lgkmcnt(6)
    v_mfma_f32_16x16x32_bf16 v[224:227], v[208:211], v[104:107], v[224:227]
    v_mfma_f32_16x16x32_bf16 v[240:243], v[208:211], v[108:111], v[240:243]
    ds_read_b64_tr_b16 v[192:193], v168 offset:8192
    s_waitcnt lgkmcnt(5)
    v_mfma_f32_16x16x32_bf16 v[228:231], v[212:215], v[104:107], v[228:231]
    s_waitcnt vmcnt(4)
    ds_read_b64_tr_b16 v[194:195], v168 offset:10240
    v_max3_u32 v5, v112, v113, v114
    v_mfma_f32_16x16x32_bf16 v[244:247], v[212:215], v[108:111], v[244:247]
    ds_read_b64_tr_b16 v[196:197], v169 offset:8192
    v_max3_u32 v5, v5, v115, v116
    s_waitcnt lgkmcnt(5)
    v_mfma_f32_16x16x32_bf16 v[232:235], v[216:219], v[104:107], v[232:235]
    ds_read_b64_tr_b16 v[198:199], v169 offset:10240
    v_max3_u32 v5, v5, v117, v118
    v_mfma_f32_16x16x32_bf16 v[248:251], v[216:219], v[108:111], v[248:251]
    ds_read_b64_tr_b16 v[200:201], v170 offset:8192
    v_max3_u32 v5, v5, v119, v120
    v_max3_u32 v5, v5, v121, v122
    s_waitcnt lgkmcnt(5)
    v_mfma_f32_16x16x32_bf16 v[236:239], v[220:223], v[104:107], v[236:239]
    ds_read_b64_tr_b16 v[202:203], v170 offset:10240
    v_max3_u32 v5, v5, v123, v124
    v_max3_u32 v5, v5, v125, v126
    v_mfma_f32_16x16x32_bf16 v[252:255], v[220:223], v[108:111], v[252:255]
    ds_read_b64_tr_b16 v[204:205], v171 offset:8192
    ds_read_b64_tr_b16 v[206:207], v171 offset:10240
    v_max_u32 v5, v5, v127
    v_cmp_eq_u32 vcc, -1, v5
    s_cbranch_vccnz Q_rt4
Q_go4:
    s_cmp_eq_u32 s51, 0
    s_cbranch_scc1 Q_ny0
    s_lshl_b32 s64, s7, 14
    s_lshl_b32 s66, s3, 11
    s_add_u32 s64, s64, s66
    s_add_u32 s64, s64, 5832704
    buffer_load_dwordx4 v[32:35], v9, s[16:19], s64 offen offset:0 sc1
    buffer_load_dwordx4 v[36:39], v9, s[16:19], s64 offen offset:1024 sc1
Q_ny0:
    s_add_u32 s66, s63, 24576
    s_and_b32 s66, s66, 32767
    s_waitcnt lgkmcnt(6)
    v_mfma_f32_16x16x32_bf16 v[224:227], v[192:195], v[112:115], v[224:227]
    buffer_load_dwordx4 v[96:99], v3, s[16:19], s66 offen offset:0 sc1
    v_mfma_f32_16x16x32_bf16 v[240:243], v[192:195], v[116:119], v[240:243]
    ds_read_b64_tr_b16 v[208:209], v168 offset:12288
    s_waitcnt lgkmcnt(5)
    v_mfma_f32_16x16x32_bf16 v[228:231], v[196:199], v[112:115], v[228:231]
    ds_read_b64_tr_b16 v[210:211], v168 offset:14336
    buffer_load_dwordx4 v[100:103], v4, s[16:19], s66 offen offset:0 sc1
    v_mfma_f32_16x16x32_bf16 v[244:247], v[196:199], v[116:119], v[244:247]
    ds_read_b64_tr_b16 v[212:213], v169 offset:12288
    s_waitcnt lgkmcnt(5)
    v_mfma_f32_16x16x32_bf16 v[232:235], v[200:203], v[112:115], v[232:235]
    ds_read_b64_tr_b16 v[214:215], v169 offset:14336
    buffer_load_dwordx4 v[104:107], v3, s[16:19], s66 offen offset:1024 sc1
    v_mfma_f32_16x16x32_bf16 v[248:251], v[200:203], v[116:119], v[248:251]
    ds_read_b64_tr_b16 v[216:217], v170 offset:12288
    s_waitcnt lgkmcnt(5)
    v_mfma_f32_16x16x32_bf16 v[236:239], v[204:207], v[112:115], v[236:239]
    ds_read_b64_tr_b16 v[218:219], v170 offset:14336
    buffer_load_dwordx4 v[108:111], v4, s[16:19], s66 offen offset:1024 sc1
    v_mfma_f32_16x16x32_bf16 v[252:255], v[204:207], v[116:119], v[252:255]
    ds_read_b64_tr_b16 v[220:221], v171 offset:12288
    ds_read_b64_tr_b16 v[222:223], v171 offset:14336
    s_waitcnt lgkmcnt(6)
    v_mfma_f32_16x16x32_bf16 v[224:227], v[208:211], v[120:123], v[224:227]
    v_mfma_f32_16x16x32_bf16 v[240:243], v[208:211], v[124:127], v[240:243]
    ds_read_b64_tr_b16 v[192:193], v168 offset:16384
    s_waitcnt lgkmcnt(5)
    v_mfma_f32_16x16x32_bf16 v[228:231], v[212:215], v[120:123], v[228:231]
    s_waitcnt vmcnt(4)
    ds_read_b64_tr_b16 v[194:195], v168 offset:18432
    v_max3_u32 v5, v128, v129, v130
    v_mfma_f32_16x16x32_bf16 v[244:247], v[212:215], v[124:127], v[244:247]
    ds_read_b64_tr_b16 v[196:197], v169 offset:16384
    v_max3_u32 v5, v5, v131, v132
    s_waitcnt lgkmcnt(5)
    v_mfma_f32_16x16x32_bf16 v[232:235], v[216:219], v[120:123], v[232:235]
    ds_read_b64_tr_b16 v[198:199], v169 offset:18432
    v_max3_u32 v5, v5, v133, v134
    v_mfma_f32_16x16x32_bf16 v[248:251], v[216:219], v[124:127], v[248:251]
    ds_read_b64_tr_b16 v[200:201], v170 offset:16384
    v_max3_u32 v5, v5, v135, v136
    v_max3_u32 v5, v5, v137, v138
    s_waitcnt lgkmcnt(5)
    v_mfma_f32_16x16x32_bf16 v[236:239], v[220:223], v[120:123], v[236:239]
    ds_read_b64_tr_b16 v[202:203], v170 offset:18432
    v_max3_u32 v5, v5, v139, v140
    v_max3_u32 v5, v5, v141, v142
    v_mfma_f32_16x16x32_bf16 v[252:255], v[220:223], v[124:127], v[252:255]
    ds_read_b64_tr_b16 v[204:205], v171 offset:16384
    ds_read_b64_tr_b16 v[206:207], v171 offset:18432
    v_max_u32 v5, v5, v143
    v_cmp_eq_u32 vcc, -1, v5
    s_cbranch_vccnz Q_rt5
Q_go5:
    s_cmp_eq_u32 s45, 0
    s_cbranch_scc1 Q_np2
    s_setprio 1
Q_np2:
    s_cmp_eq_u32 s51, 0
    s_cbranch_scc1 Q_ny1
    s_mov_b32 s59, 0
Q_ychk:
    s_waitcnt vmcnt(0)
    v_max3_u32 v5, v32, v33, v34
    v_max3_u32 v5, v5, v35, v36
    v_max3_u32 v5, v5, v37, v38
    v_max_u32 v5, v5, v39
    v_cmp_eq_u32 vcc, -1, v5
    s_cbranch_vccz Q_yok
    s_add_u32 s59, s59, 1
    s_cmp_ge_u32 s59, 200000
    s_cbranch_scc1 Q_yok
    s_sleep 4
    buffer_load_dwordx4 v[32:35], v9, s[16:19], s64 offen offset:0 sc1
    buffer_load_dwordx4 v[36:39], v9, s[16:19], s64 offen offset:1024 sc1
    s_branch Q_ychk
Q_yok:
    v_add_f32 v32, v32, v36
    v_add_f32 v33, v33, v37
    v_add_f32 v34, v34, v38
    v_add_f32 v35, v35, v39
    s_nop 1
    v_permlane16_swap_b32 v32, v34
    v_permlane16_swap_b32 v33, v35
    v_add_f32 v32, v32, v34
    v_add_f32 v33, v33, v35
    v_and_b32 v5, 15, v2
    v_lshlrev_b32 v5, 4, v5
    v_permlane32_swap_b32 v32, v33
    v_bfe_u32 v8, v2, 4, 1
    v_lshl_add_u32 v5, v8, 3, v5
    v_lshrrev_b32 v8, 5, v2
    v_lshl_add_u32 v5, v8, 2, v5
    v_add_f32 v32, v32, v33
    s_lshl_b32 s66, s3, 8
    s_add_u32 s66, s66, 156992
    v_add_u32 v5, s66, v5
    ds_write_b32 v5, v32
    v_mov_b32 v5, 155688
    v_mov_b32 v8, 1
    s_mov_b64 exec, 1
    ds_add_u32 v5, v8
    s_mov_b64 exec, -1
    s_waitcnt lgkmcnt(0)
Q_ny1:
    s_add_u32 s66, s63, 28672
    s_and_b32 s66, s66, 32767
    s_waitcnt lgkmcnt(6)
    v_mfma_f32_16x16x32_bf16 v[224:227], v[192:195], v[128:131], v[224:227]
    buffer_load_dwordx4 v[112:115], v3, s[16:19], s66 offen offset:0 sc1
    v_mfma_f32_16x16x32_bf16 v[240:243], v[192:195], v[132:135], v[240:243]
    ds_read_b64_tr_b16 v[208:209], v168 offset:20480
    s_waitcnt lgkmcnt(5)
    v_mfma_f32_16x16x32_bf16 v[228:231], v[196:199], v[128:131], v[228:231]
    ds_read_b64_tr_b16 v[210:211], v168 offset:22528
    buffer_load_dwordx4 v[116:119], v4, s[16:19], s66 offen offset:0 sc1
    v_mfma_f32_16x16x32_bf16 v[244:247], v[196:199], v[132:135], v[244:247]
    ds_read_b64_tr_b16 v[212:213], v169 offset:20480
    s_waitcnt lgkmcnt(5)
    v_mfma_f32_16x16x32_bf16 v[232:235], v[200:203], v[128:131], v[232:235]
    ds_read_b64_tr_b16 v[214:215], v169 offset:22528
    buffer_load_dwordx4 v[120:123], v3, s[16:19], s66 offen offset:1024 sc1
    v_mfma_f32_16x16x32_bf16 v[248:251], v[200:203], v[132:135], v[248:251]
    ds_read_b64_tr_b16 v[216:217], v170 offset:20480
    s_waitcnt lgkmcnt(5)
    v_mfma_f32_16x16x32_bf16 v[236:239], v[204:207], v[128:131], v[236:239]
    ds_read_b64_tr_b16 v[218:219], v170 offset:22528
    buffer_load_dwordx4 v[124:127], v4, s[16:19], s66 offen offset:1024 sc1
    v_mfma_f32_16x16x32_bf16 v[252:255], v[204:207], v[132:135], v[252:255]
    ds_read_b64_tr_b16 v[220:221], v171 offset:20480
    ds_read_b64_tr_b16 v[222:223], v171 offset:22528
    s_waitcnt lgkmcnt(6)
    v_mfma_f32_16x16x32_bf16 v[224:227], v[208:211], v[136:139], v[224:227]
    v_mfma_f32_16x16x32_bf16 v[240:243], v[208:211], v[140:143], v[240:243]
    ds_read_b64_tr_b16 v[192:193], v172 offset:0
    s_waitcnt lgkmcnt(5)
    v_mfma_f32_16x16x32_bf16 v[228:231], v[212:215], v[136:139], v[228:231]
    s_waitcnt vmcnt(4)
    ds_read_b64_tr_b16 v[194:195], v172 offset:2048
    v_max3_u32 v5, v96, v97, v98
    v_mfma_f32_16x16x32_bf16 v[244:247], v[212:215], v[140:143], v[244:247]
    ds_read_b64_tr_b16 v[196:197], v173 offset:0
    v_max3_u32 v5, v5, v99, v100
    s_waitcnt lgkmcnt(5)
    v_mfma_f32_16x16x32_bf16 v[232:235], v[216:219], v[136:139], v[232:235]
    ds_read_b64_tr_b16 v[198:199], v173 offset:2048
    v_max3_u32 v5, v5, v101, v102
    v_mfma_f32_16x16x32_bf16 v[248:251], v[216:219], v[140:143], v[248:251]
    ds_read_b64_tr_b16 v[200:201], v174 offset:0
    v_max3_u32 v5, v5, v103, v104
    v_max3_u32 v5, v5, v105, v106
    s_waitcnt lgkmcnt(5)
    v_mfma_f32_16x16x32_bf16 v[236:239], v[220:223], v[136:139], v[236:239]
    ds_read_b64_tr_b16 v[202:203], v174 offset:2048
    v_max3_u32 v5, v5, v107, v108
    v_max3_u32 v5, v5, v109, v110
    v_mfma_f32_16x16x32_bf16 v[252:255], v[220:223], v[140:143], v[252:255]
    ds_read_b64_tr_b16 v[204:205], v175 offset:0
    ds_read_b64_tr_b16 v[206:207], v175 offset:2048
    v_max_u32 v5, v5, v111
    v_cmp_eq_u32 vcc, -1, v5
    s_cbranch_vccnz Q_rt6
Q_go6:
    s_waitcnt lgkmcnt(6)
    v_mfma_f32_16x16x32_bf16 v[224:227], v[192:195], v[96:99], v[224:227]
    v_sub_f32 v153, 1.0, v152
    v_cvt_pk_bf16_f32 v153, 0, v153
    v_lshlrev_b32 v16, 16, v144
    v_mfma_f32_16x16x32_bf16 v[240:243], v[192:195], v[100:103], v[240:243]
    ds_read_b64_tr_b16 v[208:209], v172 offset:4096
    v_and_b32 v17, 0xffff0000, v144
    v_mul_f32 v16, v16, v153
    v_mul_f32 v17, v17, v153
    s_waitcnt lgkmcnt(5)
    v_mfma_f32_16x16x32_bf16 v[228:231], v[196:199], v[96:99], v[228:231]
    ds_read_b64_tr_b16 v[210:211], v172 offset:6144
    v_cvt_pk_bf16_f32 v16, 0, v16
    v_cvt_pk_bf16_f32 v17, 0, v17
    v_lshlrev_b32 v18, 16, v145
    v_mfma_f32_16x16x32_bf16 v[244:247], v[196:199], v[100:103], v[244:247]
    ds_read_b64_tr_b16 v[212:213], v173 offset:4096
    v_and_b32 v19, 0xffff0000, v145
    v_mul_f32 v18, v18, v153
    v_mul_f32 v19, v19, v153
    s_waitcnt lgkmcnt(5)
    v_mfma_f32_16x16x32_bf16 v[232:235], v[200:203], v[96:99], v[232:235]
    ds_read_b64_tr_b16 v[214:215], v173 offset:6144
    v_cvt_pk_bf16_f32 v18, 0, v18
    v_cvt_pk_bf16_f32 v19, 0, v19
    v_lshlrev_b32 v20, 16, v146
    v_mfma_f32_16x16x32_bf16 v[248:251], v[200:203], v[100:103], v[248:251]
    ds_read_b64_tr_b16 v[216:217], v174 offset:4096
    v_and_b32 v21, 0xffff0000, v146
    v_mul_f32 v20, v20, v153
    v_mul_f32 v21, v21, v153
    s_waitcnt lgkmcnt(5)
    v_mfma_f32_16x16x32_bf16 v[236:239], v[204:207], v[96:99], v[236:239]
    ds_read_b64_tr_b16 v[218:219], v174 offset:6144
    v_cvt_pk_bf16_f32 v20, 0, v20
    v_cvt_pk_bf16_f32 v21, 0, v21
    v_lshlrev_b32 v22, 16, v147
    v_mfma_f32_16x16x32_bf16 v[252:255], v[204:207], v[100:103], v[252:255]
    ds_read_b64_tr_b16 v[220:221], v175 offset:4096
    ds_read_b64_tr_b16 v[222:223], v175 offset:6144
    v_and_b32 v23, 0xffff0000, v147
    v_mul_f32 v22, v22, v153
    v_mul_f32 v23, v23, v153
    s_waitcnt lgkmcnt(6)
    v_mfma_f32_16x16x32_bf16 v[224:227], v[208:211], v[104:107], v[224:227]
    v_mfma_f32_16x16x32_bf16 v[240:243], v[208:211], v[108:111], v[240:243]
    ds_read_b64_tr_b16 v[192:193], v172 offset:8192
    s_waitcnt lgkmcnt(5)
    v_mfma_f32_16x16x32_bf16 v[228:231], v[212:215], v[104:107], v[228:231]
    s_waitcnt vmcnt(0)
    ds_read_b64_tr_b16 v[194:195], v172 offset:10240
    v_max3_u32 v5, v112, v113, v114
    v_mfma_f32_16x16x32_bf16 v[244:247], v[212:215], v[108:111], v[244:247]
    ds_read_b64_tr_b16 v[196:197], v173 offset:8192
    v_max3_u32 v5, v5, v115, v116
    s_waitcnt lgkmcnt(5)
    v_mfma_f32_16x16x32_bf16 v[232:235], v[216:219], v[104:107], v[232:235]
    ds_read_b64_tr_b16 v[198:199], v173 offset:10240
    v_max3_u32 v5, v5, v117, v118
    v_mfma_f32_16x16x32_bf16 v[248:251], v[216:219], v[108:111], v[248:251]
    ds_read_b64_tr_b16 v[200:201], v174 offset:8192
    v_max3_u32 v5, v5, v119, v120
    v_max3_u32 v5, v5, v121, v122
    s_waitcnt lgkmcnt(5)
    v_mfma_f32_16x16x32_bf16 v[236:239], v[220:223], v[104:107], v[236:239]
    ds_read_b64_tr_b16 v[202:203], v174 offset:10240
    v_max3_u32 v5, v5, v123, v124
    v_max3_u32 v5, v5, v125, v126
    v_mfma_f32_16x16x32_bf16 v[252:255], v[220:223], v[108:111], v[252:255]
    ds_read_b64_tr_b16 v[204:205], v175 offset:8192
    ds_read_b64_tr_b16 v[206:207], v175 offset:10240
    v_max_u32 v5, v5, v127
    v_cmp_eq_u32 vcc, -1, v5
    s_cbranch_vccnz Q_rt7
Q_go7:
    s_waitcnt lgkmcnt(6)
    v_mfma_f32_16x16x32_bf16 v[224:227], v[192:195], v[112:115], v[224:227]
    v_cvt_pk_bf16_f32 v22, 0, v22
    v_cvt_pk_bf16_f32 v23, 0, v23
    v_lshlrev_b32 v24, 16, v148
    v_and_b32 v25, 0xffff0000, v148
    v_mul_f32 v24, v24, v153
    v_mfma_f32_16x16x32_bf16 v[240:243], v[192:195], v[116:119], v[240:243]
    ds_read_b64_tr_b16 v[208:209], v172 offset:12288
    v_mul_f32 v25, v25, v153
    v_cvt_pk_bf16_f32 v24, 0, v24
    v_cvt_pk_bf16_f32 v25, 0, v25
    v_lshlrev_b32 v26, 16, v149
    v_and_b32 v27, 0xffff0000, v149
    s_waitcnt lgkmcnt(5)
    v_mfma_f32_16x16x32_bf16 v[228:231], v[196:199], v[112:115], v[228:231]
    ds_read_b64_tr_b16 v[210:211], v172 offset:14336
    v_mul_f32 v26, v26, v153
    v_mul_f32 v27, v27, v153
    v_cvt_pk_bf16_f32 v26, 0, v26
    v_cvt_pk_bf16_f32 v27, 0, v27
    v_mfma_f32_16x16x32_bf16 v[244:247], v[196:199], v[116:119], v[244:247]
    ds_read_b64_tr_b16 v[212:213], v173 offset:12288
    v_lshlrev_b32 v28, 16, v150
    v_and_b32 v29, 0xffff0000, v150
    v_mul_f32 v28, v28, v153
    v_mul_f32 v29, v29, v153
    s_waitcnt lgkmcnt(5)
    v_mfma_f32_16x16x32_bf16 v[232:235], v[200:203], v[112:115], v[232:235]
    ds_read_b64_tr_b16 v[214:215], v173 offset:14336
    v_cvt_pk_bf16_f32 v28, 0, v28
    v_cvt_pk_bf16_f32 v29, 0, v29
    v_lshlrev_b32 v30, 16, v151
    v_and_b32 v31, 0xffff0000, v151
    v_mfma_f32_16x16x32_bf16 v[248:251], v[200:203], v[116:119], v[248:251]
    ds_read_b64_tr_b16 v[216:217], v174 offset:12288
    v_mul_f32 v30, v30, v153
    v_mul_f32 v31, v31, v153
    v_cvt_pk_bf16_f32 v30, 0, v30
    v_cvt_pk_bf16_f32 v31, 0, v31
    s_waitcnt lgkmcnt(5)
    v_mfma_f32_16x16x32_bf16 v[236:239], v[204:207], v[112:115], v[236:239]
    ds_read_b64_tr_b16 v[218:219], v174 offset:14336
    v_mov_b32 v154, v152
    v_mov_b32 v155, v152
    s_lshl_b32 s66, s3, 12
    s_add_u32 s67, s66, 24576
    v_mfma_f32_16x16x32_bf16 v[252:255], v[204:207], v[116:119], v[252:255]
    ds_read_b64_tr_b16 v[220:221], v175 offset:12288
    ds_read_b64_tr_b16 v[222:223], v175 offset:14336
    v_add_u32 v6, s67, v9
    s_xor_b32 s66, s66, 16384
    s_add_u32 s66, s66, 24576
    v_add_u32 v7, s66, v9
    s_waitcnt lgkmcnt(6)
    v_mfma_f32_16x16x32_bf16 v[224:227], v[208:211], v[120:123], v[224:227]
    s_waitcnt lgkmcnt(4)
    v_mfma_f32_16x16x32_bf16 v[228:231], v[212:215], v[120:123], v[228:231]
    s_waitcnt lgkmcnt(2)
    v_mfma_f32_16x16x32_bf16 v[232:235], v[216:219], v[120:123], v[232:235]
    s_waitcnt lgkmcnt(0)
    v_mfma_f32_16x16x32_bf16 v[236:239], v[220:223], v[120:123], v[236:239]
    v_mfma_f32_16x16x32_bf16 v[240:243], v[208:211], v[124:127], v[240:243]
    s_nop 0
    v_mfma_f32_16x16x32_bf16 v[244:247], v[212:215], v[124:127], v[244:247]
    s_nop 0
    v_mfma_f32_16x16x32_bf16 v[248:251], v[216:219], v[124:127], v[248:251]
    s_nop 0
    v_mfma_f32_16x16x32_bf16 v[252:255], v[220:223], v[124:127], v[252:255]
    s_nop 0
    ds_write_b128 v6, v[224:227] offset:0
    ds_write_b128 v6, v[228:231] offset:1024
    ds_write_b128 v6, v[232:235] offset:2048
    ds_write_b128 v6, v[236:239] offset:3072
    s_cmp_eq_u32 s51, 0
    s_cbranch_scc1 Q_ny2
    s_cmp_lg_u32 s3, 0
    s_cbranch_scc1 Q_ny2
    v_mov_b32 v5, 155688
Q_yw:
    ds_read_b32 v8, v5
    s_waitcnt lgkmcnt(0)
    v_cmp_ne_u32 vcc, 8, v8
    s_cbranch_vccnz Q_yw
    v_lshlrev_b32 v8, 2, v2
    v_add_u32 v8, 156992, v8
    ds_read_b32 v32, v8 offset:0
    ds_read_b32 v33, v8 offset:256
    ds_read_b32 v34, v8 offset:512
    ds_read_b32 v35, v8 offset:768
    ds_read_b32 v36, v8 offset:1024
    ds_read_b32 v37, v8 offset:1280
    ds_read_b32 v38, v8 offset:1536
    ds_read_b32 v39, v8 offset:1792
    s_and_b32 s66, s74, 0xffff0000
    s_xor_b32 s67, s66, 0x80000000
    s_not_b32 s68, s66
    s_and_b32 s68, s68, 0xffff0000
    s_cmp_ge_u32 s66, 0x80000000
    s_cselect_b32 s66, s67, s68
    v_mov_b32 v40, s66
    v_mul_f32 v40, s46, v40
    v_exp_f32 v40, -v40
    s_nop 0
    v_add_f32 v40, 1.0, v40
    v_rcp_f32 v40, v40
    s_nop 0
    v_cvt_pk_bf16_f32 v40, 0, v40
    s_waitcnt lgkmcnt(0)
    v_add_f32 v32, v32, v33
    v_add_f32 v32, v32, v34
    v_add_f32 v32, v32, v35
    v_add_f32 v32, v32, v36
    v_add_f32 v32, v32, v37
    v_add_f32 v32, v32, v38
    v_add_f32 v32, v32, v39
    v_cvt_pk_bf16_f32 v32, 0, v32
    v_mul_f32 v32, v32, v40
    v_cvt_pk_bf16_f32 v32, 0, v32
    ds_write_b32 v8, v32 offset:2048
    s_waitcnt lgkmcnt(0)
Q_ny2:
    s_waitcnt lgkmcnt(0)
    s_barrier
    ds_read_b128 v[224:227], v7 offset:0
    ds_read_b128 v[228:231], v7 offset:1024
    ds_read_b128 v[232:235], v7 offset:2048
    ds_read_b128 v[236:239], v7 offset:3072
    v_cmp_eq_u32 vcc, s75, v92
    s_and_saveexec_b64 s[68:69], vcc
    s_cbranch_execz Q_nr
    v_bfe_u32 v8, v2, 4, 1
    v_lshlrev_b32 v8, 6, v8
    v_lshrrev_b32 v5, 5, v2
    v_lshl_add_u32 v8, v5, 5, v8
    v_add_u32 v8, 159040, v8
    ds_read_b128 v[40:43], v8 offset:0
    ds_read_b128 v[44:47], v8 offset:16
    ds_read_b128 v[48:51], v8 offset:128
    ds_read_b128 v[52:55], v8 offset:144
    s_waitcnt lgkmcnt(0)
    v_lshlrev_b32 v16, 16, v144
    v_and_b32 v17, 0xffff0000, v144
    v_lshlrev_b32 v18, 16, v145
    v_and_b32 v19, 0xffff0000, v145
    v_lshlrev_b32 v20, 16, v146
    v_and_b32 v21, 0xffff0000, v146
    v_lshlrev_b32 v22, 16, v147
    v_and_b32 v23, 0xffff0000, v147
    v_lshlrev_b32 v24, 16, v148
    v_and_b32 v25, 0xffff0000, v148
    v_lshlrev_b32 v26, 16, v149
    v_and_b32 v27, 0xffff0000, v149
    v_lshlrev_b32 v28, 16, v150
    v_and_b32 v29, 0xffff0000, v150
    v_lshlrev_b32 v30, 16, v151
    v_and_b32 v31, 0xffff0000, v151
    v_add_f32 v16, v16, v40
    v_cvt_pk_bf16_f32 v16, 0, v16
    v_mul_f32 v16, v16, v153
    v_cvt_pk_bf16_f32 v16, 0, v16
    v_add_f32 v17, v17, v41
    v_cvt_pk_bf16_f32 v17, 0, v17
    v_mul_f32 v17, v17, v153
    v_cvt_pk_bf16_f32 v17, 0, v17
    v_add_f32 v18, v18, v42
    v_cvt_pk_bf16_f32 v18, 0, v18
    v_mul_f32 v18, v18, v153
    v_cvt_pk_bf16_f32 v18, 0, v18
    v_add_f32 v19, v19, v43
    v_cvt_pk_bf16_f32 v19, 0, v19
    v_mul_f32 v19, v19, v153
    v_cvt_pk_bf16_f32 v19, 0, v19
    v_add_f32 v20, v20, v44
    v_cvt_pk_bf16_f32 v20, 0, v20
    v_mul_f32 v20, v20, v153
    v_cvt_pk_bf16_f32 v20, 0, v20
    v_add_f32 v21, v21, v45
    v_cvt_pk_bf16_f32 v21, 0, v21
    v_mul_f32 v21, v21, v153
    v_cvt_pk_bf16_f32 v21, 0, v21
    v_add_f32 v22, v22, v46
    v_cvt_pk_bf16_f32 v22, 0, v22
    v_mul_f32 v22, v22, v153
    v_cvt_pk_bf16_f32 v22, 0, v22
    v_add_f32 v23, v23, v47
    v_cvt_pk_bf16_f32 v23, 0, v23
    v_mul_f32 v23, v23, v153
    v_cvt_pk_bf16_f32 v23, 0, v23
    v_add_f32 v24, v24, v48
    v_cvt_pk_bf16_f32 v24, 0, v24
    v_mul_f32 v24, v24, v153
    v_cvt_pk_bf16_f32 v24, 0, v24
    v_add_f32 v25, v25, v49
    v_cvt_pk_bf16_f32 v25, 0, v25
    v_mul_f32 v25, v25, v153
    v_cvt_pk_bf16_f32 v25, 0, v25
    v_add_f32 v26, v26, v50
    v_cvt_pk_bf16_f32 v26, 0, v26
    v_mul_f32 v26, v26, v153
    v_cvt_pk_bf16_f32 v26, 0, v26
    v_add_f32 v27, v27, v51
    v_cvt_pk_bf16_f32 v27, 0, v27
    v_mul_f32 v27, v27, v153
    v_cvt_pk_bf16_f32 v27, 0, v27
    v_add_f32 v28, v28, v52
    v_cvt_pk_bf16_f32 v28, 0, v28
    v_mul_f32 v28, v28, v153
    v_cvt_pk_bf16_f32 v28, 0, v28
    v_add_f32 v29, v29, v53
    v_cvt_pk_bf16_f32 v29, 0, v29
    v_mul_f32 v29, v29, v153
    v_cvt_pk_bf16_f32 v29, 0, v29
    v_add_f32 v30, v30, v54
    v_cvt_pk_bf16_f32 v30, 0, v30
    v_mul_f32 v30, v30, v153
    v_cvt_pk_bf16_f32 v30, 0, v30
    v_add_f32 v31, v31, v55
    v_cvt_pk_bf16_f32 v31, 0, v31
    v_mul_f32 v31, v31, v153
    v_cvt_pk_bf16_f32 v31, 0, v31
Q_nr:
    s_mov_b64 exec, s[68:69]
    s_waitcnt lgkmcnt(3)
    v_pk_add_f32 v[224:225], v[224:225], v[240:241]
    v_pk_add_f32 v[226:227], v[226:227], v[242:243]
    v_cvt_pk_bf16_f32 v40, v224, v225
    v_cvt_pk_bf16_f32 v41, v226, v227
    s_waitcnt lgkmcnt(2)
    v_pk_add_f32 v[228:229], v[228:229], v[244:245]
    v_pk_add_f32 v[230:231], v[230:231], v[246:247]
    v_cvt_pk_bf16_f32 v42, v228, v229
    v_cvt_pk_bf16_f32 v43, v230, v231
    s_waitcnt lgkmcnt(1)
    v_pk_add_f32 v[232:233], v[232:233], v[248:249]
    v_pk_add_f32 v[234:235], v[234:235], v[250:251]
    v_cvt_pk_bf16_f32 v44, v232, v233
    v_cvt_pk_bf16_f32 v45, v234, v235
    s_waitcnt lgkmcnt(0)
    v_pk_add_f32 v[236:237], v[236:237], v[252:253]
    v_pk_add_f32 v[238:239], v[238:239], v[254:255]
    v_cvt_pk_bf16_f32 v46, v236, v237
    v_cvt_pk_bf16_f32 v47, v238, v239
    s_nop 0
    v_permlane16_swap_b32 v40, v42
    v_permlane16_swap_b32 v41, v43
    v_permlane16_swap_b32 v44, v46
    v_permlane16_swap_b32 v45, v47
    v_lshlrev_b32 v224, 16, v40
    v_and_b32 v225, 0xffff0000, v40
    v_lshlrev_b32 v226, 16, v41
    v_and_b32 v227, 0xffff0000, v41
    v_lshlrev_b32 v228, 16, v42
    v_and_b32 v229, 0xffff0000, v42
    v_lshlrev_b32 v230, 16, v43
    v_and_b32 v231, 0xffff0000, v43
    v_pk_mul_f32 v[224:225], v[224:225], v[154:155]
    v_pk_mul_f32 v[226:227], v[226:227], v[154:155]
    v_pk_mul_f32 v[228:229], v[228:229], v[154:155]
    v_pk_mul_f32 v[230:231], v[230:231], v[154:155]
    v_cvt_pk_bf16_f32 v224, 0, v224
    v_cvt_pk_bf16_f32 v225, 0, v225
    v_cvt_pk_bf16_f32 v226, 0, v226
    v_cvt_pk_bf16_f32 v227, 0, v227
    v_cvt_pk_bf16_f32 v228, 0, v228
    v_cvt_pk_bf16_f32 v229, 0, v229
    v_cvt_pk_bf16_f32 v230, 0, v230
    v_cvt_pk_bf16_f32 v231, 0, v231
    v_pk_add_f32 v[224:225], v[224:225], v[16:17]
    v_pk_add_f32 v[226:227], v[226:227], v[18:19]
    v_pk_add_f32 v[228:229], v[228:229], v[20:21]
    v_pk_add_f32 v[230:231], v[230:231], v[22:23]
    v_cvt_pk_bf16_f32 v48, v224, v225
    v_cvt_pk_bf16_f32 v49, v226, v227
    v_cvt_pk_bf16_f32 v50, v228, v229
    v_cvt_pk_bf16_f32 v51, v230, v231
    buffer_store_dwordx4 v[48:51], v91, s[36:39], 0 offen offset:0 sc0 sc1
    v_lshlrev_b32 v232, 16, v44
    v_and_b32 v233, 0xffff0000, v44
    v_lshlrev_b32 v234, 16, v45
    v_and_b32 v235, 0xffff0000, v45
    v_lshlrev_b32 v236, 16, v46
    v_and_b32 v237, 0xffff0000, v46
    v_lshlrev_b32 v238, 16, v47
    v_and_b32 v239, 0xffff0000, v47
    v_pk_mul_f32 v[232:233], v[232:233], v[154:155]
    v_pk_mul_f32 v[234:235], v[234:235], v[154:155]
    v_pk_mul_f32 v[236:237], v[236:237], v[154:155]
    v_pk_mul_f32 v[238:239], v[238:239], v[154:155]
    v_cvt_pk_bf16_f32 v232, 0, v232
    v_cvt_pk_bf16_f32 v233, 0, v233
    v_cvt_pk_bf16_f32 v234, 0, v234
    v_cvt_pk_bf16_f32 v235, 0, v235
    v_cvt_pk_bf16_f32 v236, 0, v236
    v_cvt_pk_bf16_f32 v237, 0, v237
    v_cvt_pk_bf16_f32 v238, 0, v238
    v_cvt_pk_bf16_f32 v239, 0, v239
    v_pk_add_f32 v[232:233], v[232:233], v[24:25]
    v_pk_add_f32 v[234:235], v[234:235], v[26:27]
    v_pk_add_f32 v[236:237], v[236:237], v[28:29]
    v_pk_add_f32 v[238:239], v[238:239], v[30:31]
    v_cvt_pk_bf16_f32 v52, v232, v233
    v_cvt_pk_bf16_f32 v53, v234, v235
    v_cvt_pk_bf16_f32 v54, v236, v237
    v_cvt_pk_bf16_f32 v55, v238, v239
    buffer_store_dwordx4 v[52:55], v91, s[36:39], 0 offen offset:64 sc0 sc1
END:
    s_endpgm
Q_rt0:
    s_mov_b32 s59, 0
    s_add_u32 s67, s63, 0
    s_and_b32 s67, s67, 32767
Q_rl0:
    s_waitcnt vmcnt(0)
    s_add_u32 s59, s59, 1
    s_cmp_ge_u32 s59, 200000
    s_cbranch_scc1 Q_rd0
    s_sleep 1
    buffer_load_dwordx4 v[96:99], v3, s[16:19], s67 offen offset:0 sc1
    buffer_load_dwordx4 v[100:103], v4, s[16:19], s67 offen offset:0 sc1
    buffer_load_dwordx4 v[104:107], v3, s[16:19], s67 offen offset:1024 sc1
    buffer_load_dwordx4 v[108:111], v4, s[16:19], s67 offen offset:1024 sc1
    s_waitcnt vmcnt(0)
    v_max3_u32 v5, v96, v97, v98
    v_max3_u32 v5, v5, v99, v100
    v_max3_u32 v5, v5, v101, v102
    v_max3_u32 v5, v5, v103, v104
    v_max3_u32 v5, v5, v105, v106
    v_max3_u32 v5, v5, v107, v108
    v_max3_u32 v5, v5, v109, v110
    v_max_u32 v5, v5, v111
    v_cmp_eq_u32 vcc, -1, v5
    s_cbranch_vccnz Q_rl0
Q_rd0:
    s_add_u32 s67, s63, 4096
    s_and_b32 s67, s67, 32767
    buffer_load_dwordx4 v[112:115], v3, s[16:19], s67 offen offset:0 sc1
    buffer_load_dwordx4 v[116:119], v4, s[16:19], s67 offen offset:0 sc1
    buffer_load_dwordx4 v[120:123], v3, s[16:19], s67 offen offset:1024 sc1
    buffer_load_dwordx4 v[124:127], v4, s[16:19], s67 offen offset:1024 sc1
    s_branch Q_go0
Q_rt1:
    s_mov_b32 s59, 0
    s_add_u32 s67, s63, 4096
    s_and_b32 s67, s67, 32767
Q_rl1:
    s_waitcnt vmcnt(0)
    s_add_u32 s59, s59, 1
    s_cmp_ge_u32 s59, 200000
    s_cbranch_scc1 Q_rd1
    s_sleep 1
    buffer_load_dwordx4 v[112:115], v3, s[16:19], s67 offen offset:0 sc1
    buffer_load_dwordx4 v[116:119], v4, s[16:19], s67 offen offset:0 sc1
    buffer_load_dwordx4 v[120:123], v3, s[16:19], s67 offen offset:1024 sc1
    buffer_load_dwordx4 v[124:127], v4, s[16:19], s67 offen offset:1024 sc1
    s_waitcnt vmcnt(0)
    v_max3_u32 v5, v112, v113, v114
    v_max3_u32 v5, v5, v115, v116
    v_max3_u32 v5, v5, v117, v118
    v_max3_u32 v5, v5, v119, v120
    v_max3_u32 v5, v5, v121, v122
    v_max3_u32 v5, v5, v123, v124
    v_max3_u32 v5, v5, v125, v126
    v_max_u32 v5, v5, v127
    v_cmp_eq_u32 vcc, -1, v5
    s_cbranch_vccnz Q_rl1
Q_rd1:
    s_add_u32 s67, s63, 8192
    s_and_b32 s67, s67, 32767
    buffer_load_dwordx4 v[128:131], v3, s[16:19], s67 offen offset:0 sc1
    buffer_load_dwordx4 v[132:135], v4, s[16:19], s67 offen offset:0 sc1
    buffer_load_dwordx4 v[136:139], v3, s[16:19], s67 offen offset:1024 sc1
    buffer_load_dwordx4 v[140:143], v4, s[16:19], s67 offen offset:1024 sc1
    s_branch Q_go1
Q_rt2:
    s_mov_b32 s59, 0
    s_add_u32 s67, s63, 8192
    s_and_b32 s67, s67, 32767
Q_rl2:
    s_waitcnt vmcnt(0)
    s_add_u32 s59, s59, 1
    s_cmp_ge_u32 s59, 200000
    s_cbranch_scc1 Q_rd2
    s_sleep 1
    buffer_load_dwordx4 v[128:131], v3, s[16:19], s67 offen offset:0 sc1
    buffer_load_dwordx4 v[132:135], v4, s[16:19], s67 offen offset:0 sc1
    buffer_load_dwordx4 v[136:139], v3, s[16:19], s67 offen offset:1024 sc1
    buffer_load_dwordx4 v[140:143], v4, s[16:19], s67 offen offset:1024 sc1
    s_waitcnt vmcnt(0)
    v_max3_u32 v5, v128, v129, v130
    v_max3_u32 v5, v5, v131, v132
    v_max3_u32 v5, v5, v133, v134
    v_max3_u32 v5, v5, v135, v136
    v_max3_u32 v5, v5, v137, v138
    v_max3_u32 v5, v5, v139, v140
    v_max3_u32 v5, v5, v141, v142
    v_max_u32 v5, v5, v143
    v_cmp_eq_u32 vcc, -1, v5
    s_cbranch_vccnz Q_rl2
Q_rd2:
    s_add_u32 s67, s63, 12288
    s_and_b32 s67, s67, 32767
    buffer_load_dwordx4 v[96:99], v3, s[16:19], s67 offen offset:0 sc1
    buffer_load_dwordx4 v[100:103], v4, s[16:19], s67 offen offset:0 sc1
    buffer_load_dwordx4 v[104:107], v3, s[16:19], s67 offen offset:1024 sc1
    buffer_load_dwordx4 v[108:111], v4, s[16:19], s67 offen offset:1024 sc1
    s_branch Q_go2
Q_rt3:
    s_mov_b32 s59, 0
    s_add_u32 s67, s63, 12288
    s_and_b32 s67, s67, 32767
Q_rl3:
    s_waitcnt vmcnt(0)
    s_add_u32 s59, s59, 1
    s_cmp_ge_u32 s59, 200000
    s_cbranch_scc1 Q_rd3
    s_sleep 1
    buffer_load_dwordx4 v[96:99], v3, s[16:19], s67 offen offset:0 sc1
    buffer_load_dwordx4 v[100:103], v4, s[16:19], s67 offen offset:0 sc1
    buffer_load_dwordx4 v[104:107], v3, s[16:19], s67 offen offset:1024 sc1
    buffer_load_dwordx4 v[108:111], v4, s[16:19], s67 offen offset:1024 sc1
    s_waitcnt vmcnt(0)
    v_max3_u32 v5, v96, v97, v98
    v_max3_u32 v5, v5, v99, v100
    v_max3_u32 v5, v5, v101, v102
    v_max3_u32 v5, v5, v103, v104
    v_max3_u32 v5, v5, v105, v106
    v_max3_u32 v5, v5, v107, v108
    v_max3_u32 v5, v5, v109, v110
    v_max_u32 v5, v5, v111
    v_cmp_eq_u32 vcc, -1, v5
    s_cbranch_vccnz Q_rl3
Q_rd3:
    s_add_u32 s67, s63, 16384
    s_and_b32 s67, s67, 32767
    buffer_load_dwordx4 v[112:115], v3, s[16:19], s67 offen offset:0 sc1
    buffer_load_dwordx4 v[116:119], v4, s[16:19], s67 offen offset:0 sc1
    buffer_load_dwordx4 v[120:123], v3, s[16:19], s67 offen offset:1024 sc1
    buffer_load_dwordx4 v[124:127], v4, s[16:19], s67 offen offset:1024 sc1
    s_branch Q_go3
Q_rt4:
    s_mov_b32 s59, 0
    s_add_u32 s67, s63, 16384
    s_and_b32 s67, s67, 32767
Q_rl4:
    s_waitcnt vmcnt(0)
    s_add_u32 s59, s59, 1
    s_cmp_ge_u32 s59, 200000
    s_cbranch_scc1 Q_rd4
    s_sleep 1
    buffer_load_dwordx4 v[112:115], v3, s[16:19], s67 offen offset:0 sc1
    buffer_load_dwordx4 v[116:119], v4, s[16:19], s67 offen offset:0 sc1
    buffer_load_dwordx4 v[120:123], v3, s[16:19], s67 offen offset:1024 sc1
    buffer_load_dwordx4 v[124:127], v4, s[16:19], s67 offen offset:1024 sc1
    s_waitcnt vmcnt(0)
    v_max3_u32 v5, v112, v113, v114
    v_max3_u32 v5, v5, v115, v116
    v_max3_u32 v5, v5, v117, v118
    v_max3_u32 v5, v5, v119, v120
    v_max3_u32 v5, v5, v121, v122
    v_max3_u32 v5, v5, v123, v124
    v_max3_u32 v5, v5, v125, v126
    v_max_u32 v5, v5, v127
    v_cmp_eq_u32 vcc, -1, v5
    s_cbranch_vccnz Q_rl4
Q_rd4:
    s_add_u32 s67, s63, 20480
    s_and_b32 s67, s67, 32767
    buffer_load_dwordx4 v[128:131], v3, s[16:19], s67 offen offset:0 sc1
    buffer_load_dwordx4 v[132:135], v4, s[16:19], s67 offen offset:0 sc1
    buffer_load_dwordx4 v[136:139], v3, s[16:19], s67 offen offset:1024 sc1
    buffer_load_dwordx4 v[140:143], v4, s[16:19], s67 offen offset:1024 sc1
    s_branch Q_go4
Q_rt5:
    s_mov_b32 s59, 0
    s_add_u32 s67, s63, 20480
    s_and_b32 s67, s67, 32767
Q_rl5:
    s_waitcnt vmcnt(0)
    s_add_u32 s59, s59, 1
    s_cmp_ge_u32 s59, 200000
    s_cbranch_scc1 Q_rd5
    s_sleep 1
    buffer_load_dwordx4 v[128:131], v3, s[16:19], s67 offen offset:0 sc1
    buffer_load_dwordx4 v[132:135], v4, s[16:19], s67 offen offset:0 sc1
    buffer_load_dwordx4 v[136:139], v3, s[16:19], s67 offen offset:1024 sc1
    buffer_load_dwordx4 v[140:143], v4, s[16:19], s67 offen offset:1024 sc1
    s_waitcnt vmcnt(0)
    v_max3_u32 v5, v128, v129, v130
    v_max3_u32 v5, v5, v131, v132
    v_max3_u32 v5, v5, v133, v134
    v_max3_u32 v5, v5, v135, v136
    v_max3_u32 v5, v5, v137, v138
    v_max3_u32 v5, v5, v139, v140
    v_max3_u32 v5, v5, v141, v142
    v_max_u32 v5, v5, v143
    v_cmp_eq_u32 vcc, -1, v5
    s_cbranch_vccnz Q_rl5
Q_rd5:
    s_add_u32 s67, s63, 24576
    s_and_b32 s67, s67, 32767
    buffer_load_dwordx4 v[96:99], v3, s[16:19], s67 offen offset:0 sc1
    buffer_load_dwordx4 v[100:103], v4, s[16:19], s67 offen offset:0 sc1
    buffer_load_dwordx4 v[104:107], v3, s[16:19], s67 offen offset:1024 sc1
    buffer_load_dwordx4 v[108:111], v4, s[16:19], s67 offen offset:1024 sc1
    s_branch Q_go5
Q_rt6:
    s_mov_b32 s59, 0
    s_add_u32 s67, s63, 24576
    s_and_b32 s67, s67, 32767
Q_rl6:
    s_waitcnt vmcnt(0)
    s_add_u32 s59, s59, 1
    s_cmp_ge_u32 s59, 200000
    s_cbranch_scc1 Q_rd6
    s_sleep 1
    buffer_load_dwordx4 v[96:99], v3, s[16:19], s67 offen offset:0 sc1
    buffer_load_dwordx4 v[100:103], v4, s[16:19], s67 offen offset:0 sc1
    buffer_load_dwordx4 v[104:107], v3, s[16:19], s67 offen offset:1024 sc1
    buffer_load_dwordx4 v[108:111], v4, s[16:19], s67 offen offset:1024 sc1
    s_waitcnt vmcnt(0)
    v_max3_u32 v5, v96, v97, v98
    v_max3_u32 v5, v5, v99, v100
    v_max3_u32 v5, v5, v101, v102
    v_max3_u32 v5, v5, v103, v104
    v_max3_u32 v5, v5, v105, v106
    v_max3_u32 v5, v5, v107, v108
    v_max3_u32 v5, v5, v109, v110
    v_max_u32 v5, v5, v111
    v_cmp_eq_u32 vcc, -1, v5
    s_cbranch_vccnz Q_rl6
Q_rd6:
    s_add_u32 s67, s63, 28672
    s_and_b32 s67, s67, 32767
    buffer_load_dwordx4 v[112:115], v3, s[16:19], s67 offen offset:0 sc1
    buffer_load_dwordx4 v[116:119], v4, s[16:19], s67 offen offset:0 sc1
    buffer_load_dwordx4 v[120:123], v3, s[16:19], s67 offen offset:1024 sc1
    buffer_load_dwordx4 v[124:127], v4, s[16:19], s67 offen offset:1024 sc1
    s_branch Q_go6
Q_rt7:
    s_mov_b32 s59, 0
    s_add_u32 s67, s63, 28672
    s_and_b32 s67, s67, 32767
Q_rl7:
    s_waitcnt vmcnt(0)
    s_add_u32 s59, s59, 1
    s_cmp_ge_u32 s59, 200000
    s_cbranch_scc1 Q_rd7
    s_sleep 1
    buffer_load_dwordx4 v[112:115], v3, s[16:19], s67 offen offset:0 sc1
    buffer_load_dwordx4 v[116:119], v4, s[16:19], s67 offen offset:0 sc1
    buffer_load_dwordx4 v[120:123], v3, s[16:19], s67 offen offset:1024 sc1
    buffer_load_dwordx4 v[124:127], v4, s[16:19], s67 offen offset:1024 sc1
    s_waitcnt vmcnt(0)
    v_max3_u32 v5, v112, v113, v114
    v_max3_u32 v5, v5, v115, v116
    v_max3_u32 v5, v5, v117, v118
    v_max3_u32 v5, v5, v119, v120
    v_max3_u32 v5, v5, v121, v122
    v_max3_u32 v5, v5, v123, v124
    v_max3_u32 v5, v5, v125, v126
    v_max_u32 v5, v5, v127
    v_cmp_eq_u32 vcc, -1, v5
    s_cbranch_vccnz Q_rl7
Q_rd7:
    s_branch Q_go7
H_eps:
    v_lshlrev_b32 v72, 16, v32
    v_and_b32 v73, 0xffff0000, v32
    v_add_f32 v72, s47, v72
    v_add_f32 v73, s47, v73
    v_cvt_pk_bf16_f32 v32, v72, v73
    v_lshlrev_b32 v72, 16, v33
    v_and_b32 v73, 0xffff0000, v33
    v_add_f32 v72, s47, v72
    v_add_f32 v73, s47, v73
    v_cvt_pk_bf16_f32 v33, v72, v73
    v_lshlrev_b32 v72, 16, v34
    v_and_b32 v73, 0xffff0000, v34
    v_add_f32 v72, s47, v72
    v_add_f32 v73, s47, v73
    v_cvt_pk_bf16_f32 v34, v72, v73
    v_lshlrev_b32 v72, 16, v35
    v_and_b32 v73, 0xffff0000, v35
    v_add_f32 v72, s47, v72
    v_add_f32 v73, s47, v73
    v_cvt_pk_bf16_f32 v35, v72, v73
    v_lshlrev_b32 v72, 16, v36
    v_and_b32 v73, 0xffff0000, v36
    v_add_f32 v72, s47, v72
    v_add_f32 v73, s47, v73
    v_cvt_pk_bf16_f32 v36, v72, v73
    v_lshlrev_b32 v72, 16, v37
    v_and_b32 v73, 0xffff0000, v37
    v_add_f32 v72, s47, v72
    v_add_f32 v73, s47, v73
    v_cvt_pk_bf16_f32 v37, v72, v73
    v_lshlrev_b32 v72, 16, v38
    v_and_b32 v73, 0xffff0000, v38
    v_add_f32 v72, s47, v72
    v_add_f32 v73, s47, v73
    v_cvt_pk_bf16_f32 v38, v72, v73
    v_lshlrev_b32 v72, 16, v39
    v_and_b32 v73, 0xffff0000, v39
    v_add_f32 v72, s47, v72
    v_add_f32 v73, s47, v73
    v_cvt_pk_bf16_f32 v39, v72, v73
    v_lshlrev_b32 v72, 16, v40
    v_and_b32 v73, 0xffff0000, v40
    v_add_f32 v72, s47, v72
    v_add_f32 v73, s47, v73
    v_cvt_pk_bf16_f32 v40, v72, v73
    v_lshlrev_b32 v72, 16, v41
    v_and_b32 v73, 0xffff0000, v41
    v_add_f32 v72, s47, v72
    v_add_f32 v73, s47, v73
    v_cvt_pk_bf16_f32 v41, v72, v73
    v_lshlrev_b32 v72, 16, v42
    v_and_b32 v73, 0xffff0000, v42
    v_add_f32 v72, s47, v72
    v_add_f32 v73, s47, v73
    v_cvt_pk_bf16_f32 v42, v72, v73
    v_lshlrev_b32 v72, 16, v43
    v_and_b32 v73, 0xffff0000, v43
    v_add_f32 v72, s47, v72
    v_add_f32 v73, s47, v73
    v_cvt_pk_bf16_f32 v43, v72, v73
    v_lshlrev_b32 v72, 16, v44
    v_and_b32 v73, 0xffff0000, v44
    v_add_f32 v72, s47, v72
    v_add_f32 v73, s47, v73
    v_cvt_pk_bf16_f32 v44, v72, v73
    v_lshlrev_b32 v72, 16, v45
    v_and_b32 v73, 0xffff0000, v45
    v_add_f32 v72, s47, v72
    v_add_f32 v73, s47, v73
    v_cvt_pk_bf16_f32 v45, v72, v73
    v_lshlrev_b32 v72, 16, v46
    v_and_b32 v73, 0xffff0000, v46
    v_add_f32 v72, s47, v72
    v_add_f32 v73, s47, v73
    v_cvt_pk_bf16_f32 v46, v72, v73
    v_lshlrev_b32 v72, 16, v47
    v_and_b32 v73, 0xffff0000, v47
    v_add_f32 v72, s47, v72
    v_add_f32 v73, s47, v73
    v_cvt_pk_bf16_f32 v47, v72, v73
    s_nop 1
    v_mfma_f32_16x16x32_bf16 v[200:203], v[32:35], v[204:207], 0
    s_waitcnt lgkmcnt(7)
    v_mfma_f32_16x16x32_bf16 v[192:195], v[32:35], v[208:211], 0
    s_waitcnt lgkmcnt(6)
    v_mfma_f32_16x16x32_bf16 v[196:199], v[32:35], v[212:215], 0
    v_mfma_f32_16x16x32_bf16 v[200:203], v[36:39], v[204:207], v[200:203]
    s_waitcnt lgkmcnt(5)
    v_mfma_f32_16x16x32_bf16 v[192:195], v[36:39], v[216:219], v[192:195]
    s_waitcnt lgkmcnt(4)
    v_mfma_f32_16x16x32_bf16 v[196:199], v[36:39], v[220:223], v[196:199]
    v_mfma_f32_16x16x32_bf16 v[200:203], v[40:43], v[204:207], v[200:203]
    s_waitcnt lgkmcnt(3)
    v_mfma_f32_16x16x32_bf16 v[192:195], v[40:43], v[224:227], v[192:195]
    s_waitcnt lgkmcnt(2)
    v_mfma_f32_16x16x32_bf16 v[196:199], v[40:43], v[228:231], v[196:199]
    v_mfma_f32_16x16x32_bf16 v[200:203], v[44:47], v[204:207], v[200:203]
    s_waitcnt lgkmcnt(1)
    v_mfma_f32_16x16x32_bf16 v[192:195], v[44:47], v[232:235], v[192:195]
    s_waitcnt lgkmcnt(0)
    v_mfma_f32_16x16x32_bf16 v[196:199], v[44:47], v[236:239], v[196:199]
    s_branch H_ne
CODE_END:
.section .rodata,"a"
.p2align 6
.amdhsa_kernel gated_mix__linear_attn_block__moe_arch_mod__prompt_kernel
  .amdhsa_next_free_vgpr 256
  .amdhsa_next_free_sgpr 102
  .amdhsa_accum_offset 256
  .amdhsa_group_segment_fixed_size 0
  .amdhsa_kernarg_size 96
  .amdhsa_user_sgpr_count 2
  .amdhsa_user_sgpr_kernarg_segment_ptr 1
  .amdhsa_system_sgpr_workgroup_id_x 1
.end_amdhsa_kernel
```

```asm
; @launch grid=(256,1,1) block=(512,1,1) lds=163840
.amdgcn_target "amdgcn-amd-amdhsa--gfx950"
.text
.globl gated_mix__linear_attn_block__moe_arch_mod__prompt_kernel
.p2align 8
.type gated_mix__linear_attn_block__moe_arch_mod__prompt_kernel,@function
gated_mix__linear_attn_block__moe_arch_mod__prompt_kernel:
    s_load_dwordx2 s[12:13], s[0:1], 8
    s_load_dwordx2 s[8:9], s[0:1], 0
    s_getpc_b64 s[64:65]
PC0:
    v_min_u32 v1, 15, v0
    v_lshlrev_b32 v1, 6, v1
    global_load_dword v246, v1, s[64:65]
    s_cmp_ge_u32 s2, 256
    s_cbranch_scc1 END
    v_lshrrev_b32 v1, 6, v0
    v_and_b32 v2, 63, v0
    s_load_dwordx8 s[48:55], s[0:1], 32
    v_readfirstlane_b32 s3, v1
    s_load_dwordx8 s[56:63], s[0:1], 64
    s_load_dwordx2 s[20:21], s[0:1], 16
    s_and_b32 s66, s2, 0xf8
    v_and_b32 v1, 31, v0
    v_lshl_add_u32 v1, s66, 2, v1
    v_lshlrev_b32 v1, 6, v1
    v_min_u32 v1, CODE_END-PC0-4, v1
    global_load_dword v247, v1, s[64:65]
    s_and_b32 s64, s2, 7
    s_lshr_b32 s65, s2, 3
    s_and_b32 s44, s3, 3
    s_lshr_b32 s45, s3, 2
    s_and_b32 s66, s64, 6
    s_lshl_b32 s5, s66, 1
    s_lshl1_add_u32 s76, s65, s64
    s_lshl_b32 s76, s76, 1
    s_lshr_b32 s66, s65, 3
    s_add_u32 s5, s5, s66
    v_lshrrev_b32 v6, 3, v2
    v_lshl_add_u32 v6, s44, 3, v6
    v_lshrrev_b32 v8, 4, v2
    v_and_b32 v10, 7, v2
    s_and_b32 s67, s44, 1
    v_mul_u32_u24 v7, 6144, v6
    v_and_b32 v9, 1, v8
    v_lshl_add_u32 v9, v9, 1, s67
    v_lshlrev_b32 v9, 1, v9
    v_xor_b32 v9, v9, v10
    v_lshl_add_u32 v7, v9, 4, v7
    v_lshl_add_u32 v5, s5, 7, v7
    s_mov_b32 s14, 0x600000
    s_mov_b32 s15, 0x00020000
    s_lshl_b32 s72, s44, 10
    s_lshl_b32 s66, s45, 12
    s_add_u32 s69, s72, s66
    s_add_u32 s68, s69, s66
    s_sub_u32 s77, s5, s76
    s_and_b32 s77, s77, 15
    s_cmp_le_u32 s77, 0
    s_addc_u32 s70, s76, 0
    s_and_b32 s70, s70, 15
    s_lshl_b32 s71, s70, 1
    s_add_u32 s71, s71, s45
    s_mul_i32 s71, s71, 196608
    s_waitcnt lgkmcnt(0)
    s_add_u32 m0, s69, 24576
    s_add_u32 s66, s71, 2048
    buffer_load_dwordx4 v5, s[12:15], s66 offen lds
    s_add_u32 m0, s69, 32768
    s_add_u32 s66, s71, 4096
    buffer_load_dwordx4 v5, s[12:15], s66 offen lds
    s_add_u32 m0, s69, 16384
    s_add_u32 s66, s71, 0
    buffer_load_dwordx4 v5, s[12:15], s66 offen lds
    s_and_b32 s4, s64, 1
    s_lshl_b32 s4, s4, 3
    s_and_b32 s66, s65, 7
    s_add_u32 s4, s4, s66
    v_lshl_add_u32 v7, s4, 7, v6
    v_lshlrev_b32 v7, 11, v7
    v_lshl_add_u32 v9, s67, 2, v8
    v_xor_b32 v9, v9, v10
    v_lshl_add_u32 v4, v9, 4, v7
    s_mov_b32 s10, 0x400000
    s_mov_b32 s11, 0x00020000
    s_lshl_b32 s70, s70, 7
    s_lshl_b32 s66, s45, 17
    s_add_u32 s70, s70, s66
    s_add_u32 m0, s68, 0
    s_add_u32 s66, s70, 0
    buffer_load_dwordx4 v4, s[8:11], s66 offen lds
    s_add_u32 m0, s68, 4096
    s_add_u32 s66, s70, 65536
    buffer_load_dwordx4 v4, s[8:11], s66 offen lds
    s_barrier
    s_cmp_le_u32 s77, 1
    s_addc_u32 s70, s76, 1
    s_and_b32 s70, s70, 15
    s_lshl_b32 s71, s70, 1
    s_add_u32 s71, s71, s45
    s_mul_i32 s71, s71, 196608
    s_add_u32 m0, s69, 65536
    s_add_u32 s66, s71, 2048
    buffer_load_dwordx4 v5, s[12:15], s66 offen lds
    s_add_u32 m0, s69, 73728
    s_add_u32 s66, s71, 4096
    buffer_load_dwordx4 v5, s[12:15], s66 offen lds
    s_add_u32 m0, s69, 57344
    s_add_u32 s66, s71, 0
    buffer_load_dwordx4 v5, s[12:15], s66 offen lds
    s_lshl_b32 s70, s70, 7
    s_lshl_b32 s66, s45, 17
    s_add_u32 s70, s70, s66
    s_add_u32 m0, s68, 40960
    s_add_u32 s66, s70, 0
    buffer_load_dwordx4 v4, s[8:11], s66 offen lds
    s_add_u32 m0, s68, 45056
    s_add_u32 s66, s70, 65536
    buffer_load_dwordx4 v4, s[8:11], s66 offen lds
    s_mov_b32 s16, s62
    s_mov_b32 s17, s63
    s_mov_b32 s32, s54
    s_mov_b32 s33, s55
    s_mov_b32 s36, s58
    s_mov_b32 s37, s59
    s_mov_b32 s40, s60
    s_mov_b32 s41, s61
    s_mov_b32 s18, 0x10000000
    s_mov_b32 s19, 0x00020000
    s_mov_b32 s34, 0x700000
    s_mov_b32 s35, 0x00020000
    s_mov_b32 s38, 0x400000
    s_mov_b32 s39, 0x00020000
    s_mov_b32 s42, 0x100
    s_mov_b32 s43, 0x00020000
    s_mov_b32 s22, 0x200000
    s_mov_b32 s23, 0x00020000
    s_bitcmp0_b32 s44, 0
    s_cselect_b32 s24, s48, s56
    s_cselect_b32 s25, s49, s57
    s_mov_b32 s26, 0x800
    s_mov_b32 s27, 0x00020000
    s_bitcmp0_b32 s44, 0
    s_cselect_b32 s28, s50, s52
    s_cselect_b32 s29, s51, s53
    s_mov_b32 s30, 0x700000
    s_mov_b32 s31, 0x00020000
    s_lshr_b32 s66, s64, 2
    s_lshl_b32 s66, s66, 1
    s_and_b32 s67, s64, 1
    s_add_u32 s66, s66, s67
    s_lshl_b32 s67, s65, 2
    s_add_u32 s66, s66, s67
    s_add_u32 s66, s66, 96
    s_bitcmp0_b32 s64, 1
    s_cselect_b32 s67, 32, 0
    s_add_u32 s66, s66, s67
    s_cmp_lt_u32 s65, 24
    s_cselect_b32 s67, s2, s66
    s_cmp_ge_u32 s67, 224
    s_cselect_b32 s30, 0, s30
    s_cselect_b32 s34, 0, s34
    s_lshr_b32 s79, s67, 2
    s_and_b32 s73, s67, 3
    s_and_b32 s6, s64, 3
    s_lshl_b32 s6, s6, 2
    s_and_b32 s66, s65, 3
    s_add_u32 s6, s6, s66
    s_lshr_b32 s7, s64, 2
    s_lshl_b32 s7, s7, 3
    s_lshr_b32 s66, s65, 2
    s_add_u32 s7, s7, s66
    s_mov_b32 s6, s4
    s_mov_b32 s7, s5
    s_mov_b32 s46, 0x3fb8aa3b
    s_mov_b32 s47, 0x358637bd
    s_cmp_ge_u32 s3, 4
    s_cbranch_scc1 HELP
    s_and_b32 s48, s3, 1
    s_lshr_b32 s49, s3, 1
    v_and_b32 v3, 15, v2
    s_lshl_b32 s66, s48, 6
    v_add_u32 v3, s66, v3
    v_lshlrev_b32 v3, 7, v3
    v_bfe_u32 v9, v2, 1, 3
    v_lshrrev_b32 v15, 4, v2
    v_xor_b32 v9, v9, v15
    v_xor_b32 v12, 0, v9
    v_lshl_add_u32 v4, v12, 4, v3
    v_xor_b32 v12, 4, v9
    v_lshl_add_u32 v5, v12, 4, v3
    v_bfe_u32 v12, v2, 2, 2
    v_lshl_add_u32 v13, v15, 3, v12
    v_lshlrev_b32 v13, 7, v13
    v_lshrrev_b32 v12, 1, v12
    v_xor_b32 v12, s49, v12
    v_lshl_add_u32 v13, v12, 6, v13
    v_and_b32 v12, 3, v2
    v_lshl_add_u32 v13, v12, 3, v13
    v_add_u32 v13, 16384, v13
    v_and_b32 v12, 1, v15
    v_xor_b32 v14, 0, v12
    v_lshl_add_u32 v6, v14, 5, v13
    v_xor_b32 v14, 1, v12
    v_lshl_add_u32 v7, v14, 5, v13
    v_mov_b32 v8, v4
    v_mov_b32 v9, v5
    v_mov_b32 v10, v6
    v_mov_b32 v11, v7
    v_mov_b32 v96, 0
    v_mov_b32 v97, 0
    v_mov_b32 v98, 0
    v_mov_b32 v99, 0
    v_mov_b32 v100, 0
    v_mov_b32 v101, 0
    v_mov_b32 v102, 0
    v_mov_b32 v103, 0
    v_mov_b32 v104, 0
    v_mov_b32 v105, 0
    v_mov_b32 v106, 0
    v_mov_b32 v107, 0
    v_mov_b32 v108, 0
    v_mov_b32 v109, 0
    v_mov_b32 v110, 0
    v_mov_b32 v111, 0
    v_mov_b32 v112, 0
    v_mov_b32 v113, 0
    v_mov_b32 v114, 0
    v_mov_b32 v115, 0
    v_mov_b32 v116, 0
    v_mov_b32 v117, 0
    v_mov_b32 v118, 0
    v_mov_b32 v119, 0
    v_mov_b32 v120, 0
    v_mov_b32 v121, 0
    v_mov_b32 v122, 0
    v_mov_b32 v123, 0
    v_mov_b32 v124, 0
    v_mov_b32 v125, 0
    v_mov_b32 v126, 0
    v_mov_b32 v127, 0
    v_mov_b32 v128, 0
    v_mov_b32 v129, 0
    v_mov_b32 v130, 0
    v_mov_b32 v131, 0
    v_mov_b32 v132, 0
    v_mov_b32 v133, 0
    v_mov_b32 v134, 0
    v_mov_b32 v135, 0
    v_mov_b32 v136, 0
    v_mov_b32 v137, 0
    v_mov_b32 v138, 0
    v_mov_b32 v139, 0
    v_mov_b32 v140, 0
    v_mov_b32 v141, 0
    v_mov_b32 v142, 0
    v_mov_b32 v143, 0
    v_mov_b32 v144, 0
    v_mov_b32 v145, 0
    v_mov_b32 v146, 0
    v_mov_b32 v147, 0
    v_mov_b32 v148, 0
    v_mov_b32 v149, 0
    v_mov_b32 v150, 0
    v_mov_b32 v151, 0
    v_mov_b32 v152, 0
    v_mov_b32 v153, 0
    v_mov_b32 v154, 0
    v_mov_b32 v155, 0
    v_mov_b32 v156, 0
    v_mov_b32 v157, 0
    v_mov_b32 v158, 0
    v_mov_b32 v159, 0
    v_mov_b32 v160, 0
    v_mov_b32 v161, 0
    v_mov_b32 v162, 0
    v_mov_b32 v163, 0
    v_mov_b32 v164, 0
    v_mov_b32 v165, 0
    v_mov_b32 v166, 0
    v_mov_b32 v167, 0
    v_mov_b32 v168, 0
    v_mov_b32 v169, 0
    v_mov_b32 v170, 0
    v_mov_b32 v171, 0
    v_mov_b32 v172, 0
    v_mov_b32 v173, 0
    v_mov_b32 v174, 0
    v_mov_b32 v175, 0
    v_mov_b32 v176, 0
    v_mov_b32 v177, 0
    v_mov_b32 v178, 0
    v_mov_b32 v179, 0
    v_mov_b32 v180, 0
    v_mov_b32 v181, 0
    v_mov_b32 v182, 0
    v_mov_b32 v183, 0
    v_mov_b32 v184, 0
    v_mov_b32 v185, 0
    v_mov_b32 v186, 0
    v_mov_b32 v187, 0
    v_mov_b32 v188, 0
    v_mov_b32 v189, 0
    v_mov_b32 v190, 0
    v_mov_b32 v191, 0
    v_lshlrev_b32 v12, 2, v2
    v_and_b32 v12, 63, v12
    v_add_u32 v12, 155648, v12
    ds_write_b32 v12, v96
    s_mov_b32 s70, 0x3fb8aa3b
    s_mov_b32 s71, 0x3fb8aa3b
    v_lshrrev_b32 v12, 3, v2
    s_lshl_b32 s67, s44, 3
    v_add_u32 v12, s67, v12
    v_lshlrev_b32 v12, 11, v12
    v_lshrrev_b32 v13, 4, v2
    v_lshlrev_b32 v13, 1, v13
    v_and_b32 v250, 7, v2
    v_xor_b32 v13, v13, v250
    v_lshl_add_u32 v12, v13, 4, v12
    s_lshl_b32 s66, s7, 7
    v_add_u32 v250, s66, v12
    s_lshl_b32 s66, s6, 7
    s_lshl_b32 s67, s44, 5
    s_add_u32 s66, s66, s67
    s_lshl_b32 s67, s45, 4
    s_add_u32 s66, s66, s67
    v_and_b32 v252, 15, v2
    v_add_u32 v252, s66, v252
    v_lshlrev_b32 v251, 11, v252
    v_bfe_u32 v12, v2, 4, 1
    v_lshl_add_u32 v251, v12, 5, v251
    v_lshrrev_b32 v12, 5, v2
    v_lshl_add_u32 v251, v12, 4, v251
    s_lshl_b32 s66, s7, 7
    v_add_u32 v251, s66, v251
    v_lshrrev_b32 v253, 2, v252
    v_lshlrev_b32 v253, 6, v253
    v_and_b32 v12, 3, v2
    v_lshl_add_u32 v253, v12, 2, v253
    s_lshl_b32 s66, s6, 1
    s_and_b32 s66, s66, 6
    s_lshl_b32 s67, s7, 3
    s_add_u32 s66, s66, s67
    s_and_b32 s66, s66, 7
    s_lshl_b32 s52, s66, 18
    s_lshr_b32 s49, s44, 1
    s_and_b32 s66, s44, 1
    s_lshl_b32 s66, s66, 2
    s_lshl_b32 s67, s45, 1
    s_add_u32 s66, s66, s67
    s_lshl_b32 s67, s4, 3
    s_add_u32 s66, s66, s67
    s_lshl_b32 s66, s66, 15
    s_lshl_b32 s67, s5, 11
    s_add_u32 s66, s66, s67
    s_lshl_b32 s67, s49, 10
    s_add_u32 s60, s66, s67
    s_add_u32 s61, s60, 32768
    s_lshl_b32 s58, s5, 2
    s_add_u32 s58, s58, s44
    s_lshl_b32 s66, s58, 14
    s_add_u32 s66, s66, 4194304
    v_lshlrev_b32 v12, 4, v2
    v_add_u32 v248, s66, v12
    s_lshl_b32 s66, s58, 10
    s_add_u32 s66, s66, 5242880
    v_and_b32 v12, 15, v2
    v_lshlrev_b32 v12, 6, v12
    v_lshrrev_b32 v13, 4, v2
    v_lshl_add_u32 v12, v13, 4, v12
    v_add_u32 v249, s66, v12
    s_lshr_b32 s57, s4, 3
    s_xor_b32 s57, s57, s4
    s_and_b32 s57, s57, 1
    s_lshl_b32 s57, s57, 13
    v_bfe_u32 v12, v2, 2, 2
    v_cmp_eq_u32 vcc, v12, v13
    v_mov_b32 v13, 0x3f80
    v_and_b32 v12, 1, v2
    v_lshlrev_b32 v12, 4, v12
    v_lshlrev_b32 v12, v12, v13
    v_cndmask_b32 v12, 0, v12, vcc
    v_and_b32 v13, 2, v2
    v_cmp_eq_u32 vcc, 0, v13
    s_nop 1
    v_cndmask_b32 v254, 0, v12, vcc
    v_cndmask_b32 v255, v12, 0, vcc
    s_mov_b32 s50, 0
    s_mov_b32 s51, 0
    s_waitcnt vmcnt(5) lgkmcnt(0)
    s_barrier
    ds_read_b64_tr_b16 v[32:33], v10 offset:0
    ds_read_b64_tr_b16 v[34:35], v10 offset:512
    ds_read_b128 v[16:19], v8 offset:0
    ds_read_b128 v[20:23], v8 offset:2048
    ds_read_b128 v[24:27], v8 offset:4096
    ds_read_b128 v[28:31], v8 offset:6144
    ds_read_b64_tr_b16 v[36:37], v11 offset:0
    ds_read_b64_tr_b16 v[38:39], v11 offset:512
    ds_read_b64_tr_b16 v[40:41], v10 offset:8192
    ds_read_b64_tr_b16 v[42:43], v10 offset:8704
    ds_read_b64_tr_b16 v[44:45], v11 offset:8192
    ds_read_b64_tr_b16 v[46:47], v11 offset:8704
    ds_read_b64_tr_b16 v[48:49], v10 offset:16384
    ds_read_b64_tr_b16 v[50:51], v10 offset:16896
    ds_read_b64_tr_b16 v[52:53], v11 offset:16384
    ds_read_b64_tr_b16 v[54:55], v11 offset:16896
.p2align 6
LOOP:
    s_waitcnt lgkmcnt(13)
    v_mfma_f32_16x16x32_bf16 v[96:99], v[32:35], v[16:19], v[96:99]
    ds_read_b64_tr_b16 v[72:73], v10 offset:4096
    s_waitcnt lgkmcnt(13)
    v_mfma_f32_16x16x32_bf16 v[104:107], v[32:35], v[20:23], v[104:107]
    ds_read_b64_tr_b16 v[74:75], v10 offset:4608
    s_waitcnt lgkmcnt(13)
    v_mfma_f32_16x16x32_bf16 v[112:115], v[32:35], v[24:27], v[112:115]
    ds_read_b128 v[56:59], v9 offset:0
    s_waitcnt lgkmcnt(13)
    v_mfma_f32_16x16x32_bf16 v[120:123], v[32:35], v[28:31], v[120:123]
    ds_read_b128 v[60:63], v9 offset:2048
    s_waitcnt lgkmcnt(12)
    v_mfma_f32_16x16x32_bf16 v[124:127], v[36:39], v[28:31], v[124:127]
    ds_read_b128 v[64:67], v9 offset:4096
    v_mfma_f32_16x16x32_bf16 v[116:119], v[36:39], v[24:27], v[116:119]
    ds_read_b128 v[68:71], v9 offset:6144
    v_mfma_f32_16x16x32_bf16 v[108:111], v[36:39], v[20:23], v[108:111]
    ds_read_b64_tr_b16 v[76:77], v11 offset:4096
    v_mfma_f32_16x16x32_bf16 v[100:103], v[36:39], v[16:19], v[100:103]
    ds_read_b64_tr_b16 v[78:79], v11 offset:4608
    s_waitcnt lgkmcnt(14)
    v_mfma_f32_16x16x32_bf16 v[128:131], v[16:19], v[40:43], v[128:131]
    ds_read_b64_tr_b16 v[80:81], v10 offset:12288
    v_mfma_f32_16x16x32_bf16 v[136:139], v[20:23], v[40:43], v[136:139]
    ds_read_b64_tr_b16 v[82:83], v10 offset:12800
    v_mfma_f32_16x16x32_bf16 v[144:147], v[24:27], v[40:43], v[144:147]
    ds_read_b64_tr_b16 v[84:85], v11 offset:12288
    v_mfma_f32_16x16x32_bf16 v[152:155], v[28:31], v[40:43], v[152:155]
    ds_read_b64_tr_b16 v[86:87], v11 offset:12800
    s_waitcnt lgkmcnt(15)
    v_mfma_f32_16x16x32_bf16 v[156:159], v[28:31], v[44:47], v[156:159]
    ds_read_b64_tr_b16 v[88:89], v10 offset:20480
    v_mfma_f32_16x16x32_bf16 v[148:151], v[24:27], v[44:47], v[148:151]
    ds_read_b64_tr_b16 v[90:91], v10 offset:20992
    v_mfma_f32_16x16x32_bf16 v[140:143], v[20:23], v[44:47], v[140:143]
    ds_read_b64_tr_b16 v[92:93], v11 offset:20480
    v_mfma_f32_16x16x32_bf16 v[132:135], v[16:19], v[44:47], v[132:135]
    ds_read_b64_tr_b16 v[94:95], v11 offset:20992
    s_waitcnt lgkmcnt(15)
    v_mfma_f32_16x16x32_bf16 v[160:163], v[16:19], v[48:51], v[160:163]
    v_mfma_f32_16x16x32_bf16 v[168:171], v[20:23], v[48:51], v[168:171]
    v_mfma_f32_16x16x32_bf16 v[176:179], v[24:27], v[48:51], v[176:179]
    v_mfma_f32_16x16x32_bf16 v[184:187], v[28:31], v[48:51], v[184:187]
    s_waitcnt lgkmcnt(15)
    v_mfma_f32_16x16x32_bf16 v[188:191], v[28:31], v[52:55], v[188:191]
    v_mfma_f32_16x16x32_bf16 v[180:183], v[24:27], v[52:55], v[180:183]
    v_mfma_f32_16x16x32_bf16 v[172:175], v[20:23], v[52:55], v[172:175]
    v_mfma_f32_16x16x32_bf16 v[164:167], v[16:19], v[52:55], v[164:167]
    s_waitcnt lgkmcnt(13)
    v_mfma_f32_16x16x32_bf16 v[96:99], v[72:75], v[56:59], v[96:99]
    s_add_u32 s50, s50, 40960
    s_cmp_eq_u32 s50, 122880
    s_cselect_b32 s50, 0, s50
    s_waitcnt lgkmcnt(12)
    v_mfma_f32_16x16x32_bf16 v[104:107], v[72:75], v[60:63], v[104:107]
    v_add_u32 v8, s50, v4
    s_waitcnt lgkmcnt(11)
    v_mfma_f32_16x16x32_bf16 v[112:115], v[72:75], v[64:67], v[112:115]
    v_add_u32 v9, s50, v5
    s_waitcnt lgkmcnt(10)
    v_mfma_f32_16x16x32_bf16 v[120:123], v[72:75], v[68:71], v[120:123]
    v_add_u32 v10, s50, v6
    s_waitcnt lgkmcnt(8)
    v_mfma_f32_16x16x32_bf16 v[124:127], v[76:79], v[68:71], v[124:127]
    v_add_u32 v11, s50, v7
    v_mfma_f32_16x16x32_bf16 v[116:119], v[76:79], v[64:67], v[116:119]
    s_waitcnt vmcnt(0) lgkmcnt(0)
    s_barrier
    v_mfma_f32_16x16x32_bf16 v[108:111], v[76:79], v[60:63], v[108:111]
    ds_read_b64_tr_b16 v[32:33], v10 offset:0
    v_mfma_f32_16x16x32_bf16 v[100:103], v[76:79], v[56:59], v[100:103]
    ds_read_b64_tr_b16 v[34:35], v10 offset:512
    v_mfma_f32_16x16x32_bf16 v[128:131], v[56:59], v[80:83], v[128:131]
    ds_read_b128 v[16:19], v8 offset:0
    v_mfma_f32_16x16x32_bf16 v[136:139], v[60:63], v[80:83], v[136:139]
    ds_read_b128 v[20:23], v8 offset:2048
    v_mfma_f32_16x16x32_bf16 v[144:147], v[64:67], v[80:83], v[144:147]
    ds_read_b128 v[24:27], v8 offset:4096
    v_mfma_f32_16x16x32_bf16 v[152:155], v[68:71], v[80:83], v[152:155]
    ds_read_b128 v[28:31], v8 offset:6144
    v_mfma_f32_16x16x32_bf16 v[156:159], v[68:71], v[84:87], v[156:159]
    ds_read_b64_tr_b16 v[36:37], v11 offset:0
    v_mfma_f32_16x16x32_bf16 v[148:151], v[64:67], v[84:87], v[148:151]
    ds_read_b64_tr_b16 v[38:39], v11 offset:512
    v_mfma_f32_16x16x32_bf16 v[140:143], v[60:63], v[84:87], v[140:143]
    ds_read_b64_tr_b16 v[40:41], v10 offset:8192
    v_mfma_f32_16x16x32_bf16 v[132:135], v[56:59], v[84:87], v[132:135]
    ds_read_b64_tr_b16 v[42:43], v10 offset:8704
    v_mfma_f32_16x16x32_bf16 v[160:163], v[56:59], v[88:91], v[160:163]
    ds_read_b64_tr_b16 v[44:45], v11 offset:8192
    v_mfma_f32_16x16x32_bf16 v[168:171], v[60:63], v[88:91], v[168:171]
    ds_read_b64_tr_b16 v[46:47], v11 offset:8704
    v_mfma_f32_16x16x32_bf16 v[176:179], v[64:67], v[88:91], v[176:179]
    ds_read_b64_tr_b16 v[48:49], v10 offset:16384
    v_mfma_f32_16x16x32_bf16 v[184:187], v[68:71], v[88:91], v[184:187]
    ds_read_b64_tr_b16 v[50:51], v10 offset:16896
    v_mfma_f32_16x16x32_bf16 v[188:191], v[68:71], v[92:95], v[188:191]
    ds_read_b64_tr_b16 v[52:53], v11 offset:16384
    v_mfma_f32_16x16x32_bf16 v[180:183], v[64:67], v[92:95], v[180:183]
    ds_read_b64_tr_b16 v[54:55], v11 offset:16896
    v_mfma_f32_16x16x32_bf16 v[172:175], v[60:63], v[92:95], v[172:175]
    v_mfma_f32_16x16x32_bf16 v[164:167], v[56:59], v[92:95], v[164:167]
    s_add_u32 s51, s51, 1
    s_cmp_lt_u32 s51, 13
    s_cbranch_scc1 LOOP
    s_waitcnt lgkmcnt(13)
    v_mfma_f32_16x16x32_bf16 v[96:99], v[32:35], v[16:19], v[96:99]
    ds_read_b64_tr_b16 v[72:73], v10 offset:12288
    v_add_u32 v12, 122880, v4
    s_waitcnt lgkmcnt(13)
    v_mfma_f32_16x16x32_bf16 v[104:107], v[32:35], v[20:23], v[104:107]
    ds_read_b64_tr_b16 v[74:75], v10 offset:12800
    v_add_u32 v13, 122880, v5
    s_waitcnt lgkmcnt(13)
    v_mfma_f32_16x16x32_bf16 v[112:115], v[32:35], v[24:27], v[112:115]
    ds_read_b128 v[56:59], v9 offset:0
    v_add_u32 v14, 114688, v6
    s_waitcnt lgkmcnt(13)
    v_mfma_f32_16x16x32_bf16 v[120:123], v[32:35], v[28:31], v[120:123]
    ds_read_b128 v[60:63], v9 offset:2048
    v_add_u32 v15, 114688, v7
    s_waitcnt lgkmcnt(12)
    v_mfma_f32_16x16x32_bf16 v[124:127], v[36:39], v[28:31], v[124:127]
    ds_read_b128 v[64:67], v9 offset:4096
    s_lshl_b32 s66, s3, 12
    v_mfma_f32_16x16x32_bf16 v[116:119], v[36:39], v[24:27], v[116:119]
    ds_read_b128 v[68:71], v9 offset:6144
    v_lshlrev_b32 v3, 4, v2
    v_mfma_f32_16x16x32_bf16 v[108:111], v[36:39], v[20:23], v[108:111]
    ds_read_b64_tr_b16 v[76:77], v11 offset:12288
    v_add_u32 v3, s66, v3
    v_mfma_f32_16x16x32_bf16 v[100:103], v[36:39], v[16:19], v[100:103]
    ds_read_b64_tr_b16 v[78:79], v11 offset:12800
    s_lshl_b32 s66, s3, 2
    s_waitcnt lgkmcnt(14)
    v_mfma_f32_16x16x32_bf16 v[128:131], v[16:19], v[40:43], v[128:131]
    ds_read_b64_tr_b16 v[80:81], v10 offset:20480
    s_add_u32 s66, s66, 155648
    v_mfma_f32_16x16x32_bf16 v[136:139], v[20:23], v[40:43], v[136:139]
    ds_read_b64_tr_b16 v[82:83], v10 offset:20992
    v_mov_b32 v1, s66
    v_mfma_f32_16x16x32_bf16 v[144:147], v[24:27], v[40:43], v[144:147]
    ds_read_b64_tr_b16 v[84:85], v11 offset:20480
    v_mov_b32 v0, 1
    v_mfma_f32_16x16x32_bf16 v[152:155], v[28:31], v[40:43], v[152:155]
    ds_read_b64_tr_b16 v[86:87], v11 offset:20992
    v_mov_b32 v88, v248
    s_waitcnt lgkmcnt(15)
    v_mfma_f32_16x16x32_bf16 v[156:159], v[28:31], v[44:47], v[156:159]
    v_mov_b32 v89, v249
    v_mfma_f32_16x16x32_bf16 v[148:151], v[24:27], v[44:47], v[148:151]
    v_mov_b32 v90, v250
    v_mfma_f32_16x16x32_bf16 v[140:143], v[20:23], v[44:47], v[140:143]
    v_mov_b32 v91, v251
    v_mfma_f32_16x16x32_bf16 v[132:135], v[16:19], v[44:47], v[132:135]
    v_mov_b32 v92, v252
    s_waitcnt lgkmcnt(14)
    v_mfma_f32_16x16x32_bf16 v[160:163], v[16:19], v[48:51], v[160:163]
    v_mov_b32 v93, v253
    v_mfma_f32_16x16x32_bf16 v[168:171], v[20:23], v[48:51], v[168:171]
    v_mov_b32 v94, v254
    v_mfma_f32_16x16x32_bf16 v[176:179], v[24:27], v[48:51], v[176:179]
    v_mov_b32 v95, v255
    v_mfma_f32_16x16x32_bf16 v[184:187], v[28:31], v[48:51], v[184:187]
    s_waitcnt lgkmcnt(12)
    v_mfma_f32_16x16x32_bf16 v[188:191], v[28:31], v[52:55], v[188:191]
    v_mfma_f32_16x16x32_bf16 v[180:183], v[24:27], v[52:55], v[180:183]
    v_mfma_f32_16x16x32_bf16 v[172:175], v[20:23], v[52:55], v[172:175]
    v_mfma_f32_16x16x32_bf16 v[164:167], v[16:19], v[52:55], v[164:167]
    s_waitcnt lgkmcnt(9)
    v_mfma_f32_16x16x32_bf16 v[128:131], v[56:59], v[72:75], v[128:131]
    s_waitcnt lgkmcnt(8)
    v_mfma_f32_16x16x32_bf16 v[136:139], v[60:63], v[72:75], v[136:139]
    s_waitcnt lgkmcnt(7)
    v_mfma_f32_16x16x32_bf16 v[144:147], v[64:67], v[72:75], v[144:147]
    s_waitcnt lgkmcnt(6)
    v_mfma_f32_16x16x32_bf16 v[152:155], v[68:71], v[72:75], v[152:155]
    s_waitcnt lgkmcnt(4)
    v_mfma_f32_16x16x32_bf16 v[156:159], v[68:71], v[76:79], v[156:159]
    v_mfma_f32_16x16x32_bf16 v[148:151], v[64:67], v[76:79], v[148:151]
    s_barrier
    v_mfma_f32_16x16x32_bf16 v[140:143], v[60:63], v[76:79], v[140:143]
    ds_read_b64_tr_b16 v[16:17], v10 offset:49152
    v_mfma_f32_16x16x32_bf16 v[132:135], v[56:59], v[76:79], v[132:135]
    ds_read_b64_tr_b16 v[18:19], v10 offset:49664
    s_waitcnt lgkmcnt(4)
    v_mfma_f32_16x16x32_bf16 v[160:163], v[56:59], v[80:83], v[160:163]
    ds_read_b128 v[192:195], v8 offset:40960
    v_mfma_f32_16x16x32_bf16 v[168:171], v[60:63], v[80:83], v[168:171]
    ds_read_b128 v[196:199], v8 offset:43008
    v_mfma_f32_16x16x32_bf16 v[176:179], v[64:67], v[80:83], v[176:179]
    ds_read_b128 v[200:203], v8 offset:45056
    v_mfma_f32_16x16x32_bf16 v[184:187], v[68:71], v[80:83], v[184:187]
    ds_read_b128 v[204:207], v8 offset:47104
    s_waitcnt lgkmcnt(6)
    v_mfma_f32_16x16x32_bf16 v[188:191], v[68:71], v[84:87], v[188:191]
    ds_read_b64_tr_b16 v[20:21], v11 offset:49152
    v_mfma_f32_16x16x32_bf16 v[180:183], v[64:67], v[84:87], v[180:183]
    ds_read_b64_tr_b16 v[22:23], v11 offset:49664
    v_mfma_f32_16x16x32_bf16 v[172:175], v[60:63], v[84:87], v[172:175]
    v_mfma_f32_16x16x32_bf16 v[164:167], v[56:59], v[84:87], v[164:167]
    s_waitcnt lgkmcnt(5)
    v_mfma_f32_16x16x32_bf16 v[128:131], v[192:195], v[16:19], v[128:131]
    ds_read_b64_tr_b16 v[24:25], v10 offset:53248
    ds_read_b64_tr_b16 v[26:27], v10 offset:53760
    s_waitcnt lgkmcnt(6)
    v_mfma_f32_16x16x32_bf16 v[136:139], v[196:199], v[16:19], v[136:139]
    ds_read_b128 v[208:211], v9 offset:40960
    ds_read_b128 v[212:215], v9 offset:43008
    s_waitcnt lgkmcnt(7)
    v_mfma_f32_16x16x32_bf16 v[144:147], v[200:203], v[16:19], v[144:147]
    ds_read_b128 v[216:219], v9 offset:45056
    s_waitcnt lgkmcnt(7)
    v_mfma_f32_16x16x32_bf16 v[152:155], v[204:207], v[16:19], v[152:155]
    ds_read_b128 v[220:223], v9 offset:47104
    s_waitcnt lgkmcnt(6)
    v_mfma_f32_16x16x32_bf16 v[156:159], v[204:207], v[20:23], v[156:159]
    ds_read_b64_tr_b16 v[28:29], v11 offset:53248
    v_mfma_f32_16x16x32_bf16 v[148:151], v[200:203], v[20:23], v[148:151]
    ds_read_b64_tr_b16 v[30:31], v11 offset:53760
    v_mfma_f32_16x16x32_bf16 v[140:143], v[196:199], v[20:23], v[140:143]
    v_mfma_f32_16x16x32_bf16 v[132:135], v[192:195], v[20:23], v[132:135]
    s_waitcnt lgkmcnt(5)
    v_mfma_f32_16x16x32_bf16 v[128:131], v[208:211], v[24:27], v[128:131]
    ds_read_b64_tr_b16 v[32:33], v10 offset:4096
    s_waitcnt lgkmcnt(5)
    v_mfma_f32_16x16x32_bf16 v[136:139], v[212:215], v[24:27], v[136:139]
    ds_read_b64_tr_b16 v[34:35], v10 offset:4608
    s_waitcnt lgkmcnt(5)
    v_mfma_f32_16x16x32_bf16 v[144:147], v[216:219], v[24:27], v[144:147]
    ds_read_b64_tr_b16 v[36:37], v11 offset:4096
    s_waitcnt lgkmcnt(5)
    v_mfma_f32_16x16x32_bf16 v[152:155], v[220:223], v[24:27], v[152:155]
    ds_read_b64_tr_b16 v[38:39], v11 offset:4608
    s_waitcnt lgkmcnt(4)
    v_mfma_f32_16x16x32_bf16 v[156:159], v[220:223], v[28:31], v[156:159]
    v_mfma_f32_16x16x32_bf16 v[148:151], v[216:219], v[28:31], v[148:151]
    v_mfma_f32_16x16x32_bf16 v[140:143], v[212:215], v[28:31], v[140:143]
    v_mfma_f32_16x16x32_bf16 v[132:135], v[208:211], v[28:31], v[132:135]
    s_waitcnt lgkmcnt(2)
    v_mfma_f32_16x16x32_bf16 v[96:99], v[32:35], v[56:59], v[96:99]
    v_mfma_f32_16x16x32_bf16 v[104:107], v[32:35], v[60:63], v[104:107]
    s_barrier
    v_mfma_f32_16x16x32_bf16 v[112:115], v[32:35], v[64:67], v[112:115]
    ds_read_b64_tr_b16 v[16:17], v14 offset:8192
    ds_read_b64_tr_b16 v[18:19], v14 offset:8704
    v_mfma_f32_16x16x32_bf16 v[120:123], v[32:35], v[68:71], v[120:123]
    ds_read_b128 v[224:227], v12 offset:0
    ds_read_b128 v[228:231], v12 offset:2048
    s_waitcnt lgkmcnt(4)
    v_mfma_f32_16x16x32_bf16 v[124:127], v[36:39], v[68:71], v[124:127]
    ds_read_b128 v[232:235], v12 offset:4096
    ds_read_b128 v[236:239], v12 offset:6144
    v_mfma_f32_16x16x32_bf16 v[116:119], v[36:39], v[64:67], v[116:119]
    ds_read_b64_tr_b16 v[20:21], v15 offset:8192
    ds_read_b64_tr_b16 v[22:23], v15 offset:8704
    v_mfma_f32_16x16x32_bf16 v[108:111], v[36:39], v[60:63], v[108:111]
    v_mfma_f32_16x16x32_bf16 v[100:103], v[36:39], v[56:59], v[100:103]
    s_waitcnt lgkmcnt(5)
    v_mfma_f32_16x16x32_bf16 v[128:131], v[224:227], v[16:19], v[128:131]
    ds_read_b64_tr_b16 v[24:25], v14 offset:12288
    ds_read_b64_tr_b16 v[26:27], v14 offset:12800
    s_waitcnt lgkmcnt(6)
    v_mfma_f32_16x16x32_bf16 v[136:139], v[228:231], v[16:19], v[136:139]
    ds_read_b128 v[240:243], v13 offset:0
    ds_read_b128 v[244:247], v13 offset:2048
    s_waitcnt lgkmcnt(7)
    v_mfma_f32_16x16x32_bf16 v[144:147], v[232:235], v[16:19], v[144:147]
    ds_read_b128 v[248:251], v13 offset:4096
    s_waitcnt lgkmcnt(7)
    v_mfma_f32_16x16x32_bf16 v[152:155], v[236:239], v[16:19], v[152:155]
    ds_read_b128 v[252:255], v13 offset:6144
    s_waitcnt lgkmcnt(6)
    v_mfma_f32_16x16x32_bf16 v[156:159], v[236:239], v[20:23], v[156:159]
    ds_read_b64_tr_b16 v[28:29], v15 offset:12288
    v_mfma_f32_16x16x32_bf16 v[148:151], v[232:235], v[20:23], v[148:151]
    ds_read_b64_tr_b16 v[30:31], v15 offset:12800
    v_mfma_f32_16x16x32_bf16 v[140:143], v[228:231], v[20:23], v[140:143]
    v_mfma_f32_16x16x32_bf16 v[132:135], v[224:227], v[20:23], v[132:135]
    s_waitcnt lgkmcnt(5)
    v_mfma_f32_16x16x32_bf16 v[128:131], v[240:243], v[24:27], v[128:131]
    ds_read_b64_tr_b16 v[32:33], v10 offset:57344
    s_waitcnt lgkmcnt(5)
    v_mfma_f32_16x16x32_bf16 v[136:139], v[244:247], v[24:27], v[136:139]
    ds_read_b64_tr_b16 v[34:35], v10 offset:57856
    s_waitcnt lgkmcnt(5)
    v_mfma_f32_16x16x32_bf16 v[144:147], v[248:251], v[24:27], v[144:147]
    ds_read_b64_tr_b16 v[36:37], v11 offset:57344
    s_waitcnt lgkmcnt(5)
    v_mfma_f32_16x16x32_bf16 v[152:155], v[252:255], v[24:27], v[152:155]
    ds_read_b64_tr_b16 v[38:39], v11 offset:57856
    s_waitcnt lgkmcnt(4)
    v_mfma_f32_16x16x32_bf16 v[156:159], v[252:255], v[28:31], v[156:159]
    v_mfma_f32_16x16x32_bf16 v[148:151], v[248:251], v[28:31], v[148:151]
    v_mfma_f32_16x16x32_bf16 v[140:143], v[244:247], v[28:31], v[140:143]
    v_mfma_f32_16x16x32_bf16 v[132:135], v[240:243], v[28:31], v[132:135]
    s_waitcnt lgkmcnt(2)
    v_mfma_f32_16x16x32_bf16 v[160:163], v[192:195], v[32:35], v[160:163]
    ds_read_b64_tr_b16 v[16:17], v10 offset:61440
    s_nop 5
    v_cvt_pk_bf16_f32 v40, v128, v129
    v_cvt_pk_bf16_f32 v41, v130, v131
    v_mfma_f32_16x16x32_bf16 v[168:171], v[196:199], v[32:35], v[168:171]
    ds_read_b64_tr_b16 v[18:19], v10 offset:61952
    v_cvt_pk_bf16_f32 v42, v136, v137
    v_cvt_pk_bf16_f32 v43, v138, v139
    ds_write_b128 v3, v[40:43] offset:0
    v_mfma_f32_16x16x32_bf16 v[176:179], v[200:203], v[32:35], v[176:179]
    ds_read_b64_tr_b16 v[20:21], v11 offset:61440
    v_cvt_pk_bf16_f32 v44, v132, v133
    v_cvt_pk_bf16_f32 v45, v134, v135
    v_cvt_pk_bf16_f32 v46, v140, v141
    v_mfma_f32_16x16x32_bf16 v[184:187], v[204:207], v[32:35], v[184:187]
    ds_read_b64_tr_b16 v[22:23], v11 offset:61952
    v_cvt_pk_bf16_f32 v47, v142, v143
    ds_write_b128 v3, v[44:47] offset:1024
    v_cvt_pk_bf16_f32 v48, v144, v145
    s_waitcnt lgkmcnt(6)
    v_mfma_f32_16x16x32_bf16 v[188:191], v[204:207], v[36:39], v[188:191]
    v_cvt_pk_bf16_f32 v49, v146, v147
    v_cvt_pk_bf16_f32 v50, v152, v153
    v_cvt_pk_bf16_f32 v51, v154, v155
    v_mfma_f32_16x16x32_bf16 v[180:183], v[200:203], v[36:39], v[180:183]
    ds_write_b128 v3, v[48:51] offset:2048
    v_cvt_pk_bf16_f32 v52, v148, v149
    v_cvt_pk_bf16_f32 v53, v150, v151
    v_mfma_f32_16x16x32_bf16 v[172:175], v[196:199], v[36:39], v[172:175]
    v_cvt_pk_bf16_f32 v54, v156, v157
    v_cvt_pk_bf16_f32 v55, v158, v159
    v_mfma_f32_16x16x32_bf16 v[164:167], v[192:195], v[36:39], v[164:167]
    ds_write_b128 v3, v[52:55] offset:3072
    ds_write_b32 v1, v0
    s_waitcnt lgkmcnt(7)
    v_mfma_f32_16x16x32_bf16 v[160:163], v[208:211], v[16:19], v[160:163]
    ds_read_b64_tr_b16 v[24:25], v14 offset:16384
    v_pk_max_u16 v72, v40, v41
    v_mfma_f32_16x16x32_bf16 v[168:171], v[212:215], v[16:19], v[168:171]
    ds_read_b64_tr_b16 v[26:27], v14 offset:16896
    v_pk_max_u16 v72, v72, v42
    v_mfma_f32_16x16x32_bf16 v[176:179], v[216:219], v[16:19], v[176:179]
    ds_read_b64_tr_b16 v[28:29], v15 offset:16384
    v_pk_max_u16 v72, v72, v43
    v_mfma_f32_16x16x32_bf16 v[184:187], v[220:223], v[16:19], v[184:187]
    ds_read_b64_tr_b16 v[30:31], v15 offset:16896
    v_pk_max_u16 v72, v72, v44
    s_waitcnt lgkmcnt(8)
    v_mfma_f32_16x16x32_bf16 v[188:191], v[220:223], v[20:23], v[188:191]
    v_pk_max_u16 v72, v72, v45
    v_mfma_f32_16x16x32_bf16 v[180:183], v[216:219], v[20:23], v[180:183]
    v_pk_max_u16 v72, v72, v46
    v_mfma_f32_16x16x32_bf16 v[172:175], v[212:215], v[20:23], v[172:175]
    v_pk_max_u16 v72, v72, v47
    v_mfma_f32_16x16x32_bf16 v[164:167], v[208:211], v[20:23], v[164:167]
    s_waitcnt lgkmcnt(2)
    v_mfma_f32_16x16x32_bf16 v[160:163], v[224:227], v[24:27], v[160:163]
    ds_read_b64_tr_b16 v[32:33], v14 offset:20480
    v_pk_max_u16 v72, v72, v48
    v_mfma_f32_16x16x32_bf16 v[168:171], v[228:231], v[24:27], v[168:171]
    ds_read_b64_tr_b16 v[34:35], v14 offset:20992
    v_pk_max_u16 v72, v72, v49
    v_mfma_f32_16x16x32_bf16 v[176:179], v[232:235], v[24:27], v[176:179]
    ds_read_b64_tr_b16 v[36:37], v15 offset:20480
    v_pk_max_u16 v72, v72, v50
    v_mfma_f32_16x16x32_bf16 v[184:187], v[236:239], v[24:27], v[184:187]
    ds_read_b64_tr_b16 v[38:39], v15 offset:20992
    v_pk_max_u16 v72, v72, v51
    s_waitcnt lgkmcnt(4)
    v_mfma_f32_16x16x32_bf16 v[188:191], v[236:239], v[28:31], v[188:191]
    v_pk_max_u16 v72, v72, v52
    v_mfma_f32_16x16x32_bf16 v[180:183], v[232:235], v[28:31], v[180:183]
    v_pk_max_u16 v72, v72, v53
    v_mfma_f32_16x16x32_bf16 v[172:175], v[228:231], v[28:31], v[172:175]
    v_pk_max_u16 v72, v72, v54
    v_mfma_f32_16x16x32_bf16 v[164:167], v[224:227], v[28:31], v[164:167]
    v_pk_max_u16 v72, v72, v55
    s_waitcnt lgkmcnt(2)
    v_mfma_f32_16x16x32_bf16 v[160:163], v[240:243], v[32:35], v[160:163]
    ds_read_b64_tr_b16 v[16:17], v10 offset:40960
    v_add_u32 v3, 65536, v3
    v_mfma_f32_16x16x32_bf16 v[168:171], v[244:247], v[32:35], v[168:171]
    ds_read_b64_tr_b16 v[18:19], v10 offset:41472
    v_lshrrev_b32 v73, 16, v72
    v_mfma_f32_16x16x32_bf16 v[176:179], v[248:251], v[32:35], v[176:179]
    ds_read_b64_tr_b16 v[20:21], v11 offset:40960
    v_and_b32 v72, 0xffff, v72
    v_mfma_f32_16x16x32_bf16 v[184:187], v[252:255], v[32:35], v[184:187]
    ds_read_b64_tr_b16 v[22:23], v11 offset:41472
    v_max_u32 v72, v72, v73
    s_waitcnt lgkmcnt(4)
    v_mfma_f32_16x16x32_bf16 v[188:191], v[252:255], v[36:39], v[188:191]
    v_cmp_lt_u32 vcc, 0xc0db, v72
    v_mfma_f32_16x16x32_bf16 v[180:183], v[248:251], v[36:39], v[180:183]
    s_cmp_lg_u64 vcc, 0
    v_mfma_f32_16x16x32_bf16 v[172:175], v[244:247], v[36:39], v[172:175]
    s_cselect_b32 s66, 2, 1
    v_mfma_f32_16x16x32_bf16 v[164:167], v[240:243], v[36:39], v[164:167]
    v_mov_b32 v0, s66
    s_waitcnt lgkmcnt(2)
    v_mfma_f32_16x16x32_bf16 v[96:99], v[16:19], v[192:195], v[96:99]
    ds_read_b64_tr_b16 v[24:25], v10 offset:45056
    s_nop 5
    v_cvt_pk_bf16_f32 v40, v160, v161
    v_cvt_pk_bf16_f32 v41, v162, v163
    v_mfma_f32_16x16x32_bf16 v[104:107], v[16:19], v[196:199], v[104:107]
    ds_read_b64_tr_b16 v[26:27], v10 offset:45568
    v_cvt_pk_bf16_f32 v42, v168, v169
    v_cvt_pk_bf16_f32 v43, v170, v171
    ds_write_b128 v3, v[40:43] offset:0
    v_mfma_f32_16x16x32_bf16 v[112:115], v[16:19], v[200:203], v[112:115]
    ds_read_b64_tr_b16 v[28:29], v11 offset:45056
    v_cvt_pk_bf16_f32 v44, v164, v165
    v_cvt_pk_bf16_f32 v45, v166, v167
    v_cvt_pk_bf16_f32 v46, v172, v173
    v_mfma_f32_16x16x32_bf16 v[120:123], v[16:19], v[204:207], v[120:123]
    ds_read_b64_tr_b16 v[30:31], v11 offset:45568
    v_cvt_pk_bf16_f32 v47, v174, v175
    ds_write_b128 v3, v[44:47] offset:1024
    v_cvt_pk_bf16_f32 v48, v176, v177
    s_waitcnt lgkmcnt(6)
    v_mfma_f32_16x16x32_bf16 v[124:127], v[20:23], v[204:207], v[124:127]
    v_cvt_pk_bf16_f32 v49, v178, v179
    v_cvt_pk_bf16_f32 v50, v184, v185
    v_cvt_pk_bf16_f32 v51, v186, v187
    v_mfma_f32_16x16x32_bf16 v[116:119], v[20:23], v[200:203], v[116:119]
    ds_write_b128 v3, v[48:51] offset:2048
    v_cvt_pk_bf16_f32 v52, v180, v181
    v_cvt_pk_bf16_f32 v53, v182, v183
    v_mfma_f32_16x16x32_bf16 v[108:111], v[20:23], v[196:199], v[108:111]
    v_cvt_pk_bf16_f32 v54, v188, v189
    v_cvt_pk_bf16_f32 v55, v190, v191
    v_mfma_f32_16x16x32_bf16 v[100:103], v[20:23], v[192:195], v[100:103]
    ds_write_b128 v3, v[52:55] offset:3072
    ds_write_b32 v1, v0 offset:16
    s_waitcnt lgkmcnt(7)
    v_mfma_f32_16x16x32_bf16 v[96:99], v[24:27], v[208:211], v[96:99]
    ds_read_b64_tr_b16 v[32:33], v6 offset:0
    v_lshlrev_b32 v9, 4, v2
    v_mfma_f32_16x16x32_bf16 v[104:107], v[24:27], v[212:215], v[104:107]
    ds_read_b64_tr_b16 v[34:35], v6 offset:512
    v_mov_b32 v136, 0
    v_mfma_f32_16x16x32_bf16 v[112:115], v[24:27], v[216:219], v[112:115]
    ds_read_b64_tr_b16 v[36:37], v7 offset:0
    v_mov_b32 v137, 0
    v_mfma_f32_16x16x32_bf16 v[120:123], v[24:27], v[220:223], v[120:123]
    ds_read_b64_tr_b16 v[38:39], v7 offset:512
    v_mov_b32 v140, 0
    s_waitcnt lgkmcnt(8)
    v_mfma_f32_16x16x32_bf16 v[124:127], v[28:31], v[220:223], v[124:127]
    v_mov_b32 v141, 0
    v_mfma_f32_16x16x32_bf16 v[116:119], v[28:31], v[216:219], v[116:119]
    v_mov_b32 v138, v94
    v_mfma_f32_16x16x32_bf16 v[108:111], v[28:31], v[212:215], v[108:111]
    v_mov_b32 v139, v95
    v_mfma_f32_16x16x32_bf16 v[100:103], v[28:31], v[208:211], v[100:103]
    s_waitcnt lgkmcnt(2)
    v_mfma_f32_16x16x32_bf16 v[96:99], v[32:35], v[224:227], v[96:99]
    ds_read_b64_tr_b16 v[16:17], v6 offset:4096
    v_bfe_u32 v77, v2, 4, 1
    v_lshrrev_b32 v78, 5, v2
    v_mfma_f32_16x16x32_bf16 v[104:107], v[32:35], v[228:231], v[104:107]
    ds_read_b64_tr_b16 v[18:19], v6 offset:4608
    v_lshl_add_u32 v77, v77, 1, v78
    v_bfe_u32 v78, v2, 1, 3
    v_mfma_f32_16x16x32_bf16 v[112:115], v[32:35], v[232:235], v[112:115]
    ds_read_b64_tr_b16 v[20:21], v7 offset:4096
    v_xor_b32 v77, v77, v78
    v_and_b32 v78, 127, v92
    v_mfma_f32_16x16x32_bf16 v[120:123], v[32:35], v[236:239], v[120:123]
    ds_read_b64_tr_b16 v[22:23], v7 offset:4608
    v_lshlrev_b32 v78, 7, v78
    v_lshl_add_u32 v77, v77, 4, v78
    s_waitcnt lgkmcnt(4)
    v_mfma_f32_16x16x32_bf16 v[124:127], v[36:39], v[236:239], v[124:127]
    v_add_u32 v77, 122880, v77
    v_xor_b32 v78, 64, v77
    v_mfma_f32_16x16x32_bf16 v[116:119], v[36:39], v[232:235], v[116:119]
    ds_read_b128 v[144:147], v77
    v_mfma_f32_16x16x32_bf16 v[108:111], v[36:39], v[228:231], v[108:111]
    ds_read_b128 v[148:151], v78
    v_mfma_f32_16x16x32_bf16 v[100:103], v[36:39], v[224:227], v[100:103]
    v_mov_b32 v76, 155664
    s_waitcnt lgkmcnt(4)
    v_mfma_f32_16x16x32_bf16 v[96:99], v[16:19], v[240:243], v[96:99]
    ds_read_b128 v[72:75], v76
    v_mfma_f32_16x16x32_bf16 v[104:107], v[16:19], v[244:247], v[104:107]
    v_mfma_f32_16x16x32_bf16 v[112:115], v[16:19], v[248:251], v[112:115]
    v_mfma_f32_16x16x32_bf16 v[120:123], v[16:19], v[252:255], v[120:123]
    s_waitcnt lgkmcnt(3)
    v_mfma_f32_16x16x32_bf16 v[124:127], v[20:23], v[252:255], v[124:127]
    v_mfma_f32_16x16x32_bf16 v[116:119], v[20:23], v[248:251], v[116:119]
    v_mfma_f32_16x16x32_bf16 v[108:111], v[20:23], v[244:247], v[108:111]
    v_mfma_f32_16x16x32_bf16 v[100:103], v[20:23], v[240:243], v[100:103]
    s_nop 7
    v_cvt_pk_bf16_f32 v16, v96, v97
    v_cvt_pk_bf16_f32 v17, v98, v99
    v_cvt_pk_bf16_f32 v18, v100, v101
    v_cvt_pk_bf16_f32 v19, v102, v103
    v_cvt_pk_bf16_f32 v20, v104, v105
    v_cvt_pk_bf16_f32 v21, v106, v107
    v_cvt_pk_bf16_f32 v22, v108, v109
    v_cvt_pk_bf16_f32 v23, v110, v111
    v_cvt_pk_bf16_f32 v40, v112, v113
    v_cvt_pk_bf16_f32 v41, v114, v115
    v_cvt_pk_bf16_f32 v42, v116, v117
    v_cvt_pk_bf16_f32 v43, v118, v119
    v_cvt_pk_bf16_f32 v44, v120, v121
    v_cvt_pk_bf16_f32 v45, v122, v123
    v_cvt_pk_bf16_f32 v46, v124, v125
    v_cvt_pk_bf16_f32 v47, v126, v127
    s_lshl_b32 s66, s3, 11
    s_add_u32 s66, s66, 139264
    v_lshlrev_b32 v3, 4, v2
    v_add_u32 v3, s66, v3
C_qw:
    s_waitcnt lgkmcnt(0)
    v_min_u32 v72, v72, v73
    v_min3_u32 v72, v72, v74, v75
    v_cmp_eq_u32 vcc, 0, v72
    s_cbranch_vccz C_qg
    ds_read_b128 v[72:75], v76
    s_branch C_qw
C_qg:
    ds_write_b128 v3, v[40:43]
    ds_write_b128 v3, v[44:47] offset:1024
    s_waitcnt lgkmcnt(0)
    s_barrier
    v_lshlrev_b32 v32, 16, v16
    v_and_b32 v33, 0xffff0000, v16
    v_pk_mul_f32 v[34:35], v[32:33], s[70:71]
    v_pk_add_f32 v[32:33], v[32:33], 1.0 op_sel_hi:[1,0]
    v_exp_f32 v34, v34 clamp
    v_exp_f32 v35, v35 clamp
    v_lshlrev_b32 v36, 16, v17
    v_and_b32 v37, 0xffff0000, v17
    v_pk_mul_f32 v[38:39], v[36:37], s[70:71]
    v_pk_add_f32 v[36:37], v[36:37], 1.0 op_sel_hi:[1,0]
    v_exp_f32 v38, v38 clamp
    v_exp_f32 v39, v39 clamp
    v_max_f32 v32, v32, v34
    v_max_f32 v33, v33, v35
    v_min_f32 v40, v32, v33
    v_cvt_pk_bf16_f32 v24, v32, v33
    v_max_f32 v36, v36, v38
    v_max_f32 v37, v37, v39
    v_min3_f32 v40, v36, v37, v40
    v_cvt_pk_bf16_f32 v25, v36, v37
    v_lshlrev_b32 v32, 16, v18
    v_and_b32 v33, 0xffff0000, v18
    v_pk_mul_f32 v[34:35], v[32:33], s[70:71]
    v_pk_add_f32 v[32:33], v[32:33], 1.0 op_sel_hi:[1,0]
    v_exp_f32 v34, v34 clamp
    v_exp_f32 v35, v35 clamp
    v_lshlrev_b32 v36, 16, v19
    v_and_b32 v37, 0xffff0000, v19
    v_pk_mul_f32 v[38:39], v[36:37], s[70:71]
    v_pk_add_f32 v[36:37], v[36:37], 1.0 op_sel_hi:[1,0]
    v_exp_f32 v38, v38 clamp
    v_exp_f32 v39, v39 clamp
    v_max_f32 v32, v32, v34
    v_max_f32 v33, v33, v35
    v_min3_f32 v40, v32, v33, v40
    v_cvt_pk_bf16_f32 v26, v32, v33
    v_max_f32 v36, v36, v38
    v_max_f32 v37, v37, v39
    v_min3_f32 v40, v36, v37, v40
    v_cvt_pk_bf16_f32 v27, v36, v37
    v_lshlrev_b32 v32, 16, v20
    v_and_b32 v33, 0xffff0000, v20
    v_pk_mul_f32 v[34:35], v[32:33], s[70:71]
    v_pk_add_f32 v[32:33], v[32:33], 1.0 op_sel_hi:[1,0]
    v_exp_f32 v34, v34 clamp
    v_exp_f32 v35, v35 clamp
    v_lshlrev_b32 v36, 16, v21
    v_and_b32 v37, 0xffff0000, v21
    v_pk_mul_f32 v[38:39], v[36:37], s[70:71]
    v_pk_add_f32 v[36:37], v[36:37], 1.0 op_sel_hi:[1,0]
    v_exp_f32 v38, v38 clamp
    v_exp_f32 v39, v39 clamp
    v_max_f32 v32, v32, v34
    v_max_f32 v33, v33, v35
    v_min3_f32 v40, v32, v33, v40
    v_cvt_pk_bf16_f32 v28, v32, v33
    v_max_f32 v36, v36, v38
    v_max_f32 v37, v37, v39
    v_min3_f32 v40, v36, v37, v40
    v_cvt_pk_bf16_f32 v29, v36, v37
    v_lshlrev_b32 v32, 16, v22
    v_and_b32 v33, 0xffff0000, v22
    v_pk_mul_f32 v[34:35], v[32:33], s[70:71]
    v_pk_add_f32 v[32:33], v[32:33], 1.0 op_sel_hi:[1,0]
    v_exp_f32 v34, v34 clamp
    v_exp_f32 v35, v35 clamp
    v_lshlrev_b32 v36, 16, v23
    v_and_b32 v37, 0xffff0000, v23
    v_pk_mul_f32 v[38:39], v[36:37], s[70:71]
    v_pk_add_f32 v[36:37], v[36:37], 1.0 op_sel_hi:[1,0]
    v_exp_f32 v38, v38 clamp
    v_exp_f32 v39, v39 clamp
    v_max_f32 v32, v32, v34
    v_max_f32 v33, v33, v35
    v_min3_f32 v40, v32, v33, v40
    v_cvt_pk_bf16_f32 v30, v32, v33
    v_max_f32 v36, v36, v38
    v_max_f32 v37, v37, v39
    v_min3_f32 v40, v36, v37, v40
    v_cvt_pk_bf16_f32 v31, v36, v37
    v_cmp_gt_f32 vcc, 0x3a800000, v40
    s_cbranch_vccz P_qd
    v_lshlrev_b32 v32, 16, v24
    v_and_b32 v33, 0xffff0000, v24
    v_add_f32 v32, s47, v32
    v_add_f32 v33, s47, v33
    v_cvt_pk_bf16_f32 v24, v32, v33
    v_lshlrev_b32 v32, 16, v25
    v_and_b32 v33, 0xffff0000, v25
    v_add_f32 v32, s47, v32
    v_add_f32 v33, s47, v33
    v_cvt_pk_bf16_f32 v25, v32, v33
    v_lshlrev_b32 v32, 16, v26
    v_and_b32 v33, 0xffff0000, v26
    v_add_f32 v32, s47, v32
    v_add_f32 v33, s47, v33
    v_cvt_pk_bf16_f32 v26, v32, v33
    v_lshlrev_b32 v32, 16, v27
    v_and_b32 v33, 0xffff0000, v27
    v_add_f32 v32, s47, v32
    v_add_f32 v33, s47, v33
    v_cvt_pk_bf16_f32 v27, v32, v33
    v_lshlrev_b32 v32, 16, v28
    v_and_b32 v33, 0xffff0000, v28
    v_add_f32 v32, s47, v32
    v_add_f32 v33, s47, v33
    v_cvt_pk_bf16_f32 v28, v32, v33
    v_lshlrev_b32 v32, 16, v29
    v_and_b32 v33, 0xffff0000, v29
    v_add_f32 v32, s47, v32
    v_add_f32 v33, s47, v33
    v_cvt_pk_bf16_f32 v29, v32, v33
    v_lshlrev_b32 v32, 16, v30
    v_and_b32 v33, 0xffff0000, v30
    v_add_f32 v32, s47, v32
    v_add_f32 v33, s47, v33
    v_cvt_pk_bf16_f32 v30, v32, v33
    v_lshlrev_b32 v32, 16, v31
    v_and_b32 v33, 0xffff0000, v31
    v_add_f32 v32, s47, v32
    v_add_f32 v33, s47, v33
    v_cvt_pk_bf16_f32 v31, v32, v33
P_qd:
    buffer_load_dwordx4 v[232:235], v89, s[16:19], 0 offen sc1
    s_lshl_b32 s66, s49, 11
    s_add_u32 s66, s66, 159744
    v_add_u32 v10, s66, v9
    s_lshl_b32 s66, s49, 6
    s_add_u32 s66, s66, 159488
    v_lshrrev_b32 v11, 4, v2
    v_lshlrev_b32 v11, 4, v11
    v_add_u32 v11, s66, v11
    s_lshr_b32 s66, s44, 1
    s_lshl_b32 s67, s66, 11
    s_lshl_b32 s66, s66, 6
    s_and_b32 s59, s44, 1
    s_lshl_b32 s59, s59, 3
    s_add_u32 s66, s66, s59
    s_add_u32 s67, s67, s59
    s_add_u32 s66, s66, 159488
    s_add_u32 s67, s67, 159744
    v_add_u32 v12, s67, v9
    v_lshrrev_b32 v13, 4, v2
    v_lshlrev_b32 v13, 4, v13
    v_add_u32 v13, s66, v13
    s_mov_b32 s59, 0
P_z:
    s_add_u32 s59, s59, 1
    s_cmp_ge_u32 s59, 200000
    s_waitcnt vmcnt(0)
    s_cbranch_scc1 P_zk
    v_max_u32 v14, v232, v233
    v_max3_u32 v14, v14, v234, v235
    v_cmp_eq_u32 vcc, -1, v14
    s_cbranch_vccz P_zk
    buffer_load_dwordx4 v[232:235], v89, s[16:19], 0 offen sc1
    s_branch P_z
P_zk:
    s_xor_b32 s66, s57, 0
    buffer_load_dwordx4 v[160:163], v88, s[16:19], s66 offen offset:0 sc1
    s_xor_b32 s66, s57, 0
    buffer_load_dwordx4 v[164:167], v88, s[16:19], s66 offen offset:1024 sc1
    s_xor_b32 s66, s57, 0
    buffer_load_dwordx4 v[168:171], v88, s[16:19], s66 offen offset:2048 sc1
    s_xor_b32 s66, s57, 0
    buffer_load_dwordx4 v[172:175], v88, s[16:19], s66 offen offset:3072 sc1
    s_xor_b32 s66, s57, 4096
    buffer_load_dwordx4 v[176:179], v88, s[16:19], s66 offen offset:0 sc1
    s_xor_b32 s66, s57, 4096
    buffer_load_dwordx4 v[180:183], v88, s[16:19], s66 offen offset:1024 sc1
    s_xor_b32 s66, s57, 4096
    buffer_load_dwordx4 v[184:187], v88, s[16:19], s66 offen offset:2048 sc1
    s_xor_b32 s66, s57, 4096
    buffer_load_dwordx4 v[188:191], v88, s[16:19], s66 offen offset:3072 sc1
    s_xor_b32 s66, s57, 8192
    buffer_load_dwordx4 v[192:195], v88, s[16:19], s66 offen offset:0 sc1
    s_xor_b32 s66, s57, 8192
    buffer_load_dwordx4 v[196:199], v88, s[16:19], s66 offen offset:1024 sc1
    s_xor_b32 s66, s57, 8192
    buffer_load_dwordx4 v[200:203], v88, s[16:19], s66 offen offset:2048 sc1
    s_xor_b32 s66, s57, 8192
    buffer_load_dwordx4 v[204:207], v88, s[16:19], s66 offen offset:3072 sc1
    s_xor_b32 s66, s57, 12288
    buffer_load_dwordx4 v[208:211], v88, s[16:19], s66 offen offset:0 sc1
    s_xor_b32 s66, s57, 12288
    buffer_load_dwordx4 v[212:215], v88, s[16:19], s66 offen offset:1024 sc1
    s_xor_b32 s66, s57, 12288
    buffer_load_dwordx4 v[216:219], v88, s[16:19], s66 offen offset:2048 sc1
    s_xor_b32 s66, s57, 12288
    buffer_load_dwordx4 v[220:223], v88, s[16:19], s66 offen offset:3072 sc1
    v_add_f32_dpp v232, v232, v232 quad_perm:[1,0,3,2] row_mask:0xf bank_mask:0xf
    v_add_f32_dpp v233, v233, v233 quad_perm:[1,0,3,2] row_mask:0xf bank_mask:0xf
    v_add_f32_dpp v234, v234, v234 quad_perm:[1,0,3,2] row_mask:0xf bank_mask:0xf
    v_add_f32_dpp v235, v235, v235 quad_perm:[1,0,3,2] row_mask:0xf bank_mask:0xf
    v_add_f32_dpp v232, v232, v232 quad_perm:[2,3,0,1] row_mask:0xf bank_mask:0xf
    v_add_f32_dpp v233, v233, v233 quad_perm:[2,3,0,1] row_mask:0xf bank_mask:0xf
    v_add_f32_dpp v234, v234, v234 quad_perm:[2,3,0,1] row_mask:0xf bank_mask:0xf
    v_add_f32_dpp v235, v235, v235 quad_perm:[2,3,0,1] row_mask:0xf bank_mask:0xf
    v_add_f32_dpp v232, v232, v232 row_half_mirror row_mask:0xf bank_mask:0xf
    v_add_f32_dpp v233, v233, v233 row_half_mirror row_mask:0xf bank_mask:0xf
    v_add_f32_dpp v234, v234, v234 row_half_mirror row_mask:0xf bank_mask:0xf
    v_add_f32_dpp v235, v235, v235 row_half_mirror row_mask:0xf bank_mask:0xf
    v_add_f32_dpp v232, v232, v232 row_mirror row_mask:0xf bank_mask:0xf
    v_add_f32_dpp v233, v233, v233 row_mirror row_mask:0xf bank_mask:0xf
    v_add_f32_dpp v234, v234, v234 row_mirror row_mask:0xf bank_mask:0xf
    v_add_f32_dpp v235, v235, v235 row_mirror row_mask:0xf bank_mask:0xf
    v_cvt_pk_bf16_f32 v232, v232, v233
    v_cvt_pk_bf16_f32 v233, v234, v235
    ds_write_b64 v13, v[232:233]
    s_waitcnt vmcnt(15)
    v_max_u32 v14, v160, v161
    v_max3_u32 v14, v14, v162, v163
    v_mfma_f32_16x16x32_bf16 v[224:227], v[138:141], v[160:163], 0
    v_mfma_f32_16x16x32_bf16 v[228:231], v[136:139], v[160:163], 0
    s_waitcnt vmcnt(14)
    v_max3_u32 v14, v14, v164, v165
    v_max3_u32 v14, v14, v166, v167
    v_mfma_f32_16x16x32_bf16 v[224:227], v[138:141], v[164:167], v[224:227]
    v_mfma_f32_16x16x32_bf16 v[228:231], v[136:139], v[164:167], v[228:231]
    s_waitcnt vmcnt(13)
    v_max3_u32 v14, v14, v168, v169
    v_max3_u32 v14, v14, v170, v171
    v_mfma_f32_16x16x32_bf16 v[224:227], v[138:141], v[168:171], v[224:227]
    v_mfma_f32_16x16x32_bf16 v[228:231], v[136:139], v[168:171], v[228:231]
    s_waitcnt vmcnt(12)
    v_max3_u32 v14, v14, v172, v173
    v_max3_u32 v14, v14, v174, v175
    v_mfma_f32_16x16x32_bf16 v[224:227], v[138:141], v[172:175], v[224:227]
    v_mfma_f32_16x16x32_bf16 v[228:231], v[136:139], v[172:175], v[228:231]
    s_waitcnt vmcnt(11)
    v_max3_u32 v14, v14, v176, v177
    v_max3_u32 v14, v14, v178, v179
    v_mfma_f32_16x16x32_bf16 v[224:227], v[138:141], v[176:179], v[224:227]
    v_mfma_f32_16x16x32_bf16 v[228:231], v[136:139], v[176:179], v[228:231]
    s_waitcnt vmcnt(10)
    v_max3_u32 v14, v14, v180, v181
    v_max3_u32 v14, v14, v182, v183
    v_mfma_f32_16x16x32_bf16 v[224:227], v[138:141], v[180:183], v[224:227]
    v_mfma_f32_16x16x32_bf16 v[228:231], v[136:139], v[180:183], v[228:231]
    s_waitcnt vmcnt(9)
    v_max3_u32 v14, v14, v184, v185
    v_max3_u32 v14, v14, v186, v187
    v_mfma_f32_16x16x32_bf16 v[224:227], v[138:141], v[184:187], v[224:227]
    v_mfma_f32_16x16x32_bf16 v[228:231], v[136:139], v[184:187], v[228:231]
    s_waitcnt vmcnt(8)
    v_max3_u32 v14, v14, v188, v189
    v_max3_u32 v14, v14, v190, v191
    v_mfma_f32_16x16x32_bf16 v[224:227], v[138:141], v[188:191], v[224:227]
    v_mfma_f32_16x16x32_bf16 v[228:231], v[136:139], v[188:191], v[228:231]
    s_waitcnt vmcnt(7)
    v_max3_u32 v14, v14, v192, v193
    v_max3_u32 v14, v14, v194, v195
    v_mfma_f32_16x16x32_bf16 v[224:227], v[138:141], v[192:195], v[224:227]
    v_mfma_f32_16x16x32_bf16 v[228:231], v[136:139], v[192:195], v[228:231]
    s_waitcnt vmcnt(6)
    v_max3_u32 v14, v14, v196, v197
    v_max3_u32 v14, v14, v198, v199
    v_mfma_f32_16x16x32_bf16 v[224:227], v[138:141], v[196:199], v[224:227]
    v_mfma_f32_16x16x32_bf16 v[228:231], v[136:139], v[196:199], v[228:231]
    s_waitcnt vmcnt(5)
    v_max3_u32 v14, v14, v200, v201
    v_max3_u32 v14, v14, v202, v203
    v_mfma_f32_16x16x32_bf16 v[224:227], v[138:141], v[200:203], v[224:227]
    v_mfma_f32_16x16x32_bf16 v[228:231], v[136:139], v[200:203], v[228:231]
    s_waitcnt vmcnt(4)
    v_max3_u32 v14, v14, v204, v205
    v_max3_u32 v14, v14, v206, v207
    v_mfma_f32_16x16x32_bf16 v[224:227], v[138:141], v[204:207], v[224:227]
    v_mfma_f32_16x16x32_bf16 v[228:231], v[136:139], v[204:207], v[228:231]
    s_waitcnt vmcnt(3)
    v_max3_u32 v14, v14, v208, v209
    v_max3_u32 v14, v14, v210, v211
    v_mfma_f32_16x16x32_bf16 v[224:227], v[138:141], v[208:211], v[224:227]
    v_mfma_f32_16x16x32_bf16 v[228:231], v[136:139], v[208:211], v[228:231]
    s_waitcnt vmcnt(2)
    v_max3_u32 v14, v14, v212, v213
    v_max3_u32 v14, v14, v214, v215
    v_mfma_f32_16x16x32_bf16 v[224:227], v[138:141], v[212:215], v[224:227]
    v_mfma_f32_16x16x32_bf16 v[228:231], v[136:139], v[212:215], v[228:231]
    s_waitcnt vmcnt(1)
    v_max3_u32 v14, v14, v216, v217
    v_max3_u32 v14, v14, v218, v219
    v_mfma_f32_16x16x32_bf16 v[224:227], v[138:141], v[216:219], v[224:227]
    v_mfma_f32_16x16x32_bf16 v[228:231], v[136:139], v[216:219], v[228:231]
    s_waitcnt vmcnt(0)
    v_max3_u32 v14, v14, v220, v221
    v_max3_u32 v14, v14, v222, v223
    v_mfma_f32_16x16x32_bf16 v[224:227], v[138:141], v[220:223], v[224:227]
    v_mfma_f32_16x16x32_bf16 v[228:231], v[136:139], v[220:223], v[228:231]
    v_cmp_eq_u32 vcc, -1, v14
    s_cbranch_vccnz P_slow
P_h1ok:
    s_nop 5
    v_cvt_pk_bf16_f32 v224, v224, v225
    v_cvt_pk_bf16_f32 v225, v226, v227
    v_cvt_pk_bf16_f32 v226, v228, v229
    v_cvt_pk_bf16_f32 v227, v230, v231
    ds_write_b64 v12, v[224:225]
    ds_write_b64 v12, v[226:227] offset:1024
    s_branch POST
P_slow:
    s_mov_b32 s59, 0
P_retry:
    s_mov_b32 s76, 0
    v_max_u32 v14, v160, v161
    v_max3_u32 v14, v14, v162, v163
    v_cmp_eq_u32 vcc, -1, v14
    s_cbranch_vccz P_rc0
    s_xor_b32 s66, s57, 0
    buffer_load_dwordx4 v[160:163], v88, s[16:19], s66 offen offset:0 sc1
    s_mov_b32 s76, 1
P_rc0:
    v_max_u32 v14, v164, v165
    v_max3_u32 v14, v14, v166, v167
    v_cmp_eq_u32 vcc, -1, v14
    s_cbranch_vccz P_rc1
    s_xor_b32 s66, s57, 0
    buffer_load_dwordx4 v[164:167], v88, s[16:19], s66 offen offset:1024 sc1
    s_mov_b32 s76, 1
P_rc1:
    v_max_u32 v14, v168, v169
    v_max3_u32 v14, v14, v170, v171
    v_cmp_eq_u32 vcc, -1, v14
    s_cbranch_vccz P_rc2
    s_xor_b32 s66, s57, 0
    buffer_load_dwordx4 v[168:171], v88, s[16:19], s66 offen offset:2048 sc1
    s_mov_b32 s76, 1
P_rc2:
    v_max_u32 v14, v172, v173
    v_max3_u32 v14, v14, v174, v175
    v_cmp_eq_u32 vcc, -1, v14
    s_cbranch_vccz P_rc3
    s_xor_b32 s66, s57, 0
    buffer_load_dwordx4 v[172:175], v88, s[16:19], s66 offen offset:3072 sc1
    s_mov_b32 s76, 1
P_rc3:
    v_max_u32 v14, v176, v177
    v_max3_u32 v14, v14, v178, v179
    v_cmp_eq_u32 vcc, -1, v14
    s_cbranch_vccz P_rc4
    s_xor_b32 s66, s57, 4096
    buffer_load_dwordx4 v[176:179], v88, s[16:19], s66 offen offset:0 sc1
    s_mov_b32 s76, 1
P_rc4:
    v_max_u32 v14, v180, v181
    v_max3_u32 v14, v14, v182, v183
    v_cmp_eq_u32 vcc, -1, v14
    s_cbranch_vccz P_rc5
    s_xor_b32 s66, s57, 4096
    buffer_load_dwordx4 v[180:183], v88, s[16:19], s66 offen offset:1024 sc1
    s_mov_b32 s76, 1
P_rc5:
    v_max_u32 v14, v184, v185
    v_max3_u32 v14, v14, v186, v187
    v_cmp_eq_u32 vcc, -1, v14
    s_cbranch_vccz P_rc6
    s_xor_b32 s66, s57, 4096
    buffer_load_dwordx4 v[184:187], v88, s[16:19], s66 offen offset:2048 sc1
    s_mov_b32 s76, 1
P_rc6:
    v_max_u32 v14, v188, v189
    v_max3_u32 v14, v14, v190, v191
    v_cmp_eq_u32 vcc, -1, v14
    s_cbranch_vccz P_rc7
    s_xor_b32 s66, s57, 4096
    buffer_load_dwordx4 v[188:191], v88, s[16:19], s66 offen offset:3072 sc1
    s_mov_b32 s76, 1
P_rc7:
    v_max_u32 v14, v192, v193
    v_max3_u32 v14, v14, v194, v195
    v_cmp_eq_u32 vcc, -1, v14
    s_cbranch_vccz P_rc8
    s_xor_b32 s66, s57, 8192
    buffer_load_dwordx4 v[192:195], v88, s[16:19], s66 offen offset:0 sc1
    s_mov_b32 s76, 1
P_rc8:
    v_max_u32 v14, v196, v197
    v_max3_u32 v14, v14, v198, v199
    v_cmp_eq_u32 vcc, -1, v14
    s_cbranch_vccz P_rc9
    s_xor_b32 s66, s57, 8192
    buffer_load_dwordx4 v[196:199], v88, s[16:19], s66 offen offset:1024 sc1
    s_mov_b32 s76, 1
P_rc9:
    v_max_u32 v14, v200, v201
    v_max3_u32 v14, v14, v202, v203
    v_cmp_eq_u32 vcc, -1, v14
    s_cbranch_vccz P_rc10
    s_xor_b32 s66, s57, 8192
    buffer_load_dwordx4 v[200:203], v88, s[16:19], s66 offen offset:2048 sc1
    s_mov_b32 s76, 1
P_rc10:
    v_max_u32 v14, v204, v205
    v_max3_u32 v14, v14, v206, v207
    v_cmp_eq_u32 vcc, -1, v14
    s_cbranch_vccz P_rc11
    s_xor_b32 s66, s57, 8192
    buffer_load_dwordx4 v[204:207], v88, s[16:19], s66 offen offset:3072 sc1
    s_mov_b32 s76, 1
P_rc11:
    v_max_u32 v14, v208, v209
    v_max3_u32 v14, v14, v210, v211
    v_cmp_eq_u32 vcc, -1, v14
    s_cbranch_vccz P_rc12
    s_xor_b32 s66, s57, 12288
    buffer_load_dwordx4 v[208:211], v88, s[16:19], s66 offen offset:0 sc1
    s_mov_b32 s76, 1
P_rc12:
    v_max_u32 v14, v212, v213
    v_max3_u32 v14, v14, v214, v215
    v_cmp_eq_u32 vcc, -1, v14
    s_cbranch_vccz P_rc13
    s_xor_b32 s66, s57, 12288
    buffer_load_dwordx4 v[212:215], v88, s[16:19], s66 offen offset:1024 sc1
    s_mov_b32 s76, 1
P_rc13:
    v_max_u32 v14, v216, v217
    v_max3_u32 v14, v14, v218, v219
    v_cmp_eq_u32 vcc, -1, v14
    s_cbranch_vccz P_rc14
    s_xor_b32 s66, s57, 12288
    buffer_load_dwordx4 v[216:219], v88, s[16:19], s66 offen offset:2048 sc1
    s_mov_b32 s76, 1
P_rc14:
    v_max_u32 v14, v220, v221
    v_max3_u32 v14, v14, v222, v223
    v_cmp_eq_u32 vcc, -1, v14
    s_cbranch_vccz P_rc15
    s_xor_b32 s66, s57, 12288
    buffer_load_dwordx4 v[220:223], v88, s[16:19], s66 offen offset:3072 sc1
    s_mov_b32 s76, 1
P_rc15:
    s_add_u32 s59, s59, 1
    s_cmp_ge_u32 s59, 200000
    s_cselect_b32 s76, 0, s76
    s_waitcnt vmcnt(0)
    s_cmp_lg_u32 s76, 0
    s_cbranch_scc1 P_retry
    v_mfma_f32_16x16x32_bf16 v[224:227], v[138:141], v[160:163], 0
    v_mfma_f32_16x16x32_bf16 v[228:231], v[136:139], v[160:163], 0
    v_mfma_f32_16x16x32_bf16 v[224:227], v[138:141], v[164:167], v[224:227]
    v_mfma_f32_16x16x32_bf16 v[228:231], v[136:139], v[164:167], v[228:231]
    v_mfma_f32_16x16x32_bf16 v[224:227], v[138:141], v[168:171], v[224:227]
    v_mfma_f32_16x16x32_bf16 v[228:231], v[136:139], v[168:171], v[228:231]
    v_mfma_f32_16x16x32_bf16 v[224:227], v[138:141], v[172:175], v[224:227]
    v_mfma_f32_16x16x32_bf16 v[228:231], v[136:139], v[172:175], v[228:231]
    v_mfma_f32_16x16x32_bf16 v[224:227], v[138:141], v[176:179], v[224:227]
    v_mfma_f32_16x16x32_bf16 v[228:231], v[136:139], v[176:179], v[228:231]
    v_mfma_f32_16x16x32_bf16 v[224:227], v[138:141], v[180:183], v[224:227]
    v_mfma_f32_16x16x32_bf16 v[228:231], v[136:139], v[180:183], v[228:231]
    v_mfma_f32_16x16x32_bf16 v[224:227], v[138:141], v[184:187], v[224:227]
    v_mfma_f32_16x16x32_bf16 v[228:231], v[136:139], v[184:187], v[228:231]
    v_mfma_f32_16x16x32_bf16 v[224:227], v[138:141], v[188:191], v[224:227]
    v_mfma_f32_16x16x32_bf16 v[228:231], v[136:139], v[188:191], v[228:231]
    v_mfma_f32_16x16x32_bf16 v[224:227], v[138:141], v[192:195], v[224:227]
    v_mfma_f32_16x16x32_bf16 v[228:231], v[136:139], v[192:195], v[228:231]
    v_mfma_f32_16x16x32_bf16 v[224:227], v[138:141], v[196:199], v[224:227]
    v_mfma_f32_16x16x32_bf16 v[228:231], v[136:139], v[196:199], v[228:231]
    v_mfma_f32_16x16x32_bf16 v[224:227], v[138:141], v[200:203], v[224:227]
    v_mfma_f32_16x16x32_bf16 v[228:231], v[136:139], v[200:203], v[228:231]
    v_mfma_f32_16x16x32_bf16 v[224:227], v[138:141], v[204:207], v[224:227]
    v_mfma_f32_16x16x32_bf16 v[228:231], v[136:139], v[204:207], v[228:231]
    v_mfma_f32_16x16x32_bf16 v[224:227], v[138:141], v[208:211], v[224:227]
    v_mfma_f32_16x16x32_bf16 v[228:231], v[136:139], v[208:211], v[228:231]
    v_mfma_f32_16x16x32_bf16 v[224:227], v[138:141], v[212:215], v[224:227]
    v_mfma_f32_16x16x32_bf16 v[228:231], v[136:139], v[212:215], v[228:231]
    v_mfma_f32_16x16x32_bf16 v[224:227], v[138:141], v[216:219], v[224:227]
    v_mfma_f32_16x16x32_bf16 v[228:231], v[136:139], v[216:219], v[228:231]
    v_mfma_f32_16x16x32_bf16 v[224:227], v[138:141], v[220:223], v[224:227]
    v_mfma_f32_16x16x32_bf16 v[228:231], v[136:139], v[220:223], v[228:231]
    s_nop 1
    s_branch P_h1ok
HELP:
    v_lshlrev_b32 v9, 4, v2
    s_lshl_b32 s56, s5, 2
    s_add_u32 s56, s56, s44
    s_lshl_b32 s53, s56, 10
    s_lshl_b32 s66, s4, 6
    s_add_u32 s53, s53, s66
    s_add_u32 s53, s53, 5242880
    s_lshl_b32 s56, s56, 4
    s_add_u32 s56, s56, s4
    s_lshl_b32 s56, s56, 10
    s_add_u32 s56, s56, 4194304
    s_lshl_b32 s55, s73, 2
    s_add_u32 s55, s55, s44
    s_lshl_b32 s55, s55, 6
    s_add_u32 s55, s55, s79
    s_lshl_b32 s55, s55, 8
    s_add_u32 s55, s55, 5832704
    v_lshrrev_b32 v12, 3, v2
    s_lshl_b32 s67, s44, 3
    v_add_u32 v12, s67, v12
    v_lshlrev_b32 v12, 11, v12
    v_lshrrev_b32 v13, 4, v2
    v_lshlrev_b32 v13, 1, v13
    v_and_b32 v90, 7, v2
    v_xor_b32 v13, v13, v90
    v_lshl_add_u32 v12, v13, 4, v12
    s_lshl_b32 s66, s7, 7
    v_add_u32 v90, s66, v12
    s_lshl_b32 s66, s6, 7
    s_lshl_b32 s67, s44, 5
    s_add_u32 s66, s66, s67
    s_lshl_b32 s67, s45, 4
    s_add_u32 s66, s66, s67
    v_and_b32 v92, 15, v2
    v_add_u32 v92, s66, v92
    v_lshlrev_b32 v91, 11, v92
    v_bfe_u32 v12, v2, 4, 1
    v_lshl_add_u32 v91, v12, 5, v91
    v_lshrrev_b32 v12, 5, v2
    v_lshl_add_u32 v91, v12, 4, v91
    s_lshl_b32 s66, s7, 7
    v_add_u32 v91, s66, v91
    v_lshrrev_b32 v93, 2, v92
    v_lshlrev_b32 v93, 6, v93
    v_and_b32 v12, 3, v2
    v_lshl_add_u32 v93, v12, 2, v93
    s_lshl_b32 s66, s6, 1
    s_and_b32 s66, s66, 6
    s_lshl_b32 s67, s7, 3
    s_add_u32 s66, s66, s67
    s_and_b32 s66, s66, 7
    s_lshl_b32 s52, s66, 18
    s_lshr_b32 s49, s44, 1
    s_and_b32 s66, s44, 1
    s_lshl_b32 s66, s66, 2
    s_lshl_b32 s67, s45, 1
    s_add_u32 s66, s66, s67
    s_lshl_b32 s67, s4, 3
    s_add_u32 s66, s66, s67
    s_lshl_b32 s66, s66, 15
    s_lshl_b32 s67, s5, 11
    s_add_u32 s66, s66, s67
    s_lshl_b32 s67, s49, 10
    s_add_u32 s60, s66, s67
    s_add_u32 s61, s60, 32768
    v_lshrrev_b32 v10, 5, v2
    v_and_b32 v11, 31, v2
    v_lshlrev_b32 v12, 3, v10
    s_lshl_b32 s66, s79, 6
    s_lshl_b32 s67, s44, 4
    s_add_u32 s66, s66, s67
    v_add_u32 v12, s66, v12
    v_lshlrev_b32 v12, 11, v12
    v_lshl_add_u32 v12, v11, 4, v12
    s_lshl_b32 s66, s73, 9
    v_add_u32 v7, s66, v12
    s_lshr_b32 s62, s79, 2
    s_lshl_b32 s62, s62, 15
    s_and_b32 s66, s79, 3
    s_lshl_b32 s66, s66, 8
    s_add_u32 s62, s62, s66
    s_lshl_b32 s66, s44, 6
    s_add_u32 s62, s62, s66
    s_add_u32 s62, s62, 5308416
    s_add_u32 s63, s62, 16384
    v_lshrrev_b32 v1, 2, v2
    v_lshlrev_b32 v1, 10, v1
    v_and_b32 v13, 3, v2
    v_lshl_add_u32 v1, v13, 4, v1
    s_cmp_ge_u32 s44, 2
    s_cbranch_scc1 WORK
    s_waitcnt vmcnt(5)
    s_barrier
    s_cmp_le_u32 s77, 2
    s_addc_u32 s71, s76, 2
    s_and_b32 s71, s71, 15
    s_lshl_b32 s70, s71, 7
    s_mul_i32 s71, s71, 393216
    s_add_u32 m0, s72, 106496
    s_add_u32 s66, s71, 2048
    buffer_load_dwordx4 v5, s[12:15], s66 offen lds
    s_add_u32 m0, s72, 108544
    s_add_u32 s66, s71, 100352
    buffer_load_dwordx4 v5, s[12:15], s66 offen lds
    s_add_u32 m0, s72, 110592
    s_add_u32 s66, s71, 198656
    buffer_load_dwordx4 v5, s[12:15], s66 offen lds
    s_add_u32 m0, s72, 112640
    s_add_u32 s66, s71, 296960
    buffer_load_dwordx4 v5, s[12:15], s66 offen lds
    s_add_u32 m0, s72, 81920
    s_add_u32 s66, s70, 0
    buffer_load_dwordx4 v4, s[8:11], s66 offen lds
    s_add_u32 m0, s72, 83968
    s_add_u32 s66, s70, 32768
    buffer_load_dwordx4 v4, s[8:11], s66 offen lds
    s_add_u32 m0, s72, 86016
    s_add_u32 s66, s70, 65536
    buffer_load_dwordx4 v4, s[8:11], s66 offen lds
    s_add_u32 m0, s72, 88064
    s_add_u32 s66, s70, 98304
    buffer_load_dwordx4 v4, s[8:11], s66 offen lds
    s_add_u32 m0, s72, 90112
    s_add_u32 s66, s70, 131072
    buffer_load_dwordx4 v4, s[8:11], s66 offen lds
    s_add_u32 m0, s72, 92160
    s_add_u32 s66, s70, 163840
    buffer_load_dwordx4 v4, s[8:11], s66 offen lds
    s_add_u32 m0, s72, 94208
    s_add_u32 s66, s70, 196608
    buffer_load_dwordx4 v4, s[8:11], s66 offen lds
    s_add_u32 m0, s72, 96256
    s_add_u32 s66, s70, 229376
    buffer_load_dwordx4 v4, s[8:11], s66 offen lds
    s_add_u32 m0, s72, 114688
    s_add_u32 s66, s71, 4096
    buffer_load_dwordx4 v5, s[12:15], s66 offen lds
    s_add_u32 m0, s72, 116736
    s_add_u32 s66, s71, 102400
    buffer_load_dwordx4 v5, s[12:15], s66 offen lds
    s_add_u32 m0, s72, 118784
    s_add_u32 s66, s71, 200704
    buffer_load_dwordx4 v5, s[12:15], s66 offen lds
    s_add_u32 m0, s72, 120832
    s_add_u32 s66, s71, 299008
    buffer_load_dwordx4 v5, s[12:15], s66 offen lds
    s_add_u32 m0, s72, 98304
    s_add_u32 s66, s71, 0
    buffer_load_dwordx4 v5, s[12:15], s66 offen lds
    s_add_u32 m0, s72, 100352
    s_add_u32 s66, s71, 98304
    buffer_load_dwordx4 v5, s[12:15], s66 offen lds
    s_add_u32 m0, s72, 102400
    s_add_u32 s66, s71, 196608
    buffer_load_dwordx4 v5, s[12:15], s66 offen lds
    s_add_u32 m0, s72, 104448
    s_add_u32 s66, s71, 294912
    buffer_load_dwordx4 v5, s[12:15], s66 offen lds
    s_waitcnt vmcnt(20)
    s_barrier
    s_cmp_le_u32 s77, 3
    s_addc_u32 s71, s76, 3
    s_and_b32 s71, s71, 15
    s_lshl_b32 s70, s71, 7
    s_mul_i32 s71, s71, 393216
    s_add_u32 m0, s72, 24576
    s_add_u32 s66, s71, 2048
    buffer_load_dwordx4 v5, s[12:15], s66 offen lds
    s_add_u32 m0, s72, 26624
    s_add_u32 s66, s71, 100352
    buffer_load_dwordx4 v5, s[12:15], s66 offen lds
    s_add_u32 m0, s72, 28672
    s_add_u32 s66, s71, 198656
    buffer_load_dwordx4 v5, s[12:15], s66 offen lds
    s_add_u32 m0, s72, 30720
    s_add_u32 s66, s71, 296960
    buffer_load_dwordx4 v5, s[12:15], s66 offen lds
    s_add_u32 m0, s72, 0
    s_add_u32 s66, s70, 0
    buffer_load_dwordx4 v4, s[8:11], s66 offen lds
    s_add_u32 m0, s72, 2048
    s_add_u32 s66, s70, 32768
    buffer_load_dwordx4 v4, s[8:11], s66 offen lds
    s_add_u32 m0, s72, 4096
    s_add_u32 s66, s70, 65536
    buffer_load_dwordx4 v4, s[8:11], s66 offen lds
    s_add_u32 m0, s72, 6144
    s_add_u32 s66, s70, 98304
    buffer_load_dwordx4 v4, s[8:11], s66 offen lds
    s_add_u32 m0, s72, 8192
    s_add_u32 s66, s70, 131072
    buffer_load_dwordx4 v4, s[8:11], s66 offen lds
    s_add_u32 m0, s72, 10240
    s_add_u32 s66, s70, 163840
    buffer_load_dwordx4 v4, s[8:11], s66 offen lds
    s_add_u32 m0, s72, 12288
    s_add_u32 s66, s70, 196608
    buffer_load_dwordx4 v4, s[8:11], s66 offen lds
    s_add_u32 m0, s72, 14336
    s_add_u32 s66, s70, 229376
    buffer_load_dwordx4 v4, s[8:11], s66 offen lds
    s_add_u32 m0, s72, 32768
    s_add_u32 s66, s71, 4096
    buffer_load_dwordx4 v5, s[12:15], s66 offen lds
    s_add_u32 m0, s72, 34816
    s_add_u32 s66, s71, 102400
    buffer_load_dwordx4 v5, s[12:15], s66 offen lds
    s_add_u32 m0, s72, 36864
    s_add_u32 s66, s71, 200704
    buffer_load_dwordx4 v5, s[12:15], s66 offen lds
    s_add_u32 m0, s72, 38912
    s_add_u32 s66, s71, 299008
    buffer_load_dwordx4 v5, s[12:15], s66 offen lds
    s_add_u32 m0, s72, 16384
    s_add_u32 s66, s71, 0
    buffer_load_dwordx4 v5, s[12:15], s66 offen lds
    s_add_u32 m0, s72, 18432
    s_add_u32 s66, s71, 98304
    buffer_load_dwordx4 v5, s[12:15], s66 offen lds
    s_add_u32 m0, s72, 20480
    s_add_u32 s66, s71, 196608
    buffer_load_dwordx4 v5, s[12:15], s66 offen lds
    s_add_u32 m0, s72, 22528
    s_add_u32 s66, s71, 294912
    buffer_load_dwordx4 v5, s[12:15], s66 offen lds
    s_waitcnt vmcnt(20)
    s_barrier
    s_cmp_le_u32 s77, 4
    s_addc_u32 s71, s76, 4
    s_and_b32 s71, s71, 15
    s_lshl_b32 s70, s71, 7
    s_mul_i32 s71, s71, 393216
    s_add_u32 m0, s72, 65536
    s_add_u32 s66, s71, 2048
    buffer_load_dwordx4 v5, s[12:15], s66 offen lds
    s_add_u32 m0, s72, 67584
    s_add_u32 s66, s71, 100352
    buffer_load_dwordx4 v5, s[12:15], s66 offen lds
    s_add_u32 m0, s72, 69632
    s_add_u32 s66, s71, 198656
    buffer_load_dwordx4 v5, s[12:15], s66 offen lds
    s_add_u32 m0, s72, 71680
    s_add_u32 s66, s71, 296960
    buffer_load_dwordx4 v5, s[12:15], s66 offen lds
    s_add_u32 m0, s72, 40960
    s_add_u32 s66, s70, 0
    buffer_load_dwordx4 v4, s[8:11], s66 offen lds
    s_add_u32 m0, s72, 43008
    s_add_u32 s66, s70, 32768
    buffer_load_dwordx4 v4, s[8:11], s66 offen lds
    s_add_u32 m0, s72, 45056
    s_add_u32 s66, s70, 65536
    buffer_load_dwordx4 v4, s[8:11], s66 offen lds
    s_add_u32 m0, s72, 47104
    s_add_u32 s66, s70, 98304
    buffer_load_dwordx4 v4, s[8:11], s66 offen lds
    s_add_u32 m0, s72, 49152
    s_add_u32 s66, s70, 131072
    buffer_load_dwordx4 v4, s[8:11], s66 offen lds
    s_add_u32 m0, s72, 51200
    s_add_u32 s66, s70, 163840
    buffer_load_dwordx4 v4, s[8:11], s66 offen lds
    s_add_u32 m0, s72, 53248
    s_add_u32 s66, s70, 196608
    buffer_load_dwordx4 v4, s[8:11], s66 offen lds
    s_add_u32 m0, s72, 55296
    s_add_u32 s66, s70, 229376
    buffer_load_dwordx4 v4, s[8:11], s66 offen lds
    s_add_u32 m0, s72, 73728
    s_add_u32 s66, s71, 4096
    buffer_load_dwordx4 v5, s[12:15], s66 offen lds
    s_add_u32 m0, s72, 75776
    s_add_u32 s66, s71, 102400
    buffer_load_dwordx4 v5, s[12:15], s66 offen lds
    s_add_u32 m0, s72, 77824
    s_add_u32 s66, s71, 200704
    buffer_load_dwordx4 v5, s[12:15], s66 offen lds
    s_add_u32 m0, s72, 79872
    s_add_u32 s66, s71, 299008
    buffer_load_dwordx4 v5, s[12:15], s66 offen lds
    s_add_u32 m0, s72, 57344
    s_add_u32 s66, s71, 0
    buffer_load_dwordx4 v5, s[12:15], s66 offen lds
    s_add_u32 m0, s72, 59392
    s_add_u32 s66, s71, 98304
    buffer_load_dwordx4 v5, s[12:15], s66 offen lds
    s_add_u32 m0, s72, 61440
    s_add_u32 s66, s71, 196608
    buffer_load_dwordx4 v5, s[12:15], s66 offen lds
    s_add_u32 m0, s72, 63488
    s_add_u32 s66, s71, 294912
    buffer_load_dwordx4 v5, s[12:15], s66 offen lds
    s_waitcnt vmcnt(20)
    s_barrier
    s_cmp_le_u32 s77, 5
    s_addc_u32 s71, s76, 5
    s_and_b32 s71, s71, 15
    s_lshl_b32 s70, s71, 7
    s_mul_i32 s71, s71, 393216
    s_add_u32 m0, s72, 106496
    s_add_u32 s66, s71, 2048
    buffer_load_dwordx4 v5, s[12:15], s66 offen lds
    s_add_u32 m0, s72, 108544
    s_add_u32 s66, s71, 100352
    buffer_load_dwordx4 v5, s[12:15], s66 offen lds
    s_add_u32 m0, s72, 110592
    s_add_u32 s66, s71, 198656
    buffer_load_dwordx4 v5, s[12:15], s66 offen lds
    s_add_u32 m0, s72, 112640
    s_add_u32 s66, s71, 296960
    buffer_load_dwordx4 v5, s[12:15], s66 offen lds
    s_add_u32 m0, s72, 81920
    s_add_u32 s66, s70, 0
    buffer_load_dwordx4 v4, s[8:11], s66 offen lds
    s_add_u32 m0, s72, 83968
    s_add_u32 s66, s70, 32768
    buffer_load_dwordx4 v4, s[8:11], s66 offen lds
    s_add_u32 m0, s72, 86016
    s_add_u32 s66, s70, 65536
    buffer_load_dwordx4 v4, s[8:11], s66 offen lds
    s_add_u32 m0, s72, 88064
    s_add_u32 s66, s70, 98304
    buffer_load_dwordx4 v4, s[8:11], s66 offen lds
    s_add_u32 m0, s72, 90112
    s_add_u32 s66, s70, 131072
    buffer_load_dwordx4 v4, s[8:11], s66 offen lds
    s_add_u32 m0, s72, 92160
    s_add_u32 s66, s70, 163840
    buffer_load_dwordx4 v4, s[8:11], s66 offen lds
    s_add_u32 m0, s72, 94208
    s_add_u32 s66, s70, 196608
    buffer_load_dwordx4 v4, s[8:11], s66 offen lds
    s_add_u32 m0, s72, 96256
    s_add_u32 s66, s70, 229376
    buffer_load_dwordx4 v4, s[8:11], s66 offen lds
    s_add_u32 m0, s72, 114688
    s_add_u32 s66, s71, 4096
    buffer_load_dwordx4 v5, s[12:15], s66 offen lds
    s_add_u32 m0, s72, 116736
    s_add_u32 s66, s71, 102400
    buffer_load_dwordx4 v5, s[12:15], s66 offen lds
    s_add_u32 m0, s72, 118784
    s_add_u32 s66, s71, 200704
    buffer_load_dwordx4 v5, s[12:15], s66 offen lds
    s_add_u32 m0, s72, 120832
    s_add_u32 s66, s71, 299008
    buffer_load_dwordx4 v5, s[12:15], s66 offen lds
    s_add_u32 m0, s72, 98304
    s_add_u32 s66, s71, 0
    buffer_load_dwordx4 v5, s[12:15], s66 offen lds
    s_add_u32 m0, s72, 100352
    s_add_u32 s66, s71, 98304
    buffer_load_dwordx4 v5, s[12:15], s66 offen lds
    s_add_u32 m0, s72, 102400
    s_add_u32 s66, s71, 196608
    buffer_load_dwordx4 v5, s[12:15], s66 offen lds
    s_add_u32 m0, s72, 104448
    s_add_u32 s66, s71, 294912
    buffer_load_dwordx4 v5, s[12:15], s66 offen lds
    s_waitcnt vmcnt(20)
    s_barrier
    s_cmp_le_u32 s77, 6
    s_addc_u32 s71, s76, 6
    s_and_b32 s71, s71, 15
    s_lshl_b32 s70, s71, 7
    s_mul_i32 s71, s71, 393216
    s_add_u32 m0, s72, 24576
    s_add_u32 s66, s71, 2048
    buffer_load_dwordx4 v5, s[12:15], s66 offen lds
    s_add_u32 m0, s72, 26624
    s_add_u32 s66, s71, 100352
    buffer_load_dwordx4 v5, s[12:15], s66 offen lds
    s_add_u32 m0, s72, 28672
    s_add_u32 s66, s71, 198656
    buffer_load_dwordx4 v5, s[12:15], s66 offen lds
    s_add_u32 m0, s72, 30720
    s_add_u32 s66, s71, 296960
    buffer_load_dwordx4 v5, s[12:15], s66 offen lds
    s_add_u32 m0, s72, 0
    s_add_u32 s66, s70, 0
    buffer_load_dwordx4 v4, s[8:11], s66 offen lds
    s_add_u32 m0, s72, 2048
    s_add_u32 s66, s70, 32768
    buffer_load_dwordx4 v4, s[8:11], s66 offen lds
    s_add_u32 m0, s72, 4096
    s_add_u32 s66, s70, 65536
    buffer_load_dwordx4 v4, s[8:11], s66 offen lds
    s_add_u32 m0, s72, 6144
    s_add_u32 s66, s70, 98304
    buffer_load_dwordx4 v4, s[8:11], s66 offen lds
    s_add_u32 m0, s72, 8192
    s_add_u32 s66, s70, 131072
    buffer_load_dwordx4 v4, s[8:11], s66 offen lds
    s_add_u32 m0, s72, 10240
    s_add_u32 s66, s70, 163840
    buffer_load_dwordx4 v4, s[8:11], s66 offen lds
    s_add_u32 m0, s72, 12288
    s_add_u32 s66, s70, 196608
    buffer_load_dwordx4 v4, s[8:11], s66 offen lds
    s_add_u32 m0, s72, 14336
    s_add_u32 s66, s70, 229376
    buffer_load_dwordx4 v4, s[8:11], s66 offen lds
    s_add_u32 m0, s72, 32768
    s_add_u32 s66, s71, 4096
    buffer_load_dwordx4 v5, s[12:15], s66 offen lds
    s_add_u32 m0, s72, 34816
    s_add_u32 s66, s71, 102400
    buffer_load_dwordx4 v5, s[12:15], s66 offen lds
    s_add_u32 m0, s72, 36864
    s_add_u32 s66, s71, 200704
    buffer_load_dwordx4 v5, s[12:15], s66 offen lds
    s_add_u32 m0, s72, 38912
    s_add_u32 s66, s71, 299008
    buffer_load_dwordx4 v5, s[12:15], s66 offen lds
    s_add_u32 m0, s72, 16384
    s_add_u32 s66, s71, 0
    buffer_load_dwordx4 v5, s[12:15], s66 offen lds
    s_add_u32 m0, s72, 18432
    s_add_u32 s66, s71, 98304
    buffer_load_dwordx4 v5, s[12:15], s66 offen lds
    s_add_u32 m0, s72, 20480
    s_add_u32 s66, s71, 196608
    buffer_load_dwordx4 v5, s[12:15], s66 offen lds
    s_add_u32 m0, s72, 22528
    s_add_u32 s66, s71, 294912
    buffer_load_dwordx4 v5, s[12:15], s66 offen lds
    s_waitcnt vmcnt(20)
    s_barrier
    s_cmp_le_u32 s77, 7
    s_addc_u32 s71, s76, 7
    s_and_b32 s71, s71, 15
    s_lshl_b32 s70, s71, 7
    s_mul_i32 s71, s71, 393216
    s_add_u32 m0, s72, 65536
    s_add_u32 s66, s71, 2048
    buffer_load_dwordx4 v5, s[12:15], s66 offen lds
    s_add_u32 m0, s72, 67584
    s_add_u32 s66, s71, 100352
    buffer_load_dwordx4 v5, s[12:15], s66 offen lds
    s_add_u32 m0, s72, 69632
    s_add_u32 s66, s71, 198656
    buffer_load_dwordx4 v5, s[12:15], s66 offen lds
    s_add_u32 m0, s72, 71680
    s_add_u32 s66, s71, 296960
    buffer_load_dwordx4 v5, s[12:15], s66 offen lds
    s_add_u32 m0, s72, 40960
    s_add_u32 s66, s70, 0
    buffer_load_dwordx4 v4, s[8:11], s66 offen lds
    s_add_u32 m0, s72, 43008
    s_add_u32 s66, s70, 32768
    buffer_load_dwordx4 v4, s[8:11], s66 offen lds
    s_add_u32 m0, s72, 45056
    s_add_u32 s66, s70, 65536
    buffer_load_dwordx4 v4, s[8:11], s66 offen lds
    s_add_u32 m0, s72, 47104
    s_add_u32 s66, s70, 98304
    buffer_load_dwordx4 v4, s[8:11], s66 offen lds
    s_add_u32 m0, s72, 49152
    s_add_u32 s66, s70, 131072
    buffer_load_dwordx4 v4, s[8:11], s66 offen lds
    s_add_u32 m0, s72, 51200
    s_add_u32 s66, s70, 163840
    buffer_load_dwordx4 v4, s[8:11], s66 offen lds
    s_add_u32 m0, s72, 53248
    s_add_u32 s66, s70, 196608
    buffer_load_dwordx4 v4, s[8:11], s66 offen lds
    s_add_u32 m0, s72, 55296
    s_add_u32 s66, s70, 229376
    buffer_load_dwordx4 v4, s[8:11], s66 offen lds
    s_add_u32 m0, s72, 73728
    s_add_u32 s66, s71, 4096
    buffer_load_dwordx4 v5, s[12:15], s66 offen lds
    s_add_u32 m0, s72, 75776
    s_add_u32 s66, s71, 102400
    buffer_load_dwordx4 v5, s[12:15], s66 offen lds
    s_add_u32 m0, s72, 77824
    s_add_u32 s66, s71, 200704
    buffer_load_dwordx4 v5, s[12:15], s66 offen lds
    s_add_u32 m0, s72, 79872
    s_add_u32 s66, s71, 299008
    buffer_load_dwordx4 v5, s[12:15], s66 offen lds
    s_add_u32 m0, s72, 57344
    s_add_u32 s66, s71, 0
    buffer_load_dwordx4 v5, s[12:15], s66 offen lds
    s_add_u32 m0, s72, 59392
    s_add_u32 s66, s71, 98304
    buffer_load_dwordx4 v5, s[12:15], s66 offen lds
    s_add_u32 m0, s72, 61440
    s_add_u32 s66, s71, 196608
    buffer_load_dwordx4 v5, s[12:15], s66 offen lds
    s_add_u32 m0, s72, 63488
    s_add_u32 s66, s71, 294912
    buffer_load_dwordx4 v5, s[12:15], s66 offen lds
    s_waitcnt vmcnt(20)
    s_barrier
    s_cmp_le_u32 s77, 8
    s_addc_u32 s71, s76, 8
    s_and_b32 s71, s71, 15
    s_lshl_b32 s70, s71, 7
    s_mul_i32 s71, s71, 393216
    s_add_u32 m0, s72, 106496
    s_add_u32 s66, s71, 2048
    buffer_load_dwordx4 v5, s[12:15], s66 offen lds
    s_add_u32 m0, s72, 108544
    s_add_u32 s66, s71, 100352
    buffer_load_dwordx4 v5, s[12:15], s66 offen lds
    s_add_u32 m0, s72, 110592
    s_add_u32 s66, s71, 198656
    buffer_load_dwordx4 v5, s[12:15], s66 offen lds
    s_add_u32 m0, s72, 112640
    s_add_u32 s66, s71, 296960
    buffer_load_dwordx4 v5, s[12:15], s66 offen lds
    s_add_u32 m0, s72, 81920
    s_add_u32 s66, s70, 0
    buffer_load_dwordx4 v4, s[8:11], s66 offen lds
    s_add_u32 m0, s72, 83968
    s_add_u32 s66, s70, 32768
    buffer_load_dwordx4 v4, s[8:11], s66 offen lds
    s_add_u32 m0, s72, 86016
    s_add_u32 s66, s70, 65536
    buffer_load_dwordx4 v4, s[8:11], s66 offen lds
    s_add_u32 m0, s72, 88064
    s_add_u32 s66, s70, 98304
    buffer_load_dwordx4 v4, s[8:11], s66 offen lds
    s_add_u32 m0, s72, 90112
    s_add_u32 s66, s70, 131072
    buffer_load_dwordx4 v4, s[8:11], s66 offen lds
    s_add_u32 m0, s72, 92160
    s_add_u32 s66, s70, 163840
    buffer_load_dwordx4 v4, s[8:11], s66 offen lds
    s_add_u32 m0, s72, 94208
    s_add_u32 s66, s70, 196608
    buffer_load_dwordx4 v4, s[8:11], s66 offen lds
    s_add_u32 m0, s72, 96256
    s_add_u32 s66, s70, 229376
    buffer_load_dwordx4 v4, s[8:11], s66 offen lds
    s_add_u32 m0, s72, 114688
    s_add_u32 s66, s71, 4096
    buffer_load_dwordx4 v5, s[12:15], s66 offen lds
    s_add_u32 m0, s72, 116736
    s_add_u32 s66, s71, 102400
    buffer_load_dwordx4 v5, s[12:15], s66 offen lds
    s_add_u32 m0, s72, 118784
    s_add_u32 s66, s71, 200704
    buffer_load_dwordx4 v5, s[12:15], s66 offen lds
    s_add_u32 m0, s72, 120832
    s_add_u32 s66, s71, 299008
    buffer_load_dwordx4 v5, s[12:15], s66 offen lds
    s_add_u32 m0, s72, 98304
    s_add_u32 s66, s71, 0
    buffer_load_dwordx4 v5, s[12:15], s66 offen lds
    s_add_u32 m0, s72, 100352
    s_add_u32 s66, s71, 98304
    buffer_load_dwordx4 v5, s[12:15], s66 offen lds
    s_add_u32 m0, s72, 102400
    s_add_u32 s66, s71, 196608
    buffer_load_dwordx4 v5, s[12:15], s66 offen lds
    s_add_u32 m0, s72, 104448
    s_add_u32 s66, s71, 294912
    buffer_load_dwordx4 v5, s[12:15], s66 offen lds
    s_waitcnt vmcnt(20)
    s_barrier
    s_cmp_le_u32 s77, 9
    s_addc_u32 s71, s76, 9
    s_and_b32 s71, s71, 15
    s_lshl_b32 s70, s71, 7
    s_mul_i32 s71, s71, 393216
    s_add_u32 m0, s72, 24576
    s_add_u32 s66, s71, 2048
    buffer_load_dwordx4 v5, s[12:15], s66 offen lds
    s_add_u32 m0, s72, 26624
    s_add_u32 s66, s71, 100352
    buffer_load_dwordx4 v5, s[12:15], s66 offen lds
    s_add_u32 m0, s72, 28672
    s_add_u32 s66, s71, 198656
    buffer_load_dwordx4 v5, s[12:15], s66 offen lds
    s_add_u32 m0, s72, 30720
    s_add_u32 s66, s71, 296960
    buffer_load_dwordx4 v5, s[12:15], s66 offen lds
    s_add_u32 m0, s72, 0
    s_add_u32 s66, s70, 0
    buffer_load_dwordx4 v4, s[8:11], s66 offen lds
    s_add_u32 m0, s72, 2048
    s_add_u32 s66, s70, 32768
    buffer_load_dwordx4 v4, s[8:11], s66 offen lds
    s_add_u32 m0, s72, 4096
    s_add_u32 s66, s70, 65536
    buffer_load_dwordx4 v4, s[8:11], s66 offen lds
    s_add_u32 m0, s72, 6144
    s_add_u32 s66, s70, 98304
    buffer_load_dwordx4 v4, s[8:11], s66 offen lds
    s_add_u32 m0, s72, 8192
    s_add_u32 s66, s70, 131072
    buffer_load_dwordx4 v4, s[8:11], s66 offen lds
    s_add_u32 m0, s72, 10240
    s_add_u32 s66, s70, 163840
    buffer_load_dwordx4 v4, s[8:11], s66 offen lds
    s_add_u32 m0, s72, 12288
    s_add_u32 s66, s70, 196608
    buffer_load_dwordx4 v4, s[8:11], s66 offen lds
    s_add_u32 m0, s72, 14336
    s_add_u32 s66, s70, 229376
    buffer_load_dwordx4 v4, s[8:11], s66 offen lds
    s_add_u32 m0, s72, 32768
    s_add_u32 s66, s71, 4096
    buffer_load_dwordx4 v5, s[12:15], s66 offen lds
    s_add_u32 m0, s72, 34816
    s_add_u32 s66, s71, 102400
    buffer_load_dwordx4 v5, s[12:15], s66 offen lds
    s_add_u32 m0, s72, 36864
    s_add_u32 s66, s71, 200704
    buffer_load_dwordx4 v5, s[12:15], s66 offen lds
    s_add_u32 m0, s72, 38912
    s_add_u32 s66, s71, 299008
    buffer_load_dwordx4 v5, s[12:15], s66 offen lds
    s_add_u32 m0, s72, 16384
    s_add_u32 s66, s71, 0
    buffer_load_dwordx4 v5, s[12:15], s66 offen lds
    s_add_u32 m0, s72, 18432
    s_add_u32 s66, s71, 98304
    buffer_load_dwordx4 v5, s[12:15], s66 offen lds
    s_add_u32 m0, s72, 20480
    s_add_u32 s66, s71, 196608
    buffer_load_dwordx4 v5, s[12:15], s66 offen lds
    s_add_u32 m0, s72, 22528
    s_add_u32 s66, s71, 294912
    buffer_load_dwordx4 v5, s[12:15], s66 offen lds
    s_waitcnt vmcnt(20)
    s_barrier
    s_cmp_le_u32 s77, 10
    s_addc_u32 s71, s76, 10
    s_and_b32 s71, s71, 15
    s_lshl_b32 s70, s71, 7
    s_mul_i32 s71, s71, 393216
    s_add_u32 m0, s72, 65536
    s_add_u32 s66, s71, 2048
    buffer_load_dwordx4 v5, s[12:15], s66 offen lds
    s_add_u32 m0, s72, 67584
    s_add_u32 s66, s71, 100352
    buffer_load_dwordx4 v5, s[12:15], s66 offen lds
    s_add_u32 m0, s72, 69632
    s_add_u32 s66, s71, 198656
    buffer_load_dwordx4 v5, s[12:15], s66 offen lds
    s_add_u32 m0, s72, 71680
    s_add_u32 s66, s71, 296960
    buffer_load_dwordx4 v5, s[12:15], s66 offen lds
    s_add_u32 m0, s72, 40960
    s_add_u32 s66, s70, 0
    buffer_load_dwordx4 v4, s[8:11], s66 offen lds
    s_add_u32 m0, s72, 43008
    s_add_u32 s66, s70, 32768
    buffer_load_dwordx4 v4, s[8:11], s66 offen lds
    s_add_u32 m0, s72, 45056
    s_add_u32 s66, s70, 65536
    buffer_load_dwordx4 v4, s[8:11], s66 offen lds
    s_add_u32 m0, s72, 47104
    s_add_u32 s66, s70, 98304
    buffer_load_dwordx4 v4, s[8:11], s66 offen lds
    s_add_u32 m0, s72, 49152
    s_add_u32 s66, s70, 131072
    buffer_load_dwordx4 v4, s[8:11], s66 offen lds
    s_add_u32 m0, s72, 51200
    s_add_u32 s66, s70, 163840
    buffer_load_dwordx4 v4, s[8:11], s66 offen lds
    s_add_u32 m0, s72, 53248
    s_add_u32 s66, s70, 196608
    buffer_load_dwordx4 v4, s[8:11], s66 offen lds
    s_add_u32 m0, s72, 55296
    s_add_u32 s66, s70, 229376
    buffer_load_dwordx4 v4, s[8:11], s66 offen lds
    s_add_u32 m0, s72, 73728
    s_add_u32 s66, s71, 4096
    buffer_load_dwordx4 v5, s[12:15], s66 offen lds
    s_add_u32 m0, s72, 75776
    s_add_u32 s66, s71, 102400
    buffer_load_dwordx4 v5, s[12:15], s66 offen lds
    s_add_u32 m0, s72, 77824
    s_add_u32 s66, s71, 200704
    buffer_load_dwordx4 v5, s[12:15], s66 offen lds
    s_add_u32 m0, s72, 79872
    s_add_u32 s66, s71, 299008
    buffer_load_dwordx4 v5, s[12:15], s66 offen lds
    s_add_u32 m0, s72, 57344
    s_add_u32 s66, s71, 0
    buffer_load_dwordx4 v5, s[12:15], s66 offen lds
    s_add_u32 m0, s72, 59392
    s_add_u32 s66, s71, 98304
    buffer_load_dwordx4 v5, s[12:15], s66 offen lds
    s_add_u32 m0, s72, 61440
    s_add_u32 s66, s71, 196608
    buffer_load_dwordx4 v5, s[12:15], s66 offen lds
    s_add_u32 m0, s72, 63488
    s_add_u32 s66, s71, 294912
    buffer_load_dwordx4 v5, s[12:15], s66 offen lds
    s_waitcnt vmcnt(20)
    s_barrier
    s_cmp_le_u32 s77, 11
    s_addc_u32 s71, s76, 11
    s_and_b32 s71, s71, 15
    s_lshl_b32 s70, s71, 7
    s_mul_i32 s71, s71, 393216
    s_add_u32 m0, s72, 106496
    s_add_u32 s66, s71, 2048
    buffer_load_dwordx4 v5, s[12:15], s66 offen lds
    s_add_u32 m0, s72, 108544
    s_add_u32 s66, s71, 100352
    buffer_load_dwordx4 v5, s[12:15], s66 offen lds
    s_add_u32 m0, s72, 110592
    s_add_u32 s66, s71, 198656
    buffer_load_dwordx4 v5, s[12:15], s66 offen lds
    s_add_u32 m0, s72, 112640
    s_add_u32 s66, s71, 296960
    buffer_load_dwordx4 v5, s[12:15], s66 offen lds
    s_add_u32 m0, s72, 81920
    s_add_u32 s66, s70, 0
    buffer_load_dwordx4 v4, s[8:11], s66 offen lds
    s_add_u32 m0, s72, 83968
    s_add_u32 s66, s70, 32768
    buffer_load_dwordx4 v4, s[8:11], s66 offen lds
    s_add_u32 m0, s72, 86016
    s_add_u32 s66, s70, 65536
    buffer_load_dwordx4 v4, s[8:11], s66 offen lds
    s_add_u32 m0, s72, 88064
    s_add_u32 s66, s70, 98304
    buffer_load_dwordx4 v4, s[8:11], s66 offen lds
    s_add_u32 m0, s72, 90112
    s_add_u32 s66, s70, 131072
    buffer_load_dwordx4 v4, s[8:11], s66 offen lds
    s_add_u32 m0, s72, 92160
    s_add_u32 s66, s70, 163840
    buffer_load_dwordx4 v4, s[8:11], s66 offen lds
    s_add_u32 m0, s72, 94208
    s_add_u32 s66, s70, 196608
    buffer_load_dwordx4 v4, s[8:11], s66 offen lds
    s_add_u32 m0, s72, 96256
    s_add_u32 s66, s70, 229376
    buffer_load_dwordx4 v4, s[8:11], s66 offen lds
    s_add_u32 m0, s72, 114688
    s_add_u32 s66, s71, 4096
    buffer_load_dwordx4 v5, s[12:15], s66 offen lds
    s_add_u32 m0, s72, 116736
    s_add_u32 s66, s71, 102400
    buffer_load_dwordx4 v5, s[12:15], s66 offen lds
    s_add_u32 m0, s72, 118784
    s_add_u32 s66, s71, 200704
    buffer_load_dwordx4 v5, s[12:15], s66 offen lds
    s_add_u32 m0, s72, 120832
    s_add_u32 s66, s71, 299008
    buffer_load_dwordx4 v5, s[12:15], s66 offen lds
    s_add_u32 m0, s72, 98304
    s_add_u32 s66, s71, 0
    buffer_load_dwordx4 v5, s[12:15], s66 offen lds
    s_add_u32 m0, s72, 100352
    s_add_u32 s66, s71, 98304
    buffer_load_dwordx4 v5, s[12:15], s66 offen lds
    s_add_u32 m0, s72, 102400
    s_add_u32 s66, s71, 196608
    buffer_load_dwordx4 v5, s[12:15], s66 offen lds
    s_add_u32 m0, s72, 104448
    s_add_u32 s66, s71, 294912
    buffer_load_dwordx4 v5, s[12:15], s66 offen lds
    s_waitcnt vmcnt(20)
    s_barrier
    s_cmp_le_u32 s77, 12
    s_addc_u32 s71, s76, 12
    s_and_b32 s71, s71, 15
    s_lshl_b32 s70, s71, 7
    s_mul_i32 s71, s71, 393216
    s_add_u32 m0, s72, 24576
    s_add_u32 s66, s71, 2048
    buffer_load_dwordx4 v5, s[12:15], s66 offen lds
    s_add_u32 m0, s72, 26624
    s_add_u32 s66, s71, 100352
    buffer_load_dwordx4 v5, s[12:15], s66 offen lds
    s_add_u32 m0, s72, 28672
    s_add_u32 s66, s71, 198656
    buffer_load_dwordx4 v5, s[12:15], s66 offen lds
    s_add_u32 m0, s72, 30720
    s_add_u32 s66, s71, 296960
    buffer_load_dwordx4 v5, s[12:15], s66 offen lds
    s_add_u32 m0, s72, 0
    s_add_u32 s66, s70, 0
    buffer_load_dwordx4 v4, s[8:11], s66 offen lds
    s_add_u32 m0, s72, 2048
    s_add_u32 s66, s70, 32768
    buffer_load_dwordx4 v4, s[8:11], s66 offen lds
    s_add_u32 m0, s72, 4096
    s_add_u32 s66, s70, 65536
    buffer_load_dwordx4 v4, s[8:11], s66 offen lds
    s_add_u32 m0, s72, 6144
    s_add_u32 s66, s70, 98304
    buffer_load_dwordx4 v4, s[8:11], s66 offen lds
    s_add_u32 m0, s72, 8192
    s_add_u32 s66, s70, 131072
    buffer_load_dwordx4 v4, s[8:11], s66 offen lds
    s_add_u32 m0, s72, 10240
    s_add_u32 s66, s70, 163840
    buffer_load_dwordx4 v4, s[8:11], s66 offen lds
    s_add_u32 m0, s72, 12288
    s_add_u32 s66, s70, 196608
    buffer_load_dwordx4 v4, s[8:11], s66 offen lds
    s_add_u32 m0, s72, 14336
    s_add_u32 s66, s70, 229376
    buffer_load_dwordx4 v4, s[8:11], s66 offen lds
    s_add_u32 m0, s72, 32768
    s_add_u32 s66, s71, 4096
    buffer_load_dwordx4 v5, s[12:15], s66 offen lds
    s_add_u32 m0, s72, 34816
    s_add_u32 s66, s71, 102400
    buffer_load_dwordx4 v5, s[12:15], s66 offen lds
    s_add_u32 m0, s72, 36864
    s_add_u32 s66, s71, 200704
    buffer_load_dwordx4 v5, s[12:15], s66 offen lds
    s_add_u32 m0, s72, 38912
    s_add_u32 s66, s71, 299008
    buffer_load_dwordx4 v5, s[12:15], s66 offen lds
    s_add_u32 m0, s72, 16384
    s_add_u32 s66, s71, 0
    buffer_load_dwordx4 v5, s[12:15], s66 offen lds
    s_add_u32 m0, s72, 18432
    s_add_u32 s66, s71, 98304
    buffer_load_dwordx4 v5, s[12:15], s66 offen lds
    s_add_u32 m0, s72, 20480
    s_add_u32 s66, s71, 196608
    buffer_load_dwordx4 v5, s[12:15], s66 offen lds
    s_add_u32 m0, s72, 22528
    s_add_u32 s66, s71, 294912
    buffer_load_dwordx4 v5, s[12:15], s66 offen lds
    s_waitcnt vmcnt(20)
    s_barrier
    s_cmp_le_u32 s77, 13
    s_addc_u32 s71, s76, 13
    s_and_b32 s71, s71, 15
    s_lshl_b32 s70, s71, 7
    s_mul_i32 s71, s71, 393216
    s_add_u32 m0, s72, 65536
    s_add_u32 s66, s71, 2048
    buffer_load_dwordx4 v5, s[12:15], s66 offen lds
    s_add_u32 m0, s72, 67584
    s_add_u32 s66, s71, 100352
    buffer_load_dwordx4 v5, s[12:15], s66 offen lds
    s_add_u32 m0, s72, 69632
    s_add_u32 s66, s71, 198656
    buffer_load_dwordx4 v5, s[12:15], s66 offen lds
    s_add_u32 m0, s72, 71680
    s_add_u32 s66, s71, 296960
    buffer_load_dwordx4 v5, s[12:15], s66 offen lds
    s_add_u32 m0, s72, 40960
    s_add_u32 s66, s70, 0
    buffer_load_dwordx4 v4, s[8:11], s66 offen lds
    s_add_u32 m0, s72, 43008
    s_add_u32 s66, s70, 32768
    buffer_load_dwordx4 v4, s[8:11], s66 offen lds
    s_add_u32 m0, s72, 45056
    s_add_u32 s66, s70, 65536
    buffer_load_dwordx4 v4, s[8:11], s66 offen lds
    s_add_u32 m0, s72, 47104
    s_add_u32 s66, s70, 98304
    buffer_load_dwordx4 v4, s[8:11], s66 offen lds
    s_add_u32 m0, s72, 49152
    s_add_u32 s66, s70, 131072
    buffer_load_dwordx4 v4, s[8:11], s66 offen lds
    s_add_u32 m0, s72, 51200
    s_add_u32 s66, s70, 163840
    buffer_load_dwordx4 v4, s[8:11], s66 offen lds
    s_add_u32 m0, s72, 53248
    s_add_u32 s66, s70, 196608
    buffer_load_dwordx4 v4, s[8:11], s66 offen lds
    s_add_u32 m0, s72, 55296
    s_add_u32 s66, s70, 229376
    buffer_load_dwordx4 v4, s[8:11], s66 offen lds
    s_add_u32 m0, s72, 73728
    s_add_u32 s66, s71, 4096
    buffer_load_dwordx4 v5, s[12:15], s66 offen lds
    s_add_u32 m0, s72, 75776
    s_add_u32 s66, s71, 102400
    buffer_load_dwordx4 v5, s[12:15], s66 offen lds
    s_add_u32 m0, s72, 77824
    s_add_u32 s66, s71, 200704
    buffer_load_dwordx4 v5, s[12:15], s66 offen lds
    s_add_u32 m0, s72, 79872
    s_add_u32 s66, s71, 299008
    buffer_load_dwordx4 v5, s[12:15], s66 offen lds
    s_add_u32 m0, s72, 57344
    s_add_u32 s66, s71, 0
    buffer_load_dwordx4 v5, s[12:15], s66 offen lds
    s_add_u32 m0, s72, 59392
    s_add_u32 s66, s71, 98304
    buffer_load_dwordx4 v5, s[12:15], s66 offen lds
    s_add_u32 m0, s72, 61440
    s_add_u32 s66, s71, 196608
    buffer_load_dwordx4 v5, s[12:15], s66 offen lds
    s_add_u32 m0, s72, 63488
    s_add_u32 s66, s71, 294912
    buffer_load_dwordx4 v5, s[12:15], s66 offen lds
    s_waitcnt vmcnt(20)
    s_barrier
    s_cmp_le_u32 s77, 14
    s_addc_u32 s71, s76, 14
    s_and_b32 s71, s71, 15
    s_lshl_b32 s70, s71, 7
    s_mul_i32 s71, s71, 393216
    s_add_u32 m0, s72, 106496
    s_add_u32 s66, s71, 2048
    buffer_load_dwordx4 v5, s[12:15], s66 offen lds
    s_add_u32 m0, s72, 108544
    s_add_u32 s66, s71, 100352
    buffer_load_dwordx4 v5, s[12:15], s66 offen lds
    s_add_u32 m0, s72, 110592
    s_add_u32 s66, s71, 198656
    buffer_load_dwordx4 v5, s[12:15], s66 offen lds
    s_add_u32 m0, s72, 112640
    s_add_u32 s66, s71, 296960
    buffer_load_dwordx4 v5, s[12:15], s66 offen lds
    s_add_u32 m0, s72, 81920
    s_add_u32 s66, s70, 0
    buffer_load_dwordx4 v4, s[8:11], s66 offen lds
    s_add_u32 m0, s72, 83968
    s_add_u32 s66, s70, 32768
    buffer_load_dwordx4 v4, s[8:11], s66 offen lds
    s_add_u32 m0, s72, 86016
    s_add_u32 s66, s70, 65536
    buffer_load_dwordx4 v4, s[8:11], s66 offen lds
    s_add_u32 m0, s72, 88064
    s_add_u32 s66, s70, 98304
    buffer_load_dwordx4 v4, s[8:11], s66 offen lds
    s_add_u32 m0, s72, 90112
    s_add_u32 s66, s70, 131072
    buffer_load_dwordx4 v4, s[8:11], s66 offen lds
    s_add_u32 m0, s72, 92160
    s_add_u32 s66, s70, 163840
    buffer_load_dwordx4 v4, s[8:11], s66 offen lds
    s_add_u32 m0, s72, 94208
    s_add_u32 s66, s70, 196608
    buffer_load_dwordx4 v4, s[8:11], s66 offen lds
    s_add_u32 m0, s72, 96256
    s_add_u32 s66, s70, 229376
    buffer_load_dwordx4 v4, s[8:11], s66 offen lds
    s_add_u32 m0, s72, 114688
    s_add_u32 s66, s71, 4096
    buffer_load_dwordx4 v5, s[12:15], s66 offen lds
    s_add_u32 m0, s72, 116736
    s_add_u32 s66, s71, 102400
    buffer_load_dwordx4 v5, s[12:15], s66 offen lds
    s_add_u32 m0, s72, 118784
    s_add_u32 s66, s71, 200704
    buffer_load_dwordx4 v5, s[12:15], s66 offen lds
    s_add_u32 m0, s72, 120832
    s_add_u32 s66, s71, 299008
    buffer_load_dwordx4 v5, s[12:15], s66 offen lds
    s_add_u32 m0, s72, 98304
    s_add_u32 s66, s71, 0
    buffer_load_dwordx4 v5, s[12:15], s66 offen lds
    s_add_u32 m0, s72, 100352
    s_add_u32 s66, s71, 98304
    buffer_load_dwordx4 v5, s[12:15], s66 offen lds
    s_add_u32 m0, s72, 102400
    s_add_u32 s66, s71, 196608
    buffer_load_dwordx4 v5, s[12:15], s66 offen lds
    s_add_u32 m0, s72, 104448
    s_add_u32 s66, s71, 294912
    buffer_load_dwordx4 v5, s[12:15], s66 offen lds
    s_mov_b32 s71, s5
    s_lshl_b32 s70, s71, 7
    s_mul_i32 s71, s71, 393216
    s_add_u32 m0, s72, 139264
    s_add_u32 s66, s71, 2048
    buffer_load_dwordx4 v5, s[12:15], s66 offen lds
    s_add_u32 m0, s72, 141312
    s_add_u32 s66, s71, 100352
    buffer_load_dwordx4 v5, s[12:15], s66 offen lds
    s_add_u32 m0, s72, 143360
    s_add_u32 s66, s71, 198656
    buffer_load_dwordx4 v5, s[12:15], s66 offen lds
    s_add_u32 m0, s72, 145408
    s_add_u32 s66, s71, 296960
    buffer_load_dwordx4 v5, s[12:15], s66 offen lds
    s_waitcnt vmcnt(24)
    s_barrier
    s_mov_b32 s71, s5
    s_lshl_b32 s70, s71, 7
    s_mul_i32 s71, s71, 393216
    s_add_u32 m0, s72, 122880
    s_add_u32 s66, s70, 0
    buffer_load_dwordx4 v4, s[8:11], s66 offen lds
    s_add_u32 m0, s72, 124928
    s_add_u32 s66, s70, 32768
    buffer_load_dwordx4 v4, s[8:11], s66 offen lds
    s_add_u32 m0, s72, 126976
    s_add_u32 s66, s70, 65536
    buffer_load_dwordx4 v4, s[8:11], s66 offen lds
    s_add_u32 m0, s72, 129024
    s_add_u32 s66, s70, 98304
    buffer_load_dwordx4 v4, s[8:11], s66 offen lds
    s_add_u32 m0, s72, 131072
    s_add_u32 s66, s70, 131072
    buffer_load_dwordx4 v4, s[8:11], s66 offen lds
    s_add_u32 m0, s72, 133120
    s_add_u32 s66, s70, 163840
    buffer_load_dwordx4 v4, s[8:11], s66 offen lds
    s_add_u32 m0, s72, 135168
    s_add_u32 s66, s70, 196608
    buffer_load_dwordx4 v4, s[8:11], s66 offen lds
    s_add_u32 m0, s72, 137216
    s_add_u32 s66, s70, 229376
    buffer_load_dwordx4 v4, s[8:11], s66 offen lds
    s_mov_b32 s71, s5
    s_lshl_b32 s70, s71, 7
    s_mul_i32 s71, s71, 393216
    s_add_u32 m0, s72, 147456
    s_add_u32 s66, s71, 4096
    buffer_load_dwordx4 v5, s[12:15], s66 offen lds
    s_add_u32 m0, s72, 149504
    s_add_u32 s66, s71, 102400
    buffer_load_dwordx4 v5, s[12:15], s66 offen lds
    s_add_u32 m0, s72, 151552
    s_add_u32 s66, s71, 200704
    buffer_load_dwordx4 v5, s[12:15], s66 offen lds
    s_add_u32 m0, s72, 153600
    s_add_u32 s66, s71, 299008
    buffer_load_dwordx4 v5, s[12:15], s66 offen lds
    s_add_u32 m0, s72, 16384
    s_add_u32 s66, s71, 0
    buffer_load_dwordx4 v5, s[12:15], s66 offen lds
    s_add_u32 m0, s72, 18432
    s_add_u32 s66, s71, 98304
    buffer_load_dwordx4 v5, s[12:15], s66 offen lds
    s_add_u32 m0, s72, 20480
    s_add_u32 s66, s71, 196608
    buffer_load_dwordx4 v5, s[12:15], s66 offen lds
    s_add_u32 m0, s72, 22528
    s_add_u32 s66, s71, 294912
    buffer_load_dwordx4 v5, s[12:15], s66 offen lds
    s_waitcnt vmcnt(20)
    s_barrier
    s_mov_b32 s66, 0
    buffer_load_dwordx4 v[96:99], v7, s[32:35], s66 offen
    s_mov_b32 s66, 2048
    buffer_load_dwordx4 v[100:103], v7, s[32:35], s66 offen
    s_mov_b32 s66, 4096
    buffer_load_dwordx4 v[104:107], v7, s[32:35], s66 offen
    s_mov_b32 s66, 6144
    buffer_load_dwordx4 v[108:111], v7, s[32:35], s66 offen
    s_mov_b32 s66, 8192
    buffer_load_dwordx4 v[112:115], v7, s[32:35], s66 offen
    s_mov_b32 s66, 10240
    buffer_load_dwordx4 v[116:119], v7, s[32:35], s66 offen
    s_mov_b32 s66, 12288
    buffer_load_dwordx4 v[120:123], v7, s[32:35], s66 offen
    s_mov_b32 s66, 14336
    buffer_load_dwordx4 v[124:127], v7, s[32:35], s66 offen
    s_waitcnt vmcnt(8)
    s_branch H_b14
WORK:
    v_mov_b32 v14, 0
    v_lshlrev_b32 v8, 5, v2
    v_add_u32 v8, 6127616, v8
    s_lshl_b32 s66, s2, 2
    s_add_u32 s66, s66, s44
    s_cmp_lg_u32 s66, 2
    s_cbranch_scc1 W_nn
    s_movk_i32 s66, 0
    buffer_load_dword v72, v8, s[16:19], s66 offen offset:4 sc1
    s_movk_i32 s66, 2048
    buffer_load_dword v73, v8, s[16:19], s66 offen offset:4 sc1
    s_movk_i32 s66, 4096
    buffer_load_dword v74, v8, s[16:19], s66 offen offset:4 sc1
    s_movk_i32 s66, 6144
    buffer_load_dword v75, v8, s[16:19], s66 offen offset:4 sc1
    s_waitcnt vmcnt(0)
    v_readfirstlane_b32 s66, v72
    s_or_b32 s66, s66, 1
W_nl:
    s_add_u32 s66, s66, 2
    v_cmp_eq_u32 vcc, s66, v72
    v_cmp_eq_u32 s[68:69], s66, v73
    s_or_b64 vcc, vcc, s[68:69]
    v_cmp_eq_u32 s[68:69], s66, v74
    s_or_b64 vcc, vcc, s[68:69]
    v_cmp_eq_u32 s[68:69], s66, v75
    s_or_b64 vcc, vcc, s[68:69]
    s_cmp_lg_u64 vcc, 0
    s_cbranch_scc1 W_nl
    v_mov_b32 v10, 0
    v_mov_b32 v11, s66
    s_mov_b64 exec, 1
    buffer_store_dword v11, v10, s[40:43], 0 offen sc0 sc1
    s_mov_b64 exec, -1
W_nn:
    s_and_b32 s48, s44, 1
    s_waitcnt vmcnt(5)
    s_barrier
    s_waitcnt vmcnt(0)
    s_barrier
    s_lshl_b32 s50, s4, 7
    s_lshl_b32 s66, s5, 3
    s_add_u32 s50, s50, s66
    s_lshl_b32 s66, s48, 2
    s_add_u32 s50, s50, s66
    s_lshl_b32 s66, s50, 11
    s_add_u32 s67, s66, 4096
    buffer_load_dwordx4 v[16:19], v9, s[8:11], s66 offen offset:0
    buffer_load_dwordx4 v[20:23], v9, s[8:11], s66 offen offset:1024
    buffer_load_dwordx4 v[24:27], v9, s[8:11], s66 offen offset:2048
    buffer_load_dwordx4 v[28:31], v9, s[8:11], s66 offen offset:3072
    buffer_load_dwordx4 v[32:35], v9, s[8:11], s67 offen offset:0
    buffer_load_dwordx4 v[36:39], v9, s[8:11], s67 offen offset:1024
    buffer_load_dwordx4 v[40:43], v9, s[8:11], s67 offen offset:2048
    buffer_load_dwordx4 v[44:47], v9, s[8:11], s67 offen offset:3072
    s_lshl_b32 s66, s48, 11
    s_add_u32 m0, s66, 159744
    s_nop 0
    buffer_load_dwordx4 v9, s[24:27], 0 offen offset:0 lds
    buffer_load_dwordx4 v9, s[24:27], 0 offen offset:1024 lds
    s_lshl_b32 s66, s79, 2
    s_add_u32 s66, s66, s73
    s_and_b32 s51, s66, 15
    s_lshr_b32 s67, s66, 4
    s_lshl_b32 s54, s67, 5
    s_lshl_b32 s66, s48, 4
    s_add_u32 s54, s54, s66
    s_add_u32 s54, s54, s51
    s_lshl_b32 s54, s54, 10
    s_add_u32 s54, s54, 5308416
    s_lshl_b32 s51, s51, 6
    v_lshrrev_b32 v10, 5, v2
    v_and_b32 v11, 31, v2
    v_lshlrev_b32 v12, 5, v10
    v_add_u32 v12, s51, v12
    v_mul_u32_u24 v12, 7168, v12
    v_lshl_add_u32 v12, v11, 4, v12
    s_lshl_b32 s67, s67, 9
    v_add_u32 v6, s67, v12
    v_mov_b32 v72, -1
    v_mov_b32 v73, -1
    v_mov_b32 v74, -1
    v_mov_b32 v75, -1
    v_and_b32 v12, 3, v2
    v_lshlrev_b32 v12, 4, v12
    v_add_u32 v12, s53, v12
    s_add_u32 s66, s53, 4294965248
    v_subrev_u32 v13, 4, v2
    v_cmp_gt_u32 vcc, 4, v13
    v_lshlrev_b32 v13, 4, v13
    v_add_u32 v13, s66, v13
    v_cndmask_b32 v12, v12, v13, vcc
    s_add_u32 s66, s55, 0
    v_subrev_u32 v13, 24, v2
    v_cmp_gt_u32 vcc, 16, v13
    v_lshlrev_b32 v13, 4, v13
    v_add_u32 v13, s66, v13
    v_cndmask_b32 v12, v12, v13, vcc
    s_add_u32 s66, s55, 4294934528
    v_subrev_u32 v13, 40, v2
    v_cmp_gt_u32 vcc, 16, v13
    v_lshlrev_b32 v13, 4, v13
    v_add_u32 v13, s66, v13
    v_cndmask_b32 v12, v12, v13, vcc
    s_sub_u32 s66, s56, 32768
    buffer_store_dwordx4 v[72:75], v9, s[16:19], s56 offen sc0 sc1
    buffer_store_dwordx4 v[72:75], v9, s[16:19], s66 offen sc0 sc1
    buffer_store_dwordx4 v[72:75], v9, s[16:19], s54 offen sc0 sc1
    buffer_store_dwordx4 v[72:75], v12, s[16:19], 0 offen sc0 sc1
    s_waitcnt vmcnt(4)
    s_barrier
    s_cmp_lg_u32 s48, 0
    s_cbranch_scc1 W_k1
    buffer_load_dword v15, v14, s[40:43], 0 offen sc1
W_k1:
    v_add_u32 v10, 159744, v9
    v_bfe_u32 v3, v2, 4, 1
    v_lshrrev_b32 v11, 5, v2
    v_lshl_add_u32 v3, v3, 1, v11
    s_mov_b32 s67, 0xffff0000
    s_mov_b32 s68, 0x00010001
    s_mov_b32 s69, 0x00010001
    ds_read_b128 v[48:51], v10 offset:0
    ds_read_b128 v[52:55], v10 offset:1024
    v_mov_b32 v72, 0
    v_mov_b32 v73, 0
    v_mov_b32 v74, 0
    v_mov_b32 v75, 0
    s_waitcnt lgkmcnt(0)
    v_dot2_f32_bf16 v72, v16, v48, v72
    v_dot2_f32_bf16 v73, v24, v48, v73
    v_dot2_f32_bf16 v74, v32, v48, v74
    v_dot2_f32_bf16 v75, v40, v48, v75
    v_dot2_f32_bf16 v72, v17, v49, v72
    v_dot2_f32_bf16 v73, v25, v49, v73
    v_dot2_f32_bf16 v74, v33, v49, v74
    v_dot2_f32_bf16 v75, v41, v49, v75
    v_dot2_f32_bf16 v72, v18, v50, v72
    v_dot2_f32_bf16 v73, v26, v50, v73
    v_dot2_f32_bf16 v74, v34, v50, v74
    v_dot2_f32_bf16 v75, v42, v50, v75
    v_dot2_f32_bf16 v72, v19, v51, v72
    v_dot2_f32_bf16 v73, v27, v51, v73
    v_dot2_f32_bf16 v74, v35, v51, v74
    v_dot2_f32_bf16 v75, v43, v51, v75
    v_dot2_f32_bf16 v72, v20, v52, v72
    v_dot2_f32_bf16 v73, v28, v52, v73
    v_dot2_f32_bf16 v74, v36, v52, v74
    v_dot2_f32_bf16 v75, v44, v52, v75
    v_dot2_f32_bf16 v72, v21, v53, v72
    v_dot2_f32_bf16 v73, v29, v53, v73
    v_dot2_f32_bf16 v74, v37, v53, v74
    v_dot2_f32_bf16 v75, v45, v53, v75
    v_dot2_f32_bf16 v72, v22, v54, v72
    v_dot2_f32_bf16 v73, v30, v54, v73
    v_dot2_f32_bf16 v74, v38, v54, v74
    v_dot2_f32_bf16 v75, v46, v54, v75
    v_dot2_f32_bf16 v72, v23, v55, v72
    v_dot2_f32_bf16 v73, v31, v55, v73
    v_dot2_f32_bf16 v74, v39, v55, v74
    v_dot2_f32_bf16 v75, v47, v55, v75
    s_nop 2
    ds_read_b128 v[48:51], v10 offset:2048
    ds_read_b128 v[52:55], v10 offset:3072
    s_nop 1
    v_permlane32_swap_b32 v72, v73
    v_permlane32_swap_b32 v74, v75
    v_add_f32 v72, v72, v73
    v_add_f32 v74, v74, v75
    s_nop 1
    v_permlane16_swap_b32 v72, v74
    v_add_f32 v72, v72, v74
    s_nop 1
    v_add_f32_dpp v72, v72, v72 quad_perm:[1,0,3,2] row_mask:0xf bank_mask:0xf
    s_nop 1
    v_add_f32_dpp v72, v72, v72 quad_perm:[2,3,0,1] row_mask:0xf bank_mask:0xf
    s_nop 1
    v_add_f32_dpp v72, v72, v72 row_half_mirror row_mask:0xf bank_mask:0xf
    s_nop 1
    v_add_f32_dpp v72, v72, v72 row_mirror row_mask:0xf bank_mask:0xf
    s_sub_u32 s66, 34815, s50
    v_cvt_pk_bf16_f32 v72, 0, v72
    v_sub_u32 v73, s66, v3
    v_ashrrev_i32 v76, 31, v72
    v_or_b32 v76, 0x80000000, v76
    v_xor_b32 v72, v72, v76
    v_and_or_b32 v72, v72, s67, v73
    v_mov_b32 v10, 155680
    s_mov_b64 exec, s[68:69]
    ds_max_u32 v10, v72
    s_mov_b64 exec, -1
    s_waitcnt vmcnt(0)
    s_waitcnt lgkmcnt(0)
    s_barrier
    s_cmp_lg_u32 s48, 0
    s_cbranch_scc1 W_k2
    v_mov_b32 v10, 155680
    ds_read_b32 v12, v10
    s_waitcnt vmcnt(0)
    s_mov_b32 s67, 0
W_ts:
    v_cmp_eq_u32 vcc, 0, v15
    s_cbranch_vccz W_tok
    s_add_u32 s67, s67, 1
    s_cmp_ge_u32 s67, 200000
    s_cbranch_scc1 W_tok
    s_sleep 4
    buffer_load_dword v15, v14, s[40:43], 0 offen sc1
    s_waitcnt vmcnt(0)
    s_branch W_ts
W_tok:
    s_lshl_b32 s66, s2, 5
    s_add_u32 s66, s66, 6127616
    v_mov_b32 v10, s66
    v_mov_b32 v13, v15
    s_waitcnt lgkmcnt(0)
    s_mov_b64 exec, 1
    buffer_store_dwordx2 v[12:13], v10, s[16:19], 0 offen sc0 sc1
    s_mov_b64 exec, -1
W_k2:
    v_mov_b32 v248, -1
    v_mov_b32 v249, -1
    v_mov_b32 v250, -1
    v_mov_b32 v251, -1
    s_lshl_b32 s67, s4, 3
    s_lshl_b32 s66, s48, 2
    s_add_u32 s67, s67, s66
    s_lshl_b32 s67, s67, 15
    s_lshl_b32 s66, s5, 11
    s_add_u32 s67, s67, s66
    s_add_u32 s66, s67, 0
    buffer_store_dwordx4 v[248:251], v9, s[16:19], s66 offen offset:0 sc0 sc1
    s_add_u32 s66, s67, 0
    buffer_store_dwordx4 v[248:251], v9, s[16:19], s66 offen offset:1024 sc0 sc1
    s_add_u32 s66, s67, 32768
    buffer_store_dwordx4 v[248:251], v9, s[16:19], s66 offen offset:0 sc0 sc1
    s_add_u32 s66, s67, 32768
    buffer_store_dwordx4 v[248:251], v9, s[16:19], s66 offen offset:1024 sc0 sc1
    s_add_u32 s66, s67, 65536
    buffer_store_dwordx4 v[248:251], v9, s[16:19], s66 offen offset:0 sc0 sc1
    s_add_u32 s66, s67, 65536
    buffer_store_dwordx4 v[248:251], v9, s[16:19], s66 offen offset:1024 sc0 sc1
    s_add_u32 s66, s67, 98304
    buffer_store_dwordx4 v[248:251], v9, s[16:19], s66 offen offset:0 sc0 sc1
    s_add_u32 s66, s67, 98304
    buffer_store_dwordx4 v[248:251], v9, s[16:19], s66 offen offset:1024 sc0 sc1
    v_lshlrev_b32 v56, 16, v48
    v_and_b32 v57, 0xffff0000, v48
    v_lshlrev_b32 v58, 16, v49
    v_and_b32 v59, 0xffff0000, v49
    v_lshlrev_b32 v60, 16, v50
    v_and_b32 v61, 0xffff0000, v50
    v_lshlrev_b32 v62, 16, v51
    v_and_b32 v63, 0xffff0000, v51
    v_lshlrev_b32 v64, 16, v52
    v_and_b32 v65, 0xffff0000, v52
    v_lshlrev_b32 v66, 16, v53
    v_and_b32 v67, 0xffff0000, v53
    v_lshlrev_b32 v68, 16, v54
    v_and_b32 v69, 0xffff0000, v54
    v_lshlrev_b32 v70, 16, v55
    v_and_b32 v71, 0xffff0000, v55
    v_mov_b32 v76, 0
    v_lshlrev_b32 v72, 16, v16
    v_and_b32 v73, 0xffff0000, v16
    v_mul_f32 v72, v72, v56
    v_mul_f32 v73, v73, v57
    v_cvt_pk_bf16_f32 v72, 0, v72
    v_cvt_pk_bf16_f32 v73, 0, v73
    v_add_f32 v76, v76, v72
    v_add_f32 v76, v76, v73
    v_lshlrev_b32 v72, 16, v17
    v_and_b32 v73, 0xffff0000, v17
    v_mul_f32 v72, v72, v58
    v_mul_f32 v73, v73, v59
    v_cvt_pk_bf16_f32 v72, 0, v72
    v_cvt_pk_bf16_f32 v73, 0, v73
    v_add_f32 v76, v76, v72
    v_add_f32 v76, v76, v73
    v_lshlrev_b32 v72, 16, v18
    v_and_b32 v73, 0xffff0000, v18
    v_mul_f32 v72, v72, v60
    v_mul_f32 v73, v73, v61
    v_cvt_pk_bf16_f32 v72, 0, v72
    v_cvt_pk_bf16_f32 v73, 0, v73
    v_add_f32 v76, v76, v72
    v_add_f32 v76, v76, v73
    v_lshlrev_b32 v72, 16, v19
    v_and_b32 v73, 0xffff0000, v19
    v_mul_f32 v72, v72, v62
    v_mul_f32 v73, v73, v63
    v_cvt_pk_bf16_f32 v72, 0, v72
    v_cvt_pk_bf16_f32 v73, 0, v73
    v_add_f32 v76, v76, v72
    v_add_f32 v76, v76, v73
    v_lshlrev_b32 v72, 16, v20
    v_and_b32 v73, 0xffff0000, v20
    v_mul_f32 v72, v72, v64
    v_mul_f32 v73, v73, v65
    v_cvt_pk_bf16_f32 v72, 0, v72
    v_cvt_pk_bf16_f32 v73, 0, v73
    v_add_f32 v76, v76, v72
    v_add_f32 v76, v76, v73
    v_lshlrev_b32 v72, 16, v21
    v_and_b32 v73, 0xffff0000, v21
    v_mul_f32 v72, v72, v66
    v_mul_f32 v73, v73, v67
    v_cvt_pk_bf16_f32 v72, 0, v72
    v_cvt_pk_bf16_f32 v73, 0, v73
    v_add_f32 v76, v76, v72
    v_add_f32 v76, v76, v73
    v_lshlrev_b32 v72, 16, v22
    v_and_b32 v73, 0xffff0000, v22
    v_mul_f32 v72, v72, v68
    v_mul_f32 v73, v73, v69
    v_cvt_pk_bf16_f32 v72, 0, v72
    v_cvt_pk_bf16_f32 v73, 0, v73
    v_add_f32 v76, v76, v72
    v_add_f32 v76, v76, v73
    v_lshlrev_b32 v72, 16, v23
    v_and_b32 v73, 0xffff0000, v23
    v_mul_f32 v72, v72, v70
    v_mul_f32 v73, v73, v71
    v_cvt_pk_bf16_f32 v72, 0, v72
    v_cvt_pk_bf16_f32 v73, 0, v73
    v_add_f32 v76, v76, v72
    v_add_f32 v76, v76, v73
    s_barrier
    s_mov_b32 s66, 0
    buffer_load_dwordx4 v[96:99], v6, s[28:31], s66 offen nt
    s_mov_b32 s66, 7168
    buffer_load_dwordx4 v[100:103], v6, s[28:31], s66 offen nt
    s_mov_b32 s66, 14336
    buffer_load_dwordx4 v[104:107], v6, s[28:31], s66 offen nt
    s_mov_b32 s66, 21504
    buffer_load_dwordx4 v[108:111], v6, s[28:31], s66 offen nt
    s_mov_b32 s66, 28672
    buffer_load_dwordx4 v[112:115], v6, s[28:31], s66 offen nt
    s_mov_b32 s66, 35840
    buffer_load_dwordx4 v[116:119], v6, s[28:31], s66 offen nt
    s_mov_b32 s66, 43008
    buffer_load_dwordx4 v[120:123], v6, s[28:31], s66 offen nt
    s_mov_b32 s66, 50176
    buffer_load_dwordx4 v[124:127], v6, s[28:31], s66 offen nt
    v_mov_b32 v77, 0
    v_lshlrev_b32 v72, 16, v24
    v_and_b32 v73, 0xffff0000, v24
    v_mul_f32 v72, v72, v56
    v_mul_f32 v73, v73, v57
    v_cvt_pk_bf16_f32 v72, 0, v72
    v_cvt_pk_bf16_f32 v73, 0, v73
    v_add_f32 v77, v77, v72
    v_add_f32 v77, v77, v73
    v_lshlrev_b32 v72, 16, v25
    v_and_b32 v73, 0xffff0000, v25
    v_mul_f32 v72, v72, v58
    v_mul_f32 v73, v73, v59
    v_cvt_pk_bf16_f32 v72, 0, v72
    v_cvt_pk_bf16_f32 v73, 0, v73
    v_add_f32 v77, v77, v72
    v_add_f32 v77, v77, v73
    v_lshlrev_b32 v72, 16, v26
    v_and_b32 v73, 0xffff0000, v26
    v_mul_f32 v72, v72, v60
    v_mul_f32 v73, v73, v61
    v_cvt_pk_bf16_f32 v72, 0, v72
    v_cvt_pk_bf16_f32 v73, 0, v73
    v_add_f32 v77, v77, v72
    v_add_f32 v77, v77, v73
    v_lshlrev_b32 v72, 16, v27
    v_and_b32 v73, 0xffff0000, v27
    v_mul_f32 v72, v72, v62
    v_mul_f32 v73, v73, v63
    v_cvt_pk_bf16_f32 v72, 0, v72
    v_cvt_pk_bf16_f32 v73, 0, v73
    v_add_f32 v77, v77, v72
    v_add_f32 v77, v77, v73
    v_lshlrev_b32 v72, 16, v28
    v_and_b32 v73, 0xffff0000, v28
    v_mul_f32 v72, v72, v64
    v_mul_f32 v73, v73, v65
    v_cvt_pk_bf16_f32 v72, 0, v72
    v_cvt_pk_bf16_f32 v73, 0, v73
    v_add_f32 v77, v77, v72
    v_add_f32 v77, v77, v73
    v_lshlrev_b32 v72, 16, v29
    v_and_b32 v73, 0xffff0000, v29
    v_mul_f32 v72, v72, v66
    v_mul_f32 v73, v73, v67
    v_cvt_pk_bf16_f32 v72, 0, v72
    v_cvt_pk_bf16_f32 v73, 0, v73
    v_add_f32 v77, v77, v72
    v_add_f32 v77, v77, v73
    v_lshlrev_b32 v72, 16, v30
    v_and_b32 v73, 0xffff0000, v30
    v_mul_f32 v72, v72, v68
    v_mul_f32 v73, v73, v69
    v_cvt_pk_bf16_f32 v72, 0, v72
    v_cvt_pk_bf16_f32 v73, 0, v73
    v_add_f32 v77, v77, v72
    v_add_f32 v77, v77, v73
    v_lshlrev_b32 v72, 16, v31
    v_and_b32 v73, 0xffff0000, v31
    v_mul_f32 v72, v72, v70
    v_mul_f32 v73, v73, v71
    v_cvt_pk_bf16_f32 v72, 0, v72
    v_cvt_pk_bf16_f32 v73, 0, v73
    v_add_f32 v77, v77, v72
    v_add_f32 v77, v77, v73
    v_mov_b32 v78, 0
    v_lshlrev_b32 v72, 16, v32
    v_and_b32 v73, 0xffff0000, v32
    v_mul_f32 v72, v72, v56
    v_mul_f32 v73, v73, v57
    v_cvt_pk_bf16_f32 v72, 0, v72
    v_cvt_pk_bf16_f32 v73, 0, v73
    v_add_f32 v78, v78, v72
    v_add_f32 v78, v78, v73
    v_lshlrev_b32 v72, 16, v33
    v_and_b32 v73, 0xffff0000, v33
    v_mul_f32 v72, v72, v58
    v_mul_f32 v73, v73, v59
    v_cvt_pk_bf16_f32 v72, 0, v72
    v_cvt_pk_bf16_f32 v73, 0, v73
    v_add_f32 v78, v78, v72
    v_add_f32 v78, v78, v73
    v_lshlrev_b32 v72, 16, v34
    v_and_b32 v73, 0xffff0000, v34
    v_mul_f32 v72, v72, v60
    v_mul_f32 v73, v73, v61
    v_cvt_pk_bf16_f32 v72, 0, v72
    v_cvt_pk_bf16_f32 v73, 0, v73
    v_add_f32 v78, v78, v72
    v_add_f32 v78, v78, v73
    v_lshlrev_b32 v72, 16, v35
    v_and_b32 v73, 0xffff0000, v35
    v_mul_f32 v72, v72, v62
    v_mul_f32 v73, v73, v63
    v_cvt_pk_bf16_f32 v72, 0, v72
    v_cvt_pk_bf16_f32 v73, 0, v73
    v_add_f32 v78, v78, v72
    v_add_f32 v78, v78, v73
    v_lshlrev_b32 v72, 16, v36
    v_and_b32 v73, 0xffff0000, v36
    v_mul_f32 v72, v72, v64
    v_mul_f32 v73, v73, v65
    v_cvt_pk_bf16_f32 v72, 0, v72
    v_cvt_pk_bf16_f32 v73, 0, v73
    v_add_f32 v78, v78, v72
    v_add_f32 v78, v78, v73
    v_lshlrev_b32 v72, 16, v37
    v_and_b32 v73, 0xffff0000, v37
    v_mul_f32 v72, v72, v66
    v_mul_f32 v73, v73, v67
    v_cvt_pk_bf16_f32 v72, 0, v72
    v_cvt_pk_bf16_f32 v73, 0, v73
    v_add_f32 v78, v78, v72
    v_add_f32 v78, v78, v73
    v_lshlrev_b32 v72, 16, v38
    v_and_b32 v73, 0xffff0000, v38
    v_mul_f32 v72, v72, v68
    v_mul_f32 v73, v73, v69
    v_cvt_pk_bf16_f32 v72, 0, v72
    v_cvt_pk_bf16_f32 v73, 0, v73
    v_add_f32 v78, v78, v72
    v_add_f32 v78, v78, v73
    v_lshlrev_b32 v72, 16, v39
    v_and_b32 v73, 0xffff0000, v39
    v_mul_f32 v72, v72, v70
    v_mul_f32 v73, v73, v71
    v_cvt_pk_bf16_f32 v72, 0, v72
    v_cvt_pk_bf16_f32 v73, 0, v73
    v_add_f32 v78, v78, v72
    v_add_f32 v78, v78, v73
    s_barrier
    s_cmp_lg_u32 s48, 0
    s_cbranch_scc1 W_k4
    s_movk_i32 s66, 0
    buffer_load_dwordx2 v[224:225], v8, s[16:19], s66 offen sc1
    s_movk_i32 s66, 2048
    buffer_load_dwordx2 v[226:227], v8, s[16:19], s66 offen sc1
    s_movk_i32 s66, 4096
    buffer_load_dwordx2 v[228:229], v8, s[16:19], s66 offen sc1
    s_movk_i32 s66, 6144
    buffer_load_dwordx2 v[230:231], v8, s[16:19], s66 offen sc1
W_k4:
    v_mov_b32 v79, 0
    v_lshlrev_b32 v72, 16, v40
    v_and_b32 v73, 0xffff0000, v40
    v_mul_f32 v72, v72, v56
    v_mul_f32 v73, v73, v57
    v_cvt_pk_bf16_f32 v72, 0, v72
    v_cvt_pk_bf16_f32 v73, 0, v73
    v_add_f32 v79, v79, v72
    v_add_f32 v79, v79, v73
    v_lshlrev_b32 v72, 16, v41
    v_and_b32 v73, 0xffff0000, v41
    v_mul_f32 v72, v72, v58
    v_mul_f32 v73, v73, v59
    v_cvt_pk_bf16_f32 v72, 0, v72
    v_cvt_pk_bf16_f32 v73, 0, v73
    v_add_f32 v79, v79, v72
    v_add_f32 v79, v79, v73
    v_lshlrev_b32 v72, 16, v42
    v_and_b32 v73, 0xffff0000, v42
    v_mul_f32 v72, v72, v60
    v_mul_f32 v73, v73, v61
    v_cvt_pk_bf16_f32 v72, 0, v72
    v_cvt_pk_bf16_f32 v73, 0, v73
    v_add_f32 v79, v79, v72
    v_add_f32 v79, v79, v73
    v_lshlrev_b32 v72, 16, v43
    v_and_b32 v73, 0xffff0000, v43
    v_mul_f32 v72, v72, v62
    v_mul_f32 v73, v73, v63
    v_cvt_pk_bf16_f32 v72, 0, v72
    v_cvt_pk_bf16_f32 v73, 0, v73
    v_add_f32 v79, v79, v72
    v_add_f32 v79, v79, v73
    v_lshlrev_b32 v72, 16, v44
    v_and_b32 v73, 0xffff0000, v44
    v_mul_f32 v72, v72, v64
    v_mul_f32 v73, v73, v65
    v_cvt_pk_bf16_f32 v72, 0, v72
    v_cvt_pk_bf16_f32 v73, 0, v73
    v_add_f32 v79, v79, v72
    v_add_f32 v79, v79, v73
    v_lshlrev_b32 v72, 16, v45
    v_and_b32 v73, 0xffff0000, v45
    v_mul_f32 v72, v72, v66
    v_mul_f32 v73, v73, v67
    v_cvt_pk_bf16_f32 v72, 0, v72
    v_cvt_pk_bf16_f32 v73, 0, v73
    v_add_f32 v79, v79, v72
    v_add_f32 v79, v79, v73
    v_lshlrev_b32 v72, 16, v46
    v_and_b32 v73, 0xffff0000, v46
    v_mul_f32 v72, v72, v68
    v_mul_f32 v73, v73, v69
    v_cvt_pk_bf16_f32 v72, 0, v72
    v_cvt_pk_bf16_f32 v73, 0, v73
    v_add_f32 v79, v79, v72
    v_add_f32 v79, v79, v73
    v_lshlrev_b32 v72, 16, v47
    v_and_b32 v73, 0xffff0000, v47
    v_mul_f32 v72, v72, v70
    v_mul_f32 v73, v73, v71
    v_cvt_pk_bf16_f32 v72, 0, v72
    v_cvt_pk_bf16_f32 v73, 0, v73
    v_add_f32 v79, v79, v72
    v_add_f32 v79, v79, v73
    s_nop 1
    v_permlane32_swap_b32 v76, v77
    v_permlane32_swap_b32 v78, v79
    v_add_f32 v76, v76, v77
    v_add_f32 v78, v78, v79
    s_nop 1
    v_permlane16_swap_b32 v76, v78
    v_add_f32 v76, v76, v78
    s_nop 1
    v_add_f32_dpp v76, v76, v76 quad_perm:[1,0,3,2] row_mask:0xf bank_mask:0xf
    s_nop 1
    v_add_f32_dpp v76, v76, v76 quad_perm:[2,3,0,1] row_mask:0xf bank_mask:0xf
    s_nop 1
    v_add_f32_dpp v76, v76, v76 row_half_mirror row_mask:0xf bank_mask:0xf
    s_nop 1
    v_add_f32_dpp v76, v76, v76 row_mirror row_mask:0xf bank_mask:0xf
    v_cvt_pk_bf16_f32 v76, 0, v76
    v_mul_f32 v76, s46, v76
    v_exp_f32 v76, -v76
    s_lshl_b32 s66, s50, 4
    v_add_f32 v76, 1.0, v76
    v_rcp_f32 v76, v76
    s_add_u32 s66, s66, 6094848
    v_cvt_pk_bf16_f32 v76, 0, v76
    v_lshlrev_b32 v10, 2, v3
    s_mov_b32 exec_lo, 0x00010001
    s_mov_b32 exec_hi, 0x00010001
    buffer_store_dword v76, v10, s[16:19], s66 offen sc0 sc1
    s_mov_b64 exec, -1
    s_barrier
    s_mov_b32 s66, 57344
    buffer_load_dwordx4 v[128:131], v6, s[28:31], s66 offen nt
    s_mov_b32 s66, 64512
    buffer_load_dwordx4 v[132:135], v6, s[28:31], s66 offen nt
    s_mov_b32 s66, 71680
    buffer_load_dwordx4 v[136:139], v6, s[28:31], s66 offen nt
    s_mov_b32 s66, 78848
    buffer_load_dwordx4 v[140:143], v6, s[28:31], s66 offen nt
    s_mov_b32 s66, 86016
    buffer_load_dwordx4 v[144:147], v6, s[28:31], s66 offen nt
    s_mov_b32 s66, 93184
    buffer_load_dwordx4 v[148:151], v6, s[28:31], s66 offen nt
    s_mov_b32 s66, 100352
    buffer_load_dwordx4 v[152:155], v6, s[28:31], s66 offen nt
    s_mov_b32 s66, 107520
    buffer_load_dwordx4 v[156:159], v6, s[28:31], s66 offen nt
    s_cmp_lg_u32 s48, 0
    s_cbranch_scc1 W_c5
    s_waitcnt vmcnt(9)
    s_mov_b32 s67, 0
W_cs:
    v_xor_b32 v10, v225, v15
    v_xor_b32 v11, v227, v15
    v_or_b32 v10, v10, v11
    v_xor_b32 v11, v229, v15
    v_or_b32 v10, v10, v11
    v_xor_b32 v11, v231, v15
    v_or_b32 v10, v10, v11
    v_cmp_ne_u32 vcc, 0, v10
    s_cbranch_vccz W_cok
    s_add_u32 s67, s67, 1
    s_cmp_ge_u32 s67, 200000
    s_cbranch_scc1 W_cok
    s_sleep 4
    s_movk_i32 s66, 0
    buffer_load_dwordx2 v[224:225], v8, s[16:19], s66 offen sc1
    s_movk_i32 s66, 2048
    buffer_load_dwordx2 v[226:227], v8, s[16:19], s66 offen sc1
    s_movk_i32 s66, 4096
    buffer_load_dwordx2 v[228:229], v8, s[16:19], s66 offen sc1
    s_movk_i32 s66, 6144
    buffer_load_dwordx2 v[230:231], v8, s[16:19], s66 offen sc1
    s_waitcnt vmcnt(0)
    s_branch W_cs
W_cok:
    v_max_u32 v12, v224, v226
    v_max3_u32 v12, v12, v228, v230
    s_nop 1
    s_nop 1
    v_max_u32_dpp v12, v12, v12 quad_perm:[1,0,3,2] row_mask:0xf bank_mask:0xf
    s_nop 1
    v_max_u32_dpp v12, v12, v12 quad_perm:[2,3,0,1] row_mask:0xf bank_mask:0xf
    s_nop 1
    v_max_u32_dpp v12, v12, v12 row_half_mirror row_mask:0xf bank_mask:0xf
    s_nop 1
    v_max_u32_dpp v12, v12, v12 row_mirror row_mask:0xf bank_mask:0xf
    s_nop 1
    v_readlane_b32 s68, v12, 0
    v_readlane_b32 s69, v12, 16
    v_readlane_b32 s70, v12, 32
    v_readlane_b32 s71, v12, 48
    s_nop 1
    v_mov_b32 v12, s68
    v_max_u32 v12, s69, v12
    v_max_u32 v12, s70, v12
    v_max_u32 v12, s71, v12
    v_mov_b32 v10, 155684
    ds_write_b32 v10, v12
W_c5:
    s_waitcnt lgkmcnt(0)
    s_barrier
    v_mov_b32 v10, 155684
    ds_read_b32 v11, v10
    v_lshrrev_b32 v10, 5, v2
    v_lshlrev_b32 v10, 6, v10
    s_waitcnt lgkmcnt(0)
    v_readfirstlane_b32 s66, v11
    s_and_b32 s66, s66, 0x7ff
    s_sub_u32 s66, 2047, s66
    s_lshl_b32 s66, s66, 10
    s_add_u32 s66, s66, s51
    s_lshl_b32 s66, s66, 1
    buffer_load_dwordx4 v[224:227], v10, s[8:11], s66 offen offset:0
    buffer_load_dwordx4 v[228:231], v10, s[8:11], s66 offen offset:16
    buffer_load_dwordx4 v[232:235], v10, s[8:11], s66 offen offset:32
    buffer_load_dwordx4 v[236:239], v10, s[8:11], s66 offen offset:48
    s_barrier
    s_mov_b32 s66, 114688
    buffer_load_dwordx4 v[160:163], v6, s[28:31], s66 offen nt
    s_mov_b32 s66, 121856
    buffer_load_dwordx4 v[164:167], v6, s[28:31], s66 offen nt
    s_mov_b32 s66, 129024
    buffer_load_dwordx4 v[168:171], v6, s[28:31], s66 offen nt
    s_mov_b32 s66, 136192
    buffer_load_dwordx4 v[172:175], v6, s[28:31], s66 offen nt
    s_mov_b32 s66, 143360
    buffer_load_dwordx4 v[176:179], v6, s[28:31], s66 offen nt
    s_mov_b32 s66, 150528
    buffer_load_dwordx4 v[180:183], v6, s[28:31], s66 offen nt
    s_mov_b32 s66, 157696
    buffer_load_dwordx4 v[184:187], v6, s[28:31], s66 offen nt
    s_mov_b32 s66, 164864
    buffer_load_dwordx4 v[188:191], v6, s[28:31], s66 offen nt
    s_waitcnt vmcnt(8)
    v_mov_b32 v64, 0
    v_mov_b32 v65, 0
    v_mov_b32 v66, 0
    v_mov_b32 v67, 0
    v_mov_b32 v68, 0
    v_mov_b32 v69, 0
    v_mov_b32 v70, 0
    v_mov_b32 v71, 0
    v_lshlrev_b32 v72, 16, v224
    v_lshlrev_b32 v73, 16, v96
    v_and_b32 v74, 0xffff0000, v96
    v_fmac_f32 v64, v73, v72
    v_fmac_f32 v65, v74, v72
    v_lshlrev_b32 v73, 16, v97
    v_and_b32 v74, 0xffff0000, v97
    v_fmac_f32 v66, v73, v72
    v_fmac_f32 v67, v74, v72
    v_lshlrev_b32 v73, 16, v98
    v_and_b32 v74, 0xffff0000, v98
    v_fmac_f32 v68, v73, v72
    v_fmac_f32 v69, v74, v72
    v_lshlrev_b32 v73, 16, v99
    v_and_b32 v74, 0xffff0000, v99
    v_fmac_f32 v70, v73, v72
    v_fmac_f32 v71, v74, v72
    v_and_b32 v72, 0xffff0000, v224
    v_lshlrev_b32 v73, 16, v100
    v_and_b32 v74, 0xffff0000, v100
    v_fmac_f32 v64, v73, v72
    v_fmac_f32 v65, v74, v72
    v_lshlrev_b32 v73, 16, v101
    v_and_b32 v74, 0xffff0000, v101
    v_fmac_f32 v66, v73, v72
    v_fmac_f32 v67, v74, v72
    v_lshlrev_b32 v73, 16, v102
    v_and_b32 v74, 0xffff0000, v102
    v_fmac_f32 v68, v73, v72
    v_fmac_f32 v69, v74, v72
    v_lshlrev_b32 v73, 16, v103
    v_and_b32 v74, 0xffff0000, v103
    v_fmac_f32 v70, v73, v72
    v_fmac_f32 v71, v74, v72
    v_lshlrev_b32 v72, 16, v225
    v_lshlrev_b32 v73, 16, v104
    v_and_b32 v74, 0xffff0000, v104
    v_fmac_f32 v64, v73, v72
    v_fmac_f32 v65, v74, v72
    v_lshlrev_b32 v73, 16, v105
    v_and_b32 v74, 0xffff0000, v105
    v_fmac_f32 v66, v73, v72
    v_fmac_f32 v67, v74, v72
    v_lshlrev_b32 v73, 16, v106
    v_and_b32 v74, 0xffff0000, v106
    v_fmac_f32 v68, v73, v72
    v_fmac_f32 v69, v74, v72
    v_lshlrev_b32 v73, 16, v107
    v_and_b32 v74, 0xffff0000, v107
    v_fmac_f32 v70, v73, v72
    v_fmac_f32 v71, v74, v72
    v_and_b32 v72, 0xffff0000, v225
    v_lshlrev_b32 v73, 16, v108
    v_and_b32 v74, 0xffff0000, v108
    v_fmac_f32 v64, v73, v72
    v_fmac_f32 v65, v74, v72
    v_lshlrev_b32 v73, 16, v109
    v_and_b32 v74, 0xffff0000, v109
    v_fmac_f32 v66, v73, v72
    v_fmac_f32 v67, v74, v72
    v_lshlrev_b32 v73, 16, v110
    v_and_b32 v74, 0xffff0000, v110
    v_fmac_f32 v68, v73, v72
    v_fmac_f32 v69, v74, v72
    v_lshlrev_b32 v73, 16, v111
    v_and_b32 v74, 0xffff0000, v111
    v_fmac_f32 v70, v73, v72
    v_fmac_f32 v71, v74, v72
    v_lshlrev_b32 v72, 16, v226
    v_lshlrev_b32 v73, 16, v112
    v_and_b32 v74, 0xffff0000, v112
    v_fmac_f32 v64, v73, v72
    v_fmac_f32 v65, v74, v72
    v_lshlrev_b32 v73, 16, v113
    v_and_b32 v74, 0xffff0000, v113
    v_fmac_f32 v66, v73, v72
    v_fmac_f32 v67, v74, v72
    v_lshlrev_b32 v73, 16, v114
    v_and_b32 v74, 0xffff0000, v114
    v_fmac_f32 v68, v73, v72
    v_fmac_f32 v69, v74, v72
    v_lshlrev_b32 v73, 16, v115
    v_and_b32 v74, 0xffff0000, v115
    v_fmac_f32 v70, v73, v72
    v_fmac_f32 v71, v74, v72
    v_and_b32 v72, 0xffff0000, v226
    v_lshlrev_b32 v73, 16, v116
    v_and_b32 v74, 0xffff0000, v116
    v_fmac_f32 v64, v73, v72
    v_fmac_f32 v65, v74, v72
    v_lshlrev_b32 v73, 16, v117
    v_and_b32 v74, 0xffff0000, v117
    v_fmac_f32 v66, v73, v72
    v_fmac_f32 v67, v74, v72
    v_lshlrev_b32 v73, 16, v118
    v_and_b32 v74, 0xffff0000, v118
    v_fmac_f32 v68, v73, v72
    v_fmac_f32 v69, v74, v72
    v_lshlrev_b32 v73, 16, v119
    v_and_b32 v74, 0xffff0000, v119
    v_fmac_f32 v70, v73, v72
    v_fmac_f32 v71, v74, v72
    s_barrier
    v_lshlrev_b32 v72, 16, v227
    v_lshlrev_b32 v73, 16, v120
    v_and_b32 v74, 0xffff0000, v120
    v_fmac_f32 v64, v73, v72
    v_fmac_f32 v65, v74, v72
    v_lshlrev_b32 v73, 16, v121
    v_and_b32 v74, 0xffff0000, v121
    v_fmac_f32 v66, v73, v72
    v_fmac_f32 v67, v74, v72
    v_lshlrev_b32 v73, 16, v122
    v_and_b32 v74, 0xffff0000, v122
    v_fmac_f32 v68, v73, v72
    v_fmac_f32 v69, v74, v72
    v_lshlrev_b32 v73, 16, v123
    v_and_b32 v74, 0xffff0000, v123
    v_fmac_f32 v70, v73, v72
    v_fmac_f32 v71, v74, v72
    v_and_b32 v72, 0xffff0000, v227
    v_lshlrev_b32 v73, 16, v124
    v_and_b32 v74, 0xffff0000, v124
    v_fmac_f32 v64, v73, v72
    v_fmac_f32 v65, v74, v72
    v_lshlrev_b32 v73, 16, v125
    v_and_b32 v74, 0xffff0000, v125
    v_fmac_f32 v66, v73, v72
    v_fmac_f32 v67, v74, v72
    v_lshlrev_b32 v73, 16, v126
    v_and_b32 v74, 0xffff0000, v126
    v_fmac_f32 v68, v73, v72
    v_fmac_f32 v69, v74, v72
    v_lshlrev_b32 v73, 16, v127
    v_and_b32 v74, 0xffff0000, v127
    v_fmac_f32 v70, v73, v72
    v_fmac_f32 v71, v74, v72
    v_lshlrev_b32 v72, 16, v228
    v_lshlrev_b32 v73, 16, v128
    v_and_b32 v74, 0xffff0000, v128
    v_fmac_f32 v64, v73, v72
    v_fmac_f32 v65, v74, v72
    v_lshlrev_b32 v73, 16, v129
    v_and_b32 v74, 0xffff0000, v129
    v_fmac_f32 v66, v73, v72
    v_fmac_f32 v67, v74, v72
    v_lshlrev_b32 v73, 16, v130
    v_and_b32 v74, 0xffff0000, v130
    v_fmac_f32 v68, v73, v72
    v_fmac_f32 v69, v74, v72
    v_lshlrev_b32 v73, 16, v131
    v_and_b32 v74, 0xffff0000, v131
    v_fmac_f32 v70, v73, v72
    v_fmac_f32 v71, v74, v72
    v_and_b32 v72, 0xffff0000, v228
    v_lshlrev_b32 v73, 16, v132
    v_and_b32 v74, 0xffff0000, v132
    v_fmac_f32 v64, v73, v72
    v_fmac_f32 v65, v74, v72
    v_lshlrev_b32 v73, 16, v133
    v_and_b32 v74, 0xffff0000, v133
    v_fmac_f32 v66, v73, v72
    v_fmac_f32 v67, v74, v72
    v_lshlrev_b32 v73, 16, v134
    v_and_b32 v74, 0xffff0000, v134
    v_fmac_f32 v68, v73, v72
    v_fmac_f32 v69, v74, v72
    v_lshlrev_b32 v73, 16, v135
    v_and_b32 v74, 0xffff0000, v135
    v_fmac_f32 v70, v73, v72
    v_fmac_f32 v71, v74, v72
    v_lshlrev_b32 v72, 16, v229
    v_lshlrev_b32 v73, 16, v136
    v_and_b32 v74, 0xffff0000, v136
    v_fmac_f32 v64, v73, v72
    v_fmac_f32 v65, v74, v72
    v_lshlrev_b32 v73, 16, v137
    v_and_b32 v74, 0xffff0000, v137
    v_fmac_f32 v66, v73, v72
    v_fmac_f32 v67, v74, v72
    v_lshlrev_b32 v73, 16, v138
    v_and_b32 v74, 0xffff0000, v138
    v_fmac_f32 v68, v73, v72
    v_fmac_f32 v69, v74, v72
    v_lshlrev_b32 v73, 16, v139
    v_and_b32 v74, 0xffff0000, v139
    v_fmac_f32 v70, v73, v72
    v_fmac_f32 v71, v74, v72
    v_and_b32 v72, 0xffff0000, v229
    v_lshlrev_b32 v73, 16, v140
    v_and_b32 v74, 0xffff0000, v140
    v_fmac_f32 v64, v73, v72
    v_fmac_f32 v65, v74, v72
    v_lshlrev_b32 v73, 16, v141
    v_and_b32 v74, 0xffff0000, v141
    v_fmac_f32 v66, v73, v72
    v_fmac_f32 v67, v74, v72
    v_lshlrev_b32 v73, 16, v142
    v_and_b32 v74, 0xffff0000, v142
    v_fmac_f32 v68, v73, v72
    v_fmac_f32 v69, v74, v72
    v_lshlrev_b32 v73, 16, v143
    v_and_b32 v74, 0xffff0000, v143
    v_fmac_f32 v70, v73, v72
    v_fmac_f32 v71, v74, v72
    s_barrier
    s_mov_b32 s66, 172032
    buffer_load_dwordx4 v[192:195], v6, s[28:31], s66 offen nt
    s_mov_b32 s66, 179200
    buffer_load_dwordx4 v[196:199], v6, s[28:31], s66 offen nt
    s_mov_b32 s66, 186368
    buffer_load_dwordx4 v[200:203], v6, s[28:31], s66 offen nt
    s_mov_b32 s66, 193536
    buffer_load_dwordx4 v[204:207], v6, s[28:31], s66 offen nt
    s_mov_b32 s66, 200704
    buffer_load_dwordx4 v[208:211], v6, s[28:31], s66 offen nt
    s_mov_b32 s66, 207872
    buffer_load_dwordx4 v[212:215], v6, s[28:31], s66 offen nt
    s_mov_b32 s66, 215040
    buffer_load_dwordx4 v[216:219], v6, s[28:31], s66 offen nt
    s_mov_b32 s66, 222208
    buffer_load_dwordx4 v[220:223], v6, s[28:31], s66 offen nt
    v_lshlrev_b32 v72, 16, v230
    v_lshlrev_b32 v73, 16, v144
    v_and_b32 v74, 0xffff0000, v144
    v_fmac_f32 v64, v73, v72
    v_fmac_f32 v65, v74, v72
    v_lshlrev_b32 v73, 16, v145
    v_and_b32 v74, 0xffff0000, v145
    v_fmac_f32 v66, v73, v72
    v_fmac_f32 v67, v74, v72
    v_lshlrev_b32 v73, 16, v146
    v_and_b32 v74, 0xffff0000, v146
    v_fmac_f32 v68, v73, v72
    v_fmac_f32 v69, v74, v72
    v_lshlrev_b32 v73, 16, v147
    v_and_b32 v74, 0xffff0000, v147
    v_fmac_f32 v70, v73, v72
    v_fmac_f32 v71, v74, v72
    v_and_b32 v72, 0xffff0000, v230
    v_lshlrev_b32 v73, 16, v148
    v_and_b32 v74, 0xffff0000, v148
    v_fmac_f32 v64, v73, v72
    v_fmac_f32 v65, v74, v72
    v_lshlrev_b32 v73, 16, v149
    v_and_b32 v74, 0xffff0000, v149
    v_fmac_f32 v66, v73, v72
    v_fmac_f32 v67, v74, v72
    v_lshlrev_b32 v73, 16, v150
    v_and_b32 v74, 0xffff0000, v150
    v_fmac_f32 v68, v73, v72
    v_fmac_f32 v69, v74, v72
    v_lshlrev_b32 v73, 16, v151
    v_and_b32 v74, 0xffff0000, v151
    v_fmac_f32 v70, v73, v72
    v_fmac_f32 v71, v74, v72
    v_lshlrev_b32 v72, 16, v231
    v_lshlrev_b32 v73, 16, v152
    v_and_b32 v74, 0xffff0000, v152
    v_fmac_f32 v64, v73, v72
    v_fmac_f32 v65, v74, v72
    v_lshlrev_b32 v73, 16, v153
    v_and_b32 v74, 0xffff0000, v153
    v_fmac_f32 v66, v73, v72
    v_fmac_f32 v67, v74, v72
    v_lshlrev_b32 v73, 16, v154
    v_and_b32 v74, 0xffff0000, v154
    v_fmac_f32 v68, v73, v72
    v_fmac_f32 v69, v74, v72
    v_lshlrev_b32 v73, 16, v155
    v_and_b32 v74, 0xffff0000, v155
    v_fmac_f32 v70, v73, v72
    v_fmac_f32 v71, v74, v72
    v_and_b32 v72, 0xffff0000, v231
    v_lshlrev_b32 v73, 16, v156
    v_and_b32 v74, 0xffff0000, v156
    v_fmac_f32 v64, v73, v72
    v_fmac_f32 v65, v74, v72
    v_lshlrev_b32 v73, 16, v157
    v_and_b32 v74, 0xffff0000, v157
    v_fmac_f32 v66, v73, v72
    v_fmac_f32 v67, v74, v72
    v_lshlrev_b32 v73, 16, v158
    v_and_b32 v74, 0xffff0000, v158
    v_fmac_f32 v68, v73, v72
    v_fmac_f32 v69, v74, v72
    v_lshlrev_b32 v73, 16, v159
    v_and_b32 v74, 0xffff0000, v159
    v_fmac_f32 v70, v73, v72
    v_fmac_f32 v71, v74, v72
    s_waitcnt vmcnt(15)
    v_lshlrev_b32 v72, 16, v232
    v_lshlrev_b32 v73, 16, v160
    v_and_b32 v74, 0xffff0000, v160
    v_fmac_f32 v64, v73, v72
    v_fmac_f32 v65, v74, v72
    v_lshlrev_b32 v73, 16, v161
    v_and_b32 v74, 0xffff0000, v161
    v_fmac_f32 v66, v73, v72
    v_fmac_f32 v67, v74, v72
    v_lshlrev_b32 v73, 16, v162
    v_and_b32 v74, 0xffff0000, v162
    v_fmac_f32 v68, v73, v72
    v_fmac_f32 v69, v74, v72
    v_lshlrev_b32 v73, 16, v163
    v_and_b32 v74, 0xffff0000, v163
    v_fmac_f32 v70, v73, v72
    v_fmac_f32 v71, v74, v72
    s_waitcnt vmcnt(14)
    v_and_b32 v72, 0xffff0000, v232
    v_lshlrev_b32 v73, 16, v164
    v_and_b32 v74, 0xffff0000, v164
    v_fmac_f32 v64, v73, v72
    v_fmac_f32 v65, v74, v72
    v_lshlrev_b32 v73, 16, v165
    v_and_b32 v74, 0xffff0000, v165
    v_fmac_f32 v66, v73, v72
    v_fmac_f32 v67, v74, v72
    v_lshlrev_b32 v73, 16, v166
    v_and_b32 v74, 0xffff0000, v166
    v_fmac_f32 v68, v73, v72
    v_fmac_f32 v69, v74, v72
    v_lshlrev_b32 v73, 16, v167
    v_and_b32 v74, 0xffff0000, v167
    v_fmac_f32 v70, v73, v72
    v_fmac_f32 v71, v74, v72
    s_barrier
    s_waitcnt vmcnt(13)
    v_lshlrev_b32 v72, 16, v233
    v_lshlrev_b32 v73, 16, v168
    v_and_b32 v74, 0xffff0000, v168
    v_fmac_f32 v64, v73, v72
    v_fmac_f32 v65, v74, v72
    v_lshlrev_b32 v73, 16, v169
    v_and_b32 v74, 0xffff0000, v169
    v_fmac_f32 v66, v73, v72
    v_fmac_f32 v67, v74, v72
    v_lshlrev_b32 v73, 16, v170
    v_and_b32 v74, 0xffff0000, v170
    v_fmac_f32 v68, v73, v72
    v_fmac_f32 v69, v74, v72
    v_lshlrev_b32 v73, 16, v171
    v_and_b32 v74, 0xffff0000, v171
    v_fmac_f32 v70, v73, v72
    v_fmac_f32 v71, v74, v72
    s_waitcnt vmcnt(12)
    v_and_b32 v72, 0xffff0000, v233
    v_lshlrev_b32 v73, 16, v172
    v_and_b32 v74, 0xffff0000, v172
    v_fmac_f32 v64, v73, v72
    v_fmac_f32 v65, v74, v72
    v_lshlrev_b32 v73, 16, v173
    v_and_b32 v74, 0xffff0000, v173
    v_fmac_f32 v66, v73, v72
    v_fmac_f32 v67, v74, v72
    v_lshlrev_b32 v73, 16, v174
    v_and_b32 v74, 0xffff0000, v174
    v_fmac_f32 v68, v73, v72
    v_fmac_f32 v69, v74, v72
    v_lshlrev_b32 v73, 16, v175
    v_and_b32 v74, 0xffff0000, v175
    v_fmac_f32 v70, v73, v72
    v_fmac_f32 v71, v74, v72
    s_waitcnt vmcnt(11)
    v_lshlrev_b32 v72, 16, v234
    v_lshlrev_b32 v73, 16, v176
    v_and_b32 v74, 0xffff0000, v176
    v_fmac_f32 v64, v73, v72
    v_fmac_f32 v65, v74, v72
    v_lshlrev_b32 v73, 16, v177
    v_and_b32 v74, 0xffff0000, v177
    v_fmac_f32 v66, v73, v72
    v_fmac_f32 v67, v74, v72
    v_lshlrev_b32 v73, 16, v178
    v_and_b32 v74, 0xffff0000, v178
    v_fmac_f32 v68, v73, v72
    v_fmac_f32 v69, v74, v72
    v_lshlrev_b32 v73, 16, v179
    v_and_b32 v74, 0xffff0000, v179
    v_fmac_f32 v70, v73, v72
    v_fmac_f32 v71, v74, v72
    s_waitcnt vmcnt(10)
    v_and_b32 v72, 0xffff0000, v234
    v_lshlrev_b32 v73, 16, v180
    v_and_b32 v74, 0xffff0000, v180
    v_fmac_f32 v64, v73, v72
    v_fmac_f32 v65, v74, v72
    v_lshlrev_b32 v73, 16, v181
    v_and_b32 v74, 0xffff0000, v181
    v_fmac_f32 v66, v73, v72
    v_fmac_f32 v67, v74, v72
    v_lshlrev_b32 v73, 16, v182
    v_and_b32 v74, 0xffff0000, v182
    v_fmac_f32 v68, v73, v72
    v_fmac_f32 v69, v74, v72
    v_lshlrev_b32 v73, 16, v183
    v_and_b32 v74, 0xffff0000, v183
    v_fmac_f32 v70, v73, v72
    v_fmac_f32 v71, v74, v72
    s_barrier
    s_waitcnt vmcnt(9)
    v_lshlrev_b32 v72, 16, v235
    v_lshlrev_b32 v73, 16, v184
    v_and_b32 v74, 0xffff0000, v184
    v_fmac_f32 v64, v73, v72
    v_fmac_f32 v65, v74, v72
    v_lshlrev_b32 v73, 16, v185
    v_and_b32 v74, 0xffff0000, v185
    v_fmac_f32 v66, v73, v72
    v_fmac_f32 v67, v74, v72
    v_lshlrev_b32 v73, 16, v186
    v_and_b32 v74, 0xffff0000, v186
    v_fmac_f32 v68, v73, v72
    v_fmac_f32 v69, v74, v72
    v_lshlrev_b32 v73, 16, v187
    v_and_b32 v74, 0xffff0000, v187
    v_fmac_f32 v70, v73, v72
    v_fmac_f32 v71, v74, v72
    s_waitcnt vmcnt(8)
    v_and_b32 v72, 0xffff0000, v235
    v_lshlrev_b32 v73, 16, v188
    v_and_b32 v74, 0xffff0000, v188
    v_fmac_f32 v64, v73, v72
    v_fmac_f32 v65, v74, v72
    v_lshlrev_b32 v73, 16, v189
    v_and_b32 v74, 0xffff0000, v189
    v_fmac_f32 v66, v73, v72
    v_fmac_f32 v67, v74, v72
    v_lshlrev_b32 v73, 16, v190
    v_and_b32 v74, 0xffff0000, v190
    v_fmac_f32 v68, v73, v72
    v_fmac_f32 v69, v74, v72
    v_lshlrev_b32 v73, 16, v191
    v_and_b32 v74, 0xffff0000, v191
    v_fmac_f32 v70, v73, v72
    v_fmac_f32 v71, v74, v72
    s_waitcnt vmcnt(7)
    v_lshlrev_b32 v72, 16, v236
    v_lshlrev_b32 v73, 16, v192
    v_and_b32 v74, 0xffff0000, v192
    v_fmac_f32 v64, v73, v72
    v_fmac_f32 v65, v74, v72
    v_lshlrev_b32 v73, 16, v193
    v_and_b32 v74, 0xffff0000, v193
    v_fmac_f32 v66, v73, v72
    v_fmac_f32 v67, v74, v72
    v_lshlrev_b32 v73, 16, v194
    v_and_b32 v74, 0xffff0000, v194
    v_fmac_f32 v68, v73, v72
    v_fmac_f32 v69, v74, v72
    v_lshlrev_b32 v73, 16, v195
    v_and_b32 v74, 0xffff0000, v195
    v_fmac_f32 v70, v73, v72
    v_fmac_f32 v71, v74, v72
    s_waitcnt vmcnt(6)
    v_and_b32 v72, 0xffff0000, v236
    v_lshlrev_b32 v73, 16, v196
    v_and_b32 v74, 0xffff0000, v196
    v_fmac_f32 v64, v73, v72
    v_fmac_f32 v65, v74, v72
    v_lshlrev_b32 v73, 16, v197
    v_and_b32 v74, 0xffff0000, v197
    v_fmac_f32 v66, v73, v72
    v_fmac_f32 v67, v74, v72
    v_lshlrev_b32 v73, 16, v198
    v_and_b32 v74, 0xffff0000, v198
    v_fmac_f32 v68, v73, v72
    v_fmac_f32 v69, v74, v72
    v_lshlrev_b32 v73, 16, v199
    v_and_b32 v74, 0xffff0000, v199
    v_fmac_f32 v70, v73, v72
    v_fmac_f32 v71, v74, v72
    s_waitcnt vmcnt(5)
    v_lshlrev_b32 v72, 16, v237
    v_lshlrev_b32 v73, 16, v200
    v_and_b32 v74, 0xffff0000, v200
    v_fmac_f32 v64, v73, v72
    v_fmac_f32 v65, v74, v72
    v_lshlrev_b32 v73, 16, v201
    v_and_b32 v74, 0xffff0000, v201
    v_fmac_f32 v66, v73, v72
    v_fmac_f32 v67, v74, v72
    v_lshlrev_b32 v73, 16, v202
    v_and_b32 v74, 0xffff0000, v202
    v_fmac_f32 v68, v73, v72
    v_fmac_f32 v69, v74, v72
    v_lshlrev_b32 v73, 16, v203
    v_and_b32 v74, 0xffff0000, v203
    v_fmac_f32 v70, v73, v72
    v_fmac_f32 v71, v74, v72
    s_waitcnt vmcnt(4)
    v_and_b32 v72, 0xffff0000, v237
    v_lshlrev_b32 v73, 16, v204
    v_and_b32 v74, 0xffff0000, v204
    v_fmac_f32 v64, v73, v72
    v_fmac_f32 v65, v74, v72
    v_lshlrev_b32 v73, 16, v205
    v_and_b32 v74, 0xffff0000, v205
    v_fmac_f32 v66, v73, v72
    v_fmac_f32 v67, v74, v72
    v_lshlrev_b32 v73, 16, v206
    v_and_b32 v74, 0xffff0000, v206
    v_fmac_f32 v68, v73, v72
    v_fmac_f32 v69, v74, v72
    v_lshlrev_b32 v73, 16, v207
    v_and_b32 v74, 0xffff0000, v207
    v_fmac_f32 v70, v73, v72
    v_fmac_f32 v71, v74, v72
    s_barrier
    s_waitcnt vmcnt(3)
    v_lshlrev_b32 v72, 16, v238
    v_lshlrev_b32 v73, 16, v208
    v_and_b32 v74, 0xffff0000, v208
    v_fmac_f32 v64, v73, v72
    v_fmac_f32 v65, v74, v72
    v_lshlrev_b32 v73, 16, v209
    v_and_b32 v74, 0xffff0000, v209
    v_fmac_f32 v66, v73, v72
    v_fmac_f32 v67, v74, v72
    v_lshlrev_b32 v73, 16, v210
    v_and_b32 v74, 0xffff0000, v210
    v_fmac_f32 v68, v73, v72
    v_fmac_f32 v69, v74, v72
    v_lshlrev_b32 v73, 16, v211
    v_and_b32 v74, 0xffff0000, v211
    v_fmac_f32 v70, v73, v72
    v_fmac_f32 v71, v74, v72
    s_waitcnt vmcnt(2)
    v_and_b32 v72, 0xffff0000, v238
    v_lshlrev_b32 v73, 16, v212
    v_and_b32 v74, 0xffff0000, v212
    v_fmac_f32 v64, v73, v72
    v_fmac_f32 v65, v74, v72
    v_lshlrev_b32 v73, 16, v213
    v_and_b32 v74, 0xffff0000, v213
    v_fmac_f32 v66, v73, v72
    v_fmac_f32 v67, v74, v72
    v_lshlrev_b32 v73, 16, v214
    v_and_b32 v74, 0xffff0000, v214
    v_fmac_f32 v68, v73, v72
    v_fmac_f32 v69, v74, v72
    v_lshlrev_b32 v73, 16, v215
    v_and_b32 v74, 0xffff0000, v215
    v_fmac_f32 v70, v73, v72
    v_fmac_f32 v71, v74, v72
    s_waitcnt vmcnt(1)
    v_lshlrev_b32 v72, 16, v239
    v_lshlrev_b32 v73, 16, v216
    v_and_b32 v74, 0xffff0000, v216
    v_fmac_f32 v64, v73, v72
    v_fmac_f32 v65, v74, v72
    v_lshlrev_b32 v73, 16, v217
    v_and_b32 v74, 0xffff0000, v217
    v_fmac_f32 v66, v73, v72
    v_fmac_f32 v67, v74, v72
    v_lshlrev_b32 v73, 16, v218
    v_and_b32 v74, 0xffff0000, v218
    v_fmac_f32 v68, v73, v72
    v_fmac_f32 v69, v74, v72
    v_lshlrev_b32 v73, 16, v219
    v_and_b32 v74, 0xffff0000, v219
    v_fmac_f32 v70, v73, v72
    v_fmac_f32 v71, v74, v72
    s_waitcnt vmcnt(0)
    v_and_b32 v72, 0xffff0000, v239
    v_lshlrev_b32 v73, 16, v220
    v_and_b32 v74, 0xffff0000, v220
    v_fmac_f32 v64, v73, v72
    v_fmac_f32 v65, v74, v72
    v_lshlrev_b32 v73, 16, v221
    v_and_b32 v74, 0xffff0000, v221
    v_fmac_f32 v66, v73, v72
    v_fmac_f32 v67, v74, v72
    v_lshlrev_b32 v73, 16, v222
    v_and_b32 v74, 0xffff0000, v222
    v_fmac_f32 v68, v73, v72
    v_fmac_f32 v69, v74, v72
    v_lshlrev_b32 v73, 16, v223
    v_and_b32 v74, 0xffff0000, v223
    v_fmac_f32 v70, v73, v72
    v_fmac_f32 v71, v74, v72
    v_and_b32 v76, 31, v2
    v_lshrrev_b32 v77, 5, v2
    v_lshl_add_u32 v76, v76, 1, v77
    v_permlane32_swap_b32 v64, v68
    v_permlane32_swap_b32 v65, v69
    v_permlane32_swap_b32 v66, v70
    v_permlane32_swap_b32 v67, v71
    v_lshlrev_b32 v76, 4, v76
    v_add_f32 v64, v64, v68
    v_add_f32 v65, v65, v69
    v_add_f32 v66, v66, v70
    v_add_f32 v67, v67, v71
    buffer_store_dwordx4 v[64:67], v76, s[16:19], s54 offen sc0 sc1
    s_barrier
    s_mov_b32 s66, 0
    buffer_load_dwordx4 v[96:99], v7, s[32:35], s66 offen
    s_mov_b32 s66, 2048
    buffer_load_dwordx4 v[100:103], v7, s[32:35], s66 offen
    s_mov_b32 s66, 4096
    buffer_load_dwordx4 v[104:107], v7, s[32:35], s66 offen
    s_mov_b32 s66, 6144
    buffer_load_dwordx4 v[108:111], v7, s[32:35], s66 offen
    s_mov_b32 s66, 8192
    buffer_load_dwordx4 v[112:115], v7, s[32:35], s66 offen
    s_mov_b32 s66, 10240
    buffer_load_dwordx4 v[116:119], v7, s[32:35], s66 offen
    s_mov_b32 s66, 12288
    buffer_load_dwordx4 v[120:123], v7, s[32:35], s66 offen
    s_mov_b32 s66, 14336
    buffer_load_dwordx4 v[124:127], v7, s[32:35], s66 offen
H_b14:
    s_barrier
    s_setprio 3
    s_add_u32 s67, s52, 0
    s_and_b32 s67, s67, 0x1fffff
    s_add_u32 m0, s72, 24576
    s_add_u32 s66, s67, 0
    buffer_load_dwordx4 v90, s[20:23], s66 offen lds
    s_add_u32 m0, s72, 28672
    s_add_u32 s66, s67, 65536
    buffer_load_dwordx4 v90, s[20:23], s66 offen lds
    s_add_u32 s67, s52, 0
    s_and_b32 s67, s67, 0x1fffff
    s_add_u32 m0, s72, 40960
    s_add_u32 s66, s67, 131072
    buffer_load_dwordx4 v90, s[20:23], s66 offen lds
    s_add_u32 m0, s72, 45056
    s_add_u32 s66, s67, 196608
    buffer_load_dwordx4 v90, s[20:23], s66 offen lds
    s_mov_b32 s70, 0x3fb8aa3b
    s_mov_b32 s71, 0x3fb8aa3b
    s_and_b32 s66, s44, 2
    s_lshl_b32 s67, s66, 2
    s_add_u32 s67, s67, 155648
    v_mov_b32 v10, s67
    s_lshl_b32 s66, s66, 12
    s_and_b32 s67, s44, 1
    s_lshl_b32 s67, s67, 10
    v_add_u32 v11, s66, v9
    v_add_u32 v12, s67, v11
    v_add_u32 v11, 65536, v11
    v_mov_b32 v204, 0x3f803f80
    v_mov_b32 v205, 0x3f803f80
    v_mov_b32 v206, 0x3f803f80
    v_mov_b32 v207, 0x3f803f80
    v_bfe_u32 v12, v2, 4, 1
    v_lshrrev_b32 v13, 5, v2
    v_lshl_add_u32 v12, v12, 1, v13
    v_bfe_u32 v13, v2, 1, 3
    v_xor_b32 v12, v12, v13
    v_and_b32 v13, 127, v92
    v_lshlrev_b32 v13, 7, v13
    v_lshl_add_u32 v12, v12, 4, v13
    v_add_u32 v12, 122880, v12
    v_xor_b32 v13, 64, v12
    ds_read_b128 v[144:147], v12
    ds_read_b128 v[148:151], v13
    s_waitcnt lgkmcnt(0)
    v_add_u32 v12, s67, v11
    v_subrev_u32 v12, 65536, v12
H_fk:
    ds_read_b64 v[14:15], v10
    s_waitcnt lgkmcnt(0)
    v_min_u32 v14, v14, v15
    v_cmp_eq_u32 vcc, 0, v14
    s_cbranch_vccnz H_fk
    ds_read_b128 v[16:19], v12 offset:0
    ds_read_b128 v[20:23], v12 offset:2048
    ds_read_b128 v[24:27], v12 offset:4096
    ds_read_b128 v[28:31], v12 offset:6144
    s_waitcnt lgkmcnt(3)
    v_lshlrev_b32 v72, 16, v16
    v_and_b32 v73, 0xffff0000, v16
    v_pk_mul_f32 v[74:75], v[72:73], s[70:71]
    v_pk_add_f32 v[72:73], v[72:73], 1.0 op_sel_hi:[1,0]
    v_exp_f32 v74, v74 clamp
    v_exp_f32 v75, v75 clamp
    v_lshlrev_b32 v76, 16, v17
    v_and_b32 v77, 0xffff0000, v17
    v_pk_mul_f32 v[78:79], v[76:77], s[70:71]
    v_pk_add_f32 v[76:77], v[76:77], 1.0 op_sel_hi:[1,0]
    v_exp_f32 v78, v78 clamp
    v_exp_f32 v79, v79 clamp
    v_max_f32 v72, v72, v74
    v_max_f32 v73, v73, v75
    v_cvt_pk_bf16_f32 v32, v72, v73
    v_max_f32 v76, v76, v78
    v_max_f32 v77, v77, v79
    v_cvt_pk_bf16_f32 v33, v76, v77
    v_lshlrev_b32 v72, 16, v18
    v_and_b32 v73, 0xffff0000, v18
    v_pk_mul_f32 v[74:75], v[72:73], s[70:71]
    v_pk_add_f32 v[72:73], v[72:73], 1.0 op_sel_hi:[1,0]
    v_exp_f32 v74, v74 clamp
    v_exp_f32 v75, v75 clamp
    v_lshlrev_b32 v76, 16, v19
    v_and_b32 v77, 0xffff0000, v19
    v_pk_mul_f32 v[78:79], v[76:77], s[70:71]
    v_pk_add_f32 v[76:77], v[76:77], 1.0 op_sel_hi:[1,0]
    v_exp_f32 v78, v78 clamp
    v_exp_f32 v79, v79 clamp
    v_max_f32 v72, v72, v74
    v_max_f32 v73, v73, v75
    v_cvt_pk_bf16_f32 v34, v72, v73
    v_max_f32 v76, v76, v78
    v_max_f32 v77, v77, v79
    v_cvt_pk_bf16_f32 v35, v76, v77
    s_waitcnt lgkmcnt(2)
    v_lshlrev_b32 v72, 16, v20
    v_and_b32 v73, 0xffff0000, v20
    v_pk_mul_f32 v[74:75], v[72:73], s[70:71]
    v_pk_add_f32 v[72:73], v[72:73], 1.0 op_sel_hi:[1,0]
    v_exp_f32 v74, v74 clamp
    v_exp_f32 v75, v75 clamp
    v_lshlrev_b32 v76, 16, v21
    v_and_b32 v77, 0xffff0000, v21
    v_pk_mul_f32 v[78:79], v[76:77], s[70:71]
    v_pk_add_f32 v[76:77], v[76:77], 1.0 op_sel_hi:[1,0]
    v_exp_f32 v78, v78 clamp
    v_exp_f32 v79, v79 clamp
    v_max_f32 v72, v72, v74
    v_max_f32 v73, v73, v75
    v_cvt_pk_bf16_f32 v36, v72, v73
    v_max_f32 v76, v76, v78
    v_max_f32 v77, v77, v79
    v_cvt_pk_bf16_f32 v37, v76, v77
    v_lshlrev_b32 v72, 16, v22
    v_and_b32 v73, 0xffff0000, v22
    v_pk_mul_f32 v[74:75], v[72:73], s[70:71]
    v_pk_add_f32 v[72:73], v[72:73], 1.0 op_sel_hi:[1,0]
    v_exp_f32 v74, v74 clamp
    v_exp_f32 v75, v75 clamp
    v_lshlrev_b32 v76, 16, v23
    v_and_b32 v77, 0xffff0000, v23
    v_pk_mul_f32 v[78:79], v[76:77], s[70:71]
    v_pk_add_f32 v[76:77], v[76:77], 1.0 op_sel_hi:[1,0]
    v_exp_f32 v78, v78 clamp
    v_exp_f32 v79, v79 clamp
    v_max_f32 v72, v72, v74
    v_max_f32 v73, v73, v75
    v_cvt_pk_bf16_f32 v38, v72, v73
    v_max_f32 v76, v76, v78
    v_max_f32 v77, v77, v79
    v_cvt_pk_bf16_f32 v39, v76, v77
    s_waitcnt lgkmcnt(1)
    v_lshlrev_b32 v72, 16, v24
    v_and_b32 v73, 0xffff0000, v24
    v_pk_mul_f32 v[74:75], v[72:73], s[70:71]
    v_pk_add_f32 v[72:73], v[72:73], 1.0 op_sel_hi:[1,0]
    v_exp_f32 v74, v74 clamp
    v_exp_f32 v75, v75 clamp
    v_lshlrev_b32 v76, 16, v25
    v_and_b32 v77, 0xffff0000, v25
    v_pk_mul_f32 v[78:79], v[76:77], s[70:71]
    v_pk_add_f32 v[76:77], v[76:77], 1.0 op_sel_hi:[1,0]
    v_exp_f32 v78, v78 clamp
    v_exp_f32 v79, v79 clamp
    v_max_f32 v72, v72, v74
    v_max_f32 v73, v73, v75
    v_cvt_pk_bf16_f32 v40, v72, v73
    v_max_f32 v76, v76, v78
    v_max_f32 v77, v77, v79
    v_cvt_pk_bf16_f32 v41, v76, v77
    v_lshlrev_b32 v72, 16, v26
    v_and_b32 v73, 0xffff0000, v26
    v_pk_mul_f32 v[74:75], v[72:73], s[70:71]
    v_pk_add_f32 v[72:73], v[72:73], 1.0 op_sel_hi:[1,0]
    v_exp_f32 v74, v74 clamp
    v_exp_f32 v75, v75 clamp
    v_lshlrev_b32 v76, 16, v27
    v_and_b32 v77, 0xffff0000, v27
    v_pk_mul_f32 v[78:79], v[76:77], s[70:71]
    v_pk_add_f32 v[76:77], v[76:77], 1.0 op_sel_hi:[1,0]
    v_exp_f32 v78, v78 clamp
    v_exp_f32 v79, v79 clamp
    v_max_f32 v72, v72, v74
    v_max_f32 v73, v73, v75
    v_cvt_pk_bf16_f32 v42, v72, v73
    v_max_f32 v76, v76, v78
    v_max_f32 v77, v77, v79
    v_cvt_pk_bf16_f32 v43, v76, v77
    s_waitcnt lgkmcnt(0)
    v_lshlrev_b32 v72, 16, v28
    v_and_b32 v73, 0xffff0000, v28
    v_pk_mul_f32 v[74:75], v[72:73], s[70:71]
    v_pk_add_f32 v[72:73], v[72:73], 1.0 op_sel_hi:[1,0]
    v_exp_f32 v74, v74 clamp
    v_exp_f32 v75, v75 clamp
    v_lshlrev_b32 v76, 16, v29
    v_and_b32 v77, 0xffff0000, v29
    v_pk_mul_f32 v[78:79], v[76:77], s[70:71]
    v_pk_add_f32 v[76:77], v[76:77], 1.0 op_sel_hi:[1,0]
    v_exp_f32 v78, v78 clamp
    v_exp_f32 v79, v79 clamp
    v_max_f32 v72, v72, v74
    v_max_f32 v73, v73, v75
    v_cvt_pk_bf16_f32 v44, v72, v73
    v_max_f32 v76, v76, v78
    v_max_f32 v77, v77, v79
    v_cvt_pk_bf16_f32 v45, v76, v77
    v_lshlrev_b32 v72, 16, v30
    v_and_b32 v73, 0xffff0000, v30
    v_pk_mul_f32 v[74:75], v[72:73], s[70:71]
    v_pk_add_f32 v[72:73], v[72:73], 1.0 op_sel_hi:[1,0]
    v_exp_f32 v74, v74 clamp
    v_exp_f32 v75, v75 clamp
    v_lshlrev_b32 v76, 16, v31
    v_and_b32 v77, 0xffff0000, v31
    v_pk_mul_f32 v[78:79], v[76:77], s[70:71]
    v_pk_add_f32 v[76:77], v[76:77], 1.0 op_sel_hi:[1,0]
    v_exp_f32 v78, v78 clamp
    v_exp_f32 v79, v79 clamp
    v_max_f32 v72, v72, v74
    v_max_f32 v73, v73, v75
    v_cvt_pk_bf16_f32 v46, v72, v73
    v_max_f32 v76, v76, v78
    v_max_f32 v77, v77, v79
    v_cvt_pk_bf16_f32 v47, v76, v77
H_fv:
    ds_read_b64 v[14:15], v10 offset:16
    s_waitcnt lgkmcnt(0)
    v_min_u32 v13, v14, v15
    v_cmp_eq_u32 vcc, 0, v13
    s_cbranch_vccnz H_fv
    ds_read_b128 v[208:211], v11 offset:0
    ds_read_b128 v[212:215], v11 offset:1024
    ds_read_b128 v[216:219], v11 offset:2048
    ds_read_b128 v[220:223], v11 offset:3072
    ds_read_b128 v[224:227], v11 offset:4096
    ds_read_b128 v[228:231], v11 offset:5120
    ds_read_b128 v[232:235], v11 offset:6144
    ds_read_b128 v[236:239], v11 offset:7168
    v_max_u32 v13, v14, v15
    v_cmp_eq_u32 vcc, 2, v13
    s_cbranch_vccnz H_eps
    v_mfma_f32_16x16x32_bf16 v[200:203], v[32:35], v[204:207], 0
    s_waitcnt lgkmcnt(7)
    v_mfma_f32_16x16x32_bf16 v[192:195], v[32:35], v[208:211], 0
    s_waitcnt lgkmcnt(6)
    v_mfma_f32_16x16x32_bf16 v[196:199], v[32:35], v[212:215], 0
    v_mfma_f32_16x16x32_bf16 v[200:203], v[36:39], v[204:207], v[200:203]
    s_waitcnt lgkmcnt(5)
    v_mfma_f32_16x16x32_bf16 v[192:195], v[36:39], v[216:219], v[192:195]
    s_waitcnt lgkmcnt(4)
    v_mfma_f32_16x16x32_bf16 v[196:199], v[36:39], v[220:223], v[196:199]
    v_mfma_f32_16x16x32_bf16 v[200:203], v[40:43], v[204:207], v[200:203]
    s_waitcnt lgkmcnt(3)
    v_mfma_f32_16x16x32_bf16 v[192:195], v[40:43], v[224:227], v[192:195]
    s_waitcnt lgkmcnt(2)
    v_mfma_f32_16x16x32_bf16 v[196:199], v[40:43], v[228:231], v[196:199]
    v_mfma_f32_16x16x32_bf16 v[200:203], v[44:47], v[204:207], v[200:203]
    s_waitcnt lgkmcnt(1)
    v_mfma_f32_16x16x32_bf16 v[192:195], v[44:47], v[232:235], v[192:195]
    s_waitcnt lgkmcnt(0)
    v_mfma_f32_16x16x32_bf16 v[196:199], v[44:47], v[236:239], v[196:199]
H_ne:
    v_lshrrev_b32 v13, 4, v2
    v_lshlrev_b32 v13, 4, v13
    v_and_b32 v14, 15, v2
    v_cmp_eq_u32 s[68:69], 0, v14
    s_lshl_b32 s66, s44, 11
    s_add_u32 s66, s66, 139264
    v_add_u32 v3, s66, v9
    s_waitcnt vmcnt(12)
    s_nop 1
    v_cvt_pk_bf16_f32 v72, v192, v193
    v_cvt_pk_bf16_f32 v73, v194, v195
    v_cvt_pk_bf16_f32 v74, v196, v197
    v_cvt_pk_bf16_f32 v75, v198, v199
    buffer_store_dwordx4 v[72:75], v9, s[16:19], s56 offen sc0 sc1
    s_mov_b64 exec, s[68:69]
    buffer_store_dwordx4 v[200:203], v13, s[16:19], s53 offen sc0 sc1
    s_mov_b64 exec, -1
    s_add_u32 s67, s52, 262144
    s_and_b32 s67, s67, 0x1fffff
    s_add_u32 m0, s72, 32768
    s_add_u32 s66, s67, 0
    buffer_load_dwordx4 v90, s[20:23], s66 offen lds
    s_add_u32 m0, s72, 36864
    s_add_u32 s66, s67, 65536
    buffer_load_dwordx4 v90, s[20:23], s66 offen lds
    s_add_u32 s67, s52, 262144
    s_and_b32 s67, s67, 0x1fffff
    s_add_u32 m0, s72, 49152
    s_add_u32 s66, s67, 131072
    buffer_load_dwordx4 v90, s[20:23], s66 offen lds
    s_add_u32 m0, s72, 53248
    s_add_u32 s66, s67, 196608
    buffer_load_dwordx4 v90, s[20:23], s66 offen lds
    s_setprio 0
    s_barrier
    ds_read_b128 v[16:19], v3
    ds_read_b128 v[20:23], v3 offset:1024
    buffer_load_dwordx4 v[80:83], v1, s[16:19], s62 offen sc1
    buffer_load_dwordx4 v[84:87], v1, s[16:19], s63 offen sc1
    s_add_u32 s67, s52, 524288
    s_and_b32 s67, s67, 0x1fffff
    s_add_u32 m0, s72, 81920
    s_add_u32 s66, s67, 0
    buffer_load_dwordx4 v90, s[20:23], s66 offen lds
    s_add_u32 m0, s72, 86016
    s_add_u32 s66, s67, 65536
    buffer_load_dwordx4 v90, s[20:23], s66 offen lds
    s_add_u32 s67, s52, 524288
    s_and_b32 s67, s67, 0x1fffff
    s_add_u32 m0, s72, 90112
    s_add_u32 s66, s67, 131072
    buffer_load_dwordx4 v90, s[20:23], s66 offen lds
    s_add_u32 m0, s72, 94208
    s_add_u32 s66, s67, 196608
    buffer_load_dwordx4 v90, s[20:23], s66 offen lds
    s_add_u32 s67, s52, 786432
    s_and_b32 s67, s67, 0x1fffff
    s_add_u32 m0, s72, 0
    s_add_u32 s66, s67, 0
    buffer_load_dwordx4 v90, s[20:23], s66 offen lds
    s_add_u32 m0, s72, 4096
    s_add_u32 s66, s67, 65536
    buffer_load_dwordx4 v90, s[20:23], s66 offen lds
    s_add_u32 s67, s52, 786432
    s_and_b32 s67, s67, 0x1fffff
    s_add_u32 m0, s72, 57344
    s_add_u32 s66, s67, 131072
    buffer_load_dwordx4 v90, s[20:23], s66 offen lds
    s_add_u32 m0, s72, 61440
    s_add_u32 s66, s67, 196608
    buffer_load_dwordx4 v90, s[20:23], s66 offen lds
    s_waitcnt lgkmcnt(0)
    v_lshlrev_b32 v32, 16, v16
    v_and_b32 v33, 0xffff0000, v16
    v_pk_mul_f32 v[34:35], v[32:33], s[70:71]
    v_pk_add_f32 v[32:33], v[32:33], 1.0 op_sel_hi:[1,0]
    v_exp_f32 v34, v34 clamp
    v_exp_f32 v35, v35 clamp
    v_lshlrev_b32 v36, 16, v17
    v_and_b32 v37, 0xffff0000, v17
    v_pk_mul_f32 v[38:39], v[36:37], s[70:71]
    v_pk_add_f32 v[36:37], v[36:37], 1.0 op_sel_hi:[1,0]
    v_exp_f32 v38, v38 clamp
    v_exp_f32 v39, v39 clamp
    v_max_f32 v32, v32, v34
    v_max_f32 v33, v33, v35
    v_min_f32 v40, v32, v33
    v_cvt_pk_bf16_f32 v24, v32, v33
    v_max_f32 v36, v36, v38
    v_max_f32 v37, v37, v39
    v_min3_f32 v40, v36, v37, v40
    v_cvt_pk_bf16_f32 v25, v36, v37
    v_lshlrev_b32 v32, 16, v18
    v_and_b32 v33, 0xffff0000, v18
    v_pk_mul_f32 v[34:35], v[32:33], s[70:71]
    v_pk_add_f32 v[32:33], v[32:33], 1.0 op_sel_hi:[1,0]
    v_exp_f32 v34, v34 clamp
    v_exp_f32 v35, v35 clamp
    v_lshlrev_b32 v36, 16, v19
    v_and_b32 v37, 0xffff0000, v19
    v_pk_mul_f32 v[38:39], v[36:37], s[70:71]
    v_pk_add_f32 v[36:37], v[36:37], 1.0 op_sel_hi:[1,0]
    v_exp_f32 v38, v38 clamp
    v_exp_f32 v39, v39 clamp
    v_max_f32 v32, v32, v34
    v_max_f32 v33, v33, v35
    v_min3_f32 v40, v32, v33, v40
    v_cvt_pk_bf16_f32 v26, v32, v33
    v_max_f32 v36, v36, v38
    v_max_f32 v37, v37, v39
    v_min3_f32 v40, v36, v37, v40
    v_cvt_pk_bf16_f32 v27, v36, v37
    v_lshlrev_b32 v32, 16, v20
    v_and_b32 v33, 0xffff0000, v20
    v_pk_mul_f32 v[34:35], v[32:33], s[70:71]
    v_pk_add_f32 v[32:33], v[32:33], 1.0 op_sel_hi:[1,0]
    v_exp_f32 v34, v34 clamp
    v_exp_f32 v35, v35 clamp
    v_lshlrev_b32 v36, 16, v21
    v_and_b32 v37, 0xffff0000, v21
    v_pk_mul_f32 v[38:39], v[36:37], s[70:71]
    v_pk_add_f32 v[36:37], v[36:37], 1.0 op_sel_hi:[1,0]
    v_exp_f32 v38, v38 clamp
    v_exp_f32 v39, v39 clamp
    v_max_f32 v32, v32, v34
    v_max_f32 v33, v33, v35
    v_min3_f32 v40, v32, v33, v40
    v_cvt_pk_bf16_f32 v28, v32, v33
    v_max_f32 v36, v36, v38
    v_max_f32 v37, v37, v39
    v_min3_f32 v40, v36, v37, v40
    v_cvt_pk_bf16_f32 v29, v36, v37
    v_lshlrev_b32 v32, 16, v22
    v_and_b32 v33, 0xffff0000, v22
    v_pk_mul_f32 v[34:35], v[32:33], s[70:71]
    v_pk_add_f32 v[32:33], v[32:33], 1.0 op_sel_hi:[1,0]
    v_exp_f32 v34, v34 clamp
    v_exp_f32 v35, v35 clamp
    v_lshlrev_b32 v36, 16, v23
    v_and_b32 v37, 0xffff0000, v23
    v_pk_mul_f32 v[38:39], v[36:37], s[70:71]
    v_pk_add_f32 v[36:37], v[36:37], 1.0 op_sel_hi:[1,0]
    v_exp_f32 v38, v38 clamp
    v_exp_f32 v39, v39 clamp
    v_max_f32 v32, v32, v34
    v_max_f32 v33, v33, v35
    v_min3_f32 v40, v32, v33, v40
    v_cvt_pk_bf16_f32 v30, v32, v33
    v_max_f32 v36, v36, v38
    v_max_f32 v37, v37, v39
    v_min3_f32 v40, v36, v37, v40
    v_cvt_pk_bf16_f32 v31, v36, v37
    v_cmp_gt_f32 vcc, 0x3a800000, v40
    s_cbranch_vccz P_qh
    v_lshlrev_b32 v32, 16, v24
    v_and_b32 v33, 0xffff0000, v24
    v_add_f32 v32, s47, v32
    v_add_f32 v33, s47, v33
    v_cvt_pk_bf16_f32 v24, v32, v33
    v_lshlrev_b32 v32, 16, v25
    v_and_b32 v33, 0xffff0000, v25
    v_add_f32 v32, s47, v32
    v_add_f32 v33, s47, v33
    v_cvt_pk_bf16_f32 v25, v32, v33
    v_lshlrev_b32 v32, 16, v26
    v_and_b32 v33, 0xffff0000, v26
    v_add_f32 v32, s47, v32
    v_add_f32 v33, s47, v33
    v_cvt_pk_bf16_f32 v26, v32, v33
    v_lshlrev_b32 v32, 16, v27
    v_and_b32 v33, 0xffff0000, v27
    v_add_f32 v32, s47, v32
    v_add_f32 v33, s47, v33
    v_cvt_pk_bf16_f32 v27, v32, v33
    v_lshlrev_b32 v32, 16, v28
    v_and_b32 v33, 0xffff0000, v28
    v_add_f32 v32, s47, v32
    v_add_f32 v33, s47, v33
    v_cvt_pk_bf16_f32 v28, v32, v33
    v_lshlrev_b32 v32, 16, v29
    v_and_b32 v33, 0xffff0000, v29
    v_add_f32 v32, s47, v32
    v_add_f32 v33, s47, v33
    v_cvt_pk_bf16_f32 v29, v32, v33
    v_lshlrev_b32 v32, 16, v30
    v_and_b32 v33, 0xffff0000, v30
    v_add_f32 v32, s47, v32
    v_add_f32 v33, s47, v33
    v_cvt_pk_bf16_f32 v30, v32, v33
    v_lshlrev_b32 v32, 16, v31
    v_and_b32 v33, 0xffff0000, v31
    v_add_f32 v32, s47, v32
    v_add_f32 v33, s47, v33
    v_cvt_pk_bf16_f32 v31, v32, v33
P_qh:
    s_lshl_b32 s66, s49, 11
    s_add_u32 s66, s66, 159744
    v_add_u32 v10, s66, v9
    s_lshl_b32 s66, s49, 6
    s_add_u32 s66, s66, 159488
    v_lshrrev_b32 v11, 4, v2
    v_lshlrev_b32 v11, 4, v11
    v_add_u32 v11, s66, v11
    s_waitcnt vmcnt(8)
    s_mov_b32 s59, 0
Q_hchk:
    v_max3_u32 v5, v80, v81, v82
    v_max3_u32 v5, v5, v83, v84
    v_max3_u32 v5, v5, v85, v86
    v_max_u32 v5, v5, v87
    v_cmp_eq_u32 vcc, -1, v5
    s_cbranch_vccz Q_hok
    s_add_u32 s59, s59, 1
    s_cmp_ge_u32 s59, 200000
    s_cbranch_scc1 Q_hok
    s_sleep 4
    buffer_load_dwordx4 v[80:83], v1, s[16:19], s62 offen sc1
    buffer_load_dwordx4 v[84:87], v1, s[16:19], s63 offen sc1
    s_waitcnt vmcnt(0)
    s_branch Q_hchk
Q_hok:
    v_permlane16_swap_b32 v80, v82
    v_permlane16_swap_b32 v81, v83
    v_permlane16_swap_b32 v84, v86
    v_permlane16_swap_b32 v85, v87
    v_add_f32 v80, v80, v82
    v_add_f32 v81, v81, v83
    v_add_f32 v84, v84, v86
    v_add_f32 v85, v85, v87
    v_and_b32 v5, 3, v2
    v_lshlrev_b32 v5, 3, v5
    v_permlane32_swap_b32 v80, v81
    v_permlane32_swap_b32 v84, v85
    v_bfe_u32 v6, v2, 4, 1
    v_lshl_add_u32 v5, v6, 2, v5
    v_add_f32 v80, v80, v81
    v_add_f32 v84, v84, v85
    v_lshrrev_b32 v6, 5, v2
    v_lshl_add_u32 v5, v6, 1, v5
    v_add_f32_dpp v80, v80, v80 row_ror:4 row_mask:0xf bank_mask:0xf
    v_add_f32_dpp v84, v84, v84 row_ror:4 row_mask:0xf bank_mask:0xf
    s_nop 0
    v_add_f32_dpp v80, v80, v80 row_ror:8 row_mask:0xf bank_mask:0xf
    v_add_f32_dpp v84, v84, v84 row_ror:8 row_mask:0xf bank_mask:0xf
    s_nop 0
    s_lshl_b32 s66, s44, 5
    s_add_u32 s66, s66, 155712
    v_cvt_pk_bf16_f32 v80, 0, v80
    v_cvt_pk_bf16_f32 v84, 0, v84
    v_mul_f32 v81, s46, v80
    v_exp_f32 v81, -v81
    v_add_u32 v5, s66, v5
    v_add_f32 v81, 1.0, v81
    v_rcp_f32 v81, v81
    v_lshlrev_b32 v6, 4, v6
    v_mul_f32 v81, v81, v80
    v_cvt_pk_bf16_f32 v81, 0, v81
    v_add_u32 v6, s66, v6
    v_mul_f32 v81, v81, v84
    v_cvt_pk_bf16_f32 v81, v81, v81
    ds_write_b16 v5, v81
    ds_read_b128 v[84:87], v6
    v_mov_b32 v64, 0
    v_mov_b32 v65, 0
    v_mov_b32 v66, 0
    v_mov_b32 v67, 0
    v_mov_b32 v68, 0
    v_mov_b32 v69, 0
    v_mov_b32 v70, 0
    v_mov_b32 v71, 0
    s_waitcnt lgkmcnt(0)
    v_and_b32 v72, 0xffff, v84
    v_lshlrev_b32 v73, 16, v84
    v_dot2_f32_bf16 v64, v96, v72, v64
    v_dot2_f32_bf16 v65, v96, v73, v65
    v_dot2_f32_bf16 v66, v97, v72, v66
    v_dot2_f32_bf16 v67, v97, v73, v67
    v_dot2_f32_bf16 v68, v98, v72, v68
    v_dot2_f32_bf16 v69, v98, v73, v69
    v_dot2_f32_bf16 v70, v99, v72, v70
    v_dot2_f32_bf16 v71, v99, v73, v71
    v_lshrrev_b32 v72, 16, v84
    v_and_b32 v73, 0xffff0000, v84
    v_dot2_f32_bf16 v64, v100, v72, v64
    v_dot2_f32_bf16 v65, v100, v73, v65
    v_dot2_f32_bf16 v66, v101, v72, v66
    v_dot2_f32_bf16 v67, v101, v73, v67
    v_dot2_f32_bf16 v68, v102, v72, v68
    v_dot2_f32_bf16 v69, v102, v73, v69
    v_dot2_f32_bf16 v70, v103, v72, v70
    v_dot2_f32_bf16 v71, v103, v73, v71
    v_and_b32 v72, 0xffff, v85
    v_lshlrev_b32 v73, 16, v85
    v_dot2_f32_bf16 v64, v104, v72, v64
    v_dot2_f32_bf16 v65, v104, v73, v65
    v_dot2_f32_bf16 v66, v105, v72, v66
    v_dot2_f32_bf16 v67, v105, v73, v67
    v_dot2_f32_bf16 v68, v106, v72, v68
    v_dot2_f32_bf16 v69, v106, v73, v69
    v_dot2_f32_bf16 v70, v107, v72, v70
    v_dot2_f32_bf16 v71, v107, v73, v71
    v_lshrrev_b32 v72, 16, v85
    v_and_b32 v73, 0xffff0000, v85
    v_dot2_f32_bf16 v64, v108, v72, v64
    v_dot2_f32_bf16 v65, v108, v73, v65
    v_dot2_f32_bf16 v66, v109, v72, v66
    v_dot2_f32_bf16 v67, v109, v73, v67
    v_dot2_f32_bf16 v68, v110, v72, v68
    v_dot2_f32_bf16 v69, v110, v73, v69
    v_dot2_f32_bf16 v70, v111, v72, v70
    v_dot2_f32_bf16 v71, v111, v73, v71
    v_and_b32 v72, 0xffff, v86
    v_lshlrev_b32 v73, 16, v86
    v_dot2_f32_bf16 v64, v112, v72, v64
    v_dot2_f32_bf16 v65, v112, v73, v65
    v_dot2_f32_bf16 v66, v113, v72, v66
    v_dot2_f32_bf16 v67, v113, v73, v67
    v_dot2_f32_bf16 v68, v114, v72, v68
    v_dot2_f32_bf16 v69, v114, v73, v69
    v_dot2_f32_bf16 v70, v115, v72, v70
    v_dot2_f32_bf16 v71, v115, v73, v71
    v_lshrrev_b32 v72, 16, v86
    v_and_b32 v73, 0xffff0000, v86
    v_dot2_f32_bf16 v64, v116, v72, v64
    v_dot2_f32_bf16 v65, v116, v73, v65
    v_dot2_f32_bf16 v66, v117, v72, v66
    v_dot2_f32_bf16 v67, v117, v73, v67
    v_dot2_f32_bf16 v68, v118, v72, v68
    v_dot2_f32_bf16 v69, v118, v73, v69
    v_dot2_f32_bf16 v70, v119, v72, v70
    v_dot2_f32_bf16 v71, v119, v73, v71
    v_and_b32 v72, 0xffff, v87
    v_lshlrev_b32 v73, 16, v87
    v_dot2_f32_bf16 v64, v120, v72, v64
    v_dot2_f32_bf16 v65, v120, v73, v65
    v_dot2_f32_bf16 v66, v121, v72, v66
    v_dot2_f32_bf16 v67, v121, v73, v67
    v_dot2_f32_bf16 v68, v122, v72, v68
    v_dot2_f32_bf16 v69, v122, v73, v69
    v_dot2_f32_bf16 v70, v123, v72, v70
    v_dot2_f32_bf16 v71, v123, v73, v71
    v_lshrrev_b32 v72, 16, v87
    v_and_b32 v73, 0xffff0000, v87
    v_dot2_f32_bf16 v64, v124, v72, v64
    v_dot2_f32_bf16 v65, v124, v73, v65
    v_dot2_f32_bf16 v66, v125, v72, v66
    v_dot2_f32_bf16 v67, v125, v73, v67
    v_dot2_f32_bf16 v68, v126, v72, v68
    v_dot2_f32_bf16 v69, v126, v73, v69
    v_dot2_f32_bf16 v70, v127, v72, v70
    v_dot2_f32_bf16 v71, v127, v73, v71
    v_and_b32 v76, 31, v2
    v_lshrrev_b32 v77, 5, v2
    v_lshl_add_u32 v76, v76, 1, v77
    v_permlane32_swap_b32 v64, v68
    v_permlane32_swap_b32 v65, v69
    v_permlane32_swap_b32 v66, v70
    v_permlane32_swap_b32 v67, v71
    v_lshlrev_b32 v76, 4, v76
    v_add_f32 v64, v64, v68
    v_add_f32 v65, v65, v69
    v_add_f32 v66, v66, v70
    v_add_f32 v67, v67, v71
    s_add_u32 s66, s72, 147456
    v_add_u32 v76, s66, v76
    ds_write_b128 v76, v[64:67]
    s_lshl_b32 s66, s6, 6
    s_add_u32 s66, s66, 5242880
    v_lshlrev_b32 v15, 10, v2
    v_add_u32 v15, s66, v15
    s_cmp_lg_u32 s44, 0
    s_cbranch_scc1 H_pd
    s_mov_b32 s59, 0
H_pl:
    buffer_load_dword v14, v15, s[16:19], 0 offen sc1
    s_waitcnt vmcnt(0)
    v_cmp_eq_u32 vcc, -1, v14
    s_cbranch_vccz H_pd
    s_add_u32 s59, s59, 1
    s_cmp_ge_u32 s59, 200000
    s_cbranch_scc1 H_pd
    s_sleep 2
    s_branch H_pl
H_pd:
POST:
    s_waitcnt lgkmcnt(0)
    s_barrier
    s_mov_b32 s66, 6094848
    buffer_load_dword v152, v93, s[16:19], s66 offen sc1
    ds_read_b128 v[40:43], v11
    ds_read_b128 v[32:35], v10
    ds_read_b128 v[36:39], v10 offset:1024
    v_mov_b32 v3, 155684
    ds_read_b32 v4, v3
    s_waitcnt lgkmcnt(3)
    v_mfma_f32_16x16x32_bf16 v[60:63], v[40:43], v[24:27], 0
    v_mfma_f32_16x16x32_bf16 v[64:67], v[40:43], v[28:31], 0
    s_waitcnt lgkmcnt(1)
    v_mfma_f32_16x16x32_bf16 v[44:47], v[32:35], v[24:27], 0
    v_mfma_f32_16x16x32_bf16 v[48:51], v[36:39], v[24:27], 0
    v_mfma_f32_16x16x32_bf16 v[52:55], v[32:35], v[28:31], 0
    v_mfma_f32_16x16x32_bf16 v[56:59], v[36:39], v[28:31], 0
    s_nop 3
    v_cvt_pk_bf16_f32 v60, 0, v60
    v_cvt_pk_bf16_f32 v64, 0, v64
    v_add_f32 v60, s47, v60
    v_add_f32 v64, s47, v64
    v_cvt_pk_bf16_f32 v60, 0, v60
    v_cvt_pk_bf16_f32 v64, 0, v64
    v_rcp_f32 v60, v60
    v_rcp_f32 v64, v64
    v_cvt_pk_bf16_f32 v44, 0, v44
    v_cvt_pk_bf16_f32 v45, 0, v45
    v_cvt_pk_bf16_f32 v46, 0, v46
    v_cvt_pk_bf16_f32 v47, 0, v47
    v_cvt_pk_bf16_f32 v48, 0, v48
    v_cvt_pk_bf16_f32 v49, 0, v49
    v_cvt_pk_bf16_f32 v50, 0, v50
    v_cvt_pk_bf16_f32 v51, 0, v51
    v_pk_mul_f32 v[44:45], v[44:45], v[60:61] op_sel_hi:[1,0]
    v_pk_mul_f32 v[46:47], v[46:47], v[60:61] op_sel_hi:[1,0]
    v_pk_mul_f32 v[48:49], v[48:49], v[60:61] op_sel_hi:[1,0]
    v_pk_mul_f32 v[50:51], v[50:51], v[60:61] op_sel_hi:[1,0]
    v_cvt_pk_bf16_f32 v32, v44, v45
    v_cvt_pk_bf16_f32 v33, v46, v47
    v_cvt_pk_bf16_f32 v34, v48, v49
    v_cvt_pk_bf16_f32 v35, v50, v51
    buffer_store_dwordx4 v[32:35], v9, s[16:19], s60 offen sc0 sc1
    v_cvt_pk_bf16_f32 v52, 0, v52
    v_cvt_pk_bf16_f32 v53, 0, v53
    v_cvt_pk_bf16_f32 v54, 0, v54
    v_cvt_pk_bf16_f32 v55, 0, v55
    v_cvt_pk_bf16_f32 v56, 0, v56
    v_cvt_pk_bf16_f32 v57, 0, v57
    v_cvt_pk_bf16_f32 v58, 0, v58
    v_cvt_pk_bf16_f32 v59, 0, v59
    v_pk_mul_f32 v[52:53], v[52:53], v[64:65] op_sel_hi:[1,0]
    v_pk_mul_f32 v[54:55], v[54:55], v[64:65] op_sel_hi:[1,0]
    v_pk_mul_f32 v[56:57], v[56:57], v[64:65] op_sel_hi:[1,0]
    v_pk_mul_f32 v[58:59], v[58:59], v[64:65] op_sel_hi:[1,0]
    v_cvt_pk_bf16_f32 v36, v52, v53
    v_cvt_pk_bf16_f32 v37, v54, v55
    v_cvt_pk_bf16_f32 v38, v56, v57
    v_cvt_pk_bf16_f32 v39, v58, v59
    buffer_store_dwordx4 v[36:39], v9, s[16:19], s61 offen sc0 sc1
    s_waitcnt lgkmcnt(0)
    v_readfirstlane_b32 s74, v4
    s_waitcnt vmcnt(3)
    s_barrier
    s_lshl_b32 s53, s45, 12
    s_add_u32 s53, s53, s72
    s_lshl_b32 s54, s45, 16
    s_add_u32 s67, s52, 1048576
    s_and_b32 s67, s67, 0x1fffff
    s_add_u32 m0, s53, 8192
    s_add_u32 s67, s67, s54
    s_add_u32 s67, s67, 0
    buffer_load_dwordx4 v90, s[20:23], s67 offen lds
    s_add_u32 s67, s52, 1048576
    s_and_b32 s67, s67, 0x1fffff
    s_add_u32 m0, s53, 65536
    s_add_u32 s67, s67, s54
    s_add_u32 s67, s67, 131072
    buffer_load_dwordx4 v90, s[20:23], s67 offen lds
    s_add_u32 s67, s52, 1310720
    s_and_b32 s67, s67, 0x1fffff
    s_add_u32 m0, s53, 16384
    s_add_u32 s67, s67, s54
    s_add_u32 s67, s67, 0
    buffer_load_dwordx4 v90, s[20:23], s67 offen lds
    s_add_u32 s67, s52, 1310720
    s_and_b32 s67, s67, 0x1fffff
    s_add_u32 m0, s53, 73728
    s_add_u32 s67, s67, s54
    s_add_u32 s67, s67, 131072
    buffer_load_dwordx4 v90, s[20:23], s67 offen lds
    s_add_u32 s67, s52, 1572864
    s_and_b32 s67, s67, 0x1fffff
    s_add_u32 m0, s53, 98304
    s_add_u32 s67, s67, s54
    s_add_u32 s67, s67, 0
    buffer_load_dwordx4 v90, s[20:23], s67 offen lds
    s_add_u32 s67, s52, 1572864
    s_and_b32 s67, s67, 0x1fffff
    s_add_u32 m0, s53, 114688
    s_add_u32 s67, s67, s54
    s_add_u32 s67, s67, 131072
    buffer_load_dwordx4 v90, s[20:23], s67 offen lds
    s_add_u32 s67, s52, 1835008
    s_and_b32 s67, s67, 0x1fffff
    s_add_u32 m0, s53, 106496
    s_add_u32 s67, s67, s54
    s_add_u32 s67, s67, 0
    buffer_load_dwordx4 v90, s[20:23], s67 offen lds
    s_add_u32 s67, s52, 1835008
    s_and_b32 s67, s67, 0x1fffff
    s_add_u32 m0, s53, 122880
    s_add_u32 s67, s67, s54
    s_add_u32 s67, s67, 131072
    buffer_load_dwordx4 v90, s[20:23], s67 offen lds
    s_cmp_eq_u32 s45, 0
    s_cbranch_scc0 Q_hg
    s_branch Q_hd
Q_hg:
    s_waitcnt lgkmcnt(0)
Q_hd:
    s_and_b32 s75, s74, 0x7ff
    s_sub_u32 s75, 2047, s75
    s_lshl_b32 s66, s6, 3
    s_lshl_b32 s67, s44, 1
    s_add_u32 s66, s66, s67
    s_lshl_b32 s66, s66, 15
    s_lshl_b32 s67, s45, 11
    s_add_u32 s66, s66, s67
    s_lshl_b32 s67, s45, 15
    s_add_u32 s66, s66, s67
    v_add_u32 v4, s66, v9
    v_xor_b32 v3, 32768, v4
    s_lshr_b32 s63, s52, 6
    v_lshrrev_b32 v5, 4, v2
    v_bfe_u32 v6, v2, 2, 2
    v_lshl_add_u32 v8, v5, 2, v6
    v_bfe_u32 v6, v8, 1, 2
    v_lshlrev_b32 v8, 7, v8
    v_and_b32 v5, 3, v2
    v_lshl_add_u32 v8, v5, 3, v8
    s_mul_i32 s66, s45, 16384
    s_add_u32 s66, s66, 24576
    s_mul_i32 s67, s45, 8192
    s_add_u32 s67, s67, 81920
    s_mul_i32 s68, s45, 57344
    s_add_u32 s68, s68, 0
    s_mul_i32 s69, s45, 16384
    s_add_u32 s69, s69, 98304
    v_xor_b32 v5, 0, v6
    v_lshl_add_u32 v5, v5, 5, v8
    v_add_u32 v160, s66, v5
    v_add_u32 v164, s67, v5
    v_add_u32 v168, s68, v5
    v_add_u32 v172, s69, v5
    v_xor_b32 v5, 1, v6
    v_lshl_add_u32 v5, v5, 5, v8
    v_add_u32 v161, s66, v5
    v_add_u32 v165, s67, v5
    v_add_u32 v169, s68, v5
    v_add_u32 v173, s69, v5
    v_xor_b32 v5, 2, v6
    v_lshl_add_u32 v5, v5, 5, v8
    v_add_u32 v162, s66, v5
    v_add_u32 v166, s67, v5
    v_add_u32 v170, s68, v5
    v_add_u32 v174, s69, v5
    v_xor_b32 v5, 3, v6
    v_lshl_add_u32 v5, v5, 5, v8
    v_add_u32 v163, s66, v5
    v_add_u32 v167, s67, v5
    v_add_u32 v171, s68, v5
    v_add_u32 v175, s69, v5
    s_lshr_b32 s66, s75, 7
    s_cmp_eq_u32 s66, s6
    s_cselect_b32 s51, 1, 0
    s_barrier
    s_add_u32 s66, s63, 0
    s_and_b32 s66, s66, 32767
    buffer_load_dwordx4 v[96:99], v3, s[16:19], s66 offen offset:0 sc1
    buffer_load_dwordx4 v[100:103], v4, s[16:19], s66 offen offset:0 sc1
    buffer_load_dwordx4 v[104:107], v3, s[16:19], s66 offen offset:1024 sc1
    buffer_load_dwordx4 v[108:111], v4, s[16:19], s66 offen offset:1024 sc1
    s_cmp_eq_u32 s45, 0
    s_cbranch_scc1 Q_ny4
    s_lshl_b32 s66, s44, 8
    s_add_u32 s66, s66, 147456
    v_lshlrev_b32 v5, 2, v2
    v_add_u32 v6, s66, v5
    ds_read_b32 v64, v6 offset:0
    ds_read_b32 v65, v6 offset:1024
    ds_read_b32 v66, v6 offset:2048
    ds_read_b32 v67, v6 offset:3072
    s_waitcnt lgkmcnt(0)
    v_add_f32 v64, v64, v65
    v_add_f32 v66, v66, v67
    v_add_f32 v64, v64, v66
    buffer_store_dword v64, v5, s[16:19], s55 offen sc0 sc1
Q_ny4:
    s_add_u32 s66, s63, 4096
    s_and_b32 s66, s66, 32767
    buffer_load_dwordx4 v[112:115], v3, s[16:19], s66 offen offset:0 sc1
    buffer_load_dwordx4 v[116:119], v4, s[16:19], s66 offen offset:0 sc1
    buffer_load_dwordx4 v[120:123], v3, s[16:19], s66 offen offset:1024 sc1
    buffer_load_dwordx4 v[124:127], v4, s[16:19], s66 offen offset:1024 sc1
    ds_read_b64_tr_b16 v[192:193], v160 offset:0
    ds_read_b64_tr_b16 v[194:195], v160 offset:2048
    ds_read_b64_tr_b16 v[196:197], v161 offset:0
    ds_read_b64_tr_b16 v[198:199], v161 offset:2048
    ds_read_b64_tr_b16 v[200:201], v162 offset:0
    ds_read_b64_tr_b16 v[202:203], v162 offset:2048
    ds_read_b64_tr_b16 v[204:205], v163 offset:0
    ds_read_b64_tr_b16 v[206:207], v163 offset:2048
    s_waitcnt vmcnt(4)
    v_max3_u32 v5, v96, v97, v98
    v_max3_u32 v5, v5, v99, v100
    v_max3_u32 v5, v5, v101, v102
    v_max3_u32 v5, v5, v103, v104
    v_max3_u32 v5, v5, v105, v106
    v_max3_u32 v5, v5, v107, v108
    v_max3_u32 v5, v5, v109, v110
    v_max_u32 v5, v5, v111
    v_cmp_eq_u32 vcc, -1, v5
    s_cbranch_vccnz Q_rt0
Q_go0:
    s_add_u32 s66, s63, 8192
    s_and_b32 s66, s66, 32767
    s_waitcnt lgkmcnt(6)
    v_mfma_f32_16x16x32_bf16 v[224:227], v[192:195], v[96:99], 0
    buffer_load_dwordx4 v[128:131], v3, s[16:19], s66 offen offset:0 sc1
    v_mfma_f32_16x16x32_bf16 v[240:243], v[192:195], v[100:103], 0
    ds_read_b64_tr_b16 v[208:209], v160 offset:4096
    s_waitcnt lgkmcnt(5)
    v_mfma_f32_16x16x32_bf16 v[228:231], v[196:199], v[96:99], 0
    ds_read_b64_tr_b16 v[210:211], v160 offset:6144
    buffer_load_dwordx4 v[132:135], v4, s[16:19], s66 offen offset:0 sc1
    v_mfma_f32_16x16x32_bf16 v[244:247], v[196:199], v[100:103], 0
    ds_read_b64_tr_b16 v[212:213], v161 offset:4096
    s_waitcnt lgkmcnt(5)
    v_mfma_f32_16x16x32_bf16 v[232:235], v[200:203], v[96:99], 0
    ds_read_b64_tr_b16 v[214:215], v161 offset:6144
    buffer_load_dwordx4 v[136:139], v3, s[16:19], s66 offen offset:1024 sc1
    v_mfma_f32_16x16x32_bf16 v[248:251], v[200:203], v[100:103], 0
    ds_read_b64_tr_b16 v[216:217], v162 offset:4096
    s_waitcnt lgkmcnt(5)
    v_mfma_f32_16x16x32_bf16 v[236:239], v[204:207], v[96:99], 0
    ds_read_b64_tr_b16 v[218:219], v162 offset:6144
    buffer_load_dwordx4 v[140:143], v4, s[16:19], s66 offen offset:1024 sc1
    v_mfma_f32_16x16x32_bf16 v[252:255], v[204:207], v[100:103], 0
    ds_read_b64_tr_b16 v[220:221], v163 offset:4096
    ds_read_b64_tr_b16 v[222:223], v163 offset:6144
    s_waitcnt lgkmcnt(6)
    v_mfma_f32_16x16x32_bf16 v[224:227], v[208:211], v[104:107], v[224:227]
    v_mfma_f32_16x16x32_bf16 v[240:243], v[208:211], v[108:111], v[240:243]
    ds_read_b64_tr_b16 v[192:193], v160 offset:8192
    s_waitcnt lgkmcnt(5)
    v_mfma_f32_16x16x32_bf16 v[228:231], v[212:215], v[104:107], v[228:231]
    s_waitcnt vmcnt(4)
    ds_read_b64_tr_b16 v[194:195], v160 offset:10240
    v_max3_u32 v5, v112, v113, v114
    v_mfma_f32_16x16x32_bf16 v[244:247], v[212:215], v[108:111], v[244:247]
    ds_read_b64_tr_b16 v[196:197], v161 offset:8192
    v_max3_u32 v5, v5, v115, v116
    s_waitcnt lgkmcnt(5)
    v_mfma_f32_16x16x32_bf16 v[232:235], v[216:219], v[104:107], v[232:235]
    ds_read_b64_tr_b16 v[198:199], v161 offset:10240
    v_max3_u32 v5, v5, v117, v118
    v_mfma_f32_16x16x32_bf16 v[248:251], v[216:219], v[108:111], v[248:251]
    ds_read_b64_tr_b16 v[200:201], v162 offset:8192
    v_max3_u32 v5, v5, v119, v120
    v_max3_u32 v5, v5, v121, v122
    s_waitcnt lgkmcnt(5)
    v_mfma_f32_16x16x32_bf16 v[236:239], v[220:223], v[104:107], v[236:239]
    ds_read_b64_tr_b16 v[202:203], v162 offset:10240
    v_max3_u32 v5, v5, v123, v124
    v_max3_u32 v5, v5, v125, v126
    v_mfma_f32_16x16x32_bf16 v[252:255], v[220:223], v[108:111], v[252:255]
    ds_read_b64_tr_b16 v[204:205], v163 offset:8192
    ds_read_b64_tr_b16 v[206:207], v163 offset:10240
    v_max_u32 v5, v5, v127
    v_cmp_eq_u32 vcc, -1, v5
    s_cbranch_vccnz Q_rt1
Q_go1:
    s_add_u32 s66, s63, 12288
    s_and_b32 s66, s66, 32767
    s_waitcnt lgkmcnt(6)
    v_mfma_f32_16x16x32_bf16 v[224:227], v[192:195], v[112:115], v[224:227]
    buffer_load_dwordx4 v[96:99], v3, s[16:19], s66 offen offset:0 sc1
    v_mfma_f32_16x16x32_bf16 v[240:243], v[192:195], v[116:119], v[240:243]
    ds_read_b64_tr_b16 v[208:209], v160 offset:12288
    s_waitcnt lgkmcnt(5)
    v_mfma_f32_16x16x32_bf16 v[228:231], v[196:199], v[112:115], v[228:231]
    ds_read_b64_tr_b16 v[210:211], v160 offset:14336
    buffer_load_dwordx4 v[100:103], v4, s[16:19], s66 offen offset:0 sc1
    v_mfma_f32_16x16x32_bf16 v[244:247], v[196:199], v[116:119], v[244:247]
    ds_read_b64_tr_b16 v[212:213], v161 offset:12288
    s_waitcnt lgkmcnt(5)
    v_mfma_f32_16x16x32_bf16 v[232:235], v[200:203], v[112:115], v[232:235]
    ds_read_b64_tr_b16 v[214:215], v161 offset:14336
    buffer_load_dwordx4 v[104:107], v3, s[16:19], s66 offen offset:1024 sc1
    v_mfma_f32_16x16x32_bf16 v[248:251], v[200:203], v[116:119], v[248:251]
    ds_read_b64_tr_b16 v[216:217], v162 offset:12288
    s_waitcnt lgkmcnt(5)
    v_mfma_f32_16x16x32_bf16 v[236:239], v[204:207], v[112:115], v[236:239]
    ds_read_b64_tr_b16 v[218:219], v162 offset:14336
    buffer_load_dwordx4 v[108:111], v4, s[16:19], s66 offen offset:1024 sc1
    v_mfma_f32_16x16x32_bf16 v[252:255], v[204:207], v[116:119], v[252:255]
    ds_read_b64_tr_b16 v[220:221], v163 offset:12288
    ds_read_b64_tr_b16 v[222:223], v163 offset:14336
    s_waitcnt lgkmcnt(0)
    s_barrier
    s_waitcnt lgkmcnt(6)
    v_mfma_f32_16x16x32_bf16 v[224:227], v[208:211], v[120:123], v[224:227]
    v_mfma_f32_16x16x32_bf16 v[240:243], v[208:211], v[124:127], v[240:243]
    ds_read_b64_tr_b16 v[192:193], v164 offset:0
    s_waitcnt lgkmcnt(5)
    v_mfma_f32_16x16x32_bf16 v[228:231], v[212:215], v[120:123], v[228:231]
    s_waitcnt vmcnt(4)
    ds_read_b64_tr_b16 v[194:195], v164 offset:2048
    v_max3_u32 v5, v128, v129, v130
    v_mfma_f32_16x16x32_bf16 v[244:247], v[212:215], v[124:127], v[244:247]
    ds_read_b64_tr_b16 v[196:197], v165 offset:0
    v_max3_u32 v5, v5, v131, v132
    s_waitcnt lgkmcnt(5)
    v_mfma_f32_16x16x32_bf16 v[232:235], v[216:219], v[120:123], v[232:235]
    ds_read_b64_tr_b16 v[198:199], v165 offset:2048
    v_max3_u32 v5, v5, v133, v134
    v_mfma_f32_16x16x32_bf16 v[248:251], v[216:219], v[124:127], v[248:251]
    ds_read_b64_tr_b16 v[200:201], v166 offset:0
    v_max3_u32 v5, v5, v135, v136
    v_max3_u32 v5, v5, v137, v138
    s_waitcnt lgkmcnt(5)
    v_mfma_f32_16x16x32_bf16 v[236:239], v[220:223], v[120:123], v[236:239]
    ds_read_b64_tr_b16 v[202:203], v166 offset:2048
    v_max3_u32 v5, v5, v139, v140
    v_max3_u32 v5, v5, v141, v142
    v_mfma_f32_16x16x32_bf16 v[252:255], v[220:223], v[124:127], v[252:255]
    ds_read_b64_tr_b16 v[204:205], v167 offset:0
    ds_read_b64_tr_b16 v[206:207], v167 offset:2048
    v_max_u32 v5, v5, v143
    v_cmp_eq_u32 vcc, -1, v5
    s_cbranch_vccnz Q_rt2
Q_go2:
    s_add_u32 s66, s63, 16384
    s_and_b32 s66, s66, 32767
    s_waitcnt lgkmcnt(6)
    v_mfma_f32_16x16x32_bf16 v[224:227], v[192:195], v[128:131], v[224:227]
    buffer_load_dwordx4 v[112:115], v3, s[16:19], s66 offen offset:0 sc1
    v_mfma_f32_16x16x32_bf16 v[240:243], v[192:195], v[132:135], v[240:243]
    ds_read_b64_tr_b16 v[208:209], v164 offset:4096
    s_waitcnt lgkmcnt(5)
    v_mfma_f32_16x16x32_bf16 v[228:231], v[196:199], v[128:131], v[228:231]
    ds_read_b64_tr_b16 v[210:211], v164 offset:6144
    buffer_load_dwordx4 v[116:119], v4, s[16:19], s66 offen offset:0 sc1
    v_mfma_f32_16x16x32_bf16 v[244:247], v[196:199], v[132:135], v[244:247]
    ds_read_b64_tr_b16 v[212:213], v165 offset:4096
    s_waitcnt lgkmcnt(5)
    v_mfma_f32_16x16x32_bf16 v[232:235], v[200:203], v[128:131], v[232:235]
    ds_read_b64_tr_b16 v[214:215], v165 offset:6144
    buffer_load_dwordx4 v[120:123], v3, s[16:19], s66 offen offset:1024 sc1
    v_mfma_f32_16x16x32_bf16 v[248:251], v[200:203], v[132:135], v[248:251]
    ds_read_b64_tr_b16 v[216:217], v166 offset:4096
    s_waitcnt lgkmcnt(5)
    v_mfma_f32_16x16x32_bf16 v[236:239], v[204:207], v[128:131], v[236:239]
    ds_read_b64_tr_b16 v[218:219], v166 offset:6144
    buffer_load_dwordx4 v[124:127], v4, s[16:19], s66 offen offset:1024 sc1
    v_mfma_f32_16x16x32_bf16 v[252:255], v[204:207], v[132:135], v[252:255]
    ds_read_b64_tr_b16 v[220:221], v167 offset:4096
    ds_read_b64_tr_b16 v[222:223], v167 offset:6144
    s_waitcnt lgkmcnt(6)
    v_mfma_f32_16x16x32_bf16 v[224:227], v[208:211], v[136:139], v[224:227]
    v_mfma_f32_16x16x32_bf16 v[240:243], v[208:211], v[140:143], v[240:243]
    ds_read_b64_tr_b16 v[192:193], v168 offset:0
    s_waitcnt lgkmcnt(5)
    v_mfma_f32_16x16x32_bf16 v[228:231], v[212:215], v[136:139], v[228:231]
    s_waitcnt vmcnt(4)
    ds_read_b64_tr_b16 v[194:195], v168 offset:2048
    v_max3_u32 v5, v96, v97, v98
    v_mfma_f32_16x16x32_bf16 v[244:247], v[212:215], v[140:143], v[244:247]
    ds_read_b64_tr_b16 v[196:197], v169 offset:0
    v_max3_u32 v5, v5, v99, v100
    s_waitcnt lgkmcnt(5)
    v_mfma_f32_16x16x32_bf16 v[232:235], v[216:219], v[136:139], v[232:235]
    ds_read_b64_tr_b16 v[198:199], v169 offset:2048
    v_max3_u32 v5, v5, v101, v102
    v_mfma_f32_16x16x32_bf16 v[248:251], v[216:219], v[140:143], v[248:251]
    ds_read_b64_tr_b16 v[200:201], v170 offset:0
    v_max3_u32 v5, v5, v103, v104
    v_max3_u32 v5, v5, v105, v106
    s_waitcnt lgkmcnt(5)
    v_mfma_f32_16x16x32_bf16 v[236:239], v[220:223], v[136:139], v[236:239]
    ds_read_b64_tr_b16 v[202:203], v170 offset:2048
    v_max3_u32 v5, v5, v107, v108
    v_max3_u32 v5, v5, v109, v110
    v_mfma_f32_16x16x32_bf16 v[252:255], v[220:223], v[140:143], v[252:255]
    ds_read_b64_tr_b16 v[204:205], v171 offset:0
    ds_read_b64_tr_b16 v[206:207], v171 offset:2048
    v_max_u32 v5, v5, v111
    v_cmp_eq_u32 vcc, -1, v5
    s_cbranch_vccnz Q_rt3
Q_go3:
    s_add_u32 s66, s63, 20480
    s_and_b32 s66, s66, 32767
    s_waitcnt lgkmcnt(6)
    v_mfma_f32_16x16x32_bf16 v[224:227], v[192:195], v[96:99], v[224:227]
    buffer_load_dwordx4 v[128:131], v3, s[16:19], s66 offen offset:0 sc1
    v_mfma_f32_16x16x32_bf16 v[240:243], v[192:195], v[100:103], v[240:243]
    ds_read_b64_tr_b16 v[208:209], v168 offset:4096
    s_waitcnt lgkmcnt(5)
    v_mfma_f32_16x16x32_bf16 v[228:231], v[196:199], v[96:99], v[228:231]
    ds_read_b64_tr_b16 v[210:211], v168 offset:6144
    buffer_load_dwordx4 v[132:135], v4, s[16:19], s66 offen offset:0 sc1
    v_mfma_f32_16x16x32_bf16 v[244:247], v[196:199], v[100:103], v[244:247]
    ds_read_b64_tr_b16 v[212:213], v169 offset:4096
    s_waitcnt lgkmcnt(5)
    v_mfma_f32_16x16x32_bf16 v[232:235], v[200:203], v[96:99], v[232:235]
    ds_read_b64_tr_b16 v[214:215], v169 offset:6144
    buffer_load_dwordx4 v[136:139], v3, s[16:19], s66 offen offset:1024 sc1
    v_mfma_f32_16x16x32_bf16 v[248:251], v[200:203], v[100:103], v[248:251]
    ds_read_b64_tr_b16 v[216:217], v170 offset:4096
    s_waitcnt lgkmcnt(5)
    v_mfma_f32_16x16x32_bf16 v[236:239], v[204:207], v[96:99], v[236:239]
    ds_read_b64_tr_b16 v[218:219], v170 offset:6144
    buffer_load_dwordx4 v[140:143], v4, s[16:19], s66 offen offset:1024 sc1
    v_mfma_f32_16x16x32_bf16 v[252:255], v[204:207], v[100:103], v[252:255]
    ds_read_b64_tr_b16 v[220:221], v171 offset:4096
    ds_read_b64_tr_b16 v[222:223], v171 offset:6144
    s_waitcnt lgkmcnt(6)
    v_mfma_f32_16x16x32_bf16 v[224:227], v[208:211], v[104:107], v[224:227]
    v_mfma_f32_16x16x32_bf16 v[240:243], v[208:211], v[108:111], v[240:243]
    ds_read_b64_tr_b16 v[192:193], v168 offset:8192
    s_waitcnt lgkmcnt(5)
    v_mfma_f32_16x16x32_bf16 v[228:231], v[212:215], v[104:107], v[228:231]
    s_waitcnt vmcnt(4)
    ds_read_b64_tr_b16 v[194:195], v168 offset:10240
    v_max3_u32 v5, v112, v113, v114
    v_mfma_f32_16x16x32_bf16 v[244:247], v[212:215], v[108:111], v[244:247]
    ds_read_b64_tr_b16 v[196:197], v169 offset:8192
    v_max3_u32 v5, v5, v115, v116
    s_waitcnt lgkmcnt(5)
    v_mfma_f32_16x16x32_bf16 v[232:235], v[216:219], v[104:107], v[232:235]
    ds_read_b64_tr_b16 v[198:199], v169 offset:10240
    v_max3_u32 v5, v5, v117, v118
    v_mfma_f32_16x16x32_bf16 v[248:251], v[216:219], v[108:111], v[248:251]
    ds_read_b64_tr_b16 v[200:201], v170 offset:8192
    v_max3_u32 v5, v5, v119, v120
    v_max3_u32 v5, v5, v121, v122
    s_waitcnt lgkmcnt(5)
    v_mfma_f32_16x16x32_bf16 v[236:239], v[220:223], v[104:107], v[236:239]
    ds_read_b64_tr_b16 v[202:203], v170 offset:10240
    v_max3_u32 v5, v5, v123, v124
    v_max3_u32 v5, v5, v125, v126
    v_mfma_f32_16x16x32_bf16 v[252:255], v[220:223], v[108:111], v[252:255]
    ds_read_b64_tr_b16 v[204:205], v171 offset:8192
    ds_read_b64_tr_b16 v[206:207], v171 offset:10240
    v_max_u32 v5, v5, v127
    v_cmp_eq_u32 vcc, -1, v5
    s_cbranch_vccnz Q_rt4
Q_go4:
    s_cmp_eq_u32 s51, 0
    s_cbranch_scc1 Q_ny0
    s_lshl_b32 s64, s7, 14
    s_lshl_b32 s66, s3, 11
    s_add_u32 s64, s64, s66
    s_add_u32 s64, s64, 5832704
    buffer_load_dwordx4 v[32:35], v9, s[16:19], s64 offen offset:0 sc1
    buffer_load_dwordx4 v[36:39], v9, s[16:19], s64 offen offset:1024 sc1
Q_ny0:
    s_add_u32 s66, s63, 24576
    s_and_b32 s66, s66, 32767
    s_waitcnt lgkmcnt(6)
    v_mfma_f32_16x16x32_bf16 v[224:227], v[192:195], v[112:115], v[224:227]
    buffer_load_dwordx4 v[96:99], v3, s[16:19], s66 offen offset:0 sc1
    v_mfma_f32_16x16x32_bf16 v[240:243], v[192:195], v[116:119], v[240:243]
    ds_read_b64_tr_b16 v[208:209], v168 offset:12288
    s_waitcnt lgkmcnt(5)
    v_mfma_f32_16x16x32_bf16 v[228:231], v[196:199], v[112:115], v[228:231]
    ds_read_b64_tr_b16 v[210:211], v168 offset:14336
    buffer_load_dwordx4 v[100:103], v4, s[16:19], s66 offen offset:0 sc1
    v_mfma_f32_16x16x32_bf16 v[244:247], v[196:199], v[116:119], v[244:247]
    ds_read_b64_tr_b16 v[212:213], v169 offset:12288
    s_waitcnt lgkmcnt(5)
    v_mfma_f32_16x16x32_bf16 v[232:235], v[200:203], v[112:115], v[232:235]
    ds_read_b64_tr_b16 v[214:215], v169 offset:14336
    buffer_load_dwordx4 v[104:107], v3, s[16:19], s66 offen offset:1024 sc1
    v_mfma_f32_16x16x32_bf16 v[248:251], v[200:203], v[116:119], v[248:251]
    ds_read_b64_tr_b16 v[216:217], v170 offset:12288
    s_waitcnt lgkmcnt(5)
    v_mfma_f32_16x16x32_bf16 v[236:239], v[204:207], v[112:115], v[236:239]
    ds_read_b64_tr_b16 v[218:219], v170 offset:14336
    buffer_load_dwordx4 v[108:111], v4, s[16:19], s66 offen offset:1024 sc1
    v_mfma_f32_16x16x32_bf16 v[252:255], v[204:207], v[116:119], v[252:255]
    ds_read_b64_tr_b16 v[220:221], v171 offset:12288
    ds_read_b64_tr_b16 v[222:223], v171 offset:14336
    s_waitcnt lgkmcnt(6)
    v_mfma_f32_16x16x32_bf16 v[224:227], v[208:211], v[120:123], v[224:227]
    v_mfma_f32_16x16x32_bf16 v[240:243], v[208:211], v[124:127], v[240:243]
    ds_read_b64_tr_b16 v[192:193], v168 offset:16384
    s_waitcnt lgkmcnt(5)
    v_mfma_f32_16x16x32_bf16 v[228:231], v[212:215], v[120:123], v[228:231]
    s_waitcnt vmcnt(4)
    ds_read_b64_tr_b16 v[194:195], v168 offset:18432
    v_max3_u32 v5, v128, v129, v130
    v_mfma_f32_16x16x32_bf16 v[244:247], v[212:215], v[124:127], v[244:247]
    ds_read_b64_tr_b16 v[196:197], v169 offset:16384
    v_max3_u32 v5, v5, v131, v132
    s_waitcnt lgkmcnt(5)
    v_mfma_f32_16x16x32_bf16 v[232:235], v[216:219], v[120:123], v[232:235]
    ds_read_b64_tr_b16 v[198:199], v169 offset:18432
    v_max3_u32 v5, v5, v133, v134
    v_mfma_f32_16x16x32_bf16 v[248:251], v[216:219], v[124:127], v[248:251]
    ds_read_b64_tr_b16 v[200:201], v170 offset:16384
    v_max3_u32 v5, v5, v135, v136
    v_max3_u32 v5, v5, v137, v138
    s_waitcnt lgkmcnt(5)
    v_mfma_f32_16x16x32_bf16 v[236:239], v[220:223], v[120:123], v[236:239]
    ds_read_b64_tr_b16 v[202:203], v170 offset:18432
    v_max3_u32 v5, v5, v139, v140
    v_max3_u32 v5, v5, v141, v142
    v_mfma_f32_16x16x32_bf16 v[252:255], v[220:223], v[124:127], v[252:255]
    ds_read_b64_tr_b16 v[204:205], v171 offset:16384
    ds_read_b64_tr_b16 v[206:207], v171 offset:18432
    v_max_u32 v5, v5, v143
    v_cmp_eq_u32 vcc, -1, v5
    s_cbranch_vccnz Q_rt5
Q_go5:
    s_cmp_eq_u32 s45, 0
    s_cbranch_scc1 Q_np2
    s_setprio 1
Q_np2:
    s_cmp_eq_u32 s51, 0
    s_cbranch_scc1 Q_ny1
    s_mov_b32 s59, 0
Q_ychk:
    s_waitcnt vmcnt(0)
    v_max3_u32 v5, v32, v33, v34
    v_max3_u32 v5, v5, v35, v36
    v_max3_u32 v5, v5, v37, v38
    v_max_u32 v5, v5, v39
    v_cmp_eq_u32 vcc, -1, v5
    s_cbranch_vccz Q_yok
    s_add_u32 s59, s59, 1
    s_cmp_ge_u32 s59, 200000
    s_cbranch_scc1 Q_yok
    s_sleep 4
    buffer_load_dwordx4 v[32:35], v9, s[16:19], s64 offen offset:0 sc1
    buffer_load_dwordx4 v[36:39], v9, s[16:19], s64 offen offset:1024 sc1
    s_branch Q_ychk
Q_yok:
    v_add_f32 v32, v32, v36
    v_add_f32 v33, v33, v37
    v_add_f32 v34, v34, v38
    v_add_f32 v35, v35, v39
    s_nop 1
    v_permlane16_swap_b32 v32, v34
    v_permlane16_swap_b32 v33, v35
    v_add_f32 v32, v32, v34
    v_add_f32 v33, v33, v35
    v_and_b32 v5, 15, v2
    v_lshlrev_b32 v5, 4, v5
    v_permlane32_swap_b32 v32, v33
    v_bfe_u32 v8, v2, 4, 1
    v_lshl_add_u32 v5, v8, 3, v5
    v_lshrrev_b32 v8, 5, v2
    v_lshl_add_u32 v5, v8, 2, v5
    v_add_f32 v32, v32, v33
    s_lshl_b32 s66, s3, 8
    s_add_u32 s66, s66, 156992
    v_add_u32 v5, s66, v5
    ds_write_b32 v5, v32
    v_mov_b32 v5, 155688
    v_mov_b32 v8, 1
    s_mov_b64 exec, 1
    ds_add_u32 v5, v8
    s_mov_b64 exec, -1
    s_waitcnt lgkmcnt(0)
Q_ny1:
    s_add_u32 s66, s63, 28672
    s_and_b32 s66, s66, 32767
    s_waitcnt lgkmcnt(6)
    v_mfma_f32_16x16x32_bf16 v[224:227], v[192:195], v[128:131], v[224:227]
    buffer_load_dwordx4 v[112:115], v3, s[16:19], s66 offen offset:0 sc1
    v_mfma_f32_16x16x32_bf16 v[240:243], v[192:195], v[132:135], v[240:243]
    ds_read_b64_tr_b16 v[208:209], v168 offset:20480
    s_waitcnt lgkmcnt(5)
    v_mfma_f32_16x16x32_bf16 v[228:231], v[196:199], v[128:131], v[228:231]
    ds_read_b64_tr_b16 v[210:211], v168 offset:22528
    buffer_load_dwordx4 v[116:119], v4, s[16:19], s66 offen offset:0 sc1
    v_mfma_f32_16x16x32_bf16 v[244:247], v[196:199], v[132:135], v[244:247]
    ds_read_b64_tr_b16 v[212:213], v169 offset:20480
    s_waitcnt lgkmcnt(5)
    v_mfma_f32_16x16x32_bf16 v[232:235], v[200:203], v[128:131], v[232:235]
    ds_read_b64_tr_b16 v[214:215], v169 offset:22528
    buffer_load_dwordx4 v[120:123], v3, s[16:19], s66 offen offset:1024 sc1
    v_mfma_f32_16x16x32_bf16 v[248:251], v[200:203], v[132:135], v[248:251]
    ds_read_b64_tr_b16 v[216:217], v170 offset:20480
    s_waitcnt lgkmcnt(5)
    v_mfma_f32_16x16x32_bf16 v[236:239], v[204:207], v[128:131], v[236:239]
    ds_read_b64_tr_b16 v[218:219], v170 offset:22528
    buffer_load_dwordx4 v[124:127], v4, s[16:19], s66 offen offset:1024 sc1
    v_mfma_f32_16x16x32_bf16 v[252:255], v[204:207], v[132:135], v[252:255]
    ds_read_b64_tr_b16 v[220:221], v171 offset:20480
    ds_read_b64_tr_b16 v[222:223], v171 offset:22528
    s_waitcnt lgkmcnt(6)
    v_mfma_f32_16x16x32_bf16 v[224:227], v[208:211], v[136:139], v[224:227]
    v_mfma_f32_16x16x32_bf16 v[240:243], v[208:211], v[140:143], v[240:243]
    ds_read_b64_tr_b16 v[192:193], v172 offset:0
    s_waitcnt lgkmcnt(5)
    v_mfma_f32_16x16x32_bf16 v[228:231], v[212:215], v[136:139], v[228:231]
    s_waitcnt vmcnt(4)
    ds_read_b64_tr_b16 v[194:195], v172 offset:2048
    v_max3_u32 v5, v96, v97, v98
    v_mfma_f32_16x16x32_bf16 v[244:247], v[212:215], v[140:143], v[244:247]
    ds_read_b64_tr_b16 v[196:197], v173 offset:0
    v_max3_u32 v5, v5, v99, v100
    s_waitcnt lgkmcnt(5)
    v_mfma_f32_16x16x32_bf16 v[232:235], v[216:219], v[136:139], v[232:235]
    ds_read_b64_tr_b16 v[198:199], v173 offset:2048
    v_max3_u32 v5, v5, v101, v102
    v_mfma_f32_16x16x32_bf16 v[248:251], v[216:219], v[140:143], v[248:251]
    ds_read_b64_tr_b16 v[200:201], v174 offset:0
    v_max3_u32 v5, v5, v103, v104
    v_max3_u32 v5, v5, v105, v106
    s_waitcnt lgkmcnt(5)
    v_mfma_f32_16x16x32_bf16 v[236:239], v[220:223], v[136:139], v[236:239]
    ds_read_b64_tr_b16 v[202:203], v174 offset:2048
    v_max3_u32 v5, v5, v107, v108
    v_max3_u32 v5, v5, v109, v110
    v_mfma_f32_16x16x32_bf16 v[252:255], v[220:223], v[140:143], v[252:255]
    ds_read_b64_tr_b16 v[204:205], v175 offset:0
    ds_read_b64_tr_b16 v[206:207], v175 offset:2048
    v_max_u32 v5, v5, v111
    v_cmp_eq_u32 vcc, -1, v5
    s_cbranch_vccnz Q_rt6
Q_go6:
    s_waitcnt lgkmcnt(6)
    v_mfma_f32_16x16x32_bf16 v[224:227], v[192:195], v[96:99], v[224:227]
    v_sub_f32 v153, 1.0, v152
    v_cvt_pk_bf16_f32 v153, 0, v153
    v_lshlrev_b32 v16, 16, v144
    v_mfma_f32_16x16x32_bf16 v[240:243], v[192:195], v[100:103], v[240:243]
    ds_read_b64_tr_b16 v[208:209], v172 offset:4096
    v_and_b32 v17, 0xffff0000, v144
    v_mul_f32 v16, v16, v153
    v_mul_f32 v17, v17, v153
    s_waitcnt lgkmcnt(5)
    v_mfma_f32_16x16x32_bf16 v[228:231], v[196:199], v[96:99], v[228:231]
    ds_read_b64_tr_b16 v[210:211], v172 offset:6144
    v_cvt_pk_bf16_f32 v16, 0, v16
    v_cvt_pk_bf16_f32 v17, 0, v17
    v_lshlrev_b32 v18, 16, v145
    v_mfma_f32_16x16x32_bf16 v[244:247], v[196:199], v[100:103], v[244:247]
    ds_read_b64_tr_b16 v[212:213], v173 offset:4096
    v_and_b32 v19, 0xffff0000, v145
    v_mul_f32 v18, v18, v153
    v_mul_f32 v19, v19, v153
    s_waitcnt lgkmcnt(5)
    v_mfma_f32_16x16x32_bf16 v[232:235], v[200:203], v[96:99], v[232:235]
    ds_read_b64_tr_b16 v[214:215], v173 offset:6144
    v_cvt_pk_bf16_f32 v18, 0, v18
    v_cvt_pk_bf16_f32 v19, 0, v19
    v_lshlrev_b32 v20, 16, v146
    v_mfma_f32_16x16x32_bf16 v[248:251], v[200:203], v[100:103], v[248:251]
    ds_read_b64_tr_b16 v[216:217], v174 offset:4096
    v_and_b32 v21, 0xffff0000, v146
    v_mul_f32 v20, v20, v153
    v_mul_f32 v21, v21, v153
    s_waitcnt lgkmcnt(5)
    v_mfma_f32_16x16x32_bf16 v[236:239], v[204:207], v[96:99], v[236:239]
    ds_read_b64_tr_b16 v[218:219], v174 offset:6144
    v_cvt_pk_bf16_f32 v20, 0, v20
    v_cvt_pk_bf16_f32 v21, 0, v21
    v_lshlrev_b32 v22, 16, v147
    v_mfma_f32_16x16x32_bf16 v[252:255], v[204:207], v[100:103], v[252:255]
    ds_read_b64_tr_b16 v[220:221], v175 offset:4096
    ds_read_b64_tr_b16 v[222:223], v175 offset:6144
    v_and_b32 v23, 0xffff0000, v147
    v_mul_f32 v22, v22, v153
    v_mul_f32 v23, v23, v153
    s_waitcnt lgkmcnt(6)
    v_mfma_f32_16x16x32_bf16 v[224:227], v[208:211], v[104:107], v[224:227]
    v_mfma_f32_16x16x32_bf16 v[240:243], v[208:211], v[108:111], v[240:243]
    ds_read_b64_tr_b16 v[192:193], v172 offset:8192
    s_waitcnt lgkmcnt(5)
    v_mfma_f32_16x16x32_bf16 v[228:231], v[212:215], v[104:107], v[228:231]
    s_waitcnt vmcnt(0)
    ds_read_b64_tr_b16 v[194:195], v172 offset:10240
    v_max3_u32 v5, v112, v113, v114
    v_mfma_f32_16x16x32_bf16 v[244:247], v[212:215], v[108:111], v[244:247]
    ds_read_b64_tr_b16 v[196:197], v173 offset:8192
    v_max3_u32 v5, v5, v115, v116
    s_waitcnt lgkmcnt(5)
    v_mfma_f32_16x16x32_bf16 v[232:235], v[216:219], v[104:107], v[232:235]
    ds_read_b64_tr_b16 v[198:199], v173 offset:10240
    v_max3_u32 v5, v5, v117, v118
    v_mfma_f32_16x16x32_bf16 v[248:251], v[216:219], v[108:111], v[248:251]
    ds_read_b64_tr_b16 v[200:201], v174 offset:8192
    v_max3_u32 v5, v5, v119, v120
    v_max3_u32 v5, v5, v121, v122
    s_waitcnt lgkmcnt(5)
    v_mfma_f32_16x16x32_bf16 v[236:239], v[220:223], v[104:107], v[236:239]
    ds_read_b64_tr_b16 v[202:203], v174 offset:10240
    v_max3_u32 v5, v5, v123, v124
    v_max3_u32 v5, v5, v125, v126
    v_mfma_f32_16x16x32_bf16 v[252:255], v[220:223], v[108:111], v[252:255]
    ds_read_b64_tr_b16 v[204:205], v175 offset:8192
    ds_read_b64_tr_b16 v[206:207], v175 offset:10240
    v_max_u32 v5, v5, v127
    v_cmp_eq_u32 vcc, -1, v5
    s_cbranch_vccnz Q_rt7
Q_go7:
    s_waitcnt lgkmcnt(6)
    v_mfma_f32_16x16x32_bf16 v[224:227], v[192:195], v[112:115], v[224:227]
    v_cvt_pk_bf16_f32 v22, 0, v22
    v_cvt_pk_bf16_f32 v23, 0, v23
    v_lshlrev_b32 v24, 16, v148
    v_and_b32 v25, 0xffff0000, v148
    v_mul_f32 v24, v24, v153
    v_mfma_f32_16x16x32_bf16 v[240:243], v[192:195], v[116:119], v[240:243]
    ds_read_b64_tr_b16 v[208:209], v172 offset:12288
    v_mul_f32 v25, v25, v153
    v_cvt_pk_bf16_f32 v24, 0, v24
    v_cvt_pk_bf16_f32 v25, 0, v25
    v_lshlrev_b32 v26, 16, v149
    v_and_b32 v27, 0xffff0000, v149
    s_waitcnt lgkmcnt(5)
    v_mfma_f32_16x16x32_bf16 v[228:231], v[196:199], v[112:115], v[228:231]
    ds_read_b64_tr_b16 v[210:211], v172 offset:14336
    v_mul_f32 v26, v26, v153
    v_mul_f32 v27, v27, v153
    v_cvt_pk_bf16_f32 v26, 0, v26
    v_cvt_pk_bf16_f32 v27, 0, v27
    v_mfma_f32_16x16x32_bf16 v[244:247], v[196:199], v[116:119], v[244:247]
    ds_read_b64_tr_b16 v[212:213], v173 offset:12288
    v_lshlrev_b32 v28, 16, v150
    v_and_b32 v29, 0xffff0000, v150
    v_mul_f32 v28, v28, v153
    v_mul_f32 v29, v29, v153
    s_waitcnt lgkmcnt(5)
    v_mfma_f32_16x16x32_bf16 v[232:235], v[200:203], v[112:115], v[232:235]
    ds_read_b64_tr_b16 v[214:215], v173 offset:14336
    v_cvt_pk_bf16_f32 v28, 0, v28
    v_cvt_pk_bf16_f32 v29, 0, v29
    v_lshlrev_b32 v30, 16, v151
    v_and_b32 v31, 0xffff0000, v151
    v_mfma_f32_16x16x32_bf16 v[248:251], v[200:203], v[116:119], v[248:251]
    ds_read_b64_tr_b16 v[216:217], v174 offset:12288
    v_mul_f32 v30, v30, v153
    v_mul_f32 v31, v31, v153
    v_cvt_pk_bf16_f32 v30, 0, v30
    v_cvt_pk_bf16_f32 v31, 0, v31
    s_waitcnt lgkmcnt(5)
    v_mfma_f32_16x16x32_bf16 v[236:239], v[204:207], v[112:115], v[236:239]
    ds_read_b64_tr_b16 v[218:219], v174 offset:14336
    v_mov_b32 v154, v152
    v_mov_b32 v155, v152
    s_lshl_b32 s66, s3, 12
    s_add_u32 s67, s66, 24576
    v_mfma_f32_16x16x32_bf16 v[252:255], v[204:207], v[116:119], v[252:255]
    ds_read_b64_tr_b16 v[220:221], v175 offset:12288
    ds_read_b64_tr_b16 v[222:223], v175 offset:14336
    v_add_u32 v6, s67, v9
    s_xor_b32 s66, s66, 16384
    s_add_u32 s66, s66, 24576
    v_add_u32 v7, s66, v9
    s_waitcnt lgkmcnt(6)
    v_mfma_f32_16x16x32_bf16 v[224:227], v[208:211], v[120:123], v[224:227]
    s_waitcnt lgkmcnt(4)
    v_mfma_f32_16x16x32_bf16 v[228:231], v[212:215], v[120:123], v[228:231]
    s_waitcnt lgkmcnt(2)
    v_mfma_f32_16x16x32_bf16 v[232:235], v[216:219], v[120:123], v[232:235]
    s_waitcnt lgkmcnt(0)
    v_mfma_f32_16x16x32_bf16 v[236:239], v[220:223], v[120:123], v[236:239]
    v_mfma_f32_16x16x32_bf16 v[240:243], v[208:211], v[124:127], v[240:243]
    s_nop 0
    v_mfma_f32_16x16x32_bf16 v[244:247], v[212:215], v[124:127], v[244:247]
    s_nop 0
    v_mfma_f32_16x16x32_bf16 v[248:251], v[216:219], v[124:127], v[248:251]
    s_nop 0
    v_mfma_f32_16x16x32_bf16 v[252:255], v[220:223], v[124:127], v[252:255]
    s_nop 0
    ds_write_b128 v6, v[224:227] offset:0
    ds_write_b128 v6, v[228:231] offset:1024
    ds_write_b128 v6, v[232:235] offset:2048
    ds_write_b128 v6, v[236:239] offset:3072
    s_cmp_eq_u32 s51, 0
    s_cbranch_scc1 Q_ny2
    s_cmp_lg_u32 s3, 0
    s_cbranch_scc1 Q_ny2
    v_mov_b32 v5, 155688
Q_yw:
    ds_read_b32 v8, v5
    s_waitcnt lgkmcnt(0)
    v_cmp_ne_u32 vcc, 8, v8
    s_cbranch_vccnz Q_yw
    v_lshlrev_b32 v8, 2, v2
    v_add_u32 v8, 156992, v8
    ds_read_b32 v32, v8 offset:0
    ds_read_b32 v33, v8 offset:256
    ds_read_b32 v34, v8 offset:512
    ds_read_b32 v35, v8 offset:768
    ds_read_b32 v36, v8 offset:1024
    ds_read_b32 v37, v8 offset:1280
    ds_read_b32 v38, v8 offset:1536
    ds_read_b32 v39, v8 offset:1792
    s_and_b32 s66, s74, 0xffff0000
    s_xor_b32 s67, s66, 0x80000000
    s_not_b32 s68, s66
    s_and_b32 s68, s68, 0xffff0000
    s_cmp_ge_u32 s66, 0x80000000
    s_cselect_b32 s66, s67, s68
    v_mov_b32 v40, s66
    v_mul_f32 v40, s46, v40
    v_exp_f32 v40, -v40
    s_nop 0
    v_add_f32 v40, 1.0, v40
    v_rcp_f32 v40, v40
    s_nop 0
    v_cvt_pk_bf16_f32 v40, 0, v40
    s_waitcnt lgkmcnt(0)
    v_add_f32 v32, v32, v33
    v_add_f32 v32, v32, v34
    v_add_f32 v32, v32, v35
    v_add_f32 v32, v32, v36
    v_add_f32 v32, v32, v37
    v_add_f32 v32, v32, v38
    v_add_f32 v32, v32, v39
    v_cvt_pk_bf16_f32 v32, 0, v32
    v_mul_f32 v32, v32, v40
    v_cvt_pk_bf16_f32 v32, 0, v32
    ds_write_b32 v8, v32 offset:2048
    s_waitcnt lgkmcnt(0)
Q_ny2:
    s_waitcnt lgkmcnt(0)
    s_barrier
    ds_read_b128 v[224:227], v7 offset:0
    ds_read_b128 v[228:231], v7 offset:1024
    ds_read_b128 v[232:235], v7 offset:2048
    ds_read_b128 v[236:239], v7 offset:3072
    v_cmp_eq_u32 vcc, s75, v92
    s_and_saveexec_b64 s[68:69], vcc
    s_cbranch_execz Q_nr
    v_bfe_u32 v8, v2, 4, 1
    v_lshlrev_b32 v8, 6, v8
    v_lshrrev_b32 v5, 5, v2
    v_lshl_add_u32 v8, v5, 5, v8
    v_add_u32 v8, 159040, v8
    ds_read_b128 v[40:43], v8 offset:0
    ds_read_b128 v[44:47], v8 offset:16
    ds_read_b128 v[48:51], v8 offset:128
    ds_read_b128 v[52:55], v8 offset:144
    s_waitcnt lgkmcnt(0)
    v_lshlrev_b32 v16, 16, v144
    v_and_b32 v17, 0xffff0000, v144
    v_lshlrev_b32 v18, 16, v145
    v_and_b32 v19, 0xffff0000, v145
    v_lshlrev_b32 v20, 16, v146
    v_and_b32 v21, 0xffff0000, v146
    v_lshlrev_b32 v22, 16, v147
    v_and_b32 v23, 0xffff0000, v147
    v_lshlrev_b32 v24, 16, v148
    v_and_b32 v25, 0xffff0000, v148
    v_lshlrev_b32 v26, 16, v149
    v_and_b32 v27, 0xffff0000, v149
    v_lshlrev_b32 v28, 16, v150
    v_and_b32 v29, 0xffff0000, v150
    v_lshlrev_b32 v30, 16, v151
    v_and_b32 v31, 0xffff0000, v151
    v_add_f32 v16, v16, v40
    v_cvt_pk_bf16_f32 v16, 0, v16
    v_mul_f32 v16, v16, v153
    v_cvt_pk_bf16_f32 v16, 0, v16
    v_add_f32 v17, v17, v41
    v_cvt_pk_bf16_f32 v17, 0, v17
    v_mul_f32 v17, v17, v153
    v_cvt_pk_bf16_f32 v17, 0, v17
    v_add_f32 v18, v18, v42
    v_cvt_pk_bf16_f32 v18, 0, v18
    v_mul_f32 v18, v18, v153
    v_cvt_pk_bf16_f32 v18, 0, v18
    v_add_f32 v19, v19, v43
    v_cvt_pk_bf16_f32 v19, 0, v19
    v_mul_f32 v19, v19, v153
    v_cvt_pk_bf16_f32 v19, 0, v19
    v_add_f32 v20, v20, v44
    v_cvt_pk_bf16_f32 v20, 0, v20
    v_mul_f32 v20, v20, v153
    v_cvt_pk_bf16_f32 v20, 0, v20
    v_add_f32 v21, v21, v45
    v_cvt_pk_bf16_f32 v21, 0, v21
    v_mul_f32 v21, v21, v153
    v_cvt_pk_bf16_f32 v21, 0, v21
    v_add_f32 v22, v22, v46
    v_cvt_pk_bf16_f32 v22, 0, v22
    v_mul_f32 v22, v22, v153
    v_cvt_pk_bf16_f32 v22, 0, v22
    v_add_f32 v23, v23, v47
    v_cvt_pk_bf16_f32 v23, 0, v23
    v_mul_f32 v23, v23, v153
    v_cvt_pk_bf16_f32 v23, 0, v23
    v_add_f32 v24, v24, v48
    v_cvt_pk_bf16_f32 v24, 0, v24
    v_mul_f32 v24, v24, v153
    v_cvt_pk_bf16_f32 v24, 0, v24
    v_add_f32 v25, v25, v49
    v_cvt_pk_bf16_f32 v25, 0, v25
    v_mul_f32 v25, v25, v153
    v_cvt_pk_bf16_f32 v25, 0, v25
    v_add_f32 v26, v26, v50
    v_cvt_pk_bf16_f32 v26, 0, v26
    v_mul_f32 v26, v26, v153
    v_cvt_pk_bf16_f32 v26, 0, v26
    v_add_f32 v27, v27, v51
    v_cvt_pk_bf16_f32 v27, 0, v27
    v_mul_f32 v27, v27, v153
    v_cvt_pk_bf16_f32 v27, 0, v27
    v_add_f32 v28, v28, v52
    v_cvt_pk_bf16_f32 v28, 0, v28
    v_mul_f32 v28, v28, v153
    v_cvt_pk_bf16_f32 v28, 0, v28
    v_add_f32 v29, v29, v53
    v_cvt_pk_bf16_f32 v29, 0, v29
    v_mul_f32 v29, v29, v153
    v_cvt_pk_bf16_f32 v29, 0, v29
    v_add_f32 v30, v30, v54
    v_cvt_pk_bf16_f32 v30, 0, v30
    v_mul_f32 v30, v30, v153
    v_cvt_pk_bf16_f32 v30, 0, v30
    v_add_f32 v31, v31, v55
    v_cvt_pk_bf16_f32 v31, 0, v31
    v_mul_f32 v31, v31, v153
    v_cvt_pk_bf16_f32 v31, 0, v31
Q_nr:
    s_mov_b64 exec, s[68:69]
    s_waitcnt lgkmcnt(3)
    v_pk_add_f32 v[224:225], v[224:225], v[240:241]
    v_pk_add_f32 v[226:227], v[226:227], v[242:243]
    v_cvt_pk_bf16_f32 v40, v224, v225
    v_cvt_pk_bf16_f32 v41, v226, v227
    s_waitcnt lgkmcnt(2)
    v_pk_add_f32 v[228:229], v[228:229], v[244:245]
    v_pk_add_f32 v[230:231], v[230:231], v[246:247]
    v_cvt_pk_bf16_f32 v42, v228, v229
    v_cvt_pk_bf16_f32 v43, v230, v231
    s_waitcnt lgkmcnt(1)
    v_pk_add_f32 v[232:233], v[232:233], v[248:249]
    v_pk_add_f32 v[234:235], v[234:235], v[250:251]
    v_cvt_pk_bf16_f32 v44, v232, v233
    v_cvt_pk_bf16_f32 v45, v234, v235
    s_waitcnt lgkmcnt(0)
    v_pk_add_f32 v[236:237], v[236:237], v[252:253]
    v_pk_add_f32 v[238:239], v[238:239], v[254:255]
    v_cvt_pk_bf16_f32 v46, v236, v237
    v_cvt_pk_bf16_f32 v47, v238, v239
    s_nop 0
    v_permlane16_swap_b32 v40, v42
    v_permlane16_swap_b32 v41, v43
    v_permlane16_swap_b32 v44, v46
    v_permlane16_swap_b32 v45, v47
    v_lshlrev_b32 v224, 16, v40
    v_and_b32 v225, 0xffff0000, v40
    v_lshlrev_b32 v226, 16, v41
    v_and_b32 v227, 0xffff0000, v41
    v_lshlrev_b32 v228, 16, v42
    v_and_b32 v229, 0xffff0000, v42
    v_lshlrev_b32 v230, 16, v43
    v_and_b32 v231, 0xffff0000, v43
    v_pk_mul_f32 v[224:225], v[224:225], v[154:155]
    v_pk_mul_f32 v[226:227], v[226:227], v[154:155]
    v_pk_mul_f32 v[228:229], v[228:229], v[154:155]
    v_pk_mul_f32 v[230:231], v[230:231], v[154:155]
    v_cvt_pk_bf16_f32 v224, 0, v224
    v_cvt_pk_bf16_f32 v225, 0, v225
    v_cvt_pk_bf16_f32 v226, 0, v226
    v_cvt_pk_bf16_f32 v227, 0, v227
    v_cvt_pk_bf16_f32 v228, 0, v228
    v_cvt_pk_bf16_f32 v229, 0, v229
    v_cvt_pk_bf16_f32 v230, 0, v230
    v_cvt_pk_bf16_f32 v231, 0, v231
    v_pk_add_f32 v[224:225], v[224:225], v[16:17]
    v_pk_add_f32 v[226:227], v[226:227], v[18:19]
    v_pk_add_f32 v[228:229], v[228:229], v[20:21]
    v_pk_add_f32 v[230:231], v[230:231], v[22:23]
    v_cvt_pk_bf16_f32 v48, v224, v225
    v_cvt_pk_bf16_f32 v49, v226, v227
    v_cvt_pk_bf16_f32 v50, v228, v229
    v_cvt_pk_bf16_f32 v51, v230, v231
    buffer_store_dwordx4 v[48:51], v91, s[36:39], 0 offen offset:0 sc0 sc1
    v_lshlrev_b32 v232, 16, v44
    v_and_b32 v233, 0xffff0000, v44
    v_lshlrev_b32 v234, 16, v45
    v_and_b32 v235, 0xffff0000, v45
    v_lshlrev_b32 v236, 16, v46
    v_and_b32 v237, 0xffff0000, v46
    v_lshlrev_b32 v238, 16, v47
    v_and_b32 v239, 0xffff0000, v47
    v_pk_mul_f32 v[232:233], v[232:233], v[154:155]
    v_pk_mul_f32 v[234:235], v[234:235], v[154:155]
    v_pk_mul_f32 v[236:237], v[236:237], v[154:155]
    v_pk_mul_f32 v[238:239], v[238:239], v[154:155]
    v_cvt_pk_bf16_f32 v232, 0, v232
    v_cvt_pk_bf16_f32 v233, 0, v233
    v_cvt_pk_bf16_f32 v234, 0, v234
    v_cvt_pk_bf16_f32 v235, 0, v235
    v_cvt_pk_bf16_f32 v236, 0, v236
    v_cvt_pk_bf16_f32 v237, 0, v237
    v_cvt_pk_bf16_f32 v238, 0, v238
    v_cvt_pk_bf16_f32 v239, 0, v239
    v_pk_add_f32 v[232:233], v[232:233], v[24:25]
    v_pk_add_f32 v[234:235], v[234:235], v[26:27]
    v_pk_add_f32 v[236:237], v[236:237], v[28:29]
    v_pk_add_f32 v[238:239], v[238:239], v[30:31]
    v_cvt_pk_bf16_f32 v52, v232, v233
    v_cvt_pk_bf16_f32 v53, v234, v235
    v_cvt_pk_bf16_f32 v54, v236, v237
    v_cvt_pk_bf16_f32 v55, v238, v239
    buffer_store_dwordx4 v[52:55], v91, s[36:39], 0 offen offset:64 sc0 sc1
END:
    s_endpgm
Q_rt0:
    s_mov_b32 s59, 0
    s_add_u32 s67, s63, 0
    s_and_b32 s67, s67, 32767
Q_rl0:
    s_waitcnt vmcnt(0)
    s_add_u32 s59, s59, 1
    s_cmp_ge_u32 s59, 200000
    s_cbranch_scc1 Q_rd0
    s_sleep 1
    buffer_load_dwordx4 v[96:99], v3, s[16:19], s67 offen offset:0 sc1
    buffer_load_dwordx4 v[100:103], v4, s[16:19], s67 offen offset:0 sc1
    buffer_load_dwordx4 v[104:107], v3, s[16:19], s67 offen offset:1024 sc1
    buffer_load_dwordx4 v[108:111], v4, s[16:19], s67 offen offset:1024 sc1
    s_waitcnt vmcnt(0)
    v_max3_u32 v5, v96, v97, v98
    v_max3_u32 v5, v5, v99, v100
    v_max3_u32 v5, v5, v101, v102
    v_max3_u32 v5, v5, v103, v104
    v_max3_u32 v5, v5, v105, v106
    v_max3_u32 v5, v5, v107, v108
    v_max3_u32 v5, v5, v109, v110
    v_max_u32 v5, v5, v111
    v_cmp_eq_u32 vcc, -1, v5
    s_cbranch_vccnz Q_rl0
Q_rd0:
    s_add_u32 s67, s63, 4096
    s_and_b32 s67, s67, 32767
    buffer_load_dwordx4 v[112:115], v3, s[16:19], s67 offen offset:0 sc1
    buffer_load_dwordx4 v[116:119], v4, s[16:19], s67 offen offset:0 sc1
    buffer_load_dwordx4 v[120:123], v3, s[16:19], s67 offen offset:1024 sc1
    buffer_load_dwordx4 v[124:127], v4, s[16:19], s67 offen offset:1024 sc1
    s_branch Q_go0
Q_rt1:
    s_mov_b32 s59, 0
    s_add_u32 s67, s63, 4096
    s_and_b32 s67, s67, 32767
Q_rl1:
    s_waitcnt vmcnt(0)
    s_add_u32 s59, s59, 1
    s_cmp_ge_u32 s59, 200000
    s_cbranch_scc1 Q_rd1
    s_sleep 1
    buffer_load_dwordx4 v[112:115], v3, s[16:19], s67 offen offset:0 sc1
    buffer_load_dwordx4 v[116:119], v4, s[16:19], s67 offen offset:0 sc1
    buffer_load_dwordx4 v[120:123], v3, s[16:19], s67 offen offset:1024 sc1
    buffer_load_dwordx4 v[124:127], v4, s[16:19], s67 offen offset:1024 sc1
    s_waitcnt vmcnt(0)
    v_max3_u32 v5, v112, v113, v114
    v_max3_u32 v5, v5, v115, v116
    v_max3_u32 v5, v5, v117, v118
    v_max3_u32 v5, v5, v119, v120
    v_max3_u32 v5, v5, v121, v122
    v_max3_u32 v5, v5, v123, v124
    v_max3_u32 v5, v5, v125, v126
    v_max_u32 v5, v5, v127
    v_cmp_eq_u32 vcc, -1, v5
    s_cbranch_vccnz Q_rl1
Q_rd1:
    s_add_u32 s67, s63, 8192
    s_and_b32 s67, s67, 32767
    buffer_load_dwordx4 v[128:131], v3, s[16:19], s67 offen offset:0 sc1
    buffer_load_dwordx4 v[132:135], v4, s[16:19], s67 offen offset:0 sc1
    buffer_load_dwordx4 v[136:139], v3, s[16:19], s67 offen offset:1024 sc1
    buffer_load_dwordx4 v[140:143], v4, s[16:19], s67 offen offset:1024 sc1
    s_branch Q_go1
Q_rt2:
    s_mov_b32 s59, 0
    s_add_u32 s67, s63, 8192
    s_and_b32 s67, s67, 32767
Q_rl2:
    s_waitcnt vmcnt(0)
    s_add_u32 s59, s59, 1
    s_cmp_ge_u32 s59, 200000
    s_cbranch_scc1 Q_rd2
    s_sleep 1
    buffer_load_dwordx4 v[128:131], v3, s[16:19], s67 offen offset:0 sc1
    buffer_load_dwordx4 v[132:135], v4, s[16:19], s67 offen offset:0 sc1
    buffer_load_dwordx4 v[136:139], v3, s[16:19], s67 offen offset:1024 sc1
    buffer_load_dwordx4 v[140:143], v4, s[16:19], s67 offen offset:1024 sc1
    s_waitcnt vmcnt(0)
    v_max3_u32 v5, v128, v129, v130
    v_max3_u32 v5, v5, v131, v132
    v_max3_u32 v5, v5, v133, v134
    v_max3_u32 v5, v5, v135, v136
    v_max3_u32 v5, v5, v137, v138
    v_max3_u32 v5, v5, v139, v140
    v_max3_u32 v5, v5, v141, v142
    v_max_u32 v5, v5, v143
    v_cmp_eq_u32 vcc, -1, v5
    s_cbranch_vccnz Q_rl2
Q_rd2:
    s_add_u32 s67, s63, 12288
    s_and_b32 s67, s67, 32767
    buffer_load_dwordx4 v[96:99], v3, s[16:19], s67 offen offset:0 sc1
    buffer_load_dwordx4 v[100:103], v4, s[16:19], s67 offen offset:0 sc1
    buffer_load_dwordx4 v[104:107], v3, s[16:19], s67 offen offset:1024 sc1
    buffer_load_dwordx4 v[108:111], v4, s[16:19], s67 offen offset:1024 sc1
    s_branch Q_go2
Q_rt3:
    s_mov_b32 s59, 0
    s_add_u32 s67, s63, 12288
    s_and_b32 s67, s67, 32767
Q_rl3:
    s_waitcnt vmcnt(0)
    s_add_u32 s59, s59, 1
    s_cmp_ge_u32 s59, 200000
    s_cbranch_scc1 Q_rd3
    s_sleep 1
    buffer_load_dwordx4 v[96:99], v3, s[16:19], s67 offen offset:0 sc1
    buffer_load_dwordx4 v[100:103], v4, s[16:19], s67 offen offset:0 sc1
    buffer_load_dwordx4 v[104:107], v3, s[16:19], s67 offen offset:1024 sc1
    buffer_load_dwordx4 v[108:111], v4, s[16:19], s67 offen offset:1024 sc1
    s_waitcnt vmcnt(0)
    v_max3_u32 v5, v96, v97, v98
    v_max3_u32 v5, v5, v99, v100
    v_max3_u32 v5, v5, v101, v102
    v_max3_u32 v5, v5, v103, v104
    v_max3_u32 v5, v5, v105, v106
    v_max3_u32 v5, v5, v107, v108
    v_max3_u32 v5, v5, v109, v110
    v_max_u32 v5, v5, v111
    v_cmp_eq_u32 vcc, -1, v5
    s_cbranch_vccnz Q_rl3
Q_rd3:
    s_add_u32 s67, s63, 16384
    s_and_b32 s67, s67, 32767
    buffer_load_dwordx4 v[112:115], v3, s[16:19], s67 offen offset:0 sc1
    buffer_load_dwordx4 v[116:119], v4, s[16:19], s67 offen offset:0 sc1
    buffer_load_dwordx4 v[120:123], v3, s[16:19], s67 offen offset:1024 sc1
    buffer_load_dwordx4 v[124:127], v4, s[16:19], s67 offen offset:1024 sc1
    s_branch Q_go3
Q_rt4:
    s_mov_b32 s59, 0
    s_add_u32 s67, s63, 16384
    s_and_b32 s67, s67, 32767
Q_rl4:
    s_waitcnt vmcnt(0)
    s_add_u32 s59, s59, 1
    s_cmp_ge_u32 s59, 200000
    s_cbranch_scc1 Q_rd4
    s_sleep 1
    buffer_load_dwordx4 v[112:115], v3, s[16:19], s67 offen offset:0 sc1
    buffer_load_dwordx4 v[116:119], v4, s[16:19], s67 offen offset:0 sc1
    buffer_load_dwordx4 v[120:123], v3, s[16:19], s67 offen offset:1024 sc1
    buffer_load_dwordx4 v[124:127], v4, s[16:19], s67 offen offset:1024 sc1
    s_waitcnt vmcnt(0)
    v_max3_u32 v5, v112, v113, v114
    v_max3_u32 v5, v5, v115, v116
    v_max3_u32 v5, v5, v117, v118
    v_max3_u32 v5, v5, v119, v120
    v_max3_u32 v5, v5, v121, v122
    v_max3_u32 v5, v5, v123, v124
    v_max3_u32 v5, v5, v125, v126
    v_max_u32 v5, v5, v127
    v_cmp_eq_u32 vcc, -1, v5
    s_cbranch_vccnz Q_rl4
Q_rd4:
    s_add_u32 s67, s63, 20480
    s_and_b32 s67, s67, 32767
    buffer_load_dwordx4 v[128:131], v3, s[16:19], s67 offen offset:0 sc1
    buffer_load_dwordx4 v[132:135], v4, s[16:19], s67 offen offset:0 sc1
    buffer_load_dwordx4 v[136:139], v3, s[16:19], s67 offen offset:1024 sc1
    buffer_load_dwordx4 v[140:143], v4, s[16:19], s67 offen offset:1024 sc1
    s_branch Q_go4
Q_rt5:
    s_mov_b32 s59, 0
    s_add_u32 s67, s63, 20480
    s_and_b32 s67, s67, 32767
Q_rl5:
    s_waitcnt vmcnt(0)
    s_add_u32 s59, s59, 1
    s_cmp_ge_u32 s59, 200000
    s_cbranch_scc1 Q_rd5
    s_sleep 1
    buffer_load_dwordx4 v[128:131], v3, s[16:19], s67 offen offset:0 sc1
    buffer_load_dwordx4 v[132:135], v4, s[16:19], s67 offen offset:0 sc1
    buffer_load_dwordx4 v[136:139], v3, s[16:19], s67 offen offset:1024 sc1
    buffer_load_dwordx4 v[140:143], v4, s[16:19], s67 offen offset:1024 sc1
    s_waitcnt vmcnt(0)
    v_max3_u32 v5, v128, v129, v130
    v_max3_u32 v5, v5, v131, v132
    v_max3_u32 v5, v5, v133, v134
    v_max3_u32 v5, v5, v135, v136
    v_max3_u32 v5, v5, v137, v138
    v_max3_u32 v5, v5, v139, v140
    v_max3_u32 v5, v5, v141, v142
    v_max_u32 v5, v5, v143
    v_cmp_eq_u32 vcc, -1, v5
    s_cbranch_vccnz Q_rl5
Q_rd5:
    s_add_u32 s67, s63, 24576
    s_and_b32 s67, s67, 32767
    buffer_load_dwordx4 v[96:99], v3, s[16:19], s67 offen offset:0 sc1
    buffer_load_dwordx4 v[100:103], v4, s[16:19], s67 offen offset:0 sc1
    buffer_load_dwordx4 v[104:107], v3, s[16:19], s67 offen offset:1024 sc1
    buffer_load_dwordx4 v[108:111], v4, s[16:19], s67 offen offset:1024 sc1
    s_branch Q_go5
Q_rt6:
    s_mov_b32 s59, 0
    s_add_u32 s67, s63, 24576
    s_and_b32 s67, s67, 32767
Q_rl6:
    s_waitcnt vmcnt(0)
    s_add_u32 s59, s59, 1
    s_cmp_ge_u32 s59, 200000
    s_cbranch_scc1 Q_rd6
    s_sleep 1
    buffer_load_dwordx4 v[96:99], v3, s[16:19], s67 offen offset:0 sc1
    buffer_load_dwordx4 v[100:103], v4, s[16:19], s67 offen offset:0 sc1
    buffer_load_dwordx4 v[104:107], v3, s[16:19], s67 offen offset:1024 sc1
    buffer_load_dwordx4 v[108:111], v4, s[16:19], s67 offen offset:1024 sc1
    s_waitcnt vmcnt(0)
    v_max3_u32 v5, v96, v97, v98
    v_max3_u32 v5, v5, v99, v100
    v_max3_u32 v5, v5, v101, v102
    v_max3_u32 v5, v5, v103, v104
    v_max3_u32 v5, v5, v105, v106
    v_max3_u32 v5, v5, v107, v108
    v_max3_u32 v5, v5, v109, v110
    v_max_u32 v5, v5, v111
    v_cmp_eq_u32 vcc, -1, v5
    s_cbranch_vccnz Q_rl6
Q_rd6:
    s_add_u32 s67, s63, 28672
    s_and_b32 s67, s67, 32767
    buffer_load_dwordx4 v[112:115], v3, s[16:19], s67 offen offset:0 sc1
    buffer_load_dwordx4 v[116:119], v4, s[16:19], s67 offen offset:0 sc1
    buffer_load_dwordx4 v[120:123], v3, s[16:19], s67 offen offset:1024 sc1
    buffer_load_dwordx4 v[124:127], v4, s[16:19], s67 offen offset:1024 sc1
    s_branch Q_go6
Q_rt7:
    s_mov_b32 s59, 0
    s_add_u32 s67, s63, 28672
    s_and_b32 s67, s67, 32767
Q_rl7:
    s_waitcnt vmcnt(0)
    s_add_u32 s59, s59, 1
    s_cmp_ge_u32 s59, 200000
    s_cbranch_scc1 Q_rd7
    s_sleep 1
    buffer_load_dwordx4 v[112:115], v3, s[16:19], s67 offen offset:0 sc1
    buffer_load_dwordx4 v[116:119], v4, s[16:19], s67 offen offset:0 sc1
    buffer_load_dwordx4 v[120:123], v3, s[16:19], s67 offen offset:1024 sc1
    buffer_load_dwordx4 v[124:127], v4, s[16:19], s67 offen offset:1024 sc1
    s_waitcnt vmcnt(0)
    v_max3_u32 v5, v112, v113, v114
    v_max3_u32 v5, v5, v115, v116
    v_max3_u32 v5, v5, v117, v118
    v_max3_u32 v5, v5, v119, v120
    v_max3_u32 v5, v5, v121, v122
    v_max3_u32 v5, v5, v123, v124
    v_max3_u32 v5, v5, v125, v126
    v_max_u32 v5, v5, v127
    v_cmp_eq_u32 vcc, -1, v5
    s_cbranch_vccnz Q_rl7
Q_rd7:
    s_branch Q_go7
H_eps:
    v_lshlrev_b32 v72, 16, v32
    v_and_b32 v73, 0xffff0000, v32
    v_add_f32 v72, s47, v72
    v_add_f32 v73, s47, v73
    v_cvt_pk_bf16_f32 v32, v72, v73
    v_lshlrev_b32 v72, 16, v33
    v_and_b32 v73, 0xffff0000, v33
    v_add_f32 v72, s47, v72
    v_add_f32 v73, s47, v73
    v_cvt_pk_bf16_f32 v33, v72, v73
    v_lshlrev_b32 v72, 16, v34
    v_and_b32 v73, 0xffff0000, v34
    v_add_f32 v72, s47, v72
    v_add_f32 v73, s47, v73
    v_cvt_pk_bf16_f32 v34, v72, v73
    v_lshlrev_b32 v72, 16, v35
    v_and_b32 v73, 0xffff0000, v35
    v_add_f32 v72, s47, v72
    v_add_f32 v73, s47, v73
    v_cvt_pk_bf16_f32 v35, v72, v73
    v_lshlrev_b32 v72, 16, v36
    v_and_b32 v73, 0xffff0000, v36
    v_add_f32 v72, s47, v72
    v_add_f32 v73, s47, v73
    v_cvt_pk_bf16_f32 v36, v72, v73
    v_lshlrev_b32 v72, 16, v37
    v_and_b32 v73, 0xffff0000, v37
    v_add_f32 v72, s47, v72
    v_add_f32 v73, s47, v73
    v_cvt_pk_bf16_f32 v37, v72, v73
    v_lshlrev_b32 v72, 16, v38
    v_and_b32 v73, 0xffff0000, v38
    v_add_f32 v72, s47, v72
    v_add_f32 v73, s47, v73
    v_cvt_pk_bf16_f32 v38, v72, v73
    v_lshlrev_b32 v72, 16, v39
    v_and_b32 v73, 0xffff0000, v39
    v_add_f32 v72, s47, v72
    v_add_f32 v73, s47, v73
    v_cvt_pk_bf16_f32 v39, v72, v73
    v_lshlrev_b32 v72, 16, v40
    v_and_b32 v73, 0xffff0000, v40
    v_add_f32 v72, s47, v72
    v_add_f32 v73, s47, v73
    v_cvt_pk_bf16_f32 v40, v72, v73
    v_lshlrev_b32 v72, 16, v41
    v_and_b32 v73, 0xffff0000, v41
    v_add_f32 v72, s47, v72
    v_add_f32 v73, s47, v73
    v_cvt_pk_bf16_f32 v41, v72, v73
    v_lshlrev_b32 v72, 16, v42
    v_and_b32 v73, 0xffff0000, v42
    v_add_f32 v72, s47, v72
    v_add_f32 v73, s47, v73
    v_cvt_pk_bf16_f32 v42, v72, v73
    v_lshlrev_b32 v72, 16, v43
    v_and_b32 v73, 0xffff0000, v43
    v_add_f32 v72, s47, v72
    v_add_f32 v73, s47, v73
    v_cvt_pk_bf16_f32 v43, v72, v73
    v_lshlrev_b32 v72, 16, v44
    v_and_b32 v73, 0xffff0000, v44
    v_add_f32 v72, s47, v72
    v_add_f32 v73, s47, v73
    v_cvt_pk_bf16_f32 v44, v72, v73
    v_lshlrev_b32 v72, 16, v45
    v_and_b32 v73, 0xffff0000, v45
    v_add_f32 v72, s47, v72
    v_add_f32 v73, s47, v73
    v_cvt_pk_bf16_f32 v45, v72, v73
    v_lshlrev_b32 v72, 16, v46
    v_and_b32 v73, 0xffff0000, v46
    v_add_f32 v72, s47, v72
    v_add_f32 v73, s47, v73
    v_cvt_pk_bf16_f32 v46, v72, v73
    v_lshlrev_b32 v72, 16, v47
    v_and_b32 v73, 0xffff0000, v47
    v_add_f32 v72, s47, v72
    v_add_f32 v73, s47, v73
    v_cvt_pk_bf16_f32 v47, v72, v73
    s_nop 1
    v_mfma_f32_16x16x32_bf16 v[200:203], v[32:35], v[204:207], 0
    s_waitcnt lgkmcnt(7)
    v_mfma_f32_16x16x32_bf16 v[192:195], v[32:35], v[208:211], 0
    s_waitcnt lgkmcnt(6)
    v_mfma_f32_16x16x32_bf16 v[196:199], v[32:35], v[212:215], 0
    v_mfma_f32_16x16x32_bf16 v[200:203], v[36:39], v[204:207], v[200:203]
    s_waitcnt lgkmcnt(5)
    v_mfma_f32_16x16x32_bf16 v[192:195], v[36:39], v[216:219], v[192:195]
    s_waitcnt lgkmcnt(4)
    v_mfma_f32_16x16x32_bf16 v[196:199], v[36:39], v[220:223], v[196:199]
    v_mfma_f32_16x16x32_bf16 v[200:203], v[40:43], v[204:207], v[200:203]
    s_waitcnt lgkmcnt(3)
    v_mfma_f32_16x16x32_bf16 v[192:195], v[40:43], v[224:227], v[192:195]
    s_waitcnt lgkmcnt(2)
    v_mfma_f32_16x16x32_bf16 v[196:199], v[40:43], v[228:231], v[196:199]
    v_mfma_f32_16x16x32_bf16 v[200:203], v[44:47], v[204:207], v[200:203]
    s_waitcnt lgkmcnt(1)
    v_mfma_f32_16x16x32_bf16 v[192:195], v[44:47], v[232:235], v[192:195]
    s_waitcnt lgkmcnt(0)
    v_mfma_f32_16x16x32_bf16 v[196:199], v[44:47], v[236:239], v[196:199]
    s_branch H_ne
CODE_END:
.section .rodata,"a"
.p2align 6
.amdhsa_kernel gated_mix__linear_attn_block__moe_arch_mod__prompt_kernel
  .amdhsa_next_free_vgpr 256
  .amdhsa_next_free_sgpr 102
  .amdhsa_accum_offset 256
  .amdhsa_group_segment_fixed_size 0
  .amdhsa_kernarg_size 96
  .amdhsa_user_sgpr_count 2
  .amdhsa_user_sgpr_kernarg_segment_ptr 1
  .amdhsa_system_sgpr_workgroup_id_x 1
.end_amdhsa_kernel
```

```asm
; @launch grid=(256,1,1) block=(512,1,1) lds=163840
.amdgcn_target "amdgcn-amd-amdhsa--gfx950"
.text
.globl gated_mix__linear_attn_block__moe_arch_mod__prompt_kernel
.p2align 8
.type gated_mix__linear_attn_block__moe_arch_mod__prompt_kernel,@function
gated_mix__linear_attn_block__moe_arch_mod__prompt_kernel:
    s_load_dwordx2 s[12:13], s[0:1], 8
    s_load_dwordx2 s[8:9], s[0:1], 0
    s_getpc_b64 s[64:65]
PC0:
    v_min_u32 v1, 15, v0
    v_lshlrev_b32 v1, 6, v1
    global_load_dword v246, v1, s[64:65]
    s_cmp_ge_u32 s2, 256
    s_cbranch_scc1 END
    v_lshrrev_b32 v1, 6, v0
    v_and_b32 v2, 63, v0
    s_load_dwordx8 s[48:55], s[0:1], 32
    v_readfirstlane_b32 s3, v1
    s_load_dwordx8 s[56:63], s[0:1], 64
    s_load_dwordx2 s[20:21], s[0:1], 16
    s_and_b32 s66, s2, 0xf8
    v_and_b32 v1, 31, v0
    v_lshl_add_u32 v1, s66, 2, v1
    v_lshlrev_b32 v1, 6, v1
    v_min_u32 v1, CODE_END-PC0-4, v1
    global_load_dword v247, v1, s[64:65]
    s_and_b32 s64, s2, 7
    s_lshr_b32 s65, s2, 3
    s_and_b32 s44, s3, 3
    s_lshr_b32 s45, s3, 2
    s_and_b32 s66, s64, 6
    s_lshl_b32 s5, s66, 1
    s_lshl1_add_u32 s76, s65, s64
    s_lshl_b32 s76, s76, 1
    s_lshr_b32 s66, s65, 3
    s_add_u32 s5, s5, s66
    v_lshrrev_b32 v6, 3, v2
    v_lshl_add_u32 v6, s44, 3, v6
    v_lshrrev_b32 v8, 4, v2
    v_and_b32 v10, 7, v2
    s_and_b32 s67, s44, 1
    v_mul_u32_u24 v7, 6144, v6
    v_and_b32 v9, 1, v8
    v_lshl_add_u32 v9, v9, 1, s67
    v_lshlrev_b32 v9, 1, v9
    v_xor_b32 v9, v9, v10
    v_lshl_add_u32 v7, v9, 4, v7
    v_lshl_add_u32 v5, s5, 7, v7
    s_mov_b32 s14, 0x600000
    s_mov_b32 s15, 0x00020000
    s_lshl_b32 s72, s44, 10
    s_lshl_b32 s66, s45, 12
    s_add_u32 s69, s72, s66
    s_add_u32 s68, s69, s66
    s_sub_u32 s77, s5, s76
    s_and_b32 s77, s77, 15
    s_cmp_le_u32 s77, 0
    s_addc_u32 s70, s76, 0
    s_and_b32 s70, s70, 15
    s_lshl_b32 s71, s70, 1
    s_add_u32 s71, s71, s45
    s_mul_i32 s71, s71, 196608
    s_waitcnt lgkmcnt(0)
    s_add_u32 m0, s69, 24576
    s_add_u32 s66, s71, 2048
    buffer_load_dwordx4 v5, s[12:15], s66 offen lds
    s_add_u32 m0, s69, 32768
    s_add_u32 s66, s71, 4096
    buffer_load_dwordx4 v5, s[12:15], s66 offen lds
    s_add_u32 m0, s69, 16384
    s_add_u32 s66, s71, 0
    buffer_load_dwordx4 v5, s[12:15], s66 offen lds
    s_and_b32 s4, s64, 1
    s_lshl_b32 s4, s4, 3
    s_and_b32 s66, s65, 7
    s_add_u32 s4, s4, s66
    v_lshl_add_u32 v7, s4, 7, v6
    v_lshlrev_b32 v7, 11, v7
    v_lshl_add_u32 v9, s67, 2, v8
    v_xor_b32 v9, v9, v10
    v_lshl_add_u32 v4, v9, 4, v7
    s_mov_b32 s10, 0x400000
    s_mov_b32 s11, 0x00020000
    s_lshl_b32 s70, s70, 7
    s_lshl_b32 s66, s45, 17
    s_add_u32 s70, s70, s66
    s_add_u32 m0, s68, 0
    s_add_u32 s66, s70, 0
    buffer_load_dwordx4 v4, s[8:11], s66 offen lds
    s_add_u32 m0, s68, 4096
    s_add_u32 s66, s70, 65536
    buffer_load_dwordx4 v4, s[8:11], s66 offen lds
    s_barrier
    s_cmp_le_u32 s77, 1
    s_addc_u32 s70, s76, 1
    s_and_b32 s70, s70, 15
    s_lshl_b32 s71, s70, 1
    s_add_u32 s71, s71, s45
    s_mul_i32 s71, s71, 196608
    s_add_u32 m0, s69, 65536
    s_add_u32 s66, s71, 2048
    buffer_load_dwordx4 v5, s[12:15], s66 offen lds
    s_add_u32 m0, s69, 73728
    s_add_u32 s66, s71, 4096
    buffer_load_dwordx4 v5, s[12:15], s66 offen lds
    s_add_u32 m0, s69, 57344
    s_add_u32 s66, s71, 0
    buffer_load_dwordx4 v5, s[12:15], s66 offen lds
    s_lshl_b32 s70, s70, 7
    s_lshl_b32 s66, s45, 17
    s_add_u32 s70, s70, s66
    s_add_u32 m0, s68, 40960
    s_add_u32 s66, s70, 0
    buffer_load_dwordx4 v4, s[8:11], s66 offen lds
    s_add_u32 m0, s68, 45056
    s_add_u32 s66, s70, 65536
    buffer_load_dwordx4 v4, s[8:11], s66 offen lds
    s_mov_b32 s16, s62
    s_mov_b32 s17, s63
    s_mov_b32 s32, s54
    s_mov_b32 s33, s55
    s_mov_b32 s36, s58
    s_mov_b32 s37, s59
    s_mov_b32 s40, s60
    s_mov_b32 s41, s61
    s_mov_b32 s18, 0x10000000
    s_mov_b32 s19, 0x00020000
    s_mov_b32 s34, 0x700000
    s_mov_b32 s35, 0x00020000
    s_mov_b32 s38, 0x400000
    s_mov_b32 s39, 0x00020000
    s_mov_b32 s42, 0x100
    s_mov_b32 s43, 0x00020000
    s_mov_b32 s22, 0x200000
    s_mov_b32 s23, 0x00020000
    s_bitcmp0_b32 s44, 0
    s_cselect_b32 s24, s48, s56
    s_cselect_b32 s25, s49, s57
    s_mov_b32 s26, 0x800
    s_mov_b32 s27, 0x00020000
    s_bitcmp0_b32 s44, 0
    s_cselect_b32 s28, s50, s52
    s_cselect_b32 s29, s51, s53
    s_mov_b32 s30, 0x700000
    s_mov_b32 s31, 0x00020000
    s_lshr_b32 s66, s64, 2
    s_lshl_b32 s66, s66, 1
    s_and_b32 s67, s64, 1
    s_add_u32 s66, s66, s67
    s_lshl_b32 s67, s65, 2
    s_add_u32 s66, s66, s67
    s_add_u32 s66, s66, 96
    s_bitcmp0_b32 s64, 1
    s_cselect_b32 s67, 32, 0
    s_add_u32 s66, s66, s67
    s_cmp_lt_u32 s65, 24
    s_cselect_b32 s67, s2, s66
    s_cmp_ge_u32 s67, 224
    s_cselect_b32 s30, 0, s30
    s_cselect_b32 s34, 0, s34
    s_lshr_b32 s79, s67, 2
    s_and_b32 s73, s67, 3
    s_and_b32 s6, s64, 3
    s_lshl_b32 s6, s6, 2
    s_and_b32 s66, s65, 3
    s_add_u32 s6, s6, s66
    s_lshr_b32 s7, s64, 2
    s_lshl_b32 s7, s7, 3
    s_lshr_b32 s66, s65, 2
    s_add_u32 s7, s7, s66
    s_mov_b32 s6, s4
    s_mov_b32 s7, s5
    s_mov_b32 s46, 0x3fb8aa3b
    s_mov_b32 s47, 0x358637bd
    s_cmp_ge_u32 s3, 4
    s_cbranch_scc1 HELP
    s_and_b32 s48, s3, 1
    s_lshr_b32 s49, s3, 1
    v_and_b32 v3, 15, v2
    s_lshl_b32 s66, s48, 6
    v_add_u32 v3, s66, v3
    v_lshlrev_b32 v3, 7, v3
    v_bfe_u32 v9, v2, 1, 3
    v_lshrrev_b32 v15, 4, v2
    v_xor_b32 v9, v9, v15
    v_xor_b32 v12, 0, v9
    v_lshl_add_u32 v4, v12, 4, v3
    v_xor_b32 v12, 4, v9
    v_lshl_add_u32 v5, v12, 4, v3
    v_bfe_u32 v12, v2, 2, 2
    v_lshl_add_u32 v13, v15, 3, v12
    v_lshlrev_b32 v13, 7, v13
    v_lshrrev_b32 v12, 1, v12
    v_xor_b32 v12, s49, v12
    v_lshl_add_u32 v13, v12, 6, v13
    v_and_b32 v12, 3, v2
    v_lshl_add_u32 v13, v12, 3, v13
    v_add_u32 v13, 16384, v13
    v_and_b32 v12, 1, v15
    v_xor_b32 v14, 0, v12
    v_lshl_add_u32 v6, v14, 5, v13
    v_xor_b32 v14, 1, v12
    v_lshl_add_u32 v7, v14, 5, v13
    v_mov_b32 v8, v4
    v_mov_b32 v9, v5
    v_mov_b32 v10, v6
    v_mov_b32 v11, v7
    v_mov_b32 v96, 0
    v_mov_b32 v97, 0
    v_mov_b32 v98, 0
    v_mov_b32 v99, 0
    v_mov_b32 v100, 0
    v_mov_b32 v101, 0
    v_mov_b32 v102, 0
    v_mov_b32 v103, 0
    v_mov_b32 v104, 0
    v_mov_b32 v105, 0
    v_mov_b32 v106, 0
    v_mov_b32 v107, 0
    v_mov_b32 v108, 0
    v_mov_b32 v109, 0
    v_mov_b32 v110, 0
    v_mov_b32 v111, 0
    v_mov_b32 v112, 0
    v_mov_b32 v113, 0
    v_mov_b32 v114, 0
    v_mov_b32 v115, 0
    v_mov_b32 v116, 0
    v_mov_b32 v117, 0
    v_mov_b32 v118, 0
    v_mov_b32 v119, 0
    v_mov_b32 v120, 0
    v_mov_b32 v121, 0
    v_mov_b32 v122, 0
    v_mov_b32 v123, 0
    v_mov_b32 v124, 0
    v_mov_b32 v125, 0
    v_mov_b32 v126, 0
    v_mov_b32 v127, 0
    v_mov_b32 v128, 0
    v_mov_b32 v129, 0
    v_mov_b32 v130, 0
    v_mov_b32 v131, 0
    v_mov_b32 v132, 0
    v_mov_b32 v133, 0
    v_mov_b32 v134, 0
    v_mov_b32 v135, 0
    v_mov_b32 v136, 0
    v_mov_b32 v137, 0
    v_mov_b32 v138, 0
    v_mov_b32 v139, 0
    v_mov_b32 v140, 0
    v_mov_b32 v141, 0
    v_mov_b32 v142, 0
    v_mov_b32 v143, 0
    v_mov_b32 v144, 0
    v_mov_b32 v145, 0
    v_mov_b32 v146, 0
    v_mov_b32 v147, 0
    v_mov_b32 v148, 0
    v_mov_b32 v149, 0
    v_mov_b32 v150, 0
    v_mov_b32 v151, 0
    v_mov_b32 v152, 0
    v_mov_b32 v153, 0
    v_mov_b32 v154, 0
    v_mov_b32 v155, 0
    v_mov_b32 v156, 0
    v_mov_b32 v157, 0
    v_mov_b32 v158, 0
    v_mov_b32 v159, 0
    v_mov_b32 v160, 0
    v_mov_b32 v161, 0
    v_mov_b32 v162, 0
    v_mov_b32 v163, 0
    v_mov_b32 v164, 0
    v_mov_b32 v165, 0
    v_mov_b32 v166, 0
    v_mov_b32 v167, 0
    v_mov_b32 v168, 0
    v_mov_b32 v169, 0
    v_mov_b32 v170, 0
    v_mov_b32 v171, 0
    v_mov_b32 v172, 0
    v_mov_b32 v173, 0
    v_mov_b32 v174, 0
    v_mov_b32 v175, 0
    v_mov_b32 v176, 0
    v_mov_b32 v177, 0
    v_mov_b32 v178, 0
    v_mov_b32 v179, 0
    v_mov_b32 v180, 0
    v_mov_b32 v181, 0
    v_mov_b32 v182, 0
    v_mov_b32 v183, 0
    v_mov_b32 v184, 0
    v_mov_b32 v185, 0
    v_mov_b32 v186, 0
    v_mov_b32 v187, 0
    v_mov_b32 v188, 0
    v_mov_b32 v189, 0
    v_mov_b32 v190, 0
    v_mov_b32 v191, 0
    v_lshlrev_b32 v12, 2, v2
    v_and_b32 v12, 63, v12
    v_add_u32 v12, 155648, v12
    ds_write_b32 v12, v96
    s_mov_b32 s70, 0x3fb8aa3b
    s_mov_b32 s71, 0x3fb8aa3b
    v_lshrrev_b32 v12, 3, v2
    s_lshl_b32 s67, s44, 3
    v_add_u32 v12, s67, v12
    v_lshlrev_b32 v12, 11, v12
    v_lshrrev_b32 v13, 4, v2
    v_lshlrev_b32 v13, 1, v13
    v_and_b32 v250, 7, v2
    v_xor_b32 v13, v13, v250
    v_lshl_add_u32 v12, v13, 4, v12
    s_lshl_b32 s66, s7, 7
    v_add_u32 v250, s66, v12
    s_lshl_b32 s66, s6, 7
    s_lshl_b32 s67, s44, 5
    s_add_u32 s66, s66, s67
    s_lshl_b32 s67, s45, 4
    s_add_u32 s66, s66, s67
    v_and_b32 v252, 15, v2
    v_add_u32 v252, s66, v252
    v_lshlrev_b32 v251, 11, v252
    v_bfe_u32 v12, v2, 4, 1
    v_lshl_add_u32 v251, v12, 5, v251
    v_lshrrev_b32 v12, 5, v2
    v_lshl_add_u32 v251, v12, 4, v251
    s_lshl_b32 s66, s7, 7
    v_add_u32 v251, s66, v251
    v_lshrrev_b32 v253, 2, v252
    v_lshlrev_b32 v253, 6, v253
    v_and_b32 v12, 3, v2
    v_lshl_add_u32 v253, v12, 2, v253
    s_lshl_b32 s66, s6, 1
    s_and_b32 s66, s66, 6
    s_lshl_b32 s67, s7, 3
    s_add_u32 s66, s66, s67
    s_and_b32 s66, s66, 7
    s_lshl_b32 s52, s66, 18
    s_lshr_b32 s49, s44, 1
    s_and_b32 s66, s44, 1
    s_lshl_b32 s66, s66, 2
    s_lshl_b32 s67, s45, 1
    s_add_u32 s66, s66, s67
    s_lshl_b32 s67, s4, 3
    s_add_u32 s66, s66, s67
    s_lshl_b32 s66, s66, 15
    s_lshl_b32 s67, s5, 11
    s_add_u32 s66, s66, s67
    s_lshl_b32 s67, s49, 10
    s_add_u32 s60, s66, s67
    s_add_u32 s61, s60, 32768
    s_lshl_b32 s58, s5, 2
    s_add_u32 s58, s58, s44
    s_lshl_b32 s66, s58, 14
    s_add_u32 s66, s66, 4194304
    v_lshlrev_b32 v12, 4, v2
    v_add_u32 v248, s66, v12
    s_lshl_b32 s66, s58, 10
    s_add_u32 s66, s66, 5242880
    v_and_b32 v12, 15, v2
    v_lshlrev_b32 v12, 6, v12
    v_lshrrev_b32 v13, 4, v2
    v_lshl_add_u32 v12, v13, 4, v12
    v_add_u32 v249, s66, v12
    s_lshr_b32 s57, s4, 3
    s_xor_b32 s57, s57, s4
    s_and_b32 s57, s57, 1
    s_lshl_b32 s57, s57, 13
    v_bfe_u32 v12, v2, 2, 2
    v_cmp_eq_u32 vcc, v12, v13
    v_mov_b32 v13, 0x3f80
    v_and_b32 v12, 1, v2
    v_lshlrev_b32 v12, 4, v12
    v_lshlrev_b32 v12, v12, v13
    v_cndmask_b32 v12, 0, v12, vcc
    v_and_b32 v13, 2, v2
    v_cmp_eq_u32 vcc, 0, v13
    s_nop 1
    v_cndmask_b32 v254, 0, v12, vcc
    v_cndmask_b32 v255, v12, 0, vcc
    s_mov_b32 s50, 0
    s_mov_b32 s51, 0
    s_waitcnt vmcnt(5) lgkmcnt(0)
    s_barrier
    ds_read_b64_tr_b16 v[32:33], v10 offset:0
    ds_read_b64_tr_b16 v[34:35], v10 offset:512
    ds_read_b128 v[16:19], v8 offset:0
    ds_read_b128 v[20:23], v8 offset:2048
    ds_read_b128 v[24:27], v8 offset:4096
    ds_read_b128 v[28:31], v8 offset:6144
    ds_read_b64_tr_b16 v[36:37], v11 offset:0
    ds_read_b64_tr_b16 v[38:39], v11 offset:512
    ds_read_b64_tr_b16 v[40:41], v10 offset:8192
    ds_read_b64_tr_b16 v[42:43], v10 offset:8704
    ds_read_b64_tr_b16 v[44:45], v11 offset:8192
    ds_read_b64_tr_b16 v[46:47], v11 offset:8704
    ds_read_b64_tr_b16 v[48:49], v10 offset:16384
    ds_read_b64_tr_b16 v[50:51], v10 offset:16896
    ds_read_b64_tr_b16 v[52:53], v11 offset:16384
    ds_read_b64_tr_b16 v[54:55], v11 offset:16896
.p2align 6
LOOP:
    s_waitcnt lgkmcnt(13)
    v_mfma_f32_16x16x32_bf16 v[96:99], v[32:35], v[16:19], v[96:99]
    ds_read_b64_tr_b16 v[72:73], v10 offset:4096
    s_waitcnt lgkmcnt(13)
    v_mfma_f32_16x16x32_bf16 v[104:107], v[32:35], v[20:23], v[104:107]
    ds_read_b64_tr_b16 v[74:75], v10 offset:4608
    s_waitcnt lgkmcnt(13)
    v_mfma_f32_16x16x32_bf16 v[112:115], v[32:35], v[24:27], v[112:115]
    ds_read_b128 v[56:59], v9 offset:0
    s_waitcnt lgkmcnt(13)
    v_mfma_f32_16x16x32_bf16 v[120:123], v[32:35], v[28:31], v[120:123]
    ds_read_b128 v[60:63], v9 offset:2048
    s_waitcnt lgkmcnt(12)
    v_mfma_f32_16x16x32_bf16 v[124:127], v[36:39], v[28:31], v[124:127]
    ds_read_b128 v[64:67], v9 offset:4096
    v_mfma_f32_16x16x32_bf16 v[116:119], v[36:39], v[24:27], v[116:119]
    ds_read_b128 v[68:71], v9 offset:6144
    v_mfma_f32_16x16x32_bf16 v[108:111], v[36:39], v[20:23], v[108:111]
    ds_read_b64_tr_b16 v[76:77], v11 offset:4096
    v_mfma_f32_16x16x32_bf16 v[100:103], v[36:39], v[16:19], v[100:103]
    ds_read_b64_tr_b16 v[78:79], v11 offset:4608
    s_waitcnt lgkmcnt(14)
    v_mfma_f32_16x16x32_bf16 v[128:131], v[16:19], v[40:43], v[128:131]
    ds_read_b64_tr_b16 v[80:81], v10 offset:12288
    v_mfma_f32_16x16x32_bf16 v[136:139], v[20:23], v[40:43], v[136:139]
    ds_read_b64_tr_b16 v[82:83], v10 offset:12800
    v_mfma_f32_16x16x32_bf16 v[144:147], v[24:27], v[40:43], v[144:147]
    ds_read_b64_tr_b16 v[84:85], v11 offset:12288
    v_mfma_f32_16x16x32_bf16 v[152:155], v[28:31], v[40:43], v[152:155]
    ds_read_b64_tr_b16 v[86:87], v11 offset:12800
    s_waitcnt lgkmcnt(15)
    v_mfma_f32_16x16x32_bf16 v[156:159], v[28:31], v[44:47], v[156:159]
    ds_read_b64_tr_b16 v[88:89], v10 offset:20480
    v_mfma_f32_16x16x32_bf16 v[148:151], v[24:27], v[44:47], v[148:151]
    ds_read_b64_tr_b16 v[90:91], v10 offset:20992
    v_mfma_f32_16x16x32_bf16 v[140:143], v[20:23], v[44:47], v[140:143]
    ds_read_b64_tr_b16 v[92:93], v11 offset:20480
    v_mfma_f32_16x16x32_bf16 v[132:135], v[16:19], v[44:47], v[132:135]
    ds_read_b64_tr_b16 v[94:95], v11 offset:20992
    s_waitcnt lgkmcnt(15)
    v_mfma_f32_16x16x32_bf16 v[160:163], v[16:19], v[48:51], v[160:163]
    v_mfma_f32_16x16x32_bf16 v[168:171], v[20:23], v[48:51], v[168:171]
    v_mfma_f32_16x16x32_bf16 v[176:179], v[24:27], v[48:51], v[176:179]
    v_mfma_f32_16x16x32_bf16 v[184:187], v[28:31], v[48:51], v[184:187]
    s_waitcnt lgkmcnt(15)
    v_mfma_f32_16x16x32_bf16 v[188:191], v[28:31], v[52:55], v[188:191]
    v_mfma_f32_16x16x32_bf16 v[180:183], v[24:27], v[52:55], v[180:183]
    v_mfma_f32_16x16x32_bf16 v[172:175], v[20:23], v[52:55], v[172:175]
    v_mfma_f32_16x16x32_bf16 v[164:167], v[16:19], v[52:55], v[164:167]
    s_waitcnt lgkmcnt(13)
    v_mfma_f32_16x16x32_bf16 v[96:99], v[72:75], v[56:59], v[96:99]
    s_add_u32 s50, s50, 40960
    s_cmp_eq_u32 s50, 122880
    s_cselect_b32 s50, 0, s50
    s_waitcnt lgkmcnt(12)
    v_mfma_f32_16x16x32_bf16 v[104:107], v[72:75], v[60:63], v[104:107]
    v_add_u32 v8, s50, v4
    s_waitcnt lgkmcnt(11)
    v_mfma_f32_16x16x32_bf16 v[112:115], v[72:75], v[64:67], v[112:115]
    v_add_u32 v9, s50, v5
    s_waitcnt lgkmcnt(10)
    v_mfma_f32_16x16x32_bf16 v[120:123], v[72:75], v[68:71], v[120:123]
    v_add_u32 v10, s50, v6
    s_waitcnt lgkmcnt(8)
    v_mfma_f32_16x16x32_bf16 v[124:127], v[76:79], v[68:71], v[124:127]
    v_add_u32 v11, s50, v7
    v_mfma_f32_16x16x32_bf16 v[116:119], v[76:79], v[64:67], v[116:119]
    s_waitcnt vmcnt(0) lgkmcnt(0)
    s_barrier
    v_mfma_f32_16x16x32_bf16 v[108:111], v[76:79], v[60:63], v[108:111]
    ds_read_b64_tr_b16 v[32:33], v10 offset:0
    v_mfma_f32_16x16x32_bf16 v[100:103], v[76:79], v[56:59], v[100:103]
    ds_read_b64_tr_b16 v[34:35], v10 offset:512
    v_mfma_f32_16x16x32_bf16 v[128:131], v[56:59], v[80:83], v[128:131]
    ds_read_b128 v[16:19], v8 offset:0
    v_mfma_f32_16x16x32_bf16 v[136:139], v[60:63], v[80:83], v[136:139]
    ds_read_b128 v[20:23], v8 offset:2048
    v_mfma_f32_16x16x32_bf16 v[144:147], v[64:67], v[80:83], v[144:147]
    ds_read_b128 v[24:27], v8 offset:4096
    v_mfma_f32_16x16x32_bf16 v[152:155], v[68:71], v[80:83], v[152:155]
    ds_read_b128 v[28:31], v8 offset:6144
    v_mfma_f32_16x16x32_bf16 v[156:159], v[68:71], v[84:87], v[156:159]
    ds_read_b64_tr_b16 v[36:37], v11 offset:0
    v_mfma_f32_16x16x32_bf16 v[148:151], v[64:67], v[84:87], v[148:151]
    ds_read_b64_tr_b16 v[38:39], v11 offset:512
    v_mfma_f32_16x16x32_bf16 v[140:143], v[60:63], v[84:87], v[140:143]
    ds_read_b64_tr_b16 v[40:41], v10 offset:8192
    v_mfma_f32_16x16x32_bf16 v[132:135], v[56:59], v[84:87], v[132:135]
    ds_read_b64_tr_b16 v[42:43], v10 offset:8704
    v_mfma_f32_16x16x32_bf16 v[160:163], v[56:59], v[88:91], v[160:163]
    ds_read_b64_tr_b16 v[44:45], v11 offset:8192
    v_mfma_f32_16x16x32_bf16 v[168:171], v[60:63], v[88:91], v[168:171]
    ds_read_b64_tr_b16 v[46:47], v11 offset:8704
    v_mfma_f32_16x16x32_bf16 v[176:179], v[64:67], v[88:91], v[176:179]
    ds_read_b64_tr_b16 v[48:49], v10 offset:16384
    v_mfma_f32_16x16x32_bf16 v[184:187], v[68:71], v[88:91], v[184:187]
    ds_read_b64_tr_b16 v[50:51], v10 offset:16896
    v_mfma_f32_16x16x32_bf16 v[188:191], v[68:71], v[92:95], v[188:191]
    ds_read_b64_tr_b16 v[52:53], v11 offset:16384
    v_mfma_f32_16x16x32_bf16 v[180:183], v[64:67], v[92:95], v[180:183]
    ds_read_b64_tr_b16 v[54:55], v11 offset:16896
    v_mfma_f32_16x16x32_bf16 v[172:175], v[60:63], v[92:95], v[172:175]
    v_mfma_f32_16x16x32_bf16 v[164:167], v[56:59], v[92:95], v[164:167]
    s_add_u32 s51, s51, 1
    s_cmp_lt_u32 s51, 13
    s_cbranch_scc1 LOOP
    s_waitcnt lgkmcnt(13)
    v_mfma_f32_16x16x32_bf16 v[96:99], v[32:35], v[16:19], v[96:99]
    ds_read_b64_tr_b16 v[72:73], v10 offset:12288
    v_add_u32 v12, 122880, v4
    s_waitcnt lgkmcnt(13)
    v_mfma_f32_16x16x32_bf16 v[104:107], v[32:35], v[20:23], v[104:107]
    ds_read_b64_tr_b16 v[74:75], v10 offset:12800
    v_add_u32 v13, 122880, v5
    s_waitcnt lgkmcnt(13)
    v_mfma_f32_16x16x32_bf16 v[112:115], v[32:35], v[24:27], v[112:115]
    ds_read_b128 v[56:59], v9 offset:0
    v_add_u32 v14, 114688, v6
    s_waitcnt lgkmcnt(13)
    v_mfma_f32_16x16x32_bf16 v[120:123], v[32:35], v[28:31], v[120:123]
    ds_read_b128 v[60:63], v9 offset:2048
    v_add_u32 v15, 114688, v7
    s_waitcnt lgkmcnt(12)
    v_mfma_f32_16x16x32_bf16 v[124:127], v[36:39], v[28:31], v[124:127]
    ds_read_b128 v[64:67], v9 offset:4096
    s_lshl_b32 s66, s3, 12
    v_mfma_f32_16x16x32_bf16 v[116:119], v[36:39], v[24:27], v[116:119]
    ds_read_b128 v[68:71], v9 offset:6144
    v_lshlrev_b32 v3, 4, v2
    v_mfma_f32_16x16x32_bf16 v[108:111], v[36:39], v[20:23], v[108:111]
    ds_read_b64_tr_b16 v[76:77], v11 offset:12288
    v_add_u32 v3, s66, v3
    v_mfma_f32_16x16x32_bf16 v[100:103], v[36:39], v[16:19], v[100:103]
    ds_read_b64_tr_b16 v[78:79], v11 offset:12800
    s_lshl_b32 s66, s3, 2
    s_waitcnt lgkmcnt(14)
    v_mfma_f32_16x16x32_bf16 v[128:131], v[16:19], v[40:43], v[128:131]
    ds_read_b64_tr_b16 v[80:81], v10 offset:20480
    s_add_u32 s66, s66, 155648
    v_mfma_f32_16x16x32_bf16 v[136:139], v[20:23], v[40:43], v[136:139]
    ds_read_b64_tr_b16 v[82:83], v10 offset:20992
    v_mov_b32 v1, s66
    v_mfma_f32_16x16x32_bf16 v[144:147], v[24:27], v[40:43], v[144:147]
    ds_read_b64_tr_b16 v[84:85], v11 offset:20480
    v_mov_b32 v0, 1
    v_mfma_f32_16x16x32_bf16 v[152:155], v[28:31], v[40:43], v[152:155]
    ds_read_b64_tr_b16 v[86:87], v11 offset:20992
    v_mov_b32 v88, v248
    s_waitcnt lgkmcnt(15)
    v_mfma_f32_16x16x32_bf16 v[156:159], v[28:31], v[44:47], v[156:159]
    v_mov_b32 v89, v249
    v_mfma_f32_16x16x32_bf16 v[148:151], v[24:27], v[44:47], v[148:151]
    v_mov_b32 v90, v250
    v_mfma_f32_16x16x32_bf16 v[140:143], v[20:23], v[44:47], v[140:143]
    v_mov_b32 v91, v251
    v_mfma_f32_16x16x32_bf16 v[132:135], v[16:19], v[44:47], v[132:135]
    v_mov_b32 v92, v252
    s_waitcnt lgkmcnt(14)
    v_mfma_f32_16x16x32_bf16 v[160:163], v[16:19], v[48:51], v[160:163]
    v_mov_b32 v93, v253
    v_mfma_f32_16x16x32_bf16 v[168:171], v[20:23], v[48:51], v[168:171]
    v_mov_b32 v94, v254
    v_mfma_f32_16x16x32_bf16 v[176:179], v[24:27], v[48:51], v[176:179]
    v_mov_b32 v95, v255
    v_mfma_f32_16x16x32_bf16 v[184:187], v[28:31], v[48:51], v[184:187]
    s_waitcnt lgkmcnt(12)
    v_mfma_f32_16x16x32_bf16 v[188:191], v[28:31], v[52:55], v[188:191]
    v_mfma_f32_16x16x32_bf16 v[180:183], v[24:27], v[52:55], v[180:183]
    v_mfma_f32_16x16x32_bf16 v[172:175], v[20:23], v[52:55], v[172:175]
    v_mfma_f32_16x16x32_bf16 v[164:167], v[16:19], v[52:55], v[164:167]
    s_waitcnt lgkmcnt(9)
    v_mfma_f32_16x16x32_bf16 v[128:131], v[56:59], v[72:75], v[128:131]
    s_waitcnt lgkmcnt(8)
    v_mfma_f32_16x16x32_bf16 v[136:139], v[60:63], v[72:75], v[136:139]
    s_waitcnt lgkmcnt(7)
    v_mfma_f32_16x16x32_bf16 v[144:147], v[64:67], v[72:75], v[144:147]
    s_waitcnt lgkmcnt(6)
    v_mfma_f32_16x16x32_bf16 v[152:155], v[68:71], v[72:75], v[152:155]
    s_waitcnt lgkmcnt(4)
    v_mfma_f32_16x16x32_bf16 v[156:159], v[68:71], v[76:79], v[156:159]
    v_mfma_f32_16x16x32_bf16 v[148:151], v[64:67], v[76:79], v[148:151]
    s_barrier
    v_mfma_f32_16x16x32_bf16 v[140:143], v[60:63], v[76:79], v[140:143]
    ds_read_b64_tr_b16 v[16:17], v10 offset:49152
    v_mfma_f32_16x16x32_bf16 v[132:135], v[56:59], v[76:79], v[132:135]
    ds_read_b64_tr_b16 v[18:19], v10 offset:49664
    s_waitcnt lgkmcnt(4)
    v_mfma_f32_16x16x32_bf16 v[160:163], v[56:59], v[80:83], v[160:163]
    ds_read_b128 v[192:195], v8 offset:40960
    v_mfma_f32_16x16x32_bf16 v[168:171], v[60:63], v[80:83], v[168:171]
    ds_read_b128 v[196:199], v8 offset:43008
    v_mfma_f32_16x16x32_bf16 v[176:179], v[64:67], v[80:83], v[176:179]
    ds_read_b128 v[200:203], v8 offset:45056
    v_mfma_f32_16x16x32_bf16 v[184:187], v[68:71], v[80:83], v[184:187]
    ds_read_b128 v[204:207], v8 offset:47104
    s_waitcnt lgkmcnt(6)
    v_mfma_f32_16x16x32_bf16 v[188:191], v[68:71], v[84:87], v[188:191]
    ds_read_b64_tr_b16 v[20:21], v11 offset:49152
    v_mfma_f32_16x16x32_bf16 v[180:183], v[64:67], v[84:87], v[180:183]
    ds_read_b64_tr_b16 v[22:23], v11 offset:49664
    v_mfma_f32_16x16x32_bf16 v[172:175], v[60:63], v[84:87], v[172:175]
    v_mfma_f32_16x16x32_bf16 v[164:167], v[56:59], v[84:87], v[164:167]
    s_waitcnt lgkmcnt(5)
    v_mfma_f32_16x16x32_bf16 v[128:131], v[192:195], v[16:19], v[128:131]
    ds_read_b64_tr_b16 v[24:25], v10 offset:53248
    ds_read_b64_tr_b16 v[26:27], v10 offset:53760
    s_waitcnt lgkmcnt(6)
    v_mfma_f32_16x16x32_bf16 v[136:139], v[196:199], v[16:19], v[136:139]
    ds_read_b128 v[208:211], v9 offset:40960
    ds_read_b128 v[212:215], v9 offset:43008
    s_waitcnt lgkmcnt(7)
    v_mfma_f32_16x16x32_bf16 v[144:147], v[200:203], v[16:19], v[144:147]
    ds_read_b128 v[216:219], v9 offset:45056
    s_waitcnt lgkmcnt(7)
    v_mfma_f32_16x16x32_bf16 v[152:155], v[204:207], v[16:19], v[152:155]
    ds_read_b128 v[220:223], v9 offset:47104
    s_waitcnt lgkmcnt(6)
    v_mfma_f32_16x16x32_bf16 v[156:159], v[204:207], v[20:23], v[156:159]
    ds_read_b64_tr_b16 v[28:29], v11 offset:53248
    v_mfma_f32_16x16x32_bf16 v[148:151], v[200:203], v[20:23], v[148:151]
    ds_read_b64_tr_b16 v[30:31], v11 offset:53760
    v_mfma_f32_16x16x32_bf16 v[140:143], v[196:199], v[20:23], v[140:143]
    v_mfma_f32_16x16x32_bf16 v[132:135], v[192:195], v[20:23], v[132:135]
    s_waitcnt lgkmcnt(5)
    v_mfma_f32_16x16x32_bf16 v[128:131], v[208:211], v[24:27], v[128:131]
    ds_read_b64_tr_b16 v[32:33], v10 offset:4096
    s_waitcnt lgkmcnt(5)
    v_mfma_f32_16x16x32_bf16 v[136:139], v[212:215], v[24:27], v[136:139]
    ds_read_b64_tr_b16 v[34:35], v10 offset:4608
    s_waitcnt lgkmcnt(5)
    v_mfma_f32_16x16x32_bf16 v[144:147], v[216:219], v[24:27], v[144:147]
    ds_read_b64_tr_b16 v[36:37], v11 offset:4096
    s_waitcnt lgkmcnt(5)
    v_mfma_f32_16x16x32_bf16 v[152:155], v[220:223], v[24:27], v[152:155]
    ds_read_b64_tr_b16 v[38:39], v11 offset:4608
    s_waitcnt lgkmcnt(4)
    v_mfma_f32_16x16x32_bf16 v[156:159], v[220:223], v[28:31], v[156:159]
    v_mfma_f32_16x16x32_bf16 v[148:151], v[216:219], v[28:31], v[148:151]
    v_mfma_f32_16x16x32_bf16 v[140:143], v[212:215], v[28:31], v[140:143]
    v_mfma_f32_16x16x32_bf16 v[132:135], v[208:211], v[28:31], v[132:135]
    s_waitcnt lgkmcnt(2)
    v_mfma_f32_16x16x32_bf16 v[96:99], v[32:35], v[56:59], v[96:99]
    v_mfma_f32_16x16x32_bf16 v[104:107], v[32:35], v[60:63], v[104:107]
    s_barrier
    v_mfma_f32_16x16x32_bf16 v[112:115], v[32:35], v[64:67], v[112:115]
    ds_read_b64_tr_b16 v[16:17], v14 offset:8192
    ds_read_b64_tr_b16 v[18:19], v14 offset:8704
    v_mfma_f32_16x16x32_bf16 v[120:123], v[32:35], v[68:71], v[120:123]
    ds_read_b128 v[224:227], v12 offset:0
    ds_read_b128 v[228:231], v12 offset:2048
    s_waitcnt lgkmcnt(4)
    v_mfma_f32_16x16x32_bf16 v[124:127], v[36:39], v[68:71], v[124:127]
    ds_read_b128 v[232:235], v12 offset:4096
    ds_read_b128 v[236:239], v12 offset:6144
    v_mfma_f32_16x16x32_bf16 v[116:119], v[36:39], v[64:67], v[116:119]
    ds_read_b64_tr_b16 v[20:21], v15 offset:8192
    ds_read_b64_tr_b16 v[22:23], v15 offset:8704
    v_mfma_f32_16x16x32_bf16 v[108:111], v[36:39], v[60:63], v[108:111]
    v_mfma_f32_16x16x32_bf16 v[100:103], v[36:39], v[56:59], v[100:103]
    s_waitcnt lgkmcnt(5)
    v_mfma_f32_16x16x32_bf16 v[128:131], v[224:227], v[16:19], v[128:131]
    ds_read_b64_tr_b16 v[24:25], v14 offset:12288
    ds_read_b64_tr_b16 v[26:27], v14 offset:12800
    s_waitcnt lgkmcnt(6)
    v_mfma_f32_16x16x32_bf16 v[136:139], v[228:231], v[16:19], v[136:139]
    ds_read_b128 v[240:243], v13 offset:0
    ds_read_b128 v[244:247], v13 offset:2048
    s_waitcnt lgkmcnt(7)
    v_mfma_f32_16x16x32_bf16 v[144:147], v[232:235], v[16:19], v[144:147]
    ds_read_b128 v[248:251], v13 offset:4096
    s_waitcnt lgkmcnt(7)
    v_mfma_f32_16x16x32_bf16 v[152:155], v[236:239], v[16:19], v[152:155]
    ds_read_b128 v[252:255], v13 offset:6144
    s_waitcnt lgkmcnt(6)
    v_mfma_f32_16x16x32_bf16 v[156:159], v[236:239], v[20:23], v[156:159]
    ds_read_b64_tr_b16 v[28:29], v15 offset:12288
    v_mfma_f32_16x16x32_bf16 v[148:151], v[232:235], v[20:23], v[148:151]
    ds_read_b64_tr_b16 v[30:31], v15 offset:12800
    v_mfma_f32_16x16x32_bf16 v[140:143], v[228:231], v[20:23], v[140:143]
    v_mfma_f32_16x16x32_bf16 v[132:135], v[224:227], v[20:23], v[132:135]
    s_waitcnt lgkmcnt(5)
    v_mfma_f32_16x16x32_bf16 v[128:131], v[240:243], v[24:27], v[128:131]
    ds_read_b64_tr_b16 v[32:33], v10 offset:57344
    s_waitcnt lgkmcnt(5)
    v_mfma_f32_16x16x32_bf16 v[136:139], v[244:247], v[24:27], v[136:139]
    ds_read_b64_tr_b16 v[34:35], v10 offset:57856
    s_waitcnt lgkmcnt(5)
    v_mfma_f32_16x16x32_bf16 v[144:147], v[248:251], v[24:27], v[144:147]
    ds_read_b64_tr_b16 v[36:37], v11 offset:57344
    s_waitcnt lgkmcnt(5)
    v_mfma_f32_16x16x32_bf16 v[152:155], v[252:255], v[24:27], v[152:155]
    ds_read_b64_tr_b16 v[38:39], v11 offset:57856
    s_waitcnt lgkmcnt(4)
    v_mfma_f32_16x16x32_bf16 v[156:159], v[252:255], v[28:31], v[156:159]
    v_mfma_f32_16x16x32_bf16 v[148:151], v[248:251], v[28:31], v[148:151]
    v_mfma_f32_16x16x32_bf16 v[140:143], v[244:247], v[28:31], v[140:143]
    v_mfma_f32_16x16x32_bf16 v[132:135], v[240:243], v[28:31], v[132:135]
    s_waitcnt lgkmcnt(2)
    v_mfma_f32_16x16x32_bf16 v[160:163], v[192:195], v[32:35], v[160:163]
    ds_read_b64_tr_b16 v[16:17], v10 offset:61440
    s_nop 5
    v_cvt_pk_bf16_f32 v40, v128, v129
    v_cvt_pk_bf16_f32 v41, v130, v131
    v_mfma_f32_16x16x32_bf16 v[168:171], v[196:199], v[32:35], v[168:171]
    ds_read_b64_tr_b16 v[18:19], v10 offset:61952
    v_cvt_pk_bf16_f32 v42, v136, v137
    v_cvt_pk_bf16_f32 v43, v138, v139
    ds_write_b128 v3, v[40:43] offset:0
    v_mfma_f32_16x16x32_bf16 v[176:179], v[200:203], v[32:35], v[176:179]
    ds_read_b64_tr_b16 v[20:21], v11 offset:61440
    v_cvt_pk_bf16_f32 v44, v132, v133
    v_cvt_pk_bf16_f32 v45, v134, v135
    v_cvt_pk_bf16_f32 v46, v140, v141
    v_mfma_f32_16x16x32_bf16 v[184:187], v[204:207], v[32:35], v[184:187]
    ds_read_b64_tr_b16 v[22:23], v11 offset:61952
    v_cvt_pk_bf16_f32 v47, v142, v143
    ds_write_b128 v3, v[44:47] offset:1024
    v_cvt_pk_bf16_f32 v48, v144, v145
    s_waitcnt lgkmcnt(6)
    v_mfma_f32_16x16x32_bf16 v[188:191], v[204:207], v[36:39], v[188:191]
    v_cvt_pk_bf16_f32 v49, v146, v147
    v_cvt_pk_bf16_f32 v50, v152, v153
    v_cvt_pk_bf16_f32 v51, v154, v155
    v_mfma_f32_16x16x32_bf16 v[180:183], v[200:203], v[36:39], v[180:183]
    ds_write_b128 v3, v[48:51] offset:2048
    v_cvt_pk_bf16_f32 v52, v148, v149
    v_cvt_pk_bf16_f32 v53, v150, v151
    v_mfma_f32_16x16x32_bf16 v[172:175], v[196:199], v[36:39], v[172:175]
    v_cvt_pk_bf16_f32 v54, v156, v157
    v_cvt_pk_bf16_f32 v55, v158, v159
    v_mfma_f32_16x16x32_bf16 v[164:167], v[192:195], v[36:39], v[164:167]
    ds_write_b128 v3, v[52:55] offset:3072
    ds_write_b32 v1, v0
    s_waitcnt lgkmcnt(7)
    v_mfma_f32_16x16x32_bf16 v[160:163], v[208:211], v[16:19], v[160:163]
    ds_read_b64_tr_b16 v[24:25], v14 offset:16384
    v_pk_max_u16 v72, v40, v41
    v_mfma_f32_16x16x32_bf16 v[168:171], v[212:215], v[16:19], v[168:171]
    ds_read_b64_tr_b16 v[26:27], v14 offset:16896
    v_pk_max_u16 v72, v72, v42
    v_mfma_f32_16x16x32_bf16 v[176:179], v[216:219], v[16:19], v[176:179]
    ds_read_b64_tr_b16 v[28:29], v15 offset:16384
    v_pk_max_u16 v72, v72, v43
    v_mfma_f32_16x16x32_bf16 v[184:187], v[220:223], v[16:19], v[184:187]
    ds_read_b64_tr_b16 v[30:31], v15 offset:16896
    v_pk_max_u16 v72, v72, v44
    s_waitcnt lgkmcnt(8)
    v_mfma_f32_16x16x32_bf16 v[188:191], v[220:223], v[20:23], v[188:191]
    v_pk_max_u16 v72, v72, v45
    v_mfma_f32_16x16x32_bf16 v[180:183], v[216:219], v[20:23], v[180:183]
    v_pk_max_u16 v72, v72, v46
    v_mfma_f32_16x16x32_bf16 v[172:175], v[212:215], v[20:23], v[172:175]
    v_pk_max_u16 v72, v72, v47
    v_mfma_f32_16x16x32_bf16 v[164:167], v[208:211], v[20:23], v[164:167]
    s_waitcnt lgkmcnt(2)
    v_mfma_f32_16x16x32_bf16 v[160:163], v[224:227], v[24:27], v[160:163]
    ds_read_b64_tr_b16 v[32:33], v14 offset:20480
    v_pk_max_u16 v72, v72, v48
    v_mfma_f32_16x16x32_bf16 v[168:171], v[228:231], v[24:27], v[168:171]
    ds_read_b64_tr_b16 v[34:35], v14 offset:20992
    v_pk_max_u16 v72, v72, v49
    v_mfma_f32_16x16x32_bf16 v[176:179], v[232:235], v[24:27], v[176:179]
    ds_read_b64_tr_b16 v[36:37], v15 offset:20480
    v_pk_max_u16 v72, v72, v50
    v_mfma_f32_16x16x32_bf16 v[184:187], v[236:239], v[24:27], v[184:187]
    ds_read_b64_tr_b16 v[38:39], v15 offset:20992
    v_pk_max_u16 v72, v72, v51
    s_waitcnt lgkmcnt(4)
    v_mfma_f32_16x16x32_bf16 v[188:191], v[236:239], v[28:31], v[188:191]
    v_pk_max_u16 v72, v72, v52
    v_mfma_f32_16x16x32_bf16 v[180:183], v[232:235], v[28:31], v[180:183]
    v_pk_max_u16 v72, v72, v53
    v_mfma_f32_16x16x32_bf16 v[172:175], v[228:231], v[28:31], v[172:175]
    v_pk_max_u16 v72, v72, v54
    v_mfma_f32_16x16x32_bf16 v[164:167], v[224:227], v[28:31], v[164:167]
    v_pk_max_u16 v72, v72, v55
    s_waitcnt lgkmcnt(2)
    v_mfma_f32_16x16x32_bf16 v[160:163], v[240:243], v[32:35], v[160:163]
    ds_read_b64_tr_b16 v[16:17], v10 offset:40960
    v_add_u32 v3, 65536, v3
    v_mfma_f32_16x16x32_bf16 v[168:171], v[244:247], v[32:35], v[168:171]
    ds_read_b64_tr_b16 v[18:19], v10 offset:41472
    v_lshrrev_b32 v73, 16, v72
    v_mfma_f32_16x16x32_bf16 v[176:179], v[248:251], v[32:35], v[176:179]
    ds_read_b64_tr_b16 v[20:21], v11 offset:40960
    v_and_b32 v72, 0xffff, v72
    v_mfma_f32_16x16x32_bf16 v[184:187], v[252:255], v[32:35], v[184:187]
    ds_read_b64_tr_b16 v[22:23], v11 offset:41472
    v_max_u32 v72, v72, v73
    s_waitcnt lgkmcnt(4)
    v_mfma_f32_16x16x32_bf16 v[188:191], v[252:255], v[36:39], v[188:191]
    v_cmp_lt_u32 vcc, 0xc0db, v72
    v_mfma_f32_16x16x32_bf16 v[180:183], v[248:251], v[36:39], v[180:183]
    s_cmp_lg_u64 vcc, 0
    v_mfma_f32_16x16x32_bf16 v[172:175], v[244:247], v[36:39], v[172:175]
    s_cselect_b32 s66, 2, 1
    v_mfma_f32_16x16x32_bf16 v[164:167], v[240:243], v[36:39], v[164:167]
    v_mov_b32 v0, s66
    s_waitcnt lgkmcnt(2)
    v_mfma_f32_16x16x32_bf16 v[96:99], v[16:19], v[192:195], v[96:99]
    ds_read_b64_tr_b16 v[24:25], v10 offset:45056
    s_nop 5
    v_cvt_pk_bf16_f32 v40, v160, v161
    v_cvt_pk_bf16_f32 v41, v162, v163
    v_mfma_f32_16x16x32_bf16 v[104:107], v[16:19], v[196:199], v[104:107]
    ds_read_b64_tr_b16 v[26:27], v10 offset:45568
    v_cvt_pk_bf16_f32 v42, v168, v169
    v_cvt_pk_bf16_f32 v43, v170, v171
    ds_write_b128 v3, v[40:43] offset:0
    v_mfma_f32_16x16x32_bf16 v[112:115], v[16:19], v[200:203], v[112:115]
    ds_read_b64_tr_b16 v[28:29], v11 offset:45056
    v_cvt_pk_bf16_f32 v44, v164, v165
    v_cvt_pk_bf16_f32 v45, v166, v167
    v_cvt_pk_bf16_f32 v46, v172, v173
    v_mfma_f32_16x16x32_bf16 v[120:123], v[16:19], v[204:207], v[120:123]
    ds_read_b64_tr_b16 v[30:31], v11 offset:45568
    v_cvt_pk_bf16_f32 v47, v174, v175
    ds_write_b128 v3, v[44:47] offset:1024
    v_cvt_pk_bf16_f32 v48, v176, v177
    s_waitcnt lgkmcnt(6)
    v_mfma_f32_16x16x32_bf16 v[124:127], v[20:23], v[204:207], v[124:127]
    v_cvt_pk_bf16_f32 v49, v178, v179
    v_cvt_pk_bf16_f32 v50, v184, v185
    v_cvt_pk_bf16_f32 v51, v186, v187
    v_mfma_f32_16x16x32_bf16 v[116:119], v[20:23], v[200:203], v[116:119]
    ds_write_b128 v3, v[48:51] offset:2048
    v_cvt_pk_bf16_f32 v52, v180, v181
    v_cvt_pk_bf16_f32 v53, v182, v183
    v_mfma_f32_16x16x32_bf16 v[108:111], v[20:23], v[196:199], v[108:111]
    v_cvt_pk_bf16_f32 v54, v188, v189
    v_cvt_pk_bf16_f32 v55, v190, v191
    v_mfma_f32_16x16x32_bf16 v[100:103], v[20:23], v[192:195], v[100:103]
    ds_write_b128 v3, v[52:55] offset:3072
    ds_write_b32 v1, v0 offset:16
    s_waitcnt lgkmcnt(7)
    v_mfma_f32_16x16x32_bf16 v[96:99], v[24:27], v[208:211], v[96:99]
    ds_read_b64_tr_b16 v[32:33], v6 offset:0
    v_lshlrev_b32 v9, 4, v2
    v_mfma_f32_16x16x32_bf16 v[104:107], v[24:27], v[212:215], v[104:107]
    ds_read_b64_tr_b16 v[34:35], v6 offset:512
    v_mov_b32 v136, 0
    v_mfma_f32_16x16x32_bf16 v[112:115], v[24:27], v[216:219], v[112:115]
    ds_read_b64_tr_b16 v[36:37], v7 offset:0
    v_mov_b32 v137, 0
    v_mfma_f32_16x16x32_bf16 v[120:123], v[24:27], v[220:223], v[120:123]
    ds_read_b64_tr_b16 v[38:39], v7 offset:512
    v_mov_b32 v140, 0
    s_waitcnt lgkmcnt(8)
    v_mfma_f32_16x16x32_bf16 v[124:127], v[28:31], v[220:223], v[124:127]
    v_mov_b32 v141, 0
    v_mfma_f32_16x16x32_bf16 v[116:119], v[28:31], v[216:219], v[116:119]
    v_mov_b32 v138, v94
    v_mfma_f32_16x16x32_bf16 v[108:111], v[28:31], v[212:215], v[108:111]
    v_mov_b32 v139, v95
    v_mfma_f32_16x16x32_bf16 v[100:103], v[28:31], v[208:211], v[100:103]
    s_waitcnt lgkmcnt(2)
    v_mfma_f32_16x16x32_bf16 v[96:99], v[32:35], v[224:227], v[96:99]
    ds_read_b64_tr_b16 v[16:17], v6 offset:4096
    v_bfe_u32 v77, v2, 4, 1
    v_lshrrev_b32 v78, 5, v2
    v_mfma_f32_16x16x32_bf16 v[104:107], v[32:35], v[228:231], v[104:107]
    ds_read_b64_tr_b16 v[18:19], v6 offset:4608
    v_lshl_add_u32 v77, v77, 1, v78
    v_bfe_u32 v78, v2, 1, 3
    v_mfma_f32_16x16x32_bf16 v[112:115], v[32:35], v[232:235], v[112:115]
    ds_read_b64_tr_b16 v[20:21], v7 offset:4096
    v_xor_b32 v77, v77, v78
    v_and_b32 v78, 127, v92
    v_mfma_f32_16x16x32_bf16 v[120:123], v[32:35], v[236:239], v[120:123]
    ds_read_b64_tr_b16 v[22:23], v7 offset:4608
    v_lshlrev_b32 v78, 7, v78
    v_lshl_add_u32 v77, v77, 4, v78
    s_waitcnt lgkmcnt(4)
    v_mfma_f32_16x16x32_bf16 v[124:127], v[36:39], v[236:239], v[124:127]
    v_add_u32 v77, 122880, v77
    v_xor_b32 v78, 64, v77
    v_mfma_f32_16x16x32_bf16 v[116:119], v[36:39], v[232:235], v[116:119]
    ds_read_b128 v[144:147], v77
    v_mfma_f32_16x16x32_bf16 v[108:111], v[36:39], v[228:231], v[108:111]
    ds_read_b128 v[148:151], v78
    v_mfma_f32_16x16x32_bf16 v[100:103], v[36:39], v[224:227], v[100:103]
    v_mov_b32 v76, 155664
    s_waitcnt lgkmcnt(4)
    v_mfma_f32_16x16x32_bf16 v[96:99], v[16:19], v[240:243], v[96:99]
    ds_read_b128 v[72:75], v76
    v_mfma_f32_16x16x32_bf16 v[104:107], v[16:19], v[244:247], v[104:107]
    v_mfma_f32_16x16x32_bf16 v[112:115], v[16:19], v[248:251], v[112:115]
    v_mfma_f32_16x16x32_bf16 v[120:123], v[16:19], v[252:255], v[120:123]
    s_waitcnt lgkmcnt(3)
    v_mfma_f32_16x16x32_bf16 v[124:127], v[20:23], v[252:255], v[124:127]
    v_mfma_f32_16x16x32_bf16 v[116:119], v[20:23], v[248:251], v[116:119]
    v_mfma_f32_16x16x32_bf16 v[108:111], v[20:23], v[244:247], v[108:111]
    v_mfma_f32_16x16x32_bf16 v[100:103], v[20:23], v[240:243], v[100:103]
    s_nop 7
    v_cvt_pk_bf16_f32 v16, v96, v97
    v_cvt_pk_bf16_f32 v17, v98, v99
    v_cvt_pk_bf16_f32 v18, v100, v101
    v_cvt_pk_bf16_f32 v19, v102, v103
    v_cvt_pk_bf16_f32 v20, v104, v105
    v_cvt_pk_bf16_f32 v21, v106, v107
    v_cvt_pk_bf16_f32 v22, v108, v109
    v_cvt_pk_bf16_f32 v23, v110, v111
    v_cvt_pk_bf16_f32 v40, v112, v113
    v_cvt_pk_bf16_f32 v41, v114, v115
    v_cvt_pk_bf16_f32 v42, v116, v117
    v_cvt_pk_bf16_f32 v43, v118, v119
    v_cvt_pk_bf16_f32 v44, v120, v121
    v_cvt_pk_bf16_f32 v45, v122, v123
    v_cvt_pk_bf16_f32 v46, v124, v125
    v_cvt_pk_bf16_f32 v47, v126, v127
    s_lshl_b32 s66, s3, 11
    s_add_u32 s66, s66, 139264
    v_lshlrev_b32 v3, 4, v2
    v_add_u32 v3, s66, v3
C_qw:
    s_waitcnt lgkmcnt(0)
    v_min_u32 v72, v72, v73
    v_min3_u32 v72, v72, v74, v75
    v_cmp_eq_u32 vcc, 0, v72
    s_cbranch_vccz C_qg
    ds_read_b128 v[72:75], v76
    s_branch C_qw
C_qg:
    ds_write_b128 v3, v[40:43]
    ds_write_b128 v3, v[44:47] offset:1024
    s_waitcnt lgkmcnt(0)
    s_barrier
    v_lshlrev_b32 v32, 16, v16
    v_and_b32 v33, 0xffff0000, v16
    v_pk_mul_f32 v[34:35], v[32:33], s[70:71]
    v_pk_add_f32 v[32:33], v[32:33], 1.0 op_sel_hi:[1,0]
    v_exp_f32 v34, v34 clamp
    v_exp_f32 v35, v35 clamp
    v_lshlrev_b32 v36, 16, v17
    v_and_b32 v37, 0xffff0000, v17
    v_pk_mul_f32 v[38:39], v[36:37], s[70:71]
    v_pk_add_f32 v[36:37], v[36:37], 1.0 op_sel_hi:[1,0]
    v_exp_f32 v38, v38 clamp
    v_exp_f32 v39, v39 clamp
    v_max_f32 v32, v32, v34
    v_max_f32 v33, v33, v35
    v_min_f32 v40, v32, v33
    v_cvt_pk_bf16_f32 v24, v32, v33
    v_max_f32 v36, v36, v38
    v_max_f32 v37, v37, v39
    v_min3_f32 v40, v36, v37, v40
    v_cvt_pk_bf16_f32 v25, v36, v37
    v_lshlrev_b32 v32, 16, v18
    v_and_b32 v33, 0xffff0000, v18
    v_pk_mul_f32 v[34:35], v[32:33], s[70:71]
    v_pk_add_f32 v[32:33], v[32:33], 1.0 op_sel_hi:[1,0]
    v_exp_f32 v34, v34 clamp
    v_exp_f32 v35, v35 clamp
    v_lshlrev_b32 v36, 16, v19
    v_and_b32 v37, 0xffff0000, v19
    v_pk_mul_f32 v[38:39], v[36:37], s[70:71]
    v_pk_add_f32 v[36:37], v[36:37], 1.0 op_sel_hi:[1,0]
    v_exp_f32 v38, v38 clamp
    v_exp_f32 v39, v39 clamp
    v_max_f32 v32, v32, v34
    v_max_f32 v33, v33, v35
    v_min3_f32 v40, v32, v33, v40
    v_cvt_pk_bf16_f32 v26, v32, v33
    v_max_f32 v36, v36, v38
    v_max_f32 v37, v37, v39
    v_min3_f32 v40, v36, v37, v40
    v_cvt_pk_bf16_f32 v27, v36, v37
    v_lshlrev_b32 v32, 16, v20
    v_and_b32 v33, 0xffff0000, v20
    v_pk_mul_f32 v[34:35], v[32:33], s[70:71]
    v_pk_add_f32 v[32:33], v[32:33], 1.0 op_sel_hi:[1,0]
    v_exp_f32 v34, v34 clamp
    v_exp_f32 v35, v35 clamp
    v_lshlrev_b32 v36, 16, v21
    v_and_b32 v37, 0xffff0000, v21
    v_pk_mul_f32 v[38:39], v[36:37], s[70:71]
    v_pk_add_f32 v[36:37], v[36:37], 1.0 op_sel_hi:[1,0]
    v_exp_f32 v38, v38 clamp
    v_exp_f32 v39, v39 clamp
    v_max_f32 v32, v32, v34
    v_max_f32 v33, v33, v35
    v_min3_f32 v40, v32, v33, v40
    v_cvt_pk_bf16_f32 v28, v32, v33
    v_max_f32 v36, v36, v38
    v_max_f32 v37, v37, v39
    v_min3_f32 v40, v36, v37, v40
    v_cvt_pk_bf16_f32 v29, v36, v37
    v_lshlrev_b32 v32, 16, v22
    v_and_b32 v33, 0xffff0000, v22
    v_pk_mul_f32 v[34:35], v[32:33], s[70:71]
    v_pk_add_f32 v[32:33], v[32:33], 1.0 op_sel_hi:[1,0]
    v_exp_f32 v34, v34 clamp
    v_exp_f32 v35, v35 clamp
    v_lshlrev_b32 v36, 16, v23
    v_and_b32 v37, 0xffff0000, v23
    v_pk_mul_f32 v[38:39], v[36:37], s[70:71]
    v_pk_add_f32 v[36:37], v[36:37], 1.0 op_sel_hi:[1,0]
    v_exp_f32 v38, v38 clamp
    v_exp_f32 v39, v39 clamp
    v_max_f32 v32, v32, v34
    v_max_f32 v33, v33, v35
    v_min3_f32 v40, v32, v33, v40
    v_cvt_pk_bf16_f32 v30, v32, v33
    v_max_f32 v36, v36, v38
    v_max_f32 v37, v37, v39
    v_min3_f32 v40, v36, v37, v40
    v_cvt_pk_bf16_f32 v31, v36, v37
    v_cmp_gt_f32 vcc, 0x3a800000, v40
    s_cbranch_vccz P_qd
    v_lshlrev_b32 v32, 16, v24
    v_and_b32 v33, 0xffff0000, v24
    v_add_f32 v32, s47, v32
    v_add_f32 v33, s47, v33
    v_cvt_pk_bf16_f32 v24, v32, v33
    v_lshlrev_b32 v32, 16, v25
    v_and_b32 v33, 0xffff0000, v25
    v_add_f32 v32, s47, v32
    v_add_f32 v33, s47, v33
    v_cvt_pk_bf16_f32 v25, v32, v33
    v_lshlrev_b32 v32, 16, v26
    v_and_b32 v33, 0xffff0000, v26
    v_add_f32 v32, s47, v32
    v_add_f32 v33, s47, v33
    v_cvt_pk_bf16_f32 v26, v32, v33
    v_lshlrev_b32 v32, 16, v27
    v_and_b32 v33, 0xffff0000, v27
    v_add_f32 v32, s47, v32
    v_add_f32 v33, s47, v33
    v_cvt_pk_bf16_f32 v27, v32, v33
    v_lshlrev_b32 v32, 16, v28
    v_and_b32 v33, 0xffff0000, v28
    v_add_f32 v32, s47, v32
    v_add_f32 v33, s47, v33
    v_cvt_pk_bf16_f32 v28, v32, v33
    v_lshlrev_b32 v32, 16, v29
    v_and_b32 v33, 0xffff0000, v29
    v_add_f32 v32, s47, v32
    v_add_f32 v33, s47, v33
    v_cvt_pk_bf16_f32 v29, v32, v33
    v_lshlrev_b32 v32, 16, v30
    v_and_b32 v33, 0xffff0000, v30
    v_add_f32 v32, s47, v32
    v_add_f32 v33, s47, v33
    v_cvt_pk_bf16_f32 v30, v32, v33
    v_lshlrev_b32 v32, 16, v31
    v_and_b32 v33, 0xffff0000, v31
    v_add_f32 v32, s47, v32
    v_add_f32 v33, s47, v33
    v_cvt_pk_bf16_f32 v31, v32, v33
P_qd:
    buffer_load_dwordx4 v[232:235], v89, s[16:19], 0 offen sc1
    s_lshl_b32 s66, s49, 11
    s_add_u32 s66, s66, 159744
    v_add_u32 v10, s66, v9
    s_lshl_b32 s66, s49, 6
    s_add_u32 s66, s66, 159488
    v_lshrrev_b32 v11, 4, v2
    v_lshlrev_b32 v11, 4, v11
    v_add_u32 v11, s66, v11
    s_lshr_b32 s66, s44, 1
    s_lshl_b32 s67, s66, 11
    s_lshl_b32 s66, s66, 6
    s_and_b32 s59, s44, 1
    s_lshl_b32 s59, s59, 3
    s_add_u32 s66, s66, s59
    s_add_u32 s67, s67, s59
    s_add_u32 s66, s66, 159488
    s_add_u32 s67, s67, 159744
    v_add_u32 v12, s67, v9
    v_lshrrev_b32 v13, 4, v2
    v_lshlrev_b32 v13, 4, v13
    v_add_u32 v13, s66, v13
    s_mov_b32 s59, 0
P_z:
    s_add_u32 s59, s59, 1
    s_cmp_ge_u32 s59, 200000
    s_waitcnt vmcnt(0)
    s_cbranch_scc1 P_zk
    v_max_u32 v14, v232, v233
    v_max3_u32 v14, v14, v234, v235
    v_cmp_eq_u32 vcc, -1, v14
    s_cbranch_vccz P_zk
    buffer_load_dwordx4 v[232:235], v89, s[16:19], 0 offen sc1
    s_branch P_z
P_zk:
    s_xor_b32 s66, s57, 0
    buffer_load_dwordx4 v[160:163], v88, s[16:19], s66 offen offset:0 sc1
    s_xor_b32 s66, s57, 0
    buffer_load_dwordx4 v[164:167], v88, s[16:19], s66 offen offset:1024 sc1
    s_xor_b32 s66, s57, 0
    buffer_load_dwordx4 v[168:171], v88, s[16:19], s66 offen offset:2048 sc1
    s_xor_b32 s66, s57, 0
    buffer_load_dwordx4 v[172:175], v88, s[16:19], s66 offen offset:3072 sc1
    s_xor_b32 s66, s57, 4096
    buffer_load_dwordx4 v[176:179], v88, s[16:19], s66 offen offset:0 sc1
    s_xor_b32 s66, s57, 4096
    buffer_load_dwordx4 v[180:183], v88, s[16:19], s66 offen offset:1024 sc1
    s_xor_b32 s66, s57, 4096
    buffer_load_dwordx4 v[184:187], v88, s[16:19], s66 offen offset:2048 sc1
    s_xor_b32 s66, s57, 4096
    buffer_load_dwordx4 v[188:191], v88, s[16:19], s66 offen offset:3072 sc1
    s_xor_b32 s66, s57, 8192
    buffer_load_dwordx4 v[192:195], v88, s[16:19], s66 offen offset:0 sc1
    s_xor_b32 s66, s57, 8192
    buffer_load_dwordx4 v[196:199], v88, s[16:19], s66 offen offset:1024 sc1
    s_xor_b32 s66, s57, 8192
    buffer_load_dwordx4 v[200:203], v88, s[16:19], s66 offen offset:2048 sc1
    s_xor_b32 s66, s57, 8192
    buffer_load_dwordx4 v[204:207], v88, s[16:19], s66 offen offset:3072 sc1
    s_xor_b32 s66, s57, 12288
    buffer_load_dwordx4 v[208:211], v88, s[16:19], s66 offen offset:0 sc1
    s_xor_b32 s66, s57, 12288
    buffer_load_dwordx4 v[212:215], v88, s[16:19], s66 offen offset:1024 sc1
    s_xor_b32 s66, s57, 12288
    buffer_load_dwordx4 v[216:219], v88, s[16:19], s66 offen offset:2048 sc1
    s_xor_b32 s66, s57, 12288
    buffer_load_dwordx4 v[220:223], v88, s[16:19], s66 offen offset:3072 sc1
    v_add_f32_dpp v232, v232, v232 quad_perm:[1,0,3,2] row_mask:0xf bank_mask:0xf
    v_add_f32_dpp v233, v233, v233 quad_perm:[1,0,3,2] row_mask:0xf bank_mask:0xf
    v_add_f32_dpp v234, v234, v234 quad_perm:[1,0,3,2] row_mask:0xf bank_mask:0xf
    v_add_f32_dpp v235, v235, v235 quad_perm:[1,0,3,2] row_mask:0xf bank_mask:0xf
    v_add_f32_dpp v232, v232, v232 quad_perm:[2,3,0,1] row_mask:0xf bank_mask:0xf
    v_add_f32_dpp v233, v233, v233 quad_perm:[2,3,0,1] row_mask:0xf bank_mask:0xf
    v_add_f32_dpp v234, v234, v234 quad_perm:[2,3,0,1] row_mask:0xf bank_mask:0xf
    v_add_f32_dpp v235, v235, v235 quad_perm:[2,3,0,1] row_mask:0xf bank_mask:0xf
    v_add_f32_dpp v232, v232, v232 row_half_mirror row_mask:0xf bank_mask:0xf
    v_add_f32_dpp v233, v233, v233 row_half_mirror row_mask:0xf bank_mask:0xf
    v_add_f32_dpp v234, v234, v234 row_half_mirror row_mask:0xf bank_mask:0xf
    v_add_f32_dpp v235, v235, v235 row_half_mirror row_mask:0xf bank_mask:0xf
    v_add_f32_dpp v232, v232, v232 row_mirror row_mask:0xf bank_mask:0xf
    v_add_f32_dpp v233, v233, v233 row_mirror row_mask:0xf bank_mask:0xf
    v_add_f32_dpp v234, v234, v234 row_mirror row_mask:0xf bank_mask:0xf
    v_add_f32_dpp v235, v235, v235 row_mirror row_mask:0xf bank_mask:0xf
    v_cvt_pk_bf16_f32 v232, v232, v233
    v_cvt_pk_bf16_f32 v233, v234, v235
    ds_write_b64 v13, v[232:233]
    s_waitcnt vmcnt(15)
    v_max_u32 v14, v160, v161
    v_max3_u32 v14, v14, v162, v163
    v_mfma_f32_16x16x32_bf16 v[224:227], v[138:141], v[160:163], 0
    v_mfma_f32_16x16x32_bf16 v[228:231], v[136:139], v[160:163], 0
    s_waitcnt vmcnt(14)
    v_max3_u32 v14, v14, v164, v165
    v_max3_u32 v14, v14, v166, v167
    v_mfma_f32_16x16x32_bf16 v[224:227], v[138:141], v[164:167], v[224:227]
    v_mfma_f32_16x16x32_bf16 v[228:231], v[136:139], v[164:167], v[228:231]
    s_waitcnt vmcnt(13)
    v_max3_u32 v14, v14, v168, v169
    v_max3_u32 v14, v14, v170, v171
    v_mfma_f32_16x16x32_bf16 v[224:227], v[138:141], v[168:171], v[224:227]
    v_mfma_f32_16x16x32_bf16 v[228:231], v[136:139], v[168:171], v[228:231]
    s_waitcnt vmcnt(12)
    v_max3_u32 v14, v14, v172, v173
    v_max3_u32 v14, v14, v174, v175
    v_mfma_f32_16x16x32_bf16 v[224:227], v[138:141], v[172:175], v[224:227]
    v_mfma_f32_16x16x32_bf16 v[228:231], v[136:139], v[172:175], v[228:231]
    s_waitcnt vmcnt(11)
    v_max3_u32 v14, v14, v176, v177
    v_max3_u32 v14, v14, v178, v179
    v_mfma_f32_16x16x32_bf16 v[224:227], v[138:141], v[176:179], v[224:227]
    v_mfma_f32_16x16x32_bf16 v[228:231], v[136:139], v[176:179], v[228:231]
    s_waitcnt vmcnt(10)
    v_max3_u32 v14, v14, v180, v181
    v_max3_u32 v14, v14, v182, v183
    v_mfma_f32_16x16x32_bf16 v[224:227], v[138:141], v[180:183], v[224:227]
    v_mfma_f32_16x16x32_bf16 v[228:231], v[136:139], v[180:183], v[228:231]
    s_waitcnt vmcnt(9)
    v_max3_u32 v14, v14, v184, v185
    v_max3_u32 v14, v14, v186, v187
    v_mfma_f32_16x16x32_bf16 v[224:227], v[138:141], v[184:187], v[224:227]
    v_mfma_f32_16x16x32_bf16 v[228:231], v[136:139], v[184:187], v[228:231]
    s_waitcnt vmcnt(8)
    v_max3_u32 v14, v14, v188, v189
    v_max3_u32 v14, v14, v190, v191
    v_mfma_f32_16x16x32_bf16 v[224:227], v[138:141], v[188:191], v[224:227]
    v_mfma_f32_16x16x32_bf16 v[228:231], v[136:139], v[188:191], v[228:231]
    s_waitcnt vmcnt(7)
    v_max3_u32 v14, v14, v192, v193
    v_max3_u32 v14, v14, v194, v195
    v_mfma_f32_16x16x32_bf16 v[224:227], v[138:141], v[192:195], v[224:227]
    v_mfma_f32_16x16x32_bf16 v[228:231], v[136:139], v[192:195], v[228:231]
    s_waitcnt vmcnt(6)
    v_max3_u32 v14, v14, v196, v197
    v_max3_u32 v14, v14, v198, v199
    v_mfma_f32_16x16x32_bf16 v[224:227], v[138:141], v[196:199], v[224:227]
    v_mfma_f32_16x16x32_bf16 v[228:231], v[136:139], v[196:199], v[228:231]
    s_waitcnt vmcnt(5)
    v_max3_u32 v14, v14, v200, v201
    v_max3_u32 v14, v14, v202, v203
    v_mfma_f32_16x16x32_bf16 v[224:227], v[138:141], v[200:203], v[224:227]
    v_mfma_f32_16x16x32_bf16 v[228:231], v[136:139], v[200:203], v[228:231]
    s_waitcnt vmcnt(4)
    v_max3_u32 v14, v14, v204, v205
    v_max3_u32 v14, v14, v206, v207
    v_mfma_f32_16x16x32_bf16 v[224:227], v[138:141], v[204:207], v[224:227]
    v_mfma_f32_16x16x32_bf16 v[228:231], v[136:139], v[204:207], v[228:231]
    s_waitcnt vmcnt(3)
    v_max3_u32 v14, v14, v208, v209
    v_max3_u32 v14, v14, v210, v211
    v_mfma_f32_16x16x32_bf16 v[224:227], v[138:141], v[208:211], v[224:227]
    v_mfma_f32_16x16x32_bf16 v[228:231], v[136:139], v[208:211], v[228:231]
    s_waitcnt vmcnt(2)
    v_max3_u32 v14, v14, v212, v213
    v_max3_u32 v14, v14, v214, v215
    v_mfma_f32_16x16x32_bf16 v[224:227], v[138:141], v[212:215], v[224:227]
    v_mfma_f32_16x16x32_bf16 v[228:231], v[136:139], v[212:215], v[228:231]
    s_waitcnt vmcnt(1)
    v_max3_u32 v14, v14, v216, v217
    v_max3_u32 v14, v14, v218, v219
    v_mfma_f32_16x16x32_bf16 v[224:227], v[138:141], v[216:219], v[224:227]
    v_mfma_f32_16x16x32_bf16 v[228:231], v[136:139], v[216:219], v[228:231]
    s_waitcnt vmcnt(0)
    v_max3_u32 v14, v14, v220, v221
    v_max3_u32 v14, v14, v222, v223
    v_mfma_f32_16x16x32_bf16 v[224:227], v[138:141], v[220:223], v[224:227]
    v_mfma_f32_16x16x32_bf16 v[228:231], v[136:139], v[220:223], v[228:231]
    v_cmp_eq_u32 vcc, -1, v14
    s_cbranch_vccnz P_slow
P_h1ok:
    s_nop 5
    v_cvt_pk_bf16_f32 v224, v224, v225
    v_cvt_pk_bf16_f32 v225, v226, v227
    v_cvt_pk_bf16_f32 v226, v228, v229
    v_cvt_pk_bf16_f32 v227, v230, v231
    ds_write_b64 v12, v[224:225]
    ds_write_b64 v12, v[226:227] offset:1024
    s_branch POST
P_slow:
    s_mov_b32 s59, 0
P_retry:
    s_mov_b32 s76, 0
    v_max_u32 v14, v160, v161
    v_max3_u32 v14, v14, v162, v163
    v_cmp_eq_u32 vcc, -1, v14
    s_cbranch_vccz P_rc0
    s_xor_b32 s66, s57, 0
    buffer_load_dwordx4 v[160:163], v88, s[16:19], s66 offen offset:0 sc1
    s_mov_b32 s76, 1
P_rc0:
    v_max_u32 v14, v164, v165
    v_max3_u32 v14, v14, v166, v167
    v_cmp_eq_u32 vcc, -1, v14
    s_cbranch_vccz P_rc1
    s_xor_b32 s66, s57, 0
    buffer_load_dwordx4 v[164:167], v88, s[16:19], s66 offen offset:1024 sc1
    s_mov_b32 s76, 1
P_rc1:
    v_max_u32 v14, v168, v169
    v_max3_u32 v14, v14, v170, v171
    v_cmp_eq_u32 vcc, -1, v14
    s_cbranch_vccz P_rc2
    s_xor_b32 s66, s57, 0
    buffer_load_dwordx4 v[168:171], v88, s[16:19], s66 offen offset:2048 sc1
    s_mov_b32 s76, 1
P_rc2:
    v_max_u32 v14, v172, v173
    v_max3_u32 v14, v14, v174, v175
    v_cmp_eq_u32 vcc, -1, v14
    s_cbranch_vccz P_rc3
    s_xor_b32 s66, s57, 0
    buffer_load_dwordx4 v[172:175], v88, s[16:19], s66 offen offset:3072 sc1
    s_mov_b32 s76, 1
P_rc3:
    v_max_u32 v14, v176, v177
    v_max3_u32 v14, v14, v178, v179
    v_cmp_eq_u32 vcc, -1, v14
    s_cbranch_vccz P_rc4
    s_xor_b32 s66, s57, 4096
    buffer_load_dwordx4 v[176:179], v88, s[16:19], s66 offen offset:0 sc1
    s_mov_b32 s76, 1
P_rc4:
    v_max_u32 v14, v180, v181
    v_max3_u32 v14, v14, v182, v183
    v_cmp_eq_u32 vcc, -1, v14
    s_cbranch_vccz P_rc5
    s_xor_b32 s66, s57, 4096
    buffer_load_dwordx4 v[180:183], v88, s[16:19], s66 offen offset:1024 sc1
    s_mov_b32 s76, 1
P_rc5:
    v_max_u32 v14, v184, v185
    v_max3_u32 v14, v14, v186, v187
    v_cmp_eq_u32 vcc, -1, v14
    s_cbranch_vccz P_rc6
    s_xor_b32 s66, s57, 4096
    buffer_load_dwordx4 v[184:187], v88, s[16:19], s66 offen offset:2048 sc1
    s_mov_b32 s76, 1
P_rc6:
    v_max_u32 v14, v188, v189
    v_max3_u32 v14, v14, v190, v191
    v_cmp_eq_u32 vcc, -1, v14
    s_cbranch_vccz P_rc7
    s_xor_b32 s66, s57, 4096
    buffer_load_dwordx4 v[188:191], v88, s[16:19], s66 offen offset:3072 sc1
    s_mov_b32 s76, 1
P_rc7:
    v_max_u32 v14, v192, v193
    v_max3_u32 v14, v14, v194, v195
    v_cmp_eq_u32 vcc, -1, v14
    s_cbranch_vccz P_rc8
    s_xor_b32 s66, s57, 8192
    buffer_load_dwordx4 v[192:195], v88, s[16:19], s66 offen offset:0 sc1
    s_mov_b32 s76, 1
P_rc8:
    v_max_u32 v14, v196, v197
    v_max3_u32 v14, v14, v198, v199
    v_cmp_eq_u32 vcc, -1, v14
    s_cbranch_vccz P_rc9
    s_xor_b32 s66, s57, 8192
    buffer_load_dwordx4 v[196:199], v88, s[16:19], s66 offen offset:1024 sc1
    s_mov_b32 s76, 1
P_rc9:
    v_max_u32 v14, v200, v201
    v_max3_u32 v14, v14, v202, v203
    v_cmp_eq_u32 vcc, -1, v14
    s_cbranch_vccz P_rc10
    s_xor_b32 s66, s57, 8192
    buffer_load_dwordx4 v[200:203], v88, s[16:19], s66 offen offset:2048 sc1
    s_mov_b32 s76, 1
P_rc10:
    v_max_u32 v14, v204, v205
    v_max3_u32 v14, v14, v206, v207
    v_cmp_eq_u32 vcc, -1, v14
    s_cbranch_vccz P_rc11
    s_xor_b32 s66, s57, 8192
    buffer_load_dwordx4 v[204:207], v88, s[16:19], s66 offen offset:3072 sc1
    s_mov_b32 s76, 1
P_rc11:
    v_max_u32 v14, v208, v209
    v_max3_u32 v14, v14, v210, v211
    v_cmp_eq_u32 vcc, -1, v14
    s_cbranch_vccz P_rc12
    s_xor_b32 s66, s57, 12288
    buffer_load_dwordx4 v[208:211], v88, s[16:19], s66 offen offset:0 sc1
    s_mov_b32 s76, 1
P_rc12:
    v_max_u32 v14, v212, v213
    v_max3_u32 v14, v14, v214, v215
    v_cmp_eq_u32 vcc, -1, v14
    s_cbranch_vccz P_rc13
    s_xor_b32 s66, s57, 12288
    buffer_load_dwordx4 v[212:215], v88, s[16:19], s66 offen offset:1024 sc1
    s_mov_b32 s76, 1
P_rc13:
    v_max_u32 v14, v216, v217
    v_max3_u32 v14, v14, v218, v219
    v_cmp_eq_u32 vcc, -1, v14
    s_cbranch_vccz P_rc14
    s_xor_b32 s66, s57, 12288
    buffer_load_dwordx4 v[216:219], v88, s[16:19], s66 offen offset:2048 sc1
    s_mov_b32 s76, 1
P_rc14:
    v_max_u32 v14, v220, v221
    v_max3_u32 v14, v14, v222, v223
    v_cmp_eq_u32 vcc, -1, v14
    s_cbranch_vccz P_rc15
    s_xor_b32 s66, s57, 12288
    buffer_load_dwordx4 v[220:223], v88, s[16:19], s66 offen offset:3072 sc1
    s_mov_b32 s76, 1
P_rc15:
    s_add_u32 s59, s59, 1
    s_cmp_ge_u32 s59, 200000
    s_cselect_b32 s76, 0, s76
    s_waitcnt vmcnt(0)
    s_cmp_lg_u32 s76, 0
    s_cbranch_scc1 P_retry
    v_mfma_f32_16x16x32_bf16 v[224:227], v[138:141], v[160:163], 0
    v_mfma_f32_16x16x32_bf16 v[228:231], v[136:139], v[160:163], 0
    v_mfma_f32_16x16x32_bf16 v[224:227], v[138:141], v[164:167], v[224:227]
    v_mfma_f32_16x16x32_bf16 v[228:231], v[136:139], v[164:167], v[228:231]
    v_mfma_f32_16x16x32_bf16 v[224:227], v[138:141], v[168:171], v[224:227]
    v_mfma_f32_16x16x32_bf16 v[228:231], v[136:139], v[168:171], v[228:231]
    v_mfma_f32_16x16x32_bf16 v[224:227], v[138:141], v[172:175], v[224:227]
    v_mfma_f32_16x16x32_bf16 v[228:231], v[136:139], v[172:175], v[228:231]
    v_mfma_f32_16x16x32_bf16 v[224:227], v[138:141], v[176:179], v[224:227]
    v_mfma_f32_16x16x32_bf16 v[228:231], v[136:139], v[176:179], v[228:231]
    v_mfma_f32_16x16x32_bf16 v[224:227], v[138:141], v[180:183], v[224:227]
    v_mfma_f32_16x16x32_bf16 v[228:231], v[136:139], v[180:183], v[228:231]
    v_mfma_f32_16x16x32_bf16 v[224:227], v[138:141], v[184:187], v[224:227]
    v_mfma_f32_16x16x32_bf16 v[228:231], v[136:139], v[184:187], v[228:231]
    v_mfma_f32_16x16x32_bf16 v[224:227], v[138:141], v[188:191], v[224:227]
    v_mfma_f32_16x16x32_bf16 v[228:231], v[136:139], v[188:191], v[228:231]
    v_mfma_f32_16x16x32_bf16 v[224:227], v[138:141], v[192:195], v[224:227]
    v_mfma_f32_16x16x32_bf16 v[228:231], v[136:139], v[192:195], v[228:231]
    v_mfma_f32_16x16x32_bf16 v[224:227], v[138:141], v[196:199], v[224:227]
    v_mfma_f32_16x16x32_bf16 v[228:231], v[136:139], v[196:199], v[228:231]
    v_mfma_f32_16x16x32_bf16 v[224:227], v[138:141], v[200:203], v[224:227]
    v_mfma_f32_16x16x32_bf16 v[228:231], v[136:139], v[200:203], v[228:231]
    v_mfma_f32_16x16x32_bf16 v[224:227], v[138:141], v[204:207], v[224:227]
    v_mfma_f32_16x16x32_bf16 v[228:231], v[136:139], v[204:207], v[228:231]
    v_mfma_f32_16x16x32_bf16 v[224:227], v[138:141], v[208:211], v[224:227]
    v_mfma_f32_16x16x32_bf16 v[228:231], v[136:139], v[208:211], v[228:231]
    v_mfma_f32_16x16x32_bf16 v[224:227], v[138:141], v[212:215], v[224:227]
    v_mfma_f32_16x16x32_bf16 v[228:231], v[136:139], v[212:215], v[228:231]
    v_mfma_f32_16x16x32_bf16 v[224:227], v[138:141], v[216:219], v[224:227]
    v_mfma_f32_16x16x32_bf16 v[228:231], v[136:139], v[216:219], v[228:231]
    v_mfma_f32_16x16x32_bf16 v[224:227], v[138:141], v[220:223], v[224:227]
    v_mfma_f32_16x16x32_bf16 v[228:231], v[136:139], v[220:223], v[228:231]
    s_nop 1
    s_branch P_h1ok
HELP:
    v_lshlrev_b32 v9, 4, v2
    s_lshl_b32 s56, s5, 2
    s_add_u32 s56, s56, s44
    s_lshl_b32 s53, s56, 10
    s_lshl_b32 s66, s4, 6
    s_add_u32 s53, s53, s66
    s_add_u32 s53, s53, 5242880
    s_lshl_b32 s56, s56, 4
    s_add_u32 s56, s56, s4
    s_lshl_b32 s56, s56, 10
    s_add_u32 s56, s56, 4194304
    s_lshl_b32 s55, s73, 2
    s_add_u32 s55, s55, s44
    s_lshl_b32 s55, s55, 6
    s_add_u32 s55, s55, s79
    s_lshl_b32 s55, s55, 8
    s_add_u32 s55, s55, 5832704
    v_lshrrev_b32 v12, 3, v2
    s_lshl_b32 s67, s44, 3
    v_add_u32 v12, s67, v12
    v_lshlrev_b32 v12, 11, v12
    v_lshrrev_b32 v13, 4, v2
    v_lshlrev_b32 v13, 1, v13
    v_and_b32 v90, 7, v2
    v_xor_b32 v13, v13, v90
    v_lshl_add_u32 v12, v13, 4, v12
    s_lshl_b32 s66, s7, 7
    v_add_u32 v90, s66, v12
    s_lshl_b32 s66, s6, 7
    s_lshl_b32 s67, s44, 5
    s_add_u32 s66, s66, s67
    s_lshl_b32 s67, s45, 4
    s_add_u32 s66, s66, s67
    v_and_b32 v92, 15, v2
    v_add_u32 v92, s66, v92
    v_lshlrev_b32 v91, 11, v92
    v_bfe_u32 v12, v2, 4, 1
    v_lshl_add_u32 v91, v12, 5, v91
    v_lshrrev_b32 v12, 5, v2
    v_lshl_add_u32 v91, v12, 4, v91
    s_lshl_b32 s66, s7, 7
    v_add_u32 v91, s66, v91
    v_lshrrev_b32 v93, 2, v92
    v_lshlrev_b32 v93, 6, v93
    v_and_b32 v12, 3, v2
    v_lshl_add_u32 v93, v12, 2, v93
    s_lshl_b32 s66, s6, 1
    s_and_b32 s66, s66, 6
    s_lshl_b32 s67, s7, 3
    s_add_u32 s66, s66, s67
    s_and_b32 s66, s66, 7
    s_lshl_b32 s52, s66, 18
    s_lshr_b32 s49, s44, 1
    s_and_b32 s66, s44, 1
    s_lshl_b32 s66, s66, 2
    s_lshl_b32 s67, s45, 1
    s_add_u32 s66, s66, s67
    s_lshl_b32 s67, s4, 3
    s_add_u32 s66, s66, s67
    s_lshl_b32 s66, s66, 15
    s_lshl_b32 s67, s5, 11
    s_add_u32 s66, s66, s67
    s_lshl_b32 s67, s49, 10
    s_add_u32 s60, s66, s67
    s_add_u32 s61, s60, 32768
    v_lshrrev_b32 v10, 5, v2
    v_and_b32 v11, 31, v2
    v_lshlrev_b32 v12, 3, v10
    s_lshl_b32 s66, s79, 6
    s_lshl_b32 s67, s44, 4
    s_add_u32 s66, s66, s67
    v_add_u32 v12, s66, v12
    v_lshlrev_b32 v12, 11, v12
    v_lshl_add_u32 v12, v11, 4, v12
    s_lshl_b32 s66, s73, 9
    v_add_u32 v7, s66, v12
    s_lshr_b32 s62, s79, 2
    s_lshl_b32 s62, s62, 15
    s_and_b32 s66, s79, 3
    s_lshl_b32 s66, s66, 8
    s_add_u32 s62, s62, s66
    s_lshl_b32 s66, s44, 6
    s_add_u32 s62, s62, s66
    s_add_u32 s62, s62, 5308416
    s_add_u32 s63, s62, 16384
    v_lshrrev_b32 v1, 2, v2
    v_lshlrev_b32 v1, 10, v1
    v_and_b32 v13, 3, v2
    v_lshl_add_u32 v1, v13, 4, v1
    s_cmp_ge_u32 s44, 2
    s_cbranch_scc1 WORK
    s_waitcnt vmcnt(5)
    s_barrier
    s_cmp_le_u32 s77, 2
    s_addc_u32 s71, s76, 2
    s_and_b32 s71, s71, 15
    s_lshl_b32 s70, s71, 7
    s_mul_i32 s71, s71, 393216
    s_add_u32 m0, s72, 106496
    s_add_u32 s66, s71, 2048
    buffer_load_dwordx4 v5, s[12:15], s66 offen lds
    s_add_u32 m0, s72, 108544
    s_add_u32 s66, s71, 100352
    buffer_load_dwordx4 v5, s[12:15], s66 offen lds
    s_add_u32 m0, s72, 110592
    s_add_u32 s66, s71, 198656
    buffer_load_dwordx4 v5, s[12:15], s66 offen lds
    s_add_u32 m0, s72, 112640
    s_add_u32 s66, s71, 296960
    buffer_load_dwordx4 v5, s[12:15], s66 offen lds
    s_add_u32 m0, s72, 81920
    s_add_u32 s66, s70, 0
    buffer_load_dwordx4 v4, s[8:11], s66 offen lds
    s_add_u32 m0, s72, 83968
    s_add_u32 s66, s70, 32768
    buffer_load_dwordx4 v4, s[8:11], s66 offen lds
    s_add_u32 m0, s72, 86016
    s_add_u32 s66, s70, 65536
    buffer_load_dwordx4 v4, s[8:11], s66 offen lds
    s_add_u32 m0, s72, 88064
    s_add_u32 s66, s70, 98304
    buffer_load_dwordx4 v4, s[8:11], s66 offen lds
    s_add_u32 m0, s72, 90112
    s_add_u32 s66, s70, 131072
    buffer_load_dwordx4 v4, s[8:11], s66 offen lds
    s_add_u32 m0, s72, 92160
    s_add_u32 s66, s70, 163840
    buffer_load_dwordx4 v4, s[8:11], s66 offen lds
    s_add_u32 m0, s72, 94208
    s_add_u32 s66, s70, 196608
    buffer_load_dwordx4 v4, s[8:11], s66 offen lds
    s_add_u32 m0, s72, 96256
    s_add_u32 s66, s70, 229376
    buffer_load_dwordx4 v4, s[8:11], s66 offen lds
    s_add_u32 m0, s72, 114688
    s_add_u32 s66, s71, 4096
    buffer_load_dwordx4 v5, s[12:15], s66 offen lds
    s_add_u32 m0, s72, 116736
    s_add_u32 s66, s71, 102400
    buffer_load_dwordx4 v5, s[12:15], s66 offen lds
    s_add_u32 m0, s72, 118784
    s_add_u32 s66, s71, 200704
    buffer_load_dwordx4 v5, s[12:15], s66 offen lds
    s_add_u32 m0, s72, 120832
    s_add_u32 s66, s71, 299008
    buffer_load_dwordx4 v5, s[12:15], s66 offen lds
    s_add_u32 m0, s72, 98304
    s_add_u32 s66, s71, 0
    buffer_load_dwordx4 v5, s[12:15], s66 offen lds
    s_add_u32 m0, s72, 100352
    s_add_u32 s66, s71, 98304
    buffer_load_dwordx4 v5, s[12:15], s66 offen lds
    s_add_u32 m0, s72, 102400
    s_add_u32 s66, s71, 196608
    buffer_load_dwordx4 v5, s[12:15], s66 offen lds
    s_add_u32 m0, s72, 104448
    s_add_u32 s66, s71, 294912
    buffer_load_dwordx4 v5, s[12:15], s66 offen lds
    s_waitcnt vmcnt(20)
    s_barrier
    s_cmp_le_u32 s77, 3
    s_addc_u32 s71, s76, 3
    s_and_b32 s71, s71, 15
    s_lshl_b32 s70, s71, 7
    s_mul_i32 s71, s71, 393216
    s_add_u32 m0, s72, 24576
    s_add_u32 s66, s71, 2048
    buffer_load_dwordx4 v5, s[12:15], s66 offen lds
    s_add_u32 m0, s72, 26624
    s_add_u32 s66, s71, 100352
    buffer_load_dwordx4 v5, s[12:15], s66 offen lds
    s_add_u32 m0, s72, 28672
    s_add_u32 s66, s71, 198656
    buffer_load_dwordx4 v5, s[12:15], s66 offen lds
    s_add_u32 m0, s72, 30720
    s_add_u32 s66, s71, 296960
    buffer_load_dwordx4 v5, s[12:15], s66 offen lds
    s_add_u32 m0, s72, 0
    s_add_u32 s66, s70, 0
    buffer_load_dwordx4 v4, s[8:11], s66 offen lds
    s_add_u32 m0, s72, 2048
    s_add_u32 s66, s70, 32768
    buffer_load_dwordx4 v4, s[8:11], s66 offen lds
    s_add_u32 m0, s72, 4096
    s_add_u32 s66, s70, 65536
    buffer_load_dwordx4 v4, s[8:11], s66 offen lds
    s_add_u32 m0, s72, 6144
    s_add_u32 s66, s70, 98304
    buffer_load_dwordx4 v4, s[8:11], s66 offen lds
    s_add_u32 m0, s72, 8192
    s_add_u32 s66, s70, 131072
    buffer_load_dwordx4 v4, s[8:11], s66 offen lds
    s_add_u32 m0, s72, 10240
    s_add_u32 s66, s70, 163840
    buffer_load_dwordx4 v4, s[8:11], s66 offen lds
    s_add_u32 m0, s72, 12288
    s_add_u32 s66, s70, 196608
    buffer_load_dwordx4 v4, s[8:11], s66 offen lds
    s_add_u32 m0, s72, 14336
    s_add_u32 s66, s70, 229376
    buffer_load_dwordx4 v4, s[8:11], s66 offen lds
    s_add_u32 m0, s72, 32768
    s_add_u32 s66, s71, 4096
    buffer_load_dwordx4 v5, s[12:15], s66 offen lds
    s_add_u32 m0, s72, 34816
    s_add_u32 s66, s71, 102400
    buffer_load_dwordx4 v5, s[12:15], s66 offen lds
    s_add_u32 m0, s72, 36864
    s_add_u32 s66, s71, 200704
    buffer_load_dwordx4 v5, s[12:15], s66 offen lds
    s_add_u32 m0, s72, 38912
    s_add_u32 s66, s71, 299008
    buffer_load_dwordx4 v5, s[12:15], s66 offen lds
    s_add_u32 m0, s72, 16384
    s_add_u32 s66, s71, 0
    buffer_load_dwordx4 v5, s[12:15], s66 offen lds
    s_add_u32 m0, s72, 18432
    s_add_u32 s66, s71, 98304
    buffer_load_dwordx4 v5, s[12:15], s66 offen lds
    s_add_u32 m0, s72, 20480
    s_add_u32 s66, s71, 196608
    buffer_load_dwordx4 v5, s[12:15], s66 offen lds
    s_add_u32 m0, s72, 22528
    s_add_u32 s66, s71, 294912
    buffer_load_dwordx4 v5, s[12:15], s66 offen lds
    s_waitcnt vmcnt(20)
    s_barrier
    s_cmp_le_u32 s77, 4
    s_addc_u32 s71, s76, 4
    s_and_b32 s71, s71, 15
    s_lshl_b32 s70, s71, 7
    s_mul_i32 s71, s71, 393216
    s_add_u32 m0, s72, 65536
    s_add_u32 s66, s71, 2048
    buffer_load_dwordx4 v5, s[12:15], s66 offen lds
    s_add_u32 m0, s72, 67584
    s_add_u32 s66, s71, 100352
    buffer_load_dwordx4 v5, s[12:15], s66 offen lds
    s_add_u32 m0, s72, 69632
    s_add_u32 s66, s71, 198656
    buffer_load_dwordx4 v5, s[12:15], s66 offen lds
    s_add_u32 m0, s72, 71680
    s_add_u32 s66, s71, 296960
    buffer_load_dwordx4 v5, s[12:15], s66 offen lds
    s_add_u32 m0, s72, 40960
    s_add_u32 s66, s70, 0
    buffer_load_dwordx4 v4, s[8:11], s66 offen lds
    s_add_u32 m0, s72, 43008
    s_add_u32 s66, s70, 32768
    buffer_load_dwordx4 v4, s[8:11], s66 offen lds
    s_add_u32 m0, s72, 45056
    s_add_u32 s66, s70, 65536
    buffer_load_dwordx4 v4, s[8:11], s66 offen lds
    s_add_u32 m0, s72, 47104
    s_add_u32 s66, s70, 98304
    buffer_load_dwordx4 v4, s[8:11], s66 offen lds
    s_add_u32 m0, s72, 49152
    s_add_u32 s66, s70, 131072
    buffer_load_dwordx4 v4, s[8:11], s66 offen lds
    s_add_u32 m0, s72, 51200
    s_add_u32 s66, s70, 163840
    buffer_load_dwordx4 v4, s[8:11], s66 offen lds
    s_add_u32 m0, s72, 53248
    s_add_u32 s66, s70, 196608
    buffer_load_dwordx4 v4, s[8:11], s66 offen lds
    s_add_u32 m0, s72, 55296
    s_add_u32 s66, s70, 229376
    buffer_load_dwordx4 v4, s[8:11], s66 offen lds
    s_add_u32 m0, s72, 73728
    s_add_u32 s66, s71, 4096
    buffer_load_dwordx4 v5, s[12:15], s66 offen lds
    s_add_u32 m0, s72, 75776
    s_add_u32 s66, s71, 102400
    buffer_load_dwordx4 v5, s[12:15], s66 offen lds
    s_add_u32 m0, s72, 77824
    s_add_u32 s66, s71, 200704
    buffer_load_dwordx4 v5, s[12:15], s66 offen lds
    s_add_u32 m0, s72, 79872
    s_add_u32 s66, s71, 299008
    buffer_load_dwordx4 v5, s[12:15], s66 offen lds
    s_add_u32 m0, s72, 57344
    s_add_u32 s66, s71, 0
    buffer_load_dwordx4 v5, s[12:15], s66 offen lds
    s_add_u32 m0, s72, 59392
    s_add_u32 s66, s71, 98304
    buffer_load_dwordx4 v5, s[12:15], s66 offen lds
    s_add_u32 m0, s72, 61440
    s_add_u32 s66, s71, 196608
    buffer_load_dwordx4 v5, s[12:15], s66 offen lds
    s_add_u32 m0, s72, 63488
    s_add_u32 s66, s71, 294912
    buffer_load_dwordx4 v5, s[12:15], s66 offen lds
    s_waitcnt vmcnt(20)
    s_barrier
    s_cmp_le_u32 s77, 5
    s_addc_u32 s71, s76, 5
    s_and_b32 s71, s71, 15
    s_lshl_b32 s70, s71, 7
    s_mul_i32 s71, s71, 393216
    s_add_u32 m0, s72, 106496
    s_add_u32 s66, s71, 2048
    buffer_load_dwordx4 v5, s[12:15], s66 offen lds
    s_add_u32 m0, s72, 108544
    s_add_u32 s66, s71, 100352
    buffer_load_dwordx4 v5, s[12:15], s66 offen lds
    s_add_u32 m0, s72, 110592
    s_add_u32 s66, s71, 198656
    buffer_load_dwordx4 v5, s[12:15], s66 offen lds
    s_add_u32 m0, s72, 112640
    s_add_u32 s66, s71, 296960
    buffer_load_dwordx4 v5, s[12:15], s66 offen lds
    s_add_u32 m0, s72, 81920
    s_add_u32 s66, s70, 0
    buffer_load_dwordx4 v4, s[8:11], s66 offen lds
    s_add_u32 m0, s72, 83968
    s_add_u32 s66, s70, 32768
    buffer_load_dwordx4 v4, s[8:11], s66 offen lds
    s_add_u32 m0, s72, 86016
    s_add_u32 s66, s70, 65536
    buffer_load_dwordx4 v4, s[8:11], s66 offen lds
    s_add_u32 m0, s72, 88064
    s_add_u32 s66, s70, 98304
    buffer_load_dwordx4 v4, s[8:11], s66 offen lds
    s_add_u32 m0, s72, 90112
    s_add_u32 s66, s70, 131072
    buffer_load_dwordx4 v4, s[8:11], s66 offen lds
    s_add_u32 m0, s72, 92160
    s_add_u32 s66, s70, 163840
    buffer_load_dwordx4 v4, s[8:11], s66 offen lds
    s_add_u32 m0, s72, 94208
    s_add_u32 s66, s70, 196608
    buffer_load_dwordx4 v4, s[8:11], s66 offen lds
    s_add_u32 m0, s72, 96256
    s_add_u32 s66, s70, 229376
    buffer_load_dwordx4 v4, s[8:11], s66 offen lds
    s_add_u32 m0, s72, 114688
    s_add_u32 s66, s71, 4096
    buffer_load_dwordx4 v5, s[12:15], s66 offen lds
    s_add_u32 m0, s72, 116736
    s_add_u32 s66, s71, 102400
    buffer_load_dwordx4 v5, s[12:15], s66 offen lds
    s_add_u32 m0, s72, 118784
    s_add_u32 s66, s71, 200704
    buffer_load_dwordx4 v5, s[12:15], s66 offen lds
    s_add_u32 m0, s72, 120832
    s_add_u32 s66, s71, 299008
    buffer_load_dwordx4 v5, s[12:15], s66 offen lds
    s_add_u32 m0, s72, 98304
    s_add_u32 s66, s71, 0
    buffer_load_dwordx4 v5, s[12:15], s66 offen lds
    s_add_u32 m0, s72, 100352
    s_add_u32 s66, s71, 98304
    buffer_load_dwordx4 v5, s[12:15], s66 offen lds
    s_add_u32 m0, s72, 102400
    s_add_u32 s66, s71, 196608
    buffer_load_dwordx4 v5, s[12:15], s66 offen lds
    s_add_u32 m0, s72, 104448
    s_add_u32 s66, s71, 294912
    buffer_load_dwordx4 v5, s[12:15], s66 offen lds
    s_waitcnt vmcnt(20)
    s_barrier
    s_cmp_le_u32 s77, 6
    s_addc_u32 s71, s76, 6
    s_and_b32 s71, s71, 15
    s_lshl_b32 s70, s71, 7
    s_mul_i32 s71, s71, 393216
    s_add_u32 m0, s72, 24576
    s_add_u32 s66, s71, 2048
    buffer_load_dwordx4 v5, s[12:15], s66 offen lds
    s_add_u32 m0, s72, 26624
    s_add_u32 s66, s71, 100352
    buffer_load_dwordx4 v5, s[12:15], s66 offen lds
    s_add_u32 m0, s72, 28672
    s_add_u32 s66, s71, 198656
    buffer_load_dwordx4 v5, s[12:15], s66 offen lds
    s_add_u32 m0, s72, 30720
    s_add_u32 s66, s71, 296960
    buffer_load_dwordx4 v5, s[12:15], s66 offen lds
    s_add_u32 m0, s72, 0
    s_add_u32 s66, s70, 0
    buffer_load_dwordx4 v4, s[8:11], s66 offen lds
    s_add_u32 m0, s72, 2048
    s_add_u32 s66, s70, 32768
    buffer_load_dwordx4 v4, s[8:11], s66 offen lds
    s_add_u32 m0, s72, 4096
    s_add_u32 s66, s70, 65536
    buffer_load_dwordx4 v4, s[8:11], s66 offen lds
    s_add_u32 m0, s72, 6144
    s_add_u32 s66, s70, 98304
    buffer_load_dwordx4 v4, s[8:11], s66 offen lds
    s_add_u32 m0, s72, 8192
    s_add_u32 s66, s70, 131072
    buffer_load_dwordx4 v4, s[8:11], s66 offen lds
    s_add_u32 m0, s72, 10240
    s_add_u32 s66, s70, 163840
    buffer_load_dwordx4 v4, s[8:11], s66 offen lds
    s_add_u32 m0, s72, 12288
    s_add_u32 s66, s70, 196608
    buffer_load_dwordx4 v4, s[8:11], s66 offen lds
    s_add_u32 m0, s72, 14336
    s_add_u32 s66, s70, 229376
    buffer_load_dwordx4 v4, s[8:11], s66 offen lds
    s_add_u32 m0, s72, 32768
    s_add_u32 s66, s71, 4096
    buffer_load_dwordx4 v5, s[12:15], s66 offen lds
    s_add_u32 m0, s72, 34816
    s_add_u32 s66, s71, 102400
    buffer_load_dwordx4 v5, s[12:15], s66 offen lds
    s_add_u32 m0, s72, 36864
    s_add_u32 s66, s71, 200704
    buffer_load_dwordx4 v5, s[12:15], s66 offen lds
    s_add_u32 m0, s72, 38912
    s_add_u32 s66, s71, 299008
    buffer_load_dwordx4 v5, s[12:15], s66 offen lds
    s_add_u32 m0, s72, 16384
    s_add_u32 s66, s71, 0
    buffer_load_dwordx4 v5, s[12:15], s66 offen lds
    s_add_u32 m0, s72, 18432
    s_add_u32 s66, s71, 98304
    buffer_load_dwordx4 v5, s[12:15], s66 offen lds
    s_add_u32 m0, s72, 20480
    s_add_u32 s66, s71, 196608
    buffer_load_dwordx4 v5, s[12:15], s66 offen lds
    s_add_u32 m0, s72, 22528
    s_add_u32 s66, s71, 294912
    buffer_load_dwordx4 v5, s[12:15], s66 offen lds
    s_waitcnt vmcnt(20)
    s_barrier
    s_cmp_le_u32 s77, 7
    s_addc_u32 s71, s76, 7
    s_and_b32 s71, s71, 15
    s_lshl_b32 s70, s71, 7
    s_mul_i32 s71, s71, 393216
    s_add_u32 m0, s72, 65536
    s_add_u32 s66, s71, 2048
    buffer_load_dwordx4 v5, s[12:15], s66 offen lds
    s_add_u32 m0, s72, 67584
    s_add_u32 s66, s71, 100352
    buffer_load_dwordx4 v5, s[12:15], s66 offen lds
    s_add_u32 m0, s72, 69632
    s_add_u32 s66, s71, 198656
    buffer_load_dwordx4 v5, s[12:15], s66 offen lds
    s_add_u32 m0, s72, 71680
    s_add_u32 s66, s71, 296960
    buffer_load_dwordx4 v5, s[12:15], s66 offen lds
    s_add_u32 m0, s72, 40960
    s_add_u32 s66, s70, 0
    buffer_load_dwordx4 v4, s[8:11], s66 offen lds
    s_add_u32 m0, s72, 43008
    s_add_u32 s66, s70, 32768
    buffer_load_dwordx4 v4, s[8:11], s66 offen lds
    s_add_u32 m0, s72, 45056
    s_add_u32 s66, s70, 65536
    buffer_load_dwordx4 v4, s[8:11], s66 offen lds
    s_add_u32 m0, s72, 47104
    s_add_u32 s66, s70, 98304
    buffer_load_dwordx4 v4, s[8:11], s66 offen lds
    s_add_u32 m0, s72, 49152
    s_add_u32 s66, s70, 131072
    buffer_load_dwordx4 v4, s[8:11], s66 offen lds
    s_add_u32 m0, s72, 51200
    s_add_u32 s66, s70, 163840
    buffer_load_dwordx4 v4, s[8:11], s66 offen lds
    s_add_u32 m0, s72, 53248
    s_add_u32 s66, s70, 196608
    buffer_load_dwordx4 v4, s[8:11], s66 offen lds
    s_add_u32 m0, s72, 55296
    s_add_u32 s66, s70, 229376
    buffer_load_dwordx4 v4, s[8:11], s66 offen lds
    s_add_u32 m0, s72, 73728
    s_add_u32 s66, s71, 4096
    buffer_load_dwordx4 v5, s[12:15], s66 offen lds
    s_add_u32 m0, s72, 75776
    s_add_u32 s66, s71, 102400
    buffer_load_dwordx4 v5, s[12:15], s66 offen lds
    s_add_u32 m0, s72, 77824
    s_add_u32 s66, s71, 200704
    buffer_load_dwordx4 v5, s[12:15], s66 offen lds
    s_add_u32 m0, s72, 79872
    s_add_u32 s66, s71, 299008
    buffer_load_dwordx4 v5, s[12:15], s66 offen lds
    s_add_u32 m0, s72, 57344
    s_add_u32 s66, s71, 0
    buffer_load_dwordx4 v5, s[12:15], s66 offen lds
    s_add_u32 m0, s72, 59392
    s_add_u32 s66, s71, 98304
    buffer_load_dwordx4 v5, s[12:15], s66 offen lds
    s_add_u32 m0, s72, 61440
    s_add_u32 s66, s71, 196608
    buffer_load_dwordx4 v5, s[12:15], s66 offen lds
    s_add_u32 m0, s72, 63488
    s_add_u32 s66, s71, 294912
    buffer_load_dwordx4 v5, s[12:15], s66 offen lds
    s_waitcnt vmcnt(20)
    s_barrier
    s_cmp_le_u32 s77, 8
    s_addc_u32 s71, s76, 8
    s_and_b32 s71, s71, 15
    s_lshl_b32 s70, s71, 7
    s_mul_i32 s71, s71, 393216
    s_add_u32 m0, s72, 106496
    s_add_u32 s66, s71, 2048
    buffer_load_dwordx4 v5, s[12:15], s66 offen lds
    s_add_u32 m0, s72, 108544
    s_add_u32 s66, s71, 100352
    buffer_load_dwordx4 v5, s[12:15], s66 offen lds
    s_add_u32 m0, s72, 110592
    s_add_u32 s66, s71, 198656
    buffer_load_dwordx4 v5, s[12:15], s66 offen lds
    s_add_u32 m0, s72, 112640
    s_add_u32 s66, s71, 296960
    buffer_load_dwordx4 v5, s[12:15], s66 offen lds
    s_add_u32 m0, s72, 81920
    s_add_u32 s66, s70, 0
    buffer_load_dwordx4 v4, s[8:11], s66 offen lds
    s_add_u32 m0, s72, 83968
    s_add_u32 s66, s70, 32768
    buffer_load_dwordx4 v4, s[8:11], s66 offen lds
    s_add_u32 m0, s72, 86016
    s_add_u32 s66, s70, 65536
    buffer_load_dwordx4 v4, s[8:11], s66 offen lds
    s_add_u32 m0, s72, 88064
    s_add_u32 s66, s70, 98304
    buffer_load_dwordx4 v4, s[8:11], s66 offen lds
    s_add_u32 m0, s72, 90112
    s_add_u32 s66, s70, 131072
    buffer_load_dwordx4 v4, s[8:11], s66 offen lds
    s_add_u32 m0, s72, 92160
    s_add_u32 s66, s70, 163840
    buffer_load_dwordx4 v4, s[8:11], s66 offen lds
    s_add_u32 m0, s72, 94208
    s_add_u32 s66, s70, 196608
    buffer_load_dwordx4 v4, s[8:11], s66 offen lds
    s_add_u32 m0, s72, 96256
    s_add_u32 s66, s70, 229376
    buffer_load_dwordx4 v4, s[8:11], s66 offen lds
    s_add_u32 m0, s72, 114688
    s_add_u32 s66, s71, 4096
    buffer_load_dwordx4 v5, s[12:15], s66 offen lds
    s_add_u32 m0, s72, 116736
    s_add_u32 s66, s71, 102400
    buffer_load_dwordx4 v5, s[12:15], s66 offen lds
    s_add_u32 m0, s72, 118784
    s_add_u32 s66, s71, 200704
    buffer_load_dwordx4 v5, s[12:15], s66 offen lds
    s_add_u32 m0, s72, 120832
    s_add_u32 s66, s71, 299008
    buffer_load_dwordx4 v5, s[12:15], s66 offen lds
    s_add_u32 m0, s72, 98304
    s_add_u32 s66, s71, 0
    buffer_load_dwordx4 v5, s[12:15], s66 offen lds
    s_add_u32 m0, s72, 100352
    s_add_u32 s66, s71, 98304
    buffer_load_dwordx4 v5, s[12:15], s66 offen lds
    s_add_u32 m0, s72, 102400
    s_add_u32 s66, s71, 196608
    buffer_load_dwordx4 v5, s[12:15], s66 offen lds
    s_add_u32 m0, s72, 104448
    s_add_u32 s66, s71, 294912
    buffer_load_dwordx4 v5, s[12:15], s66 offen lds
    s_waitcnt vmcnt(20)
    s_barrier
    s_cmp_le_u32 s77, 9
    s_addc_u32 s71, s76, 9
    s_and_b32 s71, s71, 15
    s_lshl_b32 s70, s71, 7
    s_mul_i32 s71, s71, 393216
    s_add_u32 m0, s72, 24576
    s_add_u32 s66, s71, 2048
    buffer_load_dwordx4 v5, s[12:15], s66 offen lds
    s_add_u32 m0, s72, 26624
    s_add_u32 s66, s71, 100352
    buffer_load_dwordx4 v5, s[12:15], s66 offen lds
    s_add_u32 m0, s72, 28672
    s_add_u32 s66, s71, 198656
    buffer_load_dwordx4 v5, s[12:15], s66 offen lds
    s_add_u32 m0, s72, 30720
    s_add_u32 s66, s71, 296960
    buffer_load_dwordx4 v5, s[12:15], s66 offen lds
    s_add_u32 m0, s72, 0
    s_add_u32 s66, s70, 0
    buffer_load_dwordx4 v4, s[8:11], s66 offen lds
    s_add_u32 m0, s72, 2048
    s_add_u32 s66, s70, 32768
    buffer_load_dwordx4 v4, s[8:11], s66 offen lds
    s_add_u32 m0, s72, 4096
    s_add_u32 s66, s70, 65536
    buffer_load_dwordx4 v4, s[8:11], s66 offen lds
    s_add_u32 m0, s72, 6144
    s_add_u32 s66, s70, 98304
    buffer_load_dwordx4 v4, s[8:11], s66 offen lds
    s_add_u32 m0, s72, 8192
    s_add_u32 s66, s70, 131072
    buffer_load_dwordx4 v4, s[8:11], s66 offen lds
    s_add_u32 m0, s72, 10240
    s_add_u32 s66, s70, 163840
    buffer_load_dwordx4 v4, s[8:11], s66 offen lds
    s_add_u32 m0, s72, 12288
    s_add_u32 s66, s70, 196608
    buffer_load_dwordx4 v4, s[8:11], s66 offen lds
    s_add_u32 m0, s72, 14336
    s_add_u32 s66, s70, 229376
    buffer_load_dwordx4 v4, s[8:11], s66 offen lds
    s_add_u32 m0, s72, 32768
    s_add_u32 s66, s71, 4096
    buffer_load_dwordx4 v5, s[12:15], s66 offen lds
    s_add_u32 m0, s72, 34816
    s_add_u32 s66, s71, 102400
    buffer_load_dwordx4 v5, s[12:15], s66 offen lds
    s_add_u32 m0, s72, 36864
    s_add_u32 s66, s71, 200704
    buffer_load_dwordx4 v5, s[12:15], s66 offen lds
    s_add_u32 m0, s72, 38912
    s_add_u32 s66, s71, 299008
    buffer_load_dwordx4 v5, s[12:15], s66 offen lds
    s_add_u32 m0, s72, 16384
    s_add_u32 s66, s71, 0
    buffer_load_dwordx4 v5, s[12:15], s66 offen lds
    s_add_u32 m0, s72, 18432
    s_add_u32 s66, s71, 98304
    buffer_load_dwordx4 v5, s[12:15], s66 offen lds
    s_add_u32 m0, s72, 20480
    s_add_u32 s66, s71, 196608
    buffer_load_dwordx4 v5, s[12:15], s66 offen lds
    s_add_u32 m0, s72, 22528
    s_add_u32 s66, s71, 294912
    buffer_load_dwordx4 v5, s[12:15], s66 offen lds
    s_waitcnt vmcnt(20)
    s_barrier
    s_cmp_le_u32 s77, 10
    s_addc_u32 s71, s76, 10
    s_and_b32 s71, s71, 15
    s_lshl_b32 s70, s71, 7
    s_mul_i32 s71, s71, 393216
    s_add_u32 m0, s72, 65536
    s_add_u32 s66, s71, 2048
    buffer_load_dwordx4 v5, s[12:15], s66 offen lds
    s_add_u32 m0, s72, 67584
    s_add_u32 s66, s71, 100352
    buffer_load_dwordx4 v5, s[12:15], s66 offen lds
    s_add_u32 m0, s72, 69632
    s_add_u32 s66, s71, 198656
    buffer_load_dwordx4 v5, s[12:15], s66 offen lds
    s_add_u32 m0, s72, 71680
    s_add_u32 s66, s71, 296960
    buffer_load_dwordx4 v5, s[12:15], s66 offen lds
    s_add_u32 m0, s72, 40960
    s_add_u32 s66, s70, 0
    buffer_load_dwordx4 v4, s[8:11], s66 offen lds
    s_add_u32 m0, s72, 43008
    s_add_u32 s66, s70, 32768
    buffer_load_dwordx4 v4, s[8:11], s66 offen lds
    s_add_u32 m0, s72, 45056
    s_add_u32 s66, s70, 65536
    buffer_load_dwordx4 v4, s[8:11], s66 offen lds
    s_add_u32 m0, s72, 47104
    s_add_u32 s66, s70, 98304
    buffer_load_dwordx4 v4, s[8:11], s66 offen lds
    s_add_u32 m0, s72, 49152
    s_add_u32 s66, s70, 131072
    buffer_load_dwordx4 v4, s[8:11], s66 offen lds
    s_add_u32 m0, s72, 51200
    s_add_u32 s66, s70, 163840
    buffer_load_dwordx4 v4, s[8:11], s66 offen lds
    s_add_u32 m0, s72, 53248
    s_add_u32 s66, s70, 196608
    buffer_load_dwordx4 v4, s[8:11], s66 offen lds
    s_add_u32 m0, s72, 55296
    s_add_u32 s66, s70, 229376
    buffer_load_dwordx4 v4, s[8:11], s66 offen lds
    s_add_u32 m0, s72, 73728
    s_add_u32 s66, s71, 4096
    buffer_load_dwordx4 v5, s[12:15], s66 offen lds
    s_add_u32 m0, s72, 75776
    s_add_u32 s66, s71, 102400
    buffer_load_dwordx4 v5, s[12:15], s66 offen lds
    s_add_u32 m0, s72, 77824
    s_add_u32 s66, s71, 200704
    buffer_load_dwordx4 v5, s[12:15], s66 offen lds
    s_add_u32 m0, s72, 79872
    s_add_u32 s66, s71, 299008
    buffer_load_dwordx4 v5, s[12:15], s66 offen lds
    s_add_u32 m0, s72, 57344
    s_add_u32 s66, s71, 0
    buffer_load_dwordx4 v5, s[12:15], s66 offen lds
    s_add_u32 m0, s72, 59392
    s_add_u32 s66, s71, 98304
    buffer_load_dwordx4 v5, s[12:15], s66 offen lds
    s_add_u32 m0, s72, 61440
    s_add_u32 s66, s71, 196608
    buffer_load_dwordx4 v5, s[12:15], s66 offen lds
    s_add_u32 m0, s72, 63488
    s_add_u32 s66, s71, 294912
    buffer_load_dwordx4 v5, s[12:15], s66 offen lds
    s_waitcnt vmcnt(20)
    s_barrier
    s_cmp_le_u32 s77, 11
    s_addc_u32 s71, s76, 11
    s_and_b32 s71, s71, 15
    s_lshl_b32 s70, s71, 7
    s_mul_i32 s71, s71, 393216
    s_add_u32 m0, s72, 106496
    s_add_u32 s66, s71, 2048
    buffer_load_dwordx4 v5, s[12:15], s66 offen lds
    s_add_u32 m0, s72, 108544
    s_add_u32 s66, s71, 100352
    buffer_load_dwordx4 v5, s[12:15], s66 offen lds
    s_add_u32 m0, s72, 110592
    s_add_u32 s66, s71, 198656
    buffer_load_dwordx4 v5, s[12:15], s66 offen lds
    s_add_u32 m0, s72, 112640
    s_add_u32 s66, s71, 296960
    buffer_load_dwordx4 v5, s[12:15], s66 offen lds
    s_add_u32 m0, s72, 81920
    s_add_u32 s66, s70, 0
    buffer_load_dwordx4 v4, s[8:11], s66 offen lds
    s_add_u32 m0, s72, 83968
    s_add_u32 s66, s70, 32768
    buffer_load_dwordx4 v4, s[8:11], s66 offen lds
    s_add_u32 m0, s72, 86016
    s_add_u32 s66, s70, 65536
    buffer_load_dwordx4 v4, s[8:11], s66 offen lds
    s_add_u32 m0, s72, 88064
    s_add_u32 s66, s70, 98304
    buffer_load_dwordx4 v4, s[8:11], s66 offen lds
    s_add_u32 m0, s72, 90112
    s_add_u32 s66, s70, 131072
    buffer_load_dwordx4 v4, s[8:11], s66 offen lds
    s_add_u32 m0, s72, 92160
    s_add_u32 s66, s70, 163840
    buffer_load_dwordx4 v4, s[8:11], s66 offen lds
    s_add_u32 m0, s72, 94208
    s_add_u32 s66, s70, 196608
    buffer_load_dwordx4 v4, s[8:11], s66 offen lds
    s_add_u32 m0, s72, 96256
    s_add_u32 s66, s70, 229376
    buffer_load_dwordx4 v4, s[8:11], s66 offen lds
    s_add_u32 m0, s72, 114688
    s_add_u32 s66, s71, 4096
    buffer_load_dwordx4 v5, s[12:15], s66 offen lds
    s_add_u32 m0, s72, 116736
    s_add_u32 s66, s71, 102400
    buffer_load_dwordx4 v5, s[12:15], s66 offen lds
    s_add_u32 m0, s72, 118784
    s_add_u32 s66, s71, 200704
    buffer_load_dwordx4 v5, s[12:15], s66 offen lds
    s_add_u32 m0, s72, 120832
    s_add_u32 s66, s71, 299008
    buffer_load_dwordx4 v5, s[12:15], s66 offen lds
    s_add_u32 m0, s72, 98304
    s_add_u32 s66, s71, 0
    buffer_load_dwordx4 v5, s[12:15], s66 offen lds
    s_add_u32 m0, s72, 100352
    s_add_u32 s66, s71, 98304
    buffer_load_dwordx4 v5, s[12:15], s66 offen lds
    s_add_u32 m0, s72, 102400
    s_add_u32 s66, s71, 196608
    buffer_load_dwordx4 v5, s[12:15], s66 offen lds
    s_add_u32 m0, s72, 104448
    s_add_u32 s66, s71, 294912
    buffer_load_dwordx4 v5, s[12:15], s66 offen lds
    s_waitcnt vmcnt(20)
    s_barrier
    s_cmp_le_u32 s77, 12
    s_addc_u32 s71, s76, 12
    s_and_b32 s71, s71, 15
    s_lshl_b32 s70, s71, 7
    s_mul_i32 s71, s71, 393216
    s_add_u32 m0, s72, 24576
    s_add_u32 s66, s71, 2048
    buffer_load_dwordx4 v5, s[12:15], s66 offen lds
    s_add_u32 m0, s72, 26624
    s_add_u32 s66, s71, 100352
    buffer_load_dwordx4 v5, s[12:15], s66 offen lds
    s_add_u32 m0, s72, 28672
    s_add_u32 s66, s71, 198656
    buffer_load_dwordx4 v5, s[12:15], s66 offen lds
    s_add_u32 m0, s72, 30720
    s_add_u32 s66, s71, 296960
    buffer_load_dwordx4 v5, s[12:15], s66 offen lds
    s_add_u32 m0, s72, 0
    s_add_u32 s66, s70, 0
    buffer_load_dwordx4 v4, s[8:11], s66 offen lds
    s_add_u32 m0, s72, 2048
    s_add_u32 s66, s70, 32768
    buffer_load_dwordx4 v4, s[8:11], s66 offen lds
    s_add_u32 m0, s72, 4096
    s_add_u32 s66, s70, 65536
    buffer_load_dwordx4 v4, s[8:11], s66 offen lds
    s_add_u32 m0, s72, 6144
    s_add_u32 s66, s70, 98304
    buffer_load_dwordx4 v4, s[8:11], s66 offen lds
    s_add_u32 m0, s72, 8192
    s_add_u32 s66, s70, 131072
    buffer_load_dwordx4 v4, s[8:11], s66 offen lds
    s_add_u32 m0, s72, 10240
    s_add_u32 s66, s70, 163840
    buffer_load_dwordx4 v4, s[8:11], s66 offen lds
    s_add_u32 m0, s72, 12288
    s_add_u32 s66, s70, 196608
    buffer_load_dwordx4 v4, s[8:11], s66 offen lds
    s_add_u32 m0, s72, 14336
    s_add_u32 s66, s70, 229376
    buffer_load_dwordx4 v4, s[8:11], s66 offen lds
    s_add_u32 m0, s72, 32768
    s_add_u32 s66, s71, 4096
    buffer_load_dwordx4 v5, s[12:15], s66 offen lds
    s_add_u32 m0, s72, 34816
    s_add_u32 s66, s71, 102400
    buffer_load_dwordx4 v5, s[12:15], s66 offen lds
    s_add_u32 m0, s72, 36864
    s_add_u32 s66, s71, 200704
    buffer_load_dwordx4 v5, s[12:15], s66 offen lds
    s_add_u32 m0, s72, 38912
    s_add_u32 s66, s71, 299008
    buffer_load_dwordx4 v5, s[12:15], s66 offen lds
    s_add_u32 m0, s72, 16384
    s_add_u32 s66, s71, 0
    buffer_load_dwordx4 v5, s[12:15], s66 offen lds
    s_add_u32 m0, s72, 18432
    s_add_u32 s66, s71, 98304
    buffer_load_dwordx4 v5, s[12:15], s66 offen lds
    s_add_u32 m0, s72, 20480
    s_add_u32 s66, s71, 196608
    buffer_load_dwordx4 v5, s[12:15], s66 offen lds
    s_add_u32 m0, s72, 22528
    s_add_u32 s66, s71, 294912
    buffer_load_dwordx4 v5, s[12:15], s66 offen lds
    s_waitcnt vmcnt(20)
    s_barrier
    s_cmp_le_u32 s77, 13
    s_addc_u32 s71, s76, 13
    s_and_b32 s71, s71, 15
    s_lshl_b32 s70, s71, 7
    s_mul_i32 s71, s71, 393216
    s_add_u32 m0, s72, 65536
    s_add_u32 s66, s71, 2048
    buffer_load_dwordx4 v5, s[12:15], s66 offen lds
    s_add_u32 m0, s72, 67584
    s_add_u32 s66, s71, 100352
    buffer_load_dwordx4 v5, s[12:15], s66 offen lds
    s_add_u32 m0, s72, 69632
    s_add_u32 s66, s71, 198656
    buffer_load_dwordx4 v5, s[12:15], s66 offen lds
    s_add_u32 m0, s72, 71680
    s_add_u32 s66, s71, 296960
    buffer_load_dwordx4 v5, s[12:15], s66 offen lds
    s_add_u32 m0, s72, 40960
    s_add_u32 s66, s70, 0
    buffer_load_dwordx4 v4, s[8:11], s66 offen lds
    s_add_u32 m0, s72, 43008
    s_add_u32 s66, s70, 32768
    buffer_load_dwordx4 v4, s[8:11], s66 offen lds
    s_add_u32 m0, s72, 45056
    s_add_u32 s66, s70, 65536
    buffer_load_dwordx4 v4, s[8:11], s66 offen lds
    s_add_u32 m0, s72, 47104
    s_add_u32 s66, s70, 98304
    buffer_load_dwordx4 v4, s[8:11], s66 offen lds
    s_add_u32 m0, s72, 49152
    s_add_u32 s66, s70, 131072
    buffer_load_dwordx4 v4, s[8:11], s66 offen lds
    s_add_u32 m0, s72, 51200
    s_add_u32 s66, s70, 163840
    buffer_load_dwordx4 v4, s[8:11], s66 offen lds
    s_add_u32 m0, s72, 53248
    s_add_u32 s66, s70, 196608
    buffer_load_dwordx4 v4, s[8:11], s66 offen lds
    s_add_u32 m0, s72, 55296
    s_add_u32 s66, s70, 229376
    buffer_load_dwordx4 v4, s[8:11], s66 offen lds
    s_add_u32 m0, s72, 73728
    s_add_u32 s66, s71, 4096
    buffer_load_dwordx4 v5, s[12:15], s66 offen lds
    s_add_u32 m0, s72, 75776
    s_add_u32 s66, s71, 102400
    buffer_load_dwordx4 v5, s[12:15], s66 offen lds
    s_add_u32 m0, s72, 77824
    s_add_u32 s66, s71, 200704
    buffer_load_dwordx4 v5, s[12:15], s66 offen lds
    s_add_u32 m0, s72, 79872
    s_add_u32 s66, s71, 299008
    buffer_load_dwordx4 v5, s[12:15], s66 offen lds
    s_add_u32 m0, s72, 57344
    s_add_u32 s66, s71, 0
    buffer_load_dwordx4 v5, s[12:15], s66 offen lds
    s_add_u32 m0, s72, 59392
    s_add_u32 s66, s71, 98304
    buffer_load_dwordx4 v5, s[12:15], s66 offen lds
    s_add_u32 m0, s72, 61440
    s_add_u32 s66, s71, 196608
    buffer_load_dwordx4 v5, s[12:15], s66 offen lds
    s_add_u32 m0, s72, 63488
    s_add_u32 s66, s71, 294912
    buffer_load_dwordx4 v5, s[12:15], s66 offen lds
    s_waitcnt vmcnt(20)
    s_barrier
    s_cmp_le_u32 s77, 14
    s_addc_u32 s71, s76, 14
    s_and_b32 s71, s71, 15
    s_lshl_b32 s70, s71, 7
    s_mul_i32 s71, s71, 393216
    s_add_u32 m0, s72, 106496
    s_add_u32 s66, s71, 2048
    buffer_load_dwordx4 v5, s[12:15], s66 offen lds
    s_add_u32 m0, s72, 108544
    s_add_u32 s66, s71, 100352
    buffer_load_dwordx4 v5, s[12:15], s66 offen lds
    s_add_u32 m0, s72, 110592
    s_add_u32 s66, s71, 198656
    buffer_load_dwordx4 v5, s[12:15], s66 offen lds
    s_add_u32 m0, s72, 112640
    s_add_u32 s66, s71, 296960
    buffer_load_dwordx4 v5, s[12:15], s66 offen lds
    s_add_u32 m0, s72, 81920
    s_add_u32 s66, s70, 0
    buffer_load_dwordx4 v4, s[8:11], s66 offen lds
    s_add_u32 m0, s72, 83968
    s_add_u32 s66, s70, 32768
    buffer_load_dwordx4 v4, s[8:11], s66 offen lds
    s_add_u32 m0, s72, 86016
    s_add_u32 s66, s70, 65536
    buffer_load_dwordx4 v4, s[8:11], s66 offen lds
    s_add_u32 m0, s72, 88064
    s_add_u32 s66, s70, 98304
    buffer_load_dwordx4 v4, s[8:11], s66 offen lds
    s_add_u32 m0, s72, 90112
    s_add_u32 s66, s70, 131072
    buffer_load_dwordx4 v4, s[8:11], s66 offen lds
    s_add_u32 m0, s72, 92160
    s_add_u32 s66, s70, 163840
    buffer_load_dwordx4 v4, s[8:11], s66 offen lds
    s_add_u32 m0, s72, 94208
    s_add_u32 s66, s70, 196608
    buffer_load_dwordx4 v4, s[8:11], s66 offen lds
    s_add_u32 m0, s72, 96256
    s_add_u32 s66, s70, 229376
    buffer_load_dwordx4 v4, s[8:11], s66 offen lds
    s_add_u32 m0, s72, 114688
    s_add_u32 s66, s71, 4096
    buffer_load_dwordx4 v5, s[12:15], s66 offen lds
    s_add_u32 m0, s72, 116736
    s_add_u32 s66, s71, 102400
    buffer_load_dwordx4 v5, s[12:15], s66 offen lds
    s_add_u32 m0, s72, 118784
    s_add_u32 s66, s71, 200704
    buffer_load_dwordx4 v5, s[12:15], s66 offen lds
    s_add_u32 m0, s72, 120832
    s_add_u32 s66, s71, 299008
    buffer_load_dwordx4 v5, s[12:15], s66 offen lds
    s_add_u32 m0, s72, 98304
    s_add_u32 s66, s71, 0
    buffer_load_dwordx4 v5, s[12:15], s66 offen lds
    s_add_u32 m0, s72, 100352
    s_add_u32 s66, s71, 98304
    buffer_load_dwordx4 v5, s[12:15], s66 offen lds
    s_add_u32 m0, s72, 102400
    s_add_u32 s66, s71, 196608
    buffer_load_dwordx4 v5, s[12:15], s66 offen lds
    s_add_u32 m0, s72, 104448
    s_add_u32 s66, s71, 294912
    buffer_load_dwordx4 v5, s[12:15], s66 offen lds
    s_mov_b32 s71, s5
    s_lshl_b32 s70, s71, 7
    s_mul_i32 s71, s71, 393216
    s_add_u32 m0, s72, 139264
    s_add_u32 s66, s71, 2048
    buffer_load_dwordx4 v5, s[12:15], s66 offen lds
    s_add_u32 m0, s72, 141312
    s_add_u32 s66, s71, 100352
    buffer_load_dwordx4 v5, s[12:15], s66 offen lds
    s_add_u32 m0, s72, 143360
    s_add_u32 s66, s71, 198656
    buffer_load_dwordx4 v5, s[12:15], s66 offen lds
    s_add_u32 m0, s72, 145408
    s_add_u32 s66, s71, 296960
    buffer_load_dwordx4 v5, s[12:15], s66 offen lds
    s_waitcnt vmcnt(24)
    s_barrier
    s_mov_b32 s71, s5
    s_lshl_b32 s70, s71, 7
    s_mul_i32 s71, s71, 393216
    s_add_u32 m0, s72, 122880
    s_add_u32 s66, s70, 0
    buffer_load_dwordx4 v4, s[8:11], s66 offen lds
    s_add_u32 m0, s72, 124928
    s_add_u32 s66, s70, 32768
    buffer_load_dwordx4 v4, s[8:11], s66 offen lds
    s_add_u32 m0, s72, 126976
    s_add_u32 s66, s70, 65536
    buffer_load_dwordx4 v4, s[8:11], s66 offen lds
    s_add_u32 m0, s72, 129024
    s_add_u32 s66, s70, 98304
    buffer_load_dwordx4 v4, s[8:11], s66 offen lds
    s_add_u32 m0, s72, 131072
    s_add_u32 s66, s70, 131072
    buffer_load_dwordx4 v4, s[8:11], s66 offen lds
    s_add_u32 m0, s72, 133120
    s_add_u32 s66, s70, 163840
    buffer_load_dwordx4 v4, s[8:11], s66 offen lds
    s_add_u32 m0, s72, 135168
    s_add_u32 s66, s70, 196608
    buffer_load_dwordx4 v4, s[8:11], s66 offen lds
    s_add_u32 m0, s72, 137216
    s_add_u32 s66, s70, 229376
    buffer_load_dwordx4 v4, s[8:11], s66 offen lds
    s_mov_b32 s71, s5
    s_lshl_b32 s70, s71, 7
    s_mul_i32 s71, s71, 393216
    s_add_u32 m0, s72, 147456
    s_add_u32 s66, s71, 4096
    buffer_load_dwordx4 v5, s[12:15], s66 offen lds
    s_add_u32 m0, s72, 149504
    s_add_u32 s66, s71, 102400
    buffer_load_dwordx4 v5, s[12:15], s66 offen lds
    s_add_u32 m0, s72, 151552
    s_add_u32 s66, s71, 200704
    buffer_load_dwordx4 v5, s[12:15], s66 offen lds
    s_add_u32 m0, s72, 153600
    s_add_u32 s66, s71, 299008
    buffer_load_dwordx4 v5, s[12:15], s66 offen lds
    s_add_u32 m0, s72, 16384
    s_add_u32 s66, s71, 0
    buffer_load_dwordx4 v5, s[12:15], s66 offen lds
    s_add_u32 m0, s72, 18432
    s_add_u32 s66, s71, 98304
    buffer_load_dwordx4 v5, s[12:15], s66 offen lds
    s_add_u32 m0, s72, 20480
    s_add_u32 s66, s71, 196608
    buffer_load_dwordx4 v5, s[12:15], s66 offen lds
    s_add_u32 m0, s72, 22528
    s_add_u32 s66, s71, 294912
    buffer_load_dwordx4 v5, s[12:15], s66 offen lds
    s_waitcnt vmcnt(20)
    s_barrier
    s_mov_b32 s66, 0
    buffer_load_dwordx4 v[96:99], v7, s[32:35], s66 offen
    s_mov_b32 s66, 2048
    buffer_load_dwordx4 v[100:103], v7, s[32:35], s66 offen
    s_mov_b32 s66, 4096
    buffer_load_dwordx4 v[104:107], v7, s[32:35], s66 offen
    s_mov_b32 s66, 6144
    buffer_load_dwordx4 v[108:111], v7, s[32:35], s66 offen
    s_mov_b32 s66, 8192
    buffer_load_dwordx4 v[112:115], v7, s[32:35], s66 offen
    s_mov_b32 s66, 10240
    buffer_load_dwordx4 v[116:119], v7, s[32:35], s66 offen
    s_mov_b32 s66, 12288
    buffer_load_dwordx4 v[120:123], v7, s[32:35], s66 offen
    s_mov_b32 s66, 14336
    buffer_load_dwordx4 v[124:127], v7, s[32:35], s66 offen
    s_waitcnt vmcnt(8)
    s_branch H_b14
WORK:
    v_mov_b32 v14, 0
    v_lshlrev_b32 v8, 5, v2
    v_add_u32 v8, 6127616, v8
    s_lshl_b32 s66, s2, 2
    s_add_u32 s66, s66, s44
    s_cmp_lg_u32 s66, 2
    s_cbranch_scc1 W_nn
    s_movk_i32 s66, 0
    buffer_load_dword v72, v8, s[16:19], s66 offen offset:4 sc1
    s_movk_i32 s66, 2048
    buffer_load_dword v73, v8, s[16:19], s66 offen offset:4 sc1
    s_movk_i32 s66, 4096
    buffer_load_dword v74, v8, s[16:19], s66 offen offset:4 sc1
    s_movk_i32 s66, 6144
    buffer_load_dword v75, v8, s[16:19], s66 offen offset:4 sc1
    s_waitcnt vmcnt(0)
    v_readfirstlane_b32 s66, v72
    s_or_b32 s66, s66, 1
W_nl:
    s_add_u32 s66, s66, 2
    v_cmp_eq_u32 vcc, s66, v72
    v_cmp_eq_u32 s[68:69], s66, v73
    s_or_b64 vcc, vcc, s[68:69]
    v_cmp_eq_u32 s[68:69], s66, v74
    s_or_b64 vcc, vcc, s[68:69]
    v_cmp_eq_u32 s[68:69], s66, v75
    s_or_b64 vcc, vcc, s[68:69]
    s_cmp_lg_u64 vcc, 0
    s_cbranch_scc1 W_nl
    v_mov_b32 v10, 0
    v_mov_b32 v11, s66
    s_mov_b64 exec, 1
    buffer_store_dword v11, v10, s[40:43], 0 offen sc0 sc1
    s_mov_b64 exec, -1
W_nn:
    s_and_b32 s48, s44, 1
    s_lshl_b32 s66, s79, 2
    s_add_u32 s66, s66, s73
    s_and_b32 s51, s66, 15
    s_lshr_b32 s67, s66, 4
    s_lshl_b32 s54, s67, 5
    s_lshl_b32 s66, s48, 4
    s_add_u32 s54, s54, s66
    s_add_u32 s54, s54, s51
    s_lshl_b32 s54, s54, 10
    s_add_u32 s54, s54, 5308416
    s_lshl_b32 s51, s51, 6
    v_lshrrev_b32 v10, 5, v2
    v_and_b32 v11, 31, v2
    v_lshlrev_b32 v12, 5, v10
    v_add_u32 v12, s51, v12
    v_mul_u32_u24 v12, 7168, v12
    v_lshl_add_u32 v12, v11, 4, v12
    s_lshl_b32 s67, s67, 9
    v_add_u32 v6, s67, v12
    s_waitcnt vmcnt(5)
    s_barrier
    s_waitcnt vmcnt(0)
    s_barrier
    s_lshl_b32 s50, s4, 7
    s_lshl_b32 s66, s5, 3
    s_add_u32 s50, s50, s66
    s_lshl_b32 s66, s48, 2
    s_add_u32 s50, s50, s66
    s_lshl_b32 s66, s50, 11
    s_add_u32 s67, s66, 4096
    buffer_load_dwordx4 v[16:19], v9, s[8:11], s66 offen offset:0
    buffer_load_dwordx4 v[20:23], v9, s[8:11], s66 offen offset:1024
    buffer_load_dwordx4 v[24:27], v9, s[8:11], s66 offen offset:2048
    buffer_load_dwordx4 v[28:31], v9, s[8:11], s66 offen offset:3072
    buffer_load_dwordx4 v[32:35], v9, s[8:11], s67 offen offset:0
    buffer_load_dwordx4 v[36:39], v9, s[8:11], s67 offen offset:1024
    buffer_load_dwordx4 v[40:43], v9, s[8:11], s67 offen offset:2048
    buffer_load_dwordx4 v[44:47], v9, s[8:11], s67 offen offset:3072
    s_lshl_b32 s66, s48, 11
    s_add_u32 m0, s66, 159744
    s_nop 0
    buffer_load_dwordx4 v9, s[24:27], 0 offen offset:0 lds
    buffer_load_dwordx4 v9, s[24:27], 0 offen offset:1024 lds
    v_mov_b32 v72, -1
    v_mov_b32 v73, -1
    v_mov_b32 v74, -1
    v_mov_b32 v75, -1
    v_and_b32 v12, 3, v2
    v_lshlrev_b32 v12, 4, v12
    v_add_u32 v12, s53, v12
    s_add_u32 s66, s53, 4294965248
    v_subrev_u32 v13, 4, v2
    v_cmp_gt_u32 vcc, 4, v13
    v_lshlrev_b32 v13, 4, v13
    v_add_u32 v13, s66, v13
    v_cndmask_b32 v12, v12, v13, vcc
    s_add_u32 s66, s55, 0
    v_subrev_u32 v13, 24, v2
    v_cmp_gt_u32 vcc, 16, v13
    v_lshlrev_b32 v13, 4, v13
    v_add_u32 v13, s66, v13
    v_cndmask_b32 v12, v12, v13, vcc
    s_add_u32 s66, s55, 4294934528
    v_subrev_u32 v13, 40, v2
    v_cmp_gt_u32 vcc, 16, v13
    v_lshlrev_b32 v13, 4, v13
    v_add_u32 v13, s66, v13
    v_cndmask_b32 v12, v12, v13, vcc
    s_sub_u32 s66, s56, 32768
    buffer_store_dwordx4 v[72:75], v9, s[16:19], s56 offen sc0 sc1
    buffer_store_dwordx4 v[72:75], v9, s[16:19], s66 offen sc0 sc1
    buffer_store_dwordx4 v[72:75], v9, s[16:19], s54 offen sc0 sc1
    buffer_store_dwordx4 v[72:75], v12, s[16:19], 0 offen sc0 sc1
    s_waitcnt vmcnt(4)
    s_barrier
    s_cmp_lg_u32 s48, 0
    s_cbranch_scc1 W_k1
    buffer_load_dword v15, v14, s[40:43], 0 offen sc1
W_k1:
    v_add_u32 v10, 159744, v9
    v_bfe_u32 v3, v2, 4, 1
    v_lshrrev_b32 v11, 5, v2
    v_lshl_add_u32 v3, v3, 1, v11
    s_mov_b32 s67, 0xffff0000
    s_mov_b32 s68, 0x00010001
    s_mov_b32 s69, 0x00010001
    ds_read_b128 v[48:51], v10 offset:0
    ds_read_b128 v[52:55], v10 offset:1024
    v_mov_b32 v72, 0
    v_mov_b32 v73, 0
    v_mov_b32 v74, 0
    v_mov_b32 v75, 0
    s_waitcnt lgkmcnt(0)
    v_dot2_f32_bf16 v72, v16, v48, v72
    v_dot2_f32_bf16 v73, v24, v48, v73
    v_dot2_f32_bf16 v74, v32, v48, v74
    v_dot2_f32_bf16 v75, v40, v48, v75
    v_dot2_f32_bf16 v72, v17, v49, v72
    v_dot2_f32_bf16 v73, v25, v49, v73
    v_dot2_f32_bf16 v74, v33, v49, v74
    v_dot2_f32_bf16 v75, v41, v49, v75
    v_dot2_f32_bf16 v72, v18, v50, v72
    v_dot2_f32_bf16 v73, v26, v50, v73
    v_dot2_f32_bf16 v74, v34, v50, v74
    v_dot2_f32_bf16 v75, v42, v50, v75
    v_dot2_f32_bf16 v72, v19, v51, v72
    v_dot2_f32_bf16 v73, v27, v51, v73
    v_dot2_f32_bf16 v74, v35, v51, v74
    v_dot2_f32_bf16 v75, v43, v51, v75
    v_dot2_f32_bf16 v72, v20, v52, v72
    v_dot2_f32_bf16 v73, v28, v52, v73
    v_dot2_f32_bf16 v74, v36, v52, v74
    v_dot2_f32_bf16 v75, v44, v52, v75
    v_dot2_f32_bf16 v72, v21, v53, v72
    v_dot2_f32_bf16 v73, v29, v53, v73
    v_dot2_f32_bf16 v74, v37, v53, v74
    v_dot2_f32_bf16 v75, v45, v53, v75
    v_dot2_f32_bf16 v72, v22, v54, v72
    v_dot2_f32_bf16 v73, v30, v54, v73
    v_dot2_f32_bf16 v74, v38, v54, v74
    v_dot2_f32_bf16 v75, v46, v54, v75
    v_dot2_f32_bf16 v72, v23, v55, v72
    v_dot2_f32_bf16 v73, v31, v55, v73
    v_dot2_f32_bf16 v74, v39, v55, v74
    v_dot2_f32_bf16 v75, v47, v55, v75
    s_nop 2
    ds_read_b128 v[48:51], v10 offset:2048
    ds_read_b128 v[52:55], v10 offset:3072
    s_nop 1
    v_permlane32_swap_b32 v72, v73
    v_permlane32_swap_b32 v74, v75
    v_add_f32 v72, v72, v73
    v_add_f32 v74, v74, v75
    s_nop 1
    v_permlane16_swap_b32 v72, v74
    v_add_f32 v72, v72, v74
    s_nop 1
    v_add_f32_dpp v72, v72, v72 quad_perm:[1,0,3,2] row_mask:0xf bank_mask:0xf
    s_nop 1
    v_add_f32_dpp v72, v72, v72 quad_perm:[2,3,0,1] row_mask:0xf bank_mask:0xf
    s_nop 1
    v_add_f32_dpp v72, v72, v72 row_half_mirror row_mask:0xf bank_mask:0xf
    s_nop 1
    v_add_f32_dpp v72, v72, v72 row_mirror row_mask:0xf bank_mask:0xf
    s_sub_u32 s66, 34815, s50
    v_cvt_pk_bf16_f32 v72, 0, v72
    v_sub_u32 v73, s66, v3
    v_ashrrev_i32 v76, 31, v72
    v_or_b32 v76, 0x80000000, v76
    v_xor_b32 v72, v72, v76
    v_and_or_b32 v72, v72, s67, v73
    v_mov_b32 v10, 155680
    s_mov_b64 exec, s[68:69]
    ds_max_u32 v10, v72
    s_mov_b64 exec, -1
    s_waitcnt vmcnt(0)
    s_waitcnt lgkmcnt(0)
    s_barrier
    s_cmp_lg_u32 s48, 0
    s_cbranch_scc1 W_k2
    v_mov_b32 v10, 155680
    ds_read_b32 v12, v10
    s_waitcnt vmcnt(0)
    s_mov_b32 s67, 0
W_ts:
    v_cmp_eq_u32 vcc, 0, v15
    s_cbranch_vccz W_tok
    s_add_u32 s67, s67, 1
    s_cmp_ge_u32 s67, 200000
    s_cbranch_scc1 W_tok
    s_sleep 4
    buffer_load_dword v15, v14, s[40:43], 0 offen sc1
    s_waitcnt vmcnt(0)
    s_branch W_ts
W_tok:
    s_lshl_b32 s66, s2, 5
    s_add_u32 s66, s66, 6127616
    v_mov_b32 v10, s66
    v_mov_b32 v13, v15
    s_waitcnt lgkmcnt(0)
    s_mov_b64 exec, 1
    buffer_store_dwordx2 v[12:13], v10, s[16:19], 0 offen sc0 sc1
    s_mov_b64 exec, -1
W_k2:
    v_mov_b32 v248, -1
    v_mov_b32 v249, -1
    v_mov_b32 v250, -1
    v_mov_b32 v251, -1
    s_lshl_b32 s67, s4, 3
    s_lshl_b32 s66, s48, 2
    s_add_u32 s67, s67, s66
    s_lshl_b32 s67, s67, 15
    s_lshl_b32 s66, s5, 11
    s_add_u32 s67, s67, s66
    s_add_u32 s66, s67, 0
    buffer_store_dwordx4 v[248:251], v9, s[16:19], s66 offen offset:0 sc0 sc1
    s_add_u32 s66, s67, 0
    buffer_store_dwordx4 v[248:251], v9, s[16:19], s66 offen offset:1024 sc0 sc1
    s_add_u32 s66, s67, 32768
    buffer_store_dwordx4 v[248:251], v9, s[16:19], s66 offen offset:0 sc0 sc1
    s_add_u32 s66, s67, 32768
    buffer_store_dwordx4 v[248:251], v9, s[16:19], s66 offen offset:1024 sc0 sc1
    s_add_u32 s66, s67, 65536
    buffer_store_dwordx4 v[248:251], v9, s[16:19], s66 offen offset:0 sc0 sc1
    s_add_u32 s66, s67, 65536
    buffer_store_dwordx4 v[248:251], v9, s[16:19], s66 offen offset:1024 sc0 sc1
    s_add_u32 s66, s67, 98304
    buffer_store_dwordx4 v[248:251], v9, s[16:19], s66 offen offset:0 sc0 sc1
    s_add_u32 s66, s67, 98304
    buffer_store_dwordx4 v[248:251], v9, s[16:19], s66 offen offset:1024 sc0 sc1
    v_lshlrev_b32 v56, 16, v48
    v_and_b32 v57, 0xffff0000, v48
    v_lshlrev_b32 v58, 16, v49
    v_and_b32 v59, 0xffff0000, v49
    v_lshlrev_b32 v60, 16, v50
    v_and_b32 v61, 0xffff0000, v50
    v_lshlrev_b32 v62, 16, v51
    v_and_b32 v63, 0xffff0000, v51
    v_lshlrev_b32 v64, 16, v52
    v_and_b32 v65, 0xffff0000, v52
    v_lshlrev_b32 v66, 16, v53
    v_and_b32 v67, 0xffff0000, v53
    v_lshlrev_b32 v68, 16, v54
    v_and_b32 v69, 0xffff0000, v54
    v_lshlrev_b32 v70, 16, v55
    v_and_b32 v71, 0xffff0000, v55
    v_mov_b32 v76, 0
    v_lshlrev_b32 v72, 16, v16
    v_and_b32 v73, 0xffff0000, v16
    v_mul_f32 v72, v72, v56
    v_mul_f32 v73, v73, v57
    v_cvt_pk_bf16_f32 v72, 0, v72
    v_cvt_pk_bf16_f32 v73, 0, v73
    v_add_f32 v76, v76, v72
    v_add_f32 v76, v76, v73
    v_lshlrev_b32 v72, 16, v17
    v_and_b32 v73, 0xffff0000, v17
    v_mul_f32 v72, v72, v58
    v_mul_f32 v73, v73, v59
    v_cvt_pk_bf16_f32 v72, 0, v72
    v_cvt_pk_bf16_f32 v73, 0, v73
    v_add_f32 v76, v76, v72
    v_add_f32 v76, v76, v73
    v_lshlrev_b32 v72, 16, v18
    v_and_b32 v73, 0xffff0000, v18
    v_mul_f32 v72, v72, v60
    v_mul_f32 v73, v73, v61
    v_cvt_pk_bf16_f32 v72, 0, v72
    v_cvt_pk_bf16_f32 v73, 0, v73
    v_add_f32 v76, v76, v72
    v_add_f32 v76, v76, v73
    v_lshlrev_b32 v72, 16, v19
    v_and_b32 v73, 0xffff0000, v19
    v_mul_f32 v72, v72, v62
    v_mul_f32 v73, v73, v63
    v_cvt_pk_bf16_f32 v72, 0, v72
    v_cvt_pk_bf16_f32 v73, 0, v73
    v_add_f32 v76, v76, v72
    v_add_f32 v76, v76, v73
    v_lshlrev_b32 v72, 16, v20
    v_and_b32 v73, 0xffff0000, v20
    v_mul_f32 v72, v72, v64
    v_mul_f32 v73, v73, v65
    v_cvt_pk_bf16_f32 v72, 0, v72
    v_cvt_pk_bf16_f32 v73, 0, v73
    v_add_f32 v76, v76, v72
    v_add_f32 v76, v76, v73
    v_lshlrev_b32 v72, 16, v21
    v_and_b32 v73, 0xffff0000, v21
    v_mul_f32 v72, v72, v66
    v_mul_f32 v73, v73, v67
    v_cvt_pk_bf16_f32 v72, 0, v72
    v_cvt_pk_bf16_f32 v73, 0, v73
    v_add_f32 v76, v76, v72
    v_add_f32 v76, v76, v73
    v_lshlrev_b32 v72, 16, v22
    v_and_b32 v73, 0xffff0000, v22
    v_mul_f32 v72, v72, v68
    v_mul_f32 v73, v73, v69
    v_cvt_pk_bf16_f32 v72, 0, v72
    v_cvt_pk_bf16_f32 v73, 0, v73
    v_add_f32 v76, v76, v72
    v_add_f32 v76, v76, v73
    v_lshlrev_b32 v72, 16, v23
    v_and_b32 v73, 0xffff0000, v23
    v_mul_f32 v72, v72, v70
    v_mul_f32 v73, v73, v71
    v_cvt_pk_bf16_f32 v72, 0, v72
    v_cvt_pk_bf16_f32 v73, 0, v73
    v_add_f32 v76, v76, v72
    v_add_f32 v76, v76, v73
    s_barrier
    s_mov_b32 s66, 0
    buffer_load_dwordx4 v[96:99], v6, s[28:31], s66 offen nt
    s_mov_b32 s66, 7168
    buffer_load_dwordx4 v[100:103], v6, s[28:31], s66 offen nt
    s_mov_b32 s66, 14336
    buffer_load_dwordx4 v[104:107], v6, s[28:31], s66 offen nt
    s_mov_b32 s66, 21504
    buffer_load_dwordx4 v[108:111], v6, s[28:31], s66 offen nt
    s_mov_b32 s66, 28672
    buffer_load_dwordx4 v[112:115], v6, s[28:31], s66 offen nt
    s_mov_b32 s66, 35840
    buffer_load_dwordx4 v[116:119], v6, s[28:31], s66 offen nt
    s_mov_b32 s66, 43008
    buffer_load_dwordx4 v[120:123], v6, s[28:31], s66 offen nt
    s_mov_b32 s66, 50176
    buffer_load_dwordx4 v[124:127], v6, s[28:31], s66 offen nt
    v_mov_b32 v77, 0
    v_lshlrev_b32 v72, 16, v24
    v_and_b32 v73, 0xffff0000, v24
    v_mul_f32 v72, v72, v56
    v_mul_f32 v73, v73, v57
    v_cvt_pk_bf16_f32 v72, 0, v72
    v_cvt_pk_bf16_f32 v73, 0, v73
    v_add_f32 v77, v77, v72
    v_add_f32 v77, v77, v73
    v_lshlrev_b32 v72, 16, v25
    v_and_b32 v73, 0xffff0000, v25
    v_mul_f32 v72, v72, v58
    v_mul_f32 v73, v73, v59
    v_cvt_pk_bf16_f32 v72, 0, v72
    v_cvt_pk_bf16_f32 v73, 0, v73
    v_add_f32 v77, v77, v72
    v_add_f32 v77, v77, v73
    v_lshlrev_b32 v72, 16, v26
    v_and_b32 v73, 0xffff0000, v26
    v_mul_f32 v72, v72, v60
    v_mul_f32 v73, v73, v61
    v_cvt_pk_bf16_f32 v72, 0, v72
    v_cvt_pk_bf16_f32 v73, 0, v73
    v_add_f32 v77, v77, v72
    v_add_f32 v77, v77, v73
    v_lshlrev_b32 v72, 16, v27
    v_and_b32 v73, 0xffff0000, v27
    v_mul_f32 v72, v72, v62
    v_mul_f32 v73, v73, v63
    v_cvt_pk_bf16_f32 v72, 0, v72
    v_cvt_pk_bf16_f32 v73, 0, v73
    v_add_f32 v77, v77, v72
    v_add_f32 v77, v77, v73
    v_lshlrev_b32 v72, 16, v28
    v_and_b32 v73, 0xffff0000, v28
    v_mul_f32 v72, v72, v64
    v_mul_f32 v73, v73, v65
    v_cvt_pk_bf16_f32 v72, 0, v72
    v_cvt_pk_bf16_f32 v73, 0, v73
    v_add_f32 v77, v77, v72
    v_add_f32 v77, v77, v73
    v_lshlrev_b32 v72, 16, v29
    v_and_b32 v73, 0xffff0000, v29
    v_mul_f32 v72, v72, v66
    v_mul_f32 v73, v73, v67
    v_cvt_pk_bf16_f32 v72, 0, v72
    v_cvt_pk_bf16_f32 v73, 0, v73
    v_add_f32 v77, v77, v72
    v_add_f32 v77, v77, v73
    v_lshlrev_b32 v72, 16, v30
    v_and_b32 v73, 0xffff0000, v30
    v_mul_f32 v72, v72, v68
    v_mul_f32 v73, v73, v69
    v_cvt_pk_bf16_f32 v72, 0, v72
    v_cvt_pk_bf16_f32 v73, 0, v73
    v_add_f32 v77, v77, v72
    v_add_f32 v77, v77, v73
    v_lshlrev_b32 v72, 16, v31
    v_and_b32 v73, 0xffff0000, v31
    v_mul_f32 v72, v72, v70
    v_mul_f32 v73, v73, v71
    v_cvt_pk_bf16_f32 v72, 0, v72
    v_cvt_pk_bf16_f32 v73, 0, v73
    v_add_f32 v77, v77, v72
    v_add_f32 v77, v77, v73
    v_mov_b32 v78, 0
    v_lshlrev_b32 v72, 16, v32
    v_and_b32 v73, 0xffff0000, v32
    v_mul_f32 v72, v72, v56
    v_mul_f32 v73, v73, v57
    v_cvt_pk_bf16_f32 v72, 0, v72
    v_cvt_pk_bf16_f32 v73, 0, v73
    v_add_f32 v78, v78, v72
    v_add_f32 v78, v78, v73
    v_lshlrev_b32 v72, 16, v33
    v_and_b32 v73, 0xffff0000, v33
    v_mul_f32 v72, v72, v58
    v_mul_f32 v73, v73, v59
    v_cvt_pk_bf16_f32 v72, 0, v72
    v_cvt_pk_bf16_f32 v73, 0, v73
    v_add_f32 v78, v78, v72
    v_add_f32 v78, v78, v73
    v_lshlrev_b32 v72, 16, v34
    v_and_b32 v73, 0xffff0000, v34
    v_mul_f32 v72, v72, v60
    v_mul_f32 v73, v73, v61
    v_cvt_pk_bf16_f32 v72, 0, v72
    v_cvt_pk_bf16_f32 v73, 0, v73
    v_add_f32 v78, v78, v72
    v_add_f32 v78, v78, v73
    v_lshlrev_b32 v72, 16, v35
    v_and_b32 v73, 0xffff0000, v35
    v_mul_f32 v72, v72, v62
    v_mul_f32 v73, v73, v63
    v_cvt_pk_bf16_f32 v72, 0, v72
    v_cvt_pk_bf16_f32 v73, 0, v73
    v_add_f32 v78, v78, v72
    v_add_f32 v78, v78, v73
    v_lshlrev_b32 v72, 16, v36
    v_and_b32 v73, 0xffff0000, v36
    v_mul_f32 v72, v72, v64
    v_mul_f32 v73, v73, v65
    v_cvt_pk_bf16_f32 v72, 0, v72
    v_cvt_pk_bf16_f32 v73, 0, v73
    v_add_f32 v78, v78, v72
    v_add_f32 v78, v78, v73
    v_lshlrev_b32 v72, 16, v37
    v_and_b32 v73, 0xffff0000, v37
    v_mul_f32 v72, v72, v66
    v_mul_f32 v73, v73, v67
    v_cvt_pk_bf16_f32 v72, 0, v72
    v_cvt_pk_bf16_f32 v73, 0, v73
    v_add_f32 v78, v78, v72
    v_add_f32 v78, v78, v73
    v_lshlrev_b32 v72, 16, v38
    v_and_b32 v73, 0xffff0000, v38
    v_mul_f32 v72, v72, v68
    v_mul_f32 v73, v73, v69
    v_cvt_pk_bf16_f32 v72, 0, v72
    v_cvt_pk_bf16_f32 v73, 0, v73
    v_add_f32 v78, v78, v72
    v_add_f32 v78, v78, v73
    v_lshlrev_b32 v72, 16, v39
    v_and_b32 v73, 0xffff0000, v39
    v_mul_f32 v72, v72, v70
    v_mul_f32 v73, v73, v71
    v_cvt_pk_bf16_f32 v72, 0, v72
    v_cvt_pk_bf16_f32 v73, 0, v73
    v_add_f32 v78, v78, v72
    v_add_f32 v78, v78, v73
    s_barrier
    s_cmp_lg_u32 s48, 0
    s_cbranch_scc1 W_k4
    s_movk_i32 s66, 0
    buffer_load_dwordx2 v[224:225], v8, s[16:19], s66 offen sc1
    s_movk_i32 s66, 2048
    buffer_load_dwordx2 v[226:227], v8, s[16:19], s66 offen sc1
    s_movk_i32 s66, 4096
    buffer_load_dwordx2 v[228:229], v8, s[16:19], s66 offen sc1
    s_movk_i32 s66, 6144
    buffer_load_dwordx2 v[230:231], v8, s[16:19], s66 offen sc1
W_k4:
    v_mov_b32 v79, 0
    v_lshlrev_b32 v72, 16, v40
    v_and_b32 v73, 0xffff0000, v40
    v_mul_f32 v72, v72, v56
    v_mul_f32 v73, v73, v57
    v_cvt_pk_bf16_f32 v72, 0, v72
    v_cvt_pk_bf16_f32 v73, 0, v73
    v_add_f32 v79, v79, v72
    v_add_f32 v79, v79, v73
    v_lshlrev_b32 v72, 16, v41
    v_and_b32 v73, 0xffff0000, v41
    v_mul_f32 v72, v72, v58
    v_mul_f32 v73, v73, v59
    v_cvt_pk_bf16_f32 v72, 0, v72
    v_cvt_pk_bf16_f32 v73, 0, v73
    v_add_f32 v79, v79, v72
    v_add_f32 v79, v79, v73
    v_lshlrev_b32 v72, 16, v42
    v_and_b32 v73, 0xffff0000, v42
    v_mul_f32 v72, v72, v60
    v_mul_f32 v73, v73, v61
    v_cvt_pk_bf16_f32 v72, 0, v72
    v_cvt_pk_bf16_f32 v73, 0, v73
    v_add_f32 v79, v79, v72
    v_add_f32 v79, v79, v73
    v_lshlrev_b32 v72, 16, v43
    v_and_b32 v73, 0xffff0000, v43
    v_mul_f32 v72, v72, v62
    v_mul_f32 v73, v73, v63
    v_cvt_pk_bf16_f32 v72, 0, v72
    v_cvt_pk_bf16_f32 v73, 0, v73
    v_add_f32 v79, v79, v72
    v_add_f32 v79, v79, v73
    v_lshlrev_b32 v72, 16, v44
    v_and_b32 v73, 0xffff0000, v44
    v_mul_f32 v72, v72, v64
    v_mul_f32 v73, v73, v65
    v_cvt_pk_bf16_f32 v72, 0, v72
    v_cvt_pk_bf16_f32 v73, 0, v73
    v_add_f32 v79, v79, v72
    v_add_f32 v79, v79, v73
    v_lshlrev_b32 v72, 16, v45
    v_and_b32 v73, 0xffff0000, v45
    v_mul_f32 v72, v72, v66
    v_mul_f32 v73, v73, v67
    v_cvt_pk_bf16_f32 v72, 0, v72
    v_cvt_pk_bf16_f32 v73, 0, v73
    v_add_f32 v79, v79, v72
    v_add_f32 v79, v79, v73
    v_lshlrev_b32 v72, 16, v46
    v_and_b32 v73, 0xffff0000, v46
    v_mul_f32 v72, v72, v68
    v_mul_f32 v73, v73, v69
    v_cvt_pk_bf16_f32 v72, 0, v72
    v_cvt_pk_bf16_f32 v73, 0, v73
    v_add_f32 v79, v79, v72
    v_add_f32 v79, v79, v73
    v_lshlrev_b32 v72, 16, v47
    v_and_b32 v73, 0xffff0000, v47
    v_mul_f32 v72, v72, v70
    v_mul_f32 v73, v73, v71
    v_cvt_pk_bf16_f32 v72, 0, v72
    v_cvt_pk_bf16_f32 v73, 0, v73
    v_add_f32 v79, v79, v72
    v_add_f32 v79, v79, v73
    s_nop 1
    v_permlane32_swap_b32 v76, v77
    v_permlane32_swap_b32 v78, v79
    v_add_f32 v76, v76, v77
    v_add_f32 v78, v78, v79
    s_nop 1
    v_permlane16_swap_b32 v76, v78
    v_add_f32 v76, v76, v78
    s_nop 1
    v_add_f32_dpp v76, v76, v76 quad_perm:[1,0,3,2] row_mask:0xf bank_mask:0xf
    s_nop 1
    v_add_f32_dpp v76, v76, v76 quad_perm:[2,3,0,1] row_mask:0xf bank_mask:0xf
    s_nop 1
    v_add_f32_dpp v76, v76, v76 row_half_mirror row_mask:0xf bank_mask:0xf
    s_nop 1
    v_add_f32_dpp v76, v76, v76 row_mirror row_mask:0xf bank_mask:0xf
    v_cvt_pk_bf16_f32 v76, 0, v76
    v_mul_f32 v76, s46, v76
    v_exp_f32 v76, -v76
    s_lshl_b32 s66, s50, 4
    v_add_f32 v76, 1.0, v76
    v_rcp_f32 v76, v76
    s_add_u32 s66, s66, 6094848
    v_cvt_pk_bf16_f32 v76, 0, v76
    v_lshlrev_b32 v10, 2, v3
    s_mov_b32 exec_lo, 0x00010001
    s_mov_b32 exec_hi, 0x00010001
    buffer_store_dword v76, v10, s[16:19], s66 offen sc0 sc1
    s_mov_b64 exec, -1
    s_barrier
    s_mov_b32 s66, 57344
    buffer_load_dwordx4 v[128:131], v6, s[28:31], s66 offen nt
    s_mov_b32 s66, 64512
    buffer_load_dwordx4 v[132:135], v6, s[28:31], s66 offen nt
    s_mov_b32 s66, 71680
    buffer_load_dwordx4 v[136:139], v6, s[28:31], s66 offen nt
    s_mov_b32 s66, 78848
    buffer_load_dwordx4 v[140:143], v6, s[28:31], s66 offen nt
    s_mov_b32 s66, 86016
    buffer_load_dwordx4 v[144:147], v6, s[28:31], s66 offen nt
    s_mov_b32 s66, 93184
    buffer_load_dwordx4 v[148:151], v6, s[28:31], s66 offen nt
    s_mov_b32 s66, 100352
    buffer_load_dwordx4 v[152:155], v6, s[28:31], s66 offen nt
    s_mov_b32 s66, 107520
    buffer_load_dwordx4 v[156:159], v6, s[28:31], s66 offen nt
    s_cmp_lg_u32 s48, 0
    s_cbranch_scc1 W_c5
    s_waitcnt vmcnt(9)
    s_mov_b32 s67, 0
W_cs:
    v_xor_b32 v10, v225, v15
    v_xor_b32 v11, v227, v15
    v_or_b32 v10, v10, v11
    v_xor_b32 v11, v229, v15
    v_or_b32 v10, v10, v11
    v_xor_b32 v11, v231, v15
    v_or_b32 v10, v10, v11
    v_cmp_ne_u32 vcc, 0, v10
    s_cbranch_vccz W_cok
    s_add_u32 s67, s67, 1
    s_cmp_ge_u32 s67, 200000
    s_cbranch_scc1 W_cok
    s_sleep 4
    s_movk_i32 s66, 0
    buffer_load_dwordx2 v[224:225], v8, s[16:19], s66 offen sc1
    s_movk_i32 s66, 2048
    buffer_load_dwordx2 v[226:227], v8, s[16:19], s66 offen sc1
    s_movk_i32 s66, 4096
    buffer_load_dwordx2 v[228:229], v8, s[16:19], s66 offen sc1
    s_movk_i32 s66, 6144
    buffer_load_dwordx2 v[230:231], v8, s[16:19], s66 offen sc1
    s_waitcnt vmcnt(0)
    s_branch W_cs
W_cok:
    v_max_u32 v12, v224, v226
    v_max3_u32 v12, v12, v228, v230
    s_nop 1
    s_nop 1
    v_max_u32_dpp v12, v12, v12 quad_perm:[1,0,3,2] row_mask:0xf bank_mask:0xf
    s_nop 1
    v_max_u32_dpp v12, v12, v12 quad_perm:[2,3,0,1] row_mask:0xf bank_mask:0xf
    s_nop 1
    v_max_u32_dpp v12, v12, v12 row_half_mirror row_mask:0xf bank_mask:0xf
    s_nop 1
    v_max_u32_dpp v12, v12, v12 row_mirror row_mask:0xf bank_mask:0xf
    s_nop 1
    v_readlane_b32 s68, v12, 0
    v_readlane_b32 s69, v12, 16
    v_readlane_b32 s70, v12, 32
    v_readlane_b32 s71, v12, 48
    s_nop 1
    v_mov_b32 v12, s68
    v_max_u32 v12, s69, v12
    v_max_u32 v12, s70, v12
    v_max_u32 v12, s71, v12
    v_mov_b32 v10, 155684
    ds_write_b32 v10, v12
W_c5:
    s_waitcnt lgkmcnt(0)
    s_barrier
    v_mov_b32 v10, 155684
    ds_read_b32 v11, v10
    v_lshrrev_b32 v10, 5, v2
    v_lshlrev_b32 v10, 6, v10
    s_waitcnt lgkmcnt(0)
    v_readfirstlane_b32 s66, v11
    s_and_b32 s66, s66, 0x7ff
    s_sub_u32 s66, 2047, s66
    s_lshl_b32 s66, s66, 10
    s_add_u32 s66, s66, s51
    s_lshl_b32 s66, s66, 1
    buffer_load_dwordx4 v[224:227], v10, s[8:11], s66 offen offset:0
    buffer_load_dwordx4 v[228:231], v10, s[8:11], s66 offen offset:16
    buffer_load_dwordx4 v[232:235], v10, s[8:11], s66 offen offset:32
    buffer_load_dwordx4 v[236:239], v10, s[8:11], s66 offen offset:48
    s_barrier
    s_mov_b32 s66, 114688
    buffer_load_dwordx4 v[160:163], v6, s[28:31], s66 offen nt
    s_mov_b32 s66, 121856
    buffer_load_dwordx4 v[164:167], v6, s[28:31], s66 offen nt
    s_mov_b32 s66, 129024
    buffer_load_dwordx4 v[168:171], v6, s[28:31], s66 offen nt
    s_mov_b32 s66, 136192
    buffer_load_dwordx4 v[172:175], v6, s[28:31], s66 offen nt
    s_mov_b32 s66, 143360
    buffer_load_dwordx4 v[176:179], v6, s[28:31], s66 offen nt
    s_mov_b32 s66, 150528
    buffer_load_dwordx4 v[180:183], v6, s[28:31], s66 offen nt
    s_mov_b32 s66, 157696
    buffer_load_dwordx4 v[184:187], v6, s[28:31], s66 offen nt
    s_mov_b32 s66, 164864
    buffer_load_dwordx4 v[188:191], v6, s[28:31], s66 offen nt
    s_waitcnt vmcnt(8)
    v_mov_b32 v64, 0
    v_mov_b32 v65, 0
    v_mov_b32 v66, 0
    v_mov_b32 v67, 0
    v_mov_b32 v68, 0
    v_mov_b32 v69, 0
    v_mov_b32 v70, 0
    v_mov_b32 v71, 0
    v_lshlrev_b32 v72, 16, v224
    v_lshlrev_b32 v73, 16, v96
    v_and_b32 v74, 0xffff0000, v96
    v_fmac_f32 v64, v73, v72
    v_fmac_f32 v65, v74, v72
    v_lshlrev_b32 v73, 16, v97
    v_and_b32 v74, 0xffff0000, v97
    v_fmac_f32 v66, v73, v72
    v_fmac_f32 v67, v74, v72
    v_lshlrev_b32 v73, 16, v98
    v_and_b32 v74, 0xffff0000, v98
    v_fmac_f32 v68, v73, v72
    v_fmac_f32 v69, v74, v72
    v_lshlrev_b32 v73, 16, v99
    v_and_b32 v74, 0xffff0000, v99
    v_fmac_f32 v70, v73, v72
    v_fmac_f32 v71, v74, v72
    v_and_b32 v72, 0xffff0000, v224
    v_lshlrev_b32 v73, 16, v100
    v_and_b32 v74, 0xffff0000, v100
    v_fmac_f32 v64, v73, v72
    v_fmac_f32 v65, v74, v72
    v_lshlrev_b32 v73, 16, v101
    v_and_b32 v74, 0xffff0000, v101
    v_fmac_f32 v66, v73, v72
    v_fmac_f32 v67, v74, v72
    v_lshlrev_b32 v73, 16, v102
    v_and_b32 v74, 0xffff0000, v102
    v_fmac_f32 v68, v73, v72
    v_fmac_f32 v69, v74, v72
    v_lshlrev_b32 v73, 16, v103
    v_and_b32 v74, 0xffff0000, v103
    v_fmac_f32 v70, v73, v72
    v_fmac_f32 v71, v74, v72
    v_lshlrev_b32 v72, 16, v225
    v_lshlrev_b32 v73, 16, v104
    v_and_b32 v74, 0xffff0000, v104
    v_fmac_f32 v64, v73, v72
    v_fmac_f32 v65, v74, v72
    v_lshlrev_b32 v73, 16, v105
    v_and_b32 v74, 0xffff0000, v105
    v_fmac_f32 v66, v73, v72
    v_fmac_f32 v67, v74, v72
    v_lshlrev_b32 v73, 16, v106
    v_and_b32 v74, 0xffff0000, v106
    v_fmac_f32 v68, v73, v72
    v_fmac_f32 v69, v74, v72
    v_lshlrev_b32 v73, 16, v107
    v_and_b32 v74, 0xffff0000, v107
    v_fmac_f32 v70, v73, v72
    v_fmac_f32 v71, v74, v72
    v_and_b32 v72, 0xffff0000, v225
    v_lshlrev_b32 v73, 16, v108
    v_and_b32 v74, 0xffff0000, v108
    v_fmac_f32 v64, v73, v72
    v_fmac_f32 v65, v74, v72
    v_lshlrev_b32 v73, 16, v109
    v_and_b32 v74, 0xffff0000, v109
    v_fmac_f32 v66, v73, v72
    v_fmac_f32 v67, v74, v72
    v_lshlrev_b32 v73, 16, v110
    v_and_b32 v74, 0xffff0000, v110
    v_fmac_f32 v68, v73, v72
    v_fmac_f32 v69, v74, v72
    v_lshlrev_b32 v73, 16, v111
    v_and_b32 v74, 0xffff0000, v111
    v_fmac_f32 v70, v73, v72
    v_fmac_f32 v71, v74, v72
    v_lshlrev_b32 v72, 16, v226
    v_lshlrev_b32 v73, 16, v112
    v_and_b32 v74, 0xffff0000, v112
    v_fmac_f32 v64, v73, v72
    v_fmac_f32 v65, v74, v72
    v_lshlrev_b32 v73, 16, v113
    v_and_b32 v74, 0xffff0000, v113
    v_fmac_f32 v66, v73, v72
    v_fmac_f32 v67, v74, v72
    v_lshlrev_b32 v73, 16, v114
    v_and_b32 v74, 0xffff0000, v114
    v_fmac_f32 v68, v73, v72
    v_fmac_f32 v69, v74, v72
    v_lshlrev_b32 v73, 16, v115
    v_and_b32 v74, 0xffff0000, v115
    v_fmac_f32 v70, v73, v72
    v_fmac_f32 v71, v74, v72
    v_and_b32 v72, 0xffff0000, v226
    v_lshlrev_b32 v73, 16, v116
    v_and_b32 v74, 0xffff0000, v116
    v_fmac_f32 v64, v73, v72
    v_fmac_f32 v65, v74, v72
    v_lshlrev_b32 v73, 16, v117
    v_and_b32 v74, 0xffff0000, v117
    v_fmac_f32 v66, v73, v72
    v_fmac_f32 v67, v74, v72
    v_lshlrev_b32 v73, 16, v118
    v_and_b32 v74, 0xffff0000, v118
    v_fmac_f32 v68, v73, v72
    v_fmac_f32 v69, v74, v72
    v_lshlrev_b32 v73, 16, v119
    v_and_b32 v74, 0xffff0000, v119
    v_fmac_f32 v70, v73, v72
    v_fmac_f32 v71, v74, v72
    s_barrier
    v_lshlrev_b32 v72, 16, v227
    v_lshlrev_b32 v73, 16, v120
    v_and_b32 v74, 0xffff0000, v120
    v_fmac_f32 v64, v73, v72
    v_fmac_f32 v65, v74, v72
    v_lshlrev_b32 v73, 16, v121
    v_and_b32 v74, 0xffff0000, v121
    v_fmac_f32 v66, v73, v72
    v_fmac_f32 v67, v74, v72
    v_lshlrev_b32 v73, 16, v122
    v_and_b32 v74, 0xffff0000, v122
    v_fmac_f32 v68, v73, v72
    v_fmac_f32 v69, v74, v72
    v_lshlrev_b32 v73, 16, v123
    v_and_b32 v74, 0xffff0000, v123
    v_fmac_f32 v70, v73, v72
    v_fmac_f32 v71, v74, v72
    v_and_b32 v72, 0xffff0000, v227
    v_lshlrev_b32 v73, 16, v124
    v_and_b32 v74, 0xffff0000, v124
    v_fmac_f32 v64, v73, v72
    v_fmac_f32 v65, v74, v72
    v_lshlrev_b32 v73, 16, v125
    v_and_b32 v74, 0xffff0000, v125
    v_fmac_f32 v66, v73, v72
    v_fmac_f32 v67, v74, v72
    v_lshlrev_b32 v73, 16, v126
    v_and_b32 v74, 0xffff0000, v126
    v_fmac_f32 v68, v73, v72
    v_fmac_f32 v69, v74, v72
    v_lshlrev_b32 v73, 16, v127
    v_and_b32 v74, 0xffff0000, v127
    v_fmac_f32 v70, v73, v72
    v_fmac_f32 v71, v74, v72
    v_lshlrev_b32 v72, 16, v228
    v_lshlrev_b32 v73, 16, v128
    v_and_b32 v74, 0xffff0000, v128
    v_fmac_f32 v64, v73, v72
    v_fmac_f32 v65, v74, v72
    v_lshlrev_b32 v73, 16, v129
    v_and_b32 v74, 0xffff0000, v129
    v_fmac_f32 v66, v73, v72
    v_fmac_f32 v67, v74, v72
    v_lshlrev_b32 v73, 16, v130
    v_and_b32 v74, 0xffff0000, v130
    v_fmac_f32 v68, v73, v72
    v_fmac_f32 v69, v74, v72
    v_lshlrev_b32 v73, 16, v131
    v_and_b32 v74, 0xffff0000, v131
    v_fmac_f32 v70, v73, v72
    v_fmac_f32 v71, v74, v72
    v_and_b32 v72, 0xffff0000, v228
    v_lshlrev_b32 v73, 16, v132
    v_and_b32 v74, 0xffff0000, v132
    v_fmac_f32 v64, v73, v72
    v_fmac_f32 v65, v74, v72
    v_lshlrev_b32 v73, 16, v133
    v_and_b32 v74, 0xffff0000, v133
    v_fmac_f32 v66, v73, v72
    v_fmac_f32 v67, v74, v72
    v_lshlrev_b32 v73, 16, v134
    v_and_b32 v74, 0xffff0000, v134
    v_fmac_f32 v68, v73, v72
    v_fmac_f32 v69, v74, v72
    v_lshlrev_b32 v73, 16, v135
    v_and_b32 v74, 0xffff0000, v135
    v_fmac_f32 v70, v73, v72
    v_fmac_f32 v71, v74, v72
    v_lshlrev_b32 v72, 16, v229
    v_lshlrev_b32 v73, 16, v136
    v_and_b32 v74, 0xffff0000, v136
    v_fmac_f32 v64, v73, v72
    v_fmac_f32 v65, v74, v72
    v_lshlrev_b32 v73, 16, v137
    v_and_b32 v74, 0xffff0000, v137
    v_fmac_f32 v66, v73, v72
    v_fmac_f32 v67, v74, v72
    v_lshlrev_b32 v73, 16, v138
    v_and_b32 v74, 0xffff0000, v138
    v_fmac_f32 v68, v73, v72
    v_fmac_f32 v69, v74, v72
    v_lshlrev_b32 v73, 16, v139
    v_and_b32 v74, 0xffff0000, v139
    v_fmac_f32 v70, v73, v72
    v_fmac_f32 v71, v74, v72
    v_and_b32 v72, 0xffff0000, v229
    v_lshlrev_b32 v73, 16, v140
    v_and_b32 v74, 0xffff0000, v140
    v_fmac_f32 v64, v73, v72
    v_fmac_f32 v65, v74, v72
    v_lshlrev_b32 v73, 16, v141
    v_and_b32 v74, 0xffff0000, v141
    v_fmac_f32 v66, v73, v72
    v_fmac_f32 v67, v74, v72
    v_lshlrev_b32 v73, 16, v142
    v_and_b32 v74, 0xffff0000, v142
    v_fmac_f32 v68, v73, v72
    v_fmac_f32 v69, v74, v72
    v_lshlrev_b32 v73, 16, v143
    v_and_b32 v74, 0xffff0000, v143
    v_fmac_f32 v70, v73, v72
    v_fmac_f32 v71, v74, v72
    s_barrier
    s_mov_b32 s66, 172032
    buffer_load_dwordx4 v[192:195], v6, s[28:31], s66 offen nt
    s_mov_b32 s66, 179200
    buffer_load_dwordx4 v[196:199], v6, s[28:31], s66 offen nt
    s_mov_b32 s66, 186368
    buffer_load_dwordx4 v[200:203], v6, s[28:31], s66 offen nt
    s_mov_b32 s66, 193536
    buffer_load_dwordx4 v[204:207], v6, s[28:31], s66 offen nt
    s_mov_b32 s66, 200704
    buffer_load_dwordx4 v[208:211], v6, s[28:31], s66 offen nt
    s_mov_b32 s66, 207872
    buffer_load_dwordx4 v[212:215], v6, s[28:31], s66 offen nt
    s_mov_b32 s66, 215040
    buffer_load_dwordx4 v[216:219], v6, s[28:31], s66 offen nt
    s_mov_b32 s66, 222208
    buffer_load_dwordx4 v[220:223], v6, s[28:31], s66 offen nt
    v_lshlrev_b32 v72, 16, v230
    v_lshlrev_b32 v73, 16, v144
    v_and_b32 v74, 0xffff0000, v144
    v_fmac_f32 v64, v73, v72
    v_fmac_f32 v65, v74, v72
    v_lshlrev_b32 v73, 16, v145
    v_and_b32 v74, 0xffff0000, v145
    v_fmac_f32 v66, v73, v72
    v_fmac_f32 v67, v74, v72
    v_lshlrev_b32 v73, 16, v146
    v_and_b32 v74, 0xffff0000, v146
    v_fmac_f32 v68, v73, v72
    v_fmac_f32 v69, v74, v72
    v_lshlrev_b32 v73, 16, v147
    v_and_b32 v74, 0xffff0000, v147
    v_fmac_f32 v70, v73, v72
    v_fmac_f32 v71, v74, v72
    v_and_b32 v72, 0xffff0000, v230
    v_lshlrev_b32 v73, 16, v148
    v_and_b32 v74, 0xffff0000, v148
    v_fmac_f32 v64, v73, v72
    v_fmac_f32 v65, v74, v72
    v_lshlrev_b32 v73, 16, v149
    v_and_b32 v74, 0xffff0000, v149
    v_fmac_f32 v66, v73, v72
    v_fmac_f32 v67, v74, v72
    v_lshlrev_b32 v73, 16, v150
    v_and_b32 v74, 0xffff0000, v150
    v_fmac_f32 v68, v73, v72
    v_fmac_f32 v69, v74, v72
    v_lshlrev_b32 v73, 16, v151
    v_and_b32 v74, 0xffff0000, v151
    v_fmac_f32 v70, v73, v72
    v_fmac_f32 v71, v74, v72
    v_lshlrev_b32 v72, 16, v231
    v_lshlrev_b32 v73, 16, v152
    v_and_b32 v74, 0xffff0000, v152
    v_fmac_f32 v64, v73, v72
    v_fmac_f32 v65, v74, v72
    v_lshlrev_b32 v73, 16, v153
    v_and_b32 v74, 0xffff0000, v153
    v_fmac_f32 v66, v73, v72
    v_fmac_f32 v67, v74, v72
    v_lshlrev_b32 v73, 16, v154
    v_and_b32 v74, 0xffff0000, v154
    v_fmac_f32 v68, v73, v72
    v_fmac_f32 v69, v74, v72
    v_lshlrev_b32 v73, 16, v155
    v_and_b32 v74, 0xffff0000, v155
    v_fmac_f32 v70, v73, v72
    v_fmac_f32 v71, v74, v72
    v_and_b32 v72, 0xffff0000, v231
    v_lshlrev_b32 v73, 16, v156
    v_and_b32 v74, 0xffff0000, v156
    v_fmac_f32 v64, v73, v72
    v_fmac_f32 v65, v74, v72
    v_lshlrev_b32 v73, 16, v157
    v_and_b32 v74, 0xffff0000, v157
    v_fmac_f32 v66, v73, v72
    v_fmac_f32 v67, v74, v72
    v_lshlrev_b32 v73, 16, v158
    v_and_b32 v74, 0xffff0000, v158
    v_fmac_f32 v68, v73, v72
    v_fmac_f32 v69, v74, v72
    v_lshlrev_b32 v73, 16, v159
    v_and_b32 v74, 0xffff0000, v159
    v_fmac_f32 v70, v73, v72
    v_fmac_f32 v71, v74, v72
    s_waitcnt vmcnt(15)
    v_lshlrev_b32 v72, 16, v232
    v_lshlrev_b32 v73, 16, v160
    v_and_b32 v74, 0xffff0000, v160
    v_fmac_f32 v64, v73, v72
    v_fmac_f32 v65, v74, v72
    v_lshlrev_b32 v73, 16, v161
    v_and_b32 v74, 0xffff0000, v161
    v_fmac_f32 v66, v73, v72
    v_fmac_f32 v67, v74, v72
    v_lshlrev_b32 v73, 16, v162
    v_and_b32 v74, 0xffff0000, v162
    v_fmac_f32 v68, v73, v72
    v_fmac_f32 v69, v74, v72
    v_lshlrev_b32 v73, 16, v163
    v_and_b32 v74, 0xffff0000, v163
    v_fmac_f32 v70, v73, v72
    v_fmac_f32 v71, v74, v72
    s_waitcnt vmcnt(14)
    v_and_b32 v72, 0xffff0000, v232
    v_lshlrev_b32 v73, 16, v164
    v_and_b32 v74, 0xffff0000, v164
    v_fmac_f32 v64, v73, v72
    v_fmac_f32 v65, v74, v72
    v_lshlrev_b32 v73, 16, v165
    v_and_b32 v74, 0xffff0000, v165
    v_fmac_f32 v66, v73, v72
    v_fmac_f32 v67, v74, v72
    v_lshlrev_b32 v73, 16, v166
    v_and_b32 v74, 0xffff0000, v166
    v_fmac_f32 v68, v73, v72
    v_fmac_f32 v69, v74, v72
    v_lshlrev_b32 v73, 16, v167
    v_and_b32 v74, 0xffff0000, v167
    v_fmac_f32 v70, v73, v72
    v_fmac_f32 v71, v74, v72
    s_barrier
    s_waitcnt vmcnt(13)
    v_lshlrev_b32 v72, 16, v233
    v_lshlrev_b32 v73, 16, v168
    v_and_b32 v74, 0xffff0000, v168
    v_fmac_f32 v64, v73, v72
    v_fmac_f32 v65, v74, v72
    v_lshlrev_b32 v73, 16, v169
    v_and_b32 v74, 0xffff0000, v169
    v_fmac_f32 v66, v73, v72
    v_fmac_f32 v67, v74, v72
    v_lshlrev_b32 v73, 16, v170
    v_and_b32 v74, 0xffff0000, v170
    v_fmac_f32 v68, v73, v72
    v_fmac_f32 v69, v74, v72
    v_lshlrev_b32 v73, 16, v171
    v_and_b32 v74, 0xffff0000, v171
    v_fmac_f32 v70, v73, v72
    v_fmac_f32 v71, v74, v72
    s_waitcnt vmcnt(12)
    v_and_b32 v72, 0xffff0000, v233
    v_lshlrev_b32 v73, 16, v172
    v_and_b32 v74, 0xffff0000, v172
    v_fmac_f32 v64, v73, v72
    v_fmac_f32 v65, v74, v72
    v_lshlrev_b32 v73, 16, v173
    v_and_b32 v74, 0xffff0000, v173
    v_fmac_f32 v66, v73, v72
    v_fmac_f32 v67, v74, v72
    v_lshlrev_b32 v73, 16, v174
    v_and_b32 v74, 0xffff0000, v174
    v_fmac_f32 v68, v73, v72
    v_fmac_f32 v69, v74, v72
    v_lshlrev_b32 v73, 16, v175
    v_and_b32 v74, 0xffff0000, v175
    v_fmac_f32 v70, v73, v72
    v_fmac_f32 v71, v74, v72
    s_waitcnt vmcnt(11)
    v_lshlrev_b32 v72, 16, v234
    v_lshlrev_b32 v73, 16, v176
    v_and_b32 v74, 0xffff0000, v176
    v_fmac_f32 v64, v73, v72
    v_fmac_f32 v65, v74, v72
    v_lshlrev_b32 v73, 16, v177
    v_and_b32 v74, 0xffff0000, v177
    v_fmac_f32 v66, v73, v72
    v_fmac_f32 v67, v74, v72
    v_lshlrev_b32 v73, 16, v178
    v_and_b32 v74, 0xffff0000, v178
    v_fmac_f32 v68, v73, v72
    v_fmac_f32 v69, v74, v72
    v_lshlrev_b32 v73, 16, v179
    v_and_b32 v74, 0xffff0000, v179
    v_fmac_f32 v70, v73, v72
    v_fmac_f32 v71, v74, v72
    s_waitcnt vmcnt(10)
    v_and_b32 v72, 0xffff0000, v234
    v_lshlrev_b32 v73, 16, v180
    v_and_b32 v74, 0xffff0000, v180
    v_fmac_f32 v64, v73, v72
    v_fmac_f32 v65, v74, v72
    v_lshlrev_b32 v73, 16, v181
    v_and_b32 v74, 0xffff0000, v181
    v_fmac_f32 v66, v73, v72
    v_fmac_f32 v67, v74, v72
    v_lshlrev_b32 v73, 16, v182
    v_and_b32 v74, 0xffff0000, v182
    v_fmac_f32 v68, v73, v72
    v_fmac_f32 v69, v74, v72
    v_lshlrev_b32 v73, 16, v183
    v_and_b32 v74, 0xffff0000, v183
    v_fmac_f32 v70, v73, v72
    v_fmac_f32 v71, v74, v72
    s_barrier
    s_waitcnt vmcnt(9)
    v_lshlrev_b32 v72, 16, v235
    v_lshlrev_b32 v73, 16, v184
    v_and_b32 v74, 0xffff0000, v184
    v_fmac_f32 v64, v73, v72
    v_fmac_f32 v65, v74, v72
    v_lshlrev_b32 v73, 16, v185
    v_and_b32 v74, 0xffff0000, v185
    v_fmac_f32 v66, v73, v72
    v_fmac_f32 v67, v74, v72
    v_lshlrev_b32 v73, 16, v186
    v_and_b32 v74, 0xffff0000, v186
    v_fmac_f32 v68, v73, v72
    v_fmac_f32 v69, v74, v72
    v_lshlrev_b32 v73, 16, v187
    v_and_b32 v74, 0xffff0000, v187
    v_fmac_f32 v70, v73, v72
    v_fmac_f32 v71, v74, v72
    s_waitcnt vmcnt(8)
    v_and_b32 v72, 0xffff0000, v235
    v_lshlrev_b32 v73, 16, v188
    v_and_b32 v74, 0xffff0000, v188
    v_fmac_f32 v64, v73, v72
    v_fmac_f32 v65, v74, v72
    v_lshlrev_b32 v73, 16, v189
    v_and_b32 v74, 0xffff0000, v189
    v_fmac_f32 v66, v73, v72
    v_fmac_f32 v67, v74, v72
    v_lshlrev_b32 v73, 16, v190
    v_and_b32 v74, 0xffff0000, v190
    v_fmac_f32 v68, v73, v72
    v_fmac_f32 v69, v74, v72
    v_lshlrev_b32 v73, 16, v191
    v_and_b32 v74, 0xffff0000, v191
    v_fmac_f32 v70, v73, v72
    v_fmac_f32 v71, v74, v72
    s_waitcnt vmcnt(7)
    v_lshlrev_b32 v72, 16, v236
    v_lshlrev_b32 v73, 16, v192
    v_and_b32 v74, 0xffff0000, v192
    v_fmac_f32 v64, v73, v72
    v_fmac_f32 v65, v74, v72
    v_lshlrev_b32 v73, 16, v193
    v_and_b32 v74, 0xffff0000, v193
    v_fmac_f32 v66, v73, v72
    v_fmac_f32 v67, v74, v72
    v_lshlrev_b32 v73, 16, v194
    v_and_b32 v74, 0xffff0000, v194
    v_fmac_f32 v68, v73, v72
    v_fmac_f32 v69, v74, v72
    v_lshlrev_b32 v73, 16, v195
    v_and_b32 v74, 0xffff0000, v195
    v_fmac_f32 v70, v73, v72
    v_fmac_f32 v71, v74, v72
    s_waitcnt vmcnt(6)
    v_and_b32 v72, 0xffff0000, v236
    v_lshlrev_b32 v73, 16, v196
    v_and_b32 v74, 0xffff0000, v196
    v_fmac_f32 v64, v73, v72
    v_fmac_f32 v65, v74, v72
    v_lshlrev_b32 v73, 16, v197
    v_and_b32 v74, 0xffff0000, v197
    v_fmac_f32 v66, v73, v72
    v_fmac_f32 v67, v74, v72
    v_lshlrev_b32 v73, 16, v198
    v_and_b32 v74, 0xffff0000, v198
    v_fmac_f32 v68, v73, v72
    v_fmac_f32 v69, v74, v72
    v_lshlrev_b32 v73, 16, v199
    v_and_b32 v74, 0xffff0000, v199
    v_fmac_f32 v70, v73, v72
    v_fmac_f32 v71, v74, v72
    s_waitcnt vmcnt(5)
    v_lshlrev_b32 v72, 16, v237
    v_lshlrev_b32 v73, 16, v200
    v_and_b32 v74, 0xffff0000, v200
    v_fmac_f32 v64, v73, v72
    v_fmac_f32 v65, v74, v72
    v_lshlrev_b32 v73, 16, v201
    v_and_b32 v74, 0xffff0000, v201
    v_fmac_f32 v66, v73, v72
    v_fmac_f32 v67, v74, v72
    v_lshlrev_b32 v73, 16, v202
    v_and_b32 v74, 0xffff0000, v202
    v_fmac_f32 v68, v73, v72
    v_fmac_f32 v69, v74, v72
    v_lshlrev_b32 v73, 16, v203
    v_and_b32 v74, 0xffff0000, v203
    v_fmac_f32 v70, v73, v72
    v_fmac_f32 v71, v74, v72
    s_waitcnt vmcnt(4)
    v_and_b32 v72, 0xffff0000, v237
    v_lshlrev_b32 v73, 16, v204
    v_and_b32 v74, 0xffff0000, v204
    v_fmac_f32 v64, v73, v72
    v_fmac_f32 v65, v74, v72
    v_lshlrev_b32 v73, 16, v205
    v_and_b32 v74, 0xffff0000, v205
    v_fmac_f32 v66, v73, v72
    v_fmac_f32 v67, v74, v72
    v_lshlrev_b32 v73, 16, v206
    v_and_b32 v74, 0xffff0000, v206
    v_fmac_f32 v68, v73, v72
    v_fmac_f32 v69, v74, v72
    v_lshlrev_b32 v73, 16, v207
    v_and_b32 v74, 0xffff0000, v207
    v_fmac_f32 v70, v73, v72
    v_fmac_f32 v71, v74, v72
    s_barrier
    s_waitcnt vmcnt(3)
    v_lshlrev_b32 v72, 16, v238
    v_lshlrev_b32 v73, 16, v208
    v_and_b32 v74, 0xffff0000, v208
    v_fmac_f32 v64, v73, v72
    v_fmac_f32 v65, v74, v72
    v_lshlrev_b32 v73, 16, v209
    v_and_b32 v74, 0xffff0000, v209
    v_fmac_f32 v66, v73, v72
    v_fmac_f32 v67, v74, v72
    v_lshlrev_b32 v73, 16, v210
    v_and_b32 v74, 0xffff0000, v210
    v_fmac_f32 v68, v73, v72
    v_fmac_f32 v69, v74, v72
    v_lshlrev_b32 v73, 16, v211
    v_and_b32 v74, 0xffff0000, v211
    v_fmac_f32 v70, v73, v72
    v_fmac_f32 v71, v74, v72
    s_waitcnt vmcnt(2)
    v_and_b32 v72, 0xffff0000, v238
    v_lshlrev_b32 v73, 16, v212
    v_and_b32 v74, 0xffff0000, v212
    v_fmac_f32 v64, v73, v72
    v_fmac_f32 v65, v74, v72
    v_lshlrev_b32 v73, 16, v213
    v_and_b32 v74, 0xffff0000, v213
    v_fmac_f32 v66, v73, v72
    v_fmac_f32 v67, v74, v72
    v_lshlrev_b32 v73, 16, v214
    v_and_b32 v74, 0xffff0000, v214
    v_fmac_f32 v68, v73, v72
    v_fmac_f32 v69, v74, v72
    v_lshlrev_b32 v73, 16, v215
    v_and_b32 v74, 0xffff0000, v215
    v_fmac_f32 v70, v73, v72
    v_fmac_f32 v71, v74, v72
    s_waitcnt vmcnt(1)
    v_lshlrev_b32 v72, 16, v239
    v_lshlrev_b32 v73, 16, v216
    v_and_b32 v74, 0xffff0000, v216
    v_fmac_f32 v64, v73, v72
    v_fmac_f32 v65, v74, v72
    v_lshlrev_b32 v73, 16, v217
    v_and_b32 v74, 0xffff0000, v217
    v_fmac_f32 v66, v73, v72
    v_fmac_f32 v67, v74, v72
    v_lshlrev_b32 v73, 16, v218
    v_and_b32 v74, 0xffff0000, v218
    v_fmac_f32 v68, v73, v72
    v_fmac_f32 v69, v74, v72
    v_lshlrev_b32 v73, 16, v219
    v_and_b32 v74, 0xffff0000, v219
    v_fmac_f32 v70, v73, v72
    v_fmac_f32 v71, v74, v72
    s_waitcnt vmcnt(0)
    v_and_b32 v72, 0xffff0000, v239
    v_lshlrev_b32 v73, 16, v220
    v_and_b32 v74, 0xffff0000, v220
    v_fmac_f32 v64, v73, v72
    v_fmac_f32 v65, v74, v72
    v_lshlrev_b32 v73, 16, v221
    v_and_b32 v74, 0xffff0000, v221
    v_fmac_f32 v66, v73, v72
    v_fmac_f32 v67, v74, v72
    v_lshlrev_b32 v73, 16, v222
    v_and_b32 v74, 0xffff0000, v222
    v_fmac_f32 v68, v73, v72
    v_fmac_f32 v69, v74, v72
    v_lshlrev_b32 v73, 16, v223
    v_and_b32 v74, 0xffff0000, v223
    v_fmac_f32 v70, v73, v72
    v_fmac_f32 v71, v74, v72
    v_and_b32 v76, 31, v2
    v_lshrrev_b32 v77, 5, v2
    v_lshl_add_u32 v76, v76, 1, v77
    v_permlane32_swap_b32 v64, v68
    v_permlane32_swap_b32 v65, v69
    v_permlane32_swap_b32 v66, v70
    v_permlane32_swap_b32 v67, v71
    v_lshlrev_b32 v76, 4, v76
    v_add_f32 v64, v64, v68
    v_add_f32 v65, v65, v69
    v_add_f32 v66, v66, v70
    v_add_f32 v67, v67, v71
    buffer_store_dwordx4 v[64:67], v76, s[16:19], s54 offen sc0 sc1
    s_barrier
    s_mov_b32 s66, 0
    buffer_load_dwordx4 v[96:99], v7, s[32:35], s66 offen
    s_mov_b32 s66, 2048
    buffer_load_dwordx4 v[100:103], v7, s[32:35], s66 offen
    s_mov_b32 s66, 4096
    buffer_load_dwordx4 v[104:107], v7, s[32:35], s66 offen
    s_mov_b32 s66, 6144
    buffer_load_dwordx4 v[108:111], v7, s[32:35], s66 offen
    s_mov_b32 s66, 8192
    buffer_load_dwordx4 v[112:115], v7, s[32:35], s66 offen
    s_mov_b32 s66, 10240
    buffer_load_dwordx4 v[116:119], v7, s[32:35], s66 offen
    s_mov_b32 s66, 12288
    buffer_load_dwordx4 v[120:123], v7, s[32:35], s66 offen
    s_mov_b32 s66, 14336
    buffer_load_dwordx4 v[124:127], v7, s[32:35], s66 offen
H_b14:
    s_barrier
    s_setprio 3
    s_add_u32 s67, s52, 0
    s_and_b32 s67, s67, 0x1fffff
    s_add_u32 m0, s72, 24576
    s_add_u32 s66, s67, 0
    buffer_load_dwordx4 v90, s[20:23], s66 offen lds
    s_add_u32 m0, s72, 28672
    s_add_u32 s66, s67, 65536
    buffer_load_dwordx4 v90, s[20:23], s66 offen lds
    s_add_u32 s67, s52, 0
    s_and_b32 s67, s67, 0x1fffff
    s_add_u32 m0, s72, 40960
    s_add_u32 s66, s67, 131072
    buffer_load_dwordx4 v90, s[20:23], s66 offen lds
    s_add_u32 m0, s72, 45056
    s_add_u32 s66, s67, 196608
    buffer_load_dwordx4 v90, s[20:23], s66 offen lds
    s_mov_b32 s70, 0x3fb8aa3b
    s_mov_b32 s71, 0x3fb8aa3b
    s_and_b32 s66, s44, 2
    s_lshl_b32 s67, s66, 2
    s_add_u32 s67, s67, 155648
    v_mov_b32 v10, s67
    s_lshl_b32 s66, s66, 12
    s_and_b32 s67, s44, 1
    s_lshl_b32 s67, s67, 10
    v_add_u32 v11, s66, v9
    v_add_u32 v12, s67, v11
    v_add_u32 v11, 65536, v11
    v_mov_b32 v204, 0x3f803f80
    v_mov_b32 v205, 0x3f803f80
    v_mov_b32 v206, 0x3f803f80
    v_mov_b32 v207, 0x3f803f80
    v_bfe_u32 v12, v2, 4, 1
    v_lshrrev_b32 v13, 5, v2
    v_lshl_add_u32 v12, v12, 1, v13
    v_bfe_u32 v13, v2, 1, 3
    v_xor_b32 v12, v12, v13
    v_and_b32 v13, 127, v92
    v_lshlrev_b32 v13, 7, v13
    v_lshl_add_u32 v12, v12, 4, v13
    v_add_u32 v12, 122880, v12
    v_xor_b32 v13, 64, v12
    ds_read_b128 v[144:147], v12
    ds_read_b128 v[148:151], v13
    s_waitcnt lgkmcnt(0)
    v_add_u32 v12, s67, v11
    v_subrev_u32 v12, 65536, v12
H_fk:
    ds_read_b64 v[14:15], v10
    s_waitcnt lgkmcnt(0)
    v_min_u32 v14, v14, v15
    v_cmp_eq_u32 vcc, 0, v14
    s_cbranch_vccnz H_fk
    ds_read_b128 v[16:19], v12 offset:0
    ds_read_b128 v[20:23], v12 offset:2048
    ds_read_b128 v[24:27], v12 offset:4096
    ds_read_b128 v[28:31], v12 offset:6144
    s_waitcnt lgkmcnt(3)
    v_lshlrev_b32 v72, 16, v16
    v_and_b32 v73, 0xffff0000, v16
    v_pk_mul_f32 v[74:75], v[72:73], s[70:71]
    v_pk_add_f32 v[72:73], v[72:73], 1.0 op_sel_hi:[1,0]
    v_exp_f32 v74, v74 clamp
    v_exp_f32 v75, v75 clamp
    v_lshlrev_b32 v76, 16, v17
    v_and_b32 v77, 0xffff0000, v17
    v_pk_mul_f32 v[78:79], v[76:77], s[70:71]
    v_pk_add_f32 v[76:77], v[76:77], 1.0 op_sel_hi:[1,0]
    v_exp_f32 v78, v78 clamp
    v_exp_f32 v79, v79 clamp
    v_max_f32 v72, v72, v74
    v_max_f32 v73, v73, v75
    v_cvt_pk_bf16_f32 v32, v72, v73
    v_max_f32 v76, v76, v78
    v_max_f32 v77, v77, v79
    v_cvt_pk_bf16_f32 v33, v76, v77
    v_lshlrev_b32 v72, 16, v18
    v_and_b32 v73, 0xffff0000, v18
    v_pk_mul_f32 v[74:75], v[72:73], s[70:71]
    v_pk_add_f32 v[72:73], v[72:73], 1.0 op_sel_hi:[1,0]
    v_exp_f32 v74, v74 clamp
    v_exp_f32 v75, v75 clamp
    v_lshlrev_b32 v76, 16, v19
    v_and_b32 v77, 0xffff0000, v19
    v_pk_mul_f32 v[78:79], v[76:77], s[70:71]
    v_pk_add_f32 v[76:77], v[76:77], 1.0 op_sel_hi:[1,0]
    v_exp_f32 v78, v78 clamp
    v_exp_f32 v79, v79 clamp
    v_max_f32 v72, v72, v74
    v_max_f32 v73, v73, v75
    v_cvt_pk_bf16_f32 v34, v72, v73
    v_max_f32 v76, v76, v78
    v_max_f32 v77, v77, v79
    v_cvt_pk_bf16_f32 v35, v76, v77
    s_waitcnt lgkmcnt(2)
    v_lshlrev_b32 v72, 16, v20
    v_and_b32 v73, 0xffff0000, v20
    v_pk_mul_f32 v[74:75], v[72:73], s[70:71]
    v_pk_add_f32 v[72:73], v[72:73], 1.0 op_sel_hi:[1,0]
    v_exp_f32 v74, v74 clamp
    v_exp_f32 v75, v75 clamp
    v_lshlrev_b32 v76, 16, v21
    v_and_b32 v77, 0xffff0000, v21
    v_pk_mul_f32 v[78:79], v[76:77], s[70:71]
    v_pk_add_f32 v[76:77], v[76:77], 1.0 op_sel_hi:[1,0]
    v_exp_f32 v78, v78 clamp
    v_exp_f32 v79, v79 clamp
    v_max_f32 v72, v72, v74
    v_max_f32 v73, v73, v75
    v_cvt_pk_bf16_f32 v36, v72, v73
    v_max_f32 v76, v76, v78
    v_max_f32 v77, v77, v79
    v_cvt_pk_bf16_f32 v37, v76, v77
    v_lshlrev_b32 v72, 16, v22
    v_and_b32 v73, 0xffff0000, v22
    v_pk_mul_f32 v[74:75], v[72:73], s[70:71]
    v_pk_add_f32 v[72:73], v[72:73], 1.0 op_sel_hi:[1,0]
    v_exp_f32 v74, v74 clamp
    v_exp_f32 v75, v75 clamp
    v_lshlrev_b32 v76, 16, v23
    v_and_b32 v77, 0xffff0000, v23
    v_pk_mul_f32 v[78:79], v[76:77], s[70:71]
    v_pk_add_f32 v[76:77], v[76:77], 1.0 op_sel_hi:[1,0]
    v_exp_f32 v78, v78 clamp
    v_exp_f32 v79, v79 clamp
    v_max_f32 v72, v72, v74
    v_max_f32 v73, v73, v75
    v_cvt_pk_bf16_f32 v38, v72, v73
    v_max_f32 v76, v76, v78
    v_max_f32 v77, v77, v79
    v_cvt_pk_bf16_f32 v39, v76, v77
    s_waitcnt lgkmcnt(1)
    v_lshlrev_b32 v72, 16, v24
    v_and_b32 v73, 0xffff0000, v24
    v_pk_mul_f32 v[74:75], v[72:73], s[70:71]
    v_pk_add_f32 v[72:73], v[72:73], 1.0 op_sel_hi:[1,0]
    v_exp_f32 v74, v74 clamp
    v_exp_f32 v75, v75 clamp
    v_lshlrev_b32 v76, 16, v25
    v_and_b32 v77, 0xffff0000, v25
    v_pk_mul_f32 v[78:79], v[76:77], s[70:71]
    v_pk_add_f32 v[76:77], v[76:77], 1.0 op_sel_hi:[1,0]
    v_exp_f32 v78, v78 clamp
    v_exp_f32 v79, v79 clamp
    v_max_f32 v72, v72, v74
    v_max_f32 v73, v73, v75
    v_cvt_pk_bf16_f32 v40, v72, v73
    v_max_f32 v76, v76, v78
    v_max_f32 v77, v77, v79
    v_cvt_pk_bf16_f32 v41, v76, v77
    v_lshlrev_b32 v72, 16, v26
    v_and_b32 v73, 0xffff0000, v26
    v_pk_mul_f32 v[74:75], v[72:73], s[70:71]
    v_pk_add_f32 v[72:73], v[72:73], 1.0 op_sel_hi:[1,0]
    v_exp_f32 v74, v74 clamp
    v_exp_f32 v75, v75 clamp
    v_lshlrev_b32 v76, 16, v27
    v_and_b32 v77, 0xffff0000, v27
    v_pk_mul_f32 v[78:79], v[76:77], s[70:71]
    v_pk_add_f32 v[76:77], v[76:77], 1.0 op_sel_hi:[1,0]
    v_exp_f32 v78, v78 clamp
    v_exp_f32 v79, v79 clamp
    v_max_f32 v72, v72, v74
    v_max_f32 v73, v73, v75
    v_cvt_pk_bf16_f32 v42, v72, v73
    v_max_f32 v76, v76, v78
    v_max_f32 v77, v77, v79
    v_cvt_pk_bf16_f32 v43, v76, v77
    s_waitcnt lgkmcnt(0)
    v_lshlrev_b32 v72, 16, v28
    v_and_b32 v73, 0xffff0000, v28
    v_pk_mul_f32 v[74:75], v[72:73], s[70:71]
    v_pk_add_f32 v[72:73], v[72:73], 1.0 op_sel_hi:[1,0]
    v_exp_f32 v74, v74 clamp
    v_exp_f32 v75, v75 clamp
    v_lshlrev_b32 v76, 16, v29
    v_and_b32 v77, 0xffff0000, v29
    v_pk_mul_f32 v[78:79], v[76:77], s[70:71]
    v_pk_add_f32 v[76:77], v[76:77], 1.0 op_sel_hi:[1,0]
    v_exp_f32 v78, v78 clamp
    v_exp_f32 v79, v79 clamp
    v_max_f32 v72, v72, v74
    v_max_f32 v73, v73, v75
    v_cvt_pk_bf16_f32 v44, v72, v73
    v_max_f32 v76, v76, v78
    v_max_f32 v77, v77, v79
    v_cvt_pk_bf16_f32 v45, v76, v77
    v_lshlrev_b32 v72, 16, v30
    v_and_b32 v73, 0xffff0000, v30
    v_pk_mul_f32 v[74:75], v[72:73], s[70:71]
    v_pk_add_f32 v[72:73], v[72:73], 1.0 op_sel_hi:[1,0]
    v_exp_f32 v74, v74 clamp
    v_exp_f32 v75, v75 clamp
    v_lshlrev_b32 v76, 16, v31
    v_and_b32 v77, 0xffff0000, v31
    v_pk_mul_f32 v[78:79], v[76:77], s[70:71]
    v_pk_add_f32 v[76:77], v[76:77], 1.0 op_sel_hi:[1,0]
    v_exp_f32 v78, v78 clamp
    v_exp_f32 v79, v79 clamp
    v_max_f32 v72, v72, v74
    v_max_f32 v73, v73, v75
    v_cvt_pk_bf16_f32 v46, v72, v73
    v_max_f32 v76, v76, v78
    v_max_f32 v77, v77, v79
    v_cvt_pk_bf16_f32 v47, v76, v77
H_fv:
    ds_read_b64 v[14:15], v10 offset:16
    s_waitcnt lgkmcnt(0)
    v_min_u32 v13, v14, v15
    v_cmp_eq_u32 vcc, 0, v13
    s_cbranch_vccnz H_fv
    ds_read_b128 v[208:211], v11 offset:0
    ds_read_b128 v[212:215], v11 offset:1024
    ds_read_b128 v[216:219], v11 offset:2048
    ds_read_b128 v[220:223], v11 offset:3072
    ds_read_b128 v[224:227], v11 offset:4096
    ds_read_b128 v[228:231], v11 offset:5120
    ds_read_b128 v[232:235], v11 offset:6144
    ds_read_b128 v[236:239], v11 offset:7168
    v_max_u32 v13, v14, v15
    v_cmp_eq_u32 vcc, 2, v13
    s_cbranch_vccnz H_eps
    v_mfma_f32_16x16x32_bf16 v[200:203], v[32:35], v[204:207], 0
    s_waitcnt lgkmcnt(7)
    v_mfma_f32_16x16x32_bf16 v[192:195], v[32:35], v[208:211], 0
    s_waitcnt lgkmcnt(6)
    v_mfma_f32_16x16x32_bf16 v[196:199], v[32:35], v[212:215], 0
    v_mfma_f32_16x16x32_bf16 v[200:203], v[36:39], v[204:207], v[200:203]
    s_waitcnt lgkmcnt(5)
    v_mfma_f32_16x16x32_bf16 v[192:195], v[36:39], v[216:219], v[192:195]
    s_waitcnt lgkmcnt(4)
    v_mfma_f32_16x16x32_bf16 v[196:199], v[36:39], v[220:223], v[196:199]
    v_mfma_f32_16x16x32_bf16 v[200:203], v[40:43], v[204:207], v[200:203]
    s_waitcnt lgkmcnt(3)
    v_mfma_f32_16x16x32_bf16 v[192:195], v[40:43], v[224:227], v[192:195]
    s_waitcnt lgkmcnt(2)
    v_mfma_f32_16x16x32_bf16 v[196:199], v[40:43], v[228:231], v[196:199]
    v_mfma_f32_16x16x32_bf16 v[200:203], v[44:47], v[204:207], v[200:203]
    s_waitcnt lgkmcnt(1)
    v_mfma_f32_16x16x32_bf16 v[192:195], v[44:47], v[232:235], v[192:195]
    s_waitcnt lgkmcnt(0)
    v_mfma_f32_16x16x32_bf16 v[196:199], v[44:47], v[236:239], v[196:199]
H_ne:
    v_lshrrev_b32 v13, 4, v2
    v_lshlrev_b32 v13, 4, v13
    v_and_b32 v14, 15, v2
    v_cmp_eq_u32 s[68:69], 0, v14
    s_lshl_b32 s66, s44, 11
    s_add_u32 s66, s66, 139264
    v_add_u32 v3, s66, v9
    s_waitcnt vmcnt(12)
    s_nop 1
    v_cvt_pk_bf16_f32 v72, v192, v193
    v_cvt_pk_bf16_f32 v73, v194, v195
    v_cvt_pk_bf16_f32 v74, v196, v197
    v_cvt_pk_bf16_f32 v75, v198, v199
    buffer_store_dwordx4 v[72:75], v9, s[16:19], s56 offen sc0 sc1
    s_mov_b64 exec, s[68:69]
    buffer_store_dwordx4 v[200:203], v13, s[16:19], s53 offen sc0 sc1
    s_mov_b64 exec, -1
    s_add_u32 s67, s52, 262144
    s_and_b32 s67, s67, 0x1fffff
    s_add_u32 m0, s72, 32768
    s_add_u32 s66, s67, 0
    buffer_load_dwordx4 v90, s[20:23], s66 offen lds
    s_add_u32 m0, s72, 36864
    s_add_u32 s66, s67, 65536
    buffer_load_dwordx4 v90, s[20:23], s66 offen lds
    s_add_u32 s67, s52, 262144
    s_and_b32 s67, s67, 0x1fffff
    s_add_u32 m0, s72, 49152
    s_add_u32 s66, s67, 131072
    buffer_load_dwordx4 v90, s[20:23], s66 offen lds
    s_add_u32 m0, s72, 53248
    s_add_u32 s66, s67, 196608
    buffer_load_dwordx4 v90, s[20:23], s66 offen lds
    s_setprio 0
    s_barrier
    ds_read_b128 v[16:19], v3
    ds_read_b128 v[20:23], v3 offset:1024
    buffer_load_dwordx4 v[80:83], v1, s[16:19], s62 offen sc1
    buffer_load_dwordx4 v[84:87], v1, s[16:19], s63 offen sc1
    s_add_u32 s67, s52, 524288
    s_and_b32 s67, s67, 0x1fffff
    s_add_u32 m0, s72, 81920
    s_add_u32 s66, s67, 0
    buffer_load_dwordx4 v90, s[20:23], s66 offen lds
    s_add_u32 m0, s72, 86016
    s_add_u32 s66, s67, 65536
    buffer_load_dwordx4 v90, s[20:23], s66 offen lds
    s_add_u32 s67, s52, 524288
    s_and_b32 s67, s67, 0x1fffff
    s_add_u32 m0, s72, 90112
    s_add_u32 s66, s67, 131072
    buffer_load_dwordx4 v90, s[20:23], s66 offen lds
    s_add_u32 m0, s72, 94208
    s_add_u32 s66, s67, 196608
    buffer_load_dwordx4 v90, s[20:23], s66 offen lds
    s_add_u32 s67, s52, 786432
    s_and_b32 s67, s67, 0x1fffff
    s_add_u32 m0, s72, 0
    s_add_u32 s66, s67, 0
    buffer_load_dwordx4 v90, s[20:23], s66 offen lds
    s_add_u32 m0, s72, 4096
    s_add_u32 s66, s67, 65536
    buffer_load_dwordx4 v90, s[20:23], s66 offen lds
    s_add_u32 s67, s52, 786432
    s_and_b32 s67, s67, 0x1fffff
    s_add_u32 m0, s72, 57344
    s_add_u32 s66, s67, 131072
    buffer_load_dwordx4 v90, s[20:23], s66 offen lds
    s_add_u32 m0, s72, 61440
    s_add_u32 s66, s67, 196608
    buffer_load_dwordx4 v90, s[20:23], s66 offen lds
    s_waitcnt lgkmcnt(0)
    v_lshlrev_b32 v32, 16, v16
    v_and_b32 v33, 0xffff0000, v16
    v_pk_mul_f32 v[34:35], v[32:33], s[70:71]
    v_pk_add_f32 v[32:33], v[32:33], 1.0 op_sel_hi:[1,0]
    v_exp_f32 v34, v34 clamp
    v_exp_f32 v35, v35 clamp
    v_lshlrev_b32 v36, 16, v17
    v_and_b32 v37, 0xffff0000, v17
    v_pk_mul_f32 v[38:39], v[36:37], s[70:71]
    v_pk_add_f32 v[36:37], v[36:37], 1.0 op_sel_hi:[1,0]
    v_exp_f32 v38, v38 clamp
    v_exp_f32 v39, v39 clamp
    v_max_f32 v32, v32, v34
    v_max_f32 v33, v33, v35
    v_min_f32 v40, v32, v33
    v_cvt_pk_bf16_f32 v24, v32, v33
    v_max_f32 v36, v36, v38
    v_max_f32 v37, v37, v39
    v_min3_f32 v40, v36, v37, v40
    v_cvt_pk_bf16_f32 v25, v36, v37
    v_lshlrev_b32 v32, 16, v18
    v_and_b32 v33, 0xffff0000, v18
    v_pk_mul_f32 v[34:35], v[32:33], s[70:71]
    v_pk_add_f32 v[32:33], v[32:33], 1.0 op_sel_hi:[1,0]
    v_exp_f32 v34, v34 clamp
    v_exp_f32 v35, v35 clamp
    v_lshlrev_b32 v36, 16, v19
    v_and_b32 v37, 0xffff0000, v19
    v_pk_mul_f32 v[38:39], v[36:37], s[70:71]
    v_pk_add_f32 v[36:37], v[36:37], 1.0 op_sel_hi:[1,0]
    v_exp_f32 v38, v38 clamp
    v_exp_f32 v39, v39 clamp
    v_max_f32 v32, v32, v34
    v_max_f32 v33, v33, v35
    v_min3_f32 v40, v32, v33, v40
    v_cvt_pk_bf16_f32 v26, v32, v33
    v_max_f32 v36, v36, v38
    v_max_f32 v37, v37, v39
    v_min3_f32 v40, v36, v37, v40
    v_cvt_pk_bf16_f32 v27, v36, v37
    v_lshlrev_b32 v32, 16, v20
    v_and_b32 v33, 0xffff0000, v20
    v_pk_mul_f32 v[34:35], v[32:33], s[70:71]
    v_pk_add_f32 v[32:33], v[32:33], 1.0 op_sel_hi:[1,0]
    v_exp_f32 v34, v34 clamp
    v_exp_f32 v35, v35 clamp
    v_lshlrev_b32 v36, 16, v21
    v_and_b32 v37, 0xffff0000, v21
    v_pk_mul_f32 v[38:39], v[36:37], s[70:71]
    v_pk_add_f32 v[36:37], v[36:37], 1.0 op_sel_hi:[1,0]
    v_exp_f32 v38, v38 clamp
    v_exp_f32 v39, v39 clamp
    v_max_f32 v32, v32, v34
    v_max_f32 v33, v33, v35
    v_min3_f32 v40, v32, v33, v40
    v_cvt_pk_bf16_f32 v28, v32, v33
    v_max_f32 v36, v36, v38
    v_max_f32 v37, v37, v39
    v_min3_f32 v40, v36, v37, v40
    v_cvt_pk_bf16_f32 v29, v36, v37
    v_lshlrev_b32 v32, 16, v22
    v_and_b32 v33, 0xffff0000, v22
    v_pk_mul_f32 v[34:35], v[32:33], s[70:71]
    v_pk_add_f32 v[32:33], v[32:33], 1.0 op_sel_hi:[1,0]
    v_exp_f32 v34, v34 clamp
    v_exp_f32 v35, v35 clamp
    v_lshlrev_b32 v36, 16, v23
    v_and_b32 v37, 0xffff0000, v23
    v_pk_mul_f32 v[38:39], v[36:37], s[70:71]
    v_pk_add_f32 v[36:37], v[36:37], 1.0 op_sel_hi:[1,0]
    v_exp_f32 v38, v38 clamp
    v_exp_f32 v39, v39 clamp
    v_max_f32 v32, v32, v34
    v_max_f32 v33, v33, v35
    v_min3_f32 v40, v32, v33, v40
    v_cvt_pk_bf16_f32 v30, v32, v33
    v_max_f32 v36, v36, v38
    v_max_f32 v37, v37, v39
    v_min3_f32 v40, v36, v37, v40
    v_cvt_pk_bf16_f32 v31, v36, v37
    v_cmp_gt_f32 vcc, 0x3a800000, v40
    s_cbranch_vccz P_qh
    v_lshlrev_b32 v32, 16, v24
    v_and_b32 v33, 0xffff0000, v24
    v_add_f32 v32, s47, v32
    v_add_f32 v33, s47, v33
    v_cvt_pk_bf16_f32 v24, v32, v33
    v_lshlrev_b32 v32, 16, v25
    v_and_b32 v33, 0xffff0000, v25
    v_add_f32 v32, s47, v32
    v_add_f32 v33, s47, v33
    v_cvt_pk_bf16_f32 v25, v32, v33
    v_lshlrev_b32 v32, 16, v26
    v_and_b32 v33, 0xffff0000, v26
    v_add_f32 v32, s47, v32
    v_add_f32 v33, s47, v33
    v_cvt_pk_bf16_f32 v26, v32, v33
    v_lshlrev_b32 v32, 16, v27
    v_and_b32 v33, 0xffff0000, v27
    v_add_f32 v32, s47, v32
    v_add_f32 v33, s47, v33
    v_cvt_pk_bf16_f32 v27, v32, v33
    v_lshlrev_b32 v32, 16, v28
    v_and_b32 v33, 0xffff0000, v28
    v_add_f32 v32, s47, v32
    v_add_f32 v33, s47, v33
    v_cvt_pk_bf16_f32 v28, v32, v33
    v_lshlrev_b32 v32, 16, v29
    v_and_b32 v33, 0xffff0000, v29
    v_add_f32 v32, s47, v32
    v_add_f32 v33, s47, v33
    v_cvt_pk_bf16_f32 v29, v32, v33
    v_lshlrev_b32 v32, 16, v30
    v_and_b32 v33, 0xffff0000, v30
    v_add_f32 v32, s47, v32
    v_add_f32 v33, s47, v33
    v_cvt_pk_bf16_f32 v30, v32, v33
    v_lshlrev_b32 v32, 16, v31
    v_and_b32 v33, 0xffff0000, v31
    v_add_f32 v32, s47, v32
    v_add_f32 v33, s47, v33
    v_cvt_pk_bf16_f32 v31, v32, v33
P_qh:
    s_lshl_b32 s66, s49, 11
    s_add_u32 s66, s66, 159744
    v_add_u32 v10, s66, v9
    s_lshl_b32 s66, s49, 6
    s_add_u32 s66, s66, 159488
    v_lshrrev_b32 v11, 4, v2
    v_lshlrev_b32 v11, 4, v11
    v_add_u32 v11, s66, v11
    s_waitcnt vmcnt(8)
    s_mov_b32 s59, 0
Q_hchk:
    v_max3_u32 v5, v80, v81, v82
    v_max3_u32 v5, v5, v83, v84
    v_max3_u32 v5, v5, v85, v86
    v_max_u32 v5, v5, v87
    v_cmp_eq_u32 vcc, -1, v5
    s_cbranch_vccz Q_hok
    s_add_u32 s59, s59, 1
    s_cmp_ge_u32 s59, 200000
    s_cbranch_scc1 Q_hok
    s_sleep 4
    buffer_load_dwordx4 v[80:83], v1, s[16:19], s62 offen sc1
    buffer_load_dwordx4 v[84:87], v1, s[16:19], s63 offen sc1
    s_waitcnt vmcnt(0)
    s_branch Q_hchk
Q_hok:
    v_permlane16_swap_b32 v80, v82
    v_permlane16_swap_b32 v81, v83
    v_permlane16_swap_b32 v84, v86
    v_permlane16_swap_b32 v85, v87
    v_add_f32 v80, v80, v82
    v_add_f32 v81, v81, v83
    v_add_f32 v84, v84, v86
    v_add_f32 v85, v85, v87
    v_and_b32 v5, 3, v2
    v_lshlrev_b32 v5, 3, v5
    v_permlane32_swap_b32 v80, v81
    v_permlane32_swap_b32 v84, v85
    v_bfe_u32 v6, v2, 4, 1
    v_lshl_add_u32 v5, v6, 2, v5
    v_add_f32 v80, v80, v81
    v_add_f32 v84, v84, v85
    v_lshrrev_b32 v6, 5, v2
    v_lshl_add_u32 v5, v6, 1, v5
    v_add_f32_dpp v80, v80, v80 row_ror:4 row_mask:0xf bank_mask:0xf
    v_add_f32_dpp v84, v84, v84 row_ror:4 row_mask:0xf bank_mask:0xf
    s_nop 0
    v_add_f32_dpp v80, v80, v80 row_ror:8 row_mask:0xf bank_mask:0xf
    v_add_f32_dpp v84, v84, v84 row_ror:8 row_mask:0xf bank_mask:0xf
    s_nop 0
    s_lshl_b32 s66, s44, 5
    s_add_u32 s66, s66, 155712
    v_cvt_pk_bf16_f32 v80, 0, v80
    v_cvt_pk_bf16_f32 v84, 0, v84
    v_mul_f32 v81, s46, v80
    v_exp_f32 v81, -v81
    v_add_u32 v5, s66, v5
    v_add_f32 v81, 1.0, v81
    v_rcp_f32 v81, v81
    v_lshlrev_b32 v6, 4, v6
    v_mul_f32 v81, v81, v80
    v_cvt_pk_bf16_f32 v81, 0, v81
    v_add_u32 v6, s66, v6
    v_mul_f32 v81, v81, v84
    v_cvt_pk_bf16_f32 v81, v81, v81
    ds_write_b16 v5, v81
    ds_read_b128 v[84:87], v6
    v_mov_b32 v64, 0
    v_mov_b32 v65, 0
    v_mov_b32 v66, 0
    v_mov_b32 v67, 0
    v_mov_b32 v68, 0
    v_mov_b32 v69, 0
    v_mov_b32 v70, 0
    v_mov_b32 v71, 0
    s_waitcnt lgkmcnt(0)
    v_and_b32 v72, 0xffff, v84
    v_lshlrev_b32 v73, 16, v84
    v_dot2_f32_bf16 v64, v96, v72, v64
    v_dot2_f32_bf16 v65, v96, v73, v65
    v_dot2_f32_bf16 v66, v97, v72, v66
    v_dot2_f32_bf16 v67, v97, v73, v67
    v_dot2_f32_bf16 v68, v98, v72, v68
    v_dot2_f32_bf16 v69, v98, v73, v69
    v_dot2_f32_bf16 v70, v99, v72, v70
    v_dot2_f32_bf16 v71, v99, v73, v71
    v_lshrrev_b32 v72, 16, v84
    v_and_b32 v73, 0xffff0000, v84
    v_dot2_f32_bf16 v64, v100, v72, v64
    v_dot2_f32_bf16 v65, v100, v73, v65
    v_dot2_f32_bf16 v66, v101, v72, v66
    v_dot2_f32_bf16 v67, v101, v73, v67
    v_dot2_f32_bf16 v68, v102, v72, v68
    v_dot2_f32_bf16 v69, v102, v73, v69
    v_dot2_f32_bf16 v70, v103, v72, v70
    v_dot2_f32_bf16 v71, v103, v73, v71
    v_and_b32 v72, 0xffff, v85
    v_lshlrev_b32 v73, 16, v85
    v_dot2_f32_bf16 v64, v104, v72, v64
    v_dot2_f32_bf16 v65, v104, v73, v65
    v_dot2_f32_bf16 v66, v105, v72, v66
    v_dot2_f32_bf16 v67, v105, v73, v67
    v_dot2_f32_bf16 v68, v106, v72, v68
    v_dot2_f32_bf16 v69, v106, v73, v69
    v_dot2_f32_bf16 v70, v107, v72, v70
    v_dot2_f32_bf16 v71, v107, v73, v71
    v_lshrrev_b32 v72, 16, v85
    v_and_b32 v73, 0xffff0000, v85
    v_dot2_f32_bf16 v64, v108, v72, v64
    v_dot2_f32_bf16 v65, v108, v73, v65
    v_dot2_f32_bf16 v66, v109, v72, v66
    v_dot2_f32_bf16 v67, v109, v73, v67
    v_dot2_f32_bf16 v68, v110, v72, v68
    v_dot2_f32_bf16 v69, v110, v73, v69
    v_dot2_f32_bf16 v70, v111, v72, v70
    v_dot2_f32_bf16 v71, v111, v73, v71
    v_and_b32 v72, 0xffff, v86
    v_lshlrev_b32 v73, 16, v86
    v_dot2_f32_bf16 v64, v112, v72, v64
    v_dot2_f32_bf16 v65, v112, v73, v65
    v_dot2_f32_bf16 v66, v113, v72, v66
    v_dot2_f32_bf16 v67, v113, v73, v67
    v_dot2_f32_bf16 v68, v114, v72, v68
    v_dot2_f32_bf16 v69, v114, v73, v69
    v_dot2_f32_bf16 v70, v115, v72, v70
    v_dot2_f32_bf16 v71, v115, v73, v71
    v_lshrrev_b32 v72, 16, v86
    v_and_b32 v73, 0xffff0000, v86
    v_dot2_f32_bf16 v64, v116, v72, v64
    v_dot2_f32_bf16 v65, v116, v73, v65
    v_dot2_f32_bf16 v66, v117, v72, v66
    v_dot2_f32_bf16 v67, v117, v73, v67
    v_dot2_f32_bf16 v68, v118, v72, v68
    v_dot2_f32_bf16 v69, v118, v73, v69
    v_dot2_f32_bf16 v70, v119, v72, v70
    v_dot2_f32_bf16 v71, v119, v73, v71
    v_and_b32 v72, 0xffff, v87
    v_lshlrev_b32 v73, 16, v87
    v_dot2_f32_bf16 v64, v120, v72, v64
    v_dot2_f32_bf16 v65, v120, v73, v65
    v_dot2_f32_bf16 v66, v121, v72, v66
    v_dot2_f32_bf16 v67, v121, v73, v67
    v_dot2_f32_bf16 v68, v122, v72, v68
    v_dot2_f32_bf16 v69, v122, v73, v69
    v_dot2_f32_bf16 v70, v123, v72, v70
    v_dot2_f32_bf16 v71, v123, v73, v71
    v_lshrrev_b32 v72, 16, v87
    v_and_b32 v73, 0xffff0000, v87
    v_dot2_f32_bf16 v64, v124, v72, v64
    v_dot2_f32_bf16 v65, v124, v73, v65
    v_dot2_f32_bf16 v66, v125, v72, v66
    v_dot2_f32_bf16 v67, v125, v73, v67
    v_dot2_f32_bf16 v68, v126, v72, v68
    v_dot2_f32_bf16 v69, v126, v73, v69
    v_dot2_f32_bf16 v70, v127, v72, v70
    v_dot2_f32_bf16 v71, v127, v73, v71
    v_and_b32 v76, 31, v2
    v_lshrrev_b32 v77, 5, v2
    v_lshl_add_u32 v76, v76, 1, v77
    v_permlane32_swap_b32 v64, v68
    v_permlane32_swap_b32 v65, v69
    v_permlane32_swap_b32 v66, v70
    v_permlane32_swap_b32 v67, v71
    v_lshlrev_b32 v76, 4, v76
    v_add_f32 v64, v64, v68
    v_add_f32 v65, v65, v69
    v_add_f32 v66, v66, v70
    v_add_f32 v67, v67, v71
    s_add_u32 s66, s72, 147456
    v_add_u32 v76, s66, v76
    ds_write_b128 v76, v[64:67]
    s_lshl_b32 s66, s6, 6
    s_add_u32 s66, s66, 5242880
    v_lshlrev_b32 v15, 10, v2
    v_add_u32 v15, s66, v15
    s_cmp_lg_u32 s44, 0
    s_cbranch_scc1 H_pd
    s_mov_b32 s59, 0
H_pl:
    buffer_load_dword v14, v15, s[16:19], 0 offen sc1
    s_waitcnt vmcnt(0)
    v_cmp_eq_u32 vcc, -1, v14
    s_cbranch_vccz H_pd
    s_add_u32 s59, s59, 1
    s_cmp_ge_u32 s59, 200000
    s_cbranch_scc1 H_pd
    s_sleep 2
    s_branch H_pl
H_pd:
POST:
    s_waitcnt lgkmcnt(0)
    s_barrier
    s_mov_b32 s66, 6094848
    buffer_load_dword v152, v93, s[16:19], s66 offen sc1
    ds_read_b128 v[40:43], v11
    ds_read_b128 v[32:35], v10
    ds_read_b128 v[36:39], v10 offset:1024
    v_mov_b32 v3, 155684
    ds_read_b32 v4, v3
    s_waitcnt lgkmcnt(3)
    v_mfma_f32_16x16x32_bf16 v[60:63], v[40:43], v[24:27], 0
    v_mfma_f32_16x16x32_bf16 v[64:67], v[40:43], v[28:31], 0
    s_waitcnt lgkmcnt(1)
    v_mfma_f32_16x16x32_bf16 v[44:47], v[32:35], v[24:27], 0
    v_mfma_f32_16x16x32_bf16 v[48:51], v[36:39], v[24:27], 0
    v_mfma_f32_16x16x32_bf16 v[52:55], v[32:35], v[28:31], 0
    v_mfma_f32_16x16x32_bf16 v[56:59], v[36:39], v[28:31], 0
    s_nop 3
    v_cvt_pk_bf16_f32 v60, 0, v60
    v_cvt_pk_bf16_f32 v64, 0, v64
    v_add_f32 v60, s47, v60
    v_add_f32 v64, s47, v64
    v_cvt_pk_bf16_f32 v60, 0, v60
    v_cvt_pk_bf16_f32 v64, 0, v64
    v_rcp_f32 v60, v60
    v_rcp_f32 v64, v64
    v_cvt_pk_bf16_f32 v44, 0, v44
    v_cvt_pk_bf16_f32 v45, 0, v45
    v_cvt_pk_bf16_f32 v46, 0, v46
    v_cvt_pk_bf16_f32 v47, 0, v47
    v_cvt_pk_bf16_f32 v48, 0, v48
    v_cvt_pk_bf16_f32 v49, 0, v49
    v_cvt_pk_bf16_f32 v50, 0, v50
    v_cvt_pk_bf16_f32 v51, 0, v51
    v_pk_mul_f32 v[44:45], v[44:45], v[60:61] op_sel_hi:[1,0]
    v_pk_mul_f32 v[46:47], v[46:47], v[60:61] op_sel_hi:[1,0]
    v_pk_mul_f32 v[48:49], v[48:49], v[60:61] op_sel_hi:[1,0]
    v_pk_mul_f32 v[50:51], v[50:51], v[60:61] op_sel_hi:[1,0]
    v_cvt_pk_bf16_f32 v32, v44, v45
    v_cvt_pk_bf16_f32 v33, v46, v47
    v_cvt_pk_bf16_f32 v34, v48, v49
    v_cvt_pk_bf16_f32 v35, v50, v51
    buffer_store_dwordx4 v[32:35], v9, s[16:19], s60 offen sc0 sc1
    v_cvt_pk_bf16_f32 v52, 0, v52
    v_cvt_pk_bf16_f32 v53, 0, v53
    v_cvt_pk_bf16_f32 v54, 0, v54
    v_cvt_pk_bf16_f32 v55, 0, v55
    v_cvt_pk_bf16_f32 v56, 0, v56
    v_cvt_pk_bf16_f32 v57, 0, v57
    v_cvt_pk_bf16_f32 v58, 0, v58
    v_cvt_pk_bf16_f32 v59, 0, v59
    v_pk_mul_f32 v[52:53], v[52:53], v[64:65] op_sel_hi:[1,0]
    v_pk_mul_f32 v[54:55], v[54:55], v[64:65] op_sel_hi:[1,0]
    v_pk_mul_f32 v[56:57], v[56:57], v[64:65] op_sel_hi:[1,0]
    v_pk_mul_f32 v[58:59], v[58:59], v[64:65] op_sel_hi:[1,0]
    v_cvt_pk_bf16_f32 v36, v52, v53
    v_cvt_pk_bf16_f32 v37, v54, v55
    v_cvt_pk_bf16_f32 v38, v56, v57
    v_cvt_pk_bf16_f32 v39, v58, v59
    buffer_store_dwordx4 v[36:39], v9, s[16:19], s61 offen sc0 sc1
    s_waitcnt lgkmcnt(0)
    v_readfirstlane_b32 s74, v4
    s_waitcnt vmcnt(3)
    s_barrier
    s_lshl_b32 s53, s45, 12
    s_add_u32 s53, s53, s72
    s_lshl_b32 s54, s45, 16
    s_add_u32 s67, s52, 1048576
    s_and_b32 s67, s67, 0x1fffff
    s_add_u32 m0, s53, 8192
    s_add_u32 s67, s67, s54
    s_add_u32 s67, s67, 0
    buffer_load_dwordx4 v90, s[20:23], s67 offen lds
    s_add_u32 s67, s52, 1048576
    s_and_b32 s67, s67, 0x1fffff
    s_add_u32 m0, s53, 65536
    s_add_u32 s67, s67, s54
    s_add_u32 s67, s67, 131072
    buffer_load_dwordx4 v90, s[20:23], s67 offen lds
    s_add_u32 s67, s52, 1310720
    s_and_b32 s67, s67, 0x1fffff
    s_add_u32 m0, s53, 16384
    s_add_u32 s67, s67, s54
    s_add_u32 s67, s67, 0
    buffer_load_dwordx4 v90, s[20:23], s67 offen lds
    s_add_u32 s67, s52, 1310720
    s_and_b32 s67, s67, 0x1fffff
    s_add_u32 m0, s53, 73728
    s_add_u32 s67, s67, s54
    s_add_u32 s67, s67, 131072
    buffer_load_dwordx4 v90, s[20:23], s67 offen lds
    s_add_u32 s67, s52, 1572864
    s_and_b32 s67, s67, 0x1fffff
    s_add_u32 m0, s53, 98304
    s_add_u32 s67, s67, s54
    s_add_u32 s67, s67, 0
    buffer_load_dwordx4 v90, s[20:23], s67 offen lds
    s_add_u32 s67, s52, 1572864
    s_and_b32 s67, s67, 0x1fffff
    s_add_u32 m0, s53, 114688
    s_add_u32 s67, s67, s54
    s_add_u32 s67, s67, 131072
    buffer_load_dwordx4 v90, s[20:23], s67 offen lds
    s_add_u32 s67, s52, 1835008
    s_and_b32 s67, s67, 0x1fffff
    s_add_u32 m0, s53, 106496
    s_add_u32 s67, s67, s54
    s_add_u32 s67, s67, 0
    buffer_load_dwordx4 v90, s[20:23], s67 offen lds
    s_add_u32 s67, s52, 1835008
    s_and_b32 s67, s67, 0x1fffff
    s_add_u32 m0, s53, 122880
    s_add_u32 s67, s67, s54
    s_add_u32 s67, s67, 131072
    buffer_load_dwordx4 v90, s[20:23], s67 offen lds
    s_cmp_eq_u32 s45, 0
    s_cbranch_scc0 Q_hg
    s_branch Q_hd
Q_hg:
    s_waitcnt lgkmcnt(0)
Q_hd:
    s_and_b32 s75, s74, 0x7ff
    s_sub_u32 s75, 2047, s75
    s_lshl_b32 s66, s6, 3
    s_lshl_b32 s67, s44, 1
    s_add_u32 s66, s66, s67
    s_lshl_b32 s66, s66, 15
    s_lshl_b32 s67, s45, 11
    s_add_u32 s66, s66, s67
    s_lshl_b32 s67, s45, 15
    s_add_u32 s66, s66, s67
    v_add_u32 v4, s66, v9
    v_xor_b32 v3, 32768, v4
    s_lshr_b32 s63, s52, 6
    v_lshrrev_b32 v5, 4, v2
    v_bfe_u32 v6, v2, 2, 2
    v_lshl_add_u32 v8, v5, 2, v6
    v_bfe_u32 v6, v8, 1, 2
    v_lshlrev_b32 v8, 7, v8
    v_and_b32 v5, 3, v2
    v_lshl_add_u32 v8, v5, 3, v8
    s_mul_i32 s66, s45, 16384
    s_add_u32 s66, s66, 24576
    s_mul_i32 s67, s45, 8192
    s_add_u32 s67, s67, 81920
    s_mul_i32 s68, s45, 57344
    s_add_u32 s68, s68, 0
    s_mul_i32 s69, s45, 16384
    s_add_u32 s69, s69, 98304
    v_xor_b32 v5, 0, v6
    v_lshl_add_u32 v5, v5, 5, v8
    v_add_u32 v160, s66, v5
    v_add_u32 v164, s67, v5
    v_add_u32 v168, s68, v5
    v_add_u32 v172, s69, v5
    v_xor_b32 v5, 1, v6
    v_lshl_add_u32 v5, v5, 5, v8
    v_add_u32 v161, s66, v5
    v_add_u32 v165, s67, v5
    v_add_u32 v169, s68, v5
    v_add_u32 v173, s69, v5
    v_xor_b32 v5, 2, v6
    v_lshl_add_u32 v5, v5, 5, v8
    v_add_u32 v162, s66, v5
    v_add_u32 v166, s67, v5
    v_add_u32 v170, s68, v5
    v_add_u32 v174, s69, v5
    v_xor_b32 v5, 3, v6
    v_lshl_add_u32 v5, v5, 5, v8
    v_add_u32 v163, s66, v5
    v_add_u32 v167, s67, v5
    v_add_u32 v171, s68, v5
    v_add_u32 v175, s69, v5
    s_lshr_b32 s66, s75, 7
    s_cmp_eq_u32 s66, s6
    s_cselect_b32 s51, 1, 0
    s_barrier
    s_add_u32 s66, s63, 0
    s_and_b32 s66, s66, 32767
    buffer_load_dwordx4 v[96:99], v3, s[16:19], s66 offen offset:0 sc1
    buffer_load_dwordx4 v[100:103], v4, s[16:19], s66 offen offset:0 sc1
    buffer_load_dwordx4 v[104:107], v3, s[16:19], s66 offen offset:1024 sc1
    buffer_load_dwordx4 v[108:111], v4, s[16:19], s66 offen offset:1024 sc1
    s_cmp_eq_u32 s45, 0
    s_cbranch_scc1 Q_ny4
    s_lshl_b32 s66, s44, 8
    s_add_u32 s66, s66, 147456
    v_lshlrev_b32 v5, 2, v2
    v_add_u32 v6, s66, v5
    ds_read_b32 v64, v6 offset:0
    ds_read_b32 v65, v6 offset:1024
    ds_read_b32 v66, v6 offset:2048
    ds_read_b32 v67, v6 offset:3072
    s_waitcnt lgkmcnt(0)
    v_add_f32 v64, v64, v65
    v_add_f32 v66, v66, v67
    v_add_f32 v64, v64, v66
    buffer_store_dword v64, v5, s[16:19], s55 offen sc0 sc1
Q_ny4:
    s_add_u32 s66, s63, 4096
    s_and_b32 s66, s66, 32767
    buffer_load_dwordx4 v[112:115], v3, s[16:19], s66 offen offset:0 sc1
    buffer_load_dwordx4 v[116:119], v4, s[16:19], s66 offen offset:0 sc1
    buffer_load_dwordx4 v[120:123], v3, s[16:19], s66 offen offset:1024 sc1
    buffer_load_dwordx4 v[124:127], v4, s[16:19], s66 offen offset:1024 sc1
    ds_read_b64_tr_b16 v[192:193], v160 offset:0
    ds_read_b64_tr_b16 v[194:195], v160 offset:2048
    ds_read_b64_tr_b16 v[196:197], v161 offset:0
    ds_read_b64_tr_b16 v[198:199], v161 offset:2048
    ds_read_b64_tr_b16 v[200:201], v162 offset:0
    ds_read_b64_tr_b16 v[202:203], v162 offset:2048
    ds_read_b64_tr_b16 v[204:205], v163 offset:0
    ds_read_b64_tr_b16 v[206:207], v163 offset:2048
    s_waitcnt vmcnt(4)
    v_max3_u32 v5, v96, v97, v98
    v_max3_u32 v5, v5, v99, v100
    v_max3_u32 v5, v5, v101, v102
    v_max3_u32 v5, v5, v103, v104
    v_max3_u32 v5, v5, v105, v106
    v_max3_u32 v5, v5, v107, v108
    v_max3_u32 v5, v5, v109, v110
    v_max_u32 v5, v5, v111
    v_cmp_eq_u32 vcc, -1, v5
    s_cbranch_vccnz Q_rt0
Q_go0:
    s_add_u32 s66, s63, 8192
    s_and_b32 s66, s66, 32767
    s_waitcnt lgkmcnt(6)
    v_mfma_f32_16x16x32_bf16 v[224:227], v[192:195], v[96:99], 0
    buffer_load_dwordx4 v[128:131], v3, s[16:19], s66 offen offset:0 sc1
    v_mfma_f32_16x16x32_bf16 v[240:243], v[192:195], v[100:103], 0
    ds_read_b64_tr_b16 v[208:209], v160 offset:4096
    s_waitcnt lgkmcnt(5)
    v_mfma_f32_16x16x32_bf16 v[228:231], v[196:199], v[96:99], 0
    ds_read_b64_tr_b16 v[210:211], v160 offset:6144
    buffer_load_dwordx4 v[132:135], v4, s[16:19], s66 offen offset:0 sc1
    v_mfma_f32_16x16x32_bf16 v[244:247], v[196:199], v[100:103], 0
    ds_read_b64_tr_b16 v[212:213], v161 offset:4096
    s_waitcnt lgkmcnt(5)
    v_mfma_f32_16x16x32_bf16 v[232:235], v[200:203], v[96:99], 0
    ds_read_b64_tr_b16 v[214:215], v161 offset:6144
    buffer_load_dwordx4 v[136:139], v3, s[16:19], s66 offen offset:1024 sc1
    v_mfma_f32_16x16x32_bf16 v[248:251], v[200:203], v[100:103], 0
    ds_read_b64_tr_b16 v[216:217], v162 offset:4096
    s_waitcnt lgkmcnt(5)
    v_mfma_f32_16x16x32_bf16 v[236:239], v[204:207], v[96:99], 0
    ds_read_b64_tr_b16 v[218:219], v162 offset:6144
    buffer_load_dwordx4 v[140:143], v4, s[16:19], s66 offen offset:1024 sc1
    v_mfma_f32_16x16x32_bf16 v[252:255], v[204:207], v[100:103], 0
    ds_read_b64_tr_b16 v[220:221], v163 offset:4096
    ds_read_b64_tr_b16 v[222:223], v163 offset:6144
    s_waitcnt lgkmcnt(6)
    v_mfma_f32_16x16x32_bf16 v[224:227], v[208:211], v[104:107], v[224:227]
    v_mfma_f32_16x16x32_bf16 v[240:243], v[208:211], v[108:111], v[240:243]
    ds_read_b64_tr_b16 v[192:193], v160 offset:8192
    s_waitcnt lgkmcnt(5)
    v_mfma_f32_16x16x32_bf16 v[228:231], v[212:215], v[104:107], v[228:231]
    s_waitcnt vmcnt(4)
    ds_read_b64_tr_b16 v[194:195], v160 offset:10240
    v_max3_u32 v5, v112, v113, v114
    v_mfma_f32_16x16x32_bf16 v[244:247], v[212:215], v[108:111], v[244:247]
    ds_read_b64_tr_b16 v[196:197], v161 offset:8192
    v_max3_u32 v5, v5, v115, v116
    s_waitcnt lgkmcnt(5)
    v_mfma_f32_16x16x32_bf16 v[232:235], v[216:219], v[104:107], v[232:235]
    ds_read_b64_tr_b16 v[198:199], v161 offset:10240
    v_max3_u32 v5, v5, v117, v118
    v_mfma_f32_16x16x32_bf16 v[248:251], v[216:219], v[108:111], v[248:251]
    ds_read_b64_tr_b16 v[200:201], v162 offset:8192
    v_max3_u32 v5, v5, v119, v120
    v_max3_u32 v5, v5, v121, v122
    s_waitcnt lgkmcnt(5)
    v_mfma_f32_16x16x32_bf16 v[236:239], v[220:223], v[104:107], v[236:239]
    ds_read_b64_tr_b16 v[202:203], v162 offset:10240
    v_max3_u32 v5, v5, v123, v124
    v_max3_u32 v5, v5, v125, v126
    v_mfma_f32_16x16x32_bf16 v[252:255], v[220:223], v[108:111], v[252:255]
    ds_read_b64_tr_b16 v[204:205], v163 offset:8192
    ds_read_b64_tr_b16 v[206:207], v163 offset:10240
    v_max_u32 v5, v5, v127
    v_cmp_eq_u32 vcc, -1, v5
    s_cbranch_vccnz Q_rt1
Q_go1:
    s_add_u32 s66, s63, 12288
    s_and_b32 s66, s66, 32767
    s_waitcnt lgkmcnt(6)
    v_mfma_f32_16x16x32_bf16 v[224:227], v[192:195], v[112:115], v[224:227]
    buffer_load_dwordx4 v[96:99], v3, s[16:19], s66 offen offset:0 sc1
    v_mfma_f32_16x16x32_bf16 v[240:243], v[192:195], v[116:119], v[240:243]
    ds_read_b64_tr_b16 v[208:209], v160 offset:12288
    s_waitcnt lgkmcnt(5)
    v_mfma_f32_16x16x32_bf16 v[228:231], v[196:199], v[112:115], v[228:231]
    ds_read_b64_tr_b16 v[210:211], v160 offset:14336
    buffer_load_dwordx4 v[100:103], v4, s[16:19], s66 offen offset:0 sc1
    v_mfma_f32_16x16x32_bf16 v[244:247], v[196:199], v[116:119], v[244:247]
    ds_read_b64_tr_b16 v[212:213], v161 offset:12288
    s_waitcnt lgkmcnt(5)
    v_mfma_f32_16x16x32_bf16 v[232:235], v[200:203], v[112:115], v[232:235]
    ds_read_b64_tr_b16 v[214:215], v161 offset:14336
    buffer_load_dwordx4 v[104:107], v3, s[16:19], s66 offen offset:1024 sc1
    v_mfma_f32_16x16x32_bf16 v[248:251], v[200:203], v[116:119], v[248:251]
    ds_read_b64_tr_b16 v[216:217], v162 offset:12288
    s_waitcnt lgkmcnt(5)
    v_mfma_f32_16x16x32_bf16 v[236:239], v[204:207], v[112:115], v[236:239]
    ds_read_b64_tr_b16 v[218:219], v162 offset:14336
    buffer_load_dwordx4 v[108:111], v4, s[16:19], s66 offen offset:1024 sc1
    v_mfma_f32_16x16x32_bf16 v[252:255], v[204:207], v[116:119], v[252:255]
    ds_read_b64_tr_b16 v[220:221], v163 offset:12288
    ds_read_b64_tr_b16 v[222:223], v163 offset:14336
    s_waitcnt lgkmcnt(0)
    s_barrier
    s_waitcnt lgkmcnt(6)
    v_mfma_f32_16x16x32_bf16 v[224:227], v[208:211], v[120:123], v[224:227]
    v_mfma_f32_16x16x32_bf16 v[240:243], v[208:211], v[124:127], v[240:243]
    ds_read_b64_tr_b16 v[192:193], v164 offset:0
    s_waitcnt lgkmcnt(5)
    v_mfma_f32_16x16x32_bf16 v[228:231], v[212:215], v[120:123], v[228:231]
    s_waitcnt vmcnt(4)
    ds_read_b64_tr_b16 v[194:195], v164 offset:2048
    v_max3_u32 v5, v128, v129, v130
    v_mfma_f32_16x16x32_bf16 v[244:247], v[212:215], v[124:127], v[244:247]
    ds_read_b64_tr_b16 v[196:197], v165 offset:0
    v_max3_u32 v5, v5, v131, v132
    s_waitcnt lgkmcnt(5)
    v_mfma_f32_16x16x32_bf16 v[232:235], v[216:219], v[120:123], v[232:235]
    ds_read_b64_tr_b16 v[198:199], v165 offset:2048
    v_max3_u32 v5, v5, v133, v134
    v_mfma_f32_16x16x32_bf16 v[248:251], v[216:219], v[124:127], v[248:251]
    ds_read_b64_tr_b16 v[200:201], v166 offset:0
    v_max3_u32 v5, v5, v135, v136
    v_max3_u32 v5, v5, v137, v138
    s_waitcnt lgkmcnt(5)
    v_mfma_f32_16x16x32_bf16 v[236:239], v[220:223], v[120:123], v[236:239]
    ds_read_b64_tr_b16 v[202:203], v166 offset:2048
    v_max3_u32 v5, v5, v139, v140
    v_max3_u32 v5, v5, v141, v142
    v_mfma_f32_16x16x32_bf16 v[252:255], v[220:223], v[124:127], v[252:255]
    ds_read_b64_tr_b16 v[204:205], v167 offset:0
    ds_read_b64_tr_b16 v[206:207], v167 offset:2048
    v_max_u32 v5, v5, v143
    v_cmp_eq_u32 vcc, -1, v5
    s_cbranch_vccnz Q_rt2
Q_go2:
    s_add_u32 s66, s63, 16384
    s_and_b32 s66, s66, 32767
    s_waitcnt lgkmcnt(6)
    v_mfma_f32_16x16x32_bf16 v[224:227], v[192:195], v[128:131], v[224:227]
    buffer_load_dwordx4 v[112:115], v3, s[16:19], s66 offen offset:0 sc1
    v_mfma_f32_16x16x32_bf16 v[240:243], v[192:195], v[132:135], v[240:243]
    ds_read_b64_tr_b16 v[208:209], v164 offset:4096
    s_waitcnt lgkmcnt(5)
    v_mfma_f32_16x16x32_bf16 v[228:231], v[196:199], v[128:131], v[228:231]
    ds_read_b64_tr_b16 v[210:211], v164 offset:6144
    buffer_load_dwordx4 v[116:119], v4, s[16:19], s66 offen offset:0 sc1
    v_mfma_f32_16x16x32_bf16 v[244:247], v[196:199], v[132:135], v[244:247]
    ds_read_b64_tr_b16 v[212:213], v165 offset:4096
    s_waitcnt lgkmcnt(5)
    v_mfma_f32_16x16x32_bf16 v[232:235], v[200:203], v[128:131], v[232:235]
    ds_read_b64_tr_b16 v[214:215], v165 offset:6144
    buffer_load_dwordx4 v[120:123], v3, s[16:19], s66 offen offset:1024 sc1
    v_mfma_f32_16x16x32_bf16 v[248:251], v[200:203], v[132:135], v[248:251]
    ds_read_b64_tr_b16 v[216:217], v166 offset:4096
    s_waitcnt lgkmcnt(5)
    v_mfma_f32_16x16x32_bf16 v[236:239], v[204:207], v[128:131], v[236:239]
    ds_read_b64_tr_b16 v[218:219], v166 offset:6144
    buffer_load_dwordx4 v[124:127], v4, s[16:19], s66 offen offset:1024 sc1
    v_mfma_f32_16x16x32_bf16 v[252:255], v[204:207], v[132:135], v[252:255]
    ds_read_b64_tr_b16 v[220:221], v167 offset:4096
    ds_read_b64_tr_b16 v[222:223], v167 offset:6144
    s_waitcnt lgkmcnt(6)
    v_mfma_f32_16x16x32_bf16 v[224:227], v[208:211], v[136:139], v[224:227]
    v_mfma_f32_16x16x32_bf16 v[240:243], v[208:211], v[140:143], v[240:243]
    ds_read_b64_tr_b16 v[192:193], v168 offset:0
    s_waitcnt lgkmcnt(5)
    v_mfma_f32_16x16x32_bf16 v[228:231], v[212:215], v[136:139], v[228:231]
    s_waitcnt vmcnt(4)
    ds_read_b64_tr_b16 v[194:195], v168 offset:2048
    v_max3_u32 v5, v96, v97, v98
    v_mfma_f32_16x16x32_bf16 v[244:247], v[212:215], v[140:143], v[244:247]
    ds_read_b64_tr_b16 v[196:197], v169 offset:0
    v_max3_u32 v5, v5, v99, v100
    s_waitcnt lgkmcnt(5)
    v_mfma_f32_16x16x32_bf16 v[232:235], v[216:219], v[136:139], v[232:235]
    ds_read_b64_tr_b16 v[198:199], v169 offset:2048
    v_max3_u32 v5, v5, v101, v102
    v_mfma_f32_16x16x32_bf16 v[248:251], v[216:219], v[140:143], v[248:251]
    ds_read_b64_tr_b16 v[200:201], v170 offset:0
    v_max3_u32 v5, v5, v103, v104
    v_max3_u32 v5, v5, v105, v106
    s_waitcnt lgkmcnt(5)
    v_mfma_f32_16x16x32_bf16 v[236:239], v[220:223], v[136:139], v[236:239]
    ds_read_b64_tr_b16 v[202:203], v170 offset:2048
    v_max3_u32 v5, v5, v107, v108
    v_max3_u32 v5, v5, v109, v110
    v_mfma_f32_16x16x32_bf16 v[252:255], v[220:223], v[140:143], v[252:255]
    ds_read_b64_tr_b16 v[204:205], v171 offset:0
    ds_read_b64_tr_b16 v[206:207], v171 offset:2048
    v_max_u32 v5, v5, v111
    v_cmp_eq_u32 vcc, -1, v5
    s_cbranch_vccnz Q_rt3
Q_go3:
    s_add_u32 s66, s63, 20480
    s_and_b32 s66, s66, 32767
    s_waitcnt lgkmcnt(6)
    v_mfma_f32_16x16x32_bf16 v[224:227], v[192:195], v[96:99], v[224:227]
    buffer_load_dwordx4 v[128:131], v3, s[16:19], s66 offen offset:0 sc1
    v_mfma_f32_16x16x32_bf16 v[240:243], v[192:195], v[100:103], v[240:243]
    ds_read_b64_tr_b16 v[208:209], v168 offset:4096
    s_waitcnt lgkmcnt(5)
    v_mfma_f32_16x16x32_bf16 v[228:231], v[196:199], v[96:99], v[228:231]
    ds_read_b64_tr_b16 v[210:211], v168 offset:6144
    buffer_load_dwordx4 v[132:135], v4, s[16:19], s66 offen offset:0 sc1
    v_mfma_f32_16x16x32_bf16 v[244:247], v[196:199], v[100:103], v[244:247]
    ds_read_b64_tr_b16 v[212:213], v169 offset:4096
    s_waitcnt lgkmcnt(5)
    v_mfma_f32_16x16x32_bf16 v[232:235], v[200:203], v[96:99], v[232:235]
    ds_read_b64_tr_b16 v[214:215], v169 offset:6144
    buffer_load_dwordx4 v[136:139], v3, s[16:19], s66 offen offset:1024 sc1
    v_mfma_f32_16x16x32_bf16 v[248:251], v[200:203], v[100:103], v[248:251]
    ds_read_b64_tr_b16 v[216:217], v170 offset:4096
    s_waitcnt lgkmcnt(5)
    v_mfma_f32_16x16x32_bf16 v[236:239], v[204:207], v[96:99], v[236:239]
    ds_read_b64_tr_b16 v[218:219], v170 offset:6144
    buffer_load_dwordx4 v[140:143], v4, s[16:19], s66 offen offset:1024 sc1
    v_mfma_f32_16x16x32_bf16 v[252:255], v[204:207], v[100:103], v[252:255]
    ds_read_b64_tr_b16 v[220:221], v171 offset:4096
    ds_read_b64_tr_b16 v[222:223], v171 offset:6144
    s_waitcnt lgkmcnt(6)
    v_mfma_f32_16x16x32_bf16 v[224:227], v[208:211], v[104:107], v[224:227]
    v_mfma_f32_16x16x32_bf16 v[240:243], v[208:211], v[108:111], v[240:243]
    ds_read_b64_tr_b16 v[192:193], v168 offset:8192
    s_waitcnt lgkmcnt(5)
    v_mfma_f32_16x16x32_bf16 v[228:231], v[212:215], v[104:107], v[228:231]
    s_waitcnt vmcnt(4)
    ds_read_b64_tr_b16 v[194:195], v168 offset:10240
    v_max3_u32 v5, v112, v113, v114
    v_mfma_f32_16x16x32_bf16 v[244:247], v[212:215], v[108:111], v[244:247]
    ds_read_b64_tr_b16 v[196:197], v169 offset:8192
    v_max3_u32 v5, v5, v115, v116
    s_waitcnt lgkmcnt(5)
    v_mfma_f32_16x16x32_bf16 v[232:235], v[216:219], v[104:107], v[232:235]
    ds_read_b64_tr_b16 v[198:199], v169 offset:10240
    v_max3_u32 v5, v5, v117, v118
    v_mfma_f32_16x16x32_bf16 v[248:251], v[216:219], v[108:111], v[248:251]
    ds_read_b64_tr_b16 v[200:201], v170 offset:8192
    v_max3_u32 v5, v5, v119, v120
    v_max3_u32 v5, v5, v121, v122
    s_waitcnt lgkmcnt(5)
    v_mfma_f32_16x16x32_bf16 v[236:239], v[220:223], v[104:107], v[236:239]
    ds_read_b64_tr_b16 v[202:203], v170 offset:10240
    v_max3_u32 v5, v5, v123, v124
    v_max3_u32 v5, v5, v125, v126
    v_mfma_f32_16x16x32_bf16 v[252:255], v[220:223], v[108:111], v[252:255]
    ds_read_b64_tr_b16 v[204:205], v171 offset:8192
    ds_read_b64_tr_b16 v[206:207], v171 offset:10240
    v_max_u32 v5, v5, v127
    v_cmp_eq_u32 vcc, -1, v5
    s_cbranch_vccnz Q_rt4
Q_go4:
    s_cmp_eq_u32 s51, 0
    s_cbranch_scc1 Q_ny0
    s_lshl_b32 s64, s7, 14
    s_lshl_b32 s66, s3, 11
    s_add_u32 s64, s64, s66
    s_add_u32 s64, s64, 5832704
    buffer_load_dwordx4 v[32:35], v9, s[16:19], s64 offen offset:0 sc1
    buffer_load_dwordx4 v[36:39], v9, s[16:19], s64 offen offset:1024 sc1
Q_ny0:
    s_add_u32 s66, s63, 24576
    s_and_b32 s66, s66, 32767
    s_waitcnt lgkmcnt(6)
    v_mfma_f32_16x16x32_bf16 v[224:227], v[192:195], v[112:115], v[224:227]
    buffer_load_dwordx4 v[96:99], v3, s[16:19], s66 offen offset:0 sc1
    v_mfma_f32_16x16x32_bf16 v[240:243], v[192:195], v[116:119], v[240:243]
    ds_read_b64_tr_b16 v[208:209], v168 offset:12288
    s_waitcnt lgkmcnt(5)
    v_mfma_f32_16x16x32_bf16 v[228:231], v[196:199], v[112:115], v[228:231]
    ds_read_b64_tr_b16 v[210:211], v168 offset:14336
    buffer_load_dwordx4 v[100:103], v4, s[16:19], s66 offen offset:0 sc1
    v_mfma_f32_16x16x32_bf16 v[244:247], v[196:199], v[116:119], v[244:247]
    ds_read_b64_tr_b16 v[212:213], v169 offset:12288
    s_waitcnt lgkmcnt(5)
    v_mfma_f32_16x16x32_bf16 v[232:235], v[200:203], v[112:115], v[232:235]
    ds_read_b64_tr_b16 v[214:215], v169 offset:14336
    buffer_load_dwordx4 v[104:107], v3, s[16:19], s66 offen offset:1024 sc1
    v_mfma_f32_16x16x32_bf16 v[248:251], v[200:203], v[116:119], v[248:251]
    ds_read_b64_tr_b16 v[216:217], v170 offset:12288
    s_waitcnt lgkmcnt(5)
    v_mfma_f32_16x16x32_bf16 v[236:239], v[204:207], v[112:115], v[236:239]
    ds_read_b64_tr_b16 v[218:219], v170 offset:14336
    buffer_load_dwordx4 v[108:111], v4, s[16:19], s66 offen offset:1024 sc1
    v_mfma_f32_16x16x32_bf16 v[252:255], v[204:207], v[116:119], v[252:255]
    ds_read_b64_tr_b16 v[220:221], v171 offset:12288
    ds_read_b64_tr_b16 v[222:223], v171 offset:14336
    s_waitcnt lgkmcnt(6)
    v_mfma_f32_16x16x32_bf16 v[224:227], v[208:211], v[120:123], v[224:227]
    v_mfma_f32_16x16x32_bf16 v[240:243], v[208:211], v[124:127], v[240:243]
    ds_read_b64_tr_b16 v[192:193], v168 offset:16384
    s_waitcnt lgkmcnt(5)
    v_mfma_f32_16x16x32_bf16 v[228:231], v[212:215], v[120:123], v[228:231]
    s_waitcnt vmcnt(4)
    ds_read_b64_tr_b16 v[194:195], v168 offset:18432
    v_max3_u32 v5, v128, v129, v130
    v_mfma_f32_16x16x32_bf16 v[244:247], v[212:215], v[124:127], v[244:247]
    ds_read_b64_tr_b16 v[196:197], v169 offset:16384
    v_max3_u32 v5, v5, v131, v132
    s_waitcnt lgkmcnt(5)
    v_mfma_f32_16x16x32_bf16 v[232:235], v[216:219], v[120:123], v[232:235]
    ds_read_b64_tr_b16 v[198:199], v169 offset:18432
    v_max3_u32 v5, v5, v133, v134
    v_mfma_f32_16x16x32_bf16 v[248:251], v[216:219], v[124:127], v[248:251]
    ds_read_b64_tr_b16 v[200:201], v170 offset:16384
    v_max3_u32 v5, v5, v135, v136
    v_max3_u32 v5, v5, v137, v138
    s_waitcnt lgkmcnt(5)
    v_mfma_f32_16x16x32_bf16 v[236:239], v[220:223], v[120:123], v[236:239]
    ds_read_b64_tr_b16 v[202:203], v170 offset:18432
    v_max3_u32 v5, v5, v139, v140
    v_max3_u32 v5, v5, v141, v142
    v_mfma_f32_16x16x32_bf16 v[252:255], v[220:223], v[124:127], v[252:255]
    ds_read_b64_tr_b16 v[204:205], v171 offset:16384
    ds_read_b64_tr_b16 v[206:207], v171 offset:18432
    v_max_u32 v5, v5, v143
    v_cmp_eq_u32 vcc, -1, v5
    s_cbranch_vccnz Q_rt5
Q_go5:
    s_cmp_eq_u32 s45, 0
    s_cbranch_scc1 Q_np2
    s_setprio 1
Q_np2:
    s_cmp_eq_u32 s51, 0
    s_cbranch_scc1 Q_ny1
    s_mov_b32 s59, 0
Q_ychk:
    s_waitcnt vmcnt(0)
    v_max3_u32 v5, v32, v33, v34
    v_max3_u32 v5, v5, v35, v36
    v_max3_u32 v5, v5, v37, v38
    v_max_u32 v5, v5, v39
    v_cmp_eq_u32 vcc, -1, v5
    s_cbranch_vccz Q_yok
    s_add_u32 s59, s59, 1
    s_cmp_ge_u32 s59, 200000
    s_cbranch_scc1 Q_yok
    s_sleep 4
    buffer_load_dwordx4 v[32:35], v9, s[16:19], s64 offen offset:0 sc1
    buffer_load_dwordx4 v[36:39], v9, s[16:19], s64 offen offset:1024 sc1
    s_branch Q_ychk
Q_yok:
    v_add_f32 v32, v32, v36
    v_add_f32 v33, v33, v37
    v_add_f32 v34, v34, v38
    v_add_f32 v35, v35, v39
    s_nop 1
    v_permlane16_swap_b32 v32, v34
    v_permlane16_swap_b32 v33, v35
    v_add_f32 v32, v32, v34
    v_add_f32 v33, v33, v35
    v_and_b32 v5, 15, v2
    v_lshlrev_b32 v5, 4, v5
    v_permlane32_swap_b32 v32, v33
    v_bfe_u32 v8, v2, 4, 1
    v_lshl_add_u32 v5, v8, 3, v5
    v_lshrrev_b32 v8, 5, v2
    v_lshl_add_u32 v5, v8, 2, v5
    v_add_f32 v32, v32, v33
    s_lshl_b32 s66, s3, 8
    s_add_u32 s66, s66, 156992
    v_add_u32 v5, s66, v5
    ds_write_b32 v5, v32
    v_mov_b32 v5, 155688
    v_mov_b32 v8, 1
    s_mov_b64 exec, 1
    ds_add_u32 v5, v8
    s_mov_b64 exec, -1
    s_waitcnt lgkmcnt(0)
Q_ny1:
    s_add_u32 s66, s63, 28672
    s_and_b32 s66, s66, 32767
    s_waitcnt lgkmcnt(6)
    v_mfma_f32_16x16x32_bf16 v[224:227], v[192:195], v[128:131], v[224:227]
    buffer_load_dwordx4 v[112:115], v3, s[16:19], s66 offen offset:0 sc1
    v_mfma_f32_16x16x32_bf16 v[240:243], v[192:195], v[132:135], v[240:243]
    ds_read_b64_tr_b16 v[208:209], v168 offset:20480
    s_waitcnt lgkmcnt(5)
    v_mfma_f32_16x16x32_bf16 v[228:231], v[196:199], v[128:131], v[228:231]
    ds_read_b64_tr_b16 v[210:211], v168 offset:22528
    buffer_load_dwordx4 v[116:119], v4, s[16:19], s66 offen offset:0 sc1
    v_mfma_f32_16x16x32_bf16 v[244:247], v[196:199], v[132:135], v[244:247]
    ds_read_b64_tr_b16 v[212:213], v169 offset:20480
    s_waitcnt lgkmcnt(5)
    v_mfma_f32_16x16x32_bf16 v[232:235], v[200:203], v[128:131], v[232:235]
    ds_read_b64_tr_b16 v[214:215], v169 offset:22528
    buffer_load_dwordx4 v[120:123], v3, s[16:19], s66 offen offset:1024 sc1
    v_mfma_f32_16x16x32_bf16 v[248:251], v[200:203], v[132:135], v[248:251]
    ds_read_b64_tr_b16 v[216:217], v170 offset:20480
    s_waitcnt lgkmcnt(5)
    v_mfma_f32_16x16x32_bf16 v[236:239], v[204:207], v[128:131], v[236:239]
    ds_read_b64_tr_b16 v[218:219], v170 offset:22528
    buffer_load_dwordx4 v[124:127], v4, s[16:19], s66 offen offset:1024 sc1
    v_mfma_f32_16x16x32_bf16 v[252:255], v[204:207], v[132:135], v[252:255]
    ds_read_b64_tr_b16 v[220:221], v171 offset:20480
    ds_read_b64_tr_b16 v[222:223], v171 offset:22528
    s_waitcnt lgkmcnt(6)
    v_mfma_f32_16x16x32_bf16 v[224:227], v[208:211], v[136:139], v[224:227]
    v_mfma_f32_16x16x32_bf16 v[240:243], v[208:211], v[140:143], v[240:243]
    ds_read_b64_tr_b16 v[192:193], v172 offset:0
    s_waitcnt lgkmcnt(5)
    v_mfma_f32_16x16x32_bf16 v[228:231], v[212:215], v[136:139], v[228:231]
    s_waitcnt vmcnt(4)
    ds_read_b64_tr_b16 v[194:195], v172 offset:2048
    v_max3_u32 v5, v96, v97, v98
    v_mfma_f32_16x16x32_bf16 v[244:247], v[212:215], v[140:143], v[244:247]
    ds_read_b64_tr_b16 v[196:197], v173 offset:0
    v_max3_u32 v5, v5, v99, v100
    s_waitcnt lgkmcnt(5)
    v_mfma_f32_16x16x32_bf16 v[232:235], v[216:219], v[136:139], v[232:235]
    ds_read_b64_tr_b16 v[198:199], v173 offset:2048
    v_max3_u32 v5, v5, v101, v102
    v_mfma_f32_16x16x32_bf16 v[248:251], v[216:219], v[140:143], v[248:251]
    ds_read_b64_tr_b16 v[200:201], v174 offset:0
    v_max3_u32 v5, v5, v103, v104
    v_max3_u32 v5, v5, v105, v106
    s_waitcnt lgkmcnt(5)
    v_mfma_f32_16x16x32_bf16 v[236:239], v[220:223], v[136:139], v[236:239]
    ds_read_b64_tr_b16 v[202:203], v174 offset:2048
    v_max3_u32 v5, v5, v107, v108
    v_max3_u32 v5, v5, v109, v110
    v_mfma_f32_16x16x32_bf16 v[252:255], v[220:223], v[140:143], v[252:255]
    ds_read_b64_tr_b16 v[204:205], v175 offset:0
    ds_read_b64_tr_b16 v[206:207], v175 offset:2048
    v_max_u32 v5, v5, v111
    v_cmp_eq_u32 vcc, -1, v5
    s_cbranch_vccnz Q_rt6
Q_go6:
    s_waitcnt lgkmcnt(6)
    v_mfma_f32_16x16x32_bf16 v[224:227], v[192:195], v[96:99], v[224:227]
    v_sub_f32 v153, 1.0, v152
    v_cvt_pk_bf16_f32 v153, 0, v153
    v_lshlrev_b32 v16, 16, v144
    v_mfma_f32_16x16x32_bf16 v[240:243], v[192:195], v[100:103], v[240:243]
    ds_read_b64_tr_b16 v[208:209], v172 offset:4096
    v_and_b32 v17, 0xffff0000, v144
    v_mul_f32 v16, v16, v153
    v_mul_f32 v17, v17, v153
    s_waitcnt lgkmcnt(5)
    v_mfma_f32_16x16x32_bf16 v[228:231], v[196:199], v[96:99], v[228:231]
    ds_read_b64_tr_b16 v[210:211], v172 offset:6144
    v_cvt_pk_bf16_f32 v16, 0, v16
    v_cvt_pk_bf16_f32 v17, 0, v17
    v_lshlrev_b32 v18, 16, v145
    v_mfma_f32_16x16x32_bf16 v[244:247], v[196:199], v[100:103], v[244:247]
    ds_read_b64_tr_b16 v[212:213], v173 offset:4096
    v_and_b32 v19, 0xffff0000, v145
    v_mul_f32 v18, v18, v153
    v_mul_f32 v19, v19, v153
    s_waitcnt lgkmcnt(5)
    v_mfma_f32_16x16x32_bf16 v[232:235], v[200:203], v[96:99], v[232:235]
    ds_read_b64_tr_b16 v[214:215], v173 offset:6144
    v_cvt_pk_bf16_f32 v18, 0, v18
    v_cvt_pk_bf16_f32 v19, 0, v19
    v_lshlrev_b32 v20, 16, v146
    v_mfma_f32_16x16x32_bf16 v[248:251], v[200:203], v[100:103], v[248:251]
    ds_read_b64_tr_b16 v[216:217], v174 offset:4096
    v_and_b32 v21, 0xffff0000, v146
    v_mul_f32 v20, v20, v153
    v_mul_f32 v21, v21, v153
    s_waitcnt lgkmcnt(5)
    v_mfma_f32_16x16x32_bf16 v[236:239], v[204:207], v[96:99], v[236:239]
    ds_read_b64_tr_b16 v[218:219], v174 offset:6144
    v_cvt_pk_bf16_f32 v20, 0, v20
    v_cvt_pk_bf16_f32 v21, 0, v21
    v_lshlrev_b32 v22, 16, v147
    v_mfma_f32_16x16x32_bf16 v[252:255], v[204:207], v[100:103], v[252:255]
    ds_read_b64_tr_b16 v[220:221], v175 offset:4096
    ds_read_b64_tr_b16 v[222:223], v175 offset:6144
    v_and_b32 v23, 0xffff0000, v147
    v_mul_f32 v22, v22, v153
    v_mul_f32 v23, v23, v153
    s_waitcnt lgkmcnt(6)
    v_mfma_f32_16x16x32_bf16 v[224:227], v[208:211], v[104:107], v[224:227]
    v_mfma_f32_16x16x32_bf16 v[240:243], v[208:211], v[108:111], v[240:243]
    ds_read_b64_tr_b16 v[192:193], v172 offset:8192
    s_waitcnt lgkmcnt(5)
    v_mfma_f32_16x16x32_bf16 v[228:231], v[212:215], v[104:107], v[228:231]
    s_waitcnt vmcnt(0)
    ds_read_b64_tr_b16 v[194:195], v172 offset:10240
    v_max3_u32 v5, v112, v113, v114
    v_mfma_f32_16x16x32_bf16 v[244:247], v[212:215], v[108:111], v[244:247]
    ds_read_b64_tr_b16 v[196:197], v173 offset:8192
    v_max3_u32 v5, v5, v115, v116
    s_waitcnt lgkmcnt(5)
    v_mfma_f32_16x16x32_bf16 v[232:235], v[216:219], v[104:107], v[232:235]
    ds_read_b64_tr_b16 v[198:199], v173 offset:10240
    v_max3_u32 v5, v5, v117, v118
    v_mfma_f32_16x16x32_bf16 v[248:251], v[216:219], v[108:111], v[248:251]
    ds_read_b64_tr_b16 v[200:201], v174 offset:8192
    v_max3_u32 v5, v5, v119, v120
    v_max3_u32 v5, v5, v121, v122
    s_waitcnt lgkmcnt(5)
    v_mfma_f32_16x16x32_bf16 v[236:239], v[220:223], v[104:107], v[236:239]
    ds_read_b64_tr_b16 v[202:203], v174 offset:10240
    v_max3_u32 v5, v5, v123, v124
    v_max3_u32 v5, v5, v125, v126
    v_mfma_f32_16x16x32_bf16 v[252:255], v[220:223], v[108:111], v[252:255]
    ds_read_b64_tr_b16 v[204:205], v175 offset:8192
    ds_read_b64_tr_b16 v[206:207], v175 offset:10240
    v_max_u32 v5, v5, v127
    v_cmp_eq_u32 vcc, -1, v5
    s_cbranch_vccnz Q_rt7
Q_go7:
    s_waitcnt lgkmcnt(6)
    v_mfma_f32_16x16x32_bf16 v[224:227], v[192:195], v[112:115], v[224:227]
    v_cvt_pk_bf16_f32 v22, 0, v22
    v_cvt_pk_bf16_f32 v23, 0, v23
    v_lshlrev_b32 v24, 16, v148
    v_and_b32 v25, 0xffff0000, v148
    v_mul_f32 v24, v24, v153
    v_mfma_f32_16x16x32_bf16 v[240:243], v[192:195], v[116:119], v[240:243]
    ds_read_b64_tr_b16 v[208:209], v172 offset:12288
    v_mul_f32 v25, v25, v153
    v_cvt_pk_bf16_f32 v24, 0, v24
    v_cvt_pk_bf16_f32 v25, 0, v25
    v_lshlrev_b32 v26, 16, v149
    v_and_b32 v27, 0xffff0000, v149
    s_waitcnt lgkmcnt(5)
    v_mfma_f32_16x16x32_bf16 v[228:231], v[196:199], v[112:115], v[228:231]
    ds_read_b64_tr_b16 v[210:211], v172 offset:14336
    v_mul_f32 v26, v26, v153
    v_mul_f32 v27, v27, v153
    v_cvt_pk_bf16_f32 v26, 0, v26
    v_cvt_pk_bf16_f32 v27, 0, v27
    v_mfma_f32_16x16x32_bf16 v[244:247], v[196:199], v[116:119], v[244:247]
    ds_read_b64_tr_b16 v[212:213], v173 offset:12288
    v_lshlrev_b32 v28, 16, v150
    v_and_b32 v29, 0xffff0000, v150
    v_mul_f32 v28, v28, v153
    v_mul_f32 v29, v29, v153
    s_waitcnt lgkmcnt(5)
    v_mfma_f32_16x16x32_bf16 v[232:235], v[200:203], v[112:115], v[232:235]
    ds_read_b64_tr_b16 v[214:215], v173 offset:14336
    v_cvt_pk_bf16_f32 v28, 0, v28
    v_cvt_pk_bf16_f32 v29, 0, v29
    v_lshlrev_b32 v30, 16, v151
    v_and_b32 v31, 0xffff0000, v151
    v_mfma_f32_16x16x32_bf16 v[248:251], v[200:203], v[116:119], v[248:251]
    ds_read_b64_tr_b16 v[216:217], v174 offset:12288
    v_mul_f32 v30, v30, v153
    v_mul_f32 v31, v31, v153
    v_cvt_pk_bf16_f32 v30, 0, v30
    v_cvt_pk_bf16_f32 v31, 0, v31
    s_waitcnt lgkmcnt(5)
    v_mfma_f32_16x16x32_bf16 v[236:239], v[204:207], v[112:115], v[236:239]
    ds_read_b64_tr_b16 v[218:219], v174 offset:14336
    v_mov_b32 v154, v152
    v_mov_b32 v155, v152
    s_lshl_b32 s66, s3, 12
    s_add_u32 s67, s66, 24576
    v_mfma_f32_16x16x32_bf16 v[252:255], v[204:207], v[116:119], v[252:255]
    ds_read_b64_tr_b16 v[220:221], v175 offset:12288
    ds_read_b64_tr_b16 v[222:223], v175 offset:14336
    v_add_u32 v6, s67, v9
    s_xor_b32 s66, s66, 16384
    s_add_u32 s66, s66, 24576
    v_add_u32 v7, s66, v9
    s_waitcnt lgkmcnt(6)
    v_mfma_f32_16x16x32_bf16 v[224:227], v[208:211], v[120:123], v[224:227]
    s_waitcnt lgkmcnt(4)
    v_mfma_f32_16x16x32_bf16 v[228:231], v[212:215], v[120:123], v[228:231]
    s_waitcnt lgkmcnt(2)
    v_mfma_f32_16x16x32_bf16 v[232:235], v[216:219], v[120:123], v[232:235]
    s_waitcnt lgkmcnt(0)
    v_mfma_f32_16x16x32_bf16 v[236:239], v[220:223], v[120:123], v[236:239]
    v_mfma_f32_16x16x32_bf16 v[240:243], v[208:211], v[124:127], v[240:243]
    s_nop 0
    v_mfma_f32_16x16x32_bf16 v[244:247], v[212:215], v[124:127], v[244:247]
    s_nop 0
    v_mfma_f32_16x16x32_bf16 v[248:251], v[216:219], v[124:127], v[248:251]
    s_nop 0
    v_mfma_f32_16x16x32_bf16 v[252:255], v[220:223], v[124:127], v[252:255]
    s_nop 0
    ds_write_b128 v6, v[224:227] offset:0
    ds_write_b128 v6, v[228:231] offset:1024
    ds_write_b128 v6, v[232:235] offset:2048
    ds_write_b128 v6, v[236:239] offset:3072
    s_cmp_eq_u32 s51, 0
    s_cbranch_scc1 Q_ny2
    s_cmp_lg_u32 s3, 0
    s_cbranch_scc1 Q_ny2
    v_mov_b32 v5, 155688
Q_yw:
    ds_read_b32 v8, v5
    s_waitcnt lgkmcnt(0)
    v_cmp_ne_u32 vcc, 8, v8
    s_cbranch_vccnz Q_yw
    v_lshlrev_b32 v8, 2, v2
    v_add_u32 v8, 156992, v8
    ds_read_b32 v32, v8 offset:0
    ds_read_b32 v33, v8 offset:256
    ds_read_b32 v34, v8 offset:512
    ds_read_b32 v35, v8 offset:768
    ds_read_b32 v36, v8 offset:1024
    ds_read_b32 v37, v8 offset:1280
    ds_read_b32 v38, v8 offset:1536
    ds_read_b32 v39, v8 offset:1792
    s_and_b32 s66, s74, 0xffff0000
    s_xor_b32 s67, s66, 0x80000000
    s_not_b32 s68, s66
    s_and_b32 s68, s68, 0xffff0000
    s_cmp_ge_u32 s66, 0x80000000
    s_cselect_b32 s66, s67, s68
    v_mov_b32 v40, s66
    v_mul_f32 v40, s46, v40
    v_exp_f32 v40, -v40
    s_nop 0
    v_add_f32 v40, 1.0, v40
    v_rcp_f32 v40, v40
    s_nop 0
    v_cvt_pk_bf16_f32 v40, 0, v40
    s_waitcnt lgkmcnt(0)
    v_add_f32 v32, v32, v33
    v_add_f32 v32, v32, v34
    v_add_f32 v32, v32, v35
    v_add_f32 v32, v32, v36
    v_add_f32 v32, v32, v37
    v_add_f32 v32, v32, v38
    v_add_f32 v32, v32, v39
    v_cvt_pk_bf16_f32 v32, 0, v32
    v_mul_f32 v32, v32, v40
    v_cvt_pk_bf16_f32 v32, 0, v32
    ds_write_b32 v8, v32 offset:2048
    s_waitcnt lgkmcnt(0)
Q_ny2:
    s_waitcnt lgkmcnt(0)
    s_barrier
    ds_read_b128 v[224:227], v7 offset:0
    ds_read_b128 v[228:231], v7 offset:1024
    ds_read_b128 v[232:235], v7 offset:2048
    ds_read_b128 v[236:239], v7 offset:3072
    v_cmp_eq_u32 vcc, s75, v92
    s_and_saveexec_b64 s[68:69], vcc
    s_cbranch_execz Q_nr
    v_bfe_u32 v8, v2, 4, 1
    v_lshlrev_b32 v8, 6, v8
    v_lshrrev_b32 v5, 5, v2
    v_lshl_add_u32 v8, v5, 5, v8
    v_add_u32 v8, 159040, v8
    ds_read_b128 v[40:43], v8 offset:0
    ds_read_b128 v[44:47], v8 offset:16
    ds_read_b128 v[48:51], v8 offset:128
    ds_read_b128 v[52:55], v8 offset:144
    s_waitcnt lgkmcnt(0)
    v_lshlrev_b32 v16, 16, v144
    v_and_b32 v17, 0xffff0000, v144
    v_lshlrev_b32 v18, 16, v145
    v_and_b32 v19, 0xffff0000, v145
    v_lshlrev_b32 v20, 16, v146
    v_and_b32 v21, 0xffff0000, v146
    v_lshlrev_b32 v22, 16, v147
    v_and_b32 v23, 0xffff0000, v147
    v_lshlrev_b32 v24, 16, v148
    v_and_b32 v25, 0xffff0000, v148
    v_lshlrev_b32 v26, 16, v149
    v_and_b32 v27, 0xffff0000, v149
    v_lshlrev_b32 v28, 16, v150
    v_and_b32 v29, 0xffff0000, v150
    v_lshlrev_b32 v30, 16, v151
    v_and_b32 v31, 0xffff0000, v151
    v_add_f32 v16, v16, v40
    v_cvt_pk_bf16_f32 v16, 0, v16
    v_mul_f32 v16, v16, v153
    v_cvt_pk_bf16_f32 v16, 0, v16
    v_add_f32 v17, v17, v41
    v_cvt_pk_bf16_f32 v17, 0, v17
    v_mul_f32 v17, v17, v153
    v_cvt_pk_bf16_f32 v17, 0, v17
    v_add_f32 v18, v18, v42
    v_cvt_pk_bf16_f32 v18, 0, v18
    v_mul_f32 v18, v18, v153
    v_cvt_pk_bf16_f32 v18, 0, v18
    v_add_f32 v19, v19, v43
    v_cvt_pk_bf16_f32 v19, 0, v19
    v_mul_f32 v19, v19, v153
    v_cvt_pk_bf16_f32 v19, 0, v19
    v_add_f32 v20, v20, v44
    v_cvt_pk_bf16_f32 v20, 0, v20
    v_mul_f32 v20, v20, v153
    v_cvt_pk_bf16_f32 v20, 0, v20
    v_add_f32 v21, v21, v45
    v_cvt_pk_bf16_f32 v21, 0, v21
    v_mul_f32 v21, v21, v153
    v_cvt_pk_bf16_f32 v21, 0, v21
    v_add_f32 v22, v22, v46
    v_cvt_pk_bf16_f32 v22, 0, v22
    v_mul_f32 v22, v22, v153
    v_cvt_pk_bf16_f32 v22, 0, v22
    v_add_f32 v23, v23, v47
    v_cvt_pk_bf16_f32 v23, 0, v23
    v_mul_f32 v23, v23, v153
    v_cvt_pk_bf16_f32 v23, 0, v23
    v_add_f32 v24, v24, v48
    v_cvt_pk_bf16_f32 v24, 0, v24
    v_mul_f32 v24, v24, v153
    v_cvt_pk_bf16_f32 v24, 0, v24
    v_add_f32 v25, v25, v49
    v_cvt_pk_bf16_f32 v25, 0, v25
    v_mul_f32 v25, v25, v153
    v_cvt_pk_bf16_f32 v25, 0, v25
    v_add_f32 v26, v26, v50
    v_cvt_pk_bf16_f32 v26, 0, v26
    v_mul_f32 v26, v26, v153
    v_cvt_pk_bf16_f32 v26, 0, v26
    v_add_f32 v27, v27, v51
    v_cvt_pk_bf16_f32 v27, 0, v27
    v_mul_f32 v27, v27, v153
    v_cvt_pk_bf16_f32 v27, 0, v27
    v_add_f32 v28, v28, v52
    v_cvt_pk_bf16_f32 v28, 0, v28
    v_mul_f32 v28, v28, v153
    v_cvt_pk_bf16_f32 v28, 0, v28
    v_add_f32 v29, v29, v53
    v_cvt_pk_bf16_f32 v29, 0, v29
    v_mul_f32 v29, v29, v153
    v_cvt_pk_bf16_f32 v29, 0, v29
    v_add_f32 v30, v30, v54
    v_cvt_pk_bf16_f32 v30, 0, v30
    v_mul_f32 v30, v30, v153
    v_cvt_pk_bf16_f32 v30, 0, v30
    v_add_f32 v31, v31, v55
    v_cvt_pk_bf16_f32 v31, 0, v31
    v_mul_f32 v31, v31, v153
    v_cvt_pk_bf16_f32 v31, 0, v31
Q_nr:
    s_mov_b64 exec, s[68:69]
    s_waitcnt lgkmcnt(3)
    v_pk_add_f32 v[224:225], v[224:225], v[240:241]
    v_pk_add_f32 v[226:227], v[226:227], v[242:243]
    v_cvt_pk_bf16_f32 v40, v224, v225
    v_cvt_pk_bf16_f32 v41, v226, v227
    s_waitcnt lgkmcnt(2)
    v_pk_add_f32 v[228:229], v[228:229], v[244:245]
    v_pk_add_f32 v[230:231], v[230:231], v[246:247]
    v_cvt_pk_bf16_f32 v42, v228, v229
    v_cvt_pk_bf16_f32 v43, v230, v231
    s_waitcnt lgkmcnt(1)
    v_pk_add_f32 v[232:233], v[232:233], v[248:249]
    v_pk_add_f32 v[234:235], v[234:235], v[250:251]
    v_cvt_pk_bf16_f32 v44, v232, v233
    v_cvt_pk_bf16_f32 v45, v234, v235
    s_waitcnt lgkmcnt(0)
    v_pk_add_f32 v[236:237], v[236:237], v[252:253]
    v_pk_add_f32 v[238:239], v[238:239], v[254:255]
    v_cvt_pk_bf16_f32 v46, v236, v237
    v_cvt_pk_bf16_f32 v47, v238, v239
    s_nop 0
    v_permlane16_swap_b32 v40, v42
    v_permlane16_swap_b32 v41, v43
    v_permlane16_swap_b32 v44, v46
    v_permlane16_swap_b32 v45, v47
    v_lshlrev_b32 v224, 16, v40
    v_and_b32 v225, 0xffff0000, v40
    v_lshlrev_b32 v226, 16, v41
    v_and_b32 v227, 0xffff0000, v41
    v_lshlrev_b32 v228, 16, v42
    v_and_b32 v229, 0xffff0000, v42
    v_lshlrev_b32 v230, 16, v43
    v_and_b32 v231, 0xffff0000, v43
    v_pk_mul_f32 v[224:225], v[224:225], v[154:155]
    v_pk_mul_f32 v[226:227], v[226:227], v[154:155]
    v_pk_mul_f32 v[228:229], v[228:229], v[154:155]
    v_pk_mul_f32 v[230:231], v[230:231], v[154:155]
    v_cvt_pk_bf16_f32 v224, 0, v224
    v_cvt_pk_bf16_f32 v225, 0, v225
    v_cvt_pk_bf16_f32 v226, 0, v226
    v_cvt_pk_bf16_f32 v227, 0, v227
    v_cvt_pk_bf16_f32 v228, 0, v228
    v_cvt_pk_bf16_f32 v229, 0, v229
    v_cvt_pk_bf16_f32 v230, 0, v230
    v_cvt_pk_bf16_f32 v231, 0, v231
    v_pk_add_f32 v[224:225], v[224:225], v[16:17]
    v_pk_add_f32 v[226:227], v[226:227], v[18:19]
    v_pk_add_f32 v[228:229], v[228:229], v[20:21]
    v_pk_add_f32 v[230:231], v[230:231], v[22:23]
    v_cvt_pk_bf16_f32 v48, v224, v225
    v_cvt_pk_bf16_f32 v49, v226, v227
    v_cvt_pk_bf16_f32 v50, v228, v229
    v_cvt_pk_bf16_f32 v51, v230, v231
    buffer_store_dwordx4 v[48:51], v91, s[36:39], 0 offen offset:0 sc0 sc1
    v_lshlrev_b32 v232, 16, v44
    v_and_b32 v233, 0xffff0000, v44
    v_lshlrev_b32 v234, 16, v45
    v_and_b32 v235, 0xffff0000, v45
    v_lshlrev_b32 v236, 16, v46
    v_and_b32 v237, 0xffff0000, v46
    v_lshlrev_b32 v238, 16, v47
    v_and_b32 v239, 0xffff0000, v47
    v_pk_mul_f32 v[232:233], v[232:233], v[154:155]
    v_pk_mul_f32 v[234:235], v[234:235], v[154:155]
    v_pk_mul_f32 v[236:237], v[236:237], v[154:155]
    v_pk_mul_f32 v[238:239], v[238:239], v[154:155]
    v_cvt_pk_bf16_f32 v232, 0, v232
    v_cvt_pk_bf16_f32 v233, 0, v233
    v_cvt_pk_bf16_f32 v234, 0, v234
    v_cvt_pk_bf16_f32 v235, 0, v235
    v_cvt_pk_bf16_f32 v236, 0, v236
    v_cvt_pk_bf16_f32 v237, 0, v237
    v_cvt_pk_bf16_f32 v238, 0, v238
    v_cvt_pk_bf16_f32 v239, 0, v239
    v_pk_add_f32 v[232:233], v[232:233], v[24:25]
    v_pk_add_f32 v[234:235], v[234:235], v[26:27]
    v_pk_add_f32 v[236:237], v[236:237], v[28:29]
    v_pk_add_f32 v[238:239], v[238:239], v[30:31]
    v_cvt_pk_bf16_f32 v52, v232, v233
    v_cvt_pk_bf16_f32 v53, v234, v235
    v_cvt_pk_bf16_f32 v54, v236, v237
    v_cvt_pk_bf16_f32 v55, v238, v239
    buffer_store_dwordx4 v[52:55], v91, s[36:39], 0 offen offset:64 sc0 sc1
END:
    s_endpgm
Q_rt0:
    s_mov_b32 s59, 0
    s_add_u32 s67, s63, 0
    s_and_b32 s67, s67, 32767
Q_rl0:
    s_waitcnt vmcnt(0)
    s_add_u32 s59, s59, 1
    s_cmp_ge_u32 s59, 200000
    s_cbranch_scc1 Q_rd0
    s_sleep 1
    buffer_load_dwordx4 v[96:99], v3, s[16:19], s67 offen offset:0 sc1
    buffer_load_dwordx4 v[100:103], v4, s[16:19], s67 offen offset:0 sc1
    buffer_load_dwordx4 v[104:107], v3, s[16:19], s67 offen offset:1024 sc1
    buffer_load_dwordx4 v[108:111], v4, s[16:19], s67 offen offset:1024 sc1
    s_waitcnt vmcnt(0)
    v_max3_u32 v5, v96, v97, v98
    v_max3_u32 v5, v5, v99, v100
    v_max3_u32 v5, v5, v101, v102
    v_max3_u32 v5, v5, v103, v104
    v_max3_u32 v5, v5, v105, v106
    v_max3_u32 v5, v5, v107, v108
    v_max3_u32 v5, v5, v109, v110
    v_max_u32 v5, v5, v111
    v_cmp_eq_u32 vcc, -1, v5
    s_cbranch_vccnz Q_rl0
Q_rd0:
    s_add_u32 s67, s63, 4096
    s_and_b32 s67, s67, 32767
    buffer_load_dwordx4 v[112:115], v3, s[16:19], s67 offen offset:0 sc1
    buffer_load_dwordx4 v[116:119], v4, s[16:19], s67 offen offset:0 sc1
    buffer_load_dwordx4 v[120:123], v3, s[16:19], s67 offen offset:1024 sc1
    buffer_load_dwordx4 v[124:127], v4, s[16:19], s67 offen offset:1024 sc1
    s_branch Q_go0
Q_rt1:
    s_mov_b32 s59, 0
    s_add_u32 s67, s63, 4096
    s_and_b32 s67, s67, 32767
Q_rl1:
    s_waitcnt vmcnt(0)
    s_add_u32 s59, s59, 1
    s_cmp_ge_u32 s59, 200000
    s_cbranch_scc1 Q_rd1
    s_sleep 1
    buffer_load_dwordx4 v[112:115], v3, s[16:19], s67 offen offset:0 sc1
    buffer_load_dwordx4 v[116:119], v4, s[16:19], s67 offen offset:0 sc1
    buffer_load_dwordx4 v[120:123], v3, s[16:19], s67 offen offset:1024 sc1
    buffer_load_dwordx4 v[124:127], v4, s[16:19], s67 offen offset:1024 sc1
    s_waitcnt vmcnt(0)
    v_max3_u32 v5, v112, v113, v114
    v_max3_u32 v5, v5, v115, v116
    v_max3_u32 v5, v5, v117, v118
    v_max3_u32 v5, v5, v119, v120
    v_max3_u32 v5, v5, v121, v122
    v_max3_u32 v5, v5, v123, v124
    v_max3_u32 v5, v5, v125, v126
    v_max_u32 v5, v5, v127
    v_cmp_eq_u32 vcc, -1, v5
    s_cbranch_vccnz Q_rl1
Q_rd1:
    s_add_u32 s67, s63, 8192
    s_and_b32 s67, s67, 32767
    buffer_load_dwordx4 v[128:131], v3, s[16:19], s67 offen offset:0 sc1
    buffer_load_dwordx4 v[132:135], v4, s[16:19], s67 offen offset:0 sc1
    buffer_load_dwordx4 v[136:139], v3, s[16:19], s67 offen offset:1024 sc1
    buffer_load_dwordx4 v[140:143], v4, s[16:19], s67 offen offset:1024 sc1
    s_branch Q_go1
Q_rt2:
    s_mov_b32 s59, 0
    s_add_u32 s67, s63, 8192
    s_and_b32 s67, s67, 32767
Q_rl2:
    s_waitcnt vmcnt(0)
    s_add_u32 s59, s59, 1
    s_cmp_ge_u32 s59, 200000
    s_cbranch_scc1 Q_rd2
    s_sleep 1
    buffer_load_dwordx4 v[128:131], v3, s[16:19], s67 offen offset:0 sc1
    buffer_load_dwordx4 v[132:135], v4, s[16:19], s67 offen offset:0 sc1
    buffer_load_dwordx4 v[136:139], v3, s[16:19], s67 offen offset:1024 sc1
    buffer_load_dwordx4 v[140:143], v4, s[16:19], s67 offen offset:1024 sc1
    s_waitcnt vmcnt(0)
    v_max3_u32 v5, v128, v129, v130
    v_max3_u32 v5, v5, v131, v132
    v_max3_u32 v5, v5, v133, v134
    v_max3_u32 v5, v5, v135, v136
    v_max3_u32 v5, v5, v137, v138
    v_max3_u32 v5, v5, v139, v140
    v_max3_u32 v5, v5, v141, v142
    v_max_u32 v5, v5, v143
    v_cmp_eq_u32 vcc, -1, v5
    s_cbranch_vccnz Q_rl2
Q_rd2:
    s_add_u32 s67, s63, 12288
    s_and_b32 s67, s67, 32767
    buffer_load_dwordx4 v[96:99], v3, s[16:19], s67 offen offset:0 sc1
    buffer_load_dwordx4 v[100:103], v4, s[16:19], s67 offen offset:0 sc1
    buffer_load_dwordx4 v[104:107], v3, s[16:19], s67 offen offset:1024 sc1
    buffer_load_dwordx4 v[108:111], v4, s[16:19], s67 offen offset:1024 sc1
    s_branch Q_go2
Q_rt3:
    s_mov_b32 s59, 0
    s_add_u32 s67, s63, 12288
    s_and_b32 s67, s67, 32767
Q_rl3:
    s_waitcnt vmcnt(0)
    s_add_u32 s59, s59, 1
    s_cmp_ge_u32 s59, 200000
    s_cbranch_scc1 Q_rd3
    s_sleep 1
    buffer_load_dwordx4 v[96:99], v3, s[16:19], s67 offen offset:0 sc1
    buffer_load_dwordx4 v[100:103], v4, s[16:19], s67 offen offset:0 sc1
    buffer_load_dwordx4 v[104:107], v3, s[16:19], s67 offen offset:1024 sc1
    buffer_load_dwordx4 v[108:111], v4, s[16:19], s67 offen offset:1024 sc1
    s_waitcnt vmcnt(0)
    v_max3_u32 v5, v96, v97, v98
    v_max3_u32 v5, v5, v99, v100
    v_max3_u32 v5, v5, v101, v102
    v_max3_u32 v5, v5, v103, v104
    v_max3_u32 v5, v5, v105, v106
    v_max3_u32 v5, v5, v107, v108
    v_max3_u32 v5, v5, v109, v110
    v_max_u32 v5, v5, v111
    v_cmp_eq_u32 vcc, -1, v5
    s_cbranch_vccnz Q_rl3
Q_rd3:
    s_add_u32 s67, s63, 16384
    s_and_b32 s67, s67, 32767
    buffer_load_dwordx4 v[112:115], v3, s[16:19], s67 offen offset:0 sc1
    buffer_load_dwordx4 v[116:119], v4, s[16:19], s67 offen offset:0 sc1
    buffer_load_dwordx4 v[120:123], v3, s[16:19], s67 offen offset:1024 sc1
    buffer_load_dwordx4 v[124:127], v4, s[16:19], s67 offen offset:1024 sc1
    s_branch Q_go3
Q_rt4:
    s_mov_b32 s59, 0
    s_add_u32 s67, s63, 16384
    s_and_b32 s67, s67, 32767
Q_rl4:
    s_waitcnt vmcnt(0)
    s_add_u32 s59, s59, 1
    s_cmp_ge_u32 s59, 200000
    s_cbranch_scc1 Q_rd4
    s_sleep 1
    buffer_load_dwordx4 v[112:115], v3, s[16:19], s67 offen offset:0 sc1
    buffer_load_dwordx4 v[116:119], v4, s[16:19], s67 offen offset:0 sc1
    buffer_load_dwordx4 v[120:123], v3, s[16:19], s67 offen offset:1024 sc1
    buffer_load_dwordx4 v[124:127], v4, s[16:19], s67 offen offset:1024 sc1
    s_waitcnt vmcnt(0)
    v_max3_u32 v5, v112, v113, v114
    v_max3_u32 v5, v5, v115, v116
    v_max3_u32 v5, v5, v117, v118
    v_max3_u32 v5, v5, v119, v120
    v_max3_u32 v5, v5, v121, v122
    v_max3_u32 v5, v5, v123, v124
    v_max3_u32 v5, v5, v125, v126
    v_max_u32 v5, v5, v127
    v_cmp_eq_u32 vcc, -1, v5
    s_cbranch_vccnz Q_rl4
Q_rd4:
    s_add_u32 s67, s63, 20480
    s_and_b32 s67, s67, 32767
    buffer_load_dwordx4 v[128:131], v3, s[16:19], s67 offen offset:0 sc1
    buffer_load_dwordx4 v[132:135], v4, s[16:19], s67 offen offset:0 sc1
    buffer_load_dwordx4 v[136:139], v3, s[16:19], s67 offen offset:1024 sc1
    buffer_load_dwordx4 v[140:143], v4, s[16:19], s67 offen offset:1024 sc1
    s_branch Q_go4
Q_rt5:
    s_mov_b32 s59, 0
    s_add_u32 s67, s63, 20480
    s_and_b32 s67, s67, 32767
Q_rl5:
    s_waitcnt vmcnt(0)
    s_add_u32 s59, s59, 1
    s_cmp_ge_u32 s59, 200000
    s_cbranch_scc1 Q_rd5
    s_sleep 1
    buffer_load_dwordx4 v[128:131], v3, s[16:19], s67 offen offset:0 sc1
    buffer_load_dwordx4 v[132:135], v4, s[16:19], s67 offen offset:0 sc1
    buffer_load_dwordx4 v[136:139], v3, s[16:19], s67 offen offset:1024 sc1
    buffer_load_dwordx4 v[140:143], v4, s[16:19], s67 offen offset:1024 sc1
    s_waitcnt vmcnt(0)
    v_max3_u32 v5, v128, v129, v130
    v_max3_u32 v5, v5, v131, v132
    v_max3_u32 v5, v5, v133, v134
    v_max3_u32 v5, v5, v135, v136
    v_max3_u32 v5, v5, v137, v138
    v_max3_u32 v5, v5, v139, v140
    v_max3_u32 v5, v5, v141, v142
    v_max_u32 v5, v5, v143
    v_cmp_eq_u32 vcc, -1, v5
    s_cbranch_vccnz Q_rl5
Q_rd5:
    s_add_u32 s67, s63, 24576
    s_and_b32 s67, s67, 32767
    buffer_load_dwordx4 v[96:99], v3, s[16:19], s67 offen offset:0 sc1
    buffer_load_dwordx4 v[100:103], v4, s[16:19], s67 offen offset:0 sc1
    buffer_load_dwordx4 v[104:107], v3, s[16:19], s67 offen offset:1024 sc1
    buffer_load_dwordx4 v[108:111], v4, s[16:19], s67 offen offset:1024 sc1
    s_branch Q_go5
Q_rt6:
    s_mov_b32 s59, 0
    s_add_u32 s67, s63, 24576
    s_and_b32 s67, s67, 32767
Q_rl6:
    s_waitcnt vmcnt(0)
    s_add_u32 s59, s59, 1
    s_cmp_ge_u32 s59, 200000
    s_cbranch_scc1 Q_rd6
    s_sleep 1
    buffer_load_dwordx4 v[96:99], v3, s[16:19], s67 offen offset:0 sc1
    buffer_load_dwordx4 v[100:103], v4, s[16:19], s67 offen offset:0 sc1
    buffer_load_dwordx4 v[104:107], v3, s[16:19], s67 offen offset:1024 sc1
    buffer_load_dwordx4 v[108:111], v4, s[16:19], s67 offen offset:1024 sc1
    s_waitcnt vmcnt(0)
    v_max3_u32 v5, v96, v97, v98
    v_max3_u32 v5, v5, v99, v100
    v_max3_u32 v5, v5, v101, v102
    v_max3_u32 v5, v5, v103, v104
    v_max3_u32 v5, v5, v105, v106
    v_max3_u32 v5, v5, v107, v108
    v_max3_u32 v5, v5, v109, v110
    v_max_u32 v5, v5, v111
    v_cmp_eq_u32 vcc, -1, v5
    s_cbranch_vccnz Q_rl6
Q_rd6:
    s_add_u32 s67, s63, 28672
    s_and_b32 s67, s67, 32767
    buffer_load_dwordx4 v[112:115], v3, s[16:19], s67 offen offset:0 sc1
    buffer_load_dwordx4 v[116:119], v4, s[16:19], s67 offen offset:0 sc1
    buffer_load_dwordx4 v[120:123], v3, s[16:19], s67 offen offset:1024 sc1
    buffer_load_dwordx4 v[124:127], v4, s[16:19], s67 offen offset:1024 sc1
    s_branch Q_go6
Q_rt7:
    s_mov_b32 s59, 0
    s_add_u32 s67, s63, 28672
    s_and_b32 s67, s67, 32767
Q_rl7:
    s_waitcnt vmcnt(0)
    s_add_u32 s59, s59, 1
    s_cmp_ge_u32 s59, 200000
    s_cbranch_scc1 Q_rd7
    s_sleep 1
    buffer_load_dwordx4 v[112:115], v3, s[16:19], s67 offen offset:0 sc1
    buffer_load_dwordx4 v[116:119], v4, s[16:19], s67 offen offset:0 sc1
    buffer_load_dwordx4 v[120:123], v3, s[16:19], s67 offen offset:1024 sc1
    buffer_load_dwordx4 v[124:127], v4, s[16:19], s67 offen offset:1024 sc1
    s_waitcnt vmcnt(0)
    v_max3_u32 v5, v112, v113, v114
    v_max3_u32 v5, v5, v115, v116
    v_max3_u32 v5, v5, v117, v118
    v_max3_u32 v5, v5, v119, v120
    v_max3_u32 v5, v5, v121, v122
    v_max3_u32 v5, v5, v123, v124
    v_max3_u32 v5, v5, v125, v126
    v_max_u32 v5, v5, v127
    v_cmp_eq_u32 vcc, -1, v5
    s_cbranch_vccnz Q_rl7
Q_rd7:
    s_branch Q_go7
H_eps:
    s_waitcnt lgkmcnt(8)
    v_lshlrev_b32 v72, 16, v32
    v_and_b32 v73, 0xffff0000, v32
    v_add_f32 v72, s47, v72
    v_add_f32 v73, s47, v73
    v_cvt_pk_bf16_f32 v32, v72, v73
    v_lshlrev_b32 v72, 16, v33
    v_and_b32 v73, 0xffff0000, v33
    v_add_f32 v72, s47, v72
    v_add_f32 v73, s47, v73
    v_cvt_pk_bf16_f32 v33, v72, v73
    v_lshlrev_b32 v72, 16, v34
    v_and_b32 v73, 0xffff0000, v34
    v_add_f32 v72, s47, v72
    v_add_f32 v73, s47, v73
    v_cvt_pk_bf16_f32 v34, v72, v73
    v_lshlrev_b32 v72, 16, v35
    v_and_b32 v73, 0xffff0000, v35
    v_add_f32 v72, s47, v72
    v_add_f32 v73, s47, v73
    v_cvt_pk_bf16_f32 v35, v72, v73
    v_lshlrev_b32 v72, 16, v36
    v_and_b32 v73, 0xffff0000, v36
    v_add_f32 v72, s47, v72
    v_add_f32 v73, s47, v73
    v_cvt_pk_bf16_f32 v36, v72, v73
    v_lshlrev_b32 v72, 16, v37
    v_and_b32 v73, 0xffff0000, v37
    v_add_f32 v72, s47, v72
    v_add_f32 v73, s47, v73
    v_cvt_pk_bf16_f32 v37, v72, v73
    v_lshlrev_b32 v72, 16, v38
    v_and_b32 v73, 0xffff0000, v38
    v_add_f32 v72, s47, v72
    v_add_f32 v73, s47, v73
    v_cvt_pk_bf16_f32 v38, v72, v73
    v_lshlrev_b32 v72, 16, v39
    v_and_b32 v73, 0xffff0000, v39
    v_add_f32 v72, s47, v72
    v_add_f32 v73, s47, v73
    v_cvt_pk_bf16_f32 v39, v72, v73
    v_lshlrev_b32 v72, 16, v40
    v_and_b32 v73, 0xffff0000, v40
    v_add_f32 v72, s47, v72
    v_add_f32 v73, s47, v73
    v_cvt_pk_bf16_f32 v40, v72, v73
    v_lshlrev_b32 v72, 16, v41
    v_and_b32 v73, 0xffff0000, v41
    v_add_f32 v72, s47, v72
    v_add_f32 v73, s47, v73
    v_cvt_pk_bf16_f32 v41, v72, v73
    v_lshlrev_b32 v72, 16, v42
    v_and_b32 v73, 0xffff0000, v42
    v_add_f32 v72, s47, v72
    v_add_f32 v73, s47, v73
    v_cvt_pk_bf16_f32 v42, v72, v73
    v_lshlrev_b32 v72, 16, v43
    v_and_b32 v73, 0xffff0000, v43
    v_add_f32 v72, s47, v72
    v_add_f32 v73, s47, v73
    v_cvt_pk_bf16_f32 v43, v72, v73
    v_lshlrev_b32 v72, 16, v44
    v_and_b32 v73, 0xffff0000, v44
    v_add_f32 v72, s47, v72
    v_add_f32 v73, s47, v73
    v_cvt_pk_bf16_f32 v44, v72, v73
    v_lshlrev_b32 v72, 16, v45
    v_and_b32 v73, 0xffff0000, v45
    v_add_f32 v72, s47, v72
    v_add_f32 v73, s47, v73
    v_cvt_pk_bf16_f32 v45, v72, v73
    v_lshlrev_b32 v72, 16, v46
    v_and_b32 v73, 0xffff0000, v46
    v_add_f32 v72, s47, v72
    v_add_f32 v73, s47, v73
    v_cvt_pk_bf16_f32 v46, v72, v73
    v_lshlrev_b32 v72, 16, v47
    v_and_b32 v73, 0xffff0000, v47
    v_add_f32 v72, s47, v72
    v_add_f32 v73, s47, v73
    v_cvt_pk_bf16_f32 v47, v72, v73
    s_nop 1
    v_mfma_f32_16x16x32_bf16 v[200:203], v[32:35], v[204:207], 0
    s_waitcnt lgkmcnt(7)
    v_mfma_f32_16x16x32_bf16 v[192:195], v[32:35], v[208:211], 0
    s_waitcnt lgkmcnt(6)
    v_mfma_f32_16x16x32_bf16 v[196:199], v[32:35], v[212:215], 0
    v_mfma_f32_16x16x32_bf16 v[200:203], v[36:39], v[204:207], v[200:203]
    s_waitcnt lgkmcnt(5)
    v_mfma_f32_16x16x32_bf16 v[192:195], v[36:39], v[216:219], v[192:195]
    s_waitcnt lgkmcnt(4)
    v_mfma_f32_16x16x32_bf16 v[196:199], v[36:39], v[220:223], v[196:199]
    v_mfma_f32_16x16x32_bf16 v[200:203], v[40:43], v[204:207], v[200:203]
    s_waitcnt lgkmcnt(3)
    v_mfma_f32_16x16x32_bf16 v[192:195], v[40:43], v[224:227], v[192:195]
    s_waitcnt lgkmcnt(2)
    v_mfma_f32_16x16x32_bf16 v[196:199], v[40:43], v[228:231], v[196:199]
    v_mfma_f32_16x16x32_bf16 v[200:203], v[44:47], v[204:207], v[200:203]
    s_waitcnt lgkmcnt(1)
    v_mfma_f32_16x16x32_bf16 v[192:195], v[44:47], v[232:235], v[192:195]
    s_waitcnt lgkmcnt(0)
    v_mfma_f32_16x16x32_bf16 v[196:199], v[44:47], v[236:239], v[196:199]
    s_branch H_ne
CODE_END:
.section .rodata,"a"
.p2align 6
.amdhsa_kernel gated_mix__linear_attn_block__moe_arch_mod__prompt_kernel
  .amdhsa_next_free_vgpr 256
  .amdhsa_next_free_sgpr 102
  .amdhsa_accum_offset 256
  .amdhsa_group_segment_fixed_size 0
  .amdhsa_kernarg_size 96
  .amdhsa_user_sgpr_count 2
  .amdhsa_user_sgpr_kernarg_segment_ptr 1
  .amdhsa_system_sgpr_workgroup_id_x 1
.end_amdhsa_kernel
```
